```python
import torch

def _softmax(x, axis=-1):
    return torch.softmax(x, dim=axis)
def _gelu(x):
    return torch.nn.functional.gelu(x, approximate="tanh")
def _silu(x):
    return torch.nn.functional.silu(x)
def _sigmoid(x):
    return torch.sigmoid(x)
def _layernorm(x, axis=-1, eps=1e-5):
    m = x.mean(dim=axis, keepdim=True)
    v = x.var(dim=axis, keepdim=True, unbiased=False)
    return (x - m) / torch.sqrt(v + eps)
def _scatter_add(tgt, idx, src, axis=0):
    return tgt.clone().index_add_(axis, idx, src)
def _segment_sum(src, seg, n):
    out = torch.zeros((n,) + src.shape[1:], dtype=src.dtype)
    return out.index_add_(0, seg, src)
def _pad(x, pw):
    flat = tuple(v for pair in reversed(pw) for v in pair)
    return torch.nn.functional.pad(x, flat)

kernel_name = 'gated_mix__ssm_conv_s5__ssm_conv_h3__prompt'

def setup_inputs():

    _w = (lambda a: (lambda t: t.to(torch.bfloat16) if t.is_floating_point() else t)(torch.as_tensor(a)))
    def _A_setup():
        B, S, D = 1, 2048, 1024
        P = D
        Lambda_re = -0.5 * (lambda _x: torch.exp(torch.as_tensor(_x)))((lambda *s: torch.randn(*s, dtype=torch.bfloat16) * 0.2)(P))
        Lambda_im = (lambda *s: torch.randn(*s, dtype=torch.bfloat16) * 0.4)(P) * 1.0
        B_re = (lambda *s: torch.randn(*s, dtype=torch.bfloat16) * 0.2)(P, D) * (D ** -0.5)
        B_im = (lambda *s: torch.randn(*s, dtype=torch.bfloat16) * 0.2)(P, D) * (D ** -0.5)
        C_re = (lambda *s: torch.randn(*s, dtype=torch.bfloat16) * 0.2)(D, P) * (P ** -0.5)
        C_im = (lambda *s: torch.randn(*s, dtype=torch.bfloat16) * 0.2)(D, P) * (P ** -0.5)
        log_dt = (lambda *s: torch.randn(*s, dtype=torch.bfloat16) * 0.2)(P) * 0.3 - 2.0
        Dskip = (lambda *s: torch.randn(*s, dtype=torch.bfloat16) * 0.05)(D)
        return {
            "x": _w((lambda *s: torch.randn(*s, dtype=torch.bfloat16) * 0.05)(B, S, D)),
            "Lambda_re": _w(Lambda_re),
            "Lambda_im": _w(Lambda_im),
            "B_re": _w(B_re),
            "B_im": _w(B_im),
            "C_re": _w(C_re),
            "C_im": _w(C_im),
            "log_dt": _w(log_dt),
            "Dskip": _w(Dskip),
        }
    _A_in = _A_setup()

    def _B_setup():
        B, S, D = 1, 2048, 1024
        ks = 4
        return {
            "q": _w((lambda *s: torch.randn(*s, dtype=torch.bfloat16) * 0.05)(B, S, D)),
            "k": _w((lambda *s: torch.randn(*s, dtype=torch.bfloat16) * 0.4)(B, S, D)),
            "v": _w((lambda *s: torch.randn(*s, dtype=torch.bfloat16) * 0.2)(B, S, D)),
            "shift_k": _w((lambda *s: torch.randn(*s, dtype=torch.bfloat16) * 0.4)(D, ks) * 0.5),
            "ssm_k": _w((lambda *s: torch.randn(*s, dtype=torch.bfloat16) * 0.4)(D, S) * (1.0 / S ** 0.5)),
            "ssm_D": _w((lambda *s: torch.randn(*s, dtype=torch.bfloat16) * 0.2)(D)),
        }
    _B_in = _B_setup()

    return {
        "A_x": _A_in["x"],
        "A_Lambda_re": _A_in["Lambda_re"],
        "A_Lambda_im": _A_in["Lambda_im"],
        "A_B_re": _A_in["B_re"],
        "A_B_im": _A_in["B_im"],
        "A_C_re": _A_in["C_re"],
        "A_C_im": _A_in["C_im"],
        "A_log_dt": _A_in["log_dt"],
        "A_Dskip": _A_in["Dskip"],
        "B_q": _B_in["q"],
        "B_k": _B_in["k"],
        "B_v": _B_in["v"],
        "B_shift_k": _B_in["shift_k"],
        "B_ssm_k": _B_in["ssm_k"],
        "B_ssm_D": _B_in["ssm_D"],
        "gate_w": _w((lambda *s: torch.randn(*s, dtype=torch.bfloat16) * 0.05)(1024) * 16.0),
    }

def reference(A_x, A_Lambda_re, A_Lambda_im, A_B_re, A_B_im, A_C_re, A_C_im, A_log_dt, A_Dskip, B_q, B_k, B_v, B_shift_k, B_ssm_k, B_ssm_D, gate_w):
    def _A_ref(x, Lambda_re, Lambda_im, B_re, B_im, C_re, C_im, log_dt, Dskip):
        Bsz, L, H = x.shape
        Lam = Lambda_re + 1j * Lambda_im
        Bmat = B_re + 1j * B_im
        Cmat = C_re + 1j * C_im
        dt = torch.exp(log_dt)
        Lam_bar = torch.exp(dt * Lam)
        B_bar = ((Lam_bar - 1.0) / Lam)[:, None] * Bmat
        Bu = torch.einsum("bld,pd->blp", x + 0j, B_bar)
        h = torch.zeros_like(Bu[:, 0, :])
        hs = []
        for t in range(L):
            h = Lam_bar[None, :] * h + Bu[:, t, :]
            hs.append(h)
        hseq = torch.stack(hs, 1)
        y = 2.0 * torch.einsum("blp,dp->bld", hseq, Cmat).real + x * Dskip[None, None, :]
        return y

    def _B_ref(q, k, v, shift_k, ssm_k, ssm_D):
        B, S, D = q.shape
        ks = shift_k.shape[-1]
        k_pad = _pad(k, ((0, 0), (ks - 1, 0), (0, 0)))
        k_shift = torch.zeros_like(k)
        for t in range(ks):
            k_shift = k_shift + k_pad[:, t:t + S, :] * shift_k[:, ks - 1 - t][None, None, :]
        kv = k_shift * v
        L = 2 * S
        kv_pad = _pad(kv, ((0, 0), (0, S), (0, 0)))
        kf_pad = _pad(ssm_k, ((0, 0), (0, S)))
        kv_f = (lambda x, axes=(-2,-1): torch.fft.rfft2(x.float(), dim=axes))(kv_pad[:, None, :, :], axes=(1, 2))
        kf_f = (lambda x, axes=(-2,-1): torch.fft.rfft2(x.float(), dim=axes))(kf_pad[:, None, :], axes=(1, 2))
        kf_f = (lambda x, *d: x.permute(*d))(kf_f, 1, 2, 0)
        y_f = kv_f * kf_f[None, :, :, :]
        y = (lambda x, s, axes=(-2,-1): torch.fft.irfft2(x, s=s, dim=axes).to(torch.bfloat16))(y_f, (1, L), axes=(1, 2))[:, 0, :S, :]
        y = y + kv * ssm_D[None, None, :]
        return q * y

    x = A_x
    g = _sigmoid((x * gate_w).sum(-1, keepdims=True))
    a = _A_ref(x, A_Lambda_re, A_Lambda_im, A_B_re, A_B_im, A_C_re, A_C_im, A_log_dt, A_Dskip)
    b = _B_ref(x, B_k, B_v, B_shift_k, B_ssm_k, B_ssm_D)
    return g * a + (1 - g) * b
```

```asm
; @launch kernel=prep_kernel grid=(256,1,1) block=(256,1,1) lds=16384
; @launch kernel=g1_kernel grid=(256,1,1) block=(256,1,1) lds=138240
; @launch kernel=conv_kernel grid=(256,1,1) block=(256,1,1) lds=84992
; @launch kernel=g2_kernel grid=(256,1,1) block=(256,1,1) lds=98304
.amdgcn_target "amdgcn-amd-amdhsa--gfx950"
.text
.globl prep_kernel
.p2align 8
.type prep_kernel,@function
prep_kernel:
    s_cmp_ge_u32 s2, 256
    s_cbranch_scc1 Lend_prep_kernel
    s_load_dwordx2 s[4:5], s[0:1], 0
    s_load_dwordx2 s[6:7], s[0:1], 80
    s_load_dwordx2 s[8:9], s[0:1], 88
    s_load_dwordx2 s[10:11], s[0:1], 96
    s_load_dwordx2 s[12:13], s[0:1], 120
    s_load_dwordx2 s[14:15], s[0:1], 40
    s_load_dwordx2 s[16:17], s[0:1], 48
    s_load_dwordx2 s[18:19], s[0:1], 144
    v_lshrrev_b32 v1, 6, v0
    s_nop 0
    v_readfirstlane_b32 s20, v1
    v_and_b32 v1, 63, v0
    s_and_b32 s23, s2, 7
    s_lshr_b32 s21, s23, 1
    s_lshl_b32 s21, s21, 2
    s_and_b32 s22, s23, 1
    s_lshl_b32 s22, s22, 3
    s_lshr_b32 s23, s2, 3
    s_and_b32 s3, s23, 3
    s_add_u32 s21, s21, s3
    s_lshr_b32 s23, s23, 2
    s_add_u32 s22, s22, s23
    s_and_b32 s25, s2, 7
    s_lshr_b32 s23, s25, 1
    s_lshl_b32 s23, s23, 3
    s_and_b32 s24, s25, 1
    s_lshl_b32 s24, s24, 2
    s_lshr_b32 s25, s2, 3
    s_and_b32 s3, s25, 7
    s_add_u32 s23, s23, s3
    s_lshr_b32 s25, s25, 3
    s_add_u32 s24, s24, s25
    s_waitcnt lgkmcnt(0)
    s_mov_b32 s28, s6
    s_mov_b32 s29, s7
    s_mov_b32 s30, 4194304
    s_mov_b32 s31, 131072
    s_mov_b32 s32, s8
    s_mov_b32 s33, s9
    s_mov_b32 s34, 4194304
    s_mov_b32 s35, 131072
    s_mov_b32 s36, s10
    s_mov_b32 s37, s11
    s_mov_b32 s38, 8192
    s_mov_b32 s39, 131072
    s_add_u32 s40, s18, 8388608
    s_addc_u32 s41, s19, 0
    s_mov_b32 s42, 4194304
    s_mov_b32 s43, 131072
    s_mov_b32 s25, 0xffff0000
    v_and_b32 v2, 7, v1
    v_lshrrev_b32 v3, 3, v0
    s_lshl_b32 s3, s22, 7
    v_lshl_add_u32 v4, v2, 4, s3
    s_lshl_b32 s3, s21, 18
    v_lshl_add_u32 v5, v3, 13, v4
    v_add_u32 v5, s3, v5
    v_subrev_u32 v6, 6144, v5
    v_min_u32 v6, 0x7fff0000, v6
    v_subrev_u32 v7, 4096, v5
    v_min_u32 v7, 0x7fff0000, v7
    v_subrev_u32 v8, 2048, v5
    v_min_u32 v8, 0x7fff0000, v8
    v_lshlrev_b32 v9, 2, v4
    s_mov_b32 s26, 4096
    v_sub_u32 v3, 31, v3
    v_lshlrev_b32 v4, 1, v2
    v_xor_b32 v3, v3, v4
    v_lshlrev_b32 v3, 3, v3
    v_lshl_add_u32 v10, v2, 11, v3
    v_add_u32 v10, 0, v10
    v_and_b32 v14, 15, v1
    v_lshrrev_b32 v4, 4, v1
    s_lshl_b32 s3, s20, 1
    v_xor_b32 v3, s3, v14
    v_lshlrev_b32 v3, 4, v3
    v_lshl_add_u32 v11, v4, 8, v3
    v_xor_b32 v3, s3, v14
    v_xor_b32 v3, 1, v3
    v_lshlrev_b32 v3, 4, v3
    v_lshl_add_u32 v12, v4, 8, v3
    s_lshl_b32 s3, s20, 12
    s_add_u32 s3, s3, 0
    v_add_u32 v11, s3, v11
    s_add_u32 s3, s3, 2048
    v_add_u32 v12, s3, v12
    v_lshlrev_b32 v14, 4, v14
    v_lshl_add_u32 v13, v4, 12, v14
    s_lshl_b32 s27, s22, 18
    s_lshl_b32 s3, s20, 16
    s_add_u32 s27, s27, s3
    s_add_u32 s27, s27, 3840
    s_lshl_b32 s3, s21, 8
    s_sub_u32 s27, s27, s3
    buffer_load_dwordx4 v[58:61], v9, s[36:39], 0 offen offset:0
    buffer_load_dwordx4 v[62:65], v9, s[36:39], 0 offen offset:16
    buffer_load_dwordx4 v[66:69], v9, s[36:39], 0 offen offset:32
    buffer_load_dwordx4 v[70:73], v9, s[36:39], 0 offen offset:48
    buffer_load_dwordx4 v[14:17], v6, s[28:31], 0 offen
    buffer_load_dwordx4 v[18:21], v7, s[28:31], 0 offen
    buffer_load_dwordx4 v[22:25], v8, s[28:31], 0 offen
    buffer_load_dwordx4 v[26:29], v5, s[28:31], 0 offen offset:0
    buffer_load_dwordx4 v[30:33], v5, s[28:31], 0 offen offset:2048
    buffer_load_dwordx4 v[34:37], v5, s[28:31], s26 offen offset:0
    buffer_load_dwordx4 v[38:41], v5, s[28:31], s26 offen offset:2048
    buffer_load_dwordx4 v[42:45], v5, s[32:35], 0 offen offset:0
    buffer_load_dwordx4 v[46:49], v5, s[32:35], 0 offen offset:2048
    buffer_load_dwordx4 v[50:53], v5, s[32:35], s26 offen offset:0
    buffer_load_dwordx4 v[54:57], v5, s[32:35], s26 offen offset:2048
    s_cmp_lt_u32 s23, 16
    s_cselect_b32 s44, s14, s16
    s_cselect_b32 s45, s15, s17
    s_mov_b32 s46, 2097152
    s_mov_b32 s47, 131072
    s_add_u32 s48, s18, 16777216
    s_addc_u32 s49, s19, 0
    s_mov_b32 s50, 4194304
    s_mov_b32 s51, 131072
    v_lshrrev_b32 v89, 3, v1
    v_and_b32 v92, 7, v1
    v_lshlrev_b32 v3, 4, v92
    v_lshl_add_u32 v3, v89, 11, v3
    v_lshlrev_b32 v4, 4, v89
    v_lshl_add_u32 v4, v92, 9, v4
    s_lshl_b32 s52, s24, 18
    s_lshl_b32 s3, s20, 16
    s_add_u32 s52, s52, s3
    s_and_b32 s3, s23, 15
    s_lshl_b32 s3, s3, 7
    s_add_u32 s52, s52, s3
    s_lshl_b32 s53, s24, 19
    s_lshl_b32 s3, s20, 17
    s_add_u32 s53, s53, s3
    s_lshl_b32 s3, s23, 12
    s_add_u32 s53, s53, s3
    buffer_load_dwordx4 v[92:95], v3, s[44:47], s52 offen
    s_add_u32 s52, s52, 16384
    buffer_load_dwordx4 v[96:99], v3, s[44:47], s52 offen
    s_add_u32 s52, s52, 16384
    buffer_load_dwordx4 v[100:103], v3, s[44:47], s52 offen
    s_add_u32 s52, s52, 16384
    buffer_load_dwordx4 v[104:107], v3, s[44:47], s52 offen
    s_mov_b32 s56, s4
    s_mov_b32 s57, s5
    s_mov_b32 s58, 4194304
    s_mov_b32 s59, 131072
    s_mov_b32 s60, s12
    s_mov_b32 s61, s13
    s_mov_b32 s62, 2048
    s_mov_b32 s63, 131072
    s_add_u32 s64, s18, 20971520
    s_addc_u32 s65, s19, 0
    s_mov_b32 s66, 16384
    s_mov_b32 s67, 131072
    v_lshlrev_b32 v89, 4, v1
    s_lshl_b32 s54, s21, 7
    s_lshl_b32 s3, s22, 3
    s_add_u32 s54, s54, s3
    s_lshl_b32 s3, s20, 1
    s_add_u32 s54, s54, s3
    s_lshl_b32 s3, s54, 2
    v_mov_b32 v108, s3
    s_lshl_b32 s54, s54, 11
    s_mov_b32 s55, 8192
    buffer_load_dwordx4 v[126:129], v89, s[60:63], 0 offen offset:0
    buffer_load_dwordx4 v[130:133], v89, s[60:63], 0 offen offset:1024
    buffer_load_dwordx4 v[110:113], v89, s[56:59], s54 offen offset:0
    buffer_load_dwordx4 v[114:117], v89, s[56:59], s54 offen offset:1024
    buffer_load_dwordx4 v[118:121], v89, s[56:59], s54 offen offset:2048
    buffer_load_dwordx4 v[122:125], v89, s[56:59], s54 offen offset:3072
    s_waitcnt vmcnt(24)
    v_lshlrev_b32 v74, 16, v58
    v_and_b32 v75, s25, v58
    v_lshlrev_b32 v76, 16, v59
    v_and_b32 v77, s25, v59
    s_waitcnt vmcnt(20)
    v_lshlrev_b32 v78, 16, v14
    s_waitcnt vmcnt(19)
    v_lshlrev_b32 v79, 16, v18
    s_waitcnt vmcnt(18)
    v_lshlrev_b32 v80, 16, v22
    s_waitcnt vmcnt(17)
    v_lshlrev_b32 v81, 16, v26
    s_waitcnt vmcnt(16)
    v_lshlrev_b32 v82, 16, v30
    s_waitcnt vmcnt(15)
    v_lshlrev_b32 v83, 16, v34
    s_waitcnt vmcnt(14)
    v_lshlrev_b32 v84, 16, v38
    v_mul_f32 v85, v77, v78
    v_mul_f32 v86, v77, v79
    v_mul_f32 v87, v77, v80
    v_mul_f32 v88, v77, v81
    v_fmac_f32 v85, v76, v79
    v_fmac_f32 v86, v76, v80
    v_fmac_f32 v87, v76, v81
    v_fmac_f32 v88, v76, v82
    v_fmac_f32 v85, v75, v80
    v_fmac_f32 v86, v75, v81
    v_fmac_f32 v87, v75, v82
    v_fmac_f32 v88, v75, v83
    v_fmac_f32 v85, v74, v81
    v_fmac_f32 v86, v74, v82
    v_fmac_f32 v87, v74, v83
    v_fmac_f32 v88, v74, v84
    s_waitcnt vmcnt(13)
    v_lshlrev_b32 v78, 16, v42
    s_waitcnt vmcnt(12)
    v_lshlrev_b32 v79, 16, v46
    s_waitcnt vmcnt(11)
    v_lshlrev_b32 v80, 16, v50
    s_waitcnt vmcnt(10)
    v_lshlrev_b32 v81, 16, v54
    v_mul_f32 v85, v85, v78
    v_mul_f32 v86, v86, v79
    v_mul_f32 v87, v87, v80
    v_mul_f32 v88, v88, v81
    v_cvt_pk_bf16_f32 v90, v88, v87
    v_cvt_pk_bf16_f32 v91, v86, v85
    ds_write_b64 v10, v[90:91] offset:0
    v_lshlrev_b32 v74, 16, v60
    v_and_b32 v75, s25, v60
    v_lshlrev_b32 v76, 16, v61
    v_and_b32 v77, s25, v61
    v_and_b32 v78, s25, v14
    v_and_b32 v79, s25, v18
    v_and_b32 v80, s25, v22
    v_and_b32 v81, s25, v26
    v_and_b32 v82, s25, v30
    v_and_b32 v83, s25, v34
    v_and_b32 v84, s25, v38
    v_mul_f32 v85, v77, v78
    v_mul_f32 v86, v77, v79
    v_mul_f32 v87, v77, v80
    v_mul_f32 v88, v77, v81
    v_fmac_f32 v85, v76, v79
    v_fmac_f32 v86, v76, v80
    v_fmac_f32 v87, v76, v81
    v_fmac_f32 v88, v76, v82
    v_fmac_f32 v85, v75, v80
    v_fmac_f32 v86, v75, v81
    v_fmac_f32 v87, v75, v82
    v_fmac_f32 v88, v75, v83
    v_fmac_f32 v85, v74, v81
    v_fmac_f32 v86, v74, v82
    v_fmac_f32 v87, v74, v83
    v_fmac_f32 v88, v74, v84
    v_and_b32 v78, s25, v42
    v_and_b32 v79, s25, v46
    v_and_b32 v80, s25, v50
    v_and_b32 v81, s25, v54
    v_mul_f32 v85, v85, v78
    v_mul_f32 v86, v86, v79
    v_mul_f32 v87, v87, v80
    v_mul_f32 v88, v88, v81
    v_cvt_pk_bf16_f32 v90, v88, v87
    v_cvt_pk_bf16_f32 v91, v86, v85
    ds_write_b64 v10, v[90:91] offset:256
    v_lshlrev_b32 v74, 16, v62
    v_and_b32 v75, s25, v62
    v_lshlrev_b32 v76, 16, v63
    v_and_b32 v77, s25, v63
    v_lshlrev_b32 v78, 16, v15
    v_lshlrev_b32 v79, 16, v19
    v_lshlrev_b32 v80, 16, v23
    v_lshlrev_b32 v81, 16, v27
    v_lshlrev_b32 v82, 16, v31
    v_lshlrev_b32 v83, 16, v35
    v_lshlrev_b32 v84, 16, v39
    v_mul_f32 v85, v77, v78
    v_mul_f32 v86, v77, v79
    v_mul_f32 v87, v77, v80
    v_mul_f32 v88, v77, v81
    v_fmac_f32 v85, v76, v79
    v_fmac_f32 v86, v76, v80
    v_fmac_f32 v87, v76, v81
    v_fmac_f32 v88, v76, v82
    v_fmac_f32 v85, v75, v80
    v_fmac_f32 v86, v75, v81
    v_fmac_f32 v87, v75, v82
    v_fmac_f32 v88, v75, v83
    v_fmac_f32 v85, v74, v81
    v_fmac_f32 v86, v74, v82
    v_fmac_f32 v87, v74, v83
    v_fmac_f32 v88, v74, v84
    v_lshlrev_b32 v78, 16, v43
    v_lshlrev_b32 v79, 16, v47
    v_lshlrev_b32 v80, 16, v51
    v_lshlrev_b32 v81, 16, v55
    v_mul_f32 v85, v85, v78
    v_mul_f32 v86, v86, v79
    v_mul_f32 v87, v87, v80
    v_mul_f32 v88, v88, v81
    v_cvt_pk_bf16_f32 v90, v88, v87
    v_cvt_pk_bf16_f32 v91, v86, v85
    ds_write_b64 v10, v[90:91] offset:512
    v_lshlrev_b32 v74, 16, v64
    v_and_b32 v75, s25, v64
    v_lshlrev_b32 v76, 16, v65
    v_and_b32 v77, s25, v65
    v_and_b32 v78, s25, v15
    v_and_b32 v79, s25, v19
    v_and_b32 v80, s25, v23
    v_and_b32 v81, s25, v27
    v_and_b32 v82, s25, v31
    v_and_b32 v83, s25, v35
    v_and_b32 v84, s25, v39
    v_mul_f32 v85, v77, v78
    v_mul_f32 v86, v77, v79
    v_mul_f32 v87, v77, v80
    v_mul_f32 v88, v77, v81
    v_fmac_f32 v85, v76, v79
    v_fmac_f32 v86, v76, v80
    v_fmac_f32 v87, v76, v81
    v_fmac_f32 v88, v76, v82
    v_fmac_f32 v85, v75, v80
    v_fmac_f32 v86, v75, v81
    v_fmac_f32 v87, v75, v82
    v_fmac_f32 v88, v75, v83
    v_fmac_f32 v85, v74, v81
    v_fmac_f32 v86, v74, v82
    v_fmac_f32 v87, v74, v83
    v_fmac_f32 v88, v74, v84
    v_and_b32 v78, s25, v43
    v_and_b32 v79, s25, v47
    v_and_b32 v80, s25, v51
    v_and_b32 v81, s25, v55
    v_mul_f32 v85, v85, v78
    v_mul_f32 v86, v86, v79
    v_mul_f32 v87, v87, v80
    v_mul_f32 v88, v88, v81
    v_cvt_pk_bf16_f32 v90, v88, v87
    v_cvt_pk_bf16_f32 v91, v86, v85
    ds_write_b64 v10, v[90:91] offset:768
    v_lshlrev_b32 v74, 16, v66
    v_and_b32 v75, s25, v66
    v_lshlrev_b32 v76, 16, v67
    v_and_b32 v77, s25, v67
    v_lshlrev_b32 v78, 16, v16
    v_lshlrev_b32 v79, 16, v20
    v_lshlrev_b32 v80, 16, v24
    v_lshlrev_b32 v81, 16, v28
    v_lshlrev_b32 v82, 16, v32
    v_lshlrev_b32 v83, 16, v36
    v_lshlrev_b32 v84, 16, v40
    v_mul_f32 v85, v77, v78
    v_mul_f32 v86, v77, v79
    v_mul_f32 v87, v77, v80
    v_mul_f32 v88, v77, v81
    v_fmac_f32 v85, v76, v79
    v_fmac_f32 v86, v76, v80
    v_fmac_f32 v87, v76, v81
    v_fmac_f32 v88, v76, v82
    v_fmac_f32 v85, v75, v80
    v_fmac_f32 v86, v75, v81
    v_fmac_f32 v87, v75, v82
    v_fmac_f32 v88, v75, v83
    v_fmac_f32 v85, v74, v81
    v_fmac_f32 v86, v74, v82
    v_fmac_f32 v87, v74, v83
    v_fmac_f32 v88, v74, v84
    v_lshlrev_b32 v78, 16, v44
    v_lshlrev_b32 v79, 16, v48
    v_lshlrev_b32 v80, 16, v52
    v_lshlrev_b32 v81, 16, v56
    v_mul_f32 v85, v85, v78
    v_mul_f32 v86, v86, v79
    v_mul_f32 v87, v87, v80
    v_mul_f32 v88, v88, v81
    v_cvt_pk_bf16_f32 v90, v88, v87
    v_cvt_pk_bf16_f32 v91, v86, v85
    ds_write_b64 v10, v[90:91] offset:1024
    v_lshlrev_b32 v74, 16, v68
    v_and_b32 v75, s25, v68
    v_lshlrev_b32 v76, 16, v69
    v_and_b32 v77, s25, v69
    v_and_b32 v78, s25, v16
    v_and_b32 v79, s25, v20
    v_and_b32 v80, s25, v24
    v_and_b32 v81, s25, v28
    v_and_b32 v82, s25, v32
    v_and_b32 v83, s25, v36
    v_and_b32 v84, s25, v40
    v_mul_f32 v85, v77, v78
    v_mul_f32 v86, v77, v79
    v_mul_f32 v87, v77, v80
    v_mul_f32 v88, v77, v81
    v_fmac_f32 v85, v76, v79
    v_fmac_f32 v86, v76, v80
    v_fmac_f32 v87, v76, v81
    v_fmac_f32 v88, v76, v82
    v_fmac_f32 v85, v75, v80
    v_fmac_f32 v86, v75, v81
    v_fmac_f32 v87, v75, v82
    v_fmac_f32 v88, v75, v83
    v_fmac_f32 v85, v74, v81
    v_fmac_f32 v86, v74, v82
    v_fmac_f32 v87, v74, v83
    v_fmac_f32 v88, v74, v84
    v_and_b32 v78, s25, v44
    v_and_b32 v79, s25, v48
    v_and_b32 v80, s25, v52
    v_and_b32 v81, s25, v56
    v_mul_f32 v85, v85, v78
    v_mul_f32 v86, v86, v79
    v_mul_f32 v87, v87, v80
    v_mul_f32 v88, v88, v81
    v_cvt_pk_bf16_f32 v90, v88, v87
    v_cvt_pk_bf16_f32 v91, v86, v85
    ds_write_b64 v10, v[90:91] offset:1280
    v_lshlrev_b32 v74, 16, v70
    v_and_b32 v75, s25, v70
    v_lshlrev_b32 v76, 16, v71
    v_and_b32 v77, s25, v71
    v_lshlrev_b32 v78, 16, v17
    v_lshlrev_b32 v79, 16, v21
    v_lshlrev_b32 v80, 16, v25
    v_lshlrev_b32 v81, 16, v29
    v_lshlrev_b32 v82, 16, v33
    v_lshlrev_b32 v83, 16, v37
    v_lshlrev_b32 v84, 16, v41
    v_mul_f32 v85, v77, v78
    v_mul_f32 v86, v77, v79
    v_mul_f32 v87, v77, v80
    v_mul_f32 v88, v77, v81
    v_fmac_f32 v85, v76, v79
    v_fmac_f32 v86, v76, v80
    v_fmac_f32 v87, v76, v81
    v_fmac_f32 v88, v76, v82
    v_fmac_f32 v85, v75, v80
    v_fmac_f32 v86, v75, v81
    v_fmac_f32 v87, v75, v82
    v_fmac_f32 v88, v75, v83
    v_fmac_f32 v85, v74, v81
    v_fmac_f32 v86, v74, v82
    v_fmac_f32 v87, v74, v83
    v_fmac_f32 v88, v74, v84
    v_lshlrev_b32 v78, 16, v45
    v_lshlrev_b32 v79, 16, v49
    v_lshlrev_b32 v80, 16, v53
    v_lshlrev_b32 v81, 16, v57
    v_mul_f32 v85, v85, v78
    v_mul_f32 v86, v86, v79
    v_mul_f32 v87, v87, v80
    v_mul_f32 v88, v88, v81
    v_cvt_pk_bf16_f32 v90, v88, v87
    v_cvt_pk_bf16_f32 v91, v86, v85
    ds_write_b64 v10, v[90:91] offset:1536
    v_lshlrev_b32 v74, 16, v72
    v_and_b32 v75, s25, v72
    v_lshlrev_b32 v76, 16, v73
    v_and_b32 v77, s25, v73
    v_and_b32 v78, s25, v17
    v_and_b32 v79, s25, v21
    v_and_b32 v80, s25, v25
    v_and_b32 v81, s25, v29
    v_and_b32 v82, s25, v33
    v_and_b32 v83, s25, v37
    v_and_b32 v84, s25, v41
    v_mul_f32 v85, v77, v78
    v_mul_f32 v86, v77, v79
    v_mul_f32 v87, v77, v80
    v_mul_f32 v88, v77, v81
    v_fmac_f32 v85, v76, v79
    v_fmac_f32 v86, v76, v80
    v_fmac_f32 v87, v76, v81
    v_fmac_f32 v88, v76, v82
    v_fmac_f32 v85, v75, v80
    v_fmac_f32 v86, v75, v81
    v_fmac_f32 v87, v75, v82
    v_fmac_f32 v88, v75, v83
    v_fmac_f32 v85, v74, v81
    v_fmac_f32 v86, v74, v82
    v_fmac_f32 v87, v74, v83
    v_fmac_f32 v88, v74, v84
    v_and_b32 v78, s25, v45
    v_and_b32 v79, s25, v49
    v_and_b32 v80, s25, v53
    v_and_b32 v81, s25, v57
    v_mul_f32 v85, v85, v78
    v_mul_f32 v86, v86, v79
    v_mul_f32 v87, v87, v80
    v_mul_f32 v88, v88, v81
    v_cvt_pk_bf16_f32 v90, v88, v87
    v_cvt_pk_bf16_f32 v91, v86, v85
    ds_write_b64 v10, v[90:91] offset:1792
    s_waitcnt vmcnt(9)
    buffer_store_dwordx4 v[92:95], v4, s[48:51], s53 offen offset:0 sc0 sc1
    s_waitcnt vmcnt(9)
    buffer_store_dwordx4 v[96:99], v4, s[48:51], s53 offen offset:128 sc0 sc1
    s_waitcnt vmcnt(9)
    buffer_store_dwordx4 v[100:103], v4, s[48:51], s53 offen offset:256 sc0 sc1
    s_waitcnt vmcnt(9)
    buffer_store_dwordx4 v[104:107], v4, s[48:51], s53 offen offset:384 sc0 sc1
    s_waitcnt vmcnt(9)
    v_lshlrev_b32 v136, 16, v126
    v_and_b32 v137, s25, v126
    s_waitcnt vmcnt(7)
    v_lshlrev_b32 v138, 16, v110
    v_and_b32 v139, s25, v110
    v_mul_f32 v134, v136, v138
    v_fmac_f32 v134, v137, v139
    s_waitcnt vmcnt(5)
    v_lshlrev_b32 v138, 16, v118
    v_and_b32 v139, s25, v118
    v_mul_f32 v135, v136, v138
    v_fmac_f32 v135, v137, v139
    v_lshlrev_b32 v136, 16, v127
    v_and_b32 v137, s25, v127
    v_lshlrev_b32 v138, 16, v111
    v_and_b32 v139, s25, v111
    v_fmac_f32 v134, v136, v138
    v_fmac_f32 v134, v137, v139
    v_lshlrev_b32 v138, 16, v119
    v_and_b32 v139, s25, v119
    v_fmac_f32 v135, v136, v138
    v_fmac_f32 v135, v137, v139
    v_lshlrev_b32 v136, 16, v128
    v_and_b32 v137, s25, v128
    v_lshlrev_b32 v138, 16, v112
    v_and_b32 v139, s25, v112
    v_fmac_f32 v134, v136, v138
    v_fmac_f32 v134, v137, v139
    v_lshlrev_b32 v138, 16, v120
    v_and_b32 v139, s25, v120
    v_fmac_f32 v135, v136, v138
    v_fmac_f32 v135, v137, v139
    v_lshlrev_b32 v136, 16, v129
    v_and_b32 v137, s25, v129
    v_lshlrev_b32 v138, 16, v113
    v_and_b32 v139, s25, v113
    v_fmac_f32 v134, v136, v138
    v_fmac_f32 v134, v137, v139
    v_lshlrev_b32 v138, 16, v121
    v_and_b32 v139, s25, v121
    v_fmac_f32 v135, v136, v138
    v_fmac_f32 v135, v137, v139
    v_lshlrev_b32 v136, 16, v130
    v_and_b32 v137, s25, v130
    v_lshlrev_b32 v138, 16, v114
    v_and_b32 v139, s25, v114
    v_fmac_f32 v134, v136, v138
    v_fmac_f32 v134, v137, v139
    s_waitcnt vmcnt(4)
    v_lshlrev_b32 v138, 16, v122
    v_and_b32 v139, s25, v122
    v_fmac_f32 v135, v136, v138
    v_fmac_f32 v135, v137, v139
    v_lshlrev_b32 v136, 16, v131
    v_and_b32 v137, s25, v131
    v_lshlrev_b32 v138, 16, v115
    v_and_b32 v139, s25, v115
    v_fmac_f32 v134, v136, v138
    v_fmac_f32 v134, v137, v139
    v_lshlrev_b32 v138, 16, v123
    v_and_b32 v139, s25, v123
    v_fmac_f32 v135, v136, v138
    v_fmac_f32 v135, v137, v139
    v_lshlrev_b32 v136, 16, v132
    v_and_b32 v137, s25, v132
    v_lshlrev_b32 v138, 16, v116
    v_and_b32 v139, s25, v116
    v_fmac_f32 v134, v136, v138
    v_fmac_f32 v134, v137, v139
    v_lshlrev_b32 v138, 16, v124
    v_and_b32 v139, s25, v124
    v_fmac_f32 v135, v136, v138
    v_fmac_f32 v135, v137, v139
    v_lshlrev_b32 v136, 16, v133
    v_and_b32 v137, s25, v133
    v_lshlrev_b32 v138, 16, v117
    v_and_b32 v139, s25, v117
    v_fmac_f32 v134, v136, v138
    v_fmac_f32 v134, v137, v139
    v_lshlrev_b32 v138, 16, v125
    v_and_b32 v139, s25, v125
    v_fmac_f32 v135, v136, v138
    v_fmac_f32 v135, v137, v139
    v_add_f32_dpp v134, v134, v134 row_shr:1 row_mask:0xf bank_mask:0xf bound_ctrl:0
    s_nop 0
    v_add_f32_dpp v135, v135, v135 row_shr:1 row_mask:0xf bank_mask:0xf bound_ctrl:0
    v_add_f32_dpp v134, v134, v134 row_shr:2 row_mask:0xf bank_mask:0xf bound_ctrl:0
    s_nop 0
    v_add_f32_dpp v135, v135, v135 row_shr:2 row_mask:0xf bank_mask:0xf bound_ctrl:0
    v_add_f32_dpp v134, v134, v134 row_shr:4 row_mask:0xf bank_mask:0xf bound_ctrl:0
    s_nop 0
    v_add_f32_dpp v135, v135, v135 row_shr:4 row_mask:0xf bank_mask:0xf bound_ctrl:0
    v_add_f32_dpp v134, v134, v134 row_shr:8 row_mask:0xf bank_mask:0xf bound_ctrl:0
    s_nop 0
    v_add_f32_dpp v135, v135, v135 row_shr:8 row_mask:0xf bank_mask:0xf bound_ctrl:0
    v_add_f32_dpp v134, v134, v134 row_bcast:15 row_mask:0xa bank_mask:0xf
    s_nop 0
    v_add_f32_dpp v135, v135, v135 row_bcast:15 row_mask:0xa bank_mask:0xf
    v_add_f32_dpp v134, v134, v134 row_bcast:31 row_mask:0xc bank_mask:0xf
    s_nop 0
    v_add_f32_dpp v135, v135, v135 row_bcast:31 row_mask:0xc bank_mask:0xf
    v_cvt_pk_bf16_f32 v136, v134, v135
    v_lshlrev_b32 v134, 16, v136
    v_and_b32 v135, s25, v136
    v_mul_f32 v134, 0xbfb8aa3b, v134
    v_mul_f32 v135, 0xbfb8aa3b, v135
    v_exp_f32 v134, v134
    v_exp_f32 v135, v135
    v_add_f32 v134, 1.0, v134
    v_add_f32 v135, 1.0, v135
    v_rcp_f32 v134, v134
    v_rcp_f32 v135, v135
    s_nop 0
    v_cvt_pk_bf16_f32 v136, v134, v135
    v_lshlrev_b32 v134, 16, v136
    v_and_b32 v135, s25, v136
    v_sub_f32 v140, 1.0, v134
    v_sub_f32 v141, 1.0, v135
    v_cvt_pk_bf16_f32 v136, v140, v141
    v_lshlrev_b32 v140, 16, v136
    v_and_b32 v141, s25, v136
    s_mov_b64 s[68:69], exec
    s_mov_b32 exec_lo, 0
    s_mov_b32 exec_hi, 0x80000000
    buffer_store_dwordx2 v[134:135], v108, s[64:67], 0 offen sc0 sc1
    buffer_store_dwordx2 v[140:141], v108, s[64:67], s55 offen sc0 sc1
    s_mov_b64 exec, s[68:69]
    s_waitcnt lgkmcnt(0)
    s_barrier
    ds_read_b128 v[14:17], v11 offset:0
    ds_read_b128 v[18:21], v11 offset:1024
    ds_read_b128 v[22:25], v12 offset:0
    ds_read_b128 v[26:29], v12 offset:1024
    s_waitcnt lgkmcnt(3)
    buffer_store_dwordx4 v[14:17], v13, s[40:43], s27 offen sc0 sc1
    s_add_u32 s27, s27, 16384
    s_waitcnt lgkmcnt(2)
    buffer_store_dwordx4 v[18:21], v13, s[40:43], s27 offen sc0 sc1
    s_add_u32 s27, s27, 16384
    s_waitcnt lgkmcnt(1)
    buffer_store_dwordx4 v[22:25], v13, s[40:43], s27 offen sc0 sc1
    s_add_u32 s27, s27, 16384
    s_waitcnt lgkmcnt(0)
    buffer_store_dwordx4 v[26:29], v13, s[40:43], s27 offen sc0 sc1
    s_waitcnt vmcnt(0)
Lend_prep_kernel:
    s_endpgm

.section .rodata,"a"
.p2align 6
.amdhsa_kernel prep_kernel
  .amdhsa_next_free_vgpr 144
  .amdhsa_next_free_sgpr 70
  .amdhsa_accum_offset 144
  .amdhsa_group_segment_fixed_size 0
  .amdhsa_kernarg_size 152
  .amdhsa_user_sgpr_count 2
  .amdhsa_user_sgpr_kernarg_segment_ptr 1
  .amdhsa_system_sgpr_workgroup_id_x 1
  .amdhsa_float_denorm_mode_32 3
.end_amdhsa_kernel
.text
.globl g1_kernel
.p2align 8
.type g1_kernel,@function
g1_kernel:
    s_cmp_ge_u32 s2, 256
    s_cbranch_scc1 Lend_g1_kernel
    s_load_dwordx2 s[4:5], s[0:1], 0
    s_load_dwordx2 s[6:7], s[0:1], 24
    s_load_dwordx2 s[8:9], s[0:1], 32
    s_load_dwordx2 s[10:11], s[0:1], 8
    s_load_dwordx2 s[12:13], s[0:1], 16
    s_load_dwordx2 s[14:15], s[0:1], 56
    s_load_dwordx2 s[16:17], s[0:1], 144
    s_load_dwordx2 s[18:19], s[0:1], 136
    v_lshrrev_b32 v1, 6, v0
    s_nop 0
    v_readfirstlane_b32 s20, v1
    v_and_b32 v1, 63, v0
    s_and_b32 s23, s2, 7
    s_lshr_b32 s21, s23, 1
    s_lshl_b32 s21, s21, 2
    s_and_b32 s22, s23, 1
    s_lshl_b32 s22, s22, 3
    s_lshr_b32 s23, s2, 3
    s_and_b32 s3, s23, 3
    s_add_u32 s21, s21, s3
    s_lshr_b32 s23, s23, 2
    s_add_u32 s22, s22, s23
    s_waitcnt lgkmcnt(0)
    s_mov_b32 s24, s18
    s_mov_b32 s25, s19
    s_mov_b32 s26, 256
    s_mov_b32 s27, 131072
    s_or_b32 s3, s2, s20
    s_cmp_lg_u32 s3, 0
    s_cbranch_scc1 Lnonce_1
    s_memrealtime s[28:29]
    s_waitcnt lgkmcnt(0)
    v_mov_b32 v2, s28
    v_mov_b32 v3, s29
    v_mov_b32 v4, 0
    buffer_store_dwordx2 v[2:3], v4, s[24:27], 0 offen sc0 sc1
    s_nop 1
Lnonce_1:
    v_mov_b32 v4, 0
    buffer_load_dwordx2 v[2:3], v4, s[24:27], 0 offen sc0 sc1
    s_mov_b32 s32, s4
    s_mov_b32 s33, s5
    s_mov_b32 s34, 4194304
    s_mov_b32 s35, 131072
    s_and_b32 s3, s20, 1
    s_cmp_eq_u32 s3, 0
    s_cselect_b32 s36, s6, s8
    s_cselect_b32 s37, s7, s9
    s_mov_b32 s38, 2097152
    s_mov_b32 s39, 131072
    v_lshrrev_b32 v13, 3, v1
    v_and_b32 v14, 7, v1
    s_lshl_b32 s23, s20, 5
    s_add_u32 s23, s23, 0
    v_add_u32 v15, s23, v13
    v_bfe_u32 v16, v15, 1, 3
    v_xor_b32 v16, v16, v14
    v_lshlrev_b32 v16, 4, v16
    v_and_b32 v5, 64, v15
    v_bfe_u32 v17, v15, 2, 1
    v_lshl_add_u32 v5, v17, 5, v5
    v_and_b32 v17, 1, v15
    v_lshl_add_u32 v5, v17, 4, v5
    v_bfe_u32 v17, v15, 5, 1
    v_lshl_add_u32 v5, v17, 3, v5
    v_bfe_u32 v17, v15, 3, 2
    v_lshl_add_u32 v5, v17, 1, v5
    v_bfe_u32 v17, v15, 1, 1
    v_add_u32 v5, v5, v17
    s_lshl_b32 s3, s21, 7
    v_add_u32 v5, s3, v5
    v_lshl_add_u32 v5, v5, 11, v16
    v_bfe_u32 v9, v15, 6, 1
    v_lshlrev_b32 v9, 5, v9
    v_and_b32 v17, 31, v15
    v_add_u32 v9, v9, v17
    s_lshl_b32 s3, s22, 6
    v_add_u32 v9, s3, v9
    v_lshl_add_u32 v9, v9, 11, v16
    s_lshl_b32 s23, s20, 5
    s_add_u32 s23, s23, 8
    v_add_u32 v15, s23, v13
    v_bfe_u32 v16, v15, 1, 3
    v_xor_b32 v16, v16, v14
    v_lshlrev_b32 v16, 4, v16
    v_and_b32 v6, 64, v15
    v_bfe_u32 v17, v15, 2, 1
    v_lshl_add_u32 v6, v17, 5, v6
    v_and_b32 v17, 1, v15
    v_lshl_add_u32 v6, v17, 4, v6
    v_bfe_u32 v17, v15, 5, 1
    v_lshl_add_u32 v6, v17, 3, v6
    v_bfe_u32 v17, v15, 3, 2
    v_lshl_add_u32 v6, v17, 1, v6
    v_bfe_u32 v17, v15, 1, 1
    v_add_u32 v6, v6, v17
    s_lshl_b32 s3, s21, 7
    v_add_u32 v6, s3, v6
    v_lshl_add_u32 v6, v6, 11, v16
    v_bfe_u32 v10, v15, 6, 1
    v_lshlrev_b32 v10, 5, v10
    v_and_b32 v17, 31, v15
    v_add_u32 v10, v10, v17
    s_lshl_b32 s3, s22, 6
    v_add_u32 v10, s3, v10
    v_lshl_add_u32 v10, v10, 11, v16
    s_lshl_b32 s23, s20, 5
    s_add_u32 s23, s23, 16
    v_add_u32 v15, s23, v13
    v_bfe_u32 v16, v15, 1, 3
    v_xor_b32 v16, v16, v14
    v_lshlrev_b32 v16, 4, v16
    v_and_b32 v7, 64, v15
    v_bfe_u32 v17, v15, 2, 1
    v_lshl_add_u32 v7, v17, 5, v7
    v_and_b32 v17, 1, v15
    v_lshl_add_u32 v7, v17, 4, v7
    v_bfe_u32 v17, v15, 5, 1
    v_lshl_add_u32 v7, v17, 3, v7
    v_bfe_u32 v17, v15, 3, 2
    v_lshl_add_u32 v7, v17, 1, v7
    v_bfe_u32 v17, v15, 1, 1
    v_add_u32 v7, v7, v17
    s_lshl_b32 s3, s21, 7
    v_add_u32 v7, s3, v7
    v_lshl_add_u32 v7, v7, 11, v16
    v_bfe_u32 v11, v15, 6, 1
    v_lshlrev_b32 v11, 5, v11
    v_and_b32 v17, 31, v15
    v_add_u32 v11, v11, v17
    s_lshl_b32 s3, s22, 6
    v_add_u32 v11, s3, v11
    v_lshl_add_u32 v11, v11, 11, v16
    s_lshl_b32 s23, s20, 5
    s_add_u32 s23, s23, 24
    v_add_u32 v15, s23, v13
    v_bfe_u32 v16, v15, 1, 3
    v_xor_b32 v16, v16, v14
    v_lshlrev_b32 v16, 4, v16
    v_and_b32 v8, 64, v15
    v_bfe_u32 v17, v15, 2, 1
    v_lshl_add_u32 v8, v17, 5, v8
    v_and_b32 v17, 1, v15
    v_lshl_add_u32 v8, v17, 4, v8
    v_bfe_u32 v17, v15, 5, 1
    v_lshl_add_u32 v8, v17, 3, v8
    v_bfe_u32 v17, v15, 3, 2
    v_lshl_add_u32 v8, v17, 1, v8
    v_bfe_u32 v17, v15, 1, 1
    v_add_u32 v8, v8, v17
    s_lshl_b32 s3, s21, 7
    v_add_u32 v8, s3, v8
    v_lshl_add_u32 v8, v8, 11, v16
    v_bfe_u32 v12, v15, 6, 1
    v_lshlrev_b32 v12, 5, v12
    v_and_b32 v17, 31, v15
    v_add_u32 v12, v12, v17
    s_lshl_b32 s3, s22, 6
    v_add_u32 v12, s3, v12
    v_lshl_add_u32 v12, v12, 11, v16
    s_mov_b32 s23, 0
    s_lshl_b32 s30, s20, 12
    s_and_b32 s3, s20, 1
    s_lshl_b32 s3, s3, 5
    v_and_b32 v13, 31, v1
    v_add_u32 v13, s3, v13
    s_lshl_b32 s3, s22, 6
    v_add_u32 v14, s3, v13
    v_lshlrev_b32 v14, 1, v14
    s_mov_b32 s40, s10
    s_mov_b32 s41, s11
    s_mov_b32 s42, 2048
    s_mov_b32 s43, 131072
    buffer_load_ushort v15, v14, s[40:43], 0 offen
    s_mov_b32 s44, s12
    s_mov_b32 s45, s13
    s_mov_b32 s46, 2048
    s_mov_b32 s47, 131072
    buffer_load_ushort v16, v14, s[44:47], 0 offen
    s_mov_b32 s48, s14
    s_mov_b32 s49, s15
    s_mov_b32 s50, 2048
    s_mov_b32 s51, 131072
    buffer_load_ushort v17, v14, s[48:51], 0 offen
    s_mov_b32 s31, 0
    s_add_u32 m0, s30, 0
    s_nop 0
    buffer_load_dwordx4 v5, s[32:35], s31 offen lds
    s_add_u32 m0, s30, 1024
    s_nop 0
    buffer_load_dwordx4 v6, s[32:35], s31 offen lds
    s_add_u32 m0, s30, 2048
    s_nop 0
    buffer_load_dwordx4 v7, s[32:35], s31 offen lds
    s_add_u32 m0, s30, 3072
    s_nop 0
    buffer_load_dwordx4 v8, s[32:35], s31 offen lds
    s_add_u32 m0, s30, 16384
    s_nop 0
    buffer_load_dwordx4 v9, s[36:39], s31 offen lds
    s_add_u32 m0, s30, 17408
    s_nop 0
    buffer_load_dwordx4 v10, s[36:39], s31 offen lds
    s_add_u32 m0, s30, 18432
    s_nop 0
    buffer_load_dwordx4 v11, s[36:39], s31 offen lds
    s_add_u32 m0, s30, 19456
    s_nop 0
    buffer_load_dwordx4 v12, s[36:39], s31 offen lds
    s_mov_b32 s31, 128
    s_add_u32 m0, s30, 32768
    s_nop 0
    buffer_load_dwordx4 v5, s[32:35], s31 offen lds
    s_add_u32 m0, s30, 33792
    s_nop 0
    buffer_load_dwordx4 v6, s[32:35], s31 offen lds
    s_add_u32 m0, s30, 34816
    s_nop 0
    buffer_load_dwordx4 v7, s[32:35], s31 offen lds
    s_add_u32 m0, s30, 35840
    s_nop 0
    buffer_load_dwordx4 v8, s[32:35], s31 offen lds
    s_add_u32 m0, s30, 49152
    s_nop 0
    buffer_load_dwordx4 v9, s[36:39], s31 offen lds
    s_add_u32 m0, s30, 50176
    s_nop 0
    buffer_load_dwordx4 v10, s[36:39], s31 offen lds
    s_add_u32 m0, s30, 51200
    s_nop 0
    buffer_load_dwordx4 v11, s[36:39], s31 offen lds
    s_add_u32 m0, s30, 52224
    s_nop 0
    buffer_load_dwordx4 v12, s[36:39], s31 offen lds
    s_mov_b32 s31, 256
    s_add_u32 m0, s30, 65536
    s_nop 0
    buffer_load_dwordx4 v5, s[32:35], s31 offen lds
    s_add_u32 m0, s30, 66560
    s_nop 0
    buffer_load_dwordx4 v6, s[32:35], s31 offen lds
    s_add_u32 m0, s30, 67584
    s_nop 0
    buffer_load_dwordx4 v7, s[32:35], s31 offen lds
    s_add_u32 m0, s30, 68608
    s_nop 0
    buffer_load_dwordx4 v8, s[32:35], s31 offen lds
    s_add_u32 m0, s30, 81920
    s_nop 0
    buffer_load_dwordx4 v9, s[36:39], s31 offen lds
    s_add_u32 m0, s30, 82944
    s_nop 0
    buffer_load_dwordx4 v10, s[36:39], s31 offen lds
    s_add_u32 m0, s30, 83968
    s_nop 0
    buffer_load_dwordx4 v11, s[36:39], s31 offen lds
    s_add_u32 m0, s30, 84992
    s_nop 0
    buffer_load_dwordx4 v12, s[36:39], s31 offen lds
    s_mov_b32 s31, 384
    s_add_u32 m0, s30, 98304
    s_nop 0
    buffer_load_dwordx4 v5, s[32:35], s31 offen lds
    s_add_u32 m0, s30, 99328
    s_nop 0
    buffer_load_dwordx4 v6, s[32:35], s31 offen lds
    s_add_u32 m0, s30, 100352
    s_nop 0
    buffer_load_dwordx4 v7, s[32:35], s31 offen lds
    s_add_u32 m0, s30, 101376
    s_nop 0
    buffer_load_dwordx4 v8, s[32:35], s31 offen lds
    s_add_u32 m0, s30, 114688
    s_nop 0
    buffer_load_dwordx4 v9, s[36:39], s31 offen lds
    s_add_u32 m0, s30, 115712
    s_nop 0
    buffer_load_dwordx4 v10, s[36:39], s31 offen lds
    s_add_u32 m0, s30, 116736
    s_nop 0
    buffer_load_dwordx4 v11, s[36:39], s31 offen lds
    s_add_u32 m0, s30, 117760
    s_nop 0
    buffer_load_dwordx4 v12, s[36:39], s31 offen lds
    v_and_b32 v34, 31, v1
    v_bfe_u32 v35, v34, 1, 3
    v_lshrrev_b32 v36, 5, v1
    v_xor_b32 v35, v35, v36
    v_lshlrev_b32 v35, 4, v35
    v_lshl_add_u32 v35, v34, 7, v35
    s_lshr_b32 s52, s20, 1
    s_lshl_b32 s52, s52, 13
    s_and_b32 s53, s20, 1
    s_lshl_b32 s53, s53, 13
    s_add_u32 s53, s53, 16384
    v_xor_b32 v36, 0, v35
    v_add_u32 v18, s52, v36
    v_add_u32 v26, s53, v36
    v_add_u32 v22, 0x10000, v18
    v_add_u32 v30, 0x10000, v26
    v_xor_b32 v36, 32, v35
    v_add_u32 v19, s52, v36
    v_add_u32 v27, s53, v36
    v_add_u32 v23, 0x10000, v19
    v_add_u32 v31, 0x10000, v27
    v_xor_b32 v36, 64, v35
    v_add_u32 v20, s52, v36
    v_add_u32 v28, s53, v36
    v_add_u32 v24, 0x10000, v20
    v_add_u32 v32, 0x10000, v28
    v_xor_b32 v36, 96, v35
    v_add_u32 v21, s52, v36
    v_add_u32 v29, s53, v36
    v_add_u32 v25, 0x10000, v21
    v_add_u32 v33, 0x10000, v29
    v_mov_b32 v132, 0
    v_mov_b32 v133, 0
    v_mov_b32 v134, 0
    v_mul_u32_u24 v34, 12, v0
    v_add_u32 v34, 131072, v34
    ds_write_b32 v34, v132
    ds_write_b32 v34, v132 offset:4
    ds_write_b32 v34, v132 offset:8
    s_waitcnt vmcnt(34)
    v_lshlrev_b32 v15, 16, v15
    s_waitcnt vmcnt(33)
    v_lshlrev_b32 v16, 16, v16
    s_waitcnt vmcnt(32)
    v_lshlrev_b32 v17, 16, v17
    v_mul_f32 v148, 1069066811, v17
    v_exp_f32 v148, v148
    s_nop 0
    v_cvt_pk_bf16_f32 v148, v148, v148
    v_lshlrev_b32 v148, 16, v148
    v_mul_f32 v149, v148, v15
    v_mul_f32 v150, v148, v16
    v_mul_f32 v149, 1069066811, v149
    v_exp_f32 v149, v149
    v_mul_f32 v150, 1042479491, v150
    v_fract_f32 v150, v150
    v_cos_f32 v151, v150
    v_sin_f32 v152, v150
    v_mul_f32 v136, v149, v151
    v_mul_f32 v137, v149, v152
    v_add_f32 v148, -1.0, v136
    v_mul_f32 v149, v15, v15
    v_fmac_f32 v149, v16, v16
    v_rcp_f32 v149, v149
    s_nop 0
    v_add_f32 v149, v149, v149
    v_mul_f32 v150, v148, v15
    v_fmac_f32 v150, v137, v16
    v_mul_f32 v151, v137, v15
    v_fma_f32 v151, -v148, v16, v151
    v_mul_f32 v138, v150, v149
    v_mul_f32 v139, v151, v149
    v_mul_f32 v148, v137, v137
    v_fma_f32 v148, v136, v136, -v148
    v_mul_f32 v149, v136, v137
    v_add_f32 v149, v149, v149
    v_mul_f32 v150, v149, v149
    v_fma_f32 v150, v148, v148, -v150
    v_mul_f32 v151, v148, v149
    v_add_f32 v151, v151, v151
    v_mul_f32 v148, v151, v151
    v_fma_f32 v148, v150, v150, -v148
    v_mul_f32 v149, v150, v151
    v_add_f32 v149, v149, v149
    v_mul_f32 v140, v149, v149
    v_fma_f32 v140, v148, v148, -v140
    v_mul_f32 v141, v148, v149
    v_add_f32 v141, v141, v141
    v_mul_f32 v148, v141, v141
    v_fma_f32 v148, v140, v140, -v148
    v_mul_f32 v149, v140, v141
    v_add_f32 v149, v149, v149
    v_mul_f32 v150, v149, v149
    v_fma_f32 v150, v148, v148, -v150
    v_mul_f32 v151, v148, v149
    v_add_f32 v151, v151, v151
    v_mul_f32 v142, v151, v151
    v_fma_f32 v142, v150, v150, -v142
    v_mul_f32 v143, v150, v151
    v_add_f32 v143, v143, v143
    s_mov_b32 s52, 0
    s_mov_b32 s53, -1
    s_lshr_b32 s3, s20, 1
    s_cmp_eq_u32 s3, 1
    s_cselect_b32 s54, -1, 0
    s_cselect_b32 s55, -1, 0
    v_cndmask_b32 v148, 1.0, v148, s[52:53]
    v_cndmask_b32 v149, 0, v149, s[52:53]
    v_cndmask_b32 v150, 1.0, v150, s[54:55]
    v_cndmask_b32 v151, 0, v151, s[54:55]
    v_mul_f32 v152, v149, v151
    v_fma_f32 v152, v148, v150, -v152
    v_mul_f32 v153, v148, v151
    v_fmac_f32 v153, v149, v150
    v_mul_f32 v148, v153, v141
    v_fma_f32 v148, v152, v140, -v148
    v_mul_f32 v149, v152, v141
    v_fmac_f32 v149, v153, v140
    v_mov_b32 v144, v152
    v_mov_b32 v145, v148
    v_mov_b32 v146, v153
    v_mov_b32 v147, v149
    s_mov_b32 s56, 0
    v_readfirstlane_b32 s28, v2
    v_readfirstlane_b32 s29, v3
    s_nop 3
    s_or_b32 s3, s28, s29
    s_cmp_lg_u32 s3, 0
    s_cbranch_scc1 Lnok_2
Lnretry_3:
    buffer_load_dwordx2 v[2:3], v4, s[24:27], 0 offen sc0 sc1
    s_waitcnt vmcnt(0)
    v_readfirstlane_b32 s28, v2
    v_readfirstlane_b32 s29, v3
    s_add_u32 s56, s56, 1
    s_nop 3
    s_or_b32 s3, s28, s29
    s_cmp_gt_u32 s56, 100000
    s_cbranch_scc1 Lnok_2
    s_cmp_eq_u32 s3, 0
    s_cbranch_scc1 Lnretry_3
Lnok_2:
    s_waitcnt vmcnt(24)
    s_barrier
    ds_read_b128 v[36:39], v18 offset:0
    ds_read_b128 v[44:47], v26 offset:0
    ds_read_b128 v[48:51], v26 offset:4096
    ds_read_b128 v[40:43], v18 offset:4096
    s_waitcnt lgkmcnt(2)
    v_mfma_f32_32x32x16_bf16 v[68:83], v[36:39], v[44:47], 0
    ds_read_b128 v[52:55], v19 offset:0
    ds_read_b128 v[60:63], v27 offset:0
    s_waitcnt lgkmcnt(3)
    v_mfma_f32_32x32x16_bf16 v[84:99], v[36:39], v[48:51], 0
    ds_read_b128 v[64:67], v27 offset:4096
    ds_read_b128 v[56:59], v19 offset:4096
    s_waitcnt lgkmcnt(4)
    v_mfma_f32_32x32x16_bf16 v[100:115], v[40:43], v[44:47], 0
    v_mfma_f32_32x32x16_bf16 v[116:131], v[40:43], v[48:51], 0
    s_waitcnt lgkmcnt(2)
    v_mfma_f32_32x32x16_bf16 v[68:83], v[52:55], v[60:63], v[68:83]
    ds_read_b128 v[36:39], v20 offset:0
    ds_read_b128 v[44:47], v28 offset:0
    s_waitcnt lgkmcnt(3)
    v_mfma_f32_32x32x16_bf16 v[84:99], v[52:55], v[64:67], v[84:99]
    ds_read_b128 v[48:51], v28 offset:4096
    ds_read_b128 v[40:43], v20 offset:4096
    s_waitcnt lgkmcnt(4)
    v_mfma_f32_32x32x16_bf16 v[100:115], v[56:59], v[60:63], v[100:115]
    v_mfma_f32_32x32x16_bf16 v[116:131], v[56:59], v[64:67], v[116:131]
    s_waitcnt lgkmcnt(2)
    v_mfma_f32_32x32x16_bf16 v[68:83], v[36:39], v[44:47], v[68:83]
    ds_read_b128 v[52:55], v21 offset:0
    ds_read_b128 v[60:63], v29 offset:0
    s_waitcnt lgkmcnt(3)
    v_mfma_f32_32x32x16_bf16 v[84:99], v[36:39], v[48:51], v[84:99]
    ds_read_b128 v[64:67], v29 offset:4096
    ds_read_b128 v[56:59], v21 offset:4096
    s_waitcnt lgkmcnt(4)
    v_mfma_f32_32x32x16_bf16 v[100:115], v[40:43], v[44:47], v[100:115]
    v_mfma_f32_32x32x16_bf16 v[116:131], v[40:43], v[48:51], v[116:131]
    s_waitcnt lgkmcnt(0)
    s_waitcnt vmcnt(16)
    s_barrier
    v_mfma_f32_32x32x16_bf16 v[68:83], v[52:55], v[60:63], v[68:83]
    ds_read_b128 v[36:39], v18 offset:32768
    ds_read_b128 v[44:47], v26 offset:32768
    s_mov_b32 s31, 512
    v_mfma_f32_32x32x16_bf16 v[84:99], v[52:55], v[64:67], v[84:99]
    ds_read_b128 v[48:51], v26 offset:36864
    ds_read_b128 v[40:43], v18 offset:36864
    s_add_u32 m0, s30, 0
    v_mfma_f32_32x32x16_bf16 v[100:115], v[56:59], v[60:63], v[100:115]
    buffer_load_dwordx4 v5, s[32:35], s31 offen lds
    s_add_u32 m0, s30, 1024
    v_mfma_f32_32x32x16_bf16 v[116:131], v[56:59], v[64:67], v[116:131]
    buffer_load_dwordx4 v6, s[32:35], s31 offen lds
    s_waitcnt lgkmcnt(2)
    v_mfma_f32_32x32x16_bf16 v[68:83], v[36:39], v[44:47], v[68:83]
    ds_read_b128 v[52:55], v19 offset:32768
    ds_read_b128 v[60:63], v27 offset:32768
    s_waitcnt lgkmcnt(3)
    v_mfma_f32_32x32x16_bf16 v[84:99], v[36:39], v[48:51], v[84:99]
    ds_read_b128 v[64:67], v27 offset:36864
    ds_read_b128 v[56:59], v19 offset:36864
    s_add_u32 m0, s30, 2048
    s_waitcnt lgkmcnt(4)
    v_mfma_f32_32x32x16_bf16 v[100:115], v[40:43], v[44:47], v[100:115]
    buffer_load_dwordx4 v7, s[32:35], s31 offen lds
    s_add_u32 m0, s30, 3072
    v_mfma_f32_32x32x16_bf16 v[116:131], v[40:43], v[48:51], v[116:131]
    buffer_load_dwordx4 v8, s[32:35], s31 offen lds
    s_waitcnt lgkmcnt(2)
    v_mfma_f32_32x32x16_bf16 v[68:83], v[52:55], v[60:63], v[68:83]
    ds_read_b128 v[36:39], v20 offset:32768
    ds_read_b128 v[44:47], v28 offset:32768
    s_waitcnt lgkmcnt(3)
    v_mfma_f32_32x32x16_bf16 v[84:99], v[52:55], v[64:67], v[84:99]
    ds_read_b128 v[48:51], v28 offset:36864
    ds_read_b128 v[40:43], v20 offset:36864
    s_add_u32 m0, s30, 16384
    s_waitcnt lgkmcnt(4)
    v_mfma_f32_32x32x16_bf16 v[100:115], v[56:59], v[60:63], v[100:115]
    buffer_load_dwordx4 v9, s[36:39], s31 offen lds
    s_add_u32 m0, s30, 17408
    v_mfma_f32_32x32x16_bf16 v[116:131], v[56:59], v[64:67], v[116:131]
    buffer_load_dwordx4 v10, s[36:39], s31 offen lds
    s_waitcnt lgkmcnt(2)
    v_mfma_f32_32x32x16_bf16 v[68:83], v[36:39], v[44:47], v[68:83]
    ds_read_b128 v[52:55], v21 offset:32768
    ds_read_b128 v[60:63], v29 offset:32768
    s_waitcnt lgkmcnt(3)
    v_mfma_f32_32x32x16_bf16 v[84:99], v[36:39], v[48:51], v[84:99]
    ds_read_b128 v[64:67], v29 offset:36864
    ds_read_b128 v[56:59], v21 offset:36864
    s_add_u32 m0, s30, 18432
    s_waitcnt lgkmcnt(4)
    v_mfma_f32_32x32x16_bf16 v[100:115], v[40:43], v[44:47], v[100:115]
    buffer_load_dwordx4 v11, s[36:39], s31 offen lds
    s_add_u32 m0, s30, 19456
    v_mfma_f32_32x32x16_bf16 v[116:131], v[40:43], v[48:51], v[116:131]
    buffer_load_dwordx4 v12, s[36:39], s31 offen lds
    s_waitcnt lgkmcnt(0)
    s_waitcnt vmcnt(16)
    s_barrier
    v_mfma_f32_32x32x16_bf16 v[68:83], v[52:55], v[60:63], v[68:83]
    ds_read_b128 v[36:39], v22 offset:0
    ds_read_b128 v[44:47], v30 offset:0
    s_mov_b32 s31, 640
    v_mfma_f32_32x32x16_bf16 v[84:99], v[52:55], v[64:67], v[84:99]
    ds_read_b128 v[48:51], v30 offset:4096
    ds_read_b128 v[40:43], v22 offset:4096
    s_add_u32 m0, s30, 32768
    v_mfma_f32_32x32x16_bf16 v[100:115], v[56:59], v[60:63], v[100:115]
    buffer_load_dwordx4 v5, s[32:35], s31 offen lds
    s_add_u32 m0, s30, 33792
    v_mfma_f32_32x32x16_bf16 v[116:131], v[56:59], v[64:67], v[116:131]
    buffer_load_dwordx4 v6, s[32:35], s31 offen lds
    s_waitcnt lgkmcnt(2)
    v_mfma_f32_32x32x16_bf16 v[68:83], v[36:39], v[44:47], v[68:83]
    ds_read_b128 v[52:55], v23 offset:0
    ds_read_b128 v[60:63], v31 offset:0
    s_waitcnt lgkmcnt(3)
    v_mfma_f32_32x32x16_bf16 v[84:99], v[36:39], v[48:51], v[84:99]
    ds_read_b128 v[64:67], v31 offset:4096
    ds_read_b128 v[56:59], v23 offset:4096
    s_add_u32 m0, s30, 34816
    s_waitcnt lgkmcnt(4)
    v_mfma_f32_32x32x16_bf16 v[100:115], v[40:43], v[44:47], v[100:115]
    buffer_load_dwordx4 v7, s[32:35], s31 offen lds
    s_add_u32 m0, s30, 35840
    v_mfma_f32_32x32x16_bf16 v[116:131], v[40:43], v[48:51], v[116:131]
    buffer_load_dwordx4 v8, s[32:35], s31 offen lds
    s_waitcnt lgkmcnt(2)
    v_mfma_f32_32x32x16_bf16 v[68:83], v[52:55], v[60:63], v[68:83]
    ds_read_b128 v[36:39], v24 offset:0
    ds_read_b128 v[44:47], v32 offset:0
    s_waitcnt lgkmcnt(3)
    v_mfma_f32_32x32x16_bf16 v[84:99], v[52:55], v[64:67], v[84:99]
    ds_read_b128 v[48:51], v32 offset:4096
    ds_read_b128 v[40:43], v24 offset:4096
    s_add_u32 m0, s30, 49152
    s_waitcnt lgkmcnt(4)
    v_mfma_f32_32x32x16_bf16 v[100:115], v[56:59], v[60:63], v[100:115]
    buffer_load_dwordx4 v9, s[36:39], s31 offen lds
    s_add_u32 m0, s30, 50176
    v_mfma_f32_32x32x16_bf16 v[116:131], v[56:59], v[64:67], v[116:131]
    buffer_load_dwordx4 v10, s[36:39], s31 offen lds
    s_waitcnt lgkmcnt(2)
    v_mfma_f32_32x32x16_bf16 v[68:83], v[36:39], v[44:47], v[68:83]
    ds_read_b128 v[52:55], v25 offset:0
    ds_read_b128 v[60:63], v33 offset:0
    s_waitcnt lgkmcnt(3)
    v_mfma_f32_32x32x16_bf16 v[84:99], v[36:39], v[48:51], v[84:99]
    ds_read_b128 v[64:67], v33 offset:4096
    ds_read_b128 v[56:59], v25 offset:4096
    s_add_u32 m0, s30, 51200
    s_waitcnt lgkmcnt(4)
    v_mfma_f32_32x32x16_bf16 v[100:115], v[40:43], v[44:47], v[100:115]
    buffer_load_dwordx4 v11, s[36:39], s31 offen lds
    s_add_u32 m0, s30, 52224
    v_mfma_f32_32x32x16_bf16 v[116:131], v[40:43], v[48:51], v[116:131]
    buffer_load_dwordx4 v12, s[36:39], s31 offen lds
    s_waitcnt lgkmcnt(0)
    s_waitcnt vmcnt(16)
    s_barrier
    v_mfma_f32_32x32x16_bf16 v[68:83], v[52:55], v[60:63], v[68:83]
    ds_read_b128 v[36:39], v22 offset:32768
    ds_read_b128 v[44:47], v30 offset:32768
    s_mov_b32 s31, 768
    v_mfma_f32_32x32x16_bf16 v[84:99], v[52:55], v[64:67], v[84:99]
    ds_read_b128 v[48:51], v30 offset:36864
    ds_read_b128 v[40:43], v22 offset:36864
    s_add_u32 m0, s30, 65536
    v_mfma_f32_32x32x16_bf16 v[100:115], v[56:59], v[60:63], v[100:115]
    buffer_load_dwordx4 v5, s[32:35], s31 offen lds
    s_add_u32 m0, s30, 66560
    v_mfma_f32_32x32x16_bf16 v[116:131], v[56:59], v[64:67], v[116:131]
    buffer_load_dwordx4 v6, s[32:35], s31 offen lds
    s_waitcnt lgkmcnt(2)
    v_mfma_f32_32x32x16_bf16 v[68:83], v[36:39], v[44:47], v[68:83]
    ds_read_b128 v[52:55], v23 offset:32768
    ds_read_b128 v[60:63], v31 offset:32768
    s_waitcnt lgkmcnt(3)
    v_mfma_f32_32x32x16_bf16 v[84:99], v[36:39], v[48:51], v[84:99]
    ds_read_b128 v[64:67], v31 offset:36864
    ds_read_b128 v[56:59], v23 offset:36864
    s_add_u32 m0, s30, 67584
    s_waitcnt lgkmcnt(4)
    v_mfma_f32_32x32x16_bf16 v[100:115], v[40:43], v[44:47], v[100:115]
    buffer_load_dwordx4 v7, s[32:35], s31 offen lds
    s_add_u32 m0, s30, 68608
    v_mfma_f32_32x32x16_bf16 v[116:131], v[40:43], v[48:51], v[116:131]
    buffer_load_dwordx4 v8, s[32:35], s31 offen lds
    s_waitcnt lgkmcnt(2)
    v_mfma_f32_32x32x16_bf16 v[68:83], v[52:55], v[60:63], v[68:83]
    ds_read_b128 v[36:39], v24 offset:32768
    ds_read_b128 v[44:47], v32 offset:32768
    s_waitcnt lgkmcnt(3)
    v_mfma_f32_32x32x16_bf16 v[84:99], v[52:55], v[64:67], v[84:99]
    ds_read_b128 v[48:51], v32 offset:36864
    ds_read_b128 v[40:43], v24 offset:36864
    s_add_u32 m0, s30, 81920
    s_waitcnt lgkmcnt(4)
    v_mfma_f32_32x32x16_bf16 v[100:115], v[56:59], v[60:63], v[100:115]
    buffer_load_dwordx4 v9, s[36:39], s31 offen lds
    s_add_u32 m0, s30, 82944
    v_mfma_f32_32x32x16_bf16 v[116:131], v[56:59], v[64:67], v[116:131]
    buffer_load_dwordx4 v10, s[36:39], s31 offen lds
    s_waitcnt lgkmcnt(2)
    v_mfma_f32_32x32x16_bf16 v[68:83], v[36:39], v[44:47], v[68:83]
    ds_read_b128 v[52:55], v25 offset:32768
    ds_read_b128 v[60:63], v33 offset:32768
    s_waitcnt lgkmcnt(3)
    v_mfma_f32_32x32x16_bf16 v[84:99], v[36:39], v[48:51], v[84:99]
    ds_read_b128 v[64:67], v33 offset:36864
    ds_read_b128 v[56:59], v25 offset:36864
    s_add_u32 m0, s30, 83968
    s_waitcnt lgkmcnt(4)
    v_mfma_f32_32x32x16_bf16 v[100:115], v[40:43], v[44:47], v[100:115]
    buffer_load_dwordx4 v11, s[36:39], s31 offen lds
    s_add_u32 m0, s30, 84992
    v_mfma_f32_32x32x16_bf16 v[116:131], v[40:43], v[48:51], v[116:131]
    buffer_load_dwordx4 v12, s[36:39], s31 offen lds
    s_waitcnt lgkmcnt(0)
    s_waitcnt vmcnt(16)
    s_barrier
    v_mfma_f32_32x32x16_bf16 v[68:83], v[52:55], v[60:63], v[68:83]
    ds_read_b128 v[36:39], v18 offset:0
    ds_read_b128 v[44:47], v26 offset:0
    s_mov_b32 s31, 896
    v_mfma_f32_32x32x16_bf16 v[84:99], v[52:55], v[64:67], v[84:99]
    ds_read_b128 v[48:51], v26 offset:4096
    ds_read_b128 v[40:43], v18 offset:4096
    s_add_u32 m0, s30, 98304
    v_mfma_f32_32x32x16_bf16 v[100:115], v[56:59], v[60:63], v[100:115]
    buffer_load_dwordx4 v5, s[32:35], s31 offen lds
    s_add_u32 m0, s30, 99328
    v_mfma_f32_32x32x16_bf16 v[116:131], v[56:59], v[64:67], v[116:131]
    buffer_load_dwordx4 v6, s[32:35], s31 offen lds
    s_waitcnt lgkmcnt(2)
    v_mfma_f32_32x32x16_bf16 v[68:83], v[36:39], v[44:47], v[68:83]
    ds_read_b128 v[52:55], v19 offset:0
    ds_read_b128 v[60:63], v27 offset:0
    s_waitcnt lgkmcnt(3)
    v_mfma_f32_32x32x16_bf16 v[84:99], v[36:39], v[48:51], v[84:99]
    ds_read_b128 v[64:67], v27 offset:4096
    ds_read_b128 v[56:59], v19 offset:4096
    s_add_u32 m0, s30, 100352
    s_waitcnt lgkmcnt(4)
    v_mfma_f32_32x32x16_bf16 v[100:115], v[40:43], v[44:47], v[100:115]
    buffer_load_dwordx4 v7, s[32:35], s31 offen lds
    s_add_u32 m0, s30, 101376
    v_mfma_f32_32x32x16_bf16 v[116:131], v[40:43], v[48:51], v[116:131]
    buffer_load_dwordx4 v8, s[32:35], s31 offen lds
    s_waitcnt lgkmcnt(2)
    v_mfma_f32_32x32x16_bf16 v[68:83], v[52:55], v[60:63], v[68:83]
    ds_read_b128 v[36:39], v20 offset:0
    ds_read_b128 v[44:47], v28 offset:0
    s_waitcnt lgkmcnt(3)
    v_mfma_f32_32x32x16_bf16 v[84:99], v[52:55], v[64:67], v[84:99]
    ds_read_b128 v[48:51], v28 offset:4096
    ds_read_b128 v[40:43], v20 offset:4096
    s_add_u32 m0, s30, 114688
    s_waitcnt lgkmcnt(4)
    v_mfma_f32_32x32x16_bf16 v[100:115], v[56:59], v[60:63], v[100:115]
    buffer_load_dwordx4 v9, s[36:39], s31 offen lds
    s_add_u32 m0, s30, 115712
    v_mfma_f32_32x32x16_bf16 v[116:131], v[56:59], v[64:67], v[116:131]
    buffer_load_dwordx4 v10, s[36:39], s31 offen lds
    s_waitcnt lgkmcnt(2)
    v_mfma_f32_32x32x16_bf16 v[68:83], v[36:39], v[44:47], v[68:83]
    ds_read_b128 v[52:55], v21 offset:0
    ds_read_b128 v[60:63], v29 offset:0
    s_waitcnt lgkmcnt(3)
    v_mfma_f32_32x32x16_bf16 v[84:99], v[36:39], v[48:51], v[84:99]
    ds_read_b128 v[64:67], v29 offset:4096
    ds_read_b128 v[56:59], v21 offset:4096
    s_add_u32 m0, s30, 116736
    s_waitcnt lgkmcnt(4)
    v_mfma_f32_32x32x16_bf16 v[100:115], v[40:43], v[44:47], v[100:115]
    buffer_load_dwordx4 v11, s[36:39], s31 offen lds
    s_add_u32 m0, s30, 117760
    v_mfma_f32_32x32x16_bf16 v[116:131], v[40:43], v[48:51], v[116:131]
    buffer_load_dwordx4 v12, s[36:39], s31 offen lds
    s_waitcnt lgkmcnt(0)
    s_waitcnt vmcnt(16)
    s_barrier
    v_mfma_f32_32x32x16_bf16 v[68:83], v[52:55], v[60:63], v[68:83]
    ds_read_b128 v[36:39], v18 offset:32768
    ds_read_b128 v[44:47], v26 offset:32768
    s_mov_b32 s31, 1024
    v_mfma_f32_32x32x16_bf16 v[84:99], v[52:55], v[64:67], v[84:99]
    ds_read_b128 v[48:51], v26 offset:36864
    ds_read_b128 v[40:43], v18 offset:36864
    s_add_u32 m0, s30, 0
    v_mfma_f32_32x32x16_bf16 v[100:115], v[56:59], v[60:63], v[100:115]
    buffer_load_dwordx4 v5, s[32:35], s31 offen lds
    s_add_u32 m0, s30, 1024
    v_mfma_f32_32x32x16_bf16 v[116:131], v[56:59], v[64:67], v[116:131]
    buffer_load_dwordx4 v6, s[32:35], s31 offen lds
    s_waitcnt lgkmcnt(2)
    v_mfma_f32_32x32x16_bf16 v[68:83], v[36:39], v[44:47], v[68:83]
    ds_read_b128 v[52:55], v19 offset:32768
    ds_read_b128 v[60:63], v27 offset:32768
    s_waitcnt lgkmcnt(3)
    v_mfma_f32_32x32x16_bf16 v[84:99], v[36:39], v[48:51], v[84:99]
    ds_read_b128 v[64:67], v27 offset:36864
    ds_read_b128 v[56:59], v19 offset:36864
    s_add_u32 m0, s30, 2048
    s_waitcnt lgkmcnt(4)
    v_mfma_f32_32x32x16_bf16 v[100:115], v[40:43], v[44:47], v[100:115]
    buffer_load_dwordx4 v7, s[32:35], s31 offen lds
    s_add_u32 m0, s30, 3072
    v_mfma_f32_32x32x16_bf16 v[116:131], v[40:43], v[48:51], v[116:131]
    buffer_load_dwordx4 v8, s[32:35], s31 offen lds
    s_waitcnt lgkmcnt(2)
    v_mfma_f32_32x32x16_bf16 v[68:83], v[52:55], v[60:63], v[68:83]
    ds_read_b128 v[36:39], v20 offset:32768
    ds_read_b128 v[44:47], v28 offset:32768
    s_waitcnt lgkmcnt(3)
    v_mfma_f32_32x32x16_bf16 v[84:99], v[52:55], v[64:67], v[84:99]
    ds_read_b128 v[48:51], v28 offset:36864
    ds_read_b128 v[40:43], v20 offset:36864
    s_add_u32 m0, s30, 16384
    s_waitcnt lgkmcnt(4)
    v_mfma_f32_32x32x16_bf16 v[100:115], v[56:59], v[60:63], v[100:115]
    buffer_load_dwordx4 v9, s[36:39], s31 offen lds
    s_add_u32 m0, s30, 17408
    v_mfma_f32_32x32x16_bf16 v[116:131], v[56:59], v[64:67], v[116:131]
    buffer_load_dwordx4 v10, s[36:39], s31 offen lds
    s_waitcnt lgkmcnt(2)
    v_mfma_f32_32x32x16_bf16 v[68:83], v[36:39], v[44:47], v[68:83]
    ds_read_b128 v[52:55], v21 offset:32768
    ds_read_b128 v[60:63], v29 offset:32768
    s_waitcnt lgkmcnt(3)
    v_mfma_f32_32x32x16_bf16 v[84:99], v[36:39], v[48:51], v[84:99]
    ds_read_b128 v[64:67], v29 offset:36864
    ds_read_b128 v[56:59], v21 offset:36864
    s_add_u32 m0, s30, 18432
    s_waitcnt lgkmcnt(4)
    v_mfma_f32_32x32x16_bf16 v[100:115], v[40:43], v[44:47], v[100:115]
    buffer_load_dwordx4 v11, s[36:39], s31 offen lds
    s_add_u32 m0, s30, 19456
    v_mfma_f32_32x32x16_bf16 v[116:131], v[40:43], v[48:51], v[116:131]
    buffer_load_dwordx4 v12, s[36:39], s31 offen lds
    s_waitcnt lgkmcnt(0)
    s_waitcnt vmcnt(16)
    s_barrier
    v_mfma_f32_32x32x16_bf16 v[68:83], v[52:55], v[60:63], v[68:83]
    ds_read_b128 v[36:39], v22 offset:0
    ds_read_b128 v[44:47], v30 offset:0
    s_mov_b32 s31, 1152
    v_mfma_f32_32x32x16_bf16 v[84:99], v[52:55], v[64:67], v[84:99]
    ds_read_b128 v[48:51], v30 offset:4096
    ds_read_b128 v[40:43], v22 offset:4096
    s_add_u32 m0, s30, 32768
    v_mfma_f32_32x32x16_bf16 v[100:115], v[56:59], v[60:63], v[100:115]
    buffer_load_dwordx4 v5, s[32:35], s31 offen lds
    s_add_u32 m0, s30, 33792
    v_mfma_f32_32x32x16_bf16 v[116:131], v[56:59], v[64:67], v[116:131]
    buffer_load_dwordx4 v6, s[32:35], s31 offen lds
    s_waitcnt lgkmcnt(2)
    v_mfma_f32_32x32x16_bf16 v[68:83], v[36:39], v[44:47], v[68:83]
    ds_read_b128 v[52:55], v23 offset:0
    ds_read_b128 v[60:63], v31 offset:0
    s_waitcnt lgkmcnt(3)
    v_mfma_f32_32x32x16_bf16 v[84:99], v[36:39], v[48:51], v[84:99]
    ds_read_b128 v[64:67], v31 offset:4096
    ds_read_b128 v[56:59], v23 offset:4096
    s_add_u32 m0, s30, 34816
    s_waitcnt lgkmcnt(4)
    v_mfma_f32_32x32x16_bf16 v[100:115], v[40:43], v[44:47], v[100:115]
    buffer_load_dwordx4 v7, s[32:35], s31 offen lds
    s_add_u32 m0, s30, 35840
    v_mfma_f32_32x32x16_bf16 v[116:131], v[40:43], v[48:51], v[116:131]
    buffer_load_dwordx4 v8, s[32:35], s31 offen lds
    s_waitcnt lgkmcnt(2)
    v_mfma_f32_32x32x16_bf16 v[68:83], v[52:55], v[60:63], v[68:83]
    ds_read_b128 v[36:39], v24 offset:0
    ds_read_b128 v[44:47], v32 offset:0
    s_waitcnt lgkmcnt(3)
    v_mfma_f32_32x32x16_bf16 v[84:99], v[52:55], v[64:67], v[84:99]
    ds_read_b128 v[48:51], v32 offset:4096
    ds_read_b128 v[40:43], v24 offset:4096
    s_add_u32 m0, s30, 49152
    s_waitcnt lgkmcnt(4)
    v_mfma_f32_32x32x16_bf16 v[100:115], v[56:59], v[60:63], v[100:115]
    buffer_load_dwordx4 v9, s[36:39], s31 offen lds
    s_add_u32 m0, s30, 50176
    v_mfma_f32_32x32x16_bf16 v[116:131], v[56:59], v[64:67], v[116:131]
    buffer_load_dwordx4 v10, s[36:39], s31 offen lds
    s_waitcnt lgkmcnt(2)
    v_mfma_f32_32x32x16_bf16 v[68:83], v[36:39], v[44:47], v[68:83]
    ds_read_b128 v[52:55], v25 offset:0
    ds_read_b128 v[60:63], v33 offset:0
    s_waitcnt lgkmcnt(3)
    v_mfma_f32_32x32x16_bf16 v[84:99], v[36:39], v[48:51], v[84:99]
    ds_read_b128 v[64:67], v33 offset:4096
    ds_read_b128 v[56:59], v25 offset:4096
    s_add_u32 m0, s30, 51200
    s_waitcnt lgkmcnt(4)
    v_mfma_f32_32x32x16_bf16 v[100:115], v[40:43], v[44:47], v[100:115]
    buffer_load_dwordx4 v11, s[36:39], s31 offen lds
    s_add_u32 m0, s30, 52224
    v_mfma_f32_32x32x16_bf16 v[116:131], v[40:43], v[48:51], v[116:131]
    buffer_load_dwordx4 v12, s[36:39], s31 offen lds
    s_waitcnt lgkmcnt(0)
    s_waitcnt vmcnt(16)
    s_barrier
    v_mfma_f32_32x32x16_bf16 v[68:83], v[52:55], v[60:63], v[68:83]
    ds_read_b128 v[36:39], v22 offset:32768
    ds_read_b128 v[44:47], v30 offset:32768
    s_mov_b32 s31, 1280
    v_mfma_f32_32x32x16_bf16 v[84:99], v[52:55], v[64:67], v[84:99]
    ds_read_b128 v[48:51], v30 offset:36864
    ds_read_b128 v[40:43], v22 offset:36864
    s_add_u32 m0, s30, 65536
    v_mfma_f32_32x32x16_bf16 v[100:115], v[56:59], v[60:63], v[100:115]
    buffer_load_dwordx4 v5, s[32:35], s31 offen lds
    s_add_u32 m0, s30, 66560
    v_mfma_f32_32x32x16_bf16 v[116:131], v[56:59], v[64:67], v[116:131]
    buffer_load_dwordx4 v6, s[32:35], s31 offen lds
    s_waitcnt lgkmcnt(2)
    v_mfma_f32_32x32x16_bf16 v[68:83], v[36:39], v[44:47], v[68:83]
    ds_read_b128 v[52:55], v23 offset:32768
    ds_read_b128 v[60:63], v31 offset:32768
    s_waitcnt lgkmcnt(3)
    v_mfma_f32_32x32x16_bf16 v[84:99], v[36:39], v[48:51], v[84:99]
    ds_read_b128 v[64:67], v31 offset:36864
    ds_read_b128 v[56:59], v23 offset:36864
    s_add_u32 m0, s30, 67584
    s_waitcnt lgkmcnt(4)
    v_mfma_f32_32x32x16_bf16 v[100:115], v[40:43], v[44:47], v[100:115]
    buffer_load_dwordx4 v7, s[32:35], s31 offen lds
    s_add_u32 m0, s30, 68608
    v_mfma_f32_32x32x16_bf16 v[116:131], v[40:43], v[48:51], v[116:131]
    buffer_load_dwordx4 v8, s[32:35], s31 offen lds
    s_waitcnt lgkmcnt(2)
    v_mfma_f32_32x32x16_bf16 v[68:83], v[52:55], v[60:63], v[68:83]
    ds_read_b128 v[36:39], v24 offset:32768
    ds_read_b128 v[44:47], v32 offset:32768
    s_waitcnt lgkmcnt(3)
    v_mfma_f32_32x32x16_bf16 v[84:99], v[52:55], v[64:67], v[84:99]
    ds_read_b128 v[48:51], v32 offset:36864
    ds_read_b128 v[40:43], v24 offset:36864
    s_add_u32 m0, s30, 81920
    s_waitcnt lgkmcnt(4)
    v_mfma_f32_32x32x16_bf16 v[100:115], v[56:59], v[60:63], v[100:115]
    buffer_load_dwordx4 v9, s[36:39], s31 offen lds
    s_add_u32 m0, s30, 82944
    v_mfma_f32_32x32x16_bf16 v[116:131], v[56:59], v[64:67], v[116:131]
    buffer_load_dwordx4 v10, s[36:39], s31 offen lds
    s_waitcnt lgkmcnt(2)
    v_mfma_f32_32x32x16_bf16 v[68:83], v[36:39], v[44:47], v[68:83]
    ds_read_b128 v[52:55], v25 offset:32768
    ds_read_b128 v[60:63], v33 offset:32768
    s_waitcnt lgkmcnt(3)
    v_mfma_f32_32x32x16_bf16 v[84:99], v[36:39], v[48:51], v[84:99]
    ds_read_b128 v[64:67], v33 offset:36864
    ds_read_b128 v[56:59], v25 offset:36864
    s_add_u32 m0, s30, 83968
    s_waitcnt lgkmcnt(4)
    v_mfma_f32_32x32x16_bf16 v[100:115], v[40:43], v[44:47], v[100:115]
    buffer_load_dwordx4 v11, s[36:39], s31 offen lds
    s_add_u32 m0, s30, 84992
    v_mfma_f32_32x32x16_bf16 v[116:131], v[40:43], v[48:51], v[116:131]
    buffer_load_dwordx4 v12, s[36:39], s31 offen lds
    s_waitcnt lgkmcnt(0)
    s_waitcnt vmcnt(16)
    s_barrier
    v_mfma_f32_32x32x16_bf16 v[68:83], v[52:55], v[60:63], v[68:83]
    ds_read_b128 v[36:39], v18 offset:0
    ds_read_b128 v[44:47], v26 offset:0
    s_mov_b32 s31, 1408
    v_mfma_f32_32x32x16_bf16 v[84:99], v[52:55], v[64:67], v[84:99]
    ds_read_b128 v[48:51], v26 offset:4096
    ds_read_b128 v[40:43], v18 offset:4096
    s_add_u32 m0, s30, 98304
    v_mfma_f32_32x32x16_bf16 v[100:115], v[56:59], v[60:63], v[100:115]
    buffer_load_dwordx4 v5, s[32:35], s31 offen lds
    s_add_u32 m0, s30, 99328
    v_mfma_f32_32x32x16_bf16 v[116:131], v[56:59], v[64:67], v[116:131]
    buffer_load_dwordx4 v6, s[32:35], s31 offen lds
    s_waitcnt lgkmcnt(2)
    v_mfma_f32_32x32x16_bf16 v[68:83], v[36:39], v[44:47], v[68:83]
    ds_read_b128 v[52:55], v19 offset:0
    ds_read_b128 v[60:63], v27 offset:0
    s_waitcnt lgkmcnt(3)
    v_mfma_f32_32x32x16_bf16 v[84:99], v[36:39], v[48:51], v[84:99]
    ds_read_b128 v[64:67], v27 offset:4096
    ds_read_b128 v[56:59], v19 offset:4096
    s_add_u32 m0, s30, 100352
    s_waitcnt lgkmcnt(4)
    v_mfma_f32_32x32x16_bf16 v[100:115], v[40:43], v[44:47], v[100:115]
    buffer_load_dwordx4 v7, s[32:35], s31 offen lds
    s_add_u32 m0, s30, 101376
    v_mfma_f32_32x32x16_bf16 v[116:131], v[40:43], v[48:51], v[116:131]
    buffer_load_dwordx4 v8, s[32:35], s31 offen lds
    s_waitcnt lgkmcnt(2)
    v_mfma_f32_32x32x16_bf16 v[68:83], v[52:55], v[60:63], v[68:83]
    ds_read_b128 v[36:39], v20 offset:0
    ds_read_b128 v[44:47], v28 offset:0
    s_waitcnt lgkmcnt(3)
    v_mfma_f32_32x32x16_bf16 v[84:99], v[52:55], v[64:67], v[84:99]
    ds_read_b128 v[48:51], v28 offset:4096
    ds_read_b128 v[40:43], v20 offset:4096
    s_add_u32 m0, s30, 114688
    s_waitcnt lgkmcnt(4)
    v_mfma_f32_32x32x16_bf16 v[100:115], v[56:59], v[60:63], v[100:115]
    buffer_load_dwordx4 v9, s[36:39], s31 offen lds
    s_add_u32 m0, s30, 115712
    v_mfma_f32_32x32x16_bf16 v[116:131], v[56:59], v[64:67], v[116:131]
    buffer_load_dwordx4 v10, s[36:39], s31 offen lds
    s_waitcnt lgkmcnt(2)
    v_mfma_f32_32x32x16_bf16 v[68:83], v[36:39], v[44:47], v[68:83]
    ds_read_b128 v[52:55], v21 offset:0
    ds_read_b128 v[60:63], v29 offset:0
    s_waitcnt lgkmcnt(3)
    v_mfma_f32_32x32x16_bf16 v[84:99], v[36:39], v[48:51], v[84:99]
    ds_read_b128 v[64:67], v29 offset:4096
    ds_read_b128 v[56:59], v21 offset:4096
    s_add_u32 m0, s30, 116736
    s_waitcnt lgkmcnt(4)
    v_mfma_f32_32x32x16_bf16 v[100:115], v[40:43], v[44:47], v[100:115]
    buffer_load_dwordx4 v11, s[36:39], s31 offen lds
    s_add_u32 m0, s30, 117760
    v_mfma_f32_32x32x16_bf16 v[116:131], v[40:43], v[48:51], v[116:131]
    buffer_load_dwordx4 v12, s[36:39], s31 offen lds
    s_waitcnt lgkmcnt(0)
    s_waitcnt vmcnt(16)
    s_barrier
    v_mfma_f32_32x32x16_bf16 v[68:83], v[52:55], v[60:63], v[68:83]
    ds_read_b128 v[36:39], v18 offset:32768
    ds_read_b128 v[44:47], v26 offset:32768
    s_mov_b32 s31, 1536
    v_mfma_f32_32x32x16_bf16 v[84:99], v[52:55], v[64:67], v[84:99]
    ds_read_b128 v[48:51], v26 offset:36864
    ds_read_b128 v[40:43], v18 offset:36864
    s_add_u32 m0, s30, 0
    v_mfma_f32_32x32x16_bf16 v[100:115], v[56:59], v[60:63], v[100:115]
    buffer_load_dwordx4 v5, s[32:35], s31 offen lds
    s_add_u32 m0, s30, 1024
    v_mfma_f32_32x32x16_bf16 v[116:131], v[56:59], v[64:67], v[116:131]
    buffer_load_dwordx4 v6, s[32:35], s31 offen lds
    s_waitcnt lgkmcnt(2)
    v_mfma_f32_32x32x16_bf16 v[68:83], v[36:39], v[44:47], v[68:83]
    ds_read_b128 v[52:55], v19 offset:32768
    ds_read_b128 v[60:63], v27 offset:32768
    s_waitcnt lgkmcnt(3)
    v_mfma_f32_32x32x16_bf16 v[84:99], v[36:39], v[48:51], v[84:99]
    ds_read_b128 v[64:67], v27 offset:36864
    ds_read_b128 v[56:59], v19 offset:36864
    s_add_u32 m0, s30, 2048
    s_waitcnt lgkmcnt(4)
    v_mfma_f32_32x32x16_bf16 v[100:115], v[40:43], v[44:47], v[100:115]
    buffer_load_dwordx4 v7, s[32:35], s31 offen lds
    s_add_u32 m0, s30, 3072
    v_mfma_f32_32x32x16_bf16 v[116:131], v[40:43], v[48:51], v[116:131]
    buffer_load_dwordx4 v8, s[32:35], s31 offen lds
    s_waitcnt lgkmcnt(2)
    v_mfma_f32_32x32x16_bf16 v[68:83], v[52:55], v[60:63], v[68:83]
    ds_read_b128 v[36:39], v20 offset:32768
    ds_read_b128 v[44:47], v28 offset:32768
    s_waitcnt lgkmcnt(3)
    v_mfma_f32_32x32x16_bf16 v[84:99], v[52:55], v[64:67], v[84:99]
    ds_read_b128 v[48:51], v28 offset:36864
    ds_read_b128 v[40:43], v20 offset:36864
    s_add_u32 m0, s30, 16384
    s_waitcnt lgkmcnt(4)
    v_mfma_f32_32x32x16_bf16 v[100:115], v[56:59], v[60:63], v[100:115]
    buffer_load_dwordx4 v9, s[36:39], s31 offen lds
    s_add_u32 m0, s30, 17408
    v_mfma_f32_32x32x16_bf16 v[116:131], v[56:59], v[64:67], v[116:131]
    buffer_load_dwordx4 v10, s[36:39], s31 offen lds
    s_waitcnt lgkmcnt(2)
    v_mfma_f32_32x32x16_bf16 v[68:83], v[36:39], v[44:47], v[68:83]
    ds_read_b128 v[52:55], v21 offset:32768
    ds_read_b128 v[60:63], v29 offset:32768
    s_waitcnt lgkmcnt(3)
    v_mfma_f32_32x32x16_bf16 v[84:99], v[36:39], v[48:51], v[84:99]
    ds_read_b128 v[64:67], v29 offset:36864
    ds_read_b128 v[56:59], v21 offset:36864
    s_add_u32 m0, s30, 18432
    s_waitcnt lgkmcnt(4)
    v_mfma_f32_32x32x16_bf16 v[100:115], v[40:43], v[44:47], v[100:115]
    buffer_load_dwordx4 v11, s[36:39], s31 offen lds
    s_add_u32 m0, s30, 19456
    v_mfma_f32_32x32x16_bf16 v[116:131], v[40:43], v[48:51], v[116:131]
    buffer_load_dwordx4 v12, s[36:39], s31 offen lds
    s_waitcnt lgkmcnt(0)
    s_waitcnt vmcnt(16)
    s_barrier
    v_mfma_f32_32x32x16_bf16 v[68:83], v[52:55], v[60:63], v[68:83]
    ds_read_b128 v[36:39], v22 offset:0
    ds_read_b128 v[44:47], v30 offset:0
    s_mov_b32 s31, 1664
    v_mfma_f32_32x32x16_bf16 v[84:99], v[52:55], v[64:67], v[84:99]
    ds_read_b128 v[48:51], v30 offset:4096
    ds_read_b128 v[40:43], v22 offset:4096
    s_add_u32 m0, s30, 32768
    v_mfma_f32_32x32x16_bf16 v[100:115], v[56:59], v[60:63], v[100:115]
    buffer_load_dwordx4 v5, s[32:35], s31 offen lds
    s_add_u32 m0, s30, 33792
    v_mfma_f32_32x32x16_bf16 v[116:131], v[56:59], v[64:67], v[116:131]
    buffer_load_dwordx4 v6, s[32:35], s31 offen lds
    s_waitcnt lgkmcnt(2)
    v_mfma_f32_32x32x16_bf16 v[68:83], v[36:39], v[44:47], v[68:83]
    ds_read_b128 v[52:55], v23 offset:0
    ds_read_b128 v[60:63], v31 offset:0
    s_waitcnt lgkmcnt(3)
    v_mfma_f32_32x32x16_bf16 v[84:99], v[36:39], v[48:51], v[84:99]
    ds_read_b128 v[64:67], v31 offset:4096
    ds_read_b128 v[56:59], v23 offset:4096
    s_add_u32 m0, s30, 34816
    s_waitcnt lgkmcnt(4)
    v_mfma_f32_32x32x16_bf16 v[100:115], v[40:43], v[44:47], v[100:115]
    buffer_load_dwordx4 v7, s[32:35], s31 offen lds
    s_add_u32 m0, s30, 35840
    v_mfma_f32_32x32x16_bf16 v[116:131], v[40:43], v[48:51], v[116:131]
    buffer_load_dwordx4 v8, s[32:35], s31 offen lds
    s_waitcnt lgkmcnt(2)
    v_mfma_f32_32x32x16_bf16 v[68:83], v[52:55], v[60:63], v[68:83]
    ds_read_b128 v[36:39], v24 offset:0
    ds_read_b128 v[44:47], v32 offset:0
    s_waitcnt lgkmcnt(3)
    v_mfma_f32_32x32x16_bf16 v[84:99], v[52:55], v[64:67], v[84:99]
    ds_read_b128 v[48:51], v32 offset:4096
    ds_read_b128 v[40:43], v24 offset:4096
    s_add_u32 m0, s30, 49152
    s_waitcnt lgkmcnt(4)
    v_mfma_f32_32x32x16_bf16 v[100:115], v[56:59], v[60:63], v[100:115]
    buffer_load_dwordx4 v9, s[36:39], s31 offen lds
    s_add_u32 m0, s30, 50176
    v_mfma_f32_32x32x16_bf16 v[116:131], v[56:59], v[64:67], v[116:131]
    buffer_load_dwordx4 v10, s[36:39], s31 offen lds
    s_waitcnt lgkmcnt(2)
    v_mfma_f32_32x32x16_bf16 v[68:83], v[36:39], v[44:47], v[68:83]
    ds_read_b128 v[52:55], v25 offset:0
    ds_read_b128 v[60:63], v33 offset:0
    s_waitcnt lgkmcnt(3)
    v_mfma_f32_32x32x16_bf16 v[84:99], v[36:39], v[48:51], v[84:99]
    ds_read_b128 v[64:67], v33 offset:4096
    ds_read_b128 v[56:59], v25 offset:4096
    s_add_u32 m0, s30, 51200
    s_waitcnt lgkmcnt(4)
    v_mfma_f32_32x32x16_bf16 v[100:115], v[40:43], v[44:47], v[100:115]
    buffer_load_dwordx4 v11, s[36:39], s31 offen lds
    s_add_u32 m0, s30, 52224
    v_mfma_f32_32x32x16_bf16 v[116:131], v[40:43], v[48:51], v[116:131]
    buffer_load_dwordx4 v12, s[36:39], s31 offen lds
    s_waitcnt lgkmcnt(0)
    s_waitcnt vmcnt(16)
    s_barrier
    v_mfma_f32_32x32x16_bf16 v[68:83], v[52:55], v[60:63], v[68:83]
    ds_read_b128 v[36:39], v22 offset:32768
    ds_read_b128 v[44:47], v30 offset:32768
    s_mov_b32 s31, 1792
    v_mfma_f32_32x32x16_bf16 v[84:99], v[52:55], v[64:67], v[84:99]
    ds_read_b128 v[48:51], v30 offset:36864
    ds_read_b128 v[40:43], v22 offset:36864
    s_add_u32 m0, s30, 65536
    v_mfma_f32_32x32x16_bf16 v[100:115], v[56:59], v[60:63], v[100:115]
    buffer_load_dwordx4 v5, s[32:35], s31 offen lds
    s_add_u32 m0, s30, 66560
    v_mfma_f32_32x32x16_bf16 v[116:131], v[56:59], v[64:67], v[116:131]
    buffer_load_dwordx4 v6, s[32:35], s31 offen lds
    s_waitcnt lgkmcnt(2)
    v_mfma_f32_32x32x16_bf16 v[68:83], v[36:39], v[44:47], v[68:83]
    ds_read_b128 v[52:55], v23 offset:32768
    ds_read_b128 v[60:63], v31 offset:32768
    s_waitcnt lgkmcnt(3)
    v_mfma_f32_32x32x16_bf16 v[84:99], v[36:39], v[48:51], v[84:99]
    ds_read_b128 v[64:67], v31 offset:36864
    ds_read_b128 v[56:59], v23 offset:36864
    s_add_u32 m0, s30, 67584
    s_waitcnt lgkmcnt(4)
    v_mfma_f32_32x32x16_bf16 v[100:115], v[40:43], v[44:47], v[100:115]
    buffer_load_dwordx4 v7, s[32:35], s31 offen lds
    s_add_u32 m0, s30, 68608
    v_mfma_f32_32x32x16_bf16 v[116:131], v[40:43], v[48:51], v[116:131]
    buffer_load_dwordx4 v8, s[32:35], s31 offen lds
    s_waitcnt lgkmcnt(2)
    v_mfma_f32_32x32x16_bf16 v[68:83], v[52:55], v[60:63], v[68:83]
    ds_read_b128 v[36:39], v24 offset:32768
    ds_read_b128 v[44:47], v32 offset:32768
    s_waitcnt lgkmcnt(3)
    v_mfma_f32_32x32x16_bf16 v[84:99], v[52:55], v[64:67], v[84:99]
    ds_read_b128 v[48:51], v32 offset:36864
    ds_read_b128 v[40:43], v24 offset:36864
    s_add_u32 m0, s30, 81920
    s_waitcnt lgkmcnt(4)
    v_mfma_f32_32x32x16_bf16 v[100:115], v[56:59], v[60:63], v[100:115]
    buffer_load_dwordx4 v9, s[36:39], s31 offen lds
    s_add_u32 m0, s30, 82944
    v_mfma_f32_32x32x16_bf16 v[116:131], v[56:59], v[64:67], v[116:131]
    buffer_load_dwordx4 v10, s[36:39], s31 offen lds
    s_waitcnt lgkmcnt(2)
    v_mfma_f32_32x32x16_bf16 v[68:83], v[36:39], v[44:47], v[68:83]
    ds_read_b128 v[52:55], v25 offset:32768
    ds_read_b128 v[60:63], v33 offset:32768
    s_waitcnt lgkmcnt(3)
    v_mfma_f32_32x32x16_bf16 v[84:99], v[36:39], v[48:51], v[84:99]
    ds_read_b128 v[64:67], v33 offset:36864
    ds_read_b128 v[56:59], v25 offset:36864
    s_add_u32 m0, s30, 83968
    s_waitcnt lgkmcnt(4)
    v_mfma_f32_32x32x16_bf16 v[100:115], v[40:43], v[44:47], v[100:115]
    buffer_load_dwordx4 v11, s[36:39], s31 offen lds
    s_add_u32 m0, s30, 84992
    v_mfma_f32_32x32x16_bf16 v[116:131], v[40:43], v[48:51], v[116:131]
    buffer_load_dwordx4 v12, s[36:39], s31 offen lds
    s_waitcnt lgkmcnt(0)
    s_waitcnt vmcnt(16)
    s_barrier
    v_mfma_f32_32x32x16_bf16 v[68:83], v[52:55], v[60:63], v[68:83]
    ds_read_b128 v[36:39], v18 offset:0
    ds_read_b128 v[44:47], v26 offset:0
    s_mov_b32 s31, 1920
    v_mfma_f32_32x32x16_bf16 v[84:99], v[52:55], v[64:67], v[84:99]
    ds_read_b128 v[48:51], v26 offset:4096
    ds_read_b128 v[40:43], v18 offset:4096
    s_add_u32 m0, s30, 98304
    v_mfma_f32_32x32x16_bf16 v[100:115], v[56:59], v[60:63], v[100:115]
    buffer_load_dwordx4 v5, s[32:35], s31 offen lds
    s_add_u32 m0, s30, 99328
    v_mfma_f32_32x32x16_bf16 v[116:131], v[56:59], v[64:67], v[116:131]
    buffer_load_dwordx4 v6, s[32:35], s31 offen lds
    s_waitcnt lgkmcnt(2)
    v_mfma_f32_32x32x16_bf16 v[68:83], v[36:39], v[44:47], v[68:83]
    ds_read_b128 v[52:55], v19 offset:0
    ds_read_b128 v[60:63], v27 offset:0
    s_waitcnt lgkmcnt(3)
    v_mfma_f32_32x32x16_bf16 v[84:99], v[36:39], v[48:51], v[84:99]
    ds_read_b128 v[64:67], v27 offset:4096
    ds_read_b128 v[56:59], v19 offset:4096
    s_add_u32 m0, s30, 100352
    s_waitcnt lgkmcnt(4)
    v_mfma_f32_32x32x16_bf16 v[100:115], v[40:43], v[44:47], v[100:115]
    buffer_load_dwordx4 v7, s[32:35], s31 offen lds
    s_add_u32 m0, s30, 101376
    v_mfma_f32_32x32x16_bf16 v[116:131], v[40:43], v[48:51], v[116:131]
    buffer_load_dwordx4 v8, s[32:35], s31 offen lds
    s_waitcnt lgkmcnt(2)
    v_mfma_f32_32x32x16_bf16 v[68:83], v[52:55], v[60:63], v[68:83]
    ds_read_b128 v[36:39], v20 offset:0
    ds_read_b128 v[44:47], v28 offset:0
    s_waitcnt lgkmcnt(3)
    v_mfma_f32_32x32x16_bf16 v[84:99], v[52:55], v[64:67], v[84:99]
    ds_read_b128 v[48:51], v28 offset:4096
    ds_read_b128 v[40:43], v20 offset:4096
    s_add_u32 m0, s30, 114688
    s_waitcnt lgkmcnt(4)
    v_mfma_f32_32x32x16_bf16 v[100:115], v[56:59], v[60:63], v[100:115]
    buffer_load_dwordx4 v9, s[36:39], s31 offen lds
    s_add_u32 m0, s30, 115712
    v_mfma_f32_32x32x16_bf16 v[116:131], v[56:59], v[64:67], v[116:131]
    buffer_load_dwordx4 v10, s[36:39], s31 offen lds
    s_waitcnt lgkmcnt(2)
    v_mfma_f32_32x32x16_bf16 v[68:83], v[36:39], v[44:47], v[68:83]
    ds_read_b128 v[52:55], v21 offset:0
    ds_read_b128 v[60:63], v29 offset:0
    s_waitcnt lgkmcnt(3)
    v_mfma_f32_32x32x16_bf16 v[84:99], v[36:39], v[48:51], v[84:99]
    ds_read_b128 v[64:67], v29 offset:4096
    ds_read_b128 v[56:59], v21 offset:4096
    s_add_u32 m0, s30, 116736
    s_waitcnt lgkmcnt(4)
    v_mfma_f32_32x32x16_bf16 v[100:115], v[40:43], v[44:47], v[100:115]
    buffer_load_dwordx4 v11, s[36:39], s31 offen lds
    s_add_u32 m0, s30, 117760
    v_mfma_f32_32x32x16_bf16 v[116:131], v[40:43], v[48:51], v[116:131]
    buffer_load_dwordx4 v12, s[36:39], s31 offen lds
    s_waitcnt lgkmcnt(0)
    s_waitcnt vmcnt(16)
    s_barrier
    v_mfma_f32_32x32x16_bf16 v[68:83], v[52:55], v[60:63], v[68:83]
    ds_read_b128 v[36:39], v18 offset:32768
    ds_read_b128 v[44:47], v26 offset:32768
    v_mfma_f32_32x32x16_bf16 v[84:99], v[52:55], v[64:67], v[84:99]
    ds_read_b128 v[48:51], v26 offset:36864
    ds_read_b128 v[40:43], v18 offset:36864
    v_mfma_f32_32x32x16_bf16 v[100:115], v[56:59], v[60:63], v[100:115]
    v_mfma_f32_32x32x16_bf16 v[116:131], v[56:59], v[64:67], v[116:131]
    s_waitcnt lgkmcnt(2)
    v_mfma_f32_32x32x16_bf16 v[68:83], v[36:39], v[44:47], v[68:83]
    ds_read_b128 v[52:55], v19 offset:32768
    ds_read_b128 v[60:63], v27 offset:32768
    s_waitcnt lgkmcnt(3)
    v_mfma_f32_32x32x16_bf16 v[84:99], v[36:39], v[48:51], v[84:99]
    ds_read_b128 v[64:67], v27 offset:36864
    ds_read_b128 v[56:59], v19 offset:36864
    s_waitcnt lgkmcnt(4)
    v_mfma_f32_32x32x16_bf16 v[100:115], v[40:43], v[44:47], v[100:115]
    v_mfma_f32_32x32x16_bf16 v[116:131], v[40:43], v[48:51], v[116:131]
    s_waitcnt lgkmcnt(2)
    v_mfma_f32_32x32x16_bf16 v[68:83], v[52:55], v[60:63], v[68:83]
    ds_read_b128 v[36:39], v20 offset:32768
    ds_read_b128 v[44:47], v28 offset:32768
    s_waitcnt lgkmcnt(3)
    v_mfma_f32_32x32x16_bf16 v[84:99], v[52:55], v[64:67], v[84:99]
    ds_read_b128 v[48:51], v28 offset:36864
    ds_read_b128 v[40:43], v20 offset:36864
    s_waitcnt lgkmcnt(4)
    v_mfma_f32_32x32x16_bf16 v[100:115], v[56:59], v[60:63], v[100:115]
    v_mfma_f32_32x32x16_bf16 v[116:131], v[56:59], v[64:67], v[116:131]
    s_waitcnt lgkmcnt(2)
    v_mfma_f32_32x32x16_bf16 v[68:83], v[36:39], v[44:47], v[68:83]
    ds_read_b128 v[52:55], v21 offset:32768
    ds_read_b128 v[60:63], v29 offset:32768
    s_waitcnt lgkmcnt(3)
    v_mfma_f32_32x32x16_bf16 v[84:99], v[36:39], v[48:51], v[84:99]
    ds_read_b128 v[64:67], v29 offset:36864
    ds_read_b128 v[56:59], v21 offset:36864
    s_waitcnt lgkmcnt(4)
    v_mfma_f32_32x32x16_bf16 v[100:115], v[40:43], v[44:47], v[100:115]
    v_mfma_f32_32x32x16_bf16 v[116:131], v[40:43], v[48:51], v[116:131]
    s_waitcnt lgkmcnt(0)
    s_waitcnt vmcnt(8)
    s_barrier
    v_mfma_f32_32x32x16_bf16 v[68:83], v[52:55], v[60:63], v[68:83]
    ds_read_b128 v[36:39], v22 offset:0
    ds_read_b128 v[44:47], v30 offset:0
    v_mfma_f32_32x32x16_bf16 v[84:99], v[52:55], v[64:67], v[84:99]
    ds_read_b128 v[48:51], v30 offset:4096
    ds_read_b128 v[40:43], v22 offset:4096
    v_mfma_f32_32x32x16_bf16 v[100:115], v[56:59], v[60:63], v[100:115]
    v_mfma_f32_32x32x16_bf16 v[116:131], v[56:59], v[64:67], v[116:131]
    s_waitcnt lgkmcnt(2)
    v_mfma_f32_32x32x16_bf16 v[68:83], v[36:39], v[44:47], v[68:83]
    ds_read_b128 v[52:55], v23 offset:0
    ds_read_b128 v[60:63], v31 offset:0
    s_waitcnt lgkmcnt(3)
    v_mfma_f32_32x32x16_bf16 v[84:99], v[36:39], v[48:51], v[84:99]
    ds_read_b128 v[64:67], v31 offset:4096
    ds_read_b128 v[56:59], v23 offset:4096
    s_waitcnt lgkmcnt(4)
    v_mfma_f32_32x32x16_bf16 v[100:115], v[40:43], v[44:47], v[100:115]
    v_mfma_f32_32x32x16_bf16 v[116:131], v[40:43], v[48:51], v[116:131]
    s_waitcnt lgkmcnt(2)
    v_mfma_f32_32x32x16_bf16 v[68:83], v[52:55], v[60:63], v[68:83]
    ds_read_b128 v[36:39], v24 offset:0
    ds_read_b128 v[44:47], v32 offset:0
    s_waitcnt lgkmcnt(3)
    v_mfma_f32_32x32x16_bf16 v[84:99], v[52:55], v[64:67], v[84:99]
    ds_read_b128 v[48:51], v32 offset:4096
    ds_read_b128 v[40:43], v24 offset:4096
    s_waitcnt lgkmcnt(4)
    v_mfma_f32_32x32x16_bf16 v[100:115], v[56:59], v[60:63], v[100:115]
    v_mfma_f32_32x32x16_bf16 v[116:131], v[56:59], v[64:67], v[116:131]
    s_waitcnt lgkmcnt(2)
    v_mfma_f32_32x32x16_bf16 v[68:83], v[36:39], v[44:47], v[68:83]
    ds_read_b128 v[52:55], v25 offset:0
    ds_read_b128 v[60:63], v33 offset:0
    s_waitcnt lgkmcnt(3)
    v_mfma_f32_32x32x16_bf16 v[84:99], v[36:39], v[48:51], v[84:99]
    ds_read_b128 v[64:67], v33 offset:4096
    ds_read_b128 v[56:59], v25 offset:4096
    s_waitcnt lgkmcnt(4)
    v_mfma_f32_32x32x16_bf16 v[100:115], v[40:43], v[44:47], v[100:115]
    v_mfma_f32_32x32x16_bf16 v[116:131], v[40:43], v[48:51], v[116:131]
    s_waitcnt lgkmcnt(0)
    s_waitcnt vmcnt(0)
    s_barrier
    v_mfma_f32_32x32x16_bf16 v[68:83], v[52:55], v[60:63], v[68:83]
    ds_read_b128 v[36:39], v22 offset:32768
    ds_read_b128 v[44:47], v30 offset:32768
    v_mfma_f32_32x32x16_bf16 v[84:99], v[52:55], v[64:67], v[84:99]
    ds_read_b128 v[48:51], v30 offset:36864
    ds_read_b128 v[40:43], v22 offset:36864
    v_mfma_f32_32x32x16_bf16 v[100:115], v[56:59], v[60:63], v[100:115]
    v_mfma_f32_32x32x16_bf16 v[116:131], v[56:59], v[64:67], v[116:131]
    s_waitcnt lgkmcnt(2)
    v_mfma_f32_32x32x16_bf16 v[68:83], v[36:39], v[44:47], v[68:83]
    ds_read_b128 v[52:55], v23 offset:32768
    ds_read_b128 v[60:63], v31 offset:32768
    s_waitcnt lgkmcnt(3)
    v_mfma_f32_32x32x16_bf16 v[84:99], v[36:39], v[48:51], v[84:99]
    ds_read_b128 v[64:67], v31 offset:36864
    ds_read_b128 v[56:59], v23 offset:36864
    s_waitcnt lgkmcnt(4)
    v_mfma_f32_32x32x16_bf16 v[100:115], v[40:43], v[44:47], v[100:115]
    v_mfma_f32_32x32x16_bf16 v[116:131], v[40:43], v[48:51], v[116:131]
    s_waitcnt lgkmcnt(2)
    v_mfma_f32_32x32x16_bf16 v[68:83], v[52:55], v[60:63], v[68:83]
    ds_read_b128 v[36:39], v24 offset:32768
    ds_read_b128 v[44:47], v32 offset:32768
    s_waitcnt lgkmcnt(3)
    v_mfma_f32_32x32x16_bf16 v[84:99], v[52:55], v[64:67], v[84:99]
    ds_read_b128 v[48:51], v32 offset:36864
    ds_read_b128 v[40:43], v24 offset:36864
    s_waitcnt lgkmcnt(4)
    v_mfma_f32_32x32x16_bf16 v[100:115], v[56:59], v[60:63], v[100:115]
    v_mfma_f32_32x32x16_bf16 v[116:131], v[56:59], v[64:67], v[116:131]
    s_waitcnt lgkmcnt(2)
    v_mfma_f32_32x32x16_bf16 v[68:83], v[36:39], v[44:47], v[68:83]
    ds_read_b128 v[52:55], v25 offset:32768
    ds_read_b128 v[60:63], v33 offset:32768
    s_waitcnt lgkmcnt(3)
    v_mfma_f32_32x32x16_bf16 v[84:99], v[36:39], v[48:51], v[84:99]
    ds_read_b128 v[64:67], v33 offset:36864
    ds_read_b128 v[56:59], v25 offset:36864
    s_waitcnt lgkmcnt(4)
    v_mfma_f32_32x32x16_bf16 v[100:115], v[40:43], v[44:47], v[100:115]
    v_mfma_f32_32x32x16_bf16 v[116:131], v[40:43], v[48:51], v[116:131]
    s_waitcnt lgkmcnt(0)
    s_barrier
    v_mfma_f32_32x32x16_bf16 v[68:83], v[52:55], v[60:63], v[68:83]
    v_mfma_f32_32x32x16_bf16 v[84:99], v[52:55], v[64:67], v[84:99]
    v_mfma_f32_32x32x16_bf16 v[100:115], v[56:59], v[60:63], v[100:115]
    v_mfma_f32_32x32x16_bf16 v[116:131], v[56:59], v[64:67], v[116:131]
    s_nop 9
    v_pk_fma_f32 v[156:157], v[84:85], v[136:137], v[70:71] op_sel:[0,1,0] op_sel_hi:[1,1,1] neg_lo:[0,1,0] neg_hi:[0,1,0]
    v_pk_fma_f32 v[158:159], v[68:69], v[136:137], v[86:87] op_sel:[0,1,0] op_sel_hi:[1,1,1]
    v_pk_fma_f32 v[2:3], v[68:69], v[136:137], v[156:157] op_sel:[0,0,0] op_sel_hi:[1,0,1]
    v_pk_fma_f32 v[154:155], v[84:85], v[136:137], v[158:159] op_sel:[0,0,0] op_sel_hi:[1,0,1]
    v_pk_fma_f32 v[156:157], v[154:155], v[136:137], v[72:73] op_sel:[0,1,0] op_sel_hi:[1,1,1] neg_lo:[0,1,0] neg_hi:[0,1,0]
    v_pk_fma_f32 v[158:159], v[2:3], v[136:137], v[88:89] op_sel:[0,1,0] op_sel_hi:[1,1,1]
    v_pk_fma_f32 v[2:3], v[2:3], v[136:137], v[156:157] op_sel:[0,0,0] op_sel_hi:[1,0,1]
    v_pk_fma_f32 v[154:155], v[154:155], v[136:137], v[158:159] op_sel:[0,0,0] op_sel_hi:[1,0,1]
    v_pk_fma_f32 v[156:157], v[154:155], v[136:137], v[74:75] op_sel:[0,1,0] op_sel_hi:[1,1,1] neg_lo:[0,1,0] neg_hi:[0,1,0]
    v_pk_fma_f32 v[158:159], v[2:3], v[136:137], v[90:91] op_sel:[0,1,0] op_sel_hi:[1,1,1]
    v_pk_fma_f32 v[2:3], v[2:3], v[136:137], v[156:157] op_sel:[0,0,0] op_sel_hi:[1,0,1]
    v_pk_fma_f32 v[154:155], v[154:155], v[136:137], v[158:159] op_sel:[0,0,0] op_sel_hi:[1,0,1]
    v_pk_fma_f32 v[156:157], v[154:155], v[136:137], v[76:77] op_sel:[0,1,0] op_sel_hi:[1,1,1] neg_lo:[0,1,0] neg_hi:[0,1,0]
    v_pk_fma_f32 v[158:159], v[2:3], v[136:137], v[92:93] op_sel:[0,1,0] op_sel_hi:[1,1,1]
    v_pk_fma_f32 v[2:3], v[2:3], v[136:137], v[156:157] op_sel:[0,0,0] op_sel_hi:[1,0,1]
    v_pk_fma_f32 v[154:155], v[154:155], v[136:137], v[158:159] op_sel:[0,0,0] op_sel_hi:[1,0,1]
    v_pk_fma_f32 v[156:157], v[154:155], v[136:137], v[78:79] op_sel:[0,1,0] op_sel_hi:[1,1,1] neg_lo:[0,1,0] neg_hi:[0,1,0]
    v_pk_fma_f32 v[158:159], v[2:3], v[136:137], v[94:95] op_sel:[0,1,0] op_sel_hi:[1,1,1]
    v_pk_fma_f32 v[2:3], v[2:3], v[136:137], v[156:157] op_sel:[0,0,0] op_sel_hi:[1,0,1]
    v_pk_fma_f32 v[154:155], v[154:155], v[136:137], v[158:159] op_sel:[0,0,0] op_sel_hi:[1,0,1]
    v_pk_fma_f32 v[156:157], v[154:155], v[136:137], v[80:81] op_sel:[0,1,0] op_sel_hi:[1,1,1] neg_lo:[0,1,0] neg_hi:[0,1,0]
    v_pk_fma_f32 v[158:159], v[2:3], v[136:137], v[96:97] op_sel:[0,1,0] op_sel_hi:[1,1,1]
    v_pk_fma_f32 v[2:3], v[2:3], v[136:137], v[156:157] op_sel:[0,0,0] op_sel_hi:[1,0,1]
    v_pk_fma_f32 v[154:155], v[154:155], v[136:137], v[158:159] op_sel:[0,0,0] op_sel_hi:[1,0,1]
    v_pk_fma_f32 v[156:157], v[154:155], v[136:137], v[82:83] op_sel:[0,1,0] op_sel_hi:[1,1,1] neg_lo:[0,1,0] neg_hi:[0,1,0]
    v_pk_fma_f32 v[158:159], v[2:3], v[136:137], v[98:99] op_sel:[0,1,0] op_sel_hi:[1,1,1]
    v_pk_fma_f32 v[2:3], v[2:3], v[136:137], v[156:157] op_sel:[0,0,0] op_sel_hi:[1,0,1]
    v_pk_fma_f32 v[154:155], v[154:155], v[136:137], v[158:159] op_sel:[0,0,0] op_sel_hi:[1,0,1]
    v_pk_fma_f32 v[156:157], v[154:155], v[136:137], v[100:101] op_sel:[0,1,0] op_sel_hi:[1,1,1] neg_lo:[0,1,0] neg_hi:[0,1,0]
    v_pk_fma_f32 v[158:159], v[2:3], v[136:137], v[116:117] op_sel:[0,1,0] op_sel_hi:[1,1,1]
    v_pk_fma_f32 v[2:3], v[2:3], v[136:137], v[156:157] op_sel:[0,0,0] op_sel_hi:[1,0,1]
    v_pk_fma_f32 v[154:155], v[154:155], v[136:137], v[158:159] op_sel:[0,0,0] op_sel_hi:[1,0,1]
    v_pk_fma_f32 v[156:157], v[154:155], v[136:137], v[102:103] op_sel:[0,1,0] op_sel_hi:[1,1,1] neg_lo:[0,1,0] neg_hi:[0,1,0]
    v_pk_fma_f32 v[158:159], v[2:3], v[136:137], v[118:119] op_sel:[0,1,0] op_sel_hi:[1,1,1]
    v_pk_fma_f32 v[2:3], v[2:3], v[136:137], v[156:157] op_sel:[0,0,0] op_sel_hi:[1,0,1]
    v_pk_fma_f32 v[154:155], v[154:155], v[136:137], v[158:159] op_sel:[0,0,0] op_sel_hi:[1,0,1]
    v_pk_fma_f32 v[156:157], v[154:155], v[136:137], v[104:105] op_sel:[0,1,0] op_sel_hi:[1,1,1] neg_lo:[0,1,0] neg_hi:[0,1,0]
    v_pk_fma_f32 v[158:159], v[2:3], v[136:137], v[120:121] op_sel:[0,1,0] op_sel_hi:[1,1,1]
    v_pk_fma_f32 v[2:3], v[2:3], v[136:137], v[156:157] op_sel:[0,0,0] op_sel_hi:[1,0,1]
    v_pk_fma_f32 v[154:155], v[154:155], v[136:137], v[158:159] op_sel:[0,0,0] op_sel_hi:[1,0,1]
    v_pk_fma_f32 v[156:157], v[154:155], v[136:137], v[106:107] op_sel:[0,1,0] op_sel_hi:[1,1,1] neg_lo:[0,1,0] neg_hi:[0,1,0]
    v_pk_fma_f32 v[158:159], v[2:3], v[136:137], v[122:123] op_sel:[0,1,0] op_sel_hi:[1,1,1]
    v_pk_fma_f32 v[2:3], v[2:3], v[136:137], v[156:157] op_sel:[0,0,0] op_sel_hi:[1,0,1]
    v_pk_fma_f32 v[154:155], v[154:155], v[136:137], v[158:159] op_sel:[0,0,0] op_sel_hi:[1,0,1]
    v_pk_fma_f32 v[156:157], v[154:155], v[136:137], v[108:109] op_sel:[0,1,0] op_sel_hi:[1,1,1] neg_lo:[0,1,0] neg_hi:[0,1,0]
    v_pk_fma_f32 v[158:159], v[2:3], v[136:137], v[124:125] op_sel:[0,1,0] op_sel_hi:[1,1,1]
    v_pk_fma_f32 v[2:3], v[2:3], v[136:137], v[156:157] op_sel:[0,0,0] op_sel_hi:[1,0,1]
    v_pk_fma_f32 v[154:155], v[154:155], v[136:137], v[158:159] op_sel:[0,0,0] op_sel_hi:[1,0,1]
    v_pk_fma_f32 v[156:157], v[154:155], v[136:137], v[110:111] op_sel:[0,1,0] op_sel_hi:[1,1,1] neg_lo:[0,1,0] neg_hi:[0,1,0]
    v_pk_fma_f32 v[158:159], v[2:3], v[136:137], v[126:127] op_sel:[0,1,0] op_sel_hi:[1,1,1]
    v_pk_fma_f32 v[2:3], v[2:3], v[136:137], v[156:157] op_sel:[0,0,0] op_sel_hi:[1,0,1]
    v_pk_fma_f32 v[154:155], v[154:155], v[136:137], v[158:159] op_sel:[0,0,0] op_sel_hi:[1,0,1]
    v_pk_fma_f32 v[156:157], v[154:155], v[136:137], v[112:113] op_sel:[0,1,0] op_sel_hi:[1,1,1] neg_lo:[0,1,0] neg_hi:[0,1,0]
    v_pk_fma_f32 v[158:159], v[2:3], v[136:137], v[128:129] op_sel:[0,1,0] op_sel_hi:[1,1,1]
    v_pk_fma_f32 v[2:3], v[2:3], v[136:137], v[156:157] op_sel:[0,0,0] op_sel_hi:[1,0,1]
    v_pk_fma_f32 v[154:155], v[154:155], v[136:137], v[158:159] op_sel:[0,0,0] op_sel_hi:[1,0,1]
    v_pk_fma_f32 v[156:157], v[154:155], v[136:137], v[114:115] op_sel:[0,1,0] op_sel_hi:[1,1,1] neg_lo:[0,1,0] neg_hi:[0,1,0]
    v_pk_fma_f32 v[158:159], v[2:3], v[136:137], v[130:131] op_sel:[0,1,0] op_sel_hi:[1,1,1]
    v_pk_fma_f32 v[2:3], v[2:3], v[136:137], v[156:157] op_sel:[0,0,0] op_sel_hi:[1,0,1]
    v_pk_fma_f32 v[154:155], v[154:155], v[136:137], v[158:159] op_sel:[0,0,0] op_sel_hi:[1,0,1]
    v_lshrrev_b32 v35, 5, v1
    v_lshlrev_b32 v35, 10, v35
    v_lshl_add_u32 v4, v13, 2, v35
    s_lshr_b32 s3, s20, 1
    s_lshl_b32 s3, s3, 11
    s_add_u32 s3, s3, 131072
    v_add_u32 v4, s3, v4
    ds_write2st64_b32 v4, v2, v154 offset0:12 offset1:13
    ds_write2st64_b32 v4, v3, v155 offset0:14 offset1:15
    s_waitcnt lgkmcnt(0)
    s_barrier
    ds_read2st64_b32 v[160:161], v4 offset0:0 offset1:1
    ds_read2st64_b32 v[162:163], v4 offset0:2 offset1:3
    ds_read2st64_b32 v[164:165], v4 offset0:4 offset1:5
    ds_read2st64_b32 v[166:167], v4 offset0:6 offset1:7
    ds_read2st64_b32 v[168:169], v4 offset0:8 offset1:9
    ds_read2st64_b32 v[170:171], v4 offset0:10 offset1:11
    s_waitcnt lgkmcnt(4)
    v_fma_f32 v176, -v141, v161, v162
    v_fma_f32 v177, v141, v160, v163
    v_fma_f32 v162, v140, v160, v176
    v_fma_f32 v163, v140, v161, v177
    s_waitcnt lgkmcnt(3)
    v_fma_f32 v176, -v141, v163, v164
    v_fma_f32 v177, v141, v162, v165
    v_fma_f32 v164, v140, v162, v176
    v_fma_f32 v165, v140, v163, v177
    s_waitcnt lgkmcnt(2)
    v_fma_f32 v176, -v141, v165, v166
    v_fma_f32 v177, v141, v164, v167
    v_fma_f32 v166, v140, v164, v176
    v_fma_f32 v167, v140, v165, v177
    s_waitcnt lgkmcnt(1)
    v_fma_f32 v176, -v141, v167, v168
    v_fma_f32 v177, v141, v166, v169
    v_fma_f32 v168, v140, v166, v176
    v_fma_f32 v169, v140, v167, v177
    s_waitcnt lgkmcnt(0)
    v_fma_f32 v176, -v141, v169, v170
    v_fma_f32 v177, v141, v168, v171
    v_fma_f32 v170, v140, v168, v176
    v_fma_f32 v171, v140, v169, v177
    v_fma_f32 v176, -v141, v171, v2
    v_fma_f32 v177, v141, v170, v154
    v_fma_f32 v174, v140, v170, v176
    v_fma_f32 v175, v140, v171, v177
    v_fma_f32 v176, -v141, v175, v3
    v_fma_f32 v177, v141, v174, v155
    v_fma_f32 v178, v140, v174, v176
    v_fma_f32 v179, v140, v175, v177
    v_mov_b32 v180, v170
    v_mov_b32 v181, v174
    v_mov_b32 v182, v171
    v_mov_b32 v183, v175
    s_lshl_b32 s3, s22, 14
    s_add_u32 s3, s3, 21037056
    s_add_u32 s56, s16, s3
    s_addc_u32 s57, s17, 0
    s_mov_b32 s58, 16384
    s_mov_b32 s59, 131072
    v_lshlrev_b32 v35, 4, v13
    s_lshl_b32 s60, s21, 10
    s_lshr_b32 s3, s20, 1
    s_cmp_eq_u32 s3, 0
    s_cbranch_scc1 Lnopub_4
    v_mov_b32 v160, v178
    v_mov_b32 v161, v179
    v_mov_b32 v162, s28
    v_mov_b32 v163, s29
    s_mov_b64 s[62:63], exec
    s_mov_b64 exec, s[52:53]
    buffer_store_dwordx4 v[160:163], v35, s[56:59], s60 offen sc0 sc1
    s_mov_b64 exec, s[62:63]
    s_nop 1
Lnopub_4:
    v_pk_mul_f32 v[156:157], v[84:85], v[138:139] op_sel:[0,1] op_sel_hi:[1,1] neg_lo:[0,1] neg_hi:[0,1]
    v_pk_mul_f32 v[158:159], v[68:69], v[138:139] op_sel:[0,1] op_sel_hi:[1,1]
    v_pk_fma_f32 v[68:69], v[68:69], v[138:139], v[156:157] op_sel:[0,0,0] op_sel_hi:[1,0,1]
    v_pk_fma_f32 v[84:85], v[84:85], v[138:139], v[158:159] op_sel:[0,0,0] op_sel_hi:[1,0,1]
    v_pk_mul_f32 v[156:157], v[86:87], v[138:139] op_sel:[0,1] op_sel_hi:[1,1] neg_lo:[0,1] neg_hi:[0,1]
    v_pk_mul_f32 v[158:159], v[70:71], v[138:139] op_sel:[0,1] op_sel_hi:[1,1]
    v_pk_fma_f32 v[70:71], v[70:71], v[138:139], v[156:157] op_sel:[0,0,0] op_sel_hi:[1,0,1]
    v_pk_fma_f32 v[86:87], v[86:87], v[138:139], v[158:159] op_sel:[0,0,0] op_sel_hi:[1,0,1]
    v_pk_mul_f32 v[156:157], v[88:89], v[138:139] op_sel:[0,1] op_sel_hi:[1,1] neg_lo:[0,1] neg_hi:[0,1]
    v_pk_mul_f32 v[158:159], v[72:73], v[138:139] op_sel:[0,1] op_sel_hi:[1,1]
    v_pk_fma_f32 v[72:73], v[72:73], v[138:139], v[156:157] op_sel:[0,0,0] op_sel_hi:[1,0,1]
    v_pk_fma_f32 v[88:89], v[88:89], v[138:139], v[158:159] op_sel:[0,0,0] op_sel_hi:[1,0,1]
    v_pk_mul_f32 v[156:157], v[90:91], v[138:139] op_sel:[0,1] op_sel_hi:[1,1] neg_lo:[0,1] neg_hi:[0,1]
    v_pk_mul_f32 v[158:159], v[74:75], v[138:139] op_sel:[0,1] op_sel_hi:[1,1]
    v_pk_fma_f32 v[74:75], v[74:75], v[138:139], v[156:157] op_sel:[0,0,0] op_sel_hi:[1,0,1]
    v_pk_fma_f32 v[90:91], v[90:91], v[138:139], v[158:159] op_sel:[0,0,0] op_sel_hi:[1,0,1]
    v_pk_mul_f32 v[156:157], v[92:93], v[138:139] op_sel:[0,1] op_sel_hi:[1,1] neg_lo:[0,1] neg_hi:[0,1]
    v_pk_mul_f32 v[158:159], v[76:77], v[138:139] op_sel:[0,1] op_sel_hi:[1,1]
    v_pk_fma_f32 v[76:77], v[76:77], v[138:139], v[156:157] op_sel:[0,0,0] op_sel_hi:[1,0,1]
    v_pk_fma_f32 v[92:93], v[92:93], v[138:139], v[158:159] op_sel:[0,0,0] op_sel_hi:[1,0,1]
    v_pk_mul_f32 v[156:157], v[94:95], v[138:139] op_sel:[0,1] op_sel_hi:[1,1] neg_lo:[0,1] neg_hi:[0,1]
    v_pk_mul_f32 v[158:159], v[78:79], v[138:139] op_sel:[0,1] op_sel_hi:[1,1]
    v_pk_fma_f32 v[78:79], v[78:79], v[138:139], v[156:157] op_sel:[0,0,0] op_sel_hi:[1,0,1]
    v_pk_fma_f32 v[94:95], v[94:95], v[138:139], v[158:159] op_sel:[0,0,0] op_sel_hi:[1,0,1]
    v_pk_mul_f32 v[156:157], v[96:97], v[138:139] op_sel:[0,1] op_sel_hi:[1,1] neg_lo:[0,1] neg_hi:[0,1]
    v_pk_mul_f32 v[158:159], v[80:81], v[138:139] op_sel:[0,1] op_sel_hi:[1,1]
    v_pk_fma_f32 v[80:81], v[80:81], v[138:139], v[156:157] op_sel:[0,0,0] op_sel_hi:[1,0,1]
    v_pk_fma_f32 v[96:97], v[96:97], v[138:139], v[158:159] op_sel:[0,0,0] op_sel_hi:[1,0,1]
    v_pk_mul_f32 v[156:157], v[98:99], v[138:139] op_sel:[0,1] op_sel_hi:[1,1] neg_lo:[0,1] neg_hi:[0,1]
    v_pk_mul_f32 v[158:159], v[82:83], v[138:139] op_sel:[0,1] op_sel_hi:[1,1]
    v_pk_fma_f32 v[82:83], v[82:83], v[138:139], v[156:157] op_sel:[0,0,0] op_sel_hi:[1,0,1]
    v_pk_fma_f32 v[98:99], v[98:99], v[138:139], v[158:159] op_sel:[0,0,0] op_sel_hi:[1,0,1]
    v_pk_mul_f32 v[156:157], v[116:117], v[138:139] op_sel:[0,1] op_sel_hi:[1,1] neg_lo:[0,1] neg_hi:[0,1]
    v_pk_mul_f32 v[158:159], v[100:101], v[138:139] op_sel:[0,1] op_sel_hi:[1,1]
    v_pk_fma_f32 v[100:101], v[100:101], v[138:139], v[156:157] op_sel:[0,0,0] op_sel_hi:[1,0,1]
    v_pk_fma_f32 v[116:117], v[116:117], v[138:139], v[158:159] op_sel:[0,0,0] op_sel_hi:[1,0,1]
    v_pk_mul_f32 v[156:157], v[118:119], v[138:139] op_sel:[0,1] op_sel_hi:[1,1] neg_lo:[0,1] neg_hi:[0,1]
    v_pk_mul_f32 v[158:159], v[102:103], v[138:139] op_sel:[0,1] op_sel_hi:[1,1]
    v_pk_fma_f32 v[102:103], v[102:103], v[138:139], v[156:157] op_sel:[0,0,0] op_sel_hi:[1,0,1]
    v_pk_fma_f32 v[118:119], v[118:119], v[138:139], v[158:159] op_sel:[0,0,0] op_sel_hi:[1,0,1]
    v_pk_mul_f32 v[156:157], v[120:121], v[138:139] op_sel:[0,1] op_sel_hi:[1,1] neg_lo:[0,1] neg_hi:[0,1]
    v_pk_mul_f32 v[158:159], v[104:105], v[138:139] op_sel:[0,1] op_sel_hi:[1,1]
    v_pk_fma_f32 v[104:105], v[104:105], v[138:139], v[156:157] op_sel:[0,0,0] op_sel_hi:[1,0,1]
    v_pk_fma_f32 v[120:121], v[120:121], v[138:139], v[158:159] op_sel:[0,0,0] op_sel_hi:[1,0,1]
    v_pk_mul_f32 v[156:157], v[122:123], v[138:139] op_sel:[0,1] op_sel_hi:[1,1] neg_lo:[0,1] neg_hi:[0,1]
    v_pk_mul_f32 v[158:159], v[106:107], v[138:139] op_sel:[0,1] op_sel_hi:[1,1]
    v_pk_fma_f32 v[106:107], v[106:107], v[138:139], v[156:157] op_sel:[0,0,0] op_sel_hi:[1,0,1]
    v_pk_fma_f32 v[122:123], v[122:123], v[138:139], v[158:159] op_sel:[0,0,0] op_sel_hi:[1,0,1]
    v_pk_mul_f32 v[156:157], v[124:125], v[138:139] op_sel:[0,1] op_sel_hi:[1,1] neg_lo:[0,1] neg_hi:[0,1]
    v_pk_mul_f32 v[158:159], v[108:109], v[138:139] op_sel:[0,1] op_sel_hi:[1,1]
    v_pk_fma_f32 v[108:109], v[108:109], v[138:139], v[156:157] op_sel:[0,0,0] op_sel_hi:[1,0,1]
    v_pk_fma_f32 v[124:125], v[124:125], v[138:139], v[158:159] op_sel:[0,0,0] op_sel_hi:[1,0,1]
    v_pk_mul_f32 v[156:157], v[126:127], v[138:139] op_sel:[0,1] op_sel_hi:[1,1] neg_lo:[0,1] neg_hi:[0,1]
    v_pk_mul_f32 v[158:159], v[110:111], v[138:139] op_sel:[0,1] op_sel_hi:[1,1]
    v_pk_fma_f32 v[110:111], v[110:111], v[138:139], v[156:157] op_sel:[0,0,0] op_sel_hi:[1,0,1]
    v_pk_fma_f32 v[126:127], v[126:127], v[138:139], v[158:159] op_sel:[0,0,0] op_sel_hi:[1,0,1]
    v_pk_mul_f32 v[156:157], v[128:129], v[138:139] op_sel:[0,1] op_sel_hi:[1,1] neg_lo:[0,1] neg_hi:[0,1]
    v_pk_mul_f32 v[158:159], v[112:113], v[138:139] op_sel:[0,1] op_sel_hi:[1,1]
    v_pk_fma_f32 v[112:113], v[112:113], v[138:139], v[156:157] op_sel:[0,0,0] op_sel_hi:[1,0,1]
    v_pk_fma_f32 v[128:129], v[128:129], v[138:139], v[158:159] op_sel:[0,0,0] op_sel_hi:[1,0,1]
    v_pk_mul_f32 v[156:157], v[130:131], v[138:139] op_sel:[0,1] op_sel_hi:[1,1] neg_lo:[0,1] neg_hi:[0,1]
    v_pk_mul_f32 v[158:159], v[114:115], v[138:139] op_sel:[0,1] op_sel_hi:[1,1]
    v_pk_fma_f32 v[114:115], v[114:115], v[138:139], v[156:157] op_sel:[0,0,0] op_sel_hi:[1,0,1]
    v_pk_fma_f32 v[130:131], v[130:131], v[138:139], v[158:159] op_sel:[0,0,0] op_sel_hi:[1,0,1]
    s_sub_u32 s3, s60, 1024
    v_add_u32 v160, s3, v35
    v_subrev_u32 v161, 0, v160
    v_min_u32 v161, 0x7fff0000, v161
    v_subrev_u32 v162, 1024, v160
    v_min_u32 v162, 0x7fff0000, v162
    v_subrev_u32 v163, 2048, v160
    v_min_u32 v163, 0x7fff0000, v163
    v_subrev_u32 v164, 3072, v160
    v_min_u32 v164, 0x7fff0000, v164
    v_subrev_u32 v165, 4096, v160
    v_min_u32 v165, 0x7fff0000, v165
    v_subrev_u32 v166, 5120, v160
    v_min_u32 v166, 0x7fff0000, v166
    v_subrev_u32 v167, 6144, v160
    v_min_u32 v167, 0x7fff0000, v167
    v_subrev_u32 v168, 7168, v160
    v_min_u32 v168, 0x7fff0000, v168
    v_subrev_u32 v169, 8192, v160
    v_min_u32 v169, 0x7fff0000, v169
    v_subrev_u32 v170, 9216, v160
    v_min_u32 v170, 0x7fff0000, v170
    v_subrev_u32 v171, 10240, v160
    v_min_u32 v171, 0x7fff0000, v171
    v_subrev_u32 v172, 11264, v160
    v_min_u32 v172, 0x7fff0000, v172
    v_subrev_u32 v173, 12288, v160
    v_min_u32 v173, 0x7fff0000, v173
    v_subrev_u32 v174, 13312, v160
    v_min_u32 v174, 0x7fff0000, v174
    v_subrev_u32 v175, 14336, v160
    v_min_u32 v175, 0x7fff0000, v175
    s_mov_b32 s61, 0
    buffer_load_dwordx4 v[184:187], v161, s[56:59], 0 offen sc0 sc1
    buffer_load_dwordx4 v[188:191], v162, s[56:59], 0 offen sc0 sc1
    buffer_load_dwordx4 v[192:195], v163, s[56:59], 0 offen sc0 sc1
    buffer_load_dwordx4 v[196:199], v164, s[56:59], 0 offen sc0 sc1
    buffer_load_dwordx4 v[200:203], v165, s[56:59], 0 offen sc0 sc1
    buffer_load_dwordx4 v[204:207], v166, s[56:59], 0 offen sc0 sc1
    buffer_load_dwordx4 v[208:211], v167, s[56:59], 0 offen sc0 sc1
    buffer_load_dwordx4 v[212:215], v168, s[56:59], 0 offen sc0 sc1
    buffer_load_dwordx4 v[216:219], v169, s[56:59], 0 offen sc0 sc1
    buffer_load_dwordx4 v[220:223], v170, s[56:59], 0 offen sc0 sc1
    buffer_load_dwordx4 v[224:227], v171, s[56:59], 0 offen sc0 sc1
    buffer_load_dwordx4 v[228:231], v172, s[56:59], 0 offen sc0 sc1
    buffer_load_dwordx4 v[232:235], v173, s[56:59], 0 offen sc0 sc1
    buffer_load_dwordx4 v[236:239], v174, s[56:59], 0 offen sc0 sc1
    buffer_load_dwordx4 v[240:243], v175, s[56:59], 0 offen sc0 sc1
    v_mov_b32 v160, 0
    s_waitcnt vmcnt(14)
    v_cmp_eq_u64 s[62:63], s[28:29], v[186:187]
    s_waitcnt vmcnt(13)
    v_cmp_eq_u64 s[64:65], s[28:29], v[190:191]
    s_waitcnt vmcnt(12)
    v_cmp_eq_u64 s[66:67], s[28:29], v[194:195]
    s_waitcnt vmcnt(11)
    v_cmp_eq_u64 s[68:69], s[28:29], v[198:199]
    s_waitcnt vmcnt(10)
    v_cmp_eq_u64 s[70:71], s[28:29], v[202:203]
    v_addc_co_u32 v160, vcc, 0, v160, s[62:63]
    v_addc_co_u32 v160, vcc, 0, v160, s[64:65]
    v_addc_co_u32 v160, vcc, 0, v160, s[66:67]
    v_addc_co_u32 v160, vcc, 0, v160, s[68:69]
    v_addc_co_u32 v160, vcc, 0, v160, s[70:71]
    s_waitcnt vmcnt(9)
    v_cmp_eq_u64 s[62:63], s[28:29], v[206:207]
    s_waitcnt vmcnt(8)
    v_cmp_eq_u64 s[64:65], s[28:29], v[210:211]
    s_waitcnt vmcnt(7)
    v_cmp_eq_u64 s[66:67], s[28:29], v[214:215]
    s_waitcnt vmcnt(6)
    v_cmp_eq_u64 s[68:69], s[28:29], v[218:219]
    s_waitcnt vmcnt(5)
    v_cmp_eq_u64 s[70:71], s[28:29], v[222:223]
    v_addc_co_u32 v160, vcc, 0, v160, s[62:63]
    v_addc_co_u32 v160, vcc, 0, v160, s[64:65]
    v_addc_co_u32 v160, vcc, 0, v160, s[66:67]
    v_addc_co_u32 v160, vcc, 0, v160, s[68:69]
    v_addc_co_u32 v160, vcc, 0, v160, s[70:71]
    s_waitcnt vmcnt(4)
    v_cmp_eq_u64 s[62:63], s[28:29], v[226:227]
    s_waitcnt vmcnt(3)
    v_cmp_eq_u64 s[64:65], s[28:29], v[230:231]
    s_waitcnt vmcnt(2)
    v_cmp_eq_u64 s[66:67], s[28:29], v[234:235]
    s_waitcnt vmcnt(1)
    v_cmp_eq_u64 s[68:69], s[28:29], v[238:239]
    s_waitcnt vmcnt(0)
    v_cmp_eq_u64 s[70:71], s[28:29], v[242:243]
    v_addc_co_u32 v160, vcc, 0, v160, s[62:63]
    v_addc_co_u32 v160, vcc, 0, v160, s[64:65]
    v_addc_co_u32 v160, vcc, 0, v160, s[66:67]
    v_addc_co_u32 v160, vcc, 0, v160, s[68:69]
    v_addc_co_u32 v160, vcc, 0, v160, s[70:71]
    v_cmp_ne_u32 vcc, s21, v160
    s_nop 4
    s_cbranch_vccz Lpolldone_5
Lpoll_6:
    buffer_load_dwordx4 v[184:187], v161, s[56:59], 0 offen sc0 sc1
    buffer_load_dwordx4 v[188:191], v162, s[56:59], 0 offen sc0 sc1
    buffer_load_dwordx4 v[192:195], v163, s[56:59], 0 offen sc0 sc1
    buffer_load_dwordx4 v[196:199], v164, s[56:59], 0 offen sc0 sc1
    buffer_load_dwordx4 v[200:203], v165, s[56:59], 0 offen sc0 sc1
    buffer_load_dwordx4 v[204:207], v166, s[56:59], 0 offen sc0 sc1
    buffer_load_dwordx4 v[208:211], v167, s[56:59], 0 offen sc0 sc1
    buffer_load_dwordx4 v[212:215], v168, s[56:59], 0 offen sc0 sc1
    buffer_load_dwordx4 v[216:219], v169, s[56:59], 0 offen sc0 sc1
    buffer_load_dwordx4 v[220:223], v170, s[56:59], 0 offen sc0 sc1
    buffer_load_dwordx4 v[224:227], v171, s[56:59], 0 offen sc0 sc1
    buffer_load_dwordx4 v[228:231], v172, s[56:59], 0 offen sc0 sc1
    buffer_load_dwordx4 v[232:235], v173, s[56:59], 0 offen sc0 sc1
    buffer_load_dwordx4 v[236:239], v174, s[56:59], 0 offen sc0 sc1
    buffer_load_dwordx4 v[240:243], v175, s[56:59], 0 offen sc0 sc1
    s_waitcnt vmcnt(0)
    v_mov_b32 v160, 0
    v_cmp_eq_u64 s[62:63], s[28:29], v[186:187]
    v_cmp_eq_u64 s[64:65], s[28:29], v[190:191]
    v_cmp_eq_u64 s[66:67], s[28:29], v[194:195]
    v_cmp_eq_u64 s[68:69], s[28:29], v[198:199]
    v_cmp_eq_u64 s[70:71], s[28:29], v[202:203]
    v_addc_co_u32 v160, vcc, 0, v160, s[62:63]
    v_addc_co_u32 v160, vcc, 0, v160, s[64:65]
    v_addc_co_u32 v160, vcc, 0, v160, s[66:67]
    v_addc_co_u32 v160, vcc, 0, v160, s[68:69]
    v_addc_co_u32 v160, vcc, 0, v160, s[70:71]
    v_cmp_eq_u64 s[62:63], s[28:29], v[206:207]
    v_cmp_eq_u64 s[64:65], s[28:29], v[210:211]
    v_cmp_eq_u64 s[66:67], s[28:29], v[214:215]
    v_cmp_eq_u64 s[68:69], s[28:29], v[218:219]
    v_cmp_eq_u64 s[70:71], s[28:29], v[222:223]
    v_addc_co_u32 v160, vcc, 0, v160, s[62:63]
    v_addc_co_u32 v160, vcc, 0, v160, s[64:65]
    v_addc_co_u32 v160, vcc, 0, v160, s[66:67]
    v_addc_co_u32 v160, vcc, 0, v160, s[68:69]
    v_addc_co_u32 v160, vcc, 0, v160, s[70:71]
    v_cmp_eq_u64 s[62:63], s[28:29], v[226:227]
    v_cmp_eq_u64 s[64:65], s[28:29], v[230:231]
    v_cmp_eq_u64 s[66:67], s[28:29], v[234:235]
    v_cmp_eq_u64 s[68:69], s[28:29], v[238:239]
    v_cmp_eq_u64 s[70:71], s[28:29], v[242:243]
    v_addc_co_u32 v160, vcc, 0, v160, s[62:63]
    v_addc_co_u32 v160, vcc, 0, v160, s[64:65]
    v_addc_co_u32 v160, vcc, 0, v160, s[66:67]
    v_addc_co_u32 v160, vcc, 0, v160, s[68:69]
    v_addc_co_u32 v160, vcc, 0, v160, s[70:71]
    v_cmp_ne_u32 vcc, s21, v160
    s_add_u32 s61, s61, 1
    s_cmp_gt_u32 s61, 100000
    s_cbranch_scc1 Lpolldone_5
    s_nop 1
    s_cbranch_vccnz Lpoll_6
Lpolldone_5:
    s_nop 4
    v_fma_f32 v178, -v143, v241, v236
    v_fma_f32 v179, v143, v240, v237
    v_fma_f32 v236, v142, v240, v178
    v_fma_f32 v237, v142, v241, v179
    v_fma_f32 v178, -v143, v237, v232
    v_fma_f32 v179, v143, v236, v233
    v_fma_f32 v232, v142, v236, v178
    v_fma_f32 v233, v142, v237, v179
    v_fma_f32 v178, -v143, v233, v228
    v_fma_f32 v179, v143, v232, v229
    v_fma_f32 v228, v142, v232, v178
    v_fma_f32 v229, v142, v233, v179
    v_fma_f32 v178, -v143, v229, v224
    v_fma_f32 v179, v143, v228, v225
    v_fma_f32 v224, v142, v228, v178
    v_fma_f32 v225, v142, v229, v179
    v_fma_f32 v178, -v143, v225, v220
    v_fma_f32 v179, v143, v224, v221
    v_fma_f32 v220, v142, v224, v178
    v_fma_f32 v221, v142, v225, v179
    v_fma_f32 v178, -v143, v221, v216
    v_fma_f32 v179, v143, v220, v217
    v_fma_f32 v216, v142, v220, v178
    v_fma_f32 v217, v142, v221, v179
    v_fma_f32 v178, -v143, v217, v212
    v_fma_f32 v179, v143, v216, v213
    v_fma_f32 v212, v142, v216, v178
    v_fma_f32 v213, v142, v217, v179
    v_fma_f32 v178, -v143, v213, v208
    v_fma_f32 v179, v143, v212, v209
    v_fma_f32 v208, v142, v212, v178
    v_fma_f32 v209, v142, v213, v179
    v_fma_f32 v178, -v143, v209, v204
    v_fma_f32 v179, v143, v208, v205
    v_fma_f32 v204, v142, v208, v178
    v_fma_f32 v205, v142, v209, v179
    v_fma_f32 v178, -v143, v205, v200
    v_fma_f32 v179, v143, v204, v201
    v_fma_f32 v200, v142, v204, v178
    v_fma_f32 v201, v142, v205, v179
    v_fma_f32 v178, -v143, v201, v196
    v_fma_f32 v179, v143, v200, v197
    v_fma_f32 v196, v142, v200, v178
    v_fma_f32 v197, v142, v201, v179
    v_fma_f32 v178, -v143, v197, v192
    v_fma_f32 v179, v143, v196, v193
    v_fma_f32 v192, v142, v196, v178
    v_fma_f32 v193, v142, v197, v179
    v_fma_f32 v178, -v143, v193, v188
    v_fma_f32 v179, v143, v192, v189
    v_fma_f32 v188, v142, v192, v178
    v_fma_f32 v189, v142, v193, v179
    v_fma_f32 v178, -v143, v189, v184
    v_fma_f32 v179, v143, v188, v185
    v_fma_f32 v184, v142, v188, v178
    v_fma_f32 v185, v142, v189, v179
    v_mov_b32 v176, v184
    v_mov_b32 v177, v185
    v_pk_fma_f32 v[156:157], v[146:147], v[176:177], v[180:181] op_sel:[0,1,0] op_sel_hi:[1,1,1] neg_lo:[0,1,0] neg_hi:[0,1,0]
    v_pk_fma_f32 v[158:159], v[144:145], v[176:177], v[182:183] op_sel:[0,1,0] op_sel_hi:[1,1,1]
    v_pk_fma_f32 v[160:161], v[144:145], v[176:177], v[156:157] op_sel:[0,0,0] op_sel_hi:[1,0,1]
    v_pk_fma_f32 v[162:163], v[146:147], v[176:177], v[158:159] op_sel:[0,0,0] op_sel_hi:[1,0,1]
    v_pk_mul_f32 v[156:157], v[162:163], v[138:139] op_sel:[0,1] op_sel_hi:[1,1] neg_lo:[0,1] neg_hi:[0,1]
    v_pk_mul_f32 v[158:159], v[160:161], v[138:139] op_sel:[0,1] op_sel_hi:[1,1]
    v_pk_fma_f32 v[160:161], v[160:161], v[138:139], v[156:157] op_sel:[0,0,0] op_sel_hi:[1,0,1]
    v_pk_fma_f32 v[162:163], v[162:163], v[138:139], v[158:159] op_sel:[0,0,0] op_sel_hi:[1,0,1]
    v_lshrrev_b32 v166, 5, v1
    v_lshlrev_b32 v166, 13, v166
    v_lshl_add_u32 v164, v13, 2, v166
    s_lshr_b32 s3, s20, 1
    s_lshl_b32 s3, s3, 14
    s_add_u32 s3, s3, 0
    v_add_u32 v164, s3, v164
    v_xor_b32 v165, 16, v164
    v_pk_fma_f32 v[156:157], v[162:163], v[136:137], v[68:69] op_sel:[0,1,0] op_sel_hi:[1,1,1] neg_lo:[0,1,0] neg_hi:[0,1,0]
    v_pk_fma_f32 v[158:159], v[160:161], v[136:137], v[84:85] op_sel:[0,1,0] op_sel_hi:[1,1,1]
    v_pk_fma_f32 v[68:69], v[160:161], v[136:137], v[156:157] op_sel:[0,0,0] op_sel_hi:[1,0,1]
    v_pk_fma_f32 v[84:85], v[162:163], v[136:137], v[158:159] op_sel:[0,0,0] op_sel_hi:[1,0,1]
    v_pk_fma_f32 v[156:157], v[84:85], v[136:137], v[70:71] op_sel:[0,1,0] op_sel_hi:[1,1,1] neg_lo:[0,1,0] neg_hi:[0,1,0]
    v_pk_fma_f32 v[158:159], v[68:69], v[136:137], v[86:87] op_sel:[0,1,0] op_sel_hi:[1,1,1]
    v_pk_fma_f32 v[70:71], v[68:69], v[136:137], v[156:157] op_sel:[0,0,0] op_sel_hi:[1,0,1]
    v_pk_fma_f32 v[86:87], v[84:85], v[136:137], v[158:159] op_sel:[0,0,0] op_sel_hi:[1,0,1]
    v_cvt_pk_bf16_f32 v169, v68, -v84
    v_cvt_pk_bf16_f32 v170, v69, -v85
    ds_write2st64_b32 v164, v169, v170 offset0:0 offset1:16
    v_pk_fma_f32 v[156:157], v[86:87], v[136:137], v[72:73] op_sel:[0,1,0] op_sel_hi:[1,1,1] neg_lo:[0,1,0] neg_hi:[0,1,0]
    v_pk_fma_f32 v[158:159], v[70:71], v[136:137], v[88:89] op_sel:[0,1,0] op_sel_hi:[1,1,1]
    v_pk_fma_f32 v[72:73], v[70:71], v[136:137], v[156:157] op_sel:[0,0,0] op_sel_hi:[1,0,1]
    v_pk_fma_f32 v[88:89], v[86:87], v[136:137], v[158:159] op_sel:[0,0,0] op_sel_hi:[1,0,1]
    v_cvt_pk_bf16_f32 v167, v70, -v86
    v_cvt_pk_bf16_f32 v168, v71, -v87
    ds_write2st64_b32 v165, v167, v168 offset0:1 offset1:17
    v_pk_fma_f32 v[156:157], v[88:89], v[136:137], v[74:75] op_sel:[0,1,0] op_sel_hi:[1,1,1] neg_lo:[0,1,0] neg_hi:[0,1,0]
    v_pk_fma_f32 v[158:159], v[72:73], v[136:137], v[90:91] op_sel:[0,1,0] op_sel_hi:[1,1,1]
    v_pk_fma_f32 v[74:75], v[72:73], v[136:137], v[156:157] op_sel:[0,0,0] op_sel_hi:[1,0,1]
    v_pk_fma_f32 v[90:91], v[88:89], v[136:137], v[158:159] op_sel:[0,0,0] op_sel_hi:[1,0,1]
    v_cvt_pk_bf16_f32 v169, v72, -v88
    v_cvt_pk_bf16_f32 v170, v73, -v89
    ds_write2st64_b32 v164, v169, v170 offset0:2 offset1:18
    v_pk_fma_f32 v[156:157], v[90:91], v[136:137], v[76:77] op_sel:[0,1,0] op_sel_hi:[1,1,1] neg_lo:[0,1,0] neg_hi:[0,1,0]
    v_pk_fma_f32 v[158:159], v[74:75], v[136:137], v[92:93] op_sel:[0,1,0] op_sel_hi:[1,1,1]
    v_pk_fma_f32 v[76:77], v[74:75], v[136:137], v[156:157] op_sel:[0,0,0] op_sel_hi:[1,0,1]
    v_pk_fma_f32 v[92:93], v[90:91], v[136:137], v[158:159] op_sel:[0,0,0] op_sel_hi:[1,0,1]
    v_cvt_pk_bf16_f32 v167, v74, -v90
    v_cvt_pk_bf16_f32 v168, v75, -v91
    ds_write2st64_b32 v165, v167, v168 offset0:3 offset1:19
    v_pk_fma_f32 v[156:157], v[92:93], v[136:137], v[78:79] op_sel:[0,1,0] op_sel_hi:[1,1,1] neg_lo:[0,1,0] neg_hi:[0,1,0]
    v_pk_fma_f32 v[158:159], v[76:77], v[136:137], v[94:95] op_sel:[0,1,0] op_sel_hi:[1,1,1]
    v_pk_fma_f32 v[78:79], v[76:77], v[136:137], v[156:157] op_sel:[0,0,0] op_sel_hi:[1,0,1]
    v_pk_fma_f32 v[94:95], v[92:93], v[136:137], v[158:159] op_sel:[0,0,0] op_sel_hi:[1,0,1]
    v_cvt_pk_bf16_f32 v169, v76, -v92
    v_cvt_pk_bf16_f32 v170, v77, -v93
    ds_write2st64_b32 v164, v169, v170 offset0:4 offset1:20
    v_pk_fma_f32 v[156:157], v[94:95], v[136:137], v[80:81] op_sel:[0,1,0] op_sel_hi:[1,1,1] neg_lo:[0,1,0] neg_hi:[0,1,0]
    v_pk_fma_f32 v[158:159], v[78:79], v[136:137], v[96:97] op_sel:[0,1,0] op_sel_hi:[1,1,1]
    v_pk_fma_f32 v[80:81], v[78:79], v[136:137], v[156:157] op_sel:[0,0,0] op_sel_hi:[1,0,1]
    v_pk_fma_f32 v[96:97], v[94:95], v[136:137], v[158:159] op_sel:[0,0,0] op_sel_hi:[1,0,1]
    v_cvt_pk_bf16_f32 v167, v78, -v94
    v_cvt_pk_bf16_f32 v168, v79, -v95
    ds_write2st64_b32 v165, v167, v168 offset0:5 offset1:21
    v_pk_fma_f32 v[156:157], v[96:97], v[136:137], v[82:83] op_sel:[0,1,0] op_sel_hi:[1,1,1] neg_lo:[0,1,0] neg_hi:[0,1,0]
    v_pk_fma_f32 v[158:159], v[80:81], v[136:137], v[98:99] op_sel:[0,1,0] op_sel_hi:[1,1,1]
    v_pk_fma_f32 v[82:83], v[80:81], v[136:137], v[156:157] op_sel:[0,0,0] op_sel_hi:[1,0,1]
    v_pk_fma_f32 v[98:99], v[96:97], v[136:137], v[158:159] op_sel:[0,0,0] op_sel_hi:[1,0,1]
    v_cvt_pk_bf16_f32 v169, v80, -v96
    v_cvt_pk_bf16_f32 v170, v81, -v97
    ds_write2st64_b32 v164, v169, v170 offset0:6 offset1:22
    v_pk_fma_f32 v[156:157], v[98:99], v[136:137], v[100:101] op_sel:[0,1,0] op_sel_hi:[1,1,1] neg_lo:[0,1,0] neg_hi:[0,1,0]
    v_pk_fma_f32 v[158:159], v[82:83], v[136:137], v[116:117] op_sel:[0,1,0] op_sel_hi:[1,1,1]
    v_pk_fma_f32 v[100:101], v[82:83], v[136:137], v[156:157] op_sel:[0,0,0] op_sel_hi:[1,0,1]
    v_pk_fma_f32 v[116:117], v[98:99], v[136:137], v[158:159] op_sel:[0,0,0] op_sel_hi:[1,0,1]
    v_cvt_pk_bf16_f32 v167, v82, -v98
    v_cvt_pk_bf16_f32 v168, v83, -v99
    ds_write2st64_b32 v165, v167, v168 offset0:7 offset1:23
    v_pk_fma_f32 v[156:157], v[116:117], v[136:137], v[102:103] op_sel:[0,1,0] op_sel_hi:[1,1,1] neg_lo:[0,1,0] neg_hi:[0,1,0]
    v_pk_fma_f32 v[158:159], v[100:101], v[136:137], v[118:119] op_sel:[0,1,0] op_sel_hi:[1,1,1]
    v_pk_fma_f32 v[102:103], v[100:101], v[136:137], v[156:157] op_sel:[0,0,0] op_sel_hi:[1,0,1]
    v_pk_fma_f32 v[118:119], v[116:117], v[136:137], v[158:159] op_sel:[0,0,0] op_sel_hi:[1,0,1]
    v_cvt_pk_bf16_f32 v169, v100, -v116
    v_cvt_pk_bf16_f32 v170, v101, -v117
    ds_write2st64_b32 v164, v169, v170 offset0:8 offset1:24
    v_pk_fma_f32 v[156:157], v[118:119], v[136:137], v[104:105] op_sel:[0,1,0] op_sel_hi:[1,1,1] neg_lo:[0,1,0] neg_hi:[0,1,0]
    v_pk_fma_f32 v[158:159], v[102:103], v[136:137], v[120:121] op_sel:[0,1,0] op_sel_hi:[1,1,1]
    v_pk_fma_f32 v[104:105], v[102:103], v[136:137], v[156:157] op_sel:[0,0,0] op_sel_hi:[1,0,1]
    v_pk_fma_f32 v[120:121], v[118:119], v[136:137], v[158:159] op_sel:[0,0,0] op_sel_hi:[1,0,1]
    v_cvt_pk_bf16_f32 v167, v102, -v118
    v_cvt_pk_bf16_f32 v168, v103, -v119
    ds_write2st64_b32 v165, v167, v168 offset0:9 offset1:25
    v_pk_fma_f32 v[156:157], v[120:121], v[136:137], v[106:107] op_sel:[0,1,0] op_sel_hi:[1,1,1] neg_lo:[0,1,0] neg_hi:[0,1,0]
    v_pk_fma_f32 v[158:159], v[104:105], v[136:137], v[122:123] op_sel:[0,1,0] op_sel_hi:[1,1,1]
    v_pk_fma_f32 v[106:107], v[104:105], v[136:137], v[156:157] op_sel:[0,0,0] op_sel_hi:[1,0,1]
    v_pk_fma_f32 v[122:123], v[120:121], v[136:137], v[158:159] op_sel:[0,0,0] op_sel_hi:[1,0,1]
    v_cvt_pk_bf16_f32 v169, v104, -v120
    v_cvt_pk_bf16_f32 v170, v105, -v121
    ds_write2st64_b32 v164, v169, v170 offset0:10 offset1:26
    v_pk_fma_f32 v[156:157], v[122:123], v[136:137], v[108:109] op_sel:[0,1,0] op_sel_hi:[1,1,1] neg_lo:[0,1,0] neg_hi:[0,1,0]
    v_pk_fma_f32 v[158:159], v[106:107], v[136:137], v[124:125] op_sel:[0,1,0] op_sel_hi:[1,1,1]
    v_pk_fma_f32 v[108:109], v[106:107], v[136:137], v[156:157] op_sel:[0,0,0] op_sel_hi:[1,0,1]
    v_pk_fma_f32 v[124:125], v[122:123], v[136:137], v[158:159] op_sel:[0,0,0] op_sel_hi:[1,0,1]
    v_cvt_pk_bf16_f32 v167, v106, -v122
    v_cvt_pk_bf16_f32 v168, v107, -v123
    ds_write2st64_b32 v165, v167, v168 offset0:11 offset1:27
    v_pk_fma_f32 v[156:157], v[124:125], v[136:137], v[110:111] op_sel:[0,1,0] op_sel_hi:[1,1,1] neg_lo:[0,1,0] neg_hi:[0,1,0]
    v_pk_fma_f32 v[158:159], v[108:109], v[136:137], v[126:127] op_sel:[0,1,0] op_sel_hi:[1,1,1]
    v_pk_fma_f32 v[110:111], v[108:109], v[136:137], v[156:157] op_sel:[0,0,0] op_sel_hi:[1,0,1]
    v_pk_fma_f32 v[126:127], v[124:125], v[136:137], v[158:159] op_sel:[0,0,0] op_sel_hi:[1,0,1]
    v_cvt_pk_bf16_f32 v169, v108, -v124
    v_cvt_pk_bf16_f32 v170, v109, -v125
    ds_write2st64_b32 v164, v169, v170 offset0:12 offset1:28
    v_pk_fma_f32 v[156:157], v[126:127], v[136:137], v[112:113] op_sel:[0,1,0] op_sel_hi:[1,1,1] neg_lo:[0,1,0] neg_hi:[0,1,0]
    v_pk_fma_f32 v[158:159], v[110:111], v[136:137], v[128:129] op_sel:[0,1,0] op_sel_hi:[1,1,1]
    v_pk_fma_f32 v[112:113], v[110:111], v[136:137], v[156:157] op_sel:[0,0,0] op_sel_hi:[1,0,1]
    v_pk_fma_f32 v[128:129], v[126:127], v[136:137], v[158:159] op_sel:[0,0,0] op_sel_hi:[1,0,1]
    v_cvt_pk_bf16_f32 v167, v110, -v126
    v_cvt_pk_bf16_f32 v168, v111, -v127
    ds_write2st64_b32 v165, v167, v168 offset0:13 offset1:29
    v_pk_fma_f32 v[156:157], v[128:129], v[136:137], v[114:115] op_sel:[0,1,0] op_sel_hi:[1,1,1] neg_lo:[0,1,0] neg_hi:[0,1,0]
    v_pk_fma_f32 v[158:159], v[112:113], v[136:137], v[130:131] op_sel:[0,1,0] op_sel_hi:[1,1,1]
    v_pk_fma_f32 v[114:115], v[112:113], v[136:137], v[156:157] op_sel:[0,0,0] op_sel_hi:[1,0,1]
    v_pk_fma_f32 v[130:131], v[128:129], v[136:137], v[158:159] op_sel:[0,0,0] op_sel_hi:[1,0,1]
    v_cvt_pk_bf16_f32 v169, v112, -v128
    v_cvt_pk_bf16_f32 v170, v113, -v129
    ds_write2st64_b32 v164, v169, v170 offset0:14 offset1:30
    v_cvt_pk_bf16_f32 v167, v114, -v130
    v_cvt_pk_bf16_f32 v168, v115, -v131
    ds_write2st64_b32 v165, v167, v168 offset0:15 offset1:31
    s_waitcnt lgkmcnt(0)
    s_barrier
    s_mov_b32 s64, s16
    s_mov_b32 s65, s17
    s_mov_b32 s66, 8388608
    s_mov_b32 s67, 131072
    v_lshrrev_b32 v162, 3, v1
    v_and_b32 v160, 7, v1
    v_lshlrev_b32 v161, 4, v160
    v_lshlrev_b32 v160, 5, v160
    v_lshl_add_u32 v160, v162, 8, v160
    v_lshl_add_u32 v161, v162, 12, v161
    v_and_b32 v162, 1, v162
    v_lshlrev_b32 v162, 4, v162
    v_xor_b32 v163, 16, v162
    v_add_u32 v163, v163, v160
    v_add_u32 v160, v160, v162
    s_lshl_b32 s3, s20, 13
    s_add_u32 s3, s3, 0
    v_add_u32 v160, s3, v160
    v_add_u32 v163, s3, v163
    s_lshl_b32 s61, s21, 19
    s_lshl_b32 s3, s20, 17
    s_add_u32 s61, s61, s3
    s_lshl_b32 s3, s22, 7
    s_add_u32 s61, s61, s3
    s_mov_b32 s62, 0x05040100
    s_mov_b32 s63, 0x07060302
    ds_read_b128 v[164:167], v160 offset:0
    ds_read_b128 v[168:171], v163 offset:0
    ds_read_b128 v[184:187], v160 offset:2048
    ds_read_b128 v[188:191], v163 offset:2048
    ds_read_b128 v[192:195], v160 offset:4096
    ds_read_b128 v[196:199], v163 offset:4096
    ds_read_b128 v[200:203], v160 offset:6144
    ds_read_b128 v[204:207], v163 offset:6144
    s_waitcnt lgkmcnt(7)
    v_perm_b32 v208, v165, v164, s62
    v_perm_b32 v209, v167, v166, s62
    s_waitcnt lgkmcnt(6)
    v_perm_b32 v210, v169, v168, s62
    v_perm_b32 v211, v171, v170, s62
    v_perm_b32 v212, v165, v164, s63
    v_perm_b32 v213, v167, v166, s63
    v_perm_b32 v214, v169, v168, s63
    v_perm_b32 v215, v171, v170, s63
    buffer_store_dwordx4 v[208:211], v161, s[64:67], s61 offen sc0 sc1
    buffer_store_dwordx4 v[212:215], v161, s[64:67], s61 offen offset:2048 sc0 sc1
    s_waitcnt lgkmcnt(5)
    v_perm_b32 v216, v185, v184, s62
    v_perm_b32 v217, v187, v186, s62
    s_waitcnt lgkmcnt(4)
    v_perm_b32 v218, v189, v188, s62
    v_perm_b32 v219, v191, v190, s62
    v_perm_b32 v220, v185, v184, s63
    v_perm_b32 v221, v187, v186, s63
    v_perm_b32 v222, v189, v188, s63
    v_perm_b32 v223, v191, v190, s63
    s_add_u32 s61, s61, 32768
    buffer_store_dwordx4 v[216:219], v161, s[64:67], s61 offen sc0 sc1
    buffer_store_dwordx4 v[220:223], v161, s[64:67], s61 offen offset:2048 sc0 sc1
    s_waitcnt lgkmcnt(3)
    v_perm_b32 v208, v193, v192, s62
    v_perm_b32 v209, v195, v194, s62
    s_waitcnt lgkmcnt(2)
    v_perm_b32 v210, v197, v196, s62
    v_perm_b32 v211, v199, v198, s62
    v_perm_b32 v212, v193, v192, s63
    v_perm_b32 v213, v195, v194, s63
    v_perm_b32 v214, v197, v196, s63
    v_perm_b32 v215, v199, v198, s63
    s_add_u32 s61, s61, 32768
    buffer_store_dwordx4 v[208:211], v161, s[64:67], s61 offen sc0 sc1
    buffer_store_dwordx4 v[212:215], v161, s[64:67], s61 offen offset:2048 sc0 sc1
    s_waitcnt lgkmcnt(1)
    v_perm_b32 v216, v201, v200, s62
    v_perm_b32 v217, v203, v202, s62
    s_waitcnt lgkmcnt(0)
    v_perm_b32 v218, v205, v204, s62
    v_perm_b32 v219, v207, v206, s62
    v_perm_b32 v220, v201, v200, s63
    v_perm_b32 v221, v203, v202, s63
    v_perm_b32 v222, v205, v204, s63
    v_perm_b32 v223, v207, v206, s63
    s_add_u32 s61, s61, 32768
    buffer_store_dwordx4 v[216:219], v161, s[64:67], s61 offen sc0 sc1
    buffer_store_dwordx4 v[220:223], v161, s[64:67], s61 offen offset:2048 sc0 sc1
    s_waitcnt vmcnt(0)
Lend_g1_kernel:
    s_endpgm

.section .rodata,"a"
.p2align 6
.amdhsa_kernel g1_kernel
  .amdhsa_next_free_vgpr 244
  .amdhsa_next_free_sgpr 72
  .amdhsa_accum_offset 244
  .amdhsa_group_segment_fixed_size 0
  .amdhsa_kernarg_size 152
  .amdhsa_user_sgpr_count 2
  .amdhsa_user_sgpr_kernarg_segment_ptr 1
  .amdhsa_system_sgpr_workgroup_id_x 1
  .amdhsa_float_denorm_mode_32 3
.end_amdhsa_kernel
.text
.globl conv_kernel
.p2align 8
.type conv_kernel,@function
conv_kernel:
    s_cmp_ge_u32 s2, 256
    s_cbranch_scc1 Lend_conv_kernel
    s_load_dwordx2 s[4:5], s[0:1], 104
    s_load_dwordx2 s[6:7], s[0:1], 112
    s_load_dwordx2 s[8:9], s[0:1], 144
    v_lshrrev_b32 v1, 6, v0
    s_nop 0
    v_readfirstlane_b32 s10, v1
    v_and_b32 v1, 63, v0
    s_and_b32 s13, s2, 7
    s_lshr_b32 s11, s13, 1
    s_lshl_b32 s11, s11, 3
    s_and_b32 s12, s13, 1
    s_lshl_b32 s12, s12, 2
    s_lshr_b32 s13, s2, 3
    s_and_b32 s3, s13, 7
    s_add_u32 s11, s11, s3
    s_lshr_b32 s13, s13, 3
    s_add_u32 s12, s12, s13
    s_lshl_b32 s13, s12, 7
    s_lshl_b32 s3, s11, 2
    s_add_u32 s13, s13, s3
    s_add_u32 s13, s13, s10
    s_lshl_b32 s14, s13, 12
    s_waitcnt lgkmcnt(0)
    s_add_u32 s16, s4, s14
    s_addc_u32 s17, s5, 0
    s_mov_b32 s18, 4096
    s_mov_b32 s19, 131072
    s_add_u32 s20, s8, 8388608
    s_addc_u32 s21, s9, 0
    s_mov_b32 s22, 4194304
    s_mov_b32 s23, 131072
    s_add_u32 s24, s8, 12582912
    s_addc_u32 s25, s9, 0
    s_mov_b32 s26, 4194304
    s_mov_b32 s27, 131072
    s_mov_b32 s28, s6
    s_mov_b32 s29, s7
    s_mov_b32 s30, 2048
    s_mov_b32 s31, 131072
    s_mul_i32 s15, s10, 21248
    v_lshlrev_b32 v2, 4, v1
    v_and_b32 v3, 15, v1
    v_lshrrev_b32 v4, 4, v1
    v_add_u32 v5, 1, v3
    v_and_b32 v6, 3, v5
    v_mul_u32_u24 v6, 4160, v6
    v_and_b32 v5, 28, v5
    v_lshl_add_u32 v6, v5, 1, v6
    v_lshl_add_u32 v6, v4, 4, v6
    v_add_u32 v7, s15, v6
    s_add_u32 s3, s15, 17120
    v_lshlrev_b32 v5, 5, v3
    v_sub_u32 v5, s3, v5
    v_lshl_add_u32 v8, v4, 4, v5
    v_lshlrev_b32 v6, 3, v4
    v_sub_u32 v5, v5, v6
    v_add_u32 v9, 24, v5
    v_and_b32 v5, 1, v4
    v_lshlrev_b32 v5, 9, v5
    v_lshl_add_u32 v5, v3, 5, v5
    v_lshrrev_b32 v6, 1, v4
    v_lshl_add_u32 v10, v6, 4, v5
    s_mov_b32 s32, 0xffff0000
    v_subrev_u32 v52, 32, v2
    v_min_u32 v52, 0x7fff0000, v52
    v_subrev_u32 v53, 16, v2
    v_min_u32 v53, 0x7fff0000, v53
    v_add_u32 v3, s15, v2
    buffer_load_dwordx4 v[28:31], v52, s[16:19], 0 offen
    buffer_load_dwordx2 v[38:39], v53, s[16:19], 0 offen
    buffer_load_dwordx4 v[12:15], v2, s[16:19], 0 offen offset:0
    buffer_load_dwordx2 v[4:5], v2, s[16:19], 0 offen offset:16
    buffer_load_dwordx4 v[16:19], v2, s[16:19], 0 offen offset:1024
    buffer_load_dwordx2 v[32:33], v2, s[16:19], 0 offen offset:1040
    buffer_load_dwordx4 v[20:23], v2, s[16:19], 0 offen offset:2048
    buffer_load_dwordx2 v[34:35], v2, s[16:19], 0 offen offset:2064
    buffer_load_dwordx4 v[24:27], v2, s[16:19], 0 offen offset:3072
    buffer_load_dwordx2 v[36:37], v2, s[16:19], 0 offen offset:3088
    s_lshl_b32 s3, s13, 1
    v_mov_b32 v6, s3
    buffer_load_ushort v6, v6, s[28:31], 0 offen
    s_add_u32 m0, s15, 16640
    s_nop 0
    buffer_load_dwordx4 v2, s[20:23], s14 offen offset:0 lds
    buffer_load_dwordx4 v2, s[20:23], s14 offen offset:1024 lds
    buffer_load_dwordx4 v2, s[20:23], s14 offen offset:2048 lds
    buffer_load_dwordx4 v2, s[20:23], s14 offen offset:3072 lds
    v_mov_b32 v54, 0
    v_mov_b32 v55, 0
    v_lshrrev_b32 v11, 1, v2
    v_add_u32 v11, s15, v11
    ds_write_b64 v11, v[54:55] offset:20736
    s_waitcnt vmcnt(14)
    ds_write_b128 v3, v[28:31] offset:0
    v_alignbit_b32 v40, v29, v28, 16
    v_alignbit_b32 v41, v30, v29, 16
    v_alignbit_b32 v42, v31, v30, 16
    s_waitcnt vmcnt(13)
    v_alignbit_b32 v43, v38, v31, 16
    v_pk_mov_b32 v[44:45], v[28:29], v[30:31] op_sel:[1,0]
    v_pk_mov_b32 v[46:47], v[30:31], v[38:39] op_sel:[1,0]
    ds_write_b128 v3, v[40:43] offset:4160
    v_pk_mov_b32 v[48:49], v[40:41], v[42:43] op_sel:[1,0]
    v_mov_b32 v50, v43
    v_alignbit_b32 v51, v39, v38, 16
    ds_write_b128 v3, v[44:47] offset:8320
    ds_write_b128 v3, v[48:51] offset:12480
    s_waitcnt vmcnt(12)
    ds_write_b128 v3, v[12:15] offset:32
    v_alignbit_b32 v40, v13, v12, 16
    v_alignbit_b32 v41, v14, v13, 16
    v_alignbit_b32 v42, v15, v14, 16
    s_waitcnt vmcnt(11)
    v_alignbit_b32 v43, v4, v15, 16
    v_pk_mov_b32 v[44:45], v[12:13], v[14:15] op_sel:[1,0]
    v_pk_mov_b32 v[46:47], v[14:15], v[4:5] op_sel:[1,0]
    ds_write_b128 v3, v[40:43] offset:4192
    v_pk_mov_b32 v[48:49], v[40:41], v[42:43] op_sel:[1,0]
    v_mov_b32 v50, v43
    v_alignbit_b32 v51, v5, v4, 16
    ds_write_b128 v3, v[44:47] offset:8352
    ds_write_b128 v3, v[48:51] offset:12512
    s_waitcnt vmcnt(10)
    ds_write_b128 v3, v[16:19] offset:1056
    v_alignbit_b32 v40, v17, v16, 16
    v_alignbit_b32 v41, v18, v17, 16
    v_alignbit_b32 v42, v19, v18, 16
    s_waitcnt vmcnt(9)
    v_alignbit_b32 v43, v32, v19, 16
    v_pk_mov_b32 v[44:45], v[16:17], v[18:19] op_sel:[1,0]
    v_pk_mov_b32 v[46:47], v[18:19], v[32:33] op_sel:[1,0]
    ds_write_b128 v3, v[40:43] offset:5216
    v_pk_mov_b32 v[48:49], v[40:41], v[42:43] op_sel:[1,0]
    v_mov_b32 v50, v43
    v_alignbit_b32 v51, v33, v32, 16
    ds_write_b128 v3, v[44:47] offset:9376
    ds_write_b128 v3, v[48:51] offset:13536
    s_waitcnt vmcnt(8)
    ds_write_b128 v3, v[20:23] offset:2080
    v_alignbit_b32 v40, v21, v20, 16
    v_alignbit_b32 v41, v22, v21, 16
    v_alignbit_b32 v42, v23, v22, 16
    s_waitcnt vmcnt(7)
    v_alignbit_b32 v43, v34, v23, 16
    v_pk_mov_b32 v[44:45], v[20:21], v[22:23] op_sel:[1,0]
    v_pk_mov_b32 v[46:47], v[22:23], v[34:35] op_sel:[1,0]
    ds_write_b128 v3, v[40:43] offset:6240
    v_pk_mov_b32 v[48:49], v[40:41], v[42:43] op_sel:[1,0]
    v_mov_b32 v50, v43
    v_alignbit_b32 v51, v35, v34, 16
    ds_write_b128 v3, v[44:47] offset:10400
    ds_write_b128 v3, v[48:51] offset:14560
    s_waitcnt vmcnt(6)
    ds_write_b128 v3, v[24:27] offset:3104
    v_alignbit_b32 v40, v25, v24, 16
    v_alignbit_b32 v41, v26, v25, 16
    v_alignbit_b32 v42, v27, v26, 16
    s_waitcnt vmcnt(5)
    v_alignbit_b32 v43, v36, v27, 16
    v_pk_mov_b32 v[44:45], v[24:25], v[26:27] op_sel:[1,0]
    v_pk_mov_b32 v[46:47], v[26:27], v[36:37] op_sel:[1,0]
    ds_write_b128 v3, v[40:43] offset:7264
    v_pk_mov_b32 v[48:49], v[40:41], v[42:43] op_sel:[1,0]
    v_mov_b32 v50, v43
    v_alignbit_b32 v51, v37, v36, 16
    ds_write_b128 v3, v[44:47] offset:11424
    ds_write_b128 v3, v[48:51] offset:15584
    s_waitcnt vmcnt(4)
    v_lshlrev_b32 v6, 16, v6
    s_waitcnt vmcnt(0) lgkmcnt(0)
    ds_read_b64 v[44:45], v7 offset:448
    ds_read_b64 v[46:47], v7 offset:456
    ds_read_b128 v[48:51], v8 offset:4032
    ds_read_b64 v[52:53], v7 offset:960
    ds_read_b64 v[54:55], v7 offset:968
    ds_read_b128 v[56:59], v8 offset:3520
    ds_read_b64 v[60:61], v7 offset:1472
    ds_read_b64 v[62:63], v7 offset:1480
    ds_read_b128 v[64:67], v8 offset:3008
    s_waitcnt lgkmcnt(6)
    v_mfma_f32_16x16x32_bf16 v[12:15], v[44:47], v[48:51], 0
    s_waitcnt lgkmcnt(4)
    v_mfma_f32_16x16x32_bf16 v[16:19], v[52:55], v[48:51], 0
    s_waitcnt lgkmcnt(3)
    v_mfma_f32_16x16x32_bf16 v[16:19], v[44:47], v[56:59], v[16:19]
    ds_read_b64 v[68:69], v7 offset:1984
    ds_read_b64 v[70:71], v7 offset:1992
    v_mfma_f32_16x16x32_bf16 v[20:23], v[52:55], v[56:59], 0
    ds_read_b128 v[72:75], v8 offset:2496
    s_waitcnt lgkmcnt(4)
    v_mfma_f32_16x16x32_bf16 v[20:23], v[60:63], v[48:51], v[20:23]
    s_waitcnt lgkmcnt(3)
    v_mfma_f32_16x16x32_bf16 v[20:23], v[44:47], v[64:67], v[20:23]
    v_mfma_f32_16x16x32_bf16 v[24:27], v[60:63], v[56:59], 0
    v_mfma_f32_16x16x32_bf16 v[24:27], v[52:55], v[64:67], v[24:27]
    v_mfma_f32_16x16x32_bf16 v[28:31], v[60:63], v[64:67], 0
    s_waitcnt lgkmcnt(1)
    v_mfma_f32_16x16x32_bf16 v[24:27], v[68:71], v[48:51], v[24:27]
    ds_read_b64 v[76:77], v7 offset:2496
    ds_read_b64 v[78:79], v7 offset:2504
    s_waitcnt lgkmcnt(2)
    v_mfma_f32_16x16x32_bf16 v[24:27], v[44:47], v[72:75], v[24:27]
    ds_read_b128 v[80:83], v8 offset:1984
    v_mfma_f32_16x16x32_bf16 v[28:31], v[68:71], v[56:59], v[28:31]
    v_mfma_f32_16x16x32_bf16 v[28:31], v[52:55], v[72:75], v[28:31]
    v_mfma_f32_16x16x32_bf16 v[32:35], v[68:71], v[64:67], 0
    v_mfma_f32_16x16x32_bf16 v[32:35], v[60:63], v[72:75], v[32:35]
    v_mfma_f32_16x16x32_bf16 v[36:39], v[68:71], v[72:75], 0
    s_waitcnt lgkmcnt(1)
    v_mfma_f32_16x16x32_bf16 v[28:31], v[76:79], v[48:51], v[28:31]
    s_waitcnt lgkmcnt(0)
    v_mfma_f32_16x16x32_bf16 v[28:31], v[44:47], v[80:83], v[28:31]
    ds_read_b64 v[84:85], v7 offset:3008
    ds_read_b64 v[86:87], v7 offset:3016
    v_mfma_f32_16x16x32_bf16 v[32:35], v[76:79], v[56:59], v[32:35]
    ds_read_b128 v[88:91], v8 offset:1472
    v_mfma_f32_16x16x32_bf16 v[32:35], v[52:55], v[80:83], v[32:35]
    v_mfma_f32_16x16x32_bf16 v[36:39], v[76:79], v[64:67], v[36:39]
    v_mfma_f32_16x16x32_bf16 v[36:39], v[60:63], v[80:83], v[36:39]
    v_mfma_f32_16x16x32_bf16 v[40:43], v[76:79], v[72:75], 0
    v_mfma_f32_16x16x32_bf16 v[40:43], v[68:71], v[80:83], v[40:43]
    ds_read_b64 v[92:93], v7 offset:3520
    ds_read_b64 v[94:95], v7 offset:3528
    s_waitcnt lgkmcnt(3)
    v_mfma_f32_16x16x32_bf16 v[32:35], v[84:87], v[48:51], v[32:35]
    ds_read_b128 v[96:99], v8 offset:960
    s_waitcnt lgkmcnt(3)
    v_mfma_f32_16x16x32_bf16 v[32:35], v[44:47], v[88:91], v[32:35]
    v_mfma_f32_16x16x32_bf16 v[36:39], v[84:87], v[56:59], v[36:39]
    v_mfma_f32_16x16x32_bf16 v[36:39], v[52:55], v[88:91], v[36:39]
    ds_read_b64 v[76:77], v7 offset:4032
    ds_read_b64 v[78:79], v7 offset:4040
    v_mfma_f32_16x16x32_bf16 v[40:43], v[84:87], v[64:67], v[40:43]
    ds_read_b128 v[72:75], v8 offset:448
    v_mfma_f32_16x16x32_bf16 v[40:43], v[60:63], v[88:91], v[40:43]
    ds_read_b64 v[68:69], v7 offset:384
    ds_read_b64 v[70:71], v7 offset:392
    s_waitcnt lgkmcnt(6)
    v_mfma_f32_16x16x32_bf16 v[36:39], v[92:95], v[48:51], v[36:39]
    ds_read_b128 v[80:83], v8 offset:3968
    s_waitcnt lgkmcnt(6)
    v_mfma_f32_16x16x32_bf16 v[36:39], v[44:47], v[96:99], v[36:39]
    ds_read_b64 v[84:85], v7 offset:896
    ds_read_b64 v[86:87], v7 offset:904
    v_mfma_f32_16x16x32_bf16 v[40:43], v[92:95], v[56:59], v[40:43]
    ds_read_b128 v[64:67], v8 offset:3456
    v_mfma_f32_16x16x32_bf16 v[40:43], v[52:55], v[96:99], v[40:43]
    ds_read_b64 v[60:61], v7 offset:1408
    ds_read_b64 v[62:63], v7 offset:1416
    s_waitcnt lgkmcnt(9)
    v_mfma_f32_16x16x32_bf16 v[40:43], v[76:79], v[48:51], v[40:43]
    ds_read_b128 v[88:91], v8 offset:2944
    s_waitcnt lgkmcnt(9)
    v_mfma_f32_16x16x32_bf16 v[40:43], v[44:47], v[72:75], v[40:43]
    s_waitcnt lgkmcnt(6)
    v_mfma_f32_16x16x32_bf16 v[12:15], v[68:71], v[80:83], v[12:15]
    s_waitcnt lgkmcnt(4)
    v_mfma_f32_16x16x32_bf16 v[16:19], v[84:87], v[80:83], v[16:19]
    s_waitcnt lgkmcnt(3)
    v_mfma_f32_16x16x32_bf16 v[16:19], v[68:71], v[64:67], v[16:19]
    ds_read_b64 v[92:93], v7 offset:1920
    ds_read_b64 v[94:95], v7 offset:1928
    v_mfma_f32_16x16x32_bf16 v[20:23], v[84:87], v[64:67], v[20:23]
    ds_read_b128 v[56:59], v8 offset:2432
    s_waitcnt lgkmcnt(4)
    v_mfma_f32_16x16x32_bf16 v[20:23], v[60:63], v[80:83], v[20:23]
    s_waitcnt lgkmcnt(3)
    v_mfma_f32_16x16x32_bf16 v[20:23], v[68:71], v[88:91], v[20:23]
    v_mfma_f32_16x16x32_bf16 v[24:27], v[60:63], v[64:67], v[24:27]
    v_mfma_f32_16x16x32_bf16 v[24:27], v[84:87], v[88:91], v[24:27]
    v_mfma_f32_16x16x32_bf16 v[28:31], v[60:63], v[88:91], v[28:31]
    s_waitcnt lgkmcnt(1)
    v_mfma_f32_16x16x32_bf16 v[24:27], v[92:95], v[80:83], v[24:27]
    ds_read_b64 v[52:53], v7 offset:2432
    ds_read_b64 v[54:55], v7 offset:2440
    s_waitcnt lgkmcnt(2)
    v_mfma_f32_16x16x32_bf16 v[24:27], v[68:71], v[56:59], v[24:27]
    ds_read_b128 v[96:99], v8 offset:1920
    v_mfma_f32_16x16x32_bf16 v[28:31], v[92:95], v[64:67], v[28:31]
    v_mfma_f32_16x16x32_bf16 v[28:31], v[84:87], v[56:59], v[28:31]
    v_mfma_f32_16x16x32_bf16 v[32:35], v[92:95], v[88:91], v[32:35]
    v_mfma_f32_16x16x32_bf16 v[32:35], v[60:63], v[56:59], v[32:35]
    v_mfma_f32_16x16x32_bf16 v[36:39], v[92:95], v[56:59], v[36:39]
    s_waitcnt lgkmcnt(1)
    v_mfma_f32_16x16x32_bf16 v[28:31], v[52:55], v[80:83], v[28:31]
    s_waitcnt lgkmcnt(0)
    v_mfma_f32_16x16x32_bf16 v[28:31], v[68:71], v[96:99], v[28:31]
    ds_read_b64 v[76:77], v7 offset:2944
    ds_read_b64 v[78:79], v7 offset:2952
    v_mfma_f32_16x16x32_bf16 v[32:35], v[52:55], v[64:67], v[32:35]
    ds_read_b128 v[48:51], v8 offset:1408
    v_mfma_f32_16x16x32_bf16 v[32:35], v[84:87], v[96:99], v[32:35]
    v_mfma_f32_16x16x32_bf16 v[36:39], v[52:55], v[88:91], v[36:39]
    v_mfma_f32_16x16x32_bf16 v[36:39], v[60:63], v[96:99], v[36:39]
    v_mfma_f32_16x16x32_bf16 v[40:43], v[52:55], v[56:59], v[40:43]
    v_mfma_f32_16x16x32_bf16 v[40:43], v[92:95], v[96:99], v[40:43]
    ds_read_b64 v[44:45], v7 offset:3456
    ds_read_b64 v[46:47], v7 offset:3464
    s_waitcnt lgkmcnt(3)
    v_mfma_f32_16x16x32_bf16 v[32:35], v[76:79], v[80:83], v[32:35]
    ds_read_b128 v[72:75], v8 offset:896
    s_waitcnt lgkmcnt(3)
    v_mfma_f32_16x16x32_bf16 v[32:35], v[68:71], v[48:51], v[32:35]
    v_mfma_f32_16x16x32_bf16 v[36:39], v[76:79], v[64:67], v[36:39]
    v_mfma_f32_16x16x32_bf16 v[36:39], v[84:87], v[48:51], v[36:39]
    ds_read_b64 v[52:53], v7 offset:3968
    ds_read_b64 v[54:55], v7 offset:3976
    v_mfma_f32_16x16x32_bf16 v[40:43], v[76:79], v[88:91], v[40:43]
    ds_read_b128 v[56:59], v8 offset:384
    v_mfma_f32_16x16x32_bf16 v[40:43], v[60:63], v[48:51], v[40:43]
    ds_read_b64 v[92:93], v7 offset:320
    ds_read_b64 v[94:95], v7 offset:328
    s_waitcnt lgkmcnt(6)
    v_mfma_f32_16x16x32_bf16 v[36:39], v[44:47], v[80:83], v[36:39]
    ds_read_b128 v[96:99], v8 offset:3904
    s_waitcnt lgkmcnt(6)
    v_mfma_f32_16x16x32_bf16 v[36:39], v[68:71], v[72:75], v[36:39]
    ds_read_b64 v[76:77], v7 offset:832
    ds_read_b64 v[78:79], v7 offset:840
    v_mfma_f32_16x16x32_bf16 v[40:43], v[44:47], v[64:67], v[40:43]
    ds_read_b128 v[88:91], v8 offset:3392
    v_mfma_f32_16x16x32_bf16 v[40:43], v[84:87], v[72:75], v[40:43]
    ds_read_b64 v[60:61], v7 offset:1344
    ds_read_b64 v[62:63], v7 offset:1352
    s_waitcnt lgkmcnt(9)
    v_mfma_f32_16x16x32_bf16 v[40:43], v[52:55], v[80:83], v[40:43]
    ds_read_b128 v[48:51], v8 offset:2880
    s_waitcnt lgkmcnt(9)
    v_mfma_f32_16x16x32_bf16 v[40:43], v[68:71], v[56:59], v[40:43]
    s_waitcnt lgkmcnt(6)
    v_mfma_f32_16x16x32_bf16 v[12:15], v[92:95], v[96:99], v[12:15]
    s_waitcnt lgkmcnt(4)
    v_mfma_f32_16x16x32_bf16 v[16:19], v[76:79], v[96:99], v[16:19]
    s_waitcnt lgkmcnt(3)
    v_mfma_f32_16x16x32_bf16 v[16:19], v[92:95], v[88:91], v[16:19]
    ds_read_b64 v[44:45], v7 offset:1856
    ds_read_b64 v[46:47], v7 offset:1864
    v_mfma_f32_16x16x32_bf16 v[20:23], v[76:79], v[88:91], v[20:23]
    ds_read_b128 v[64:67], v8 offset:2368
    s_waitcnt lgkmcnt(4)
    v_mfma_f32_16x16x32_bf16 v[20:23], v[60:63], v[96:99], v[20:23]
    s_waitcnt lgkmcnt(3)
    v_mfma_f32_16x16x32_bf16 v[20:23], v[92:95], v[48:51], v[20:23]
    v_mfma_f32_16x16x32_bf16 v[24:27], v[60:63], v[88:91], v[24:27]
    v_mfma_f32_16x16x32_bf16 v[24:27], v[76:79], v[48:51], v[24:27]
    v_mfma_f32_16x16x32_bf16 v[28:31], v[60:63], v[48:51], v[28:31]
    s_waitcnt lgkmcnt(1)
    v_mfma_f32_16x16x32_bf16 v[24:27], v[44:47], v[96:99], v[24:27]
    ds_read_b64 v[84:85], v7 offset:2368
    ds_read_b64 v[86:87], v7 offset:2376
    s_waitcnt lgkmcnt(2)
    v_mfma_f32_16x16x32_bf16 v[24:27], v[92:95], v[64:67], v[24:27]
    ds_read_b128 v[72:75], v8 offset:1856
    v_mfma_f32_16x16x32_bf16 v[28:31], v[44:47], v[88:91], v[28:31]
    v_mfma_f32_16x16x32_bf16 v[28:31], v[76:79], v[64:67], v[28:31]
    v_mfma_f32_16x16x32_bf16 v[32:35], v[44:47], v[48:51], v[32:35]
    v_mfma_f32_16x16x32_bf16 v[32:35], v[60:63], v[64:67], v[32:35]
    v_mfma_f32_16x16x32_bf16 v[36:39], v[44:47], v[64:67], v[36:39]
    s_waitcnt lgkmcnt(1)
    v_mfma_f32_16x16x32_bf16 v[28:31], v[84:87], v[96:99], v[28:31]
    s_waitcnt lgkmcnt(0)
    v_mfma_f32_16x16x32_bf16 v[28:31], v[92:95], v[72:75], v[28:31]
    ds_read_b64 v[52:53], v7 offset:2880
    ds_read_b64 v[54:55], v7 offset:2888
    v_mfma_f32_16x16x32_bf16 v[32:35], v[84:87], v[88:91], v[32:35]
    ds_read_b128 v[80:83], v8 offset:1344
    v_mfma_f32_16x16x32_bf16 v[32:35], v[76:79], v[72:75], v[32:35]
    v_mfma_f32_16x16x32_bf16 v[36:39], v[84:87], v[48:51], v[36:39]
    v_mfma_f32_16x16x32_bf16 v[36:39], v[60:63], v[72:75], v[36:39]
    v_mfma_f32_16x16x32_bf16 v[40:43], v[84:87], v[64:67], v[40:43]
    v_mfma_f32_16x16x32_bf16 v[40:43], v[44:47], v[72:75], v[40:43]
    ds_read_b64 v[68:69], v7 offset:3392
    ds_read_b64 v[70:71], v7 offset:3400
    s_waitcnt lgkmcnt(3)
    v_mfma_f32_16x16x32_bf16 v[32:35], v[52:55], v[96:99], v[32:35]
    ds_read_b128 v[56:59], v8 offset:832
    s_waitcnt lgkmcnt(3)
    v_mfma_f32_16x16x32_bf16 v[32:35], v[92:95], v[80:83], v[32:35]
    v_mfma_f32_16x16x32_bf16 v[36:39], v[52:55], v[88:91], v[36:39]
    v_mfma_f32_16x16x32_bf16 v[36:39], v[76:79], v[80:83], v[36:39]
    ds_read_b64 v[84:85], v7 offset:3904
    ds_read_b64 v[86:87], v7 offset:3912
    v_mfma_f32_16x16x32_bf16 v[40:43], v[52:55], v[48:51], v[40:43]
    ds_read_b128 v[64:67], v8 offset:320
    v_mfma_f32_16x16x32_bf16 v[40:43], v[60:63], v[80:83], v[40:43]
    ds_read_b64 v[44:45], v7 offset:256
    ds_read_b64 v[46:47], v7 offset:264
    s_waitcnt lgkmcnt(6)
    v_mfma_f32_16x16x32_bf16 v[36:39], v[68:71], v[96:99], v[36:39]
    ds_read_b128 v[72:75], v8 offset:3840
    s_waitcnt lgkmcnt(6)
    v_mfma_f32_16x16x32_bf16 v[36:39], v[92:95], v[56:59], v[36:39]
    ds_read_b64 v[52:53], v7 offset:768
    ds_read_b64 v[54:55], v7 offset:776
    v_mfma_f32_16x16x32_bf16 v[40:43], v[68:71], v[88:91], v[40:43]
    ds_read_b128 v[48:51], v8 offset:3328
    v_mfma_f32_16x16x32_bf16 v[40:43], v[76:79], v[56:59], v[40:43]
    ds_read_b64 v[60:61], v7 offset:1280
    ds_read_b64 v[62:63], v7 offset:1288
    s_waitcnt lgkmcnt(9)
    v_mfma_f32_16x16x32_bf16 v[40:43], v[84:87], v[96:99], v[40:43]
    ds_read_b128 v[80:83], v8 offset:2816
    s_waitcnt lgkmcnt(9)
    v_mfma_f32_16x16x32_bf16 v[40:43], v[92:95], v[64:67], v[40:43]
    s_waitcnt lgkmcnt(6)
    v_mfma_f32_16x16x32_bf16 v[12:15], v[44:47], v[72:75], v[12:15]
    s_waitcnt lgkmcnt(4)
    v_mfma_f32_16x16x32_bf16 v[16:19], v[52:55], v[72:75], v[16:19]
    s_waitcnt lgkmcnt(3)
    v_mfma_f32_16x16x32_bf16 v[16:19], v[44:47], v[48:51], v[16:19]
    ds_read_b64 v[68:69], v7 offset:1792
    ds_read_b64 v[70:71], v7 offset:1800
    v_mfma_f32_16x16x32_bf16 v[20:23], v[52:55], v[48:51], v[20:23]
    ds_read_b128 v[88:91], v8 offset:2304
    s_waitcnt lgkmcnt(4)
    v_mfma_f32_16x16x32_bf16 v[20:23], v[60:63], v[72:75], v[20:23]
    s_waitcnt lgkmcnt(3)
    v_mfma_f32_16x16x32_bf16 v[20:23], v[44:47], v[80:83], v[20:23]
    v_mfma_f32_16x16x32_bf16 v[24:27], v[60:63], v[48:51], v[24:27]
    v_mfma_f32_16x16x32_bf16 v[24:27], v[52:55], v[80:83], v[24:27]
    v_mfma_f32_16x16x32_bf16 v[28:31], v[60:63], v[80:83], v[28:31]
    s_waitcnt lgkmcnt(1)
    v_mfma_f32_16x16x32_bf16 v[24:27], v[68:71], v[72:75], v[24:27]
    ds_read_b64 v[76:77], v7 offset:2304
    ds_read_b64 v[78:79], v7 offset:2312
    s_waitcnt lgkmcnt(2)
    v_mfma_f32_16x16x32_bf16 v[24:27], v[44:47], v[88:91], v[24:27]
    ds_read_b128 v[56:59], v8 offset:1792
    v_mfma_f32_16x16x32_bf16 v[28:31], v[68:71], v[48:51], v[28:31]
    v_mfma_f32_16x16x32_bf16 v[28:31], v[52:55], v[88:91], v[28:31]
    v_mfma_f32_16x16x32_bf16 v[32:35], v[68:71], v[80:83], v[32:35]
    v_mfma_f32_16x16x32_bf16 v[32:35], v[60:63], v[88:91], v[32:35]
    v_mfma_f32_16x16x32_bf16 v[36:39], v[68:71], v[88:91], v[36:39]
    s_waitcnt lgkmcnt(1)
    v_mfma_f32_16x16x32_bf16 v[28:31], v[76:79], v[72:75], v[28:31]
    s_waitcnt lgkmcnt(0)
    v_mfma_f32_16x16x32_bf16 v[28:31], v[44:47], v[56:59], v[28:31]
    ds_read_b64 v[84:85], v7 offset:2816
    ds_read_b64 v[86:87], v7 offset:2824
    v_mfma_f32_16x16x32_bf16 v[32:35], v[76:79], v[48:51], v[32:35]
    ds_read_b128 v[96:99], v8 offset:1280
    v_mfma_f32_16x16x32_bf16 v[32:35], v[52:55], v[56:59], v[32:35]
    v_mfma_f32_16x16x32_bf16 v[36:39], v[76:79], v[80:83], v[36:39]
    v_mfma_f32_16x16x32_bf16 v[36:39], v[60:63], v[56:59], v[36:39]
    v_mfma_f32_16x16x32_bf16 v[40:43], v[76:79], v[88:91], v[40:43]
    v_mfma_f32_16x16x32_bf16 v[40:43], v[68:71], v[56:59], v[40:43]
    ds_read_b64 v[92:93], v7 offset:3328
    ds_read_b64 v[94:95], v7 offset:3336
    s_waitcnt lgkmcnt(3)
    v_mfma_f32_16x16x32_bf16 v[32:35], v[84:87], v[72:75], v[32:35]
    ds_read_b128 v[64:67], v8 offset:768
    s_waitcnt lgkmcnt(3)
    v_mfma_f32_16x16x32_bf16 v[32:35], v[44:47], v[96:99], v[32:35]
    v_mfma_f32_16x16x32_bf16 v[36:39], v[84:87], v[48:51], v[36:39]
    v_mfma_f32_16x16x32_bf16 v[36:39], v[52:55], v[96:99], v[36:39]
    ds_read_b64 v[76:77], v7 offset:3840
    ds_read_b64 v[78:79], v7 offset:3848
    v_mfma_f32_16x16x32_bf16 v[40:43], v[84:87], v[80:83], v[40:43]
    ds_read_b128 v[88:91], v8 offset:256
    v_mfma_f32_16x16x32_bf16 v[40:43], v[60:63], v[96:99], v[40:43]
    ds_read_b64 v[68:69], v7 offset:192
    ds_read_b64 v[70:71], v7 offset:200
    s_waitcnt lgkmcnt(6)
    v_mfma_f32_16x16x32_bf16 v[36:39], v[92:95], v[72:75], v[36:39]
    ds_read_b128 v[56:59], v8 offset:3776
    s_waitcnt lgkmcnt(6)
    v_mfma_f32_16x16x32_bf16 v[36:39], v[44:47], v[64:67], v[36:39]
    ds_read_b64 v[84:85], v7 offset:704
    ds_read_b64 v[86:87], v7 offset:712
    v_mfma_f32_16x16x32_bf16 v[40:43], v[92:95], v[48:51], v[40:43]
    ds_read_b128 v[80:83], v8 offset:3264
    v_mfma_f32_16x16x32_bf16 v[40:43], v[52:55], v[64:67], v[40:43]
    ds_read_b64 v[60:61], v7 offset:1216
    ds_read_b64 v[62:63], v7 offset:1224
    s_waitcnt lgkmcnt(9)
    v_mfma_f32_16x16x32_bf16 v[40:43], v[76:79], v[72:75], v[40:43]
    ds_read_b128 v[96:99], v8 offset:2752
    s_waitcnt lgkmcnt(9)
    v_mfma_f32_16x16x32_bf16 v[40:43], v[44:47], v[88:91], v[40:43]
    s_waitcnt lgkmcnt(6)
    v_mfma_f32_16x16x32_bf16 v[12:15], v[68:71], v[56:59], v[12:15]
    s_waitcnt lgkmcnt(4)
    v_mfma_f32_16x16x32_bf16 v[16:19], v[84:87], v[56:59], v[16:19]
    s_waitcnt lgkmcnt(3)
    v_mfma_f32_16x16x32_bf16 v[16:19], v[68:71], v[80:83], v[16:19]
    ds_read_b64 v[92:93], v7 offset:1728
    ds_read_b64 v[94:95], v7 offset:1736
    v_mfma_f32_16x16x32_bf16 v[20:23], v[84:87], v[80:83], v[20:23]
    ds_read_b128 v[48:51], v8 offset:2240
    s_waitcnt lgkmcnt(4)
    v_mfma_f32_16x16x32_bf16 v[20:23], v[60:63], v[56:59], v[20:23]
    s_waitcnt lgkmcnt(3)
    v_mfma_f32_16x16x32_bf16 v[20:23], v[68:71], v[96:99], v[20:23]
    v_mfma_f32_16x16x32_bf16 v[24:27], v[60:63], v[80:83], v[24:27]
    v_mfma_f32_16x16x32_bf16 v[24:27], v[84:87], v[96:99], v[24:27]
    v_mfma_f32_16x16x32_bf16 v[28:31], v[60:63], v[96:99], v[28:31]
    s_waitcnt lgkmcnt(1)
    v_mfma_f32_16x16x32_bf16 v[24:27], v[92:95], v[56:59], v[24:27]
    ds_read_b64 v[52:53], v7 offset:2240
    ds_read_b64 v[54:55], v7 offset:2248
    s_waitcnt lgkmcnt(2)
    v_mfma_f32_16x16x32_bf16 v[24:27], v[68:71], v[48:51], v[24:27]
    ds_read_b128 v[64:67], v8 offset:1728
    v_mfma_f32_16x16x32_bf16 v[28:31], v[92:95], v[80:83], v[28:31]
    v_mfma_f32_16x16x32_bf16 v[28:31], v[84:87], v[48:51], v[28:31]
    v_mfma_f32_16x16x32_bf16 v[32:35], v[92:95], v[96:99], v[32:35]
    v_mfma_f32_16x16x32_bf16 v[32:35], v[60:63], v[48:51], v[32:35]
    v_mfma_f32_16x16x32_bf16 v[36:39], v[92:95], v[48:51], v[36:39]
    s_waitcnt lgkmcnt(1)
    v_mfma_f32_16x16x32_bf16 v[28:31], v[52:55], v[56:59], v[28:31]
    s_waitcnt lgkmcnt(0)
    v_mfma_f32_16x16x32_bf16 v[28:31], v[68:71], v[64:67], v[28:31]
    ds_read_b64 v[76:77], v7 offset:2752
    ds_read_b64 v[78:79], v7 offset:2760
    v_mfma_f32_16x16x32_bf16 v[32:35], v[52:55], v[80:83], v[32:35]
    ds_read_b128 v[72:75], v8 offset:1216
    v_mfma_f32_16x16x32_bf16 v[32:35], v[84:87], v[64:67], v[32:35]
    v_mfma_f32_16x16x32_bf16 v[36:39], v[52:55], v[96:99], v[36:39]
    v_mfma_f32_16x16x32_bf16 v[36:39], v[60:63], v[64:67], v[36:39]
    v_mfma_f32_16x16x32_bf16 v[40:43], v[52:55], v[48:51], v[40:43]
    v_mfma_f32_16x16x32_bf16 v[40:43], v[92:95], v[64:67], v[40:43]
    ds_read_b64 v[44:45], v7 offset:3264
    ds_read_b64 v[46:47], v7 offset:3272
    s_waitcnt lgkmcnt(3)
    v_mfma_f32_16x16x32_bf16 v[32:35], v[76:79], v[56:59], v[32:35]
    ds_read_b128 v[88:91], v8 offset:704
    s_waitcnt lgkmcnt(3)
    v_mfma_f32_16x16x32_bf16 v[32:35], v[68:71], v[72:75], v[32:35]
    v_mfma_f32_16x16x32_bf16 v[36:39], v[76:79], v[80:83], v[36:39]
    v_mfma_f32_16x16x32_bf16 v[36:39], v[84:87], v[72:75], v[36:39]
    ds_read_b64 v[52:53], v7 offset:3776
    ds_read_b64 v[54:55], v7 offset:3784
    v_mfma_f32_16x16x32_bf16 v[40:43], v[76:79], v[96:99], v[40:43]
    ds_read_b128 v[48:51], v8 offset:192
    v_mfma_f32_16x16x32_bf16 v[40:43], v[60:63], v[72:75], v[40:43]
    ds_read_b64 v[92:93], v7 offset:128
    ds_read_b64 v[94:95], v7 offset:136
    s_waitcnt lgkmcnt(6)
    v_mfma_f32_16x16x32_bf16 v[36:39], v[44:47], v[56:59], v[36:39]
    ds_read_b128 v[64:67], v8 offset:3712
    s_waitcnt lgkmcnt(6)
    v_mfma_f32_16x16x32_bf16 v[36:39], v[68:71], v[88:91], v[36:39]
    ds_read_b64 v[76:77], v7 offset:640
    ds_read_b64 v[78:79], v7 offset:648
    v_mfma_f32_16x16x32_bf16 v[40:43], v[44:47], v[80:83], v[40:43]
    ds_read_b128 v[96:99], v8 offset:3200
    v_mfma_f32_16x16x32_bf16 v[40:43], v[84:87], v[88:91], v[40:43]
    ds_read_b64 v[60:61], v7 offset:1152
    ds_read_b64 v[62:63], v7 offset:1160
    s_waitcnt lgkmcnt(9)
    v_mfma_f32_16x16x32_bf16 v[40:43], v[52:55], v[56:59], v[40:43]
    ds_read_b128 v[72:75], v8 offset:2688
    s_waitcnt lgkmcnt(9)
    v_mfma_f32_16x16x32_bf16 v[40:43], v[68:71], v[48:51], v[40:43]
    s_waitcnt lgkmcnt(6)
    v_mfma_f32_16x16x32_bf16 v[12:15], v[92:95], v[64:67], v[12:15]
    s_waitcnt lgkmcnt(4)
    v_mfma_f32_16x16x32_bf16 v[16:19], v[76:79], v[64:67], v[16:19]
    s_waitcnt lgkmcnt(3)
    v_mfma_f32_16x16x32_bf16 v[16:19], v[92:95], v[96:99], v[16:19]
    ds_read_b64 v[44:45], v7 offset:1664
    ds_read_b64 v[46:47], v7 offset:1672
    v_mfma_f32_16x16x32_bf16 v[20:23], v[76:79], v[96:99], v[20:23]
    ds_read_b128 v[80:83], v8 offset:2176
    s_waitcnt lgkmcnt(4)
    v_mfma_f32_16x16x32_bf16 v[20:23], v[60:63], v[64:67], v[20:23]
    s_waitcnt lgkmcnt(3)
    v_mfma_f32_16x16x32_bf16 v[20:23], v[92:95], v[72:75], v[20:23]
    v_mfma_f32_16x16x32_bf16 v[24:27], v[60:63], v[96:99], v[24:27]
    v_mfma_f32_16x16x32_bf16 v[24:27], v[76:79], v[72:75], v[24:27]
    v_mfma_f32_16x16x32_bf16 v[28:31], v[60:63], v[72:75], v[28:31]
    s_waitcnt lgkmcnt(1)
    v_mfma_f32_16x16x32_bf16 v[24:27], v[44:47], v[64:67], v[24:27]
    ds_read_b64 v[84:85], v7 offset:2176
    ds_read_b64 v[86:87], v7 offset:2184
    s_waitcnt lgkmcnt(2)
    v_mfma_f32_16x16x32_bf16 v[24:27], v[92:95], v[80:83], v[24:27]
    ds_read_b128 v[88:91], v8 offset:1664
    v_mfma_f32_16x16x32_bf16 v[28:31], v[44:47], v[96:99], v[28:31]
    v_mfma_f32_16x16x32_bf16 v[28:31], v[76:79], v[80:83], v[28:31]
    v_mfma_f32_16x16x32_bf16 v[32:35], v[44:47], v[72:75], v[32:35]
    v_mfma_f32_16x16x32_bf16 v[32:35], v[60:63], v[80:83], v[32:35]
    v_mfma_f32_16x16x32_bf16 v[36:39], v[44:47], v[80:83], v[36:39]
    s_waitcnt lgkmcnt(1)
    v_mfma_f32_16x16x32_bf16 v[28:31], v[84:87], v[64:67], v[28:31]
    s_waitcnt lgkmcnt(0)
    v_mfma_f32_16x16x32_bf16 v[28:31], v[92:95], v[88:91], v[28:31]
    ds_read_b64 v[52:53], v7 offset:2688
    ds_read_b64 v[54:55], v7 offset:2696
    v_mfma_f32_16x16x32_bf16 v[32:35], v[84:87], v[96:99], v[32:35]
    ds_read_b128 v[56:59], v8 offset:1152
    v_mfma_f32_16x16x32_bf16 v[32:35], v[76:79], v[88:91], v[32:35]
    v_mfma_f32_16x16x32_bf16 v[36:39], v[84:87], v[72:75], v[36:39]
    v_mfma_f32_16x16x32_bf16 v[36:39], v[60:63], v[88:91], v[36:39]
    v_mfma_f32_16x16x32_bf16 v[40:43], v[84:87], v[80:83], v[40:43]
    v_mfma_f32_16x16x32_bf16 v[40:43], v[44:47], v[88:91], v[40:43]
    ds_read_b64 v[68:69], v7 offset:3200
    ds_read_b64 v[70:71], v7 offset:3208
    s_waitcnt lgkmcnt(3)
    v_mfma_f32_16x16x32_bf16 v[32:35], v[52:55], v[64:67], v[32:35]
    ds_read_b128 v[48:51], v8 offset:640
    s_waitcnt lgkmcnt(3)
    v_mfma_f32_16x16x32_bf16 v[32:35], v[92:95], v[56:59], v[32:35]
    v_mfma_f32_16x16x32_bf16 v[36:39], v[52:55], v[96:99], v[36:39]
    v_mfma_f32_16x16x32_bf16 v[36:39], v[76:79], v[56:59], v[36:39]
    ds_read_b64 v[84:85], v7 offset:3712
    ds_read_b64 v[86:87], v7 offset:3720
    v_mfma_f32_16x16x32_bf16 v[40:43], v[52:55], v[72:75], v[40:43]
    ds_read_b128 v[80:83], v8 offset:128
    v_mfma_f32_16x16x32_bf16 v[40:43], v[60:63], v[56:59], v[40:43]
    ds_read_b64 v[44:45], v7 offset:64
    ds_read_b64 v[46:47], v7 offset:72
    s_waitcnt lgkmcnt(6)
    v_mfma_f32_16x16x32_bf16 v[36:39], v[68:71], v[64:67], v[36:39]
    ds_read_b128 v[88:91], v8 offset:3648
    s_waitcnt lgkmcnt(6)
    v_mfma_f32_16x16x32_bf16 v[36:39], v[92:95], v[48:51], v[36:39]
    ds_read_b64 v[52:53], v7 offset:576
    ds_read_b64 v[54:55], v7 offset:584
    v_mfma_f32_16x16x32_bf16 v[40:43], v[68:71], v[96:99], v[40:43]
    ds_read_b128 v[72:75], v8 offset:3136
    v_mfma_f32_16x16x32_bf16 v[40:43], v[76:79], v[48:51], v[40:43]
    ds_read_b64 v[60:61], v7 offset:1088
    ds_read_b64 v[62:63], v7 offset:1096
    s_waitcnt lgkmcnt(9)
    v_mfma_f32_16x16x32_bf16 v[40:43], v[84:87], v[64:67], v[40:43]
    ds_read_b128 v[56:59], v8 offset:2624
    s_waitcnt lgkmcnt(9)
    v_mfma_f32_16x16x32_bf16 v[40:43], v[92:95], v[80:83], v[40:43]
    s_waitcnt lgkmcnt(6)
    v_mfma_f32_16x16x32_bf16 v[12:15], v[44:47], v[88:91], v[12:15]
    s_waitcnt lgkmcnt(4)
    v_mfma_f32_16x16x32_bf16 v[16:19], v[52:55], v[88:91], v[16:19]
    s_waitcnt lgkmcnt(3)
    v_mfma_f32_16x16x32_bf16 v[16:19], v[44:47], v[72:75], v[16:19]
    ds_read_b64 v[68:69], v7 offset:1600
    ds_read_b64 v[70:71], v7 offset:1608
    v_mfma_f32_16x16x32_bf16 v[20:23], v[52:55], v[72:75], v[20:23]
    ds_read_b128 v[96:99], v8 offset:2112
    s_waitcnt lgkmcnt(4)
    v_mfma_f32_16x16x32_bf16 v[20:23], v[60:63], v[88:91], v[20:23]
    s_waitcnt lgkmcnt(3)
    v_mfma_f32_16x16x32_bf16 v[20:23], v[44:47], v[56:59], v[20:23]
    v_mfma_f32_16x16x32_bf16 v[24:27], v[60:63], v[72:75], v[24:27]
    v_mfma_f32_16x16x32_bf16 v[24:27], v[52:55], v[56:59], v[24:27]
    v_mfma_f32_16x16x32_bf16 v[28:31], v[60:63], v[56:59], v[28:31]
    s_waitcnt lgkmcnt(1)
    v_mfma_f32_16x16x32_bf16 v[24:27], v[68:71], v[88:91], v[24:27]
    ds_read_b64 v[76:77], v7 offset:2112
    ds_read_b64 v[78:79], v7 offset:2120
    s_waitcnt lgkmcnt(2)
    v_mfma_f32_16x16x32_bf16 v[24:27], v[44:47], v[96:99], v[24:27]
    ds_read_b128 v[48:51], v8 offset:1600
    v_mfma_f32_16x16x32_bf16 v[28:31], v[68:71], v[72:75], v[28:31]
    v_mfma_f32_16x16x32_bf16 v[28:31], v[52:55], v[96:99], v[28:31]
    v_mfma_f32_16x16x32_bf16 v[32:35], v[68:71], v[56:59], v[32:35]
    v_mfma_f32_16x16x32_bf16 v[32:35], v[60:63], v[96:99], v[32:35]
    v_mfma_f32_16x16x32_bf16 v[36:39], v[68:71], v[96:99], v[36:39]
    s_waitcnt lgkmcnt(1)
    v_mfma_f32_16x16x32_bf16 v[28:31], v[76:79], v[88:91], v[28:31]
    s_waitcnt lgkmcnt(0)
    v_mfma_f32_16x16x32_bf16 v[28:31], v[44:47], v[48:51], v[28:31]
    ds_read_b64 v[84:85], v7 offset:2624
    ds_read_b64 v[86:87], v7 offset:2632
    v_mfma_f32_16x16x32_bf16 v[32:35], v[76:79], v[72:75], v[32:35]
    ds_read_b128 v[64:67], v8 offset:1088
    v_mfma_f32_16x16x32_bf16 v[32:35], v[52:55], v[48:51], v[32:35]
    v_mfma_f32_16x16x32_bf16 v[36:39], v[76:79], v[56:59], v[36:39]
    v_mfma_f32_16x16x32_bf16 v[36:39], v[60:63], v[48:51], v[36:39]
    v_mfma_f32_16x16x32_bf16 v[40:43], v[76:79], v[96:99], v[40:43]
    v_mfma_f32_16x16x32_bf16 v[40:43], v[68:71], v[48:51], v[40:43]
    ds_read_b64 v[92:93], v7 offset:3136
    ds_read_b64 v[94:95], v7 offset:3144
    s_waitcnt lgkmcnt(3)
    v_mfma_f32_16x16x32_bf16 v[32:35], v[84:87], v[88:91], v[32:35]
    ds_read_b128 v[80:83], v8 offset:576
    s_waitcnt lgkmcnt(3)
    v_mfma_f32_16x16x32_bf16 v[32:35], v[44:47], v[64:67], v[32:35]
    v_mfma_f32_16x16x32_bf16 v[36:39], v[84:87], v[72:75], v[36:39]
    v_mfma_f32_16x16x32_bf16 v[36:39], v[52:55], v[64:67], v[36:39]
    ds_read_b64 v[76:77], v7 offset:3648
    ds_read_b64 v[78:79], v7 offset:3656
    v_mfma_f32_16x16x32_bf16 v[40:43], v[84:87], v[56:59], v[40:43]
    ds_read_b128 v[96:99], v8 offset:64
    v_mfma_f32_16x16x32_bf16 v[40:43], v[60:63], v[64:67], v[40:43]
    ds_read_b64 v[68:69], v7 offset:0
    ds_read_b64 v[70:71], v7 offset:8
    s_waitcnt lgkmcnt(6)
    v_mfma_f32_16x16x32_bf16 v[36:39], v[92:95], v[88:91], v[36:39]
    ds_read_b128 v[48:51], v8 offset:3584
    s_waitcnt lgkmcnt(6)
    v_mfma_f32_16x16x32_bf16 v[36:39], v[44:47], v[80:83], v[36:39]
    ds_read_b64 v[84:85], v7 offset:512
    ds_read_b64 v[86:87], v7 offset:520
    v_mfma_f32_16x16x32_bf16 v[40:43], v[92:95], v[72:75], v[40:43]
    ds_read_b128 v[56:59], v8 offset:3072
    v_mfma_f32_16x16x32_bf16 v[40:43], v[52:55], v[80:83], v[40:43]
    ds_read_b64 v[60:61], v7 offset:1024
    ds_read_b64 v[62:63], v7 offset:1032
    s_waitcnt lgkmcnt(9)
    v_mfma_f32_16x16x32_bf16 v[40:43], v[76:79], v[88:91], v[40:43]
    ds_read_b128 v[64:67], v8 offset:2560
    s_waitcnt lgkmcnt(9)
    v_mfma_f32_16x16x32_bf16 v[40:43], v[44:47], v[96:99], v[40:43]
    s_waitcnt lgkmcnt(6)
    v_mfma_f32_16x16x32_bf16 v[12:15], v[68:71], v[48:51], v[12:15]
    s_waitcnt lgkmcnt(4)
    v_mfma_f32_16x16x32_bf16 v[16:19], v[84:87], v[48:51], v[16:19]
    s_waitcnt lgkmcnt(3)
    v_mfma_f32_16x16x32_bf16 v[16:19], v[68:71], v[56:59], v[16:19]
    ds_read_b64 v[92:93], v7 offset:1536
    ds_read_b64 v[94:95], v7 offset:1544
    v_mfma_f32_16x16x32_bf16 v[20:23], v[84:87], v[56:59], v[20:23]
    ds_read_b128 v[72:75], v8 offset:2048
    s_waitcnt lgkmcnt(4)
    v_mfma_f32_16x16x32_bf16 v[20:23], v[60:63], v[48:51], v[20:23]
    s_waitcnt lgkmcnt(3)
    v_mfma_f32_16x16x32_bf16 v[20:23], v[68:71], v[64:67], v[20:23]
    v_mfma_f32_16x16x32_bf16 v[24:27], v[60:63], v[56:59], v[24:27]
    v_mfma_f32_16x16x32_bf16 v[24:27], v[84:87], v[64:67], v[24:27]
    v_mfma_f32_16x16x32_bf16 v[28:31], v[60:63], v[64:67], v[28:31]
    s_waitcnt lgkmcnt(1)
    v_mfma_f32_16x16x32_bf16 v[24:27], v[92:95], v[48:51], v[24:27]
    ds_read_b64 v[52:53], v7 offset:2048
    ds_read_b64 v[54:55], v7 offset:2056
    s_waitcnt lgkmcnt(2)
    v_mfma_f32_16x16x32_bf16 v[24:27], v[68:71], v[72:75], v[24:27]
    ds_read_b128 v[80:83], v8 offset:1536
    v_mfma_f32_16x16x32_bf16 v[28:31], v[92:95], v[56:59], v[28:31]
    v_mfma_f32_16x16x32_bf16 v[28:31], v[84:87], v[72:75], v[28:31]
    v_mfma_f32_16x16x32_bf16 v[32:35], v[92:95], v[64:67], v[32:35]
    v_mfma_f32_16x16x32_bf16 v[32:35], v[60:63], v[72:75], v[32:35]
    v_mfma_f32_16x16x32_bf16 v[36:39], v[92:95], v[72:75], v[36:39]
    s_waitcnt lgkmcnt(1)
    v_mfma_f32_16x16x32_bf16 v[28:31], v[52:55], v[48:51], v[28:31]
    s_waitcnt lgkmcnt(0)
    v_mfma_f32_16x16x32_bf16 v[28:31], v[68:71], v[80:83], v[28:31]
    ds_read_b64 v[76:77], v7 offset:2560
    ds_read_b64 v[78:79], v7 offset:2568
    v_mfma_f32_16x16x32_bf16 v[32:35], v[52:55], v[56:59], v[32:35]
    ds_read_b128 v[88:91], v8 offset:1024
    v_mfma_f32_16x16x32_bf16 v[32:35], v[84:87], v[80:83], v[32:35]
    v_mfma_f32_16x16x32_bf16 v[36:39], v[52:55], v[64:67], v[36:39]
    v_mfma_f32_16x16x32_bf16 v[36:39], v[60:63], v[80:83], v[36:39]
    v_mfma_f32_16x16x32_bf16 v[40:43], v[52:55], v[72:75], v[40:43]
    v_mfma_f32_16x16x32_bf16 v[40:43], v[92:95], v[80:83], v[40:43]
    ds_read_b64 v[44:45], v7 offset:3072
    ds_read_b64 v[46:47], v7 offset:3080
    s_waitcnt lgkmcnt(3)
    v_mfma_f32_16x16x32_bf16 v[32:35], v[76:79], v[48:51], v[32:35]
    ds_read_b128 v[96:99], v8 offset:512
    s_waitcnt lgkmcnt(3)
    v_mfma_f32_16x16x32_bf16 v[32:35], v[68:71], v[88:91], v[32:35]
    v_mfma_f32_16x16x32_bf16 v[36:39], v[76:79], v[56:59], v[36:39]
    v_mfma_f32_16x16x32_bf16 v[36:39], v[84:87], v[88:91], v[36:39]
    ds_read_b64 v[52:53], v7 offset:3584
    ds_read_b64 v[54:55], v7 offset:3592
    v_mfma_f32_16x16x32_bf16 v[40:43], v[76:79], v[64:67], v[40:43]
    ds_read_b128 v[72:75], v8 offset:0
    v_mfma_f32_16x16x32_bf16 v[40:43], v[60:63], v[88:91], v[40:43]
    s_waitcnt lgkmcnt(4)
    v_mfma_f32_16x16x32_bf16 v[36:39], v[44:47], v[48:51], v[36:39]
    s_waitcnt lgkmcnt(3)
    v_mfma_f32_16x16x32_bf16 v[36:39], v[68:71], v[96:99], v[36:39]
    v_mfma_f32_16x16x32_bf16 v[40:43], v[44:47], v[56:59], v[40:43]
    v_mfma_f32_16x16x32_bf16 v[40:43], v[84:87], v[96:99], v[40:43]
    s_waitcnt lgkmcnt(1)
    v_mfma_f32_16x16x32_bf16 v[40:43], v[52:55], v[48:51], v[40:43]
    s_waitcnt lgkmcnt(0)
    v_mfma_f32_16x16x32_bf16 v[40:43], v[68:71], v[72:75], v[40:43]
    ds_read_b64 v[4:5], v9 offset:3584
    ds_read_b64 v[44:45], v9 offset:3072
    ds_read_b64 v[46:47], v9 offset:2560
    ds_read_b64 v[48:49], v9 offset:2048
    ds_read_b64 v[50:51], v9 offset:1536
    ds_read_b64 v[52:53], v9 offset:1024
    ds_read_b64 v[54:55], v9 offset:512
    ds_read_b64 v[56:57], v9 offset:0
    s_mov_b32 s33, s14
    s_waitcnt lgkmcnt(7)
    v_and_b32 v58, s32, v5
    v_lshlrev_b32 v59, 16, v5
    v_and_b32 v60, s32, v4
    v_lshlrev_b32 v61, 16, v4
    v_fmac_f32 v12, v6, v58
    v_fmac_f32 v13, v6, v59
    v_fmac_f32 v14, v6, v60
    v_fmac_f32 v15, v6, v61
    v_cvt_pk_bf16_f32 v62, v12, v13
    v_cvt_pk_bf16_f32 v63, v14, v15
    s_waitcnt lgkmcnt(6)
    v_and_b32 v58, s32, v45
    v_lshlrev_b32 v59, 16, v45
    v_and_b32 v60, s32, v44
    v_lshlrev_b32 v61, 16, v44
    v_fmac_f32 v16, v6, v58
    v_fmac_f32 v17, v6, v59
    v_fmac_f32 v18, v6, v60
    v_fmac_f32 v19, v6, v61
    v_cvt_pk_bf16_f32 v64, v16, v17
    v_cvt_pk_bf16_f32 v65, v18, v19
    s_nop 0
    v_permlane16_swap_b32 v62, v64
    v_permlane16_swap_b32 v63, v65
    buffer_store_dwordx4 v[62:65], v10, s[24:27], s33 offen offset:0 sc0 sc1
    s_waitcnt lgkmcnt(5)
    v_and_b32 v58, s32, v47
    v_lshlrev_b32 v59, 16, v47
    v_and_b32 v60, s32, v46
    v_lshlrev_b32 v61, 16, v46
    v_fmac_f32 v20, v6, v58
    v_fmac_f32 v21, v6, v59
    v_fmac_f32 v22, v6, v60
    v_fmac_f32 v23, v6, v61
    v_cvt_pk_bf16_f32 v66, v20, v21
    v_cvt_pk_bf16_f32 v67, v22, v23
    s_waitcnt lgkmcnt(4)
    v_and_b32 v58, s32, v49
    v_lshlrev_b32 v59, 16, v49
    v_and_b32 v60, s32, v48
    v_lshlrev_b32 v61, 16, v48
    v_fmac_f32 v24, v6, v58
    v_fmac_f32 v25, v6, v59
    v_fmac_f32 v26, v6, v60
    v_fmac_f32 v27, v6, v61
    v_cvt_pk_bf16_f32 v68, v24, v25
    v_cvt_pk_bf16_f32 v69, v26, v27
    s_nop 0
    v_permlane16_swap_b32 v66, v68
    v_permlane16_swap_b32 v67, v69
    buffer_store_dwordx4 v[66:69], v10, s[24:27], s33 offen offset:1024 sc0 sc1
    s_waitcnt lgkmcnt(3)
    v_and_b32 v58, s32, v51
    v_lshlrev_b32 v59, 16, v51
    v_and_b32 v60, s32, v50
    v_lshlrev_b32 v61, 16, v50
    v_fmac_f32 v28, v6, v58
    v_fmac_f32 v29, v6, v59
    v_fmac_f32 v30, v6, v60
    v_fmac_f32 v31, v6, v61
    v_cvt_pk_bf16_f32 v62, v28, v29
    v_cvt_pk_bf16_f32 v63, v30, v31
    s_waitcnt lgkmcnt(2)
    v_and_b32 v58, s32, v53
    v_lshlrev_b32 v59, 16, v53
    v_and_b32 v60, s32, v52
    v_lshlrev_b32 v61, 16, v52
    v_fmac_f32 v32, v6, v58
    v_fmac_f32 v33, v6, v59
    v_fmac_f32 v34, v6, v60
    v_fmac_f32 v35, v6, v61
    v_cvt_pk_bf16_f32 v64, v32, v33
    v_cvt_pk_bf16_f32 v65, v34, v35
    s_nop 0
    v_permlane16_swap_b32 v62, v64
    v_permlane16_swap_b32 v63, v65
    buffer_store_dwordx4 v[62:65], v10, s[24:27], s33 offen offset:2048 sc0 sc1
    s_waitcnt lgkmcnt(1)
    v_and_b32 v58, s32, v55
    v_lshlrev_b32 v59, 16, v55
    v_and_b32 v60, s32, v54
    v_lshlrev_b32 v61, 16, v54
    v_fmac_f32 v36, v6, v58
    v_fmac_f32 v37, v6, v59
    v_fmac_f32 v38, v6, v60
    v_fmac_f32 v39, v6, v61
    v_cvt_pk_bf16_f32 v66, v36, v37
    v_cvt_pk_bf16_f32 v67, v38, v39
    s_waitcnt lgkmcnt(0)
    v_and_b32 v58, s32, v57
    v_lshlrev_b32 v59, 16, v57
    v_and_b32 v60, s32, v56
    v_lshlrev_b32 v61, 16, v56
    v_fmac_f32 v40, v6, v58
    v_fmac_f32 v41, v6, v59
    v_fmac_f32 v42, v6, v60
    v_fmac_f32 v43, v6, v61
    v_cvt_pk_bf16_f32 v68, v40, v41
    v_cvt_pk_bf16_f32 v69, v42, v43
    s_nop 0
    v_permlane16_swap_b32 v66, v68
    v_permlane16_swap_b32 v67, v69
    buffer_store_dwordx4 v[66:69], v10, s[24:27], s33 offen offset:3072 sc0 sc1
    s_waitcnt vmcnt(0)
Lend_conv_kernel:
    s_endpgm

.section .rodata,"a"
.p2align 6
.amdhsa_kernel conv_kernel
  .amdhsa_next_free_vgpr 100
  .amdhsa_next_free_sgpr 34
  .amdhsa_accum_offset 100
  .amdhsa_group_segment_fixed_size 0
  .amdhsa_kernarg_size 152
  .amdhsa_user_sgpr_count 2
  .amdhsa_user_sgpr_kernarg_segment_ptr 1
  .amdhsa_system_sgpr_workgroup_id_x 1
  .amdhsa_float_denorm_mode_32 3
.end_amdhsa_kernel
.text
.globl g2_kernel
.p2align 8
.type g2_kernel,@function
g2_kernel:
    s_cmp_ge_u32 s2, 256
    s_cbranch_scc1 Lend_g2_kernel
    s_load_dwordx2 s[4:5], s[0:1], 0
    s_load_dwordx2 s[6:7], s[0:1], 64
    s_load_dwordx2 s[8:9], s[0:1], 128
    s_load_dwordx2 s[10:11], s[0:1], 144
    v_lshrrev_b32 v1, 6, v0
    s_nop 0
    v_readfirstlane_b32 s12, v1
    v_and_b32 v1, 63, v0
    s_and_b32 s15, s2, 7
    s_lshr_b32 s13, s15, 1
    s_lshl_b32 s13, s13, 3
    s_and_b32 s14, s15, 1
    s_lshl_b32 s14, s14, 2
    s_lshr_b32 s15, s2, 3
    s_and_b32 s3, s15, 7
    s_add_u32 s13, s13, s3
    s_lshr_b32 s15, s15, 3
    s_add_u32 s14, s14, s15
    s_waitcnt lgkmcnt(0)
    s_mov_b32 s16, s10
    s_mov_b32 s17, s11
    s_mov_b32 s18, 8388608
    s_mov_b32 s19, 131072
    s_lshl_b32 s3, s14, 2
    s_add_u32 s3, s3, s12
    s_lshl_b32 s3, s3, 17
    s_add_u32 s3, s3, 16777216
    s_add_u32 s20, s10, s3
    s_addc_u32 s21, s11, 0
    s_mov_b32 s22, 131072
    s_mov_b32 s23, 131072
    v_lshlrev_b32 v2, 4, v1
    v_and_b32 v6, 7, v1
    v_lshrrev_b32 v5, 3, v1
    s_lshl_b32 s3, s12, 4
    s_add_u32 s3, s3, 0
    v_add_u32 v5, s3, v5
    v_bfe_u32 v7, v5, 1, 3
    v_xor_b32 v7, v7, v6
    v_lshlrev_b32 v7, 4, v7
    s_lshl_b32 s3, s13, 6
    v_add_u32 v5, s3, v5
    v_lshl_add_u32 v3, v5, 12, v7
    v_lshrrev_b32 v5, 3, v1
    s_lshl_b32 s3, s12, 4
    s_add_u32 s3, s3, 8
    v_add_u32 v5, s3, v5
    v_bfe_u32 v7, v5, 1, 3
    v_xor_b32 v7, v7, v6
    v_lshlrev_b32 v7, 4, v7
    s_lshl_b32 s3, s13, 6
    v_add_u32 v5, s3, v5
    v_lshl_add_u32 v4, v5, 12, v7
    s_lshl_b32 s25, s12, 11
    v_and_b32 v5, 31, v1
    v_bfe_u32 v6, v5, 1, 3
    v_lshrrev_b32 v7, 5, v1
    v_xor_b32 v6, v6, v7
    v_lshlrev_b32 v6, 4, v6
    v_lshl_add_u32 v6, v5, 7, v6
    v_xor_b32 v8, 0, v6
    v_xor_b32 v9, 32, v6
    v_xor_b32 v10, 64, v6
    v_xor_b32 v11, 96, v6
    s_mov_b32 s24, 0
    s_add_u32 m0, s25, 0
    s_nop 0
    buffer_load_dwordx4 v3, s[16:19], s24 offen offset:0 lds
    s_add_u32 m0, s25, 1024
    s_nop 0
    buffer_load_dwordx4 v4, s[16:19], s24 offen offset:0 lds
    s_add_u32 m0, s25, 8064
    s_nop 0
    buffer_load_dwordx4 v3, s[16:19], s24 offen offset:128 lds
    s_add_u32 m0, s25, 9088
    s_nop 0
    buffer_load_dwordx4 v4, s[16:19], s24 offen offset:128 lds
    s_mov_b32 s24, 256
    s_add_u32 m0, s25, 16384
    s_nop 0
    buffer_load_dwordx4 v3, s[16:19], s24 offen offset:0 lds
    s_add_u32 m0, s25, 17408
    s_nop 0
    buffer_load_dwordx4 v4, s[16:19], s24 offen offset:0 lds
    s_add_u32 m0, s25, 24448
    s_nop 0
    buffer_load_dwordx4 v3, s[16:19], s24 offen offset:128 lds
    s_add_u32 m0, s25, 25472
    s_nop 0
    buffer_load_dwordx4 v4, s[16:19], s24 offen offset:128 lds
    s_mov_b32 s24, 512
    s_add_u32 m0, s25, 32768
    s_nop 0
    buffer_load_dwordx4 v3, s[16:19], s24 offen offset:0 lds
    s_add_u32 m0, s25, 33792
    s_nop 0
    buffer_load_dwordx4 v4, s[16:19], s24 offen offset:0 lds
    s_add_u32 m0, s25, 40832
    s_nop 0
    buffer_load_dwordx4 v3, s[16:19], s24 offen offset:128 lds
    s_add_u32 m0, s25, 41856
    s_nop 0
    buffer_load_dwordx4 v4, s[16:19], s24 offen offset:128 lds
    s_mov_b32 s15, 0
    buffer_load_dwordx4 v[60:63], v2, s[20:23], s15 offen offset:0
    s_mov_b32 s15, 0
    buffer_load_dwordx4 v[64:67], v2, s[20:23], s15 offen offset:1024
    s_mov_b32 s15, 0
    buffer_load_dwordx4 v[68:71], v2, s[20:23], s15 offen offset:2048
    s_mov_b32 s15, 0
    buffer_load_dwordx4 v[72:75], v2, s[20:23], s15 offen offset:3072
    s_mov_b32 s15, 4096
    buffer_load_dwordx4 v[76:79], v2, s[20:23], s15 offen offset:0
    s_mov_b32 s15, 4096
    buffer_load_dwordx4 v[80:83], v2, s[20:23], s15 offen offset:1024
    s_mov_b32 s15, 4096
    buffer_load_dwordx4 v[84:87], v2, s[20:23], s15 offen offset:2048
    s_mov_b32 s15, 4096
    buffer_load_dwordx4 v[88:91], v2, s[20:23], s15 offen offset:3072
    s_mov_b32 s15, 8192
    buffer_load_dwordx4 v[92:95], v2, s[20:23], s15 offen offset:0
    s_mov_b32 s15, 8192
    buffer_load_dwordx4 v[96:99], v2, s[20:23], s15 offen offset:1024
    s_mov_b32 s15, 8192
    buffer_load_dwordx4 v[100:103], v2, s[20:23], s15 offen offset:2048
    s_mov_b32 s15, 8192
    buffer_load_dwordx4 v[104:107], v2, s[20:23], s15 offen offset:3072
    s_mov_b32 s15, 12288
    buffer_load_dwordx4 v[108:111], v2, s[20:23], s15 offen offset:0
    s_mov_b32 s15, 12288
    buffer_load_dwordx4 v[112:115], v2, s[20:23], s15 offen offset:1024
    s_mov_b32 s28, s4
    s_mov_b32 s29, s5
    s_mov_b32 s30, 4194304
    s_mov_b32 s31, 131072
    s_add_u32 s32, s10, 12582912
    s_addc_u32 s33, s11, 0
    s_mov_b32 s34, 4194304
    s_mov_b32 s35, 131072
    s_add_u32 s36, s10, 20971520
    s_addc_u32 s37, s11, 0
    s_mov_b32 s38, 16384
    s_mov_b32 s39, 131072
    s_mov_b32 s40, s6
    s_mov_b32 s41, s7
    s_mov_b32 s42, 2048
    s_mov_b32 s43, 131072
    s_mov_b32 s44, s8
    s_mov_b32 s45, s9
    s_mov_b32 s46, 8388608
    s_mov_b32 s47, 131072
    s_mov_b32 s26, 0xffff0000
    v_lshrrev_b32 v5, 4, v1
    v_and_b32 v6, 15, v1
    v_lshlrev_b32 v7, 2, v5
    v_xor_b32 v6, v6, v7
    v_lshlrev_b32 v6, 4, v6
    v_lshl_add_u32 v116, v5, 11, v6
    s_lshl_b32 s27, s13, 17
    s_lshl_b32 s3, s12, 15
    s_add_u32 s27, s27, s3
    s_lshl_b32 s3, s14, 8
    s_add_u32 s27, s27, s3
    v_lshrrev_b32 v5, 4, v1
    v_and_b32 v6, 7, v1
    v_xor_b32 v6, v6, v5
    v_lshlrev_b32 v6, 4, v6
    v_lshrrev_b32 v5, 3, v1
    v_lshl_add_u32 v117, v5, 12, v6
    v_lshrrev_b32 v5, 4, v1
    v_add_u32 v5, 4, v5
    v_and_b32 v6, 7, v1
    v_xor_b32 v6, v6, v5
    v_lshlrev_b32 v6, 4, v6
    v_lshrrev_b32 v5, 3, v1
    v_lshl_add_u32 v118, v5, 12, v6
    s_lshl_b32 s48, s14, 19
    s_lshl_b32 s3, s12, 17
    s_add_u32 s48, s48, s3
    s_lshl_b32 s3, s13, 7
    s_add_u32 s48, s48, s3
    v_bfe_u32 v120, v1, 2, 2
    v_bfe_u32 v5, v1, 4, 1
    v_lshlrev_b32 v5, 1, v5
    v_bfe_u32 v6, v1, 1, 1
    v_add_u32 v5, v5, v6
    s_lshl_b32 s3, s12, 2
    v_add_u32 v5, s3, v5
    v_lshlrev_b32 v6, 2, v120
    v_xor_b32 v5, v5, v6
    v_lshlrev_b32 v5, 4, v5
    v_and_b32 v6, 1, v1
    v_lshl_add_u32 v5, v6, 3, v5
    v_lshrrev_b32 v6, 5, v1
    v_lshl_add_u32 v120, v6, 2, v120
    v_lshl_add_u32 v5, v120, 8, v5
    v_add_u32 v119, 65536, v5
    v_and_b32 v5, 31, v1
    v_bfe_u32 v7, v5, 1, 3
    v_lshlrev_b32 v7, 4, v7
    v_lshl_add_u32 v7, v5, 7, v7
    v_lshrrev_b32 v6, 5, v1
    v_lshl_add_u32 v7, v6, 3, v7
    s_lshl_b32 s3, s12, 12
    s_add_u32 s3, s3, 81920
    v_add_u32 v121, s3, v7
    v_lshlrev_b32 v6, 4, v6
    s_lshl_b32 s3, s13, 8
    v_add_u32 v122, s3, v6
    v_and_b32 v5, 31, v1
    s_lshl_b32 s3, s14, 7
    v_add_u32 v5, s3, v5
    s_lshl_b32 s3, s12, 5
    v_add_u32 v5, s3, v5
    v_lshlrev_b32 v123, 1, v5
    v_lshrrev_b32 v6, 5, v1
    v_lshlrev_b32 v6, 14, v6
    v_lshl_add_u32 v124, v5, 2, v6
    s_lshl_b32 s49, s13, 18
    s_lshl_b32 s50, s12, 12
    s_add_u32 m0, s50, 65536
    s_nop 0
    buffer_load_dwordx4 v116, s[28:31], s27 offen lds
    s_add_u32 s27, s27, 8192
    s_add_u32 m0, s50, 66560
    s_nop 0
    buffer_load_dwordx4 v116, s[28:31], s27 offen lds
    s_add_u32 s27, s27, 8192
    s_add_u32 m0, s50, 67584
    s_nop 0
    buffer_load_dwordx4 v116, s[28:31], s27 offen lds
    s_add_u32 s27, s27, 8192
    s_add_u32 m0, s50, 68608
    s_nop 0
    buffer_load_dwordx4 v116, s[28:31], s27 offen lds
    s_lshl_b32 s50, s12, 12
    s_add_u32 m0, s50, 81920
    s_nop 0
    buffer_load_dwordx4 v117, s[32:35], s48 offen lds
    s_add_u32 s48, s48, 32768
    s_add_u32 m0, s50, 82944
    s_nop 0
    buffer_load_dwordx4 v118, s[32:35], s48 offen lds
    s_add_u32 s48, s48, 32768
    s_add_u32 m0, s50, 83968
    s_nop 0
    buffer_load_dwordx4 v117, s[32:35], s48 offen lds
    s_add_u32 s48, s48, 32768
    s_add_u32 m0, s50, 84992
    s_nop 0
    buffer_load_dwordx4 v118, s[32:35], s48 offen lds
    buffer_load_ushort v5, v123, s[40:43], 0 offen
    buffer_load_dwordx4 v[126:129], v122, s[36:39], 0 offen offset:0
    s_nop 0
    buffer_load_dwordx4 v[130:133], v122, s[36:39], 0 offen offset:32
    s_nop 0
    buffer_load_dwordx4 v[134:137], v122, s[36:39], 0 offen offset:64
    s_nop 0
    buffer_load_dwordx4 v[138:141], v122, s[36:39], 0 offen offset:96
    s_nop 0
    buffer_load_dwordx4 v[142:145], v122, s[36:39], 0 offen offset:128
    s_nop 0
    buffer_load_dwordx4 v[146:149], v122, s[36:39], 0 offen offset:160
    s_nop 0
    buffer_load_dwordx4 v[150:153], v122, s[36:39], 0 offen offset:192
    s_nop 0
    buffer_load_dwordx4 v[154:157], v122, s[36:39], 0 offen offset:224
    s_nop 0
    v_add_u32 v120, 8192, v122
    buffer_load_dwordx4 v[158:161], v120, s[36:39], 0 offen offset:0
    buffer_load_dwordx4 v[162:165], v120, s[36:39], 0 offen offset:32
    buffer_load_dwordx4 v[166:169], v120, s[36:39], 0 offen offset:64
    buffer_load_dwordx4 v[170:173], v120, s[36:39], 0 offen offset:96
    buffer_load_dwordx4 v[174:177], v120, s[36:39], 0 offen offset:128
    buffer_load_dwordx4 v[178:181], v120, s[36:39], 0 offen offset:160
    buffer_load_dwordx4 v[182:185], v120, s[36:39], 0 offen offset:192
    buffer_load_dwordx4 v[186:189], v120, s[36:39], 0 offen offset:224
    s_waitcnt vmcnt(47)
    s_barrier
    ds_read_b128 v[12:15], v8 offset:0
    ds_read_b128 v[16:19], v8 offset:4096
    s_waitcnt vmcnt(38) lgkmcnt(1)
    v_mfma_f32_32x32x16_bf16 v[28:43], v[12:15], v[60:63], 0
    ds_read_b128 v[20:23], v9 offset:0
    ds_read_b128 v[24:27], v9 offset:4096
    s_mov_b32 s24, 768
    s_add_u32 m0, s25, 49152
    s_waitcnt lgkmcnt(2)
    v_mfma_f32_32x32x16_bf16 v[44:59], v[16:19], v[60:63], 0
    buffer_load_dwordx4 v3, s[16:19], s24 offen offset:0 lds
    s_mov_b32 s15, 12288
    buffer_load_dwordx4 v[60:63], v2, s[20:23], s15 offen offset:2048
    s_waitcnt vmcnt(39) lgkmcnt(1)
    v_mfma_f32_32x32x16_bf16 v[28:43], v[20:23], v[64:67], v[28:43]
    ds_read_b128 v[12:15], v10 offset:0
    ds_read_b128 v[16:19], v10 offset:4096
    s_add_u32 m0, s25, 50176
    s_waitcnt lgkmcnt(2)
    v_mfma_f32_32x32x16_bf16 v[44:59], v[24:27], v[64:67], v[44:59]
    buffer_load_dwordx4 v4, s[16:19], s24 offen offset:0 lds
    s_mov_b32 s15, 12288
    buffer_load_dwordx4 v[64:67], v2, s[20:23], s15 offen offset:3072
    s_waitcnt vmcnt(40) lgkmcnt(1)
    v_mfma_f32_32x32x16_bf16 v[28:43], v[12:15], v[68:71], v[28:43]
    ds_read_b128 v[20:23], v11 offset:0
    ds_read_b128 v[24:27], v11 offset:4096
    s_add_u32 m0, s25, 57216
    s_waitcnt lgkmcnt(2)
    v_mfma_f32_32x32x16_bf16 v[44:59], v[16:19], v[68:71], v[44:59]
    buffer_load_dwordx4 v3, s[16:19], s24 offen offset:128 lds
    s_mov_b32 s15, 16384
    buffer_load_dwordx4 v[68:71], v2, s[20:23], s15 offen offset:0
    s_waitcnt vmcnt(41) lgkmcnt(1)
    v_mfma_f32_32x32x16_bf16 v[28:43], v[20:23], v[72:75], v[28:43]
    ds_read_b128 v[12:15], v8 offset:8192
    ds_read_b128 v[16:19], v8 offset:12288
    s_add_u32 m0, s25, 58240
    s_waitcnt lgkmcnt(2)
    v_mfma_f32_32x32x16_bf16 v[44:59], v[24:27], v[72:75], v[44:59]
    buffer_load_dwordx4 v4, s[16:19], s24 offen offset:128 lds
    s_mov_b32 s15, 16384
    buffer_load_dwordx4 v[72:75], v2, s[20:23], s15 offen offset:1024
    s_waitcnt vmcnt(42) lgkmcnt(1)
    v_mfma_f32_32x32x16_bf16 v[28:43], v[12:15], v[76:79], v[28:43]
    ds_read_b128 v[20:23], v9 offset:8192
    ds_read_b128 v[24:27], v9 offset:12288
    s_waitcnt lgkmcnt(2)
    v_mfma_f32_32x32x16_bf16 v[44:59], v[16:19], v[76:79], v[44:59]
    s_mov_b32 s15, 16384
    buffer_load_dwordx4 v[76:79], v2, s[20:23], s15 offen offset:2048
    s_waitcnt vmcnt(42) lgkmcnt(1)
    v_mfma_f32_32x32x16_bf16 v[28:43], v[20:23], v[80:83], v[28:43]
    ds_read_b128 v[12:15], v10 offset:8192
    ds_read_b128 v[16:19], v10 offset:12288
    s_waitcnt lgkmcnt(2)
    v_mfma_f32_32x32x16_bf16 v[44:59], v[24:27], v[80:83], v[44:59]
    s_mov_b32 s15, 16384
    buffer_load_dwordx4 v[80:83], v2, s[20:23], s15 offen offset:3072
    s_waitcnt vmcnt(42) lgkmcnt(1)
    v_mfma_f32_32x32x16_bf16 v[28:43], v[12:15], v[84:87], v[28:43]
    ds_read_b128 v[20:23], v11 offset:8192
    ds_read_b128 v[24:27], v11 offset:12288
    s_waitcnt lgkmcnt(2)
    v_mfma_f32_32x32x16_bf16 v[44:59], v[16:19], v[84:87], v[44:59]
    s_mov_b32 s15, 20480
    buffer_load_dwordx4 v[84:87], v2, s[20:23], s15 offen offset:0
    s_waitcnt lgkmcnt(0)
    s_barrier
    s_waitcnt vmcnt(42)
    v_mfma_f32_32x32x16_bf16 v[28:43], v[20:23], v[88:91], v[28:43]
    ds_read_b128 v[12:15], v8 offset:16384
    ds_read_b128 v[16:19], v8 offset:20480
    s_mov_b32 s24, 1024
    s_add_u32 m0, s25, 0
    v_mfma_f32_32x32x16_bf16 v[44:59], v[24:27], v[88:91], v[44:59]
    buffer_load_dwordx4 v3, s[16:19], s24 offen offset:0 lds
    s_mov_b32 s15, 20480
    buffer_load_dwordx4 v[88:91], v2, s[20:23], s15 offen offset:1024
    s_waitcnt vmcnt(43) lgkmcnt(1)
    v_mfma_f32_32x32x16_bf16 v[28:43], v[12:15], v[92:95], v[28:43]
    ds_read_b128 v[20:23], v9 offset:16384
    ds_read_b128 v[24:27], v9 offset:20480
    s_add_u32 m0, s25, 1024
    s_waitcnt lgkmcnt(2)
    v_mfma_f32_32x32x16_bf16 v[44:59], v[16:19], v[92:95], v[44:59]
    buffer_load_dwordx4 v4, s[16:19], s24 offen offset:0 lds
    s_mov_b32 s15, 20480
    buffer_load_dwordx4 v[92:95], v2, s[20:23], s15 offen offset:2048
    s_waitcnt vmcnt(44) lgkmcnt(1)
    v_mfma_f32_32x32x16_bf16 v[28:43], v[20:23], v[96:99], v[28:43]
    ds_read_b128 v[12:15], v10 offset:16384
    ds_read_b128 v[16:19], v10 offset:20480
    s_add_u32 m0, s25, 8064
    s_waitcnt lgkmcnt(2)
    v_mfma_f32_32x32x16_bf16 v[44:59], v[24:27], v[96:99], v[44:59]
    buffer_load_dwordx4 v3, s[16:19], s24 offen offset:128 lds
    s_mov_b32 s15, 20480
    buffer_load_dwordx4 v[96:99], v2, s[20:23], s15 offen offset:3072
    s_waitcnt vmcnt(45) lgkmcnt(1)
    v_mfma_f32_32x32x16_bf16 v[28:43], v[12:15], v[100:103], v[28:43]
    ds_read_b128 v[20:23], v11 offset:16384
    ds_read_b128 v[24:27], v11 offset:20480
    s_add_u32 m0, s25, 9088
    s_waitcnt lgkmcnt(2)
    v_mfma_f32_32x32x16_bf16 v[44:59], v[16:19], v[100:103], v[44:59]
    buffer_load_dwordx4 v4, s[16:19], s24 offen offset:128 lds
    s_mov_b32 s15, 24576
    buffer_load_dwordx4 v[100:103], v2, s[20:23], s15 offen offset:0
    s_waitcnt vmcnt(46) lgkmcnt(1)
    v_mfma_f32_32x32x16_bf16 v[28:43], v[20:23], v[104:107], v[28:43]
    ds_read_b128 v[12:15], v8 offset:24576
    ds_read_b128 v[16:19], v8 offset:28672
    s_waitcnt lgkmcnt(2)
    v_mfma_f32_32x32x16_bf16 v[44:59], v[24:27], v[104:107], v[44:59]
    s_mov_b32 s15, 24576
    buffer_load_dwordx4 v[104:107], v2, s[20:23], s15 offen offset:1024
    s_waitcnt vmcnt(46) lgkmcnt(1)
    v_mfma_f32_32x32x16_bf16 v[28:43], v[12:15], v[108:111], v[28:43]
    ds_read_b128 v[20:23], v9 offset:24576
    ds_read_b128 v[24:27], v9 offset:28672
    s_waitcnt lgkmcnt(2)
    v_mfma_f32_32x32x16_bf16 v[44:59], v[16:19], v[108:111], v[44:59]
    s_mov_b32 s15, 24576
    buffer_load_dwordx4 v[108:111], v2, s[20:23], s15 offen offset:2048
    s_waitcnt vmcnt(46) lgkmcnt(1)
    v_mfma_f32_32x32x16_bf16 v[28:43], v[20:23], v[112:115], v[28:43]
    ds_read_b128 v[12:15], v10 offset:24576
    ds_read_b128 v[16:19], v10 offset:28672
    s_waitcnt lgkmcnt(2)
    v_mfma_f32_32x32x16_bf16 v[44:59], v[24:27], v[112:115], v[44:59]
    s_mov_b32 s15, 24576
    buffer_load_dwordx4 v[112:115], v2, s[20:23], s15 offen offset:3072
    s_waitcnt vmcnt(20) lgkmcnt(1)
    v_mfma_f32_32x32x16_bf16 v[28:43], v[12:15], v[60:63], v[28:43]
    ds_read_b128 v[20:23], v11 offset:24576
    ds_read_b128 v[24:27], v11 offset:28672
    s_waitcnt lgkmcnt(2)
    v_mfma_f32_32x32x16_bf16 v[44:59], v[16:19], v[60:63], v[44:59]
    s_mov_b32 s15, 28672
    buffer_load_dwordx4 v[60:63], v2, s[20:23], s15 offen offset:0
    s_waitcnt lgkmcnt(0)
    s_barrier
    s_waitcnt vmcnt(19)
    v_mfma_f32_32x32x16_bf16 v[28:43], v[20:23], v[64:67], v[28:43]
    ds_read_b128 v[12:15], v8 offset:32768
    ds_read_b128 v[16:19], v8 offset:36864
    s_mov_b32 s24, 1280
    s_add_u32 m0, s25, 16384
    v_mfma_f32_32x32x16_bf16 v[44:59], v[24:27], v[64:67], v[44:59]
    buffer_load_dwordx4 v3, s[16:19], s24 offen offset:0 lds
    s_mov_b32 s15, 28672
    buffer_load_dwordx4 v[64:67], v2, s[20:23], s15 offen offset:1024
    s_waitcnt vmcnt(19) lgkmcnt(1)
    v_mfma_f32_32x32x16_bf16 v[28:43], v[12:15], v[68:71], v[28:43]
    ds_read_b128 v[20:23], v9 offset:32768
    ds_read_b128 v[24:27], v9 offset:36864
    s_add_u32 m0, s25, 17408
    s_waitcnt lgkmcnt(2)
    v_mfma_f32_32x32x16_bf16 v[44:59], v[16:19], v[68:71], v[44:59]
    buffer_load_dwordx4 v4, s[16:19], s24 offen offset:0 lds
    s_mov_b32 s15, 28672
    buffer_load_dwordx4 v[68:71], v2, s[20:23], s15 offen offset:2048
    s_waitcnt vmcnt(19) lgkmcnt(1)
    v_mfma_f32_32x32x16_bf16 v[28:43], v[20:23], v[72:75], v[28:43]
    ds_read_b128 v[12:15], v10 offset:32768
    ds_read_b128 v[16:19], v10 offset:36864
    s_add_u32 m0, s25, 24448
    s_waitcnt lgkmcnt(2)
    v_mfma_f32_32x32x16_bf16 v[44:59], v[24:27], v[72:75], v[44:59]
    buffer_load_dwordx4 v3, s[16:19], s24 offen offset:128 lds
    s_mov_b32 s15, 28672
    buffer_load_dwordx4 v[72:75], v2, s[20:23], s15 offen offset:3072
    s_waitcnt vmcnt(20) lgkmcnt(1)
    v_mfma_f32_32x32x16_bf16 v[28:43], v[12:15], v[76:79], v[28:43]
    ds_read_b128 v[20:23], v11 offset:32768
    ds_read_b128 v[24:27], v11 offset:36864
    s_add_u32 m0, s25, 25472
    s_waitcnt lgkmcnt(2)
    v_mfma_f32_32x32x16_bf16 v[44:59], v[16:19], v[76:79], v[44:59]
    buffer_load_dwordx4 v4, s[16:19], s24 offen offset:128 lds
    s_mov_b32 s15, 32768
    buffer_load_dwordx4 v[76:79], v2, s[20:23], s15 offen offset:0
    s_waitcnt vmcnt(21) lgkmcnt(1)
    v_mfma_f32_32x32x16_bf16 v[28:43], v[20:23], v[80:83], v[28:43]
    ds_read_b128 v[12:15], v8 offset:40960
    ds_read_b128 v[16:19], v8 offset:45056
    s_waitcnt lgkmcnt(2)
    v_mfma_f32_32x32x16_bf16 v[44:59], v[24:27], v[80:83], v[44:59]
    s_mov_b32 s15, 32768
    buffer_load_dwordx4 v[80:83], v2, s[20:23], s15 offen offset:1024
    s_waitcnt vmcnt(21) lgkmcnt(1)
    v_mfma_f32_32x32x16_bf16 v[28:43], v[12:15], v[84:87], v[28:43]
    ds_read_b128 v[20:23], v9 offset:40960
    ds_read_b128 v[24:27], v9 offset:45056
    s_waitcnt lgkmcnt(2)
    v_mfma_f32_32x32x16_bf16 v[44:59], v[16:19], v[84:87], v[44:59]
    s_mov_b32 s15, 32768
    buffer_load_dwordx4 v[84:87], v2, s[20:23], s15 offen offset:2048
    s_waitcnt vmcnt(20) lgkmcnt(1)
    v_mfma_f32_32x32x16_bf16 v[28:43], v[20:23], v[88:91], v[28:43]
    ds_read_b128 v[12:15], v10 offset:40960
    ds_read_b128 v[16:19], v10 offset:45056
    s_waitcnt lgkmcnt(2)
    v_mfma_f32_32x32x16_bf16 v[44:59], v[24:27], v[88:91], v[44:59]
    s_mov_b32 s15, 32768
    buffer_load_dwordx4 v[88:91], v2, s[20:23], s15 offen offset:3072
    s_waitcnt vmcnt(19) lgkmcnt(1)
    v_mfma_f32_32x32x16_bf16 v[28:43], v[12:15], v[92:95], v[28:43]
    ds_read_b128 v[20:23], v11 offset:40960
    ds_read_b128 v[24:27], v11 offset:45056
    s_waitcnt lgkmcnt(2)
    v_mfma_f32_32x32x16_bf16 v[44:59], v[16:19], v[92:95], v[44:59]
    s_mov_b32 s15, 36864
    buffer_load_dwordx4 v[92:95], v2, s[20:23], s15 offen offset:0
    s_waitcnt lgkmcnt(0)
    s_barrier
    s_waitcnt vmcnt(18)
    v_mfma_f32_32x32x16_bf16 v[28:43], v[20:23], v[96:99], v[28:43]
    ds_read_b128 v[12:15], v8 offset:49152
    ds_read_b128 v[16:19], v8 offset:53248
    s_mov_b32 s24, 1536
    s_add_u32 m0, s25, 32768
    v_mfma_f32_32x32x16_bf16 v[44:59], v[24:27], v[96:99], v[44:59]
    buffer_load_dwordx4 v3, s[16:19], s24 offen offset:0 lds
    s_mov_b32 s15, 36864
    buffer_load_dwordx4 v[96:99], v2, s[20:23], s15 offen offset:1024
    s_waitcnt vmcnt(18) lgkmcnt(1)
    v_mfma_f32_32x32x16_bf16 v[28:43], v[12:15], v[100:103], v[28:43]
    ds_read_b128 v[20:23], v9 offset:49152
    ds_read_b128 v[24:27], v9 offset:53248
    s_add_u32 m0, s25, 33792
    s_waitcnt lgkmcnt(2)
    v_mfma_f32_32x32x16_bf16 v[44:59], v[16:19], v[100:103], v[44:59]
    buffer_load_dwordx4 v4, s[16:19], s24 offen offset:0 lds
    s_mov_b32 s15, 36864
    buffer_load_dwordx4 v[100:103], v2, s[20:23], s15 offen offset:2048
    s_waitcnt vmcnt(19) lgkmcnt(1)
    v_mfma_f32_32x32x16_bf16 v[28:43], v[20:23], v[104:107], v[28:43]
    ds_read_b128 v[12:15], v10 offset:49152
    ds_read_b128 v[16:19], v10 offset:53248
    s_add_u32 m0, s25, 40832
    s_waitcnt lgkmcnt(2)
    v_mfma_f32_32x32x16_bf16 v[44:59], v[24:27], v[104:107], v[44:59]
    buffer_load_dwordx4 v3, s[16:19], s24 offen offset:128 lds
    s_mov_b32 s15, 36864
    buffer_load_dwordx4 v[104:107], v2, s[20:23], s15 offen offset:3072
    s_waitcnt vmcnt(20) lgkmcnt(1)
    v_mfma_f32_32x32x16_bf16 v[28:43], v[12:15], v[108:111], v[28:43]
    ds_read_b128 v[20:23], v11 offset:49152
    ds_read_b128 v[24:27], v11 offset:53248
    s_add_u32 m0, s25, 41856
    s_waitcnt lgkmcnt(2)
    v_mfma_f32_32x32x16_bf16 v[44:59], v[16:19], v[108:111], v[44:59]
    buffer_load_dwordx4 v4, s[16:19], s24 offen offset:128 lds
    s_mov_b32 s15, 40960
    buffer_load_dwordx4 v[108:111], v2, s[20:23], s15 offen offset:0
    s_waitcnt vmcnt(21) lgkmcnt(1)
    v_mfma_f32_32x32x16_bf16 v[28:43], v[20:23], v[112:115], v[28:43]
    ds_read_b128 v[12:15], v8 offset:57344
    ds_read_b128 v[16:19], v8 offset:61440
    s_waitcnt lgkmcnt(2)
    v_mfma_f32_32x32x16_bf16 v[44:59], v[24:27], v[112:115], v[44:59]
    s_mov_b32 s15, 40960
    buffer_load_dwordx4 v[112:115], v2, s[20:23], s15 offen offset:1024
    s_waitcnt vmcnt(21) lgkmcnt(1)
    v_mfma_f32_32x32x16_bf16 v[28:43], v[12:15], v[60:63], v[28:43]
    ds_read_b128 v[20:23], v9 offset:57344
    ds_read_b128 v[24:27], v9 offset:61440
    s_waitcnt lgkmcnt(2)
    v_mfma_f32_32x32x16_bf16 v[44:59], v[16:19], v[60:63], v[44:59]
    s_mov_b32 s15, 40960
    buffer_load_dwordx4 v[60:63], v2, s[20:23], s15 offen offset:2048
    s_waitcnt vmcnt(20) lgkmcnt(1)
    v_mfma_f32_32x32x16_bf16 v[28:43], v[20:23], v[64:67], v[28:43]
    ds_read_b128 v[12:15], v10 offset:57344
    ds_read_b128 v[16:19], v10 offset:61440
    s_waitcnt lgkmcnt(2)
    v_mfma_f32_32x32x16_bf16 v[44:59], v[24:27], v[64:67], v[44:59]
    s_mov_b32 s15, 40960
    buffer_load_dwordx4 v[64:67], v2, s[20:23], s15 offen offset:3072
    s_waitcnt vmcnt(19) lgkmcnt(1)
    v_mfma_f32_32x32x16_bf16 v[28:43], v[12:15], v[68:71], v[28:43]
    ds_read_b128 v[20:23], v11 offset:57344
    ds_read_b128 v[24:27], v11 offset:61440
    s_waitcnt lgkmcnt(2)
    v_mfma_f32_32x32x16_bf16 v[44:59], v[16:19], v[68:71], v[44:59]
    s_mov_b32 s15, 45056
    buffer_load_dwordx4 v[68:71], v2, s[20:23], s15 offen offset:0
    s_waitcnt lgkmcnt(0)
    s_barrier
    s_waitcnt vmcnt(18)
    v_mfma_f32_32x32x16_bf16 v[28:43], v[20:23], v[72:75], v[28:43]
    ds_read_b128 v[12:15], v8 offset:0
    ds_read_b128 v[16:19], v8 offset:4096
    s_mov_b32 s24, 1792
    s_add_u32 m0, s25, 49152
    v_mfma_f32_32x32x16_bf16 v[44:59], v[24:27], v[72:75], v[44:59]
    buffer_load_dwordx4 v3, s[16:19], s24 offen offset:0 lds
    s_mov_b32 s15, 45056
    buffer_load_dwordx4 v[72:75], v2, s[20:23], s15 offen offset:1024
    s_waitcnt vmcnt(18) lgkmcnt(1)
    v_mfma_f32_32x32x16_bf16 v[28:43], v[12:15], v[76:79], v[28:43]
    ds_read_b128 v[20:23], v9 offset:0
    ds_read_b128 v[24:27], v9 offset:4096
    s_add_u32 m0, s25, 50176
    s_waitcnt lgkmcnt(2)
    v_mfma_f32_32x32x16_bf16 v[44:59], v[16:19], v[76:79], v[44:59]
    buffer_load_dwordx4 v4, s[16:19], s24 offen offset:0 lds
    s_mov_b32 s15, 45056
    buffer_load_dwordx4 v[76:79], v2, s[20:23], s15 offen offset:2048
    s_waitcnt vmcnt(19) lgkmcnt(1)
    v_mfma_f32_32x32x16_bf16 v[28:43], v[20:23], v[80:83], v[28:43]
    ds_read_b128 v[12:15], v10 offset:0
    ds_read_b128 v[16:19], v10 offset:4096
    s_add_u32 m0, s25, 57216
    s_waitcnt lgkmcnt(2)
    v_mfma_f32_32x32x16_bf16 v[44:59], v[24:27], v[80:83], v[44:59]
    buffer_load_dwordx4 v3, s[16:19], s24 offen offset:128 lds
    s_mov_b32 s15, 45056
    buffer_load_dwordx4 v[80:83], v2, s[20:23], s15 offen offset:3072
    s_waitcnt vmcnt(20) lgkmcnt(1)
    v_mfma_f32_32x32x16_bf16 v[28:43], v[12:15], v[84:87], v[28:43]
    ds_read_b128 v[20:23], v11 offset:0
    ds_read_b128 v[24:27], v11 offset:4096
    s_add_u32 m0, s25, 58240
    s_waitcnt lgkmcnt(2)
    v_mfma_f32_32x32x16_bf16 v[44:59], v[16:19], v[84:87], v[44:59]
    buffer_load_dwordx4 v4, s[16:19], s24 offen offset:128 lds
    s_mov_b32 s15, 49152
    buffer_load_dwordx4 v[84:87], v2, s[20:23], s15 offen offset:0
    s_waitcnt vmcnt(21) lgkmcnt(1)
    v_mfma_f32_32x32x16_bf16 v[28:43], v[20:23], v[88:91], v[28:43]
    ds_read_b128 v[12:15], v8 offset:8192
    ds_read_b128 v[16:19], v8 offset:12288
    s_waitcnt lgkmcnt(2)
    v_mfma_f32_32x32x16_bf16 v[44:59], v[24:27], v[88:91], v[44:59]
    s_mov_b32 s15, 49152
    buffer_load_dwordx4 v[88:91], v2, s[20:23], s15 offen offset:1024
    s_waitcnt vmcnt(21) lgkmcnt(1)
    v_mfma_f32_32x32x16_bf16 v[28:43], v[12:15], v[92:95], v[28:43]
    ds_read_b128 v[20:23], v9 offset:8192
    ds_read_b128 v[24:27], v9 offset:12288
    s_waitcnt lgkmcnt(2)
    v_mfma_f32_32x32x16_bf16 v[44:59], v[16:19], v[92:95], v[44:59]
    s_mov_b32 s15, 49152
    buffer_load_dwordx4 v[92:95], v2, s[20:23], s15 offen offset:2048
    s_waitcnt vmcnt(20) lgkmcnt(1)
    v_mfma_f32_32x32x16_bf16 v[28:43], v[20:23], v[96:99], v[28:43]
    ds_read_b128 v[12:15], v10 offset:8192
    ds_read_b128 v[16:19], v10 offset:12288
    s_waitcnt lgkmcnt(2)
    v_mfma_f32_32x32x16_bf16 v[44:59], v[24:27], v[96:99], v[44:59]
    s_mov_b32 s15, 49152
    buffer_load_dwordx4 v[96:99], v2, s[20:23], s15 offen offset:3072
    s_waitcnt vmcnt(19) lgkmcnt(1)
    v_mfma_f32_32x32x16_bf16 v[28:43], v[12:15], v[100:103], v[28:43]
    ds_read_b128 v[20:23], v11 offset:8192
    ds_read_b128 v[24:27], v11 offset:12288
    s_waitcnt lgkmcnt(2)
    v_mfma_f32_32x32x16_bf16 v[44:59], v[16:19], v[100:103], v[44:59]
    s_mov_b32 s15, 53248
    buffer_load_dwordx4 v[100:103], v2, s[20:23], s15 offen offset:0
    s_waitcnt lgkmcnt(0)
    s_barrier
    s_waitcnt vmcnt(18)
    v_mfma_f32_32x32x16_bf16 v[28:43], v[20:23], v[104:107], v[28:43]
    ds_read_b128 v[12:15], v8 offset:16384
    ds_read_b128 v[16:19], v8 offset:20480
    s_mov_b32 s24, 2048
    s_add_u32 m0, s25, 0
    v_mfma_f32_32x32x16_bf16 v[44:59], v[24:27], v[104:107], v[44:59]
    buffer_load_dwordx4 v3, s[16:19], s24 offen offset:0 lds
    s_mov_b32 s15, 53248
    buffer_load_dwordx4 v[104:107], v2, s[20:23], s15 offen offset:1024
    s_waitcnt vmcnt(18) lgkmcnt(1)
    v_mfma_f32_32x32x16_bf16 v[28:43], v[12:15], v[108:111], v[28:43]
    ds_read_b128 v[20:23], v9 offset:16384
    ds_read_b128 v[24:27], v9 offset:20480
    s_add_u32 m0, s25, 1024
    s_waitcnt lgkmcnt(2)
    v_mfma_f32_32x32x16_bf16 v[44:59], v[16:19], v[108:111], v[44:59]
    buffer_load_dwordx4 v4, s[16:19], s24 offen offset:0 lds
    s_mov_b32 s15, 53248
    buffer_load_dwordx4 v[108:111], v2, s[20:23], s15 offen offset:2048
    s_waitcnt vmcnt(19) lgkmcnt(1)
    v_mfma_f32_32x32x16_bf16 v[28:43], v[20:23], v[112:115], v[28:43]
    ds_read_b128 v[12:15], v10 offset:16384
    ds_read_b128 v[16:19], v10 offset:20480
    s_add_u32 m0, s25, 8064
    s_waitcnt lgkmcnt(2)
    v_mfma_f32_32x32x16_bf16 v[44:59], v[24:27], v[112:115], v[44:59]
    buffer_load_dwordx4 v3, s[16:19], s24 offen offset:128 lds
    s_mov_b32 s15, 53248
    buffer_load_dwordx4 v[112:115], v2, s[20:23], s15 offen offset:3072
    s_waitcnt vmcnt(20) lgkmcnt(1)
    v_mfma_f32_32x32x16_bf16 v[28:43], v[12:15], v[60:63], v[28:43]
    ds_read_b128 v[20:23], v11 offset:16384
    ds_read_b128 v[24:27], v11 offset:20480
    s_add_u32 m0, s25, 9088
    s_waitcnt lgkmcnt(2)
    v_mfma_f32_32x32x16_bf16 v[44:59], v[16:19], v[60:63], v[44:59]
    buffer_load_dwordx4 v4, s[16:19], s24 offen offset:128 lds
    s_mov_b32 s15, 57344
    buffer_load_dwordx4 v[60:63], v2, s[20:23], s15 offen offset:0
    s_waitcnt vmcnt(21) lgkmcnt(1)
    v_mfma_f32_32x32x16_bf16 v[28:43], v[20:23], v[64:67], v[28:43]
    ds_read_b128 v[12:15], v8 offset:24576
    ds_read_b128 v[16:19], v8 offset:28672
    s_waitcnt lgkmcnt(2)
    v_mfma_f32_32x32x16_bf16 v[44:59], v[24:27], v[64:67], v[44:59]
    s_mov_b32 s15, 57344
    buffer_load_dwordx4 v[64:67], v2, s[20:23], s15 offen offset:1024
    s_waitcnt vmcnt(21) lgkmcnt(1)
    v_mfma_f32_32x32x16_bf16 v[28:43], v[12:15], v[68:71], v[28:43]
    ds_read_b128 v[20:23], v9 offset:24576
    ds_read_b128 v[24:27], v9 offset:28672
    s_waitcnt lgkmcnt(2)
    v_mfma_f32_32x32x16_bf16 v[44:59], v[16:19], v[68:71], v[44:59]
    s_mov_b32 s15, 57344
    buffer_load_dwordx4 v[68:71], v2, s[20:23], s15 offen offset:2048
    s_waitcnt vmcnt(20) lgkmcnt(1)
    v_mfma_f32_32x32x16_bf16 v[28:43], v[20:23], v[72:75], v[28:43]
    ds_read_b128 v[12:15], v10 offset:24576
    ds_read_b128 v[16:19], v10 offset:28672
    s_waitcnt lgkmcnt(2)
    v_mfma_f32_32x32x16_bf16 v[44:59], v[24:27], v[72:75], v[44:59]
    s_mov_b32 s15, 57344
    buffer_load_dwordx4 v[72:75], v2, s[20:23], s15 offen offset:3072
    s_waitcnt vmcnt(19) lgkmcnt(1)
    v_mfma_f32_32x32x16_bf16 v[28:43], v[12:15], v[76:79], v[28:43]
    ds_read_b128 v[20:23], v11 offset:24576
    ds_read_b128 v[24:27], v11 offset:28672
    s_waitcnt lgkmcnt(2)
    v_mfma_f32_32x32x16_bf16 v[44:59], v[16:19], v[76:79], v[44:59]
    s_mov_b32 s15, 61440
    buffer_load_dwordx4 v[76:79], v2, s[20:23], s15 offen offset:0
    s_waitcnt lgkmcnt(0)
    s_barrier
    s_waitcnt vmcnt(18)
    v_mfma_f32_32x32x16_bf16 v[28:43], v[20:23], v[80:83], v[28:43]
    ds_read_b128 v[12:15], v8 offset:32768
    ds_read_b128 v[16:19], v8 offset:36864
    s_mov_b32 s24, 2304
    s_add_u32 m0, s25, 16384
    v_mfma_f32_32x32x16_bf16 v[44:59], v[24:27], v[80:83], v[44:59]
    buffer_load_dwordx4 v3, s[16:19], s24 offen offset:0 lds
    s_mov_b32 s15, 61440
    buffer_load_dwordx4 v[80:83], v2, s[20:23], s15 offen offset:1024
    s_waitcnt vmcnt(18) lgkmcnt(1)
    v_mfma_f32_32x32x16_bf16 v[28:43], v[12:15], v[84:87], v[28:43]
    ds_read_b128 v[20:23], v9 offset:32768
    ds_read_b128 v[24:27], v9 offset:36864
    s_add_u32 m0, s25, 17408
    s_waitcnt lgkmcnt(2)
    v_mfma_f32_32x32x16_bf16 v[44:59], v[16:19], v[84:87], v[44:59]
    buffer_load_dwordx4 v4, s[16:19], s24 offen offset:0 lds
    s_mov_b32 s15, 61440
    buffer_load_dwordx4 v[84:87], v2, s[20:23], s15 offen offset:2048
    s_waitcnt vmcnt(19) lgkmcnt(1)
    v_mfma_f32_32x32x16_bf16 v[28:43], v[20:23], v[88:91], v[28:43]
    ds_read_b128 v[12:15], v10 offset:32768
    ds_read_b128 v[16:19], v10 offset:36864
    s_add_u32 m0, s25, 24448
    s_waitcnt lgkmcnt(2)
    v_mfma_f32_32x32x16_bf16 v[44:59], v[24:27], v[88:91], v[44:59]
    buffer_load_dwordx4 v3, s[16:19], s24 offen offset:128 lds
    s_mov_b32 s15, 61440
    buffer_load_dwordx4 v[88:91], v2, s[20:23], s15 offen offset:3072
    s_waitcnt vmcnt(20) lgkmcnt(1)
    v_mfma_f32_32x32x16_bf16 v[28:43], v[12:15], v[92:95], v[28:43]
    ds_read_b128 v[20:23], v11 offset:32768
    ds_read_b128 v[24:27], v11 offset:36864
    s_add_u32 m0, s25, 25472
    s_waitcnt lgkmcnt(2)
    v_mfma_f32_32x32x16_bf16 v[44:59], v[16:19], v[92:95], v[44:59]
    buffer_load_dwordx4 v4, s[16:19], s24 offen offset:128 lds
    s_mov_b32 s15, 65536
    buffer_load_dwordx4 v[92:95], v2, s[20:23], s15 offen offset:0
    s_waitcnt vmcnt(21) lgkmcnt(1)
    v_mfma_f32_32x32x16_bf16 v[28:43], v[20:23], v[96:99], v[28:43]
    ds_read_b128 v[12:15], v8 offset:40960
    ds_read_b128 v[16:19], v8 offset:45056
    s_waitcnt lgkmcnt(2)
    v_mfma_f32_32x32x16_bf16 v[44:59], v[24:27], v[96:99], v[44:59]
    s_mov_b32 s15, 65536
    buffer_load_dwordx4 v[96:99], v2, s[20:23], s15 offen offset:1024
    s_waitcnt vmcnt(21) lgkmcnt(1)
    v_mfma_f32_32x32x16_bf16 v[28:43], v[12:15], v[100:103], v[28:43]
    ds_read_b128 v[20:23], v9 offset:40960
    ds_read_b128 v[24:27], v9 offset:45056
    s_waitcnt lgkmcnt(2)
    v_mfma_f32_32x32x16_bf16 v[44:59], v[16:19], v[100:103], v[44:59]
    s_mov_b32 s15, 65536
    buffer_load_dwordx4 v[100:103], v2, s[20:23], s15 offen offset:2048
    s_waitcnt vmcnt(20) lgkmcnt(1)
    v_mfma_f32_32x32x16_bf16 v[28:43], v[20:23], v[104:107], v[28:43]
    ds_read_b128 v[12:15], v10 offset:40960
    ds_read_b128 v[16:19], v10 offset:45056
    s_waitcnt lgkmcnt(2)
    v_mfma_f32_32x32x16_bf16 v[44:59], v[24:27], v[104:107], v[44:59]
    s_mov_b32 s15, 65536
    buffer_load_dwordx4 v[104:107], v2, s[20:23], s15 offen offset:3072
    s_waitcnt vmcnt(19) lgkmcnt(1)
    v_mfma_f32_32x32x16_bf16 v[28:43], v[12:15], v[108:111], v[28:43]
    ds_read_b128 v[20:23], v11 offset:40960
    ds_read_b128 v[24:27], v11 offset:45056
    s_waitcnt lgkmcnt(2)
    v_mfma_f32_32x32x16_bf16 v[44:59], v[16:19], v[108:111], v[44:59]
    s_mov_b32 s15, 69632
    buffer_load_dwordx4 v[108:111], v2, s[20:23], s15 offen offset:0
    s_waitcnt lgkmcnt(0)
    s_barrier
    s_waitcnt vmcnt(18)
    v_mfma_f32_32x32x16_bf16 v[28:43], v[20:23], v[112:115], v[28:43]
    ds_read_b128 v[12:15], v8 offset:49152
    ds_read_b128 v[16:19], v8 offset:53248
    s_mov_b32 s24, 2560
    s_add_u32 m0, s25, 32768
    v_mfma_f32_32x32x16_bf16 v[44:59], v[24:27], v[112:115], v[44:59]
    buffer_load_dwordx4 v3, s[16:19], s24 offen offset:0 lds
    s_mov_b32 s15, 69632
    buffer_load_dwordx4 v[112:115], v2, s[20:23], s15 offen offset:1024
    s_waitcnt vmcnt(18) lgkmcnt(1)
    v_mfma_f32_32x32x16_bf16 v[28:43], v[12:15], v[60:63], v[28:43]
    ds_read_b128 v[20:23], v9 offset:49152
    ds_read_b128 v[24:27], v9 offset:53248
    s_add_u32 m0, s25, 33792
    s_waitcnt lgkmcnt(2)
    v_mfma_f32_32x32x16_bf16 v[44:59], v[16:19], v[60:63], v[44:59]
    buffer_load_dwordx4 v4, s[16:19], s24 offen offset:0 lds
    s_mov_b32 s15, 69632
    buffer_load_dwordx4 v[60:63], v2, s[20:23], s15 offen offset:2048
    s_waitcnt vmcnt(19) lgkmcnt(1)
    v_mfma_f32_32x32x16_bf16 v[28:43], v[20:23], v[64:67], v[28:43]
    ds_read_b128 v[12:15], v10 offset:49152
    ds_read_b128 v[16:19], v10 offset:53248
    s_add_u32 m0, s25, 40832
    s_waitcnt lgkmcnt(2)
    v_mfma_f32_32x32x16_bf16 v[44:59], v[24:27], v[64:67], v[44:59]
    buffer_load_dwordx4 v3, s[16:19], s24 offen offset:128 lds
    s_mov_b32 s15, 69632
    buffer_load_dwordx4 v[64:67], v2, s[20:23], s15 offen offset:3072
    s_waitcnt vmcnt(20) lgkmcnt(1)
    v_mfma_f32_32x32x16_bf16 v[28:43], v[12:15], v[68:71], v[28:43]
    ds_read_b128 v[20:23], v11 offset:49152
    ds_read_b128 v[24:27], v11 offset:53248
    s_add_u32 m0, s25, 41856
    s_waitcnt lgkmcnt(2)
    v_mfma_f32_32x32x16_bf16 v[44:59], v[16:19], v[68:71], v[44:59]
    buffer_load_dwordx4 v4, s[16:19], s24 offen offset:128 lds
    s_mov_b32 s15, 73728
    buffer_load_dwordx4 v[68:71], v2, s[20:23], s15 offen offset:0
    s_waitcnt vmcnt(21) lgkmcnt(1)
    v_mfma_f32_32x32x16_bf16 v[28:43], v[20:23], v[72:75], v[28:43]
    ds_read_b128 v[12:15], v8 offset:57344
    ds_read_b128 v[16:19], v8 offset:61440
    s_waitcnt lgkmcnt(2)
    v_mfma_f32_32x32x16_bf16 v[44:59], v[24:27], v[72:75], v[44:59]
    s_mov_b32 s15, 73728
    buffer_load_dwordx4 v[72:75], v2, s[20:23], s15 offen offset:1024
    s_waitcnt vmcnt(21) lgkmcnt(1)
    v_mfma_f32_32x32x16_bf16 v[28:43], v[12:15], v[76:79], v[28:43]
    ds_read_b128 v[20:23], v9 offset:57344
    ds_read_b128 v[24:27], v9 offset:61440
    s_waitcnt lgkmcnt(2)
    v_mfma_f32_32x32x16_bf16 v[44:59], v[16:19], v[76:79], v[44:59]
    s_mov_b32 s15, 73728
    buffer_load_dwordx4 v[76:79], v2, s[20:23], s15 offen offset:2048
    s_waitcnt vmcnt(20) lgkmcnt(1)
    v_mfma_f32_32x32x16_bf16 v[28:43], v[20:23], v[80:83], v[28:43]
    ds_read_b128 v[12:15], v10 offset:57344
    ds_read_b128 v[16:19], v10 offset:61440
    s_waitcnt lgkmcnt(2)
    v_mfma_f32_32x32x16_bf16 v[44:59], v[24:27], v[80:83], v[44:59]
    s_mov_b32 s15, 73728
    buffer_load_dwordx4 v[80:83], v2, s[20:23], s15 offen offset:3072
    s_waitcnt vmcnt(19) lgkmcnt(1)
    v_mfma_f32_32x32x16_bf16 v[28:43], v[12:15], v[84:87], v[28:43]
    ds_read_b128 v[20:23], v11 offset:57344
    ds_read_b128 v[24:27], v11 offset:61440
    s_waitcnt lgkmcnt(2)
    v_mfma_f32_32x32x16_bf16 v[44:59], v[16:19], v[84:87], v[44:59]
    s_mov_b32 s15, 77824
    buffer_load_dwordx4 v[84:87], v2, s[20:23], s15 offen offset:0
    s_waitcnt lgkmcnt(0)
    s_barrier
    s_waitcnt vmcnt(18)
    v_mfma_f32_32x32x16_bf16 v[28:43], v[20:23], v[88:91], v[28:43]
    ds_read_b128 v[12:15], v8 offset:0
    ds_read_b128 v[16:19], v8 offset:4096
    s_mov_b32 s24, 2816
    s_add_u32 m0, s25, 49152
    v_mfma_f32_32x32x16_bf16 v[44:59], v[24:27], v[88:91], v[44:59]
    buffer_load_dwordx4 v3, s[16:19], s24 offen offset:0 lds
    s_mov_b32 s15, 77824
    buffer_load_dwordx4 v[88:91], v2, s[20:23], s15 offen offset:1024
    s_waitcnt vmcnt(18) lgkmcnt(1)
    v_mfma_f32_32x32x16_bf16 v[28:43], v[12:15], v[92:95], v[28:43]
    ds_read_b128 v[20:23], v9 offset:0
    ds_read_b128 v[24:27], v9 offset:4096
    v_lshlrev_b32 v5, 16, v5
    s_add_u32 m0, s25, 50176
    s_waitcnt lgkmcnt(2)
    v_mfma_f32_32x32x16_bf16 v[44:59], v[16:19], v[92:95], v[44:59]
    buffer_load_dwordx4 v4, s[16:19], s24 offen offset:0 lds
    s_mov_b32 s15, 77824
    buffer_load_dwordx4 v[92:95], v2, s[20:23], s15 offen offset:2048
    ds_read_b64_tr_b16 v[6:7], v119 offset:0
    s_waitcnt vmcnt(19) lgkmcnt(2)
    v_mfma_f32_32x32x16_bf16 v[28:43], v[20:23], v[96:99], v[28:43]
    ds_read_b128 v[12:15], v10 offset:0
    ds_read_b128 v[16:19], v10 offset:4096
    v_xor_b32 v120, 0, v121
    s_add_u32 m0, s25, 57216
    s_waitcnt lgkmcnt(3)
    v_mfma_f32_32x32x16_bf16 v[44:59], v[24:27], v[96:99], v[44:59]
    buffer_load_dwordx4 v3, s[16:19], s24 offen offset:128 lds
    s_mov_b32 s15, 77824
    buffer_load_dwordx4 v[96:99], v2, s[20:23], s15 offen offset:3072
    ds_read_b64 v[192:193], v120
    s_waitcnt vmcnt(20) lgkmcnt(2)
    v_mfma_f32_32x32x16_bf16 v[28:43], v[12:15], v[100:103], v[28:43]
    ds_read_b128 v[20:23], v11 offset:0
    ds_read_b128 v[24:27], v11 offset:4096
    s_waitcnt lgkmcnt(2)
    v_lshlrev_b32 v196, 16, v192
    s_add_u32 m0, s25, 58240
    v_mfma_f32_32x32x16_bf16 v[44:59], v[16:19], v[100:103], v[44:59]
    buffer_load_dwordx4 v4, s[16:19], s24 offen offset:128 lds
    s_mov_b32 s15, 81920
    buffer_load_dwordx4 v[100:103], v2, s[20:23], s15 offen offset:0
    v_lshlrev_b32 v200, 16, v6
    s_waitcnt vmcnt(21) lgkmcnt(1)
    v_mfma_f32_32x32x16_bf16 v[28:43], v[20:23], v[104:107], v[28:43]
    ds_read_b128 v[12:15], v8 offset:8192
    ds_read_b128 v[16:19], v8 offset:12288
    v_and_b32 v197, s26, v192
    s_waitcnt lgkmcnt(2)
    v_mfma_f32_32x32x16_bf16 v[44:59], v[24:27], v[104:107], v[44:59]
    s_mov_b32 s15, 81920
    buffer_load_dwordx4 v[104:107], v2, s[20:23], s15 offen offset:1024
    v_and_b32 v201, s26, v6
    v_lshlrev_b32 v198, 16, v193
    v_lshlrev_b32 v202, 16, v7
    s_waitcnt vmcnt(21) lgkmcnt(1)
    v_mfma_f32_32x32x16_bf16 v[28:43], v[12:15], v[108:111], v[28:43]
    ds_read_b128 v[20:23], v9 offset:8192
    ds_read_b128 v[24:27], v9 offset:12288
    v_and_b32 v199, s26, v193
    s_waitcnt lgkmcnt(2)
    v_mfma_f32_32x32x16_bf16 v[44:59], v[16:19], v[108:111], v[44:59]
    s_mov_b32 s15, 81920
    buffer_load_dwordx4 v[108:111], v2, s[20:23], s15 offen offset:2048
    v_and_b32 v203, s26, v7
    v_mul_f32 v158, v158, v196
    v_mul_f32 v159, v159, v197
    s_waitcnt vmcnt(20) lgkmcnt(1)
    v_mfma_f32_32x32x16_bf16 v[28:43], v[20:23], v[112:115], v[28:43]
    ds_read_b128 v[12:15], v10 offset:8192
    ds_read_b128 v[16:19], v10 offset:12288
    v_mul_f32 v160, v160, v198
    s_waitcnt lgkmcnt(2)
    v_mfma_f32_32x32x16_bf16 v[44:59], v[24:27], v[112:115], v[44:59]
    s_mov_b32 s15, 81920
    buffer_load_dwordx4 v[112:115], v2, s[20:23], s15 offen offset:3072
    v_mul_f32 v161, v161, v199
    v_fmac_f32 v158, v126, v5
    v_fmac_f32 v159, v127, v5
    s_waitcnt vmcnt(19) lgkmcnt(1)
    v_mfma_f32_32x32x16_bf16 v[28:43], v[12:15], v[60:63], v[28:43]
    ds_read_b128 v[20:23], v11 offset:8192
    ds_read_b128 v[24:27], v11 offset:12288
    v_fmac_f32 v160, v128, v5
    s_waitcnt lgkmcnt(2)
    v_mfma_f32_32x32x16_bf16 v[44:59], v[16:19], v[60:63], v[44:59]
    s_mov_b32 s15, 86016
    buffer_load_dwordx4 v[60:63], v2, s[20:23], s15 offen offset:0
    v_fmac_f32 v161, v129, v5
    v_mul_f32 v158, v158, v200
    v_mul_f32 v159, v159, v201
    s_waitcnt lgkmcnt(0)
    s_barrier
    s_waitcnt vmcnt(18)
    v_mfma_f32_32x32x16_bf16 v[28:43], v[20:23], v[64:67], v[28:43]
    ds_read_b128 v[12:15], v8 offset:16384
    ds_read_b128 v[16:19], v8 offset:20480
    v_mul_f32 v160, v160, v202
    s_mov_b32 s24, 3072
    s_add_u32 m0, s25, 0
    v_mfma_f32_32x32x16_bf16 v[44:59], v[24:27], v[64:67], v[44:59]
    buffer_load_dwordx4 v3, s[16:19], s24 offen offset:0 lds
    s_mov_b32 s15, 86016
    buffer_load_dwordx4 v[64:67], v2, s[20:23], s15 offen offset:1024
    s_waitcnt vmcnt(18) lgkmcnt(1)
    v_mfma_f32_32x32x16_bf16 v[28:43], v[12:15], v[68:71], v[28:43]
    ds_read_b128 v[20:23], v9 offset:16384
    ds_read_b128 v[24:27], v9 offset:20480
    v_mul_f32 v161, v161, v203
    s_add_u32 m0, s25, 1024
    s_waitcnt lgkmcnt(2)
    v_mfma_f32_32x32x16_bf16 v[44:59], v[16:19], v[68:71], v[44:59]
    buffer_load_dwordx4 v4, s[16:19], s24 offen offset:0 lds
    s_mov_b32 s15, 86016
    buffer_load_dwordx4 v[68:71], v2, s[20:23], s15 offen offset:2048
    ds_read_b64_tr_b16 v[190:191], v119 offset:2048
    s_waitcnt vmcnt(19) lgkmcnt(2)
    v_mfma_f32_32x32x16_bf16 v[28:43], v[20:23], v[72:75], v[28:43]
    ds_read_b128 v[12:15], v10 offset:16384
    ds_read_b128 v[16:19], v10 offset:20480
    v_xor_b32 v120, 16, v121
    s_add_u32 m0, s25, 8064
    s_waitcnt lgkmcnt(3)
    v_mfma_f32_32x32x16_bf16 v[44:59], v[24:27], v[72:75], v[44:59]
    buffer_load_dwordx4 v3, s[16:19], s24 offen offset:128 lds
    s_mov_b32 s15, 86016
    buffer_load_dwordx4 v[72:75], v2, s[20:23], s15 offen offset:3072
    ds_read_b64 v[194:195], v120
    s_waitcnt vmcnt(20) lgkmcnt(2)
    v_mfma_f32_32x32x16_bf16 v[28:43], v[12:15], v[76:79], v[28:43]
    ds_read_b128 v[20:23], v11 offset:16384
    ds_read_b128 v[24:27], v11 offset:20480
    s_waitcnt lgkmcnt(2)
    v_lshlrev_b32 v196, 16, v194
    s_add_u32 m0, s25, 9088
    v_mfma_f32_32x32x16_bf16 v[44:59], v[16:19], v[76:79], v[44:59]
    buffer_load_dwordx4 v4, s[16:19], s24 offen offset:128 lds
    s_mov_b32 s15, 90112
    buffer_load_dwordx4 v[76:79], v2, s[20:23], s15 offen offset:0
    v_lshlrev_b32 v200, 16, v190
    s_waitcnt vmcnt(21) lgkmcnt(1)
    v_mfma_f32_32x32x16_bf16 v[28:43], v[20:23], v[80:83], v[28:43]
    ds_read_b128 v[12:15], v8 offset:24576
    ds_read_b128 v[16:19], v8 offset:28672
    v_and_b32 v197, s26, v194
    s_waitcnt lgkmcnt(2)
    v_mfma_f32_32x32x16_bf16 v[44:59], v[24:27], v[80:83], v[44:59]
    s_mov_b32 s15, 90112
    buffer_load_dwordx4 v[80:83], v2, s[20:23], s15 offen offset:1024
    v_and_b32 v201, s26, v190
    v_lshlrev_b32 v198, 16, v195
    v_lshlrev_b32 v202, 16, v191
    s_waitcnt vmcnt(21) lgkmcnt(1)
    v_mfma_f32_32x32x16_bf16 v[28:43], v[12:15], v[84:87], v[28:43]
    ds_read_b128 v[20:23], v9 offset:24576
    ds_read_b128 v[24:27], v9 offset:28672
    v_and_b32 v199, s26, v195
    s_waitcnt lgkmcnt(2)
    v_mfma_f32_32x32x16_bf16 v[44:59], v[16:19], v[84:87], v[44:59]
    s_mov_b32 s15, 90112
    buffer_load_dwordx4 v[84:87], v2, s[20:23], s15 offen offset:2048
    v_and_b32 v203, s26, v191
    v_mul_f32 v162, v162, v196
    v_mul_f32 v163, v163, v197
    s_waitcnt vmcnt(20) lgkmcnt(1)
    v_mfma_f32_32x32x16_bf16 v[28:43], v[20:23], v[88:91], v[28:43]
    ds_read_b128 v[12:15], v10 offset:24576
    ds_read_b128 v[16:19], v10 offset:28672
    v_mul_f32 v164, v164, v198
    s_waitcnt lgkmcnt(2)
    v_mfma_f32_32x32x16_bf16 v[44:59], v[24:27], v[88:91], v[44:59]
    s_mov_b32 s15, 90112
    buffer_load_dwordx4 v[88:91], v2, s[20:23], s15 offen offset:3072
    v_mul_f32 v165, v165, v199
    v_fmac_f32 v162, v130, v5
    v_fmac_f32 v163, v131, v5
    s_waitcnt vmcnt(19) lgkmcnt(1)
    v_mfma_f32_32x32x16_bf16 v[28:43], v[12:15], v[92:95], v[28:43]
    ds_read_b128 v[20:23], v11 offset:24576
    ds_read_b128 v[24:27], v11 offset:28672
    v_fmac_f32 v164, v132, v5
    s_waitcnt lgkmcnt(2)
    v_mfma_f32_32x32x16_bf16 v[44:59], v[16:19], v[92:95], v[44:59]
    s_mov_b32 s15, 94208
    buffer_load_dwordx4 v[92:95], v2, s[20:23], s15 offen offset:0
    v_fmac_f32 v165, v133, v5
    v_mul_f32 v162, v162, v200
    v_mul_f32 v163, v163, v201
    s_waitcnt lgkmcnt(0)
    s_barrier
    s_waitcnt vmcnt(18)
    v_mfma_f32_32x32x16_bf16 v[28:43], v[20:23], v[96:99], v[28:43]
    ds_read_b128 v[12:15], v8 offset:32768
    ds_read_b128 v[16:19], v8 offset:36864
    v_mul_f32 v164, v164, v202
    s_mov_b32 s24, 3328
    s_add_u32 m0, s25, 16384
    v_mfma_f32_32x32x16_bf16 v[44:59], v[24:27], v[96:99], v[44:59]
    buffer_load_dwordx4 v3, s[16:19], s24 offen offset:0 lds
    s_mov_b32 s15, 94208
    buffer_load_dwordx4 v[96:99], v2, s[20:23], s15 offen offset:1024
    s_waitcnt vmcnt(18) lgkmcnt(1)
    v_mfma_f32_32x32x16_bf16 v[28:43], v[12:15], v[100:103], v[28:43]
    ds_read_b128 v[20:23], v9 offset:32768
    ds_read_b128 v[24:27], v9 offset:36864
    v_mul_f32 v165, v165, v203
    s_add_u32 m0, s25, 17408
    s_waitcnt lgkmcnt(2)
    v_mfma_f32_32x32x16_bf16 v[44:59], v[16:19], v[100:103], v[44:59]
    buffer_load_dwordx4 v4, s[16:19], s24 offen offset:0 lds
    s_mov_b32 s15, 94208
    buffer_load_dwordx4 v[100:103], v2, s[20:23], s15 offen offset:2048
    ds_read_b64_tr_b16 v[6:7], v119 offset:4096
    s_waitcnt vmcnt(19) lgkmcnt(2)
    v_mfma_f32_32x32x16_bf16 v[28:43], v[20:23], v[104:107], v[28:43]
    ds_read_b128 v[12:15], v10 offset:32768
    ds_read_b128 v[16:19], v10 offset:36864
    v_xor_b32 v120, 32, v121
    s_add_u32 m0, s25, 24448
    s_waitcnt lgkmcnt(3)
    v_mfma_f32_32x32x16_bf16 v[44:59], v[24:27], v[104:107], v[44:59]
    buffer_load_dwordx4 v3, s[16:19], s24 offen offset:128 lds
    s_mov_b32 s15, 94208
    buffer_load_dwordx4 v[104:107], v2, s[20:23], s15 offen offset:3072
    ds_read_b64 v[192:193], v120
    s_waitcnt vmcnt(20) lgkmcnt(2)
    v_mfma_f32_32x32x16_bf16 v[28:43], v[12:15], v[108:111], v[28:43]
    ds_read_b128 v[20:23], v11 offset:32768
    ds_read_b128 v[24:27], v11 offset:36864
    s_waitcnt lgkmcnt(2)
    v_lshlrev_b32 v196, 16, v192
    s_add_u32 m0, s25, 25472
    v_mfma_f32_32x32x16_bf16 v[44:59], v[16:19], v[108:111], v[44:59]
    buffer_load_dwordx4 v4, s[16:19], s24 offen offset:128 lds
    s_mov_b32 s15, 98304
    buffer_load_dwordx4 v[108:111], v2, s[20:23], s15 offen offset:0
    v_lshlrev_b32 v200, 16, v6
    s_waitcnt vmcnt(21) lgkmcnt(1)
    v_mfma_f32_32x32x16_bf16 v[28:43], v[20:23], v[112:115], v[28:43]
    ds_read_b128 v[12:15], v8 offset:40960
    ds_read_b128 v[16:19], v8 offset:45056
    v_and_b32 v197, s26, v192
    s_waitcnt lgkmcnt(2)
    v_mfma_f32_32x32x16_bf16 v[44:59], v[24:27], v[112:115], v[44:59]
    s_mov_b32 s15, 98304
    buffer_load_dwordx4 v[112:115], v2, s[20:23], s15 offen offset:1024
    v_and_b32 v201, s26, v6
    v_lshlrev_b32 v198, 16, v193
    v_lshlrev_b32 v202, 16, v7
    s_waitcnt vmcnt(21) lgkmcnt(1)
    v_mfma_f32_32x32x16_bf16 v[28:43], v[12:15], v[60:63], v[28:43]
    ds_read_b128 v[20:23], v9 offset:40960
    ds_read_b128 v[24:27], v9 offset:45056
    v_and_b32 v199, s26, v193
    s_waitcnt lgkmcnt(2)
    v_mfma_f32_32x32x16_bf16 v[44:59], v[16:19], v[60:63], v[44:59]
    s_mov_b32 s15, 98304
    buffer_load_dwordx4 v[60:63], v2, s[20:23], s15 offen offset:2048
    v_and_b32 v203, s26, v7
    v_mul_f32 v166, v166, v196
    v_mul_f32 v167, v167, v197
    s_waitcnt vmcnt(20) lgkmcnt(1)
    v_mfma_f32_32x32x16_bf16 v[28:43], v[20:23], v[64:67], v[28:43]
    ds_read_b128 v[12:15], v10 offset:40960
    ds_read_b128 v[16:19], v10 offset:45056
    v_mul_f32 v168, v168, v198
    s_waitcnt lgkmcnt(2)
    v_mfma_f32_32x32x16_bf16 v[44:59], v[24:27], v[64:67], v[44:59]
    s_mov_b32 s15, 98304
    buffer_load_dwordx4 v[64:67], v2, s[20:23], s15 offen offset:3072
    v_mul_f32 v169, v169, v199
    v_fmac_f32 v166, v134, v5
    v_fmac_f32 v167, v135, v5
    s_waitcnt vmcnt(19) lgkmcnt(1)
    v_mfma_f32_32x32x16_bf16 v[28:43], v[12:15], v[68:71], v[28:43]
    ds_read_b128 v[20:23], v11 offset:40960
    ds_read_b128 v[24:27], v11 offset:45056
    v_fmac_f32 v168, v136, v5
    s_waitcnt lgkmcnt(2)
    v_mfma_f32_32x32x16_bf16 v[44:59], v[16:19], v[68:71], v[44:59]
    s_mov_b32 s15, 102400
    buffer_load_dwordx4 v[68:71], v2, s[20:23], s15 offen offset:0
    v_fmac_f32 v169, v137, v5
    v_mul_f32 v166, v166, v200
    v_mul_f32 v167, v167, v201
    s_waitcnt lgkmcnt(0)
    s_barrier
    s_waitcnt vmcnt(18)
    v_mfma_f32_32x32x16_bf16 v[28:43], v[20:23], v[72:75], v[28:43]
    ds_read_b128 v[12:15], v8 offset:49152
    ds_read_b128 v[16:19], v8 offset:53248
    v_mul_f32 v168, v168, v202
    s_mov_b32 s24, 3584
    s_add_u32 m0, s25, 32768
    v_mfma_f32_32x32x16_bf16 v[44:59], v[24:27], v[72:75], v[44:59]
    buffer_load_dwordx4 v3, s[16:19], s24 offen offset:0 lds
    s_mov_b32 s15, 102400
    buffer_load_dwordx4 v[72:75], v2, s[20:23], s15 offen offset:1024
    s_waitcnt vmcnt(18) lgkmcnt(1)
    v_mfma_f32_32x32x16_bf16 v[28:43], v[12:15], v[76:79], v[28:43]
    ds_read_b128 v[20:23], v9 offset:49152
    ds_read_b128 v[24:27], v9 offset:53248
    v_mul_f32 v169, v169, v203
    s_add_u32 m0, s25, 33792
    s_waitcnt lgkmcnt(2)
    v_mfma_f32_32x32x16_bf16 v[44:59], v[16:19], v[76:79], v[44:59]
    buffer_load_dwordx4 v4, s[16:19], s24 offen offset:0 lds
    s_mov_b32 s15, 102400
    buffer_load_dwordx4 v[76:79], v2, s[20:23], s15 offen offset:2048
    ds_read_b64_tr_b16 v[190:191], v119 offset:6144
    s_waitcnt vmcnt(19) lgkmcnt(2)
    v_mfma_f32_32x32x16_bf16 v[28:43], v[20:23], v[80:83], v[28:43]
    ds_read_b128 v[12:15], v10 offset:49152
    ds_read_b128 v[16:19], v10 offset:53248
    v_xor_b32 v120, 48, v121
    s_add_u32 m0, s25, 40832
    s_waitcnt lgkmcnt(3)
    v_mfma_f32_32x32x16_bf16 v[44:59], v[24:27], v[80:83], v[44:59]
    buffer_load_dwordx4 v3, s[16:19], s24 offen offset:128 lds
    s_mov_b32 s15, 102400
    buffer_load_dwordx4 v[80:83], v2, s[20:23], s15 offen offset:3072
    ds_read_b64 v[194:195], v120
    s_waitcnt vmcnt(20) lgkmcnt(2)
    v_mfma_f32_32x32x16_bf16 v[28:43], v[12:15], v[84:87], v[28:43]
    ds_read_b128 v[20:23], v11 offset:49152
    ds_read_b128 v[24:27], v11 offset:53248
    s_waitcnt lgkmcnt(2)
    v_lshlrev_b32 v196, 16, v194
    s_add_u32 m0, s25, 41856
    v_mfma_f32_32x32x16_bf16 v[44:59], v[16:19], v[84:87], v[44:59]
    buffer_load_dwordx4 v4, s[16:19], s24 offen offset:128 lds
    s_mov_b32 s15, 106496
    buffer_load_dwordx4 v[84:87], v2, s[20:23], s15 offen offset:0
    v_lshlrev_b32 v200, 16, v190
    s_waitcnt vmcnt(21) lgkmcnt(1)
    v_mfma_f32_32x32x16_bf16 v[28:43], v[20:23], v[88:91], v[28:43]
    ds_read_b128 v[12:15], v8 offset:57344
    ds_read_b128 v[16:19], v8 offset:61440
    v_and_b32 v197, s26, v194
    s_waitcnt lgkmcnt(2)
    v_mfma_f32_32x32x16_bf16 v[44:59], v[24:27], v[88:91], v[44:59]
    s_mov_b32 s15, 106496
    buffer_load_dwordx4 v[88:91], v2, s[20:23], s15 offen offset:1024
    v_and_b32 v201, s26, v190
    v_lshlrev_b32 v198, 16, v195
    v_lshlrev_b32 v202, 16, v191
    s_waitcnt vmcnt(21) lgkmcnt(1)
    v_mfma_f32_32x32x16_bf16 v[28:43], v[12:15], v[92:95], v[28:43]
    ds_read_b128 v[20:23], v9 offset:57344
    ds_read_b128 v[24:27], v9 offset:61440
    v_and_b32 v199, s26, v195
    s_waitcnt lgkmcnt(2)
    v_mfma_f32_32x32x16_bf16 v[44:59], v[16:19], v[92:95], v[44:59]
    s_mov_b32 s15, 106496
    buffer_load_dwordx4 v[92:95], v2, s[20:23], s15 offen offset:2048
    v_and_b32 v203, s26, v191
    v_mul_f32 v170, v170, v196
    v_mul_f32 v171, v171, v197
    s_waitcnt vmcnt(20) lgkmcnt(1)
    v_mfma_f32_32x32x16_bf16 v[28:43], v[20:23], v[96:99], v[28:43]
    ds_read_b128 v[12:15], v10 offset:57344
    ds_read_b128 v[16:19], v10 offset:61440
    v_mul_f32 v172, v172, v198
    s_waitcnt lgkmcnt(2)
    v_mfma_f32_32x32x16_bf16 v[44:59], v[24:27], v[96:99], v[44:59]
    s_mov_b32 s15, 106496
    buffer_load_dwordx4 v[96:99], v2, s[20:23], s15 offen offset:3072
    v_mul_f32 v173, v173, v199
    v_fmac_f32 v170, v138, v5
    v_fmac_f32 v171, v139, v5
    s_waitcnt vmcnt(19) lgkmcnt(1)
    v_mfma_f32_32x32x16_bf16 v[28:43], v[12:15], v[100:103], v[28:43]
    ds_read_b128 v[20:23], v11 offset:57344
    ds_read_b128 v[24:27], v11 offset:61440
    v_fmac_f32 v172, v140, v5
    s_waitcnt lgkmcnt(2)
    v_mfma_f32_32x32x16_bf16 v[44:59], v[16:19], v[100:103], v[44:59]
    s_mov_b32 s15, 110592
    buffer_load_dwordx4 v[100:103], v2, s[20:23], s15 offen offset:0
    v_fmac_f32 v173, v141, v5
    v_mul_f32 v170, v170, v200
    v_mul_f32 v171, v171, v201
    s_waitcnt lgkmcnt(0)
    s_barrier
    s_waitcnt vmcnt(18)
    v_mfma_f32_32x32x16_bf16 v[28:43], v[20:23], v[104:107], v[28:43]
    ds_read_b128 v[12:15], v8 offset:0
    ds_read_b128 v[16:19], v8 offset:4096
    v_mul_f32 v172, v172, v202
    s_mov_b32 s24, 3840
    s_add_u32 m0, s25, 49152
    v_mfma_f32_32x32x16_bf16 v[44:59], v[24:27], v[104:107], v[44:59]
    buffer_load_dwordx4 v3, s[16:19], s24 offen offset:0 lds
    s_mov_b32 s15, 110592
    buffer_load_dwordx4 v[104:107], v2, s[20:23], s15 offen offset:1024
    s_waitcnt vmcnt(18) lgkmcnt(1)
    v_mfma_f32_32x32x16_bf16 v[28:43], v[12:15], v[108:111], v[28:43]
    ds_read_b128 v[20:23], v9 offset:0
    ds_read_b128 v[24:27], v9 offset:4096
    v_mul_f32 v173, v173, v203
    s_add_u32 m0, s25, 50176
    s_waitcnt lgkmcnt(2)
    v_mfma_f32_32x32x16_bf16 v[44:59], v[16:19], v[108:111], v[44:59]
    buffer_load_dwordx4 v4, s[16:19], s24 offen offset:0 lds
    s_mov_b32 s15, 110592
    buffer_load_dwordx4 v[108:111], v2, s[20:23], s15 offen offset:2048
    ds_read_b64_tr_b16 v[6:7], v119 offset:8192
    s_waitcnt vmcnt(19) lgkmcnt(2)
    v_mfma_f32_32x32x16_bf16 v[28:43], v[20:23], v[112:115], v[28:43]
    ds_read_b128 v[12:15], v10 offset:0
    ds_read_b128 v[16:19], v10 offset:4096
    v_xor_b32 v120, 64, v121
    s_add_u32 m0, s25, 57216
    s_waitcnt lgkmcnt(3)
    v_mfma_f32_32x32x16_bf16 v[44:59], v[24:27], v[112:115], v[44:59]
    buffer_load_dwordx4 v3, s[16:19], s24 offen offset:128 lds
    s_mov_b32 s15, 110592
    buffer_load_dwordx4 v[112:115], v2, s[20:23], s15 offen offset:3072
    ds_read_b64 v[192:193], v120
    s_waitcnt vmcnt(20) lgkmcnt(2)
    v_mfma_f32_32x32x16_bf16 v[28:43], v[12:15], v[60:63], v[28:43]
    ds_read_b128 v[20:23], v11 offset:0
    ds_read_b128 v[24:27], v11 offset:4096
    s_waitcnt lgkmcnt(2)
    v_lshlrev_b32 v196, 16, v192
    s_add_u32 m0, s25, 58240
    v_mfma_f32_32x32x16_bf16 v[44:59], v[16:19], v[60:63], v[44:59]
    buffer_load_dwordx4 v4, s[16:19], s24 offen offset:128 lds
    s_mov_b32 s15, 114688
    buffer_load_dwordx4 v[60:63], v2, s[20:23], s15 offen offset:0
    v_lshlrev_b32 v200, 16, v6
    s_waitcnt vmcnt(21) lgkmcnt(1)
    v_mfma_f32_32x32x16_bf16 v[28:43], v[20:23], v[64:67], v[28:43]
    ds_read_b128 v[12:15], v8 offset:8192
    ds_read_b128 v[16:19], v8 offset:12288
    v_and_b32 v197, s26, v192
    s_waitcnt lgkmcnt(2)
    v_mfma_f32_32x32x16_bf16 v[44:59], v[24:27], v[64:67], v[44:59]
    s_mov_b32 s15, 114688
    buffer_load_dwordx4 v[64:67], v2, s[20:23], s15 offen offset:1024
    v_and_b32 v201, s26, v6
    v_lshlrev_b32 v198, 16, v193
    v_lshlrev_b32 v202, 16, v7
    s_waitcnt vmcnt(21) lgkmcnt(1)
    v_mfma_f32_32x32x16_bf16 v[28:43], v[12:15], v[68:71], v[28:43]
    ds_read_b128 v[20:23], v9 offset:8192
    ds_read_b128 v[24:27], v9 offset:12288
    v_and_b32 v199, s26, v193
    s_waitcnt lgkmcnt(2)
    v_mfma_f32_32x32x16_bf16 v[44:59], v[16:19], v[68:71], v[44:59]
    s_mov_b32 s15, 114688
    buffer_load_dwordx4 v[68:71], v2, s[20:23], s15 offen offset:2048
    v_and_b32 v203, s26, v7
    v_mul_f32 v174, v174, v196
    v_mul_f32 v175, v175, v197
    s_waitcnt vmcnt(20) lgkmcnt(1)
    v_mfma_f32_32x32x16_bf16 v[28:43], v[20:23], v[72:75], v[28:43]
    ds_read_b128 v[12:15], v10 offset:8192
    ds_read_b128 v[16:19], v10 offset:12288
    v_mul_f32 v176, v176, v198
    s_waitcnt lgkmcnt(2)
    v_mfma_f32_32x32x16_bf16 v[44:59], v[24:27], v[72:75], v[44:59]
    s_mov_b32 s15, 114688
    buffer_load_dwordx4 v[72:75], v2, s[20:23], s15 offen offset:3072
    v_mul_f32 v177, v177, v199
    v_fmac_f32 v174, v142, v5
    v_fmac_f32 v175, v143, v5
    s_waitcnt vmcnt(19) lgkmcnt(1)
    v_mfma_f32_32x32x16_bf16 v[28:43], v[12:15], v[76:79], v[28:43]
    ds_read_b128 v[20:23], v11 offset:8192
    ds_read_b128 v[24:27], v11 offset:12288
    v_fmac_f32 v176, v144, v5
    s_waitcnt lgkmcnt(2)
    v_mfma_f32_32x32x16_bf16 v[44:59], v[16:19], v[76:79], v[44:59]
    s_mov_b32 s15, 118784
    buffer_load_dwordx4 v[76:79], v2, s[20:23], s15 offen offset:0
    v_fmac_f32 v177, v145, v5
    v_mul_f32 v174, v174, v200
    v_mul_f32 v175, v175, v201
    s_waitcnt lgkmcnt(0)
    s_barrier
    s_waitcnt vmcnt(18)
    v_mfma_f32_32x32x16_bf16 v[28:43], v[20:23], v[80:83], v[28:43]
    ds_read_b128 v[12:15], v8 offset:16384
    ds_read_b128 v[16:19], v8 offset:20480
    v_mul_f32 v176, v176, v202
    v_mfma_f32_32x32x16_bf16 v[44:59], v[24:27], v[80:83], v[44:59]
    s_mov_b32 s15, 118784
    buffer_load_dwordx4 v[80:83], v2, s[20:23], s15 offen offset:1024
    v_mul_f32 v177, v177, v203
    ds_read_b64_tr_b16 v[190:191], v119 offset:10240
    v_xor_b32 v120, 80, v121
    s_waitcnt vmcnt(17) lgkmcnt(2)
    v_mfma_f32_32x32x16_bf16 v[28:43], v[12:15], v[84:87], v[28:43]
    ds_read_b128 v[20:23], v9 offset:16384
    ds_read_b128 v[24:27], v9 offset:20480
    ds_read_b64 v[194:195], v120
    s_waitcnt lgkmcnt(4)
    v_mfma_f32_32x32x16_bf16 v[44:59], v[16:19], v[84:87], v[44:59]
    s_mov_b32 s15, 118784
    buffer_load_dwordx4 v[84:87], v2, s[20:23], s15 offen offset:2048
    s_waitcnt lgkmcnt(0)
    v_lshlrev_b32 v196, 16, v194
    v_lshlrev_b32 v200, 16, v190
    v_and_b32 v197, s26, v194
    s_waitcnt vmcnt(17)
    v_mfma_f32_32x32x16_bf16 v[28:43], v[20:23], v[88:91], v[28:43]
    ds_read_b128 v[12:15], v10 offset:16384
    ds_read_b128 v[16:19], v10 offset:20480
    v_and_b32 v201, s26, v190
    v_mfma_f32_32x32x16_bf16 v[44:59], v[24:27], v[88:91], v[44:59]
    s_mov_b32 s15, 118784
    buffer_load_dwordx4 v[88:91], v2, s[20:23], s15 offen offset:3072
    v_lshlrev_b32 v198, 16, v195
    v_lshlrev_b32 v202, 16, v191
    v_and_b32 v199, s26, v195
    s_waitcnt vmcnt(17) lgkmcnt(1)
    v_mfma_f32_32x32x16_bf16 v[28:43], v[12:15], v[92:95], v[28:43]
    ds_read_b128 v[20:23], v11 offset:16384
    ds_read_b128 v[24:27], v11 offset:20480
    v_and_b32 v203, s26, v191
    s_waitcnt lgkmcnt(2)
    v_mfma_f32_32x32x16_bf16 v[44:59], v[16:19], v[92:95], v[44:59]
    s_mov_b32 s15, 122880
    buffer_load_dwordx4 v[92:95], v2, s[20:23], s15 offen offset:0
    v_mul_f32 v178, v178, v196
    v_mul_f32 v179, v179, v197
    v_mul_f32 v180, v180, v198
    s_waitcnt vmcnt(17) lgkmcnt(1)
    v_mfma_f32_32x32x16_bf16 v[28:43], v[20:23], v[96:99], v[28:43]
    ds_read_b128 v[12:15], v8 offset:24576
    ds_read_b128 v[16:19], v8 offset:28672
    v_mul_f32 v181, v181, v199
    s_waitcnt lgkmcnt(2)
    v_mfma_f32_32x32x16_bf16 v[44:59], v[24:27], v[96:99], v[44:59]
    s_mov_b32 s15, 122880
    buffer_load_dwordx4 v[96:99], v2, s[20:23], s15 offen offset:1024
    v_fmac_f32 v178, v146, v5
    v_fmac_f32 v179, v147, v5
    v_fmac_f32 v180, v148, v5
    s_waitcnt vmcnt(17) lgkmcnt(1)
    v_mfma_f32_32x32x16_bf16 v[28:43], v[12:15], v[100:103], v[28:43]
    ds_read_b128 v[20:23], v9 offset:24576
    ds_read_b128 v[24:27], v9 offset:28672
    v_fmac_f32 v181, v149, v5
    s_waitcnt lgkmcnt(2)
    v_mfma_f32_32x32x16_bf16 v[44:59], v[16:19], v[100:103], v[44:59]
    s_mov_b32 s15, 122880
    buffer_load_dwordx4 v[100:103], v2, s[20:23], s15 offen offset:2048
    v_mul_f32 v178, v178, v200
    v_mul_f32 v179, v179, v201
    v_mul_f32 v180, v180, v202
    s_waitcnt vmcnt(16) lgkmcnt(1)
    v_mfma_f32_32x32x16_bf16 v[28:43], v[20:23], v[104:107], v[28:43]
    ds_read_b128 v[12:15], v10 offset:24576
    ds_read_b128 v[16:19], v10 offset:28672
    v_mul_f32 v181, v181, v203
    s_waitcnt lgkmcnt(2)
    v_mfma_f32_32x32x16_bf16 v[44:59], v[24:27], v[104:107], v[44:59]
    s_mov_b32 s15, 122880
    buffer_load_dwordx4 v[104:107], v2, s[20:23], s15 offen offset:3072
    ds_read_b64_tr_b16 v[6:7], v119 offset:12288
    v_xor_b32 v120, 96, v121
    ds_read_b64 v[192:193], v120
    s_waitcnt vmcnt(15) lgkmcnt(3)
    v_mfma_f32_32x32x16_bf16 v[28:43], v[12:15], v[108:111], v[28:43]
    ds_read_b128 v[20:23], v11 offset:24576
    ds_read_b128 v[24:27], v11 offset:28672
    s_waitcnt lgkmcnt(2)
    v_lshlrev_b32 v196, 16, v192
    v_mfma_f32_32x32x16_bf16 v[44:59], v[16:19], v[108:111], v[44:59]
    s_mov_b32 s15, 126976
    buffer_load_dwordx4 v[108:111], v2, s[20:23], s15 offen offset:0
    v_lshlrev_b32 v200, 16, v6
    v_and_b32 v197, s26, v192
    v_and_b32 v201, s26, v6
    s_waitcnt lgkmcnt(0)
    s_barrier
    s_waitcnt vmcnt(14)
    v_mfma_f32_32x32x16_bf16 v[28:43], v[20:23], v[112:115], v[28:43]
    ds_read_b128 v[12:15], v8 offset:32768
    ds_read_b128 v[16:19], v8 offset:36864
    v_lshlrev_b32 v198, 16, v193
    v_mfma_f32_32x32x16_bf16 v[44:59], v[24:27], v[112:115], v[44:59]
    s_mov_b32 s15, 126976
    buffer_load_dwordx4 v[112:115], v2, s[20:23], s15 offen offset:1024
    v_lshlrev_b32 v202, 16, v7
    v_and_b32 v199, s26, v193
    v_and_b32 v203, s26, v7
    s_waitcnt vmcnt(13) lgkmcnt(1)
    v_mfma_f32_32x32x16_bf16 v[28:43], v[12:15], v[60:63], v[28:43]
    ds_read_b128 v[20:23], v9 offset:32768
    ds_read_b128 v[24:27], v9 offset:36864
    v_mul_f32 v182, v182, v196
    s_waitcnt lgkmcnt(2)
    v_mfma_f32_32x32x16_bf16 v[44:59], v[16:19], v[60:63], v[44:59]
    s_mov_b32 s15, 126976
    buffer_load_dwordx4 v[60:63], v2, s[20:23], s15 offen offset:2048
    v_mul_f32 v183, v183, v197
    v_mul_f32 v184, v184, v198
    v_mul_f32 v185, v185, v199
    s_waitcnt vmcnt(13) lgkmcnt(1)
    v_mfma_f32_32x32x16_bf16 v[28:43], v[20:23], v[64:67], v[28:43]
    ds_read_b128 v[12:15], v10 offset:32768
    ds_read_b128 v[16:19], v10 offset:36864
    v_fmac_f32 v182, v150, v5
    s_waitcnt lgkmcnt(2)
    v_mfma_f32_32x32x16_bf16 v[44:59], v[24:27], v[64:67], v[44:59]
    s_mov_b32 s15, 126976
    buffer_load_dwordx4 v[64:67], v2, s[20:23], s15 offen offset:3072
    v_fmac_f32 v183, v151, v5
    v_fmac_f32 v184, v152, v5
    v_fmac_f32 v185, v153, v5
    s_waitcnt vmcnt(13) lgkmcnt(1)
    v_mfma_f32_32x32x16_bf16 v[28:43], v[12:15], v[68:71], v[28:43]
    ds_read_b128 v[20:23], v11 offset:32768
    ds_read_b128 v[24:27], v11 offset:36864
    v_mul_f32 v182, v182, v200
    s_waitcnt lgkmcnt(2)
    v_mfma_f32_32x32x16_bf16 v[44:59], v[16:19], v[68:71], v[44:59]
    v_mul_f32 v183, v183, v201
    v_mul_f32 v184, v184, v202
    v_mul_f32 v185, v185, v203
    s_waitcnt vmcnt(12) lgkmcnt(1)
    v_mfma_f32_32x32x16_bf16 v[28:43], v[20:23], v[72:75], v[28:43]
    ds_read_b128 v[12:15], v8 offset:40960
    ds_read_b128 v[16:19], v8 offset:45056
    ds_read_b64_tr_b16 v[190:191], v119 offset:14336
    s_waitcnt lgkmcnt(3)
    v_mfma_f32_32x32x16_bf16 v[44:59], v[24:27], v[72:75], v[44:59]
    v_xor_b32 v120, 112, v121
    ds_read_b64 v[194:195], v120
    s_waitcnt lgkmcnt(0)
    v_lshlrev_b32 v196, 16, v194
    s_waitcnt vmcnt(11)
    v_mfma_f32_32x32x16_bf16 v[28:43], v[12:15], v[76:79], v[28:43]
    ds_read_b128 v[20:23], v9 offset:40960
    ds_read_b128 v[24:27], v9 offset:45056
    v_lshlrev_b32 v200, 16, v190
    v_mfma_f32_32x32x16_bf16 v[44:59], v[16:19], v[76:79], v[44:59]
    v_and_b32 v197, s26, v194
    v_and_b32 v201, s26, v190
    v_lshlrev_b32 v198, 16, v195
    s_waitcnt vmcnt(10) lgkmcnt(1)
    v_mfma_f32_32x32x16_bf16 v[28:43], v[20:23], v[80:83], v[28:43]
    ds_read_b128 v[12:15], v10 offset:40960
    ds_read_b128 v[16:19], v10 offset:45056
    v_lshlrev_b32 v202, 16, v191
    s_waitcnt lgkmcnt(2)
    v_mfma_f32_32x32x16_bf16 v[44:59], v[24:27], v[80:83], v[44:59]
    v_and_b32 v199, s26, v195
    v_and_b32 v203, s26, v191
    v_mul_f32 v186, v186, v196
    s_waitcnt vmcnt(9) lgkmcnt(1)
    v_mfma_f32_32x32x16_bf16 v[28:43], v[12:15], v[84:87], v[28:43]
    ds_read_b128 v[20:23], v11 offset:40960
    ds_read_b128 v[24:27], v11 offset:45056
    v_mul_f32 v187, v187, v197
    s_waitcnt lgkmcnt(2)
    v_mfma_f32_32x32x16_bf16 v[44:59], v[16:19], v[84:87], v[44:59]
    v_mul_f32 v188, v188, v198
    v_mul_f32 v189, v189, v199
    v_fmac_f32 v186, v154, v5
    s_waitcnt lgkmcnt(0)
    s_barrier
    s_waitcnt vmcnt(8)
    v_mfma_f32_32x32x16_bf16 v[28:43], v[20:23], v[88:91], v[28:43]
    ds_read_b128 v[12:15], v8 offset:49152
    ds_read_b128 v[16:19], v8 offset:53248
    v_fmac_f32 v187, v155, v5
    v_mfma_f32_32x32x16_bf16 v[44:59], v[24:27], v[88:91], v[44:59]
    v_fmac_f32 v188, v156, v5
    v_fmac_f32 v189, v157, v5
    v_mul_f32 v186, v186, v200
    s_waitcnt vmcnt(7) lgkmcnt(1)
    v_mfma_f32_32x32x16_bf16 v[28:43], v[12:15], v[92:95], v[28:43]
    ds_read_b128 v[20:23], v9 offset:49152
    ds_read_b128 v[24:27], v9 offset:53248
    v_mul_f32 v187, v187, v201
    s_waitcnt lgkmcnt(2)
    v_mfma_f32_32x32x16_bf16 v[44:59], v[16:19], v[92:95], v[44:59]
    v_mul_f32 v188, v188, v202
    v_mul_f32 v189, v189, v203
    s_waitcnt vmcnt(6) lgkmcnt(1)
    v_mfma_f32_32x32x16_bf16 v[28:43], v[20:23], v[96:99], v[28:43]
    ds_read_b128 v[12:15], v10 offset:49152
    ds_read_b128 v[16:19], v10 offset:53248
    s_waitcnt lgkmcnt(2)
    v_mfma_f32_32x32x16_bf16 v[44:59], v[24:27], v[96:99], v[44:59]
    s_waitcnt vmcnt(5) lgkmcnt(1)
    v_mfma_f32_32x32x16_bf16 v[28:43], v[12:15], v[100:103], v[28:43]
    ds_read_b128 v[20:23], v11 offset:49152
    ds_read_b128 v[24:27], v11 offset:53248
    s_waitcnt lgkmcnt(2)
    v_mfma_f32_32x32x16_bf16 v[44:59], v[16:19], v[100:103], v[44:59]
    s_waitcnt vmcnt(4) lgkmcnt(1)
    v_mfma_f32_32x32x16_bf16 v[28:43], v[20:23], v[104:107], v[28:43]
    ds_read_b128 v[12:15], v8 offset:57344
    ds_read_b128 v[16:19], v8 offset:61440
    s_waitcnt lgkmcnt(2)
    v_mfma_f32_32x32x16_bf16 v[44:59], v[24:27], v[104:107], v[44:59]
    s_waitcnt vmcnt(3) lgkmcnt(1)
    v_mfma_f32_32x32x16_bf16 v[28:43], v[12:15], v[108:111], v[28:43]
    ds_read_b128 v[20:23], v9 offset:57344
    ds_read_b128 v[24:27], v9 offset:61440
    s_waitcnt lgkmcnt(2)
    v_mfma_f32_32x32x16_bf16 v[44:59], v[16:19], v[108:111], v[44:59]
    s_waitcnt vmcnt(2) lgkmcnt(1)
    v_mfma_f32_32x32x16_bf16 v[28:43], v[20:23], v[112:115], v[28:43]
    ds_read_b128 v[12:15], v10 offset:57344
    ds_read_b128 v[16:19], v10 offset:61440
    s_waitcnt lgkmcnt(2)
    v_mfma_f32_32x32x16_bf16 v[44:59], v[24:27], v[112:115], v[44:59]
    s_waitcnt vmcnt(1) lgkmcnt(1)
    v_mfma_f32_32x32x16_bf16 v[28:43], v[12:15], v[60:63], v[28:43]
    ds_read_b128 v[20:23], v11 offset:57344
    ds_read_b128 v[24:27], v11 offset:61440
    s_waitcnt lgkmcnt(2)
    v_mfma_f32_32x32x16_bf16 v[44:59], v[16:19], v[60:63], v[44:59]
    s_waitcnt lgkmcnt(0)
    s_barrier
    s_waitcnt vmcnt(0)
    v_mfma_f32_32x32x16_bf16 v[28:43], v[20:23], v[64:67], v[28:43]
    v_mfma_f32_32x32x16_bf16 v[44:59], v[24:27], v[64:67], v[44:59]
    s_nop 10
    v_fma_f32 v28, v126, v28, v158
    v_fma_f32 v29, v127, v29, v159
    v_fma_f32 v30, v128, v30, v160
    v_fma_f32 v31, v129, v31, v161
    v_fma_f32 v32, v130, v32, v162
    v_fma_f32 v33, v131, v33, v163
    v_fma_f32 v34, v132, v34, v164
    v_fma_f32 v35, v133, v35, v165
    v_fma_f32 v36, v134, v36, v166
    v_fma_f32 v37, v135, v37, v167
    v_fma_f32 v38, v136, v38, v168
    v_fma_f32 v39, v137, v39, v169
    v_fma_f32 v40, v138, v40, v170
    v_fma_f32 v41, v139, v41, v171
    v_fma_f32 v42, v140, v42, v172
    v_fma_f32 v43, v141, v43, v173
    v_fma_f32 v44, v142, v44, v174
    v_fma_f32 v45, v143, v45, v175
    v_fma_f32 v46, v144, v46, v176
    v_fma_f32 v47, v145, v47, v177
    v_fma_f32 v48, v146, v48, v178
    v_fma_f32 v49, v147, v49, v179
    v_fma_f32 v50, v148, v50, v180
    v_fma_f32 v51, v149, v51, v181
    v_fma_f32 v52, v150, v52, v182
    v_fma_f32 v53, v151, v53, v183
    v_fma_f32 v54, v152, v54, v184
    v_fma_f32 v55, v153, v55, v185
    v_fma_f32 v56, v154, v56, v186
    v_fma_f32 v57, v155, v57, v187
    v_fma_f32 v58, v156, v58, v188
    v_fma_f32 v59, v157, v59, v189
    s_add_u32 s3, s49, 0
    buffer_store_dword v28, v124, s[44:47], s3 offen
    s_add_u32 s3, s49, 4096
    buffer_store_dword v29, v124, s[44:47], s3 offen
    s_add_u32 s3, s49, 8192
    buffer_store_dword v30, v124, s[44:47], s3 offen
    s_add_u32 s3, s49, 12288
    buffer_store_dword v31, v124, s[44:47], s3 offen
    s_add_u32 s3, s49, 32768
    buffer_store_dword v32, v124, s[44:47], s3 offen
    s_add_u32 s3, s49, 36864
    buffer_store_dword v33, v124, s[44:47], s3 offen
    s_add_u32 s3, s49, 40960
    buffer_store_dword v34, v124, s[44:47], s3 offen
    s_add_u32 s3, s49, 45056
    buffer_store_dword v35, v124, s[44:47], s3 offen
    s_add_u32 s3, s49, 65536
    buffer_store_dword v36, v124, s[44:47], s3 offen
    s_add_u32 s3, s49, 69632
    buffer_store_dword v37, v124, s[44:47], s3 offen
    s_add_u32 s3, s49, 73728
    buffer_store_dword v38, v124, s[44:47], s3 offen
    s_add_u32 s3, s49, 77824
    buffer_store_dword v39, v124, s[44:47], s3 offen
    s_add_u32 s3, s49, 98304
    buffer_store_dword v40, v124, s[44:47], s3 offen
    s_add_u32 s3, s49, 102400
    buffer_store_dword v41, v124, s[44:47], s3 offen
    s_add_u32 s3, s49, 106496
    buffer_store_dword v42, v124, s[44:47], s3 offen
    s_add_u32 s3, s49, 110592
    buffer_store_dword v43, v124, s[44:47], s3 offen
    s_add_u32 s3, s49, 131072
    buffer_store_dword v44, v124, s[44:47], s3 offen
    s_add_u32 s3, s49, 135168
    buffer_store_dword v45, v124, s[44:47], s3 offen
    s_add_u32 s3, s49, 139264
    buffer_store_dword v46, v124, s[44:47], s3 offen
    s_add_u32 s3, s49, 143360
    buffer_store_dword v47, v124, s[44:47], s3 offen
    s_add_u32 s3, s49, 163840
    buffer_store_dword v48, v124, s[44:47], s3 offen
    s_add_u32 s3, s49, 167936
    buffer_store_dword v49, v124, s[44:47], s3 offen
    s_add_u32 s3, s49, 172032
    buffer_store_dword v50, v124, s[44:47], s3 offen
    s_add_u32 s3, s49, 176128
    buffer_store_dword v51, v124, s[44:47], s3 offen
    s_add_u32 s3, s49, 196608
    buffer_store_dword v52, v124, s[44:47], s3 offen
    s_add_u32 s3, s49, 200704
    buffer_store_dword v53, v124, s[44:47], s3 offen
    s_add_u32 s3, s49, 204800
    buffer_store_dword v54, v124, s[44:47], s3 offen
    s_add_u32 s3, s49, 208896
    buffer_store_dword v55, v124, s[44:47], s3 offen
    s_add_u32 s3, s49, 229376
    buffer_store_dword v56, v124, s[44:47], s3 offen
    s_add_u32 s3, s49, 233472
    buffer_store_dword v57, v124, s[44:47], s3 offen
    s_add_u32 s3, s49, 237568
    buffer_store_dword v58, v124, s[44:47], s3 offen
    s_add_u32 s3, s49, 241664
    buffer_store_dword v59, v124, s[44:47], s3 offen
    s_waitcnt vmcnt(0)
Lend_g2_kernel:
    s_endpgm

.section .rodata,"a"
.p2align 6
.amdhsa_kernel g2_kernel
  .amdhsa_next_free_vgpr 204
  .amdhsa_next_free_sgpr 51
  .amdhsa_accum_offset 204
  .amdhsa_group_segment_fixed_size 0
  .amdhsa_kernarg_size 152
  .amdhsa_user_sgpr_count 2
  .amdhsa_user_sgpr_kernarg_segment_ptr 1
  .amdhsa_system_sgpr_workgroup_id_x 1
  .amdhsa_float_denorm_mode_32 3
.end_amdhsa_kernel
```

```asm
; @launch grid=(256,1,1) block=(256,1,1) lds=163840
.amdgcn_target "amdgcn-amd-amdhsa--gfx950"
.text
.globl gated_mix__ssm_conv_s5__ssm_conv_h3__prompt_kernel
.p2align 8
.type gated_mix__ssm_conv_s5__ssm_conv_h3__prompt_kernel,@function
gated_mix__ssm_conv_s5__ssm_conv_h3__prompt_kernel:
    s_cmp_ge_u32 s2, 256
    s_cbranch_scc1 Lend_gated_mix__ssm_conv_s5__ssm_conv_h3__prompt_kernel
    s_load_dwordx2 s[4:5], s[0:1], 144
    s_load_dwordx2 s[6:7], s[0:1], 24
    s_load_dwordx2 s[8:9], s[0:1], 32
    s_load_dwordx2 s[12:13], s[0:1], 0
    s_mov_b32 s14, 4194304
    s_mov_b32 s15, 131072
    s_load_dwordx2 s[16:17], s[0:1], 8
    s_mov_b32 s18, 2048
    s_mov_b32 s19, 131072
    s_load_dwordx2 s[20:21], s[0:1], 16
    s_mov_b32 s22, 2048
    s_mov_b32 s23, 131072
    s_load_dwordx2 s[24:25], s[0:1], 56
    s_mov_b32 s26, 2048
    s_mov_b32 s27, 131072
    s_load_dwordx2 s[28:29], s[0:1], 136
    s_mov_b32 s30, 256
    s_mov_b32 s31, 131072
    s_load_dwordx2 s[32:33], s[0:1], 80
    s_mov_b32 s34, 4194304
    s_mov_b32 s35, 131072
    s_load_dwordx2 s[36:37], s[0:1], 88
    s_mov_b32 s38, 4194304
    s_mov_b32 s39, 131072
    s_load_dwordx2 s[40:41], s[0:1], 96
    s_mov_b32 s42, 8192
    s_mov_b32 s43, 131072
    v_lshrrev_b32 v1, 6, v0
    s_nop 0
    v_readfirstlane_b32 s10, v1
    v_and_b32 v1, 63, v0
    s_and_b32 s45, s2, 7
    s_lshr_b32 s11, s45, 1
    s_lshl_b32 s11, s11, 2
    s_and_b32 s44, s45, 1
    s_lshl_b32 s44, s44, 3
    s_lshr_b32 s45, s2, 3
    s_and_b32 s3, s45, 3
    s_add_u32 s11, s11, s3
    s_lshr_b32 s45, s45, 2
    s_add_u32 s44, s44, s45
    s_and_b32 s47, s2, 7
    s_lshr_b32 s45, s47, 1
    s_lshl_b32 s45, s45, 3
    s_and_b32 s46, s47, 1
    s_lshl_b32 s46, s46, 2
    s_lshr_b32 s47, s2, 3
    s_and_b32 s3, s47, 7
    s_add_u32 s45, s45, s3
    s_lshr_b32 s47, s47, 3
    s_add_u32 s46, s46, s47
    v_lshlrev_b32 v2, 4, v1
    s_mov_b32 s47, 0xffff0000
    v_mov_b32 v3, 0
    s_and_b32 s3, s10, 1
    s_cmp_eq_u32 s3, 0
    s_waitcnt lgkmcnt(0)
    s_cselect_b32 s48, s6, s8
    s_cselect_b32 s49, s7, s9
    s_mov_b32 s50, 2097152
    s_mov_b32 s51, 131072
    v_lshrrev_b32 v12, 3, v1
    v_and_b32 v13, 7, v1
    s_lshl_b32 s6, s10, 5
    s_add_u32 s6, s6, 0
    v_add_u32 v14, s6, v12
    v_bfe_u32 v15, v14, 1, 3
    v_xor_b32 v15, v15, v13
    v_lshlrev_b32 v15, 4, v15
    v_and_b32 v4, 64, v14
    v_bfe_u32 v16, v14, 2, 1
    v_lshl_add_u32 v4, v16, 5, v4
    v_and_b32 v16, 1, v14
    v_lshl_add_u32 v4, v16, 4, v4
    v_bfe_u32 v16, v14, 5, 1
    v_lshl_add_u32 v4, v16, 3, v4
    v_bfe_u32 v16, v14, 3, 2
    v_lshl_add_u32 v4, v16, 1, v4
    v_bfe_u32 v16, v14, 1, 1
    v_add_u32 v4, v4, v16
    s_lshl_b32 s3, s11, 7
    v_add_u32 v4, s3, v4
    v_lshl_add_u32 v4, v4, 11, v15
    v_bfe_u32 v8, v14, 6, 1
    v_lshlrev_b32 v8, 5, v8
    v_and_b32 v16, 31, v14
    v_add_u32 v8, v8, v16
    s_lshl_b32 s3, s44, 6
    v_add_u32 v8, s3, v8
    v_lshl_add_u32 v8, v8, 11, v15
    s_lshl_b32 s6, s10, 5
    s_add_u32 s6, s6, 8
    v_add_u32 v14, s6, v12
    v_bfe_u32 v15, v14, 1, 3
    v_xor_b32 v15, v15, v13
    v_lshlrev_b32 v15, 4, v15
    v_and_b32 v5, 64, v14
    v_bfe_u32 v16, v14, 2, 1
    v_lshl_add_u32 v5, v16, 5, v5
    v_and_b32 v16, 1, v14
    v_lshl_add_u32 v5, v16, 4, v5
    v_bfe_u32 v16, v14, 5, 1
    v_lshl_add_u32 v5, v16, 3, v5
    v_bfe_u32 v16, v14, 3, 2
    v_lshl_add_u32 v5, v16, 1, v5
    v_bfe_u32 v16, v14, 1, 1
    v_add_u32 v5, v5, v16
    s_lshl_b32 s3, s11, 7
    v_add_u32 v5, s3, v5
    v_lshl_add_u32 v5, v5, 11, v15
    v_bfe_u32 v9, v14, 6, 1
    v_lshlrev_b32 v9, 5, v9
    v_and_b32 v16, 31, v14
    v_add_u32 v9, v9, v16
    s_lshl_b32 s3, s44, 6
    v_add_u32 v9, s3, v9
    v_lshl_add_u32 v9, v9, 11, v15
    s_lshl_b32 s6, s10, 5
    s_add_u32 s6, s6, 16
    v_add_u32 v14, s6, v12
    v_bfe_u32 v15, v14, 1, 3
    v_xor_b32 v15, v15, v13
    v_lshlrev_b32 v15, 4, v15
    v_and_b32 v6, 64, v14
    v_bfe_u32 v16, v14, 2, 1
    v_lshl_add_u32 v6, v16, 5, v6
    v_and_b32 v16, 1, v14
    v_lshl_add_u32 v6, v16, 4, v6
    v_bfe_u32 v16, v14, 5, 1
    v_lshl_add_u32 v6, v16, 3, v6
    v_bfe_u32 v16, v14, 3, 2
    v_lshl_add_u32 v6, v16, 1, v6
    v_bfe_u32 v16, v14, 1, 1
    v_add_u32 v6, v6, v16
    s_lshl_b32 s3, s11, 7
    v_add_u32 v6, s3, v6
    v_lshl_add_u32 v6, v6, 11, v15
    v_bfe_u32 v10, v14, 6, 1
    v_lshlrev_b32 v10, 5, v10
    v_and_b32 v16, 31, v14
    v_add_u32 v10, v10, v16
    s_lshl_b32 s3, s44, 6
    v_add_u32 v10, s3, v10
    v_lshl_add_u32 v10, v10, 11, v15
    s_lshl_b32 s6, s10, 5
    s_add_u32 s6, s6, 24
    v_add_u32 v14, s6, v12
    v_bfe_u32 v15, v14, 1, 3
    v_xor_b32 v15, v15, v13
    v_lshlrev_b32 v15, 4, v15
    v_and_b32 v7, 64, v14
    v_bfe_u32 v16, v14, 2, 1
    v_lshl_add_u32 v7, v16, 5, v7
    v_and_b32 v16, 1, v14
    v_lshl_add_u32 v7, v16, 4, v7
    v_bfe_u32 v16, v14, 5, 1
    v_lshl_add_u32 v7, v16, 3, v7
    v_bfe_u32 v16, v14, 3, 2
    v_lshl_add_u32 v7, v16, 1, v7
    v_bfe_u32 v16, v14, 1, 1
    v_add_u32 v7, v7, v16
    s_lshl_b32 s3, s11, 7
    v_add_u32 v7, s3, v7
    v_lshl_add_u32 v7, v7, 11, v15
    v_bfe_u32 v11, v14, 6, 1
    v_lshlrev_b32 v11, 5, v11
    v_and_b32 v16, 31, v14
    v_add_u32 v11, v11, v16
    s_lshl_b32 s3, s44, 6
    v_add_u32 v11, s3, v11
    v_lshl_add_u32 v11, v11, 11, v15
    s_lshl_b32 s6, s10, 12
    s_mov_b32 s7, 0
    s_add_u32 m0, s6, 0
    s_nop 0
    buffer_load_dwordx4 v4, s[12:15], s7 offen lds
    s_add_u32 m0, s6, 1024
    s_nop 0
    buffer_load_dwordx4 v5, s[12:15], s7 offen lds
    s_add_u32 m0, s6, 2048
    s_nop 0
    buffer_load_dwordx4 v6, s[12:15], s7 offen lds
    s_add_u32 m0, s6, 3072
    s_nop 0
    buffer_load_dwordx4 v7, s[12:15], s7 offen lds
    s_add_u32 m0, s6, 16384
    s_nop 0
    buffer_load_dwordx4 v8, s[48:51], s7 offen lds
    s_add_u32 m0, s6, 17408
    s_nop 0
    buffer_load_dwordx4 v9, s[48:51], s7 offen lds
    s_add_u32 m0, s6, 18432
    s_nop 0
    buffer_load_dwordx4 v10, s[48:51], s7 offen lds
    s_add_u32 m0, s6, 19456
    s_nop 0
    buffer_load_dwordx4 v11, s[48:51], s7 offen lds
    s_mov_b32 s7, 128
    s_add_u32 m0, s6, 32768
    s_nop 0
    buffer_load_dwordx4 v4, s[12:15], s7 offen lds
    s_add_u32 m0, s6, 33792
    s_nop 0
    buffer_load_dwordx4 v5, s[12:15], s7 offen lds
    s_add_u32 m0, s6, 34816
    s_nop 0
    buffer_load_dwordx4 v6, s[12:15], s7 offen lds
    s_add_u32 m0, s6, 35840
    s_nop 0
    buffer_load_dwordx4 v7, s[12:15], s7 offen lds
    s_add_u32 m0, s6, 49152
    s_nop 0
    buffer_load_dwordx4 v8, s[48:51], s7 offen lds
    s_add_u32 m0, s6, 50176
    s_nop 0
    buffer_load_dwordx4 v9, s[48:51], s7 offen lds
    s_add_u32 m0, s6, 51200
    s_nop 0
    buffer_load_dwordx4 v10, s[48:51], s7 offen lds
    s_add_u32 m0, s6, 52224
    s_nop 0
    buffer_load_dwordx4 v11, s[48:51], s7 offen lds
    s_mov_b32 s7, 256
    s_add_u32 m0, s6, 65536
    s_nop 0
    buffer_load_dwordx4 v4, s[12:15], s7 offen lds
    s_add_u32 m0, s6, 66560
    s_nop 0
    buffer_load_dwordx4 v5, s[12:15], s7 offen lds
    s_add_u32 m0, s6, 67584
    s_nop 0
    buffer_load_dwordx4 v6, s[12:15], s7 offen lds
    s_add_u32 m0, s6, 68608
    s_nop 0
    buffer_load_dwordx4 v7, s[12:15], s7 offen lds
    s_add_u32 m0, s6, 81920
    s_nop 0
    buffer_load_dwordx4 v8, s[48:51], s7 offen lds
    s_add_u32 m0, s6, 82944
    s_nop 0
    buffer_load_dwordx4 v9, s[48:51], s7 offen lds
    s_add_u32 m0, s6, 83968
    s_nop 0
    buffer_load_dwordx4 v10, s[48:51], s7 offen lds
    s_add_u32 m0, s6, 84992
    s_nop 0
    buffer_load_dwordx4 v11, s[48:51], s7 offen lds
    s_mov_b32 s7, 384
    s_add_u32 m0, s6, 98304
    s_nop 0
    buffer_load_dwordx4 v4, s[12:15], s7 offen lds
    s_add_u32 m0, s6, 99328
    s_nop 0
    buffer_load_dwordx4 v5, s[12:15], s7 offen lds
    s_add_u32 m0, s6, 100352
    s_nop 0
    buffer_load_dwordx4 v6, s[12:15], s7 offen lds
    s_add_u32 m0, s6, 101376
    s_nop 0
    buffer_load_dwordx4 v7, s[12:15], s7 offen lds
    s_add_u32 m0, s6, 114688
    s_nop 0
    buffer_load_dwordx4 v8, s[48:51], s7 offen lds
    s_add_u32 m0, s6, 115712
    s_nop 0
    buffer_load_dwordx4 v9, s[48:51], s7 offen lds
    s_add_u32 m0, s6, 116736
    s_nop 0
    buffer_load_dwordx4 v10, s[48:51], s7 offen lds
    s_add_u32 m0, s6, 117760
    s_nop 0
    buffer_load_dwordx4 v11, s[48:51], s7 offen lds
    s_or_b32 s3, s2, s10
    s_cmp_lg_u32 s3, 0
    s_cbranch_scc1 Lnonce_gate_1
    s_memrealtime s[8:9]
    s_waitcnt lgkmcnt(0)
    v_mov_b32 v12, s8
    v_mov_b32 v13, s9
    v_mov_b32 v14, 0
    buffer_store_dwordx2 v[12:13], v14, s[28:31], 0 offen sc0 sc1
    s_nop 1
Lnonce_gate_1:
    s_and_b32 s3, s10, 1
    s_lshl_b32 s3, s3, 5
    v_and_b32 v15, 31, v1
    v_add_u32 v15, s3, v15
    s_lshl_b32 s3, s44, 6
    v_add_u32 v16, s3, v15
    v_lshlrev_b32 v16, 1, v16
    buffer_load_ushort v17, v16, s[16:19], 0 offen
    buffer_load_ushort v18, v16, s[20:23], 0 offen
    buffer_load_ushort v19, v16, s[24:27], 0 offen
    s_add_u32 s16, s4, 8388608
    s_addc_u32 s17, s5, 0
    s_mov_b32 s18, 4194304
    s_mov_b32 s19, 131072
    v_and_b32 v20, 7, v1
    v_lshrrev_b32 v21, 3, v0
    s_lshl_b32 s3, s44, 7
    v_lshl_add_u32 v22, v20, 4, s3
    s_lshl_b32 s3, s11, 18
    v_lshl_add_u32 v23, v21, 13, v22
    v_add_u32 v23, s3, v23
    v_subrev_u32 v24, 6144, v23
    v_min_u32 v24, 0x7fff0000, v24
    v_subrev_u32 v25, 4096, v23
    v_min_u32 v25, 0x7fff0000, v25
    v_subrev_u32 v26, 2048, v23
    v_min_u32 v26, 0x7fff0000, v26
    v_lshlrev_b32 v27, 2, v22
    s_mov_b32 s20, 4096
    v_sub_u32 v21, 31, v21
    v_lshlrev_b32 v22, 1, v20
    v_xor_b32 v21, v21, v22
    v_lshlrev_b32 v21, 3, v21
    v_lshl_add_u32 v28, v20, 11, v21
    v_add_u32 v28, 138240, v28
    v_and_b32 v32, 15, v1
    v_lshrrev_b32 v22, 4, v1
    s_lshl_b32 s3, s10, 1
    v_xor_b32 v21, s3, v32
    v_lshlrev_b32 v21, 4, v21
    v_lshl_add_u32 v29, v22, 8, v21
    v_xor_b32 v21, s3, v32
    v_xor_b32 v21, 1, v21
    v_lshlrev_b32 v21, 4, v21
    v_lshl_add_u32 v30, v22, 8, v21
    s_lshl_b32 s3, s10, 12
    s_add_u32 s3, s3, 138240
    v_add_u32 v29, s3, v29
    s_add_u32 s3, s3, 2048
    v_add_u32 v30, s3, v30
    v_lshlrev_b32 v32, 4, v32
    v_lshl_add_u32 v31, v22, 12, v32
    s_lshl_b32 s21, s44, 18
    s_lshl_b32 s3, s10, 16
    s_add_u32 s21, s21, s3
    s_add_u32 s21, s21, 3840
    s_lshl_b32 s3, s11, 8
    s_sub_u32 s21, s21, s3
    buffer_load_dwordx4 v[76:79], v27, s[40:43], 0 offen offset:0
    buffer_load_dwordx4 v[80:83], v27, s[40:43], 0 offen offset:16
    buffer_load_dwordx4 v[84:87], v27, s[40:43], 0 offen offset:32
    buffer_load_dwordx4 v[88:91], v27, s[40:43], 0 offen offset:48
    buffer_load_dwordx4 v[32:35], v24, s[32:35], 0 offen
    buffer_load_dwordx4 v[36:39], v25, s[32:35], 0 offen
    buffer_load_dwordx4 v[40:43], v26, s[32:35], 0 offen
    buffer_load_dwordx4 v[44:47], v23, s[32:35], 0 offen offset:0
    buffer_load_dwordx4 v[48:51], v23, s[32:35], 0 offen offset:2048
    buffer_load_dwordx4 v[52:55], v23, s[32:35], s20 offen offset:0
    buffer_load_dwordx4 v[56:59], v23, s[32:35], s20 offen offset:2048
    buffer_load_dwordx4 v[60:63], v23, s[36:39], 0 offen offset:0
    buffer_load_dwordx4 v[64:67], v23, s[36:39], 0 offen offset:2048
    buffer_load_dwordx4 v[68:71], v23, s[36:39], s20 offen offset:0
    buffer_load_dwordx4 v[72:75], v23, s[36:39], s20 offen offset:2048
    s_load_dwordx2 s[22:23], s[0:1], 40
    s_load_dwordx2 s[24:25], s[0:1], 48
    s_load_dwordx2 s[26:27], s[0:1], 104
    s_load_dwordx2 s[32:33], s[0:1], 120
    s_mov_b32 s34, 2048
    s_mov_b32 s35, 131072
    s_load_dwordx2 s[36:37], s[0:1], 112
    s_mov_b32 s38, 2048
    s_mov_b32 s39, 131072
    v_and_b32 v123, 31, v1
    v_bfe_u32 v124, v123, 1, 3
    v_lshrrev_b32 v125, 5, v1
    v_xor_b32 v124, v124, v125
    v_lshlrev_b32 v124, 4, v124
    v_lshl_add_u32 v124, v123, 7, v124
    s_lshr_b32 s40, s10, 1
    s_lshl_b32 s40, s40, 13
    s_and_b32 s41, s10, 1
    s_lshl_b32 s41, s41, 13
    s_add_u32 s41, s41, 16384
    v_xor_b32 v125, 0, v124
    v_add_u32 v21, s40, v125
    v_add_u32 v115, s41, v125
    v_add_u32 v111, 0x10000, v21
    v_add_u32 v119, 0x10000, v115
    v_xor_b32 v125, 32, v124
    v_add_u32 v22, s40, v125
    v_add_u32 v116, s41, v125
    v_add_u32 v112, 0x10000, v22
    v_add_u32 v120, 0x10000, v116
    v_xor_b32 v125, 64, v124
    v_add_u32 v107, s40, v125
    v_add_u32 v117, s41, v125
    v_add_u32 v113, 0x10000, v107
    v_add_u32 v121, 0x10000, v117
    v_xor_b32 v125, 96, v124
    v_add_u32 v110, s40, v125
    v_add_u32 v118, s41, v125
    v_add_u32 v114, 0x10000, v110
    v_add_u32 v122, 0x10000, v118
    v_mov_b32 v220, 0
    v_mov_b32 v221, 0
    v_mov_b32 v222, 0
    v_mul_u32_u24 v123, 12, v0
    v_add_u32 v123, 131072, v123
    ds_write_b32 v123, v220
    ds_write_b32 v123, v220 offset:4
    ds_write_b32 v123, v220 offset:8
    s_waitcnt vmcnt(17)
    v_lshlrev_b32 v17, 16, v17
    s_waitcnt vmcnt(16)
    v_lshlrev_b32 v18, 16, v18
    s_waitcnt vmcnt(15)
    v_lshlrev_b32 v19, 16, v19
    v_mul_f32 v236, 1069066811, v19
    v_exp_f32 v236, v236
    s_nop 0
    v_cvt_pk_bf16_f32 v236, v236, v236
    v_lshlrev_b32 v236, 16, v236
    v_mul_f32 v237, v236, v17
    v_mul_f32 v238, v236, v18
    v_mul_f32 v237, 1069066811, v237
    v_exp_f32 v237, v237
    v_mul_f32 v238, 1042479491, v238
    v_fract_f32 v238, v238
    v_cos_f32 v239, v238
    v_sin_f32 v240, v238
    v_mul_f32 v224, v237, v239
    v_mul_f32 v225, v237, v240
    v_add_f32 v236, -1.0, v224
    v_mul_f32 v237, v17, v17
    v_fmac_f32 v237, v18, v18
    v_rcp_f32 v237, v237
    s_nop 0
    v_add_f32 v237, v237, v237
    v_mul_f32 v238, v236, v17
    v_fmac_f32 v238, v225, v18
    v_mul_f32 v239, v225, v17
    v_fma_f32 v239, -v236, v18, v239
    v_mul_f32 v226, v238, v237
    v_mul_f32 v227, v239, v237
    v_mul_f32 v236, v225, v225
    v_fma_f32 v236, v224, v224, -v236
    v_mul_f32 v237, v224, v225
    v_add_f32 v237, v237, v237
    v_mul_f32 v238, v237, v237
    v_fma_f32 v238, v236, v236, -v238
    v_mul_f32 v239, v236, v237
    v_add_f32 v239, v239, v239
    v_mul_f32 v236, v239, v239
    v_fma_f32 v236, v238, v238, -v236
    v_mul_f32 v237, v238, v239
    v_add_f32 v237, v237, v237
    v_mul_f32 v228, v237, v237
    v_fma_f32 v228, v236, v236, -v228
    v_mul_f32 v229, v236, v237
    v_add_f32 v229, v229, v229
    v_mul_f32 v236, v229, v229
    v_fma_f32 v236, v228, v228, -v236
    v_mul_f32 v237, v228, v229
    v_add_f32 v237, v237, v237
    v_mul_f32 v238, v237, v237
    v_fma_f32 v238, v236, v236, -v238
    v_mul_f32 v239, v236, v237
    v_add_f32 v239, v239, v239
    v_mul_f32 v230, v239, v239
    v_fma_f32 v230, v238, v238, -v230
    v_mul_f32 v231, v238, v239
    v_add_f32 v231, v231, v231
    s_mov_b32 s40, 0
    s_mov_b32 s41, -1
    s_lshr_b32 s3, s10, 1
    s_cmp_eq_u32 s3, 1
    s_cselect_b32 s42, -1, 0
    s_cselect_b32 s43, -1, 0
    v_cndmask_b32 v236, 1.0, v236, s[40:41]
    v_cndmask_b32 v237, 0, v237, s[40:41]
    v_cndmask_b32 v238, 1.0, v238, s[42:43]
    v_cndmask_b32 v239, 0, v239, s[42:43]
    v_mul_f32 v240, v237, v239
    v_fma_f32 v240, v236, v238, -v240
    v_mul_f32 v241, v236, v239
    v_fmac_f32 v241, v237, v238
    v_mul_f32 v236, v241, v229
    v_fma_f32 v236, v240, v228, -v236
    v_mul_f32 v237, v240, v229
    v_fmac_f32 v237, v241, v228
    v_mov_b32 v232, v240
    v_mov_b32 v233, v236
    v_mov_b32 v234, v241
    v_mov_b32 v235, v237
    s_cmp_lt_u32 s45, 16
    s_waitcnt lgkmcnt(0)
    s_cselect_b32 s52, s22, s24
    s_cselect_b32 s53, s23, s25
    s_mov_b32 s54, 2097152
    s_mov_b32 s55, 131072
    s_add_u32 s56, s4, 16777216
    s_addc_u32 s57, s5, 0
    s_mov_b32 s58, 4194304
    s_mov_b32 s59, 131072
    v_lshrrev_b32 v18, 3, v1
    v_and_b32 v19, 7, v1
    v_lshlrev_b32 v16, 4, v19
    v_lshl_add_u32 v16, v18, 11, v16
    v_lshlrev_b32 v17, 4, v18
    v_lshl_add_u32 v17, v19, 9, v17
    s_lshl_b32 s22, s46, 18
    s_lshl_b32 s3, s10, 16
    s_add_u32 s22, s22, s3
    s_and_b32 s3, s45, 15
    s_lshl_b32 s3, s3, 7
    s_add_u32 s22, s22, s3
    s_lshl_b32 s23, s46, 19
    s_lshl_b32 s3, s10, 17
    s_add_u32 s23, s23, s3
    s_lshl_b32 s3, s45, 12
    s_add_u32 s23, s23, s3
    s_add_u32 s60, s4, 20971520
    s_addc_u32 s61, s5, 0
    s_mov_b32 s62, 16384
    s_mov_b32 s63, 131072
    s_lshl_b32 s24, s11, 7
    s_lshl_b32 s3, s44, 3
    s_add_u32 s24, s24, s3
    s_lshl_b32 s3, s10, 1
    s_add_u32 s24, s24, s3
    s_lshl_b32 s3, s24, 2
    v_mov_b32 v18, s3
    s_lshl_b32 s24, s24, 11
    s_mov_b32 s25, 8192
    s_lshl_b32 s64, s46, 7
    s_lshl_b32 s3, s45, 2
    s_add_u32 s64, s64, s3
    s_add_u32 s64, s64, s10
    s_lshl_b32 s65, s64, 12
    s_add_u32 s68, s26, s65
    s_addc_u32 s69, s27, 0
    s_mov_b32 s70, 4096
    s_mov_b32 s71, 131072
    s_mul_i32 s26, s10, 21248
    v_and_b32 v19, 15, v1
    v_lshrrev_b32 v123, 4, v1
    v_add_u32 v220, 1, v19
    v_and_b32 v221, 3, v220
    v_mul_u32_u24 v221, 4160, v221
    v_and_b32 v220, 28, v220
    v_lshl_add_u32 v221, v220, 1, v221
    v_lshl_add_u32 v221, v123, 4, v221
    v_add_u32 v222, s26, v221
    s_add_u32 s3, s26, 17120
    v_lshlrev_b32 v220, 5, v19
    v_sub_u32 v220, s3, v220
    v_lshl_add_u32 v223, v123, 4, v220
    v_lshlrev_b32 v221, 3, v123
    v_sub_u32 v220, v220, v221
    v_add_u32 v236, 24, v220
    v_and_b32 v220, 1, v123
    v_lshlrev_b32 v220, 9, v220
    v_lshl_add_u32 v220, v19, 5, v220
    v_lshrrev_b32 v221, 1, v123
    v_lshl_add_u32 v237, v221, 4, v220
    s_add_u32 s72, s4, 21495808
    s_addc_u32 s73, s5, 0
    s_mov_b32 s74, 40960
    s_mov_b32 s75, 131072
    s_lshl_b32 s27, s44, 2
    s_add_u32 s27, s27, s10
    s_lshl_b32 s27, s27, 4
    s_add_u32 s27, s27, s11
    s_lshl_b32 s27, s27, 3
    s_add_u32 s27, s27, 0
    s_lshl_b32 s66, s46, 2
    s_add_u32 s66, s66, s10
    s_lshl_b32 s66, s66, 5
    s_add_u32 s66, s66, s45
    s_lshl_b32 s66, s66, 3
    s_add_u32 s66, s66, 8192
    s_lshl_b32 s67, s46, 1
    s_lshr_b32 s3, s45, 4
    s_add_u32 s67, s67, s3
    s_lshl_b32 s67, s67, 2
    s_and_b32 s3, s45, 15
    s_lshr_b32 s3, s3, 2
    s_add_u32 s67, s67, s3
    s_lshl_b32 s67, s67, 7
    s_add_u32 s67, s67, 0
    s_lshl_b32 s76, s46, 2
    s_add_u32 s76, s76, s10
    s_lshl_b32 s76, s76, 1
    s_and_b32 s3, s45, 1
    s_add_u32 s76, s76, s3
    s_lshl_b32 s76, s76, 7
    s_add_u32 s76, s76, 8192
    v_and_b32 v123, 16, v1
    v_cmp_eq_u32 vcc, 0, v123
    v_mov_b32 v123, s76
    v_mov_b32 v19, s67
    v_cndmask_b32 v19, v123, v19, vcc
    v_and_b32 v123, 15, v1
    v_lshl_add_u32 v19, v123, 3, v19
    s_barrier
    ds_read_b128 v[124:127], v21 offset:0
    ds_read_b128 v[132:135], v115 offset:0
    ds_read_b128 v[136:139], v115 offset:4096
    ds_read_b128 v[128:131], v21 offset:4096
    s_waitcnt lgkmcnt(2)
    v_mfma_f32_32x32x16_bf16 v[156:171], v[124:127], v[132:135], 0
    ds_read_b128 v[140:143], v22 offset:0
    ds_read_b128 v[148:151], v116 offset:0
    s_waitcnt lgkmcnt(3)
    v_mfma_f32_32x32x16_bf16 v[172:187], v[124:127], v[136:139], 0
    ds_read_b128 v[152:155], v116 offset:4096
    ds_read_b128 v[144:147], v22 offset:4096
    s_waitcnt lgkmcnt(4)
    v_mfma_f32_32x32x16_bf16 v[188:203], v[128:131], v[132:135], 0
    v_mfma_f32_32x32x16_bf16 v[204:219], v[128:131], v[136:139], 0
    s_waitcnt lgkmcnt(2)
    v_mfma_f32_32x32x16_bf16 v[156:171], v[140:143], v[148:151], v[156:171]
    ds_read_b128 v[124:127], v107 offset:0
    ds_read_b128 v[132:135], v117 offset:0
    s_waitcnt lgkmcnt(3)
    v_mfma_f32_32x32x16_bf16 v[172:187], v[140:143], v[152:155], v[172:187]
    ds_read_b128 v[136:139], v117 offset:4096
    ds_read_b128 v[128:131], v107 offset:4096
    s_waitcnt lgkmcnt(4)
    v_mfma_f32_32x32x16_bf16 v[188:203], v[144:147], v[148:151], v[188:203]
    v_mfma_f32_32x32x16_bf16 v[204:219], v[144:147], v[152:155], v[204:219]
    s_waitcnt lgkmcnt(2)
    v_mfma_f32_32x32x16_bf16 v[156:171], v[124:127], v[132:135], v[156:171]
    ds_read_b128 v[140:143], v110 offset:0
    ds_read_b128 v[148:151], v118 offset:0
    s_waitcnt lgkmcnt(3)
    v_mfma_f32_32x32x16_bf16 v[172:187], v[124:127], v[136:139], v[172:187]
    ds_read_b128 v[152:155], v118 offset:4096
    ds_read_b128 v[144:147], v110 offset:4096
    s_waitcnt lgkmcnt(4)
    v_mfma_f32_32x32x16_bf16 v[188:203], v[128:131], v[132:135], v[188:203]
    v_mfma_f32_32x32x16_bf16 v[204:219], v[128:131], v[136:139], v[204:219]
    s_waitcnt lgkmcnt(0)
    s_barrier
    v_mfma_f32_32x32x16_bf16 v[156:171], v[140:143], v[148:151], v[156:171]
    ds_read_b128 v[124:127], v21 offset:32768
    ds_read_b128 v[132:135], v115 offset:32768
    s_mov_b32 s7, 512
    v_mfma_f32_32x32x16_bf16 v[172:187], v[140:143], v[152:155], v[172:187]
    ds_read_b128 v[136:139], v115 offset:36864
    ds_read_b128 v[128:131], v21 offset:36864
    s_add_u32 m0, s6, 0
    v_mfma_f32_32x32x16_bf16 v[188:203], v[144:147], v[148:151], v[188:203]
    buffer_load_dwordx4 v4, s[12:15], s7 offen lds
    s_add_u32 m0, s6, 1024
    v_mfma_f32_32x32x16_bf16 v[204:219], v[144:147], v[152:155], v[204:219]
    buffer_load_dwordx4 v5, s[12:15], s7 offen lds
    s_waitcnt lgkmcnt(2)
    v_mfma_f32_32x32x16_bf16 v[156:171], v[124:127], v[132:135], v[156:171]
    ds_read_b128 v[140:143], v22 offset:32768
    ds_read_b128 v[148:151], v116 offset:32768
    s_waitcnt lgkmcnt(3)
    v_mfma_f32_32x32x16_bf16 v[172:187], v[124:127], v[136:139], v[172:187]
    ds_read_b128 v[152:155], v116 offset:36864
    ds_read_b128 v[144:147], v22 offset:36864
    s_add_u32 m0, s6, 2048
    s_waitcnt lgkmcnt(4)
    v_mfma_f32_32x32x16_bf16 v[188:203], v[128:131], v[132:135], v[188:203]
    buffer_load_dwordx4 v6, s[12:15], s7 offen lds
    s_add_u32 m0, s6, 3072
    v_mfma_f32_32x32x16_bf16 v[204:219], v[128:131], v[136:139], v[204:219]
    buffer_load_dwordx4 v7, s[12:15], s7 offen lds
    s_waitcnt lgkmcnt(2)
    v_mfma_f32_32x32x16_bf16 v[156:171], v[140:143], v[148:151], v[156:171]
    ds_read_b128 v[124:127], v107 offset:32768
    ds_read_b128 v[132:135], v117 offset:32768
    s_waitcnt lgkmcnt(3)
    v_mfma_f32_32x32x16_bf16 v[172:187], v[140:143], v[152:155], v[172:187]
    ds_read_b128 v[136:139], v117 offset:36864
    ds_read_b128 v[128:131], v107 offset:36864
    s_add_u32 m0, s6, 16384
    s_waitcnt lgkmcnt(4)
    v_mfma_f32_32x32x16_bf16 v[188:203], v[144:147], v[148:151], v[188:203]
    buffer_load_dwordx4 v8, s[48:51], s7 offen lds
    s_add_u32 m0, s6, 17408
    v_mfma_f32_32x32x16_bf16 v[204:219], v[144:147], v[152:155], v[204:219]
    buffer_load_dwordx4 v9, s[48:51], s7 offen lds
    s_waitcnt lgkmcnt(2)
    v_mfma_f32_32x32x16_bf16 v[156:171], v[124:127], v[132:135], v[156:171]
    ds_read_b128 v[140:143], v110 offset:32768
    ds_read_b128 v[148:151], v118 offset:32768
    s_waitcnt lgkmcnt(3)
    v_mfma_f32_32x32x16_bf16 v[172:187], v[124:127], v[136:139], v[172:187]
    ds_read_b128 v[152:155], v118 offset:36864
    ds_read_b128 v[144:147], v110 offset:36864
    s_add_u32 m0, s6, 18432
    s_waitcnt lgkmcnt(4)
    v_mfma_f32_32x32x16_bf16 v[188:203], v[128:131], v[132:135], v[188:203]
    buffer_load_dwordx4 v10, s[48:51], s7 offen lds
    s_add_u32 m0, s6, 19456
    v_mfma_f32_32x32x16_bf16 v[204:219], v[128:131], v[136:139], v[204:219]
    buffer_load_dwordx4 v11, s[48:51], s7 offen lds
    s_waitcnt lgkmcnt(0)
    s_barrier
    v_mfma_f32_32x32x16_bf16 v[156:171], v[140:143], v[148:151], v[156:171]
    ds_read_b128 v[124:127], v111 offset:0
    ds_read_b128 v[132:135], v119 offset:0
    s_mov_b32 s7, 640
    v_mfma_f32_32x32x16_bf16 v[172:187], v[140:143], v[152:155], v[172:187]
    ds_read_b128 v[136:139], v119 offset:4096
    ds_read_b128 v[128:131], v111 offset:4096
    s_add_u32 m0, s6, 32768
    v_mfma_f32_32x32x16_bf16 v[188:203], v[144:147], v[148:151], v[188:203]
    buffer_load_dwordx4 v4, s[12:15], s7 offen lds
    s_add_u32 m0, s6, 33792
    v_mfma_f32_32x32x16_bf16 v[204:219], v[144:147], v[152:155], v[204:219]
    buffer_load_dwordx4 v5, s[12:15], s7 offen lds
    s_waitcnt lgkmcnt(2)
    v_mfma_f32_32x32x16_bf16 v[156:171], v[124:127], v[132:135], v[156:171]
    ds_read_b128 v[140:143], v112 offset:0
    ds_read_b128 v[148:151], v120 offset:0
    s_waitcnt lgkmcnt(3)
    v_mfma_f32_32x32x16_bf16 v[172:187], v[124:127], v[136:139], v[172:187]
    ds_read_b128 v[152:155], v120 offset:4096
    ds_read_b128 v[144:147], v112 offset:4096
    s_add_u32 m0, s6, 34816
    s_waitcnt lgkmcnt(4)
    v_mfma_f32_32x32x16_bf16 v[188:203], v[128:131], v[132:135], v[188:203]
    buffer_load_dwordx4 v6, s[12:15], s7 offen lds
    s_add_u32 m0, s6, 35840
    v_mfma_f32_32x32x16_bf16 v[204:219], v[128:131], v[136:139], v[204:219]
    buffer_load_dwordx4 v7, s[12:15], s7 offen lds
    s_waitcnt lgkmcnt(2)
    v_mfma_f32_32x32x16_bf16 v[156:171], v[140:143], v[148:151], v[156:171]
    ds_read_b128 v[124:127], v113 offset:0
    ds_read_b128 v[132:135], v121 offset:0
    s_waitcnt lgkmcnt(3)
    v_mfma_f32_32x32x16_bf16 v[172:187], v[140:143], v[152:155], v[172:187]
    ds_read_b128 v[136:139], v121 offset:4096
    ds_read_b128 v[128:131], v113 offset:4096
    s_add_u32 m0, s6, 49152
    s_waitcnt lgkmcnt(4)
    v_mfma_f32_32x32x16_bf16 v[188:203], v[144:147], v[148:151], v[188:203]
    buffer_load_dwordx4 v8, s[48:51], s7 offen lds
    s_add_u32 m0, s6, 50176
    v_mfma_f32_32x32x16_bf16 v[204:219], v[144:147], v[152:155], v[204:219]
    buffer_load_dwordx4 v9, s[48:51], s7 offen lds
    s_waitcnt lgkmcnt(2)
    v_mfma_f32_32x32x16_bf16 v[156:171], v[124:127], v[132:135], v[156:171]
    ds_read_b128 v[140:143], v114 offset:0
    ds_read_b128 v[148:151], v122 offset:0
    s_waitcnt lgkmcnt(3)
    v_mfma_f32_32x32x16_bf16 v[172:187], v[124:127], v[136:139], v[172:187]
    ds_read_b128 v[152:155], v122 offset:4096
    ds_read_b128 v[144:147], v114 offset:4096
    s_add_u32 m0, s6, 51200
    s_waitcnt lgkmcnt(4)
    v_mfma_f32_32x32x16_bf16 v[188:203], v[128:131], v[132:135], v[188:203]
    buffer_load_dwordx4 v10, s[48:51], s7 offen lds
    s_add_u32 m0, s6, 52224
    v_mfma_f32_32x32x16_bf16 v[204:219], v[128:131], v[136:139], v[204:219]
    buffer_load_dwordx4 v11, s[48:51], s7 offen lds
    s_waitcnt lgkmcnt(0)
    s_barrier
    v_mfma_f32_32x32x16_bf16 v[156:171], v[140:143], v[148:151], v[156:171]
    ds_read_b128 v[124:127], v111 offset:32768
    ds_read_b128 v[132:135], v119 offset:32768
    s_mov_b32 s7, 768
    v_mfma_f32_32x32x16_bf16 v[172:187], v[140:143], v[152:155], v[172:187]
    ds_read_b128 v[136:139], v119 offset:36864
    ds_read_b128 v[128:131], v111 offset:36864
    s_add_u32 m0, s6, 65536
    v_mfma_f32_32x32x16_bf16 v[188:203], v[144:147], v[148:151], v[188:203]
    buffer_load_dwordx4 v4, s[12:15], s7 offen lds
    s_add_u32 m0, s6, 66560
    v_mfma_f32_32x32x16_bf16 v[204:219], v[144:147], v[152:155], v[204:219]
    buffer_load_dwordx4 v5, s[12:15], s7 offen lds
    s_waitcnt lgkmcnt(2)
    v_mfma_f32_32x32x16_bf16 v[156:171], v[124:127], v[132:135], v[156:171]
    ds_read_b128 v[140:143], v112 offset:32768
    ds_read_b128 v[148:151], v120 offset:32768
    buffer_load_dwordx4 a[0:3], v16, s[52:55], s22 offen
    s_add_u32 s22, s22, 16384
    buffer_load_dwordx4 a[4:7], v16, s[52:55], s22 offen
    s_waitcnt lgkmcnt(3)
    v_mfma_f32_32x32x16_bf16 v[172:187], v[124:127], v[136:139], v[172:187]
    ds_read_b128 v[152:155], v120 offset:36864
    ds_read_b128 v[144:147], v112 offset:36864
    s_add_u32 s22, s22, 16384
    buffer_load_dwordx4 a[8:11], v16, s[52:55], s22 offen
    s_add_u32 m0, s6, 67584
    s_waitcnt lgkmcnt(4)
    v_mfma_f32_32x32x16_bf16 v[188:203], v[128:131], v[132:135], v[188:203]
    buffer_load_dwordx4 v6, s[12:15], s7 offen lds
    s_add_u32 s22, s22, 16384
    buffer_load_dwordx4 a[12:15], v16, s[52:55], s22 offen
    s_waitcnt vmcnt(37)
    v_lshlrev_b32 v92, 16, v76
    s_add_u32 m0, s6, 68608
    v_mfma_f32_32x32x16_bf16 v[204:219], v[128:131], v[136:139], v[204:219]
    buffer_load_dwordx4 v7, s[12:15], s7 offen lds
    v_and_b32 v93, s47, v76
    v_lshlrev_b32 v94, 16, v77
    v_and_b32 v95, s47, v77
    s_waitcnt vmcnt(34)
    v_lshlrev_b32 v96, 16, v32
    s_waitcnt lgkmcnt(2)
    v_mfma_f32_32x32x16_bf16 v[156:171], v[140:143], v[148:151], v[156:171]
    ds_read_b128 v[124:127], v113 offset:32768
    ds_read_b128 v[132:135], v121 offset:32768
    s_waitcnt vmcnt(33)
    v_lshlrev_b32 v97, 16, v36
    s_waitcnt vmcnt(32)
    v_lshlrev_b32 v98, 16, v40
    s_waitcnt vmcnt(31)
    v_lshlrev_b32 v99, 16, v44
    s_waitcnt lgkmcnt(3)
    v_mfma_f32_32x32x16_bf16 v[172:187], v[140:143], v[152:155], v[172:187]
    ds_read_b128 v[136:139], v121 offset:36864
    ds_read_b128 v[128:131], v113 offset:36864
    s_waitcnt vmcnt(30)
    v_lshlrev_b32 v100, 16, v48
    s_waitcnt vmcnt(29)
    v_lshlrev_b32 v101, 16, v52
    s_add_u32 m0, s6, 81920
    s_waitcnt lgkmcnt(4)
    v_mfma_f32_32x32x16_bf16 v[188:203], v[144:147], v[148:151], v[188:203]
    buffer_load_dwordx4 v8, s[48:51], s7 offen lds
    s_waitcnt vmcnt(29)
    v_lshlrev_b32 v102, 16, v56
    v_mul_f32 v103, v95, v96
    v_mul_f32 v104, v95, v97
    s_add_u32 m0, s6, 82944
    v_mfma_f32_32x32x16_bf16 v[204:219], v[144:147], v[152:155], v[204:219]
    buffer_load_dwordx4 v9, s[48:51], s7 offen lds
    v_mul_f32 v105, v95, v98
    v_mul_f32 v106, v95, v99
    v_fmac_f32 v103, v94, v97
    v_fmac_f32 v104, v94, v98
    s_waitcnt lgkmcnt(2)
    v_mfma_f32_32x32x16_bf16 v[156:171], v[124:127], v[132:135], v[156:171]
    ds_read_b128 v[140:143], v114 offset:32768
    ds_read_b128 v[148:151], v122 offset:32768
    v_fmac_f32 v105, v94, v99
    v_fmac_f32 v106, v94, v100
    v_fmac_f32 v103, v93, v98
    s_waitcnt lgkmcnt(3)
    v_mfma_f32_32x32x16_bf16 v[172:187], v[124:127], v[136:139], v[172:187]
    ds_read_b128 v[152:155], v122 offset:36864
    ds_read_b128 v[144:147], v114 offset:36864
    v_fmac_f32 v104, v93, v99
    v_fmac_f32 v105, v93, v100
    s_add_u32 m0, s6, 83968
    s_waitcnt lgkmcnt(4)
    v_mfma_f32_32x32x16_bf16 v[188:203], v[128:131], v[132:135], v[188:203]
    buffer_load_dwordx4 v10, s[48:51], s7 offen lds
    v_fmac_f32 v106, v93, v101
    v_fmac_f32 v103, v92, v99
    v_fmac_f32 v104, v92, v100
    s_add_u32 m0, s6, 84992
    v_mfma_f32_32x32x16_bf16 v[204:219], v[128:131], v[136:139], v[204:219]
    buffer_load_dwordx4 v11, s[48:51], s7 offen lds
    v_fmac_f32 v105, v92, v101
    v_fmac_f32 v106, v92, v102
    s_waitcnt vmcnt(31)
    v_lshlrev_b32 v96, 16, v60
    s_waitcnt vmcnt(30)
    v_lshlrev_b32 v97, 16, v64
    s_waitcnt lgkmcnt(0)
    s_waitcnt vmcnt(20)
    s_barrier
    v_mfma_f32_32x32x16_bf16 v[156:171], v[140:143], v[148:151], v[156:171]
    ds_read_b128 v[124:127], v21 offset:0
    ds_read_b128 v[132:135], v115 offset:0
    v_lshlrev_b32 v98, 16, v68
    v_lshlrev_b32 v99, 16, v72
    s_mov_b32 s7, 896
    v_mfma_f32_32x32x16_bf16 v[172:187], v[140:143], v[152:155], v[172:187]
    ds_read_b128 v[136:139], v115 offset:4096
    ds_read_b128 v[128:131], v21 offset:4096
    v_mul_f32 v103, v103, v96
    v_mul_f32 v104, v104, v97
    s_add_u32 m0, s6, 98304
    v_mfma_f32_32x32x16_bf16 v[188:203], v[144:147], v[148:151], v[188:203]
    buffer_load_dwordx4 v4, s[12:15], s7 offen lds
    v_mul_f32 v105, v105, v98
    v_mul_f32 v106, v106, v99
    v_cvt_pk_bf16_f32 v108, v106, v105
    s_add_u32 m0, s6, 99328
    v_mfma_f32_32x32x16_bf16 v[204:219], v[144:147], v[152:155], v[204:219]
    buffer_load_dwordx4 v5, s[12:15], s7 offen lds
    v_cvt_pk_bf16_f32 v109, v104, v103
    ds_write_b64 v28, v[108:109] offset:0
    v_lshlrev_b32 v92, 16, v78
    v_and_b32 v93, s47, v78
    s_waitcnt lgkmcnt(3)
    v_mfma_f32_32x32x16_bf16 v[156:171], v[124:127], v[132:135], v[156:171]
    ds_read_b128 v[140:143], v22 offset:0
    ds_read_b128 v[148:151], v116 offset:0
    v_lshlrev_b32 v94, 16, v79
    v_and_b32 v95, s47, v79
    v_and_b32 v96, s47, v32
    s_waitcnt lgkmcnt(4)
    v_mfma_f32_32x32x16_bf16 v[172:187], v[124:127], v[136:139], v[172:187]
    ds_read_b128 v[152:155], v116 offset:4096
    ds_read_b128 v[144:147], v22 offset:4096
    v_and_b32 v97, s47, v36
    v_and_b32 v98, s47, v40
    s_add_u32 m0, s6, 100352
    s_waitcnt lgkmcnt(5)
    v_mfma_f32_32x32x16_bf16 v[188:203], v[128:131], v[132:135], v[188:203]
    buffer_load_dwordx4 v6, s[12:15], s7 offen lds
    v_and_b32 v99, s47, v44
    v_and_b32 v100, s47, v48
    v_and_b32 v101, s47, v52
    s_add_u32 m0, s6, 101376
    v_mfma_f32_32x32x16_bf16 v[204:219], v[128:131], v[136:139], v[204:219]
    buffer_load_dwordx4 v7, s[12:15], s7 offen lds
    v_and_b32 v102, s47, v56
    v_mul_f32 v103, v95, v96
    v_mul_f32 v104, v95, v97
    v_mul_f32 v105, v95, v98
    s_waitcnt lgkmcnt(2)
    v_mfma_f32_32x32x16_bf16 v[156:171], v[140:143], v[148:151], v[156:171]
    ds_read_b128 v[124:127], v107 offset:0
    ds_read_b128 v[132:135], v117 offset:0
    v_mul_f32 v106, v95, v99
    v_fmac_f32 v103, v94, v97
    v_fmac_f32 v104, v94, v98
    s_waitcnt lgkmcnt(3)
    v_mfma_f32_32x32x16_bf16 v[172:187], v[140:143], v[152:155], v[172:187]
    ds_read_b128 v[136:139], v117 offset:4096
    ds_read_b128 v[128:131], v107 offset:4096
    v_fmac_f32 v105, v94, v99
    v_fmac_f32 v106, v94, v100
    s_add_u32 m0, s6, 114688
    s_waitcnt lgkmcnt(4)
    v_mfma_f32_32x32x16_bf16 v[188:203], v[144:147], v[148:151], v[188:203]
    buffer_load_dwordx4 v8, s[48:51], s7 offen lds
    v_fmac_f32 v103, v93, v98
    v_fmac_f32 v104, v93, v99
    v_fmac_f32 v105, v93, v100
    s_add_u32 m0, s6, 115712
    v_mfma_f32_32x32x16_bf16 v[204:219], v[144:147], v[152:155], v[204:219]
    buffer_load_dwordx4 v9, s[48:51], s7 offen lds
    v_fmac_f32 v106, v93, v101
    v_fmac_f32 v103, v92, v99
    v_fmac_f32 v104, v92, v100
    v_fmac_f32 v105, v92, v101
    s_waitcnt lgkmcnt(2)
    v_mfma_f32_32x32x16_bf16 v[156:171], v[124:127], v[132:135], v[156:171]
    ds_read_b128 v[140:143], v110 offset:0
    ds_read_b128 v[148:151], v118 offset:0
    v_fmac_f32 v106, v92, v102
    v_and_b32 v96, s47, v60
    v_and_b32 v97, s47, v64
    s_waitcnt lgkmcnt(3)
    v_mfma_f32_32x32x16_bf16 v[172:187], v[124:127], v[136:139], v[172:187]
    ds_read_b128 v[152:155], v118 offset:4096
    ds_read_b128 v[144:147], v110 offset:4096
    v_and_b32 v98, s47, v68
    v_and_b32 v99, s47, v72
    s_add_u32 m0, s6, 116736
    s_waitcnt lgkmcnt(4)
    v_mfma_f32_32x32x16_bf16 v[188:203], v[128:131], v[132:135], v[188:203]
    buffer_load_dwordx4 v10, s[48:51], s7 offen lds
    v_mul_f32 v103, v103, v96
    v_mul_f32 v104, v104, v97
    v_mul_f32 v105, v105, v98
    s_add_u32 m0, s6, 117760
    v_mfma_f32_32x32x16_bf16 v[204:219], v[128:131], v[136:139], v[204:219]
    buffer_load_dwordx4 v11, s[48:51], s7 offen lds
    v_mul_f32 v106, v106, v99
    v_cvt_pk_bf16_f32 v108, v106, v105
    v_cvt_pk_bf16_f32 v109, v104, v103
    ds_write_b64 v28, v[108:109] offset:256
    s_waitcnt lgkmcnt(1)
    s_waitcnt vmcnt(20)
    s_barrier
    v_mfma_f32_32x32x16_bf16 v[156:171], v[140:143], v[148:151], v[156:171]
    ds_read_b128 v[124:127], v21 offset:32768
    ds_read_b128 v[132:135], v115 offset:32768
    v_lshlrev_b32 v92, 16, v80
    v_and_b32 v93, s47, v80
    s_mov_b32 s7, 1024
    v_mfma_f32_32x32x16_bf16 v[172:187], v[140:143], v[152:155], v[172:187]
    ds_read_b128 v[136:139], v115 offset:36864
    ds_read_b128 v[128:131], v21 offset:36864
    v_lshlrev_b32 v94, 16, v81
    v_and_b32 v95, s47, v81
    s_add_u32 m0, s6, 0
    v_mfma_f32_32x32x16_bf16 v[188:203], v[144:147], v[148:151], v[188:203]
    buffer_load_dwordx4 v4, s[12:15], s7 offen lds
    v_lshlrev_b32 v96, 16, v33
    v_lshlrev_b32 v97, 16, v37
    v_lshlrev_b32 v98, 16, v41
    s_add_u32 m0, s6, 1024
    v_mfma_f32_32x32x16_bf16 v[204:219], v[144:147], v[152:155], v[204:219]
    buffer_load_dwordx4 v5, s[12:15], s7 offen lds
    v_lshlrev_b32 v99, 16, v45
    v_lshlrev_b32 v100, 16, v49
    v_lshlrev_b32 v101, 16, v53
    v_lshlrev_b32 v102, 16, v57
    s_waitcnt lgkmcnt(2)
    v_mfma_f32_32x32x16_bf16 v[156:171], v[124:127], v[132:135], v[156:171]
    ds_read_b128 v[140:143], v22 offset:32768
    ds_read_b128 v[148:151], v116 offset:32768
    v_mul_f32 v103, v95, v96
    v_mul_f32 v104, v95, v97
    v_mul_f32 v105, v95, v98
    s_waitcnt lgkmcnt(3)
    v_mfma_f32_32x32x16_bf16 v[172:187], v[124:127], v[136:139], v[172:187]
    ds_read_b128 v[152:155], v116 offset:36864
    ds_read_b128 v[144:147], v22 offset:36864
    v_mul_f32 v106, v95, v99
    v_fmac_f32 v103, v94, v97
    s_add_u32 m0, s6, 2048
    s_waitcnt lgkmcnt(4)
    v_mfma_f32_32x32x16_bf16 v[188:203], v[128:131], v[132:135], v[188:203]
    buffer_load_dwordx4 v6, s[12:15], s7 offen lds
    v_fmac_f32 v104, v94, v98
    v_fmac_f32 v105, v94, v99
    v_fmac_f32 v106, v94, v100
    s_add_u32 m0, s6, 3072
    v_mfma_f32_32x32x16_bf16 v[204:219], v[128:131], v[136:139], v[204:219]
    buffer_load_dwordx4 v7, s[12:15], s7 offen lds
    v_fmac_f32 v103, v93, v98
    v_fmac_f32 v104, v93, v99
    v_fmac_f32 v105, v93, v100
    v_fmac_f32 v106, v93, v101
    s_waitcnt lgkmcnt(2)
    v_mfma_f32_32x32x16_bf16 v[156:171], v[140:143], v[148:151], v[156:171]
    ds_read_b128 v[124:127], v107 offset:32768
    ds_read_b128 v[132:135], v117 offset:32768
    v_fmac_f32 v103, v92, v99
    v_fmac_f32 v104, v92, v100
    v_fmac_f32 v105, v92, v101
    s_waitcnt lgkmcnt(3)
    v_mfma_f32_32x32x16_bf16 v[172:187], v[140:143], v[152:155], v[172:187]
    ds_read_b128 v[136:139], v117 offset:36864
    ds_read_b128 v[128:131], v107 offset:36864
    v_fmac_f32 v106, v92, v102
    v_lshlrev_b32 v96, 16, v61
    s_add_u32 m0, s6, 16384
    s_waitcnt lgkmcnt(4)
    v_mfma_f32_32x32x16_bf16 v[188:203], v[144:147], v[148:151], v[188:203]
    buffer_load_dwordx4 v8, s[48:51], s7 offen lds
    v_lshlrev_b32 v97, 16, v65
    v_lshlrev_b32 v98, 16, v69
    v_lshlrev_b32 v99, 16, v73
    s_add_u32 m0, s6, 17408
    v_mfma_f32_32x32x16_bf16 v[204:219], v[144:147], v[152:155], v[204:219]
    buffer_load_dwordx4 v9, s[48:51], s7 offen lds
    v_mul_f32 v103, v103, v96
    v_mul_f32 v104, v104, v97
    v_mul_f32 v105, v105, v98
    v_mul_f32 v106, v106, v99
    s_waitcnt lgkmcnt(2)
    v_mfma_f32_32x32x16_bf16 v[156:171], v[124:127], v[132:135], v[156:171]
    ds_read_b128 v[140:143], v110 offset:32768
    ds_read_b128 v[148:151], v118 offset:32768
    v_cvt_pk_bf16_f32 v108, v106, v105
    v_cvt_pk_bf16_f32 v109, v104, v103
    ds_write_b64 v28, v[108:109] offset:512
    s_waitcnt lgkmcnt(4)
    v_mfma_f32_32x32x16_bf16 v[172:187], v[124:127], v[136:139], v[172:187]
    ds_read_b128 v[152:155], v118 offset:36864
    ds_read_b128 v[144:147], v110 offset:36864
    v_lshlrev_b32 v92, 16, v82
    v_and_b32 v93, s47, v82
    s_add_u32 m0, s6, 18432
    s_waitcnt lgkmcnt(5)
    v_mfma_f32_32x32x16_bf16 v[188:203], v[128:131], v[132:135], v[188:203]
    buffer_load_dwordx4 v10, s[48:51], s7 offen lds
    v_lshlrev_b32 v94, 16, v83
    v_and_b32 v95, s47, v83
    v_and_b32 v96, s47, v33
    s_add_u32 m0, s6, 19456
    v_mfma_f32_32x32x16_bf16 v[204:219], v[128:131], v[136:139], v[204:219]
    buffer_load_dwordx4 v11, s[48:51], s7 offen lds
    v_and_b32 v97, s47, v37
    v_and_b32 v98, s47, v41
    v_and_b32 v99, s47, v45
    v_and_b32 v100, s47, v49
    s_waitcnt lgkmcnt(0)
    s_waitcnt vmcnt(16)
    s_barrier
    v_mfma_f32_32x32x16_bf16 v[156:171], v[140:143], v[148:151], v[156:171]
    ds_read_b128 v[124:127], v111 offset:0
    ds_read_b128 v[132:135], v119 offset:0
    v_and_b32 v101, s47, v53
    v_and_b32 v102, s47, v57
    s_mov_b32 s7, 1152
    v_mfma_f32_32x32x16_bf16 v[172:187], v[140:143], v[152:155], v[172:187]
    ds_read_b128 v[136:139], v119 offset:4096
    ds_read_b128 v[128:131], v111 offset:4096
    v_mul_f32 v103, v95, v96
    v_mul_f32 v104, v95, v97
    s_add_u32 m0, s6, 32768
    v_mfma_f32_32x32x16_bf16 v[188:203], v[144:147], v[148:151], v[188:203]
    buffer_load_dwordx4 v4, s[12:15], s7 offen lds
    v_mul_f32 v105, v95, v98
    v_mul_f32 v106, v95, v99
    v_fmac_f32 v103, v94, v97
    s_add_u32 m0, s6, 33792
    v_mfma_f32_32x32x16_bf16 v[204:219], v[144:147], v[152:155], v[204:219]
    buffer_load_dwordx4 v5, s[12:15], s7 offen lds
    v_fmac_f32 v104, v94, v98
    v_fmac_f32 v105, v94, v99
    v_fmac_f32 v106, v94, v100
    v_fmac_f32 v103, v93, v98
    s_waitcnt lgkmcnt(2)
    v_mfma_f32_32x32x16_bf16 v[156:171], v[124:127], v[132:135], v[156:171]
    ds_read_b128 v[140:143], v112 offset:0
    ds_read_b128 v[148:151], v120 offset:0
    v_fmac_f32 v104, v93, v99
    v_fmac_f32 v105, v93, v100
    v_fmac_f32 v106, v93, v101
    s_waitcnt lgkmcnt(3)
    v_mfma_f32_32x32x16_bf16 v[172:187], v[124:127], v[136:139], v[172:187]
    ds_read_b128 v[152:155], v120 offset:4096
    ds_read_b128 v[144:147], v112 offset:4096
    v_fmac_f32 v103, v92, v99
    v_fmac_f32 v104, v92, v100
    s_add_u32 m0, s6, 34816
    s_waitcnt lgkmcnt(4)
    v_mfma_f32_32x32x16_bf16 v[188:203], v[128:131], v[132:135], v[188:203]
    buffer_load_dwordx4 v6, s[12:15], s7 offen lds
    v_fmac_f32 v105, v92, v101
    v_fmac_f32 v106, v92, v102
    v_and_b32 v96, s47, v61
    s_add_u32 m0, s6, 35840
    v_mfma_f32_32x32x16_bf16 v[204:219], v[128:131], v[136:139], v[204:219]
    buffer_load_dwordx4 v7, s[12:15], s7 offen lds
    v_and_b32 v97, s47, v65
    v_and_b32 v98, s47, v69
    v_and_b32 v99, s47, v73
    v_mul_f32 v103, v103, v96
    s_waitcnt lgkmcnt(2)
    v_mfma_f32_32x32x16_bf16 v[156:171], v[140:143], v[148:151], v[156:171]
    ds_read_b128 v[124:127], v113 offset:0
    ds_read_b128 v[132:135], v121 offset:0
    v_mul_f32 v104, v104, v97
    v_mul_f32 v105, v105, v98
    v_mul_f32 v106, v106, v99
    s_waitcnt lgkmcnt(3)
    v_mfma_f32_32x32x16_bf16 v[172:187], v[140:143], v[152:155], v[172:187]
    ds_read_b128 v[136:139], v121 offset:4096
    ds_read_b128 v[128:131], v113 offset:4096
    v_cvt_pk_bf16_f32 v108, v106, v105
    v_cvt_pk_bf16_f32 v109, v104, v103
    s_add_u32 m0, s6, 49152
    s_waitcnt lgkmcnt(4)
    v_mfma_f32_32x32x16_bf16 v[188:203], v[144:147], v[148:151], v[188:203]
    buffer_load_dwordx4 v8, s[48:51], s7 offen lds
    ds_write_b64 v28, v[108:109] offset:768
    v_lshlrev_b32 v92, 16, v84
    v_and_b32 v93, s47, v84
    s_add_u32 m0, s6, 50176
    v_mfma_f32_32x32x16_bf16 v[204:219], v[144:147], v[152:155], v[204:219]
    buffer_load_dwordx4 v9, s[48:51], s7 offen lds
    v_lshlrev_b32 v94, 16, v85
    v_and_b32 v95, s47, v85
    v_lshlrev_b32 v96, 16, v34
    v_lshlrev_b32 v97, 16, v38
    s_waitcnt lgkmcnt(3)
    v_mfma_f32_32x32x16_bf16 v[156:171], v[124:127], v[132:135], v[156:171]
    ds_read_b128 v[140:143], v114 offset:0
    ds_read_b128 v[148:151], v122 offset:0
    v_lshlrev_b32 v98, 16, v42
    v_lshlrev_b32 v99, 16, v46
    v_lshlrev_b32 v100, 16, v50
    s_waitcnt lgkmcnt(4)
    v_mfma_f32_32x32x16_bf16 v[172:187], v[124:127], v[136:139], v[172:187]
    ds_read_b128 v[152:155], v122 offset:4096
    ds_read_b128 v[144:147], v114 offset:4096
    v_lshlrev_b32 v101, 16, v54
    v_lshlrev_b32 v102, 16, v58
    s_add_u32 m0, s6, 51200
    s_waitcnt lgkmcnt(5)
    v_mfma_f32_32x32x16_bf16 v[188:203], v[128:131], v[132:135], v[188:203]
    buffer_load_dwordx4 v10, s[48:51], s7 offen lds
    v_mul_f32 v103, v95, v96
    v_mul_f32 v104, v95, v97
    v_mul_f32 v105, v95, v98
    s_add_u32 m0, s6, 52224
    v_mfma_f32_32x32x16_bf16 v[204:219], v[128:131], v[136:139], v[204:219]
    buffer_load_dwordx4 v11, s[48:51], s7 offen lds
    v_mul_f32 v106, v95, v99
    v_fmac_f32 v103, v94, v97
    v_fmac_f32 v104, v94, v98
    v_fmac_f32 v105, v94, v99
    s_waitcnt lgkmcnt(0)
    s_waitcnt vmcnt(16)
    s_barrier
    v_mfma_f32_32x32x16_bf16 v[156:171], v[140:143], v[148:151], v[156:171]
    ds_read_b128 v[124:127], v111 offset:32768
    ds_read_b128 v[132:135], v119 offset:32768
    v_fmac_f32 v106, v94, v100
    v_fmac_f32 v103, v93, v98
    s_mov_b32 s7, 1280
    v_mfma_f32_32x32x16_bf16 v[172:187], v[140:143], v[152:155], v[172:187]
    ds_read_b128 v[136:139], v119 offset:36864
    ds_read_b128 v[128:131], v111 offset:36864
    v_fmac_f32 v104, v93, v99
    v_fmac_f32 v105, v93, v100
    s_add_u32 m0, s6, 65536
    v_mfma_f32_32x32x16_bf16 v[188:203], v[144:147], v[148:151], v[188:203]
    buffer_load_dwordx4 v4, s[12:15], s7 offen lds
    v_fmac_f32 v106, v93, v101
    v_fmac_f32 v103, v92, v99
    v_fmac_f32 v104, v92, v100
    s_add_u32 m0, s6, 66560
    v_mfma_f32_32x32x16_bf16 v[204:219], v[144:147], v[152:155], v[204:219]
    buffer_load_dwordx4 v5, s[12:15], s7 offen lds
    v_fmac_f32 v105, v92, v101
    v_fmac_f32 v106, v92, v102
    v_lshlrev_b32 v96, 16, v62
    v_lshlrev_b32 v97, 16, v66
    s_waitcnt lgkmcnt(2)
    v_mfma_f32_32x32x16_bf16 v[156:171], v[124:127], v[132:135], v[156:171]
    ds_read_b128 v[140:143], v112 offset:32768
    ds_read_b128 v[148:151], v120 offset:32768
    v_lshlrev_b32 v98, 16, v70
    v_lshlrev_b32 v99, 16, v74
    v_mul_f32 v103, v103, v96
    s_waitcnt lgkmcnt(3)
    v_mfma_f32_32x32x16_bf16 v[172:187], v[124:127], v[136:139], v[172:187]
    ds_read_b128 v[152:155], v120 offset:36864
    ds_read_b128 v[144:147], v112 offset:36864
    v_mul_f32 v104, v104, v97
    v_mul_f32 v105, v105, v98
    s_add_u32 m0, s6, 67584
    s_waitcnt lgkmcnt(4)
    v_mfma_f32_32x32x16_bf16 v[188:203], v[128:131], v[132:135], v[188:203]
    buffer_load_dwordx4 v6, s[12:15], s7 offen lds
    v_mul_f32 v106, v106, v99
    v_cvt_pk_bf16_f32 v108, v106, v105
    v_cvt_pk_bf16_f32 v109, v104, v103
    s_add_u32 m0, s6, 68608
    v_mfma_f32_32x32x16_bf16 v[204:219], v[128:131], v[136:139], v[204:219]
    buffer_load_dwordx4 v7, s[12:15], s7 offen lds
    ds_write_b64 v28, v[108:109] offset:1024
    v_lshlrev_b32 v92, 16, v86
    v_and_b32 v93, s47, v86
    v_lshlrev_b32 v94, 16, v87
    s_waitcnt lgkmcnt(3)
    v_mfma_f32_32x32x16_bf16 v[156:171], v[140:143], v[148:151], v[156:171]
    ds_read_b128 v[124:127], v113 offset:32768
    ds_read_b128 v[132:135], v121 offset:32768
    v_and_b32 v95, s47, v87
    v_and_b32 v96, s47, v34
    v_and_b32 v97, s47, v38
    s_waitcnt lgkmcnt(4)
    v_mfma_f32_32x32x16_bf16 v[172:187], v[140:143], v[152:155], v[172:187]
    ds_read_b128 v[136:139], v121 offset:36864
    ds_read_b128 v[128:131], v113 offset:36864
    v_and_b32 v98, s47, v42
    v_and_b32 v99, s47, v46
    s_add_u32 m0, s6, 81920
    s_waitcnt lgkmcnt(5)
    v_mfma_f32_32x32x16_bf16 v[188:203], v[144:147], v[148:151], v[188:203]
    buffer_load_dwordx4 v8, s[48:51], s7 offen lds
    v_and_b32 v100, s47, v50
    v_and_b32 v101, s47, v54
    v_and_b32 v102, s47, v58
    s_add_u32 m0, s6, 82944
    v_mfma_f32_32x32x16_bf16 v[204:219], v[144:147], v[152:155], v[204:219]
    buffer_load_dwordx4 v9, s[48:51], s7 offen lds
    v_mul_f32 v103, v95, v96
    v_mul_f32 v104, v95, v97
    v_mul_f32 v105, v95, v98
    v_mul_f32 v106, v95, v99
    s_waitcnt lgkmcnt(2)
    v_mfma_f32_32x32x16_bf16 v[156:171], v[124:127], v[132:135], v[156:171]
    ds_read_b128 v[140:143], v114 offset:32768
    ds_read_b128 v[148:151], v122 offset:32768
    v_fmac_f32 v103, v94, v97
    v_fmac_f32 v104, v94, v98
    v_fmac_f32 v105, v94, v99
    s_waitcnt lgkmcnt(3)
    v_mfma_f32_32x32x16_bf16 v[172:187], v[124:127], v[136:139], v[172:187]
    ds_read_b128 v[152:155], v122 offset:36864
    ds_read_b128 v[144:147], v114 offset:36864
    v_fmac_f32 v106, v94, v100
    v_fmac_f32 v103, v93, v98
    s_add_u32 m0, s6, 83968
    s_waitcnt lgkmcnt(4)
    v_mfma_f32_32x32x16_bf16 v[188:203], v[128:131], v[132:135], v[188:203]
    buffer_load_dwordx4 v10, s[48:51], s7 offen lds
    v_fmac_f32 v104, v93, v99
    v_fmac_f32 v105, v93, v100
    v_fmac_f32 v106, v93, v101
    s_add_u32 m0, s6, 84992
    v_mfma_f32_32x32x16_bf16 v[204:219], v[128:131], v[136:139], v[204:219]
    buffer_load_dwordx4 v11, s[48:51], s7 offen lds
    v_fmac_f32 v103, v92, v99
    v_fmac_f32 v104, v92, v100
    v_fmac_f32 v105, v92, v101
    v_fmac_f32 v106, v92, v102
    s_waitcnt lgkmcnt(0)
    s_waitcnt vmcnt(16)
    s_barrier
    v_mfma_f32_32x32x16_bf16 v[156:171], v[140:143], v[148:151], v[156:171]
    ds_read_b128 v[124:127], v21 offset:0
    ds_read_b128 v[132:135], v115 offset:0
    v_and_b32 v96, s47, v62
    v_and_b32 v97, s47, v66
    s_mov_b32 s7, 1408
    v_mfma_f32_32x32x16_bf16 v[172:187], v[140:143], v[152:155], v[172:187]
    ds_read_b128 v[136:139], v115 offset:4096
    ds_read_b128 v[128:131], v21 offset:4096
    v_and_b32 v98, s47, v70
    v_and_b32 v99, s47, v74
    s_add_u32 m0, s6, 98304
    v_mfma_f32_32x32x16_bf16 v[188:203], v[144:147], v[148:151], v[188:203]
    buffer_load_dwordx4 v4, s[12:15], s7 offen lds
    v_mul_f32 v103, v103, v96
    v_mul_f32 v104, v104, v97
    v_mul_f32 v105, v105, v98
    s_add_u32 m0, s6, 99328
    v_mfma_f32_32x32x16_bf16 v[204:219], v[144:147], v[152:155], v[204:219]
    buffer_load_dwordx4 v5, s[12:15], s7 offen lds
    v_mul_f32 v106, v106, v99
    v_cvt_pk_bf16_f32 v108, v106, v105
    v_cvt_pk_bf16_f32 v109, v104, v103
    ds_write_b64 v28, v[108:109] offset:1280
    s_waitcnt lgkmcnt(3)
    v_mfma_f32_32x32x16_bf16 v[156:171], v[124:127], v[132:135], v[156:171]
    ds_read_b128 v[140:143], v22 offset:0
    ds_read_b128 v[148:151], v116 offset:0
    v_lshlrev_b32 v92, 16, v88
    v_and_b32 v93, s47, v88
    v_lshlrev_b32 v94, 16, v89
    s_waitcnt lgkmcnt(4)
    v_mfma_f32_32x32x16_bf16 v[172:187], v[124:127], v[136:139], v[172:187]
    ds_read_b128 v[152:155], v116 offset:4096
    ds_read_b128 v[144:147], v22 offset:4096
    v_and_b32 v95, s47, v89
    v_lshlrev_b32 v96, 16, v35
    s_add_u32 m0, s6, 100352
    s_waitcnt lgkmcnt(5)
    v_mfma_f32_32x32x16_bf16 v[188:203], v[128:131], v[132:135], v[188:203]
    buffer_load_dwordx4 v6, s[12:15], s7 offen lds
    v_lshlrev_b32 v97, 16, v39
    v_lshlrev_b32 v98, 16, v43
    v_lshlrev_b32 v99, 16, v47
    s_add_u32 m0, s6, 101376
    v_mfma_f32_32x32x16_bf16 v[204:219], v[128:131], v[136:139], v[204:219]
    buffer_load_dwordx4 v7, s[12:15], s7 offen lds
    v_lshlrev_b32 v100, 16, v51
    v_lshlrev_b32 v101, 16, v55
    v_lshlrev_b32 v102, 16, v59
    v_mul_f32 v103, v95, v96
    s_waitcnt lgkmcnt(2)
    v_mfma_f32_32x32x16_bf16 v[156:171], v[140:143], v[148:151], v[156:171]
    ds_read_b128 v[124:127], v107 offset:0
    ds_read_b128 v[132:135], v117 offset:0
    v_mul_f32 v104, v95, v97
    v_mul_f32 v105, v95, v98
    v_mul_f32 v106, v95, v99
    s_waitcnt lgkmcnt(3)
    v_mfma_f32_32x32x16_bf16 v[172:187], v[140:143], v[152:155], v[172:187]
    ds_read_b128 v[136:139], v117 offset:4096
    ds_read_b128 v[128:131], v107 offset:4096
    v_fmac_f32 v103, v94, v97
    v_fmac_f32 v104, v94, v98
    s_add_u32 m0, s6, 114688
    s_waitcnt lgkmcnt(4)
    v_mfma_f32_32x32x16_bf16 v[188:203], v[144:147], v[148:151], v[188:203]
    buffer_load_dwordx4 v8, s[48:51], s7 offen lds
    v_fmac_f32 v105, v94, v99
    v_fmac_f32 v106, v94, v100
    v_fmac_f32 v103, v93, v98
    s_add_u32 m0, s6, 115712
    v_mfma_f32_32x32x16_bf16 v[204:219], v[144:147], v[152:155], v[204:219]
    buffer_load_dwordx4 v9, s[48:51], s7 offen lds
    v_fmac_f32 v104, v93, v99
    v_fmac_f32 v105, v93, v100
    v_fmac_f32 v106, v93, v101
    v_fmac_f32 v103, v92, v99
    s_waitcnt lgkmcnt(2)
    v_mfma_f32_32x32x16_bf16 v[156:171], v[124:127], v[132:135], v[156:171]
    ds_read_b128 v[140:143], v110 offset:0
    ds_read_b128 v[148:151], v118 offset:0
    v_fmac_f32 v104, v92, v100
    v_fmac_f32 v105, v92, v101
    v_fmac_f32 v106, v92, v102
    s_waitcnt lgkmcnt(3)
    v_mfma_f32_32x32x16_bf16 v[172:187], v[124:127], v[136:139], v[172:187]
    ds_read_b128 v[152:155], v118 offset:4096
    ds_read_b128 v[144:147], v110 offset:4096
    v_lshlrev_b32 v96, 16, v63
    v_lshlrev_b32 v97, 16, v67
    s_add_u32 m0, s6, 116736
    s_waitcnt lgkmcnt(4)
    v_mfma_f32_32x32x16_bf16 v[188:203], v[128:131], v[132:135], v[188:203]
    buffer_load_dwordx4 v10, s[48:51], s7 offen lds
    v_lshlrev_b32 v98, 16, v71
    v_lshlrev_b32 v99, 16, v75
    v_mul_f32 v103, v103, v96
    s_add_u32 m0, s6, 117760
    v_mfma_f32_32x32x16_bf16 v[204:219], v[128:131], v[136:139], v[204:219]
    buffer_load_dwordx4 v11, s[48:51], s7 offen lds
    v_mul_f32 v104, v104, v97
    v_mul_f32 v105, v105, v98
    v_mul_f32 v106, v106, v99
    v_cvt_pk_bf16_f32 v108, v106, v105
    s_waitcnt lgkmcnt(0)
    s_waitcnt vmcnt(16)
    s_barrier
    v_mfma_f32_32x32x16_bf16 v[156:171], v[140:143], v[148:151], v[156:171]
    ds_read_b128 v[124:127], v21 offset:32768
    ds_read_b128 v[132:135], v115 offset:32768
    v_cvt_pk_bf16_f32 v109, v104, v103
    ds_write_b64 v28, v[108:109] offset:1536
    s_mov_b32 s7, 1536
    v_mfma_f32_32x32x16_bf16 v[172:187], v[140:143], v[152:155], v[172:187]
    ds_read_b128 v[136:139], v115 offset:36864
    ds_read_b128 v[128:131], v21 offset:36864
    v_lshlrev_b32 v92, 16, v90
    v_and_b32 v93, s47, v90
    s_add_u32 m0, s6, 0
    v_mfma_f32_32x32x16_bf16 v[188:203], v[144:147], v[148:151], v[188:203]
    buffer_load_dwordx4 v4, s[12:15], s7 offen lds
    v_lshlrev_b32 v94, 16, v91
    v_and_b32 v95, s47, v91
    v_and_b32 v96, s47, v35
    s_add_u32 m0, s6, 1024
    v_mfma_f32_32x32x16_bf16 v[204:219], v[144:147], v[152:155], v[204:219]
    buffer_load_dwordx4 v5, s[12:15], s7 offen lds
    v_and_b32 v97, s47, v39
    v_and_b32 v98, s47, v43
    v_and_b32 v99, s47, v47
    v_and_b32 v100, s47, v51
    s_waitcnt lgkmcnt(3)
    v_mfma_f32_32x32x16_bf16 v[156:171], v[124:127], v[132:135], v[156:171]
    ds_read_b128 v[140:143], v22 offset:32768
    ds_read_b128 v[148:151], v116 offset:32768
    v_and_b32 v101, s47, v55
    v_and_b32 v102, s47, v59
    v_mul_f32 v103, v95, v96
    s_waitcnt lgkmcnt(3)
    v_mfma_f32_32x32x16_bf16 v[172:187], v[124:127], v[136:139], v[172:187]
    ds_read_b128 v[152:155], v116 offset:36864
    ds_read_b128 v[144:147], v22 offset:36864
    v_mul_f32 v104, v95, v97
    v_mul_f32 v105, v95, v98
    s_add_u32 m0, s6, 2048
    s_waitcnt lgkmcnt(4)
    v_mfma_f32_32x32x16_bf16 v[188:203], v[128:131], v[132:135], v[188:203]
    buffer_load_dwordx4 v6, s[12:15], s7 offen lds
    v_mul_f32 v106, v95, v99
    v_fmac_f32 v103, v94, v97
    v_fmac_f32 v104, v94, v98
    s_add_u32 m0, s6, 3072
    v_mfma_f32_32x32x16_bf16 v[204:219], v[128:131], v[136:139], v[204:219]
    buffer_load_dwordx4 v7, s[12:15], s7 offen lds
    v_fmac_f32 v105, v94, v99
    v_fmac_f32 v106, v94, v100
    v_fmac_f32 v103, v93, v98
    v_fmac_f32 v104, v93, v99
    s_waitcnt lgkmcnt(2)
    v_mfma_f32_32x32x16_bf16 v[156:171], v[140:143], v[148:151], v[156:171]
    ds_read_b128 v[124:127], v107 offset:32768
    ds_read_b128 v[132:135], v117 offset:32768
    v_fmac_f32 v105, v93, v100
    v_fmac_f32 v106, v93, v101
    v_fmac_f32 v103, v92, v99
    s_waitcnt lgkmcnt(3)
    v_mfma_f32_32x32x16_bf16 v[172:187], v[140:143], v[152:155], v[172:187]
    ds_read_b128 v[136:139], v117 offset:36864
    ds_read_b128 v[128:131], v107 offset:36864
    v_fmac_f32 v104, v92, v100
    v_fmac_f32 v105, v92, v101
    s_add_u32 m0, s6, 16384
    s_waitcnt lgkmcnt(4)
    v_mfma_f32_32x32x16_bf16 v[188:203], v[144:147], v[148:151], v[188:203]
    buffer_load_dwordx4 v8, s[48:51], s7 offen lds
    v_fmac_f32 v106, v92, v102
    v_and_b32 v96, s47, v63
    v_and_b32 v97, s47, v67
    s_add_u32 m0, s6, 17408
    v_mfma_f32_32x32x16_bf16 v[204:219], v[144:147], v[152:155], v[204:219]
    buffer_load_dwordx4 v9, s[48:51], s7 offen lds
    v_and_b32 v98, s47, v71
    v_and_b32 v99, s47, v75
    v_mul_f32 v103, v103, v96
    v_mul_f32 v104, v104, v97
    s_waitcnt lgkmcnt(2)
    v_mfma_f32_32x32x16_bf16 v[156:171], v[124:127], v[132:135], v[156:171]
    ds_read_b128 v[140:143], v110 offset:32768
    ds_read_b128 v[148:151], v118 offset:32768
    v_mul_f32 v105, v105, v98
    v_mul_f32 v106, v106, v99
    v_cvt_pk_bf16_f32 v108, v106, v105
    s_waitcnt lgkmcnt(3)
    v_mfma_f32_32x32x16_bf16 v[172:187], v[124:127], v[136:139], v[172:187]
    ds_read_b128 v[152:155], v118 offset:36864
    ds_read_b128 v[144:147], v110 offset:36864
    v_cvt_pk_bf16_f32 v109, v104, v103
    ds_write_b64 v28, v[108:109] offset:1792
    s_add_u32 m0, s6, 18432
    s_waitcnt lgkmcnt(5)
    v_mfma_f32_32x32x16_bf16 v[188:203], v[128:131], v[132:135], v[188:203]
    buffer_load_dwordx4 v10, s[48:51], s7 offen lds
    s_add_u32 m0, s6, 19456
    v_mfma_f32_32x32x16_bf16 v[204:219], v[128:131], v[136:139], v[204:219]
    buffer_load_dwordx4 v11, s[48:51], s7 offen lds
    s_waitcnt lgkmcnt(1)
    s_waitcnt vmcnt(16)
    s_waitcnt lgkmcnt(0)
    s_barrier
    v_mfma_f32_32x32x16_bf16 v[156:171], v[140:143], v[148:151], v[156:171]
    ds_read_b128 v[124:127], v111 offset:0
    ds_read_b128 v[132:135], v119 offset:0
    ds_read_b128 v[32:35], v29 offset:0
    ds_read_b128 v[36:39], v29 offset:1024
    s_mov_b32 s7, 1664
    v_mfma_f32_32x32x16_bf16 v[172:187], v[140:143], v[152:155], v[172:187]
    ds_read_b128 v[136:139], v119 offset:4096
    ds_read_b128 v[128:131], v111 offset:4096
    ds_read_b128 v[40:43], v30 offset:0
    ds_read_b128 v[44:47], v30 offset:1024
    s_add_u32 m0, s6, 32768
    v_mfma_f32_32x32x16_bf16 v[188:203], v[144:147], v[148:151], v[188:203]
    buffer_load_dwordx4 v4, s[12:15], s7 offen lds
    s_waitcnt lgkmcnt(5)
    buffer_store_dwordx4 v[32:35], v31, s[16:19], s21 offen sc0 sc1
    s_add_u32 s21, s21, 16384
    s_waitcnt lgkmcnt(4)
    buffer_store_dwordx4 v[36:39], v31, s[16:19], s21 offen sc0 sc1
    s_add_u32 m0, s6, 33792
    v_mfma_f32_32x32x16_bf16 v[204:219], v[144:147], v[152:155], v[204:219]
    buffer_load_dwordx4 v5, s[12:15], s7 offen lds
    s_add_u32 s21, s21, 16384
    s_waitcnt lgkmcnt(1)
    buffer_store_dwordx4 v[40:43], v31, s[16:19], s21 offen sc0 sc1
    s_add_u32 s21, s21, 16384
    s_waitcnt lgkmcnt(0)
    buffer_store_dwordx4 v[44:47], v31, s[16:19], s21 offen sc0 sc1
    v_mfma_f32_32x32x16_bf16 v[156:171], v[124:127], v[132:135], v[156:171]
    ds_read_b128 v[140:143], v112 offset:0
    ds_read_b128 v[148:151], v120 offset:0
    v_subrev_u32 v98, 32, v2
    v_min_u32 v98, 0x7fff0000, v98
    v_subrev_u32 v99, 16, v2
    v_mfma_f32_32x32x16_bf16 v[172:187], v[124:127], v[136:139], v[172:187]
    ds_read_b128 v[152:155], v120 offset:4096
    ds_read_b128 v[144:147], v112 offset:4096
    v_min_u32 v99, 0x7fff0000, v99
    v_add_u32 v20, s26, v2
    s_add_u32 m0, s6, 34816
    v_mfma_f32_32x32x16_bf16 v[188:203], v[128:131], v[132:135], v[188:203]
    buffer_load_dwordx4 v6, s[12:15], s7 offen lds
    buffer_load_dwordx4 v[40:43], v2, s[32:35], 0 offen offset:0
    buffer_load_dwordx4 v[44:47], v2, s[32:35], 0 offen offset:1024
    buffer_load_dwordx4 v[24:27], v2, s[12:15], s24 offen offset:0
    s_add_u32 m0, s6, 35840
    v_mfma_f32_32x32x16_bf16 v[204:219], v[128:131], v[136:139], v[204:219]
    buffer_load_dwordx4 v7, s[12:15], s7 offen lds
    buffer_load_dwordx4 v[28:31], v2, s[12:15], s24 offen offset:1024
    buffer_load_dwordx4 v[32:35], v2, s[12:15], s24 offen offset:2048
    buffer_load_dwordx4 v[36:39], v2, s[12:15], s24 offen offset:3072
    buffer_load_dwordx4 v[72:75], v98, s[68:71], 0 offen
    s_waitcnt lgkmcnt(2)
    v_mfma_f32_32x32x16_bf16 v[156:171], v[140:143], v[148:151], v[156:171]
    ds_read_b128 v[124:127], v113 offset:0
    ds_read_b128 v[132:135], v121 offset:0
    buffer_load_dwordx2 v[84:85], v99, s[68:71], 0 offen
    buffer_load_dwordx4 v[56:59], v2, s[68:71], 0 offen offset:0
    buffer_load_dwordx2 v[76:77], v2, s[68:71], 0 offen offset:16
    s_waitcnt lgkmcnt(3)
    v_mfma_f32_32x32x16_bf16 v[172:187], v[140:143], v[152:155], v[172:187]
    ds_read_b128 v[136:139], v121 offset:4096
    ds_read_b128 v[128:131], v113 offset:4096
    buffer_load_dwordx4 v[60:63], v2, s[68:71], 0 offen offset:1024
    buffer_load_dwordx2 v[78:79], v2, s[68:71], 0 offen offset:1040
    s_add_u32 m0, s6, 49152
    s_waitcnt lgkmcnt(4)
    v_mfma_f32_32x32x16_bf16 v[188:203], v[144:147], v[148:151], v[188:203]
    buffer_load_dwordx4 v8, s[48:51], s7 offen lds
    buffer_load_dwordx4 v[64:67], v2, s[68:71], 0 offen offset:2048
    buffer_load_dwordx2 v[80:81], v2, s[68:71], 0 offen offset:2064
    buffer_load_dwordx4 v[68:71], v2, s[68:71], 0 offen offset:3072
    s_add_u32 m0, s6, 50176
    v_mfma_f32_32x32x16_bf16 v[204:219], v[144:147], v[152:155], v[204:219]
    buffer_load_dwordx4 v9, s[48:51], s7 offen lds
    buffer_load_dwordx2 v[82:83], v2, s[68:71], 0 offen offset:3088
    s_lshl_b32 s3, s64, 1
    v_mov_b32 v23, s3
    buffer_load_ushort v23, v23, s[36:39], 0 offen
    buffer_store_dwordx4 a[0:3], v17, s[56:59], s23 offen offset:0 sc0 sc1
    s_waitcnt lgkmcnt(2)
    v_mfma_f32_32x32x16_bf16 v[156:171], v[124:127], v[132:135], v[156:171]
    ds_read_b128 v[140:143], v114 offset:0
    ds_read_b128 v[148:151], v122 offset:0
    buffer_store_dwordx4 a[4:7], v17, s[56:59], s23 offen offset:128 sc0 sc1
    buffer_store_dwordx4 a[8:11], v17, s[56:59], s23 offen offset:256 sc0 sc1
    buffer_store_dwordx4 a[12:15], v17, s[56:59], s23 offen offset:384 sc0 sc1
    s_waitcnt lgkmcnt(3)
    v_mfma_f32_32x32x16_bf16 v[172:187], v[124:127], v[136:139], v[172:187]
    ds_read_b128 v[152:155], v122 offset:4096
    ds_read_b128 v[144:147], v114 offset:4096
    v_mov_b32 v14, 0
    buffer_load_dwordx2 v[12:13], v14, s[28:31], 0 offen sc0 sc1
    s_add_u32 m0, s6, 51200
    s_waitcnt lgkmcnt(4)
    v_mfma_f32_32x32x16_bf16 v[188:203], v[128:131], v[132:135], v[188:203]
    buffer_load_dwordx4 v10, s[48:51], s7 offen lds
    s_add_u32 m0, s6, 52224
    v_mfma_f32_32x32x16_bf16 v[204:219], v[128:131], v[136:139], v[204:219]
    buffer_load_dwordx4 v11, s[48:51], s7 offen lds
    s_waitcnt lgkmcnt(0)
    s_waitcnt vmcnt(42)
    s_barrier
    v_mfma_f32_32x32x16_bf16 v[156:171], v[140:143], v[148:151], v[156:171]
    ds_read_b128 v[124:127], v111 offset:32768
    ds_read_b128 v[132:135], v119 offset:32768
    s_mov_b32 s7, 1792
    v_mfma_f32_32x32x16_bf16 v[172:187], v[140:143], v[152:155], v[172:187]
    ds_read_b128 v[136:139], v119 offset:36864
    ds_read_b128 v[128:131], v111 offset:36864
    s_add_u32 m0, s6, 65536
    v_mfma_f32_32x32x16_bf16 v[188:203], v[144:147], v[148:151], v[188:203]
    buffer_load_dwordx4 v4, s[12:15], s7 offen lds
    s_add_u32 m0, s6, 66560
    v_mfma_f32_32x32x16_bf16 v[204:219], v[144:147], v[152:155], v[204:219]
    buffer_load_dwordx4 v5, s[12:15], s7 offen lds
    s_waitcnt lgkmcnt(2)
    v_mfma_f32_32x32x16_bf16 v[156:171], v[124:127], v[132:135], v[156:171]
    ds_read_b128 v[140:143], v112 offset:32768
    ds_read_b128 v[148:151], v120 offset:32768
    s_waitcnt lgkmcnt(3)
    v_mfma_f32_32x32x16_bf16 v[172:187], v[124:127], v[136:139], v[172:187]
    ds_read_b128 v[152:155], v120 offset:36864
    ds_read_b128 v[144:147], v112 offset:36864
    s_add_u32 m0, s6, 67584
    s_waitcnt lgkmcnt(4)
    v_mfma_f32_32x32x16_bf16 v[188:203], v[128:131], v[132:135], v[188:203]
    buffer_load_dwordx4 v6, s[12:15], s7 offen lds
    s_add_u32 m0, s6, 68608
    v_mfma_f32_32x32x16_bf16 v[204:219], v[128:131], v[136:139], v[204:219]
    buffer_load_dwordx4 v7, s[12:15], s7 offen lds
    s_waitcnt lgkmcnt(2)
    v_mfma_f32_32x32x16_bf16 v[156:171], v[140:143], v[148:151], v[156:171]
    ds_read_b128 v[124:127], v113 offset:32768
    ds_read_b128 v[132:135], v121 offset:32768
    s_waitcnt lgkmcnt(3)
    v_mfma_f32_32x32x16_bf16 v[172:187], v[140:143], v[152:155], v[172:187]
    ds_read_b128 v[136:139], v121 offset:36864
    ds_read_b128 v[128:131], v113 offset:36864
    s_add_u32 m0, s6, 81920
    s_waitcnt lgkmcnt(4)
    v_mfma_f32_32x32x16_bf16 v[188:203], v[144:147], v[148:151], v[188:203]
    buffer_load_dwordx4 v8, s[48:51], s7 offen lds
    s_add_u32 m0, s6, 82944
    v_mfma_f32_32x32x16_bf16 v[204:219], v[144:147], v[152:155], v[204:219]
    buffer_load_dwordx4 v9, s[48:51], s7 offen lds
    s_waitcnt lgkmcnt(2)
    v_mfma_f32_32x32x16_bf16 v[156:171], v[124:127], v[132:135], v[156:171]
    ds_read_b128 v[140:143], v114 offset:32768
    ds_read_b128 v[148:151], v122 offset:32768
    s_waitcnt lgkmcnt(3)
    v_mfma_f32_32x32x16_bf16 v[172:187], v[124:127], v[136:139], v[172:187]
    ds_read_b128 v[152:155], v122 offset:36864
    ds_read_b128 v[144:147], v114 offset:36864
    s_add_u32 m0, s6, 83968
    s_waitcnt lgkmcnt(4)
    v_mfma_f32_32x32x16_bf16 v[188:203], v[128:131], v[132:135], v[188:203]
    buffer_load_dwordx4 v10, s[48:51], s7 offen lds
    s_add_u32 m0, s6, 84992
    v_mfma_f32_32x32x16_bf16 v[204:219], v[128:131], v[136:139], v[204:219]
    buffer_load_dwordx4 v11, s[48:51], s7 offen lds
    s_waitcnt lgkmcnt(0)
    s_waitcnt vmcnt(42)
    s_barrier
    v_mfma_f32_32x32x16_bf16 v[156:171], v[140:143], v[148:151], v[156:171]
    ds_read_b128 v[124:127], v21 offset:0
    ds_read_b128 v[132:135], v115 offset:0
    s_mov_b32 s7, 1920
    v_mfma_f32_32x32x16_bf16 v[172:187], v[140:143], v[152:155], v[172:187]
    ds_read_b128 v[136:139], v115 offset:4096
    ds_read_b128 v[128:131], v21 offset:4096
    s_add_u32 m0, s6, 98304
    v_mfma_f32_32x32x16_bf16 v[188:203], v[144:147], v[148:151], v[188:203]
    buffer_load_dwordx4 v4, s[12:15], s7 offen lds
    s_add_u32 m0, s6, 99328
    v_mfma_f32_32x32x16_bf16 v[204:219], v[144:147], v[152:155], v[204:219]
    buffer_load_dwordx4 v5, s[12:15], s7 offen lds
    s_waitcnt lgkmcnt(2)
    v_mfma_f32_32x32x16_bf16 v[156:171], v[124:127], v[132:135], v[156:171]
    ds_read_b128 v[140:143], v22 offset:0
    ds_read_b128 v[148:151], v116 offset:0
    s_waitcnt vmcnt(36)
    v_lshlrev_b32 v50, 16, v40
    v_and_b32 v51, s47, v40
    s_waitcnt vmcnt(34)
    v_lshlrev_b32 v52, 16, v24
    s_waitcnt lgkmcnt(3)
    v_mfma_f32_32x32x16_bf16 v[172:187], v[124:127], v[136:139], v[172:187]
    ds_read_b128 v[152:155], v116 offset:4096
    ds_read_b128 v[144:147], v22 offset:4096
    v_and_b32 v53, s47, v24
    v_mul_f32 v48, v50, v52
    s_add_u32 m0, s6, 100352
    s_waitcnt lgkmcnt(4)
    v_mfma_f32_32x32x16_bf16 v[188:203], v[128:131], v[132:135], v[188:203]
    buffer_load_dwordx4 v6, s[12:15], s7 offen lds
    v_fmac_f32 v48, v51, v53
    s_waitcnt vmcnt(32)
    v_lshlrev_b32 v52, 16, v32
    v_and_b32 v53, s47, v32
    s_add_u32 m0, s6, 101376
    v_mfma_f32_32x32x16_bf16 v[204:219], v[128:131], v[136:139], v[204:219]
    buffer_load_dwordx4 v7, s[12:15], s7 offen lds
    v_mul_f32 v49, v50, v52
    v_fmac_f32 v49, v51, v53
    v_lshlrev_b32 v50, 16, v41
    v_and_b32 v51, s47, v41
    s_waitcnt lgkmcnt(2)
    v_mfma_f32_32x32x16_bf16 v[156:171], v[140:143], v[148:151], v[156:171]
    ds_read_b128 v[124:127], v107 offset:0
    ds_read_b128 v[132:135], v117 offset:0
    v_lshlrev_b32 v52, 16, v25
    v_and_b32 v53, s47, v25
    v_fmac_f32 v48, v50, v52
    s_waitcnt lgkmcnt(3)
    v_mfma_f32_32x32x16_bf16 v[172:187], v[140:143], v[152:155], v[172:187]
    ds_read_b128 v[136:139], v117 offset:4096
    ds_read_b128 v[128:131], v107 offset:4096
    v_fmac_f32 v48, v51, v53
    v_lshlrev_b32 v52, 16, v33
    s_add_u32 m0, s6, 114688
    s_waitcnt lgkmcnt(4)
    v_mfma_f32_32x32x16_bf16 v[188:203], v[144:147], v[148:151], v[188:203]
    buffer_load_dwordx4 v8, s[48:51], s7 offen lds
    v_and_b32 v53, s47, v33
    v_fmac_f32 v49, v50, v52
    v_fmac_f32 v49, v51, v53
    s_add_u32 m0, s6, 115712
    v_mfma_f32_32x32x16_bf16 v[204:219], v[144:147], v[152:155], v[204:219]
    buffer_load_dwordx4 v9, s[48:51], s7 offen lds
    v_lshlrev_b32 v50, 16, v42
    v_and_b32 v51, s47, v42
    v_lshlrev_b32 v52, 16, v26
    v_and_b32 v53, s47, v26
    s_waitcnt lgkmcnt(2)
    v_mfma_f32_32x32x16_bf16 v[156:171], v[124:127], v[132:135], v[156:171]
    ds_read_b128 v[140:143], v110 offset:0
    ds_read_b128 v[148:151], v118 offset:0
    v_fmac_f32 v48, v50, v52
    v_fmac_f32 v48, v51, v53
    v_lshlrev_b32 v52, 16, v34
    s_waitcnt lgkmcnt(3)
    v_mfma_f32_32x32x16_bf16 v[172:187], v[124:127], v[136:139], v[172:187]
    ds_read_b128 v[152:155], v118 offset:4096
    ds_read_b128 v[144:147], v110 offset:4096
    v_and_b32 v53, s47, v34
    v_fmac_f32 v49, v50, v52
    s_add_u32 m0, s6, 116736
    s_waitcnt lgkmcnt(4)
    v_mfma_f32_32x32x16_bf16 v[188:203], v[128:131], v[132:135], v[188:203]
    buffer_load_dwordx4 v10, s[48:51], s7 offen lds
    v_fmac_f32 v49, v51, v53
    v_lshlrev_b32 v50, 16, v43
    v_and_b32 v51, s47, v43
    s_add_u32 m0, s6, 117760
    v_mfma_f32_32x32x16_bf16 v[204:219], v[128:131], v[136:139], v[204:219]
    buffer_load_dwordx4 v11, s[48:51], s7 offen lds
    v_lshlrev_b32 v52, 16, v27
    v_and_b32 v53, s47, v27
    v_fmac_f32 v48, v50, v52
    v_fmac_f32 v48, v51, v53
    s_waitcnt lgkmcnt(0)
    s_waitcnt vmcnt(16)
    s_barrier
    v_mfma_f32_32x32x16_bf16 v[156:171], v[140:143], v[148:151], v[156:171]
    ds_read_b128 v[124:127], v21 offset:32768
    ds_read_b128 v[132:135], v115 offset:32768
    v_lshlrev_b32 v52, 16, v35
    v_and_b32 v53, s47, v35
    v_fmac_f32 v49, v50, v52
    v_mfma_f32_32x32x16_bf16 v[172:187], v[140:143], v[152:155], v[172:187]
    ds_read_b128 v[136:139], v115 offset:36864
    ds_read_b128 v[128:131], v21 offset:36864
    v_fmac_f32 v49, v51, v53
    v_lshlrev_b32 v50, 16, v44
    v_and_b32 v51, s47, v44
    v_mfma_f32_32x32x16_bf16 v[188:203], v[144:147], v[148:151], v[188:203]
    v_lshlrev_b32 v52, 16, v28
    v_and_b32 v53, s47, v28
    v_fmac_f32 v48, v50, v52
    v_fmac_f32 v48, v51, v53
    v_lshlrev_b32 v52, 16, v36
    v_mfma_f32_32x32x16_bf16 v[204:219], v[144:147], v[152:155], v[204:219]
    v_and_b32 v53, s47, v36
    v_fmac_f32 v49, v50, v52
    v_fmac_f32 v49, v51, v53
    v_lshlrev_b32 v50, 16, v45
    v_and_b32 v51, s47, v45
    s_waitcnt lgkmcnt(2)
    v_mfma_f32_32x32x16_bf16 v[156:171], v[124:127], v[132:135], v[156:171]
    ds_read_b128 v[140:143], v22 offset:32768
    ds_read_b128 v[148:151], v116 offset:32768
    v_lshlrev_b32 v52, 16, v29
    v_and_b32 v53, s47, v29
    v_fmac_f32 v48, v50, v52
    s_waitcnt lgkmcnt(3)
    v_mfma_f32_32x32x16_bf16 v[172:187], v[124:127], v[136:139], v[172:187]
    ds_read_b128 v[152:155], v116 offset:36864
    ds_read_b128 v[144:147], v22 offset:36864
    v_fmac_f32 v48, v51, v53
    v_lshlrev_b32 v52, 16, v37
    v_and_b32 v53, s47, v37
    s_waitcnt lgkmcnt(4)
    v_mfma_f32_32x32x16_bf16 v[188:203], v[128:131], v[132:135], v[188:203]
    v_fmac_f32 v49, v50, v52
    v_fmac_f32 v49, v51, v53
    v_lshlrev_b32 v50, 16, v46
    v_and_b32 v51, s47, v46
    v_lshlrev_b32 v52, 16, v30
    v_mfma_f32_32x32x16_bf16 v[204:219], v[128:131], v[136:139], v[204:219]
    v_and_b32 v53, s47, v30
    v_fmac_f32 v48, v50, v52
    v_fmac_f32 v48, v51, v53
    v_lshlrev_b32 v52, 16, v38
    v_and_b32 v53, s47, v38
    s_waitcnt lgkmcnt(2)
    v_mfma_f32_32x32x16_bf16 v[156:171], v[140:143], v[148:151], v[156:171]
    ds_read_b128 v[124:127], v107 offset:32768
    ds_read_b128 v[132:135], v117 offset:32768
    v_fmac_f32 v49, v50, v52
    v_fmac_f32 v49, v51, v53
    v_lshlrev_b32 v50, 16, v47
    s_waitcnt lgkmcnt(3)
    v_mfma_f32_32x32x16_bf16 v[172:187], v[140:143], v[152:155], v[172:187]
    ds_read_b128 v[136:139], v117 offset:36864
    ds_read_b128 v[128:131], v107 offset:36864
    v_and_b32 v51, s47, v47
    v_lshlrev_b32 v52, 16, v31
    v_and_b32 v53, s47, v31
    s_waitcnt lgkmcnt(4)
    v_mfma_f32_32x32x16_bf16 v[188:203], v[144:147], v[148:151], v[188:203]
    v_fmac_f32 v48, v50, v52
    v_fmac_f32 v48, v51, v53
    v_lshlrev_b32 v52, 16, v39
    v_and_b32 v53, s47, v39
    v_fmac_f32 v49, v50, v52
    v_mfma_f32_32x32x16_bf16 v[204:219], v[144:147], v[152:155], v[204:219]
    v_fmac_f32 v49, v51, v53
    v_add_f32_dpp v48, v48, v48 row_shr:1 row_mask:0xf bank_mask:0xf bound_ctrl:0
    s_nop 0
    v_add_f32_dpp v49, v49, v49 row_shr:1 row_mask:0xf bank_mask:0xf bound_ctrl:0
    v_add_f32_dpp v48, v48, v48 row_shr:2 row_mask:0xf bank_mask:0xf bound_ctrl:0
    s_nop 0
    v_add_f32_dpp v49, v49, v49 row_shr:2 row_mask:0xf bank_mask:0xf bound_ctrl:0
    s_waitcnt lgkmcnt(2)
    v_mfma_f32_32x32x16_bf16 v[156:171], v[124:127], v[132:135], v[156:171]
    ds_read_b128 v[140:143], v110 offset:32768
    ds_read_b128 v[148:151], v118 offset:32768
    v_add_f32_dpp v48, v48, v48 row_shr:4 row_mask:0xf bank_mask:0xf bound_ctrl:0
    v_add_f32_dpp v49, v49, v49 row_shr:4 row_mask:0xf bank_mask:0xf bound_ctrl:0
    s_nop 0
    v_add_f32_dpp v48, v48, v48 row_shr:8 row_mask:0xf bank_mask:0xf bound_ctrl:0
    s_waitcnt lgkmcnt(3)
    v_mfma_f32_32x32x16_bf16 v[172:187], v[124:127], v[136:139], v[172:187]
    ds_read_b128 v[152:155], v118 offset:36864
    ds_read_b128 v[144:147], v110 offset:36864
    v_add_f32_dpp v49, v49, v49 row_shr:8 row_mask:0xf bank_mask:0xf bound_ctrl:0
    v_add_f32_dpp v48, v48, v48 row_bcast:15 row_mask:0xa bank_mask:0xf
    s_nop 0
    v_add_f32_dpp v49, v49, v49 row_bcast:15 row_mask:0xa bank_mask:0xf
    s_waitcnt lgkmcnt(4)
    v_mfma_f32_32x32x16_bf16 v[188:203], v[128:131], v[132:135], v[188:203]
    v_add_f32_dpp v48, v48, v48 row_bcast:31 row_mask:0xc bank_mask:0xf
    v_add_f32_dpp v49, v49, v49 row_bcast:31 row_mask:0xc bank_mask:0xf
    v_cvt_pk_bf16_f32 v50, v48, v49
    v_lshlrev_b32 v48, 16, v50
    v_and_b32 v49, s47, v50
    v_mfma_f32_32x32x16_bf16 v[204:219], v[128:131], v[136:139], v[204:219]
    v_mul_f32 v48, 0xbfb8aa3b, v48
    v_mul_f32 v49, 0xbfb8aa3b, v49
    v_exp_f32 v48, v48
    v_exp_f32 v49, v49
    v_add_f32 v48, 1.0, v48
    s_waitcnt lgkmcnt(0)
    s_waitcnt vmcnt(8)
    s_barrier
    v_mfma_f32_32x32x16_bf16 v[156:171], v[140:143], v[148:151], v[156:171]
    ds_read_b128 v[124:127], v111 offset:0
    ds_read_b128 v[132:135], v119 offset:0
    v_add_f32 v49, 1.0, v49
    v_rcp_f32 v48, v48
    v_rcp_f32 v49, v49
    v_mfma_f32_32x32x16_bf16 v[172:187], v[140:143], v[152:155], v[172:187]
    ds_read_b128 v[136:139], v119 offset:4096
    ds_read_b128 v[128:131], v111 offset:4096
    v_cvt_pk_bf16_f32 v50, v48, v49
    v_lshlrev_b32 v48, 16, v50
    v_and_b32 v49, s47, v50
    v_mfma_f32_32x32x16_bf16 v[188:203], v[144:147], v[148:151], v[188:203]
    v_sub_f32 v54, 1.0, v48
    v_sub_f32 v55, 1.0, v49
    v_cvt_pk_bf16_f32 v50, v54, v55
    v_lshlrev_b32 v54, 16, v50
    v_and_b32 v55, s47, v50
    v_mfma_f32_32x32x16_bf16 v[204:219], v[144:147], v[152:155], v[204:219]
    s_mov_b64 s[42:43], exec
    s_mov_b32 exec_lo, 0
    s_mov_b32 exec_hi, 0x80000000
    buffer_store_dwordx2 v[48:49], v18, s[60:63], 0 offen sc0 sc1
    buffer_store_dwordx2 v[54:55], v18, s[60:63], s25 offen sc0 sc1
    s_mov_b64 exec, s[42:43]
    s_mov_b32 s20, 0
    v_readfirstlane_b32 s8, v12
    v_readfirstlane_b32 s9, v13
    s_nop 3
    s_or_b32 s3, s8, s9
    s_cmp_lg_u32 s3, 0
    s_cbranch_scc1 Lnok_gate_2
Lnretry_gate_3:
    buffer_load_dwordx2 v[12:13], v14, s[28:31], 0 offen sc0 sc1
    s_waitcnt vmcnt(0)
    v_readfirstlane_b32 s8, v12
    v_readfirstlane_b32 s9, v13
    s_add_u32 s20, s20, 1
    s_nop 3
    s_or_b32 s3, s8, s9
    s_cmp_gt_u32 s20, 20000
    s_cbranch_scc1 Lnok_gate_2
    s_cmp_eq_u32 s3, 0
    s_cbranch_scc1 Lnretry_gate_3
Lnok_gate_2:
    v_mov_b32 v220, s8
    v_mov_b32 v221, s9
    s_mov_b64 s[20:21], exec
    s_mov_b64 exec, 1
    buffer_store_dwordx2 v[220:221], v3, s[72:75], s27 offen sc0 sc1
    s_mov_b64 exec, s[20:21]
    v_mov_b32 v220, s8
    v_mov_b32 v221, s9
    s_mov_b64 s[20:21], exec
    s_mov_b64 exec, 1
    buffer_store_dwordx2 v[220:221], v3, s[72:75], s66 offen sc0 sc1
    s_mov_b64 exec, s[20:21]
    s_waitcnt lgkmcnt(2)
    v_mfma_f32_32x32x16_bf16 v[156:171], v[124:127], v[132:135], v[156:171]
    ds_read_b128 v[140:143], v112 offset:0
    ds_read_b128 v[148:151], v120 offset:0
    buffer_load_dwordx2 v[220:221], v19, s[72:75], 0 offen sc0 sc1
    s_waitcnt lgkmcnt(3)
    v_mfma_f32_32x32x16_bf16 v[172:187], v[124:127], v[136:139], v[172:187]
    ds_read_b128 v[152:155], v120 offset:4096
    ds_read_b128 v[144:147], v112 offset:4096
    s_waitcnt lgkmcnt(4)
    v_mfma_f32_32x32x16_bf16 v[188:203], v[128:131], v[132:135], v[188:203]
    v_mfma_f32_32x32x16_bf16 v[204:219], v[128:131], v[136:139], v[204:219]
    s_waitcnt lgkmcnt(2)
    v_mfma_f32_32x32x16_bf16 v[156:171], v[140:143], v[148:151], v[156:171]
    ds_read_b128 v[124:127], v113 offset:0
    ds_read_b128 v[132:135], v121 offset:0
    s_waitcnt lgkmcnt(3)
    v_mfma_f32_32x32x16_bf16 v[172:187], v[140:143], v[152:155], v[172:187]
    ds_read_b128 v[136:139], v121 offset:4096
    ds_read_b128 v[128:131], v113 offset:4096
    s_waitcnt lgkmcnt(4)
    v_mfma_f32_32x32x16_bf16 v[188:203], v[144:147], v[148:151], v[188:203]
    v_mfma_f32_32x32x16_bf16 v[204:219], v[144:147], v[152:155], v[204:219]
    s_waitcnt lgkmcnt(2)
    v_mfma_f32_32x32x16_bf16 v[156:171], v[124:127], v[132:135], v[156:171]
    ds_read_b128 v[140:143], v114 offset:0
    ds_read_b128 v[148:151], v122 offset:0
    s_waitcnt lgkmcnt(3)
    v_mfma_f32_32x32x16_bf16 v[172:187], v[124:127], v[136:139], v[172:187]
    ds_read_b128 v[152:155], v122 offset:4096
    ds_read_b128 v[144:147], v114 offset:4096
    s_waitcnt lgkmcnt(4)
    v_mfma_f32_32x32x16_bf16 v[188:203], v[128:131], v[132:135], v[188:203]
    v_mfma_f32_32x32x16_bf16 v[204:219], v[128:131], v[136:139], v[204:219]
    s_waitcnt lgkmcnt(0)
    s_waitcnt vmcnt(5)
    s_barrier
    v_mfma_f32_32x32x16_bf16 v[156:171], v[140:143], v[148:151], v[156:171]
    ds_read_b128 v[124:127], v111 offset:32768
    ds_read_b128 v[132:135], v119 offset:32768
    ds_write_b128 v20, v[72:75] offset:0
    v_alignbit_b32 v86, v73, v72, 16
    v_alignbit_b32 v87, v74, v73, 16
    v_mfma_f32_32x32x16_bf16 v[172:187], v[140:143], v[152:155], v[172:187]
    ds_read_b128 v[136:139], v119 offset:36864
    ds_read_b128 v[128:131], v111 offset:36864
    v_alignbit_b32 v88, v75, v74, 16
    v_alignbit_b32 v89, v84, v75, 16
    v_pk_mov_b32 v[90:91], v[72:73], v[74:75] op_sel:[1,0]
    v_mfma_f32_32x32x16_bf16 v[188:203], v[144:147], v[148:151], v[188:203]
    v_pk_mov_b32 v[92:93], v[74:75], v[84:85] op_sel:[1,0]
    ds_write_b128 v20, v[86:89] offset:4160
    v_pk_mov_b32 v[94:95], v[86:87], v[88:89] op_sel:[1,0]
    v_mov_b32 v96, v89
    v_alignbit_b32 v97, v85, v84, 16
    v_mfma_f32_32x32x16_bf16 v[204:219], v[144:147], v[152:155], v[204:219]
    ds_write_b128 v20, v[90:93] offset:8320
    ds_write_b128 v20, v[94:97] offset:12480
    ds_write_b128 v20, v[56:59] offset:32
    v_alignbit_b32 v86, v57, v56, 16
    v_alignbit_b32 v87, v58, v57, 16
    s_waitcnt lgkmcnt(7)
    v_mfma_f32_32x32x16_bf16 v[156:171], v[124:127], v[132:135], v[156:171]
    ds_read_b128 v[140:143], v112 offset:32768
    ds_read_b128 v[148:151], v120 offset:32768
    v_alignbit_b32 v88, v59, v58, 16
    v_alignbit_b32 v89, v76, v59, 16
    v_pk_mov_b32 v[90:91], v[56:57], v[58:59] op_sel:[1,0]
    s_waitcnt lgkmcnt(7)
    v_mfma_f32_32x32x16_bf16 v[172:187], v[124:127], v[136:139], v[172:187]
    ds_read_b128 v[152:155], v120 offset:36864
    ds_read_b128 v[144:147], v112 offset:36864
    v_pk_mov_b32 v[92:93], v[58:59], v[76:77] op_sel:[1,0]
    ds_write_b128 v20, v[86:89] offset:4192
    v_pk_mov_b32 v[94:95], v[86:87], v[88:89] op_sel:[1,0]
    s_waitcnt lgkmcnt(9)
    v_mfma_f32_32x32x16_bf16 v[188:203], v[128:131], v[132:135], v[188:203]
    v_mov_b32 v96, v89
    v_alignbit_b32 v97, v77, v76, 16
    ds_write_b128 v20, v[90:93] offset:8352
    ds_write_b128 v20, v[94:97] offset:12512
    ds_write_b128 v20, v[60:63] offset:1056
    v_mfma_f32_32x32x16_bf16 v[204:219], v[128:131], v[136:139], v[204:219]
    v_alignbit_b32 v86, v61, v60, 16
    v_alignbit_b32 v87, v62, v61, 16
    v_alignbit_b32 v88, v63, v62, 16
    v_alignbit_b32 v89, v78, v63, 16
    v_pk_mov_b32 v[90:91], v[60:61], v[62:63] op_sel:[1,0]
    s_waitcnt lgkmcnt(6)
    v_mfma_f32_32x32x16_bf16 v[156:171], v[140:143], v[148:151], v[156:171]
    ds_read_b128 v[124:127], v113 offset:32768
    ds_read_b128 v[132:135], v121 offset:32768
    v_pk_mov_b32 v[92:93], v[62:63], v[78:79] op_sel:[1,0]
    ds_write_b128 v20, v[86:89] offset:5216
    v_pk_mov_b32 v[94:95], v[86:87], v[88:89] op_sel:[1,0]
    s_waitcnt lgkmcnt(8)
    v_mfma_f32_32x32x16_bf16 v[172:187], v[140:143], v[152:155], v[172:187]
    ds_read_b128 v[136:139], v121 offset:36864
    ds_read_b128 v[128:131], v113 offset:36864
    v_mov_b32 v96, v89
    v_alignbit_b32 v97, v79, v78, 16
    ds_write_b128 v20, v[90:93] offset:9376
    s_waitcnt lgkmcnt(10)
    v_mfma_f32_32x32x16_bf16 v[188:203], v[144:147], v[148:151], v[188:203]
    ds_write_b128 v20, v[94:97] offset:13536
    ds_write_b128 v20, v[64:67] offset:2080
    v_alignbit_b32 v86, v65, v64, 16
    v_alignbit_b32 v87, v66, v65, 16
    v_alignbit_b32 v88, v67, v66, 16
    v_mfma_f32_32x32x16_bf16 v[204:219], v[144:147], v[152:155], v[204:219]
    v_alignbit_b32 v89, v80, v67, 16
    v_pk_mov_b32 v[90:91], v[64:65], v[66:67] op_sel:[1,0]
    v_pk_mov_b32 v[92:93], v[66:67], v[80:81] op_sel:[1,0]
    ds_write_b128 v20, v[86:89] offset:6240
    v_pk_mov_b32 v[94:95], v[86:87], v[88:89] op_sel:[1,0]
    s_waitcnt lgkmcnt(7)
    v_mfma_f32_32x32x16_bf16 v[156:171], v[124:127], v[132:135], v[156:171]
    ds_read_b128 v[140:143], v114 offset:32768
    ds_read_b128 v[148:151], v122 offset:32768
    v_mov_b32 v96, v89
    v_alignbit_b32 v97, v81, v80, 16
    ds_write_b128 v20, v[90:93] offset:10400
    s_waitcnt lgkmcnt(8)
    v_mfma_f32_32x32x16_bf16 v[172:187], v[124:127], v[136:139], v[172:187]
    ds_read_b128 v[152:155], v122 offset:36864
    ds_read_b128 v[144:147], v114 offset:36864
    ds_write_b128 v20, v[94:97] offset:14560
    ds_write_b128 v20, v[68:71] offset:3104
    v_alignbit_b32 v86, v69, v68, 16
    s_waitcnt lgkmcnt(11)
    v_mfma_f32_32x32x16_bf16 v[188:203], v[128:131], v[132:135], v[188:203]
    v_alignbit_b32 v87, v70, v69, 16
    v_alignbit_b32 v88, v71, v70, 16
    v_alignbit_b32 v89, v82, v71, 16
    v_pk_mov_b32 v[90:91], v[68:69], v[70:71] op_sel:[1,0]
    v_pk_mov_b32 v[92:93], v[70:71], v[82:83] op_sel:[1,0]
    v_mfma_f32_32x32x16_bf16 v[204:219], v[128:131], v[136:139], v[204:219]
    ds_write_b128 v20, v[86:89] offset:7264
    v_pk_mov_b32 v[94:95], v[86:87], v[88:89] op_sel:[1,0]
    v_mov_b32 v96, v89
    v_alignbit_b32 v97, v83, v82, 16
    ds_write_b128 v20, v[90:93] offset:11424
    s_waitcnt lgkmcnt(4)
    s_barrier
    v_mfma_f32_32x32x16_bf16 v[156:171], v[140:143], v[148:151], v[156:171]
    ds_write_b128 v20, v[94:97] offset:15584
    v_lshlrev_b32 v23, 16, v23
    v_mfma_f32_32x32x16_bf16 v[172:187], v[140:143], v[152:155], v[172:187]
    v_mfma_f32_32x32x16_bf16 v[188:203], v[144:147], v[148:151], v[188:203]
    v_mfma_f32_32x32x16_bf16 v[204:219], v[144:147], v[152:155], v[204:219]
    s_mov_b32 s12, 0
    s_waitcnt vmcnt(0)
    v_cmp_ne_u64 vcc, s[8:9], v[220:221]
    s_nop 4
    s_cbranch_vccz Lfdone_gate_4
Lfpoll_gate_5:
    buffer_load_dwordx2 v[220:221], v19, s[72:75], 0 offen sc0 sc1
    s_waitcnt vmcnt(0)
    v_cmp_ne_u64 vcc, s[8:9], v[220:221]
    s_nop 4
    s_add_u32 s12, s12, 1
    s_cmp_gt_u32 s12, 20000
    s_cbranch_scc1 Lfdone_gate_4
    s_cbranch_vccnz Lfpoll_gate_5
Lfdone_gate_4:
    s_add_u32 m0, s26, 16640
    s_nop 0
    buffer_load_dwordx4 v2, s[16:19], s65 offen offset:0 sc0 sc1 lds
    buffer_load_dwordx4 v2, s[16:19], s65 offen offset:1024 sc0 sc1 lds
    buffer_load_dwordx4 v2, s[16:19], s65 offen offset:2048 sc0 sc1 lds
    buffer_load_dwordx4 v2, s[16:19], s65 offen offset:3072 sc0 sc1 lds
    v_mov_b32 v4, 0
    v_mov_b32 v5, 0
    v_lshrrev_b32 v6, 1, v2
    v_add_u32 v6, s26, v6
    ds_write_b64 v6, v[4:5] offset:20736
    s_lshl_b32 s3, s46, 2
    s_add_u32 s3, s3, s10
    s_lshl_b32 s3, s3, 1
    s_and_b32 s6, s45, 1
    s_add_u32 s3, s3, s6
    s_lshl_b32 s3, s3, 16
    s_add_u32 s3, s3, 16777216
    s_add_u32 s12, s4, s3
    s_addc_u32 s13, s5, 0
    s_mov_b32 s14, 65536
    s_mov_b32 s15, 131072
    v_pk_fma_f32 v[12:13], v[172:173], v[224:225], v[158:159] op_sel:[0,1,0] op_sel_hi:[1,1,1] neg_lo:[0,1,0] neg_hi:[0,1,0]
    v_pk_fma_f32 v[16:17], v[156:157], v[224:225], v[174:175] op_sel:[0,1,0] op_sel_hi:[1,1,1]
    v_pk_fma_f32 v[8:9], v[156:157], v[224:225], v[12:13] op_sel:[0,0,0] op_sel_hi:[1,0,1]
    v_pk_fma_f32 v[10:11], v[172:173], v[224:225], v[16:17] op_sel:[0,0,0] op_sel_hi:[1,0,1]
    v_pk_fma_f32 v[12:13], v[10:11], v[224:225], v[160:161] op_sel:[0,1,0] op_sel_hi:[1,1,1] neg_lo:[0,1,0] neg_hi:[0,1,0]
    v_pk_fma_f32 v[16:17], v[8:9], v[224:225], v[176:177] op_sel:[0,1,0] op_sel_hi:[1,1,1]
    v_pk_fma_f32 v[8:9], v[8:9], v[224:225], v[12:13] op_sel:[0,0,0] op_sel_hi:[1,0,1]
    v_pk_fma_f32 v[10:11], v[10:11], v[224:225], v[16:17] op_sel:[0,0,0] op_sel_hi:[1,0,1]
    v_pk_fma_f32 v[12:13], v[10:11], v[224:225], v[162:163] op_sel:[0,1,0] op_sel_hi:[1,1,1] neg_lo:[0,1,0] neg_hi:[0,1,0]
    v_pk_fma_f32 v[16:17], v[8:9], v[224:225], v[178:179] op_sel:[0,1,0] op_sel_hi:[1,1,1]
    v_pk_fma_f32 v[8:9], v[8:9], v[224:225], v[12:13] op_sel:[0,0,0] op_sel_hi:[1,0,1]
    v_pk_fma_f32 v[10:11], v[10:11], v[224:225], v[16:17] op_sel:[0,0,0] op_sel_hi:[1,0,1]
    v_pk_fma_f32 v[12:13], v[10:11], v[224:225], v[164:165] op_sel:[0,1,0] op_sel_hi:[1,1,1] neg_lo:[0,1,0] neg_hi:[0,1,0]
    v_pk_fma_f32 v[16:17], v[8:9], v[224:225], v[180:181] op_sel:[0,1,0] op_sel_hi:[1,1,1]
    v_pk_fma_f32 v[8:9], v[8:9], v[224:225], v[12:13] op_sel:[0,0,0] op_sel_hi:[1,0,1]
    v_pk_fma_f32 v[10:11], v[10:11], v[224:225], v[16:17] op_sel:[0,0,0] op_sel_hi:[1,0,1]
    v_pk_fma_f32 v[12:13], v[10:11], v[224:225], v[166:167] op_sel:[0,1,0] op_sel_hi:[1,1,1] neg_lo:[0,1,0] neg_hi:[0,1,0]
    v_pk_fma_f32 v[16:17], v[8:9], v[224:225], v[182:183] op_sel:[0,1,0] op_sel_hi:[1,1,1]
    v_pk_fma_f32 v[8:9], v[8:9], v[224:225], v[12:13] op_sel:[0,0,0] op_sel_hi:[1,0,1]
    v_pk_fma_f32 v[10:11], v[10:11], v[224:225], v[16:17] op_sel:[0,0,0] op_sel_hi:[1,0,1]
    v_pk_fma_f32 v[12:13], v[10:11], v[224:225], v[168:169] op_sel:[0,1,0] op_sel_hi:[1,1,1] neg_lo:[0,1,0] neg_hi:[0,1,0]
    v_pk_fma_f32 v[16:17], v[8:9], v[224:225], v[184:185] op_sel:[0,1,0] op_sel_hi:[1,1,1]
    v_pk_fma_f32 v[8:9], v[8:9], v[224:225], v[12:13] op_sel:[0,0,0] op_sel_hi:[1,0,1]
    v_pk_fma_f32 v[10:11], v[10:11], v[224:225], v[16:17] op_sel:[0,0,0] op_sel_hi:[1,0,1]
    v_pk_fma_f32 v[12:13], v[10:11], v[224:225], v[170:171] op_sel:[0,1,0] op_sel_hi:[1,1,1] neg_lo:[0,1,0] neg_hi:[0,1,0]
    v_pk_fma_f32 v[16:17], v[8:9], v[224:225], v[186:187] op_sel:[0,1,0] op_sel_hi:[1,1,1]
    v_pk_fma_f32 v[8:9], v[8:9], v[224:225], v[12:13] op_sel:[0,0,0] op_sel_hi:[1,0,1]
    v_pk_fma_f32 v[10:11], v[10:11], v[224:225], v[16:17] op_sel:[0,0,0] op_sel_hi:[1,0,1]
    v_pk_fma_f32 v[12:13], v[10:11], v[224:225], v[188:189] op_sel:[0,1,0] op_sel_hi:[1,1,1] neg_lo:[0,1,0] neg_hi:[0,1,0]
    v_pk_fma_f32 v[16:17], v[8:9], v[224:225], v[204:205] op_sel:[0,1,0] op_sel_hi:[1,1,1]
    v_pk_fma_f32 v[8:9], v[8:9], v[224:225], v[12:13] op_sel:[0,0,0] op_sel_hi:[1,0,1]
    v_pk_fma_f32 v[10:11], v[10:11], v[224:225], v[16:17] op_sel:[0,0,0] op_sel_hi:[1,0,1]
    v_pk_fma_f32 v[12:13], v[10:11], v[224:225], v[190:191] op_sel:[0,1,0] op_sel_hi:[1,1,1] neg_lo:[0,1,0] neg_hi:[0,1,0]
    v_pk_fma_f32 v[16:17], v[8:9], v[224:225], v[206:207] op_sel:[0,1,0] op_sel_hi:[1,1,1]
    v_pk_fma_f32 v[8:9], v[8:9], v[224:225], v[12:13] op_sel:[0,0,0] op_sel_hi:[1,0,1]
    v_pk_fma_f32 v[10:11], v[10:11], v[224:225], v[16:17] op_sel:[0,0,0] op_sel_hi:[1,0,1]
    v_pk_fma_f32 v[12:13], v[10:11], v[224:225], v[192:193] op_sel:[0,1,0] op_sel_hi:[1,1,1] neg_lo:[0,1,0] neg_hi:[0,1,0]
    v_pk_fma_f32 v[16:17], v[8:9], v[224:225], v[208:209] op_sel:[0,1,0] op_sel_hi:[1,1,1]
    v_pk_fma_f32 v[8:9], v[8:9], v[224:225], v[12:13] op_sel:[0,0,0] op_sel_hi:[1,0,1]
    v_pk_fma_f32 v[10:11], v[10:11], v[224:225], v[16:17] op_sel:[0,0,0] op_sel_hi:[1,0,1]
    v_pk_fma_f32 v[12:13], v[10:11], v[224:225], v[194:195] op_sel:[0,1,0] op_sel_hi:[1,1,1] neg_lo:[0,1,0] neg_hi:[0,1,0]
    v_pk_fma_f32 v[16:17], v[8:9], v[224:225], v[210:211] op_sel:[0,1,0] op_sel_hi:[1,1,1]
    v_pk_fma_f32 v[8:9], v[8:9], v[224:225], v[12:13] op_sel:[0,0,0] op_sel_hi:[1,0,1]
    v_pk_fma_f32 v[10:11], v[10:11], v[224:225], v[16:17] op_sel:[0,0,0] op_sel_hi:[1,0,1]
    v_pk_fma_f32 v[12:13], v[10:11], v[224:225], v[196:197] op_sel:[0,1,0] op_sel_hi:[1,1,1] neg_lo:[0,1,0] neg_hi:[0,1,0]
    v_pk_fma_f32 v[16:17], v[8:9], v[224:225], v[212:213] op_sel:[0,1,0] op_sel_hi:[1,1,1]
    v_pk_fma_f32 v[8:9], v[8:9], v[224:225], v[12:13] op_sel:[0,0,0] op_sel_hi:[1,0,1]
    v_pk_fma_f32 v[10:11], v[10:11], v[224:225], v[16:17] op_sel:[0,0,0] op_sel_hi:[1,0,1]
    v_pk_fma_f32 v[12:13], v[10:11], v[224:225], v[198:199] op_sel:[0,1,0] op_sel_hi:[1,1,1] neg_lo:[0,1,0] neg_hi:[0,1,0]
    v_pk_fma_f32 v[16:17], v[8:9], v[224:225], v[214:215] op_sel:[0,1,0] op_sel_hi:[1,1,1]
    v_pk_fma_f32 v[8:9], v[8:9], v[224:225], v[12:13] op_sel:[0,0,0] op_sel_hi:[1,0,1]
    v_pk_fma_f32 v[10:11], v[10:11], v[224:225], v[16:17] op_sel:[0,0,0] op_sel_hi:[1,0,1]
    v_pk_fma_f32 v[12:13], v[10:11], v[224:225], v[200:201] op_sel:[0,1,0] op_sel_hi:[1,1,1] neg_lo:[0,1,0] neg_hi:[0,1,0]
    v_pk_fma_f32 v[16:17], v[8:9], v[224:225], v[216:217] op_sel:[0,1,0] op_sel_hi:[1,1,1]
    v_pk_fma_f32 v[8:9], v[8:9], v[224:225], v[12:13] op_sel:[0,0,0] op_sel_hi:[1,0,1]
    v_pk_fma_f32 v[10:11], v[10:11], v[224:225], v[16:17] op_sel:[0,0,0] op_sel_hi:[1,0,1]
    v_pk_fma_f32 v[12:13], v[10:11], v[224:225], v[202:203] op_sel:[0,1,0] op_sel_hi:[1,1,1] neg_lo:[0,1,0] neg_hi:[0,1,0]
    v_pk_fma_f32 v[16:17], v[8:9], v[224:225], v[218:219] op_sel:[0,1,0] op_sel_hi:[1,1,1]
    v_pk_fma_f32 v[8:9], v[8:9], v[224:225], v[12:13] op_sel:[0,0,0] op_sel_hi:[1,0,1]
    v_pk_fma_f32 v[10:11], v[10:11], v[224:225], v[16:17] op_sel:[0,0,0] op_sel_hi:[1,0,1]
    v_lshrrev_b32 v14, 5, v1
    v_lshlrev_b32 v14, 10, v14
    v_lshl_add_u32 v7, v15, 2, v14
    s_lshr_b32 s3, s10, 1
    s_lshl_b32 s3, s3, 11
    s_add_u32 s3, s3, 131072
    v_add_u32 v7, s3, v7
    ds_write2st64_b32 v7, v8, v10 offset0:12 offset1:13
    ds_write2st64_b32 v7, v9, v11 offset0:14 offset1:15
    s_waitcnt lgkmcnt(0)
    s_barrier
    ds_read2st64_b32 v[24:25], v7 offset0:0 offset1:1
    ds_read2st64_b32 v[26:27], v7 offset0:2 offset1:3
    ds_read2st64_b32 v[28:29], v7 offset0:4 offset1:5
    ds_read2st64_b32 v[30:31], v7 offset0:6 offset1:7
    ds_read2st64_b32 v[32:33], v7 offset0:8 offset1:9
    ds_read2st64_b32 v[34:35], v7 offset0:10 offset1:11
    s_waitcnt lgkmcnt(4)
    v_fma_f32 v38, -v229, v25, v26
    v_fma_f32 v39, v229, v24, v27
    v_fma_f32 v26, v228, v24, v38
    v_fma_f32 v27, v228, v25, v39
    s_waitcnt lgkmcnt(3)
    v_fma_f32 v38, -v229, v27, v28
    v_fma_f32 v39, v229, v26, v29
    v_fma_f32 v28, v228, v26, v38
    v_fma_f32 v29, v228, v27, v39
    s_waitcnt lgkmcnt(2)
    v_fma_f32 v38, -v229, v29, v30
    v_fma_f32 v39, v229, v28, v31
    v_fma_f32 v30, v228, v28, v38
    v_fma_f32 v31, v228, v29, v39
    s_waitcnt lgkmcnt(1)
    v_fma_f32 v38, -v229, v31, v32
    v_fma_f32 v39, v229, v30, v33
    v_fma_f32 v32, v228, v30, v38
    v_fma_f32 v33, v228, v31, v39
    s_waitcnt lgkmcnt(0)
    v_fma_f32 v38, -v229, v33, v34
    v_fma_f32 v39, v229, v32, v35
    v_fma_f32 v34, v228, v32, v38
    v_fma_f32 v35, v228, v33, v39
    v_fma_f32 v38, -v229, v35, v8
    v_fma_f32 v39, v229, v34, v10
    v_fma_f32 v20, v228, v34, v38
    v_fma_f32 v21, v228, v35, v39
    v_fma_f32 v38, -v229, v21, v9
    v_fma_f32 v39, v229, v20, v11
    v_fma_f32 v40, v228, v20, v38
    v_fma_f32 v41, v228, v21, v39
    v_mov_b32 v42, v34
    v_mov_b32 v43, v20
    v_mov_b32 v44, v35
    v_mov_b32 v45, v21
    s_lshl_b32 s3, s44, 14
    s_add_u32 s3, s3, 21037056
    s_add_u32 s20, s4, s3
    s_addc_u32 s21, s5, 0
    s_mov_b32 s22, 16384
    s_mov_b32 s23, 131072
    v_lshlrev_b32 v7, 4, v15
    s_lshl_b32 s7, s11, 10
    s_lshr_b32 s3, s10, 1
    s_cmp_eq_u32 s3, 0
    s_cbranch_scc1 Lnopub_gate_6
    v_mov_b32 v8, v40
    v_mov_b32 v9, v41
    v_mov_b32 v10, s8
    v_mov_b32 v11, s9
    s_mov_b64 s[24:25], exec
    s_mov_b64 exec, s[40:41]
    buffer_store_dwordx4 v[8:11], v7, s[20:23], s7 offen sc0 sc1
    s_mov_b64 exec, s[24:25]
    s_nop 1
Lnopub_gate_6:
    s_sub_u32 s3, s7, 1024
    v_add_u32 v8, s3, v7
    s_waitcnt vmcnt(0)
    ds_read_b64 v[118:119], v222 offset:448
    ds_read_b64 v[120:121], v222 offset:456
    ds_read_b128 v[122:125], v223 offset:4032
    ds_read_b64 v[126:127], v222 offset:960
    ds_read_b64 v[128:129], v222 offset:968
    ds_read_b128 v[130:133], v223 offset:3520
    ds_read_b64 v[134:135], v222 offset:1472
    ds_read_b64 v[136:137], v222 offset:1480
    ds_read_b128 v[138:141], v223 offset:3008
    s_waitcnt lgkmcnt(6)
    v_mfma_f32_16x16x32_bf16 v[18:21], v[118:121], v[122:125], 0
    s_mov_b32 s6, 0
    buffer_load_dwordx4 a[0:3], v2, s[12:15], s6 offen offset:0 sc0 sc1
    s_waitcnt lgkmcnt(4)
    v_mfma_f32_16x16x32_bf16 v[24:27], v[126:129], v[122:125], 0
    v_mul_f32 v12, v227, v172
    v_mul_f32 v16, v227, v156
    s_waitcnt lgkmcnt(3)
    v_mfma_f32_16x16x32_bf16 v[24:27], v[118:121], v[130:133], v[24:27]
    ds_read_b64 v[142:143], v222 offset:1984
    ds_read_b64 v[144:145], v222 offset:1992
    v_mul_f32 v13, v227, v173
    v_mfma_f32_16x16x32_bf16 v[28:31], v[126:129], v[130:133], 0
    ds_read_b128 v[146:149], v223 offset:2496
    v_mul_f32 v17, v227, v157
    s_waitcnt lgkmcnt(4)
    v_mfma_f32_16x16x32_bf16 v[28:31], v[134:137], v[122:125], v[28:31]
    v_fma_f32 v156, v226, v156, -v12
    buffer_load_dwordx4 a[4:7], v2, s[12:15], s6 offen offset:1024 sc0 sc1
    s_waitcnt lgkmcnt(3)
    v_mfma_f32_16x16x32_bf16 v[28:31], v[118:121], v[138:141], v[28:31]
    v_fma_f32 v172, v226, v172, v16
    v_fma_f32 v157, v226, v157, -v13
    v_mfma_f32_16x16x32_bf16 v[32:35], v[134:137], v[130:133], 0
    v_fma_f32 v173, v226, v173, v17
    v_mul_f32 v12, v227, v174
    v_mfma_f32_16x16x32_bf16 v[32:35], v[126:129], v[138:141], v[32:35]
    v_mul_f32 v16, v227, v158
    buffer_load_dwordx4 a[8:11], v2, s[12:15], s6 offen offset:2048 sc0 sc1
    v_mfma_f32_16x16x32_bf16 v[36:39], v[134:137], v[138:141], 0
    v_mul_f32 v13, v227, v175
    v_mul_f32 v17, v227, v159
    s_waitcnt lgkmcnt(1)
    v_mfma_f32_16x16x32_bf16 v[32:35], v[142:145], v[122:125], v[32:35]
    ds_read_b64 v[150:151], v222 offset:2496
    ds_read_b64 v[152:153], v222 offset:2504
    v_fma_f32 v158, v226, v158, -v12
    s_waitcnt lgkmcnt(2)
    v_mfma_f32_16x16x32_bf16 v[32:35], v[118:121], v[146:149], v[32:35]
    ds_read_b128 v[238:241], v223 offset:1984
    v_fma_f32 v174, v226, v174, v16
    v_mfma_f32_16x16x32_bf16 v[36:39], v[142:145], v[130:133], v[36:39]
    v_fma_f32 v159, v226, v159, -v13
    buffer_load_dwordx4 a[12:15], v2, s[12:15], s6 offen offset:3072 sc0 sc1
    v_mfma_f32_16x16x32_bf16 v[36:39], v[126:129], v[146:149], v[36:39]
    v_fma_f32 v175, v226, v175, v17
    v_mul_f32 v12, v227, v176
    v_mfma_f32_16x16x32_bf16 v[106:109], v[142:145], v[138:141], 0
    v_mul_f32 v16, v227, v160
    v_mul_f32 v13, v227, v177
    v_mfma_f32_16x16x32_bf16 v[106:109], v[134:137], v[146:149], v[106:109]
    v_mul_f32 v17, v227, v161
    s_mov_b32 s6, 4096
    v_mfma_f32_16x16x32_bf16 v[110:113], v[142:145], v[146:149], 0
    buffer_load_dwordx4 a[16:19], v2, s[12:15], s6 offen offset:0 sc0 sc1
    v_fma_f32 v160, v226, v160, -v12
    s_waitcnt lgkmcnt(1)
    v_mfma_f32_16x16x32_bf16 v[36:39], v[150:153], v[122:125], v[36:39]
    v_fma_f32 v176, v226, v176, v16
    v_fma_f32 v161, v226, v161, -v13
    s_waitcnt lgkmcnt(0)
    v_mfma_f32_16x16x32_bf16 v[36:39], v[118:121], v[238:241], v[36:39]
    ds_read_b64 v[242:243], v222 offset:3008
    ds_read_b64 v[244:245], v222 offset:3016
    v_fma_f32 v177, v226, v177, v17
    v_mfma_f32_16x16x32_bf16 v[106:109], v[150:153], v[130:133], v[106:109]
    ds_read_b128 v[246:249], v223 offset:1472
    v_mul_f32 v12, v227, v178
    v_mfma_f32_16x16x32_bf16 v[106:109], v[126:129], v[238:241], v[106:109]
    buffer_load_dwordx4 a[20:23], v2, s[12:15], s6 offen offset:1024 sc0 sc1
    v_mul_f32 v16, v227, v162
    v_mfma_f32_16x16x32_bf16 v[110:113], v[150:153], v[138:141], v[110:113]
    v_mul_f32 v13, v227, v179
    v_mul_f32 v17, v227, v163
    v_mfma_f32_16x16x32_bf16 v[110:113], v[134:137], v[238:241], v[110:113]
    v_fma_f32 v162, v226, v162, -v12
    v_fma_f32 v178, v226, v178, v16
    v_mfma_f32_16x16x32_bf16 v[114:117], v[150:153], v[146:149], 0
    buffer_load_dwordx4 a[24:27], v2, s[12:15], s6 offen offset:2048 sc0 sc1
    v_fma_f32 v163, v226, v163, -v13
    v_mfma_f32_16x16x32_bf16 v[114:117], v[142:145], v[238:241], v[114:117]
    ds_read_b64 v[250:251], v222 offset:3520
    ds_read_b64 v[252:253], v222 offset:3528
    v_fma_f32 v179, v226, v179, v17
    s_waitcnt lgkmcnt(3)
    v_mfma_f32_16x16x32_bf16 v[106:109], v[242:245], v[122:125], v[106:109]
    ds_read_b128 v[150:153], v223 offset:960
    v_mul_f32 v12, v227, v180
    s_waitcnt lgkmcnt(3)
    v_mfma_f32_16x16x32_bf16 v[106:109], v[118:121], v[246:249], v[106:109]
    v_mul_f32 v16, v227, v164
    v_mul_f32 v13, v227, v181
    v_mfma_f32_16x16x32_bf16 v[110:113], v[242:245], v[130:133], v[110:113]
    buffer_load_dwordx4 a[28:31], v2, s[12:15], s6 offen offset:3072 sc0 sc1
    v_mul_f32 v17, v227, v165
    v_mfma_f32_16x16x32_bf16 v[110:113], v[126:129], v[246:249], v[110:113]
    ds_read_b64 v[146:147], v222 offset:4032
    ds_read_b64 v[148:149], v222 offset:4040
    v_fma_f32 v164, v226, v164, -v12
    v_mfma_f32_16x16x32_bf16 v[114:117], v[242:245], v[138:141], v[114:117]
    ds_read_b128 v[142:145], v223 offset:448
    v_fma_f32 v180, v226, v180, v16
    v_mfma_f32_16x16x32_bf16 v[114:117], v[134:137], v[246:249], v[114:117]
    ds_read_b64 v[238:239], v222 offset:384
    ds_read_b64 v[240:241], v222 offset:392
    v_fma_f32 v165, v226, v165, -v13
    s_waitcnt lgkmcnt(6)
    v_mfma_f32_16x16x32_bf16 v[110:113], v[250:253], v[122:125], v[110:113]
    ds_read_b128 v[242:245], v223 offset:3968
    v_fma_f32 v181, v226, v181, v17
    s_waitcnt lgkmcnt(6)
    v_mfma_f32_16x16x32_bf16 v[110:113], v[118:121], v[150:153], v[110:113]
    ds_read_b64 v[138:139], v222 offset:896
    ds_read_b64 v[140:141], v222 offset:904
    s_mov_b32 s6, 8192
    v_mfma_f32_16x16x32_bf16 v[114:117], v[250:253], v[130:133], v[114:117]
    ds_read_b128 v[134:137], v223 offset:3456
    buffer_load_dwordx4 a[32:35], v2, s[12:15], s6 offen offset:0 sc0 sc1
    v_mfma_f32_16x16x32_bf16 v[114:117], v[126:129], v[150:153], v[114:117]
    ds_read_b64 v[246:247], v222 offset:1408
    ds_read_b64 v[248:249], v222 offset:1416
    v_mul_f32 v12, v227, v182
    s_waitcnt lgkmcnt(9)
    v_mfma_f32_16x16x32_bf16 v[114:117], v[146:149], v[122:125], v[114:117]
    ds_read_b128 v[250:253], v223 offset:2944
    v_mul_f32 v16, v227, v166
    s_waitcnt lgkmcnt(9)
    v_mfma_f32_16x16x32_bf16 v[114:117], v[118:121], v[142:145], v[114:117]
    v_mul_f32 v13, v227, v183
    v_mul_f32 v17, v227, v167
    s_waitcnt lgkmcnt(6)
    v_mfma_f32_16x16x32_bf16 v[18:21], v[238:241], v[242:245], v[18:21]
    v_fma_f32 v166, v226, v166, -v12
    buffer_load_dwordx4 a[36:39], v2, s[12:15], s6 offen offset:1024 sc0 sc1
    s_waitcnt lgkmcnt(4)
    v_mfma_f32_16x16x32_bf16 v[24:27], v[138:141], v[242:245], v[24:27]
    v_fma_f32 v182, v226, v182, v16
    v_fma_f32 v167, v226, v167, -v13
    s_waitcnt lgkmcnt(3)
    v_mfma_f32_16x16x32_bf16 v[24:27], v[238:241], v[134:137], v[24:27]
    ds_read_b64 v[130:131], v222 offset:1920
    ds_read_b64 v[132:133], v222 offset:1928
    v_fma_f32 v183, v226, v183, v17
    v_mfma_f32_16x16x32_bf16 v[28:31], v[138:141], v[134:137], v[28:31]
    ds_read_b128 v[126:129], v223 offset:2432
    v_mul_f32 v12, v227, v184
    s_waitcnt lgkmcnt(4)
    v_mfma_f32_16x16x32_bf16 v[28:31], v[246:249], v[242:245], v[28:31]
    v_mul_f32 v16, v227, v168
    buffer_load_dwordx4 a[40:43], v2, s[12:15], s6 offen offset:2048 sc0 sc1
    s_waitcnt lgkmcnt(3)
    v_mfma_f32_16x16x32_bf16 v[28:31], v[238:241], v[250:253], v[28:31]
    v_mul_f32 v13, v227, v185
    v_mul_f32 v17, v227, v169
    v_mfma_f32_16x16x32_bf16 v[32:35], v[246:249], v[134:137], v[32:35]
    v_fma_f32 v168, v226, v168, -v12
    v_fma_f32 v184, v226, v184, v16
    v_mfma_f32_16x16x32_bf16 v[32:35], v[138:141], v[250:253], v[32:35]
    v_fma_f32 v169, v226, v169, -v13
    buffer_load_dwordx4 a[44:47], v2, s[12:15], s6 offen offset:3072 sc0 sc1
    v_mfma_f32_16x16x32_bf16 v[36:39], v[246:249], v[250:253], v[36:39]
    v_fma_f32 v185, v226, v185, v17
    v_mul_f32 v12, v227, v186
    s_waitcnt lgkmcnt(1)
    v_mfma_f32_16x16x32_bf16 v[32:35], v[130:133], v[242:245], v[32:35]
    ds_read_b64 v[150:151], v222 offset:2432
    ds_read_b64 v[152:153], v222 offset:2440
    v_mul_f32 v16, v227, v170
    s_waitcnt lgkmcnt(2)
    v_mfma_f32_16x16x32_bf16 v[32:35], v[238:241], v[126:129], v[32:35]
    ds_read_b128 v[146:149], v223 offset:1920
    v_mul_f32 v13, v227, v187
    v_mfma_f32_16x16x32_bf16 v[36:39], v[130:133], v[134:137], v[36:39]
    v_mul_f32 v17, v227, v171
    s_mov_b32 s6, 12288
    v_mfma_f32_16x16x32_bf16 v[36:39], v[138:141], v[126:129], v[36:39]
    buffer_load_dwordx4 a[48:51], v2, s[12:15], s6 offen offset:0 sc0 sc1
    v_fma_f32 v170, v226, v170, -v12
    v_mfma_f32_16x16x32_bf16 v[106:109], v[130:133], v[250:253], v[106:109]
    v_fma_f32 v186, v226, v186, v16
    v_fma_f32 v171, v226, v171, -v13
    v_mfma_f32_16x16x32_bf16 v[106:109], v[246:249], v[126:129], v[106:109]
    v_fma_f32 v187, v226, v187, v17
    v_mul_f32 v12, v227, v204
    v_mfma_f32_16x16x32_bf16 v[110:113], v[130:133], v[126:129], v[110:113]
    buffer_load_dwordx4 a[52:55], v2, s[12:15], s6 offen offset:1024 sc0 sc1
    v_mul_f32 v16, v227, v188
    s_waitcnt lgkmcnt(1)
    v_mfma_f32_16x16x32_bf16 v[36:39], v[150:153], v[242:245], v[36:39]
    v_mul_f32 v13, v227, v205
    v_mul_f32 v17, v227, v189
    s_waitcnt lgkmcnt(0)
    v_mfma_f32_16x16x32_bf16 v[36:39], v[238:241], v[146:149], v[36:39]
    ds_read_b64 v[122:123], v222 offset:2944
    ds_read_b64 v[124:125], v222 offset:2952
    v_fma_f32 v188, v226, v188, -v12
    v_mfma_f32_16x16x32_bf16 v[106:109], v[150:153], v[134:137], v[106:109]
    ds_read_b128 v[118:121], v223 offset:1408
    v_fma_f32 v204, v226, v204, v16
    v_mfma_f32_16x16x32_bf16 v[106:109], v[138:141], v[146:149], v[106:109]
    buffer_load_dwordx4 a[56:59], v2, s[12:15], s6 offen offset:2048 sc0 sc1
    v_fma_f32 v189, v226, v189, -v13
    v_mfma_f32_16x16x32_bf16 v[110:113], v[150:153], v[250:253], v[110:113]
    v_fma_f32 v205, v226, v205, v17
    v_mul_f32 v12, v227, v206
    v_mfma_f32_16x16x32_bf16 v[110:113], v[246:249], v[146:149], v[110:113]
    v_mul_f32 v16, v227, v190
    v_mul_f32 v13, v227, v207
    v_mfma_f32_16x16x32_bf16 v[114:117], v[150:153], v[126:129], v[114:117]
    buffer_load_dwordx4 a[60:63], v2, s[12:15], s6 offen offset:3072 sc0 sc1
    v_mul_f32 v17, v227, v191
    v_mfma_f32_16x16x32_bf16 v[114:117], v[130:133], v[146:149], v[114:117]
    ds_read_b64 v[142:143], v222 offset:3456
    ds_read_b64 v[144:145], v222 offset:3464
    v_fma_f32 v190, v226, v190, -v12
    s_waitcnt lgkmcnt(3)
    v_mfma_f32_16x16x32_bf16 v[106:109], v[122:125], v[242:245], v[106:109]
    ds_read_b128 v[150:153], v223 offset:896
    v_fma_f32 v206, v226, v206, v16
    s_waitcnt lgkmcnt(3)
    v_mfma_f32_16x16x32_bf16 v[106:109], v[238:241], v[118:121], v[106:109]
    v_fma_f32 v191, v226, v191, -v13
    v_fma_f32 v207, v226, v207, v17
    v_mfma_f32_16x16x32_bf16 v[110:113], v[122:125], v[134:137], v[110:113]
    s_mov_b32 s6, 16384
    buffer_load_dwordx4 a[64:67], v2, s[12:15], s6 offen offset:0 sc0 sc1
    v_mfma_f32_16x16x32_bf16 v[110:113], v[138:141], v[118:121], v[110:113]
    ds_read_b64 v[126:127], v222 offset:3968
    ds_read_b64 v[128:129], v222 offset:3976
    v_mul_f32 v12, v227, v208
    v_mfma_f32_16x16x32_bf16 v[114:117], v[122:125], v[250:253], v[114:117]
    ds_read_b128 v[130:133], v223 offset:384
    v_mul_f32 v16, v227, v192
    v_mfma_f32_16x16x32_bf16 v[114:117], v[246:249], v[118:121], v[114:117]
    ds_read_b64 v[146:147], v222 offset:320
    ds_read_b64 v[148:149], v222 offset:328
    v_mul_f32 v13, v227, v209
    s_waitcnt lgkmcnt(6)
    v_mfma_f32_16x16x32_bf16 v[110:113], v[142:145], v[242:245], v[110:113]
    ds_read_b128 v[122:125], v223 offset:3904
    v_mul_f32 v17, v227, v193
    s_waitcnt lgkmcnt(6)
    v_mfma_f32_16x16x32_bf16 v[110:113], v[238:241], v[150:153], v[110:113]
    ds_read_b64 v[250:251], v222 offset:832
    ds_read_b64 v[252:253], v222 offset:840
    v_fma_f32 v192, v226, v192, -v12
    v_mfma_f32_16x16x32_bf16 v[114:117], v[142:145], v[134:137], v[114:117]
    ds_read_b128 v[246:249], v223 offset:3392
    buffer_load_dwordx4 a[68:71], v2, s[12:15], s6 offen offset:1024 sc0 sc1
    v_mfma_f32_16x16x32_bf16 v[114:117], v[138:141], v[150:153], v[114:117]
    ds_read_b64 v[118:119], v222 offset:1344
    ds_read_b64 v[120:121], v222 offset:1352
    v_fma_f32 v208, v226, v208, v16
    s_waitcnt lgkmcnt(9)
    v_mfma_f32_16x16x32_bf16 v[114:117], v[126:129], v[242:245], v[114:117]
    ds_read_b128 v[142:145], v223 offset:2880
    v_fma_f32 v193, v226, v193, -v13
    s_waitcnt lgkmcnt(9)
    v_mfma_f32_16x16x32_bf16 v[114:117], v[238:241], v[130:133], v[114:117]
    v_fma_f32 v209, v226, v209, v17
    v_mul_f32 v12, v227, v210
    s_waitcnt lgkmcnt(6)
    v_mfma_f32_16x16x32_bf16 v[18:21], v[146:149], v[122:125], v[18:21]
    v_mul_f32 v16, v227, v194
    buffer_load_dwordx4 a[72:75], v2, s[12:15], s6 offen offset:2048 sc0 sc1
    s_waitcnt lgkmcnt(4)
    v_mfma_f32_16x16x32_bf16 v[24:27], v[250:253], v[122:125], v[24:27]
    v_mul_f32 v13, v227, v211
    v_mul_f32 v17, v227, v195
    s_waitcnt lgkmcnt(3)
    v_mfma_f32_16x16x32_bf16 v[24:27], v[146:149], v[246:249], v[24:27]
    ds_read_b64 v[134:135], v222 offset:1856
    ds_read_b64 v[136:137], v222 offset:1864
    v_fma_f32 v194, v226, v194, -v12
    v_mfma_f32_16x16x32_bf16 v[28:31], v[250:253], v[246:249], v[28:31]
    ds_read_b128 v[138:141], v223 offset:2368
    v_fma_f32 v210, v226, v210, v16
    s_waitcnt lgkmcnt(4)
    v_mfma_f32_16x16x32_bf16 v[28:31], v[118:121], v[122:125], v[28:31]
    v_fma_f32 v195, v226, v195, -v13
    buffer_load_dwordx4 a[76:79], v2, s[12:15], s6 offen offset:3072 sc0 sc1
    s_waitcnt lgkmcnt(3)
    v_mfma_f32_16x16x32_bf16 v[28:31], v[146:149], v[142:145], v[28:31]
    v_fma_f32 v211, v226, v211, v17
    v_mul_f32 v12, v227, v212
    v_mfma_f32_16x16x32_bf16 v[32:35], v[118:121], v[246:249], v[32:35]
    v_mul_f32 v16, v227, v196
    v_mul_f32 v13, v227, v213
    v_mfma_f32_16x16x32_bf16 v[32:35], v[250:253], v[142:145], v[32:35]
    v_mul_f32 v17, v227, v197
    s_mov_b32 s6, 20480
    v_mfma_f32_16x16x32_bf16 v[36:39], v[118:121], v[142:145], v[36:39]
    buffer_load_dwordx4 a[80:83], v2, s[12:15], s6 offen offset:0 sc0 sc1
    v_fma_f32 v196, v226, v196, -v12
    s_waitcnt lgkmcnt(1)
    v_mfma_f32_16x16x32_bf16 v[32:35], v[134:137], v[122:125], v[32:35]
    ds_read_b64 v[150:151], v222 offset:2368
    ds_read_b64 v[152:153], v222 offset:2376
    v_fma_f32 v212, v226, v212, v16
    s_waitcnt lgkmcnt(2)
    v_mfma_f32_16x16x32_bf16 v[32:35], v[146:149], v[138:141], v[32:35]
    ds_read_b128 v[126:129], v223 offset:1856
    v_fma_f32 v197, v226, v197, -v13
    v_mfma_f32_16x16x32_bf16 v[36:39], v[134:137], v[246:249], v[36:39]
    v_fma_f32 v213, v226, v213, v17
    v_mul_f32 v12, v227, v214
    v_mfma_f32_16x16x32_bf16 v[36:39], v[250:253], v[138:141], v[36:39]
    buffer_load_dwordx4 a[84:87], v2, s[12:15], s6 offen offset:1024 sc0 sc1
    v_mul_f32 v16, v227, v198
    v_mfma_f32_16x16x32_bf16 v[106:109], v[134:137], v[142:145], v[106:109]
    v_mul_f32 v13, v227, v215
    v_mul_f32 v17, v227, v199
    v_mfma_f32_16x16x32_bf16 v[106:109], v[118:121], v[138:141], v[106:109]
    v_fma_f32 v198, v226, v198, -v12
    v_fma_f32 v214, v226, v214, v16
    v_mfma_f32_16x16x32_bf16 v[110:113], v[134:137], v[138:141], v[110:113]
    buffer_load_dwordx4 a[88:91], v2, s[12:15], s6 offen offset:2048 sc0 sc1
    v_fma_f32 v199, v226, v199, -v13
    s_waitcnt lgkmcnt(1)
    v_mfma_f32_16x16x32_bf16 v[36:39], v[150:153], v[122:125], v[36:39]
    v_fma_f32 v215, v226, v215, v17
    v_mul_f32 v12, v227, v216
    s_waitcnt lgkmcnt(0)
    v_mfma_f32_16x16x32_bf16 v[36:39], v[146:149], v[126:129], v[36:39]
    ds_read_b64 v[242:243], v222 offset:2880
    ds_read_b64 v[244:245], v222 offset:2888
    v_mul_f32 v16, v227, v200
    v_mfma_f32_16x16x32_bf16 v[106:109], v[150:153], v[246:249], v[106:109]
    ds_read_b128 v[238:241], v223 offset:1344
    v_mul_f32 v13, v227, v217
    v_mfma_f32_16x16x32_bf16 v[106:109], v[250:253], v[126:129], v[106:109]
    buffer_load_dwordx4 a[92:95], v2, s[12:15], s6 offen offset:3072 sc0 sc1
    v_mul_f32 v17, v227, v201
    v_mfma_f32_16x16x32_bf16 v[110:113], v[150:153], v[142:145], v[110:113]
    v_fma_f32 v200, v226, v200, -v12
    v_fma_f32 v216, v226, v216, v16
    v_mfma_f32_16x16x32_bf16 v[110:113], v[118:121], v[126:129], v[110:113]
    v_fma_f32 v201, v226, v201, -v13
    v_fma_f32 v217, v226, v217, v17
    v_mfma_f32_16x16x32_bf16 v[114:117], v[150:153], v[138:141], v[114:117]
    v_mul_f32 v12, v227, v218
    v_mul_f32 v16, v227, v202
    v_mfma_f32_16x16x32_bf16 v[114:117], v[134:137], v[126:129], v[114:117]
    ds_read_b64 v[130:131], v222 offset:3392
    ds_read_b64 v[132:133], v222 offset:3400
    v_mul_f32 v13, v227, v219
    s_waitcnt lgkmcnt(3)
    v_mfma_f32_16x16x32_bf16 v[106:109], v[242:245], v[122:125], v[106:109]
    ds_read_b128 v[150:153], v223 offset:832
    v_mul_f32 v17, v227, v203
    s_waitcnt lgkmcnt(3)
    v_mfma_f32_16x16x32_bf16 v[106:109], v[146:149], v[238:241], v[106:109]
    v_fma_f32 v202, v226, v202, -v12
    v_fma_f32 v218, v226, v218, v16
    v_mfma_f32_16x16x32_bf16 v[110:113], v[242:245], v[246:249], v[110:113]
    v_fma_f32 v203, v226, v203, -v13
    v_fma_f32 v219, v226, v219, v17
    v_mfma_f32_16x16x32_bf16 v[110:113], v[250:253], v[238:241], v[110:113]
    ds_read_b64 v[138:139], v222 offset:3904
    ds_read_b64 v[140:141], v222 offset:3912
    v_subrev_u32 v46, 0, v8
    v_mfma_f32_16x16x32_bf16 v[114:117], v[242:245], v[142:145], v[114:117]
    ds_read_b128 v[134:137], v223 offset:320
    v_min_u32 v46, 0x7fff0000, v46
    v_mfma_f32_16x16x32_bf16 v[114:117], v[118:121], v[238:241], v[114:117]
    ds_read_b64 v[126:127], v222 offset:256
    ds_read_b64 v[128:129], v222 offset:264
    buffer_load_dwordx4 v[46:49], v46, s[20:23], 0 offen sc0 sc1
    s_waitcnt lgkmcnt(6)
    v_mfma_f32_16x16x32_bf16 v[110:113], v[130:133], v[122:125], v[110:113]
    ds_read_b128 v[242:245], v223 offset:3840
    v_subrev_u32 v50, 1024, v8
    s_waitcnt lgkmcnt(6)
    v_mfma_f32_16x16x32_bf16 v[110:113], v[146:149], v[150:153], v[110:113]
    ds_read_b64 v[142:143], v222 offset:768
    ds_read_b64 v[144:145], v222 offset:776
    v_min_u32 v50, 0x7fff0000, v50
    v_mfma_f32_16x16x32_bf16 v[114:117], v[130:133], v[246:249], v[114:117]
    ds_read_b128 v[118:121], v223 offset:3328
    buffer_load_dwordx4 v[50:53], v50, s[20:23], 0 offen sc0 sc1
    v_mfma_f32_16x16x32_bf16 v[114:117], v[250:253], v[150:153], v[114:117]
    ds_read_b64 v[238:239], v222 offset:1280
    ds_read_b64 v[240:241], v222 offset:1288
    v_subrev_u32 v54, 2048, v8
    s_waitcnt lgkmcnt(9)
    v_mfma_f32_16x16x32_bf16 v[114:117], v[138:141], v[122:125], v[114:117]
    ds_read_b128 v[130:133], v223 offset:2816
    v_min_u32 v54, 0x7fff0000, v54
    s_waitcnt lgkmcnt(9)
    v_mfma_f32_16x16x32_bf16 v[114:117], v[146:149], v[134:137], v[114:117]
    buffer_load_dwordx4 v[54:57], v54, s[20:23], 0 offen sc0 sc1
    v_subrev_u32 v58, 3072, v8
    s_waitcnt lgkmcnt(6)
    v_mfma_f32_16x16x32_bf16 v[18:21], v[126:129], v[242:245], v[18:21]
    v_min_u32 v58, 0x7fff0000, v58
    buffer_load_dwordx4 v[58:61], v58, s[20:23], 0 offen sc0 sc1
    s_waitcnt lgkmcnt(4)
    v_mfma_f32_16x16x32_bf16 v[24:27], v[142:145], v[242:245], v[24:27]
    v_subrev_u32 v62, 4096, v8
    v_min_u32 v62, 0x7fff0000, v62
    s_waitcnt lgkmcnt(3)
    v_mfma_f32_16x16x32_bf16 v[24:27], v[126:129], v[118:121], v[24:27]
    ds_read_b64 v[246:247], v222 offset:1792
    ds_read_b64 v[248:249], v222 offset:1800
    buffer_load_dwordx4 v[62:65], v62, s[20:23], 0 offen sc0 sc1
    v_mfma_f32_16x16x32_bf16 v[28:31], v[142:145], v[118:121], v[28:31]
    ds_read_b128 v[250:253], v223 offset:2304
    v_subrev_u32 v66, 5120, v8
    s_waitcnt lgkmcnt(4)
    v_mfma_f32_16x16x32_bf16 v[28:31], v[238:241], v[242:245], v[28:31]
    v_min_u32 v66, 0x7fff0000, v66
    buffer_load_dwordx4 v[66:69], v66, s[20:23], 0 offen sc0 sc1
    s_waitcnt lgkmcnt(3)
    v_mfma_f32_16x16x32_bf16 v[28:31], v[126:129], v[130:133], v[28:31]
    v_subrev_u32 v70, 6144, v8
    v_min_u32 v70, 0x7fff0000, v70
    v_mfma_f32_16x16x32_bf16 v[32:35], v[238:241], v[118:121], v[32:35]
    buffer_load_dwordx4 v[70:73], v70, s[20:23], 0 offen sc0 sc1
    v_subrev_u32 v74, 7168, v8
    v_mfma_f32_16x16x32_bf16 v[32:35], v[142:145], v[130:133], v[32:35]
    v_min_u32 v74, 0x7fff0000, v74
    buffer_load_dwordx4 v[74:77], v74, s[20:23], 0 offen sc0 sc1
    v_mfma_f32_16x16x32_bf16 v[36:39], v[238:241], v[130:133], v[36:39]
    v_subrev_u32 v78, 8192, v8
    v_min_u32 v78, 0x7fff0000, v78
    s_waitcnt lgkmcnt(1)
    v_mfma_f32_16x16x32_bf16 v[32:35], v[246:249], v[242:245], v[32:35]
    ds_read_b64 v[150:151], v222 offset:2304
    ds_read_b64 v[152:153], v222 offset:2312
    buffer_load_dwordx4 v[78:81], v78, s[20:23], 0 offen sc0 sc1
    s_waitcnt lgkmcnt(2)
    v_mfma_f32_16x16x32_bf16 v[32:35], v[126:129], v[250:253], v[32:35]
    ds_read_b128 v[138:141], v223 offset:1792
    v_subrev_u32 v82, 9216, v8
    v_mfma_f32_16x16x32_bf16 v[36:39], v[246:249], v[118:121], v[36:39]
    v_min_u32 v82, 0x7fff0000, v82
    buffer_load_dwordx4 v[82:85], v82, s[20:23], 0 offen sc0 sc1
    v_mfma_f32_16x16x32_bf16 v[36:39], v[142:145], v[250:253], v[36:39]
    v_subrev_u32 v86, 10240, v8
    v_min_u32 v86, 0x7fff0000, v86
    v_mfma_f32_16x16x32_bf16 v[106:109], v[246:249], v[130:133], v[106:109]
    buffer_load_dwordx4 v[86:89], v86, s[20:23], 0 offen sc0 sc1
    v_subrev_u32 v90, 11264, v8
    v_mfma_f32_16x16x32_bf16 v[106:109], v[238:241], v[250:253], v[106:109]
    v_min_u32 v90, 0x7fff0000, v90
    buffer_load_dwordx4 v[90:93], v90, s[20:23], 0 offen sc0 sc1
    v_mfma_f32_16x16x32_bf16 v[110:113], v[246:249], v[250:253], v[110:113]
    v_subrev_u32 v94, 12288, v8
    v_min_u32 v94, 0x7fff0000, v94
    s_waitcnt lgkmcnt(1)
    v_mfma_f32_16x16x32_bf16 v[36:39], v[150:153], v[242:245], v[36:39]
    buffer_load_dwordx4 v[94:97], v94, s[20:23], 0 offen sc0 sc1
    v_subrev_u32 v98, 13312, v8
    s_waitcnt lgkmcnt(0)
    v_mfma_f32_16x16x32_bf16 v[36:39], v[126:129], v[138:141], v[36:39]
    ds_read_b64 v[122:123], v222 offset:2816
    ds_read_b64 v[124:125], v222 offset:2824
    v_min_u32 v98, 0x7fff0000, v98
    v_mfma_f32_16x16x32_bf16 v[106:109], v[150:153], v[118:121], v[106:109]
    ds_read_b128 v[146:149], v223 offset:1280
    buffer_load_dwordx4 v[98:101], v98, s[20:23], 0 offen sc0 sc1
    v_mfma_f32_16x16x32_bf16 v[106:109], v[142:145], v[138:141], v[106:109]
    v_subrev_u32 v102, 14336, v8
    v_min_u32 v102, 0x7fff0000, v102
    v_mfma_f32_16x16x32_bf16 v[110:113], v[150:153], v[130:133], v[110:113]
    buffer_load_dwordx4 v[102:105], v102, s[20:23], 0 offen sc0 sc1
    v_mfma_f32_16x16x32_bf16 v[110:113], v[238:241], v[138:141], v[110:113]
    v_mfma_f32_16x16x32_bf16 v[114:117], v[150:153], v[250:253], v[114:117]
    v_mfma_f32_16x16x32_bf16 v[114:117], v[246:249], v[138:141], v[114:117]
    ds_read_b64 v[134:135], v222 offset:3328
    ds_read_b64 v[136:137], v222 offset:3336
    s_waitcnt lgkmcnt(3)
    v_mfma_f32_16x16x32_bf16 v[106:109], v[122:125], v[242:245], v[106:109]
    ds_read_b128 v[150:153], v223 offset:768
    s_waitcnt lgkmcnt(3)
    v_mfma_f32_16x16x32_bf16 v[106:109], v[126:129], v[146:149], v[106:109]
    v_mfma_f32_16x16x32_bf16 v[110:113], v[122:125], v[118:121], v[110:113]
    v_mfma_f32_16x16x32_bf16 v[110:113], v[142:145], v[146:149], v[110:113]
    ds_read_b64 v[250:251], v222 offset:3840
    ds_read_b64 v[252:253], v222 offset:3848
    v_mfma_f32_16x16x32_bf16 v[114:117], v[122:125], v[130:133], v[114:117]
    ds_read_b128 v[246:249], v223 offset:256
    v_mfma_f32_16x16x32_bf16 v[114:117], v[238:241], v[146:149], v[114:117]
    s_waitcnt lgkmcnt(4)
    v_mfma_f32_16x16x32_bf16 v[110:113], v[134:137], v[242:245], v[110:113]
    s_waitcnt lgkmcnt(3)
    v_mfma_f32_16x16x32_bf16 v[110:113], v[126:129], v[150:153], v[110:113]
    v_mfma_f32_16x16x32_bf16 v[114:117], v[134:137], v[118:121], v[114:117]
    v_mfma_f32_16x16x32_bf16 v[114:117], v[142:145], v[150:153], v[114:117]
    s_waitcnt lgkmcnt(1)
    v_mfma_f32_16x16x32_bf16 v[114:117], v[250:253], v[242:245], v[114:117]
    s_waitcnt lgkmcnt(0)
    v_mfma_f32_16x16x32_bf16 v[114:117], v[126:129], v[246:249], v[114:117]
    s_mov_b32 s24, 0
    v_mov_b32 v4, 0
    s_waitcnt vmcnt(14)
    v_cmp_eq_u64 s[28:29], s[8:9], v[48:49]
    s_waitcnt vmcnt(13)
    v_cmp_eq_u64 s[30:31], s[8:9], v[52:53]
    s_waitcnt vmcnt(12)
    v_cmp_eq_u64 s[32:33], s[8:9], v[56:57]
    s_waitcnt vmcnt(11)
    v_cmp_eq_u64 s[34:35], s[8:9], v[60:61]
    s_waitcnt vmcnt(10)
    v_cmp_eq_u64 s[36:37], s[8:9], v[64:65]
    v_addc_co_u32 v4, vcc, 0, v4, s[28:29]
    v_addc_co_u32 v4, vcc, 0, v4, s[30:31]
    v_addc_co_u32 v4, vcc, 0, v4, s[32:33]
    v_addc_co_u32 v4, vcc, 0, v4, s[34:35]
    v_addc_co_u32 v4, vcc, 0, v4, s[36:37]
    s_waitcnt vmcnt(9)
    v_cmp_eq_u64 s[28:29], s[8:9], v[68:69]
    s_waitcnt vmcnt(8)
    v_cmp_eq_u64 s[30:31], s[8:9], v[72:73]
    s_waitcnt vmcnt(7)
    v_cmp_eq_u64 s[32:33], s[8:9], v[76:77]
    s_waitcnt vmcnt(6)
    v_cmp_eq_u64 s[34:35], s[8:9], v[80:81]
    s_waitcnt vmcnt(5)
    v_cmp_eq_u64 s[36:37], s[8:9], v[84:85]
    v_addc_co_u32 v4, vcc, 0, v4, s[28:29]
    v_addc_co_u32 v4, vcc, 0, v4, s[30:31]
    v_addc_co_u32 v4, vcc, 0, v4, s[32:33]
    v_addc_co_u32 v4, vcc, 0, v4, s[34:35]
    v_addc_co_u32 v4, vcc, 0, v4, s[36:37]
    s_waitcnt vmcnt(4)
    v_cmp_eq_u64 s[28:29], s[8:9], v[88:89]
    s_waitcnt vmcnt(3)
    v_cmp_eq_u64 s[30:31], s[8:9], v[92:93]
    s_waitcnt vmcnt(2)
    v_cmp_eq_u64 s[32:33], s[8:9], v[96:97]
    s_waitcnt vmcnt(1)
    v_cmp_eq_u64 s[34:35], s[8:9], v[100:101]
    s_waitcnt vmcnt(0)
    v_cmp_eq_u64 s[36:37], s[8:9], v[104:105]
    v_addc_co_u32 v4, vcc, 0, v4, s[28:29]
    v_addc_co_u32 v4, vcc, 0, v4, s[30:31]
    v_addc_co_u32 v4, vcc, 0, v4, s[32:33]
    v_addc_co_u32 v4, vcc, 0, v4, s[34:35]
    v_addc_co_u32 v4, vcc, 0, v4, s[36:37]
    v_cmp_ne_u32 vcc, s11, v4
    s_nop 4
    s_cbranch_vccz Lpolldone_gate_7
Lpoll_gate_8:
    v_subrev_u32 v46, 0, v8
    v_min_u32 v46, 0x7fff0000, v46
    buffer_load_dwordx4 v[46:49], v46, s[20:23], 0 offen sc0 sc1
    v_subrev_u32 v50, 1024, v8
    v_min_u32 v50, 0x7fff0000, v50
    buffer_load_dwordx4 v[50:53], v50, s[20:23], 0 offen sc0 sc1
    v_subrev_u32 v54, 2048, v8
    v_min_u32 v54, 0x7fff0000, v54
    buffer_load_dwordx4 v[54:57], v54, s[20:23], 0 offen sc0 sc1
    v_subrev_u32 v58, 3072, v8
    v_min_u32 v58, 0x7fff0000, v58
    buffer_load_dwordx4 v[58:61], v58, s[20:23], 0 offen sc0 sc1
    v_subrev_u32 v62, 4096, v8
    v_min_u32 v62, 0x7fff0000, v62
    buffer_load_dwordx4 v[62:65], v62, s[20:23], 0 offen sc0 sc1
    v_subrev_u32 v66, 5120, v8
    v_min_u32 v66, 0x7fff0000, v66
    buffer_load_dwordx4 v[66:69], v66, s[20:23], 0 offen sc0 sc1
    v_subrev_u32 v70, 6144, v8
    v_min_u32 v70, 0x7fff0000, v70
    buffer_load_dwordx4 v[70:73], v70, s[20:23], 0 offen sc0 sc1
    v_subrev_u32 v74, 7168, v8
    v_min_u32 v74, 0x7fff0000, v74
    buffer_load_dwordx4 v[74:77], v74, s[20:23], 0 offen sc0 sc1
    v_subrev_u32 v78, 8192, v8
    v_min_u32 v78, 0x7fff0000, v78
    buffer_load_dwordx4 v[78:81], v78, s[20:23], 0 offen sc0 sc1
    v_subrev_u32 v82, 9216, v8
    v_min_u32 v82, 0x7fff0000, v82
    buffer_load_dwordx4 v[82:85], v82, s[20:23], 0 offen sc0 sc1
    v_subrev_u32 v86, 10240, v8
    v_min_u32 v86, 0x7fff0000, v86
    buffer_load_dwordx4 v[86:89], v86, s[20:23], 0 offen sc0 sc1
    v_subrev_u32 v90, 11264, v8
    v_min_u32 v90, 0x7fff0000, v90
    buffer_load_dwordx4 v[90:93], v90, s[20:23], 0 offen sc0 sc1
    v_subrev_u32 v94, 12288, v8
    v_min_u32 v94, 0x7fff0000, v94
    buffer_load_dwordx4 v[94:97], v94, s[20:23], 0 offen sc0 sc1
    v_subrev_u32 v98, 13312, v8
    v_min_u32 v98, 0x7fff0000, v98
    buffer_load_dwordx4 v[98:101], v98, s[20:23], 0 offen sc0 sc1
    v_subrev_u32 v102, 14336, v8
    v_min_u32 v102, 0x7fff0000, v102
    buffer_load_dwordx4 v[102:105], v102, s[20:23], 0 offen sc0 sc1
    s_waitcnt vmcnt(0)
    v_mov_b32 v4, 0
    v_cmp_eq_u64 s[28:29], s[8:9], v[48:49]
    v_cmp_eq_u64 s[30:31], s[8:9], v[52:53]
    v_cmp_eq_u64 s[32:33], s[8:9], v[56:57]
    v_cmp_eq_u64 s[34:35], s[8:9], v[60:61]
    v_cmp_eq_u64 s[36:37], s[8:9], v[64:65]
    v_addc_co_u32 v4, vcc, 0, v4, s[28:29]
    v_addc_co_u32 v4, vcc, 0, v4, s[30:31]
    v_addc_co_u32 v4, vcc, 0, v4, s[32:33]
    v_addc_co_u32 v4, vcc, 0, v4, s[34:35]
    v_addc_co_u32 v4, vcc, 0, v4, s[36:37]
    v_cmp_eq_u64 s[28:29], s[8:9], v[68:69]
    v_cmp_eq_u64 s[30:31], s[8:9], v[72:73]
    v_cmp_eq_u64 s[32:33], s[8:9], v[76:77]
    v_cmp_eq_u64 s[34:35], s[8:9], v[80:81]
    v_cmp_eq_u64 s[36:37], s[8:9], v[84:85]
    v_addc_co_u32 v4, vcc, 0, v4, s[28:29]
    v_addc_co_u32 v4, vcc, 0, v4, s[30:31]
    v_addc_co_u32 v4, vcc, 0, v4, s[32:33]
    v_addc_co_u32 v4, vcc, 0, v4, s[34:35]
    v_addc_co_u32 v4, vcc, 0, v4, s[36:37]
    v_cmp_eq_u64 s[28:29], s[8:9], v[88:89]
    v_cmp_eq_u64 s[30:31], s[8:9], v[92:93]
    v_cmp_eq_u64 s[32:33], s[8:9], v[96:97]
    v_cmp_eq_u64 s[34:35], s[8:9], v[100:101]
    v_cmp_eq_u64 s[36:37], s[8:9], v[104:105]
    v_addc_co_u32 v4, vcc, 0, v4, s[28:29]
    v_addc_co_u32 v4, vcc, 0, v4, s[30:31]
    v_addc_co_u32 v4, vcc, 0, v4, s[32:33]
    v_addc_co_u32 v4, vcc, 0, v4, s[34:35]
    v_addc_co_u32 v4, vcc, 0, v4, s[36:37]
    v_cmp_ne_u32 vcc, s11, v4
    s_add_u32 s24, s24, 1
    s_cmp_gt_u32 s24, 20000
    s_cbranch_scc1 Lpolldone_gate_7
    s_nop 1
    s_cbranch_vccnz Lpoll_gate_8
Lpolldone_gate_7:
    s_nop 4
    v_fma_f32 v40, -v231, v103, v98
    v_fma_f32 v41, v231, v102, v99
    v_fma_f32 v98, v230, v102, v40
    v_fma_f32 v99, v230, v103, v41
    v_fma_f32 v40, -v231, v99, v94
    v_fma_f32 v41, v231, v98, v95
    v_fma_f32 v94, v230, v98, v40
    v_fma_f32 v95, v230, v99, v41
    v_fma_f32 v40, -v231, v95, v90
    v_fma_f32 v41, v231, v94, v91
    v_fma_f32 v90, v230, v94, v40
    v_fma_f32 v91, v230, v95, v41
    v_fma_f32 v40, -v231, v91, v86
    v_fma_f32 v41, v231, v90, v87
    v_fma_f32 v86, v230, v90, v40
    v_fma_f32 v87, v230, v91, v41
    v_fma_f32 v40, -v231, v87, v82
    v_fma_f32 v41, v231, v86, v83
    v_fma_f32 v82, v230, v86, v40
    v_fma_f32 v83, v230, v87, v41
    v_fma_f32 v40, -v231, v83, v78
    v_fma_f32 v41, v231, v82, v79
    v_fma_f32 v78, v230, v82, v40
    v_fma_f32 v79, v230, v83, v41
    v_fma_f32 v40, -v231, v79, v74
    v_fma_f32 v41, v231, v78, v75
    v_fma_f32 v74, v230, v78, v40
    v_fma_f32 v75, v230, v79, v41
    v_fma_f32 v40, -v231, v75, v70
    v_fma_f32 v41, v231, v74, v71
    v_fma_f32 v70, v230, v74, v40
    v_fma_f32 v71, v230, v75, v41
    v_fma_f32 v40, -v231, v71, v66
    v_fma_f32 v41, v231, v70, v67
    v_fma_f32 v66, v230, v70, v40
    v_fma_f32 v67, v230, v71, v41
    v_fma_f32 v40, -v231, v67, v62
    v_fma_f32 v41, v231, v66, v63
    v_fma_f32 v62, v230, v66, v40
    v_fma_f32 v63, v230, v67, v41
    v_fma_f32 v40, -v231, v63, v58
    v_fma_f32 v41, v231, v62, v59
    v_fma_f32 v58, v230, v62, v40
    v_fma_f32 v59, v230, v63, v41
    v_fma_f32 v40, -v231, v59, v54
    v_fma_f32 v41, v231, v58, v55
    v_fma_f32 v54, v230, v58, v40
    v_fma_f32 v55, v230, v59, v41
    v_fma_f32 v40, -v231, v55, v50
    v_fma_f32 v41, v231, v54, v51
    v_fma_f32 v50, v230, v54, v40
    v_fma_f32 v51, v230, v55, v41
    v_fma_f32 v40, -v231, v51, v46
    v_fma_f32 v41, v231, v50, v47
    v_fma_f32 v46, v230, v50, v40
    v_fma_f32 v47, v230, v51, v41
    v_mov_b32 v10, v46
    v_mov_b32 v11, v47
    v_pk_fma_f32 v[12:13], v[234:235], v[10:11], v[42:43] op_sel:[0,1,0] op_sel_hi:[1,1,1] neg_lo:[0,1,0] neg_hi:[0,1,0]
    v_pk_fma_f32 v[16:17], v[232:233], v[10:11], v[44:45] op_sel:[0,1,0] op_sel_hi:[1,1,1]
    v_pk_fma_f32 v[4:5], v[232:233], v[10:11], v[12:13] op_sel:[0,0,0] op_sel_hi:[1,0,1]
    v_pk_fma_f32 v[6:7], v[234:235], v[10:11], v[16:17] op_sel:[0,0,0] op_sel_hi:[1,0,1]
    v_pk_mul_f32 v[12:13], v[6:7], v[226:227] op_sel:[0,1] op_sel_hi:[1,1] neg_lo:[0,1] neg_hi:[0,1]
    v_pk_mul_f32 v[16:17], v[4:5], v[226:227] op_sel:[0,1] op_sel_hi:[1,1]
    v_pk_fma_f32 v[4:5], v[4:5], v[226:227], v[12:13] op_sel:[0,0,0] op_sel_hi:[1,0,1]
    v_pk_fma_f32 v[6:7], v[6:7], v[226:227], v[16:17] op_sel:[0,0,0] op_sel_hi:[1,0,1]
    v_lshrrev_b32 v14, 5, v1
    v_lshlrev_b32 v14, 13, v14
    v_lshl_add_u32 v8, v15, 2, v14
    s_lshr_b32 s3, s10, 1
    s_lshl_b32 s3, s3, 14
    s_add_u32 s3, s3, 84992
    v_add_u32 v8, s3, v8
    v_xor_b32 v9, 16, v8
    v_pk_fma_f32 v[12:13], v[6:7], v[224:225], v[156:157] op_sel:[0,1,0] op_sel_hi:[1,1,1] neg_lo:[0,1,0] neg_hi:[0,1,0]
    v_pk_fma_f32 v[16:17], v[4:5], v[224:225], v[172:173] op_sel:[0,1,0] op_sel_hi:[1,1,1]
    v_pk_fma_f32 v[156:157], v[4:5], v[224:225], v[12:13] op_sel:[0,0,0] op_sel_hi:[1,0,1]
    v_pk_fma_f32 v[172:173], v[6:7], v[224:225], v[16:17] op_sel:[0,0,0] op_sel_hi:[1,0,1]
    v_pk_fma_f32 v[12:13], v[172:173], v[224:225], v[158:159] op_sel:[0,1,0] op_sel_hi:[1,1,1] neg_lo:[0,1,0] neg_hi:[0,1,0]
    v_pk_fma_f32 v[16:17], v[156:157], v[224:225], v[174:175] op_sel:[0,1,0] op_sel_hi:[1,1,1]
    v_pk_fma_f32 v[158:159], v[156:157], v[224:225], v[12:13] op_sel:[0,0,0] op_sel_hi:[1,0,1]
    v_pk_fma_f32 v[174:175], v[172:173], v[224:225], v[16:17] op_sel:[0,0,0] op_sel_hi:[1,0,1]
    v_cvt_pk_bf16_f32 v46, v156, -v172
    v_cvt_pk_bf16_f32 v47, v157, -v173
    ds_write2st64_b32 v8, v46, v47 offset0:0 offset1:16
    v_pk_fma_f32 v[12:13], v[174:175], v[224:225], v[160:161] op_sel:[0,1,0] op_sel_hi:[1,1,1] neg_lo:[0,1,0] neg_hi:[0,1,0]
    v_pk_fma_f32 v[16:17], v[158:159], v[224:225], v[176:177] op_sel:[0,1,0] op_sel_hi:[1,1,1]
    v_pk_fma_f32 v[160:161], v[158:159], v[224:225], v[12:13] op_sel:[0,0,0] op_sel_hi:[1,0,1]
    v_pk_fma_f32 v[176:177], v[174:175], v[224:225], v[16:17] op_sel:[0,0,0] op_sel_hi:[1,0,1]
    v_cvt_pk_bf16_f32 v40, v158, -v174
    v_cvt_pk_bf16_f32 v41, v159, -v175
    ds_write2st64_b32 v9, v40, v41 offset0:1 offset1:17
    v_pk_fma_f32 v[12:13], v[176:177], v[224:225], v[162:163] op_sel:[0,1,0] op_sel_hi:[1,1,1] neg_lo:[0,1,0] neg_hi:[0,1,0]
    v_pk_fma_f32 v[16:17], v[160:161], v[224:225], v[178:179] op_sel:[0,1,0] op_sel_hi:[1,1,1]
    v_pk_fma_f32 v[162:163], v[160:161], v[224:225], v[12:13] op_sel:[0,0,0] op_sel_hi:[1,0,1]
    v_pk_fma_f32 v[178:179], v[176:177], v[224:225], v[16:17] op_sel:[0,0,0] op_sel_hi:[1,0,1]
    v_cvt_pk_bf16_f32 v46, v160, -v176
    v_cvt_pk_bf16_f32 v47, v161, -v177
    ds_write2st64_b32 v8, v46, v47 offset0:2 offset1:18
    v_pk_fma_f32 v[12:13], v[178:179], v[224:225], v[164:165] op_sel:[0,1,0] op_sel_hi:[1,1,1] neg_lo:[0,1,0] neg_hi:[0,1,0]
    v_pk_fma_f32 v[16:17], v[162:163], v[224:225], v[180:181] op_sel:[0,1,0] op_sel_hi:[1,1,1]
    v_pk_fma_f32 v[164:165], v[162:163], v[224:225], v[12:13] op_sel:[0,0,0] op_sel_hi:[1,0,1]
    v_pk_fma_f32 v[180:181], v[178:179], v[224:225], v[16:17] op_sel:[0,0,0] op_sel_hi:[1,0,1]
    v_cvt_pk_bf16_f32 v40, v162, -v178
    v_cvt_pk_bf16_f32 v41, v163, -v179
    ds_write2st64_b32 v9, v40, v41 offset0:3 offset1:19
    v_pk_fma_f32 v[12:13], v[180:181], v[224:225], v[166:167] op_sel:[0,1,0] op_sel_hi:[1,1,1] neg_lo:[0,1,0] neg_hi:[0,1,0]
    v_pk_fma_f32 v[16:17], v[164:165], v[224:225], v[182:183] op_sel:[0,1,0] op_sel_hi:[1,1,1]
    v_pk_fma_f32 v[166:167], v[164:165], v[224:225], v[12:13] op_sel:[0,0,0] op_sel_hi:[1,0,1]
    v_pk_fma_f32 v[182:183], v[180:181], v[224:225], v[16:17] op_sel:[0,0,0] op_sel_hi:[1,0,1]
    v_cvt_pk_bf16_f32 v46, v164, -v180
    v_cvt_pk_bf16_f32 v47, v165, -v181
    ds_write2st64_b32 v8, v46, v47 offset0:4 offset1:20
    v_pk_fma_f32 v[12:13], v[182:183], v[224:225], v[168:169] op_sel:[0,1,0] op_sel_hi:[1,1,1] neg_lo:[0,1,0] neg_hi:[0,1,0]
    v_pk_fma_f32 v[16:17], v[166:167], v[224:225], v[184:185] op_sel:[0,1,0] op_sel_hi:[1,1,1]
    v_pk_fma_f32 v[168:169], v[166:167], v[224:225], v[12:13] op_sel:[0,0,0] op_sel_hi:[1,0,1]
    v_pk_fma_f32 v[184:185], v[182:183], v[224:225], v[16:17] op_sel:[0,0,0] op_sel_hi:[1,0,1]
    v_cvt_pk_bf16_f32 v40, v166, -v182
    v_cvt_pk_bf16_f32 v41, v167, -v183
    ds_write2st64_b32 v9, v40, v41 offset0:5 offset1:21
    v_pk_fma_f32 v[12:13], v[184:185], v[224:225], v[170:171] op_sel:[0,1,0] op_sel_hi:[1,1,1] neg_lo:[0,1,0] neg_hi:[0,1,0]
    v_pk_fma_f32 v[16:17], v[168:169], v[224:225], v[186:187] op_sel:[0,1,0] op_sel_hi:[1,1,1]
    v_pk_fma_f32 v[170:171], v[168:169], v[224:225], v[12:13] op_sel:[0,0,0] op_sel_hi:[1,0,1]
    v_pk_fma_f32 v[186:187], v[184:185], v[224:225], v[16:17] op_sel:[0,0,0] op_sel_hi:[1,0,1]
    v_cvt_pk_bf16_f32 v46, v168, -v184
    v_cvt_pk_bf16_f32 v47, v169, -v185
    ds_write2st64_b32 v8, v46, v47 offset0:6 offset1:22
    v_pk_fma_f32 v[12:13], v[186:187], v[224:225], v[188:189] op_sel:[0,1,0] op_sel_hi:[1,1,1] neg_lo:[0,1,0] neg_hi:[0,1,0]
    v_pk_fma_f32 v[16:17], v[170:171], v[224:225], v[204:205] op_sel:[0,1,0] op_sel_hi:[1,1,1]
    v_pk_fma_f32 v[188:189], v[170:171], v[224:225], v[12:13] op_sel:[0,0,0] op_sel_hi:[1,0,1]
    v_pk_fma_f32 v[204:205], v[186:187], v[224:225], v[16:17] op_sel:[0,0,0] op_sel_hi:[1,0,1]
    v_cvt_pk_bf16_f32 v40, v170, -v186
    v_cvt_pk_bf16_f32 v41, v171, -v187
    ds_write2st64_b32 v9, v40, v41 offset0:7 offset1:23
    v_pk_fma_f32 v[12:13], v[204:205], v[224:225], v[190:191] op_sel:[0,1,0] op_sel_hi:[1,1,1] neg_lo:[0,1,0] neg_hi:[0,1,0]
    v_pk_fma_f32 v[16:17], v[188:189], v[224:225], v[206:207] op_sel:[0,1,0] op_sel_hi:[1,1,1]
    v_pk_fma_f32 v[190:191], v[188:189], v[224:225], v[12:13] op_sel:[0,0,0] op_sel_hi:[1,0,1]
    v_pk_fma_f32 v[206:207], v[204:205], v[224:225], v[16:17] op_sel:[0,0,0] op_sel_hi:[1,0,1]
    v_cvt_pk_bf16_f32 v46, v188, -v204
    v_cvt_pk_bf16_f32 v47, v189, -v205
    ds_write2st64_b32 v8, v46, v47 offset0:8 offset1:24
    v_pk_fma_f32 v[12:13], v[206:207], v[224:225], v[192:193] op_sel:[0,1,0] op_sel_hi:[1,1,1] neg_lo:[0,1,0] neg_hi:[0,1,0]
    v_pk_fma_f32 v[16:17], v[190:191], v[224:225], v[208:209] op_sel:[0,1,0] op_sel_hi:[1,1,1]
    v_pk_fma_f32 v[192:193], v[190:191], v[224:225], v[12:13] op_sel:[0,0,0] op_sel_hi:[1,0,1]
    v_pk_fma_f32 v[208:209], v[206:207], v[224:225], v[16:17] op_sel:[0,0,0] op_sel_hi:[1,0,1]
    v_cvt_pk_bf16_f32 v40, v190, -v206
    v_cvt_pk_bf16_f32 v41, v191, -v207
    ds_write2st64_b32 v9, v40, v41 offset0:9 offset1:25
    v_pk_fma_f32 v[12:13], v[208:209], v[224:225], v[194:195] op_sel:[0,1,0] op_sel_hi:[1,1,1] neg_lo:[0,1,0] neg_hi:[0,1,0]
    v_pk_fma_f32 v[16:17], v[192:193], v[224:225], v[210:211] op_sel:[0,1,0] op_sel_hi:[1,1,1]
    v_pk_fma_f32 v[194:195], v[192:193], v[224:225], v[12:13] op_sel:[0,0,0] op_sel_hi:[1,0,1]
    v_pk_fma_f32 v[210:211], v[208:209], v[224:225], v[16:17] op_sel:[0,0,0] op_sel_hi:[1,0,1]
    v_cvt_pk_bf16_f32 v46, v192, -v208
    v_cvt_pk_bf16_f32 v47, v193, -v209
    ds_write2st64_b32 v8, v46, v47 offset0:10 offset1:26
    v_pk_fma_f32 v[12:13], v[210:211], v[224:225], v[196:197] op_sel:[0,1,0] op_sel_hi:[1,1,1] neg_lo:[0,1,0] neg_hi:[0,1,0]
    v_pk_fma_f32 v[16:17], v[194:195], v[224:225], v[212:213] op_sel:[0,1,0] op_sel_hi:[1,1,1]
    v_pk_fma_f32 v[196:197], v[194:195], v[224:225], v[12:13] op_sel:[0,0,0] op_sel_hi:[1,0,1]
    v_pk_fma_f32 v[212:213], v[210:211], v[224:225], v[16:17] op_sel:[0,0,0] op_sel_hi:[1,0,1]
    v_cvt_pk_bf16_f32 v40, v194, -v210
    v_cvt_pk_bf16_f32 v41, v195, -v211
    ds_write2st64_b32 v9, v40, v41 offset0:11 offset1:27
    v_pk_fma_f32 v[12:13], v[212:213], v[224:225], v[198:199] op_sel:[0,1,0] op_sel_hi:[1,1,1] neg_lo:[0,1,0] neg_hi:[0,1,0]
    v_pk_fma_f32 v[16:17], v[196:197], v[224:225], v[214:215] op_sel:[0,1,0] op_sel_hi:[1,1,1]
    v_pk_fma_f32 v[198:199], v[196:197], v[224:225], v[12:13] op_sel:[0,0,0] op_sel_hi:[1,0,1]
    v_pk_fma_f32 v[214:215], v[212:213], v[224:225], v[16:17] op_sel:[0,0,0] op_sel_hi:[1,0,1]
    v_cvt_pk_bf16_f32 v46, v196, -v212
    v_cvt_pk_bf16_f32 v47, v197, -v213
    ds_write2st64_b32 v8, v46, v47 offset0:12 offset1:28
    v_pk_fma_f32 v[12:13], v[214:215], v[224:225], v[200:201] op_sel:[0,1,0] op_sel_hi:[1,1,1] neg_lo:[0,1,0] neg_hi:[0,1,0]
    v_pk_fma_f32 v[16:17], v[198:199], v[224:225], v[216:217] op_sel:[0,1,0] op_sel_hi:[1,1,1]
    v_pk_fma_f32 v[200:201], v[198:199], v[224:225], v[12:13] op_sel:[0,0,0] op_sel_hi:[1,0,1]
    v_pk_fma_f32 v[216:217], v[214:215], v[224:225], v[16:17] op_sel:[0,0,0] op_sel_hi:[1,0,1]
    v_cvt_pk_bf16_f32 v40, v198, -v214
    v_cvt_pk_bf16_f32 v41, v199, -v215
    ds_write2st64_b32 v9, v40, v41 offset0:13 offset1:29
    v_pk_fma_f32 v[12:13], v[216:217], v[224:225], v[202:203] op_sel:[0,1,0] op_sel_hi:[1,1,1] neg_lo:[0,1,0] neg_hi:[0,1,0]
    v_pk_fma_f32 v[16:17], v[200:201], v[224:225], v[218:219] op_sel:[0,1,0] op_sel_hi:[1,1,1]
    v_pk_fma_f32 v[202:203], v[200:201], v[224:225], v[12:13] op_sel:[0,0,0] op_sel_hi:[1,0,1]
    v_pk_fma_f32 v[218:219], v[216:217], v[224:225], v[16:17] op_sel:[0,0,0] op_sel_hi:[1,0,1]
    v_cvt_pk_bf16_f32 v46, v200, -v216
    v_cvt_pk_bf16_f32 v47, v201, -v217
    ds_write2st64_b32 v8, v46, v47 offset0:14 offset1:30
    v_cvt_pk_bf16_f32 v40, v202, -v218
    v_cvt_pk_bf16_f32 v41, v203, -v219
    ds_write2st64_b32 v9, v40, v41 offset0:15 offset1:31
    s_waitcnt lgkmcnt(0)
    s_barrier
    s_mov_b32 s20, s4
    s_mov_b32 s21, s5
    s_mov_b32 s22, 8388608
    s_mov_b32 s23, 131072
    v_lshrrev_b32 v6, 3, v1
    v_and_b32 v4, 7, v1
    v_lshlrev_b32 v5, 4, v4
    v_lshlrev_b32 v4, 5, v4
    v_lshl_add_u32 v4, v6, 8, v4
    v_lshl_add_u32 v5, v6, 12, v5
    v_and_b32 v6, 1, v6
    v_lshlrev_b32 v6, 4, v6
    v_xor_b32 v7, 16, v6
    v_add_u32 v7, v7, v4
    v_add_u32 v4, v4, v6
    s_lshl_b32 s3, s10, 13
    s_add_u32 s3, s3, 84992
    v_add_u32 v4, s3, v4
    v_add_u32 v7, s3, v7
    s_lshl_b32 s7, s11, 19
    s_lshl_b32 s3, s10, 17
    s_add_u32 s7, s7, s3
    s_lshl_b32 s3, s44, 7
    s_add_u32 s7, s7, s3
    s_mov_b32 s24, 0x05040100
    s_mov_b32 s25, 0x07060302
    ds_read_b128 v[40:43], v4 offset:0
    ds_read_b128 v[44:47], v7 offset:0
    ds_read_b128 v[48:51], v4 offset:2048
    ds_read_b128 v[52:55], v7 offset:2048
    ds_read_b128 v[56:59], v4 offset:4096
    ds_read_b128 v[60:63], v7 offset:4096
    ds_read_b128 v[64:67], v4 offset:6144
    ds_read_b128 v[68:71], v7 offset:6144
    s_waitcnt lgkmcnt(7)
    v_perm_b32 v72, v41, v40, s24
    v_perm_b32 v73, v43, v42, s24
    s_waitcnt lgkmcnt(6)
    v_perm_b32 v74, v45, v44, s24
    v_perm_b32 v75, v47, v46, s24
    v_perm_b32 v76, v41, v40, s25
    v_perm_b32 v77, v43, v42, s25
    v_perm_b32 v78, v45, v44, s25
    v_perm_b32 v79, v47, v46, s25
    buffer_store_dwordx4 v[72:75], v5, s[20:23], s7 offen sc0 sc1
    buffer_store_dwordx4 v[76:79], v5, s[20:23], s7 offen offset:2048 sc0 sc1
    s_waitcnt lgkmcnt(5)
    v_perm_b32 v80, v49, v48, s24
    v_perm_b32 v81, v51, v50, s24
    s_waitcnt lgkmcnt(4)
    v_perm_b32 v82, v53, v52, s24
    v_perm_b32 v83, v55, v54, s24
    v_perm_b32 v84, v49, v48, s25
    v_perm_b32 v85, v51, v50, s25
    v_perm_b32 v86, v53, v52, s25
    v_perm_b32 v87, v55, v54, s25
    s_add_u32 s7, s7, 32768
    buffer_store_dwordx4 v[80:83], v5, s[20:23], s7 offen sc0 sc1
    buffer_store_dwordx4 v[84:87], v5, s[20:23], s7 offen offset:2048 sc0 sc1
    s_waitcnt lgkmcnt(3)
    v_perm_b32 v72, v57, v56, s24
    v_perm_b32 v73, v59, v58, s24
    s_waitcnt lgkmcnt(2)
    v_perm_b32 v74, v61, v60, s24
    v_perm_b32 v75, v63, v62, s24
    v_perm_b32 v76, v57, v56, s25
    v_perm_b32 v77, v59, v58, s25
    v_perm_b32 v78, v61, v60, s25
    v_perm_b32 v79, v63, v62, s25
    s_add_u32 s7, s7, 32768
    buffer_store_dwordx4 v[72:75], v5, s[20:23], s7 offen sc0 sc1
    buffer_store_dwordx4 v[76:79], v5, s[20:23], s7 offen offset:2048 sc0 sc1
    s_waitcnt lgkmcnt(1)
    v_perm_b32 v80, v65, v64, s24
    v_perm_b32 v81, v67, v66, s24
    s_waitcnt lgkmcnt(0)
    v_perm_b32 v82, v69, v68, s24
    v_perm_b32 v83, v71, v70, s24
    v_perm_b32 v84, v65, v64, s25
    v_perm_b32 v85, v67, v66, s25
    v_perm_b32 v86, v69, v68, s25
    v_perm_b32 v87, v71, v70, s25
    s_add_u32 s7, s7, 32768
    buffer_store_dwordx4 v[80:83], v5, s[20:23], s7 offen sc0 sc1
    buffer_store_dwordx4 v[84:87], v5, s[20:23], s7 offen offset:2048 sc0 sc1
    ds_read_b64 v[14:15], v222 offset:192
    ds_read_b64 v[16:17], v222 offset:200
    ds_read_b128 v[40:43], v223 offset:3776
    ds_read_b64 v[44:45], v222 offset:704
    ds_read_b64 v[46:47], v222 offset:712
    ds_read_b128 v[48:51], v223 offset:3264
    ds_read_b64 v[52:53], v222 offset:1216
    ds_read_b64 v[54:55], v222 offset:1224
    ds_read_b128 v[56:59], v223 offset:2752
    s_waitcnt lgkmcnt(6)
    v_mfma_f32_16x16x32_bf16 v[18:21], v[14:17], v[40:43], v[18:21]
    s_lshl_b32 s7, s11, 4
    s_waitcnt lgkmcnt(4)
    v_mfma_f32_16x16x32_bf16 v[24:27], v[44:47], v[40:43], v[24:27]
    s_add_u32 s7, s7, s44
    s_waitcnt lgkmcnt(3)
    v_mfma_f32_16x16x32_bf16 v[24:27], v[14:17], v[48:51], v[24:27]
    ds_read_b64 v[60:61], v222 offset:1728
    ds_read_b64 v[62:63], v222 offset:1736
    v_mfma_f32_16x16x32_bf16 v[28:31], v[44:47], v[48:51], v[28:31]
    ds_read_b128 v[64:67], v223 offset:2240
    s_waitcnt lgkmcnt(4)
    v_mfma_f32_16x16x32_bf16 v[28:31], v[52:55], v[40:43], v[28:31]
    s_lshl_b32 s7, s7, 2
    s_waitcnt lgkmcnt(3)
    v_mfma_f32_16x16x32_bf16 v[28:31], v[14:17], v[56:59], v[28:31]
    s_add_u32 s7, s7, s10
    v_mfma_f32_16x16x32_bf16 v[32:35], v[52:55], v[48:51], v[32:35]
    s_lshl_b32 s7, s7, 3
    v_mfma_f32_16x16x32_bf16 v[32:35], v[44:47], v[56:59], v[32:35]
    s_add_u32 s7, s7, 16384
    v_mfma_f32_16x16x32_bf16 v[36:39], v[52:55], v[56:59], v[36:39]
    s_lshl_b32 s24, s46, 5
    s_waitcnt lgkmcnt(1)
    v_mfma_f32_16x16x32_bf16 v[32:35], v[60:63], v[40:43], v[32:35]
    ds_read_b64 v[68:69], v222 offset:2240
    ds_read_b64 v[70:71], v222 offset:2248
    s_waitcnt lgkmcnt(2)
    v_mfma_f32_16x16x32_bf16 v[32:35], v[14:17], v[64:67], v[32:35]
    ds_read_b128 v[72:75], v223 offset:1728
    v_mfma_f32_16x16x32_bf16 v[36:39], v[60:63], v[48:51], v[36:39]
    s_add_u32 s24, s24, s45
    v_mfma_f32_16x16x32_bf16 v[36:39], v[44:47], v[64:67], v[36:39]
    s_lshl_b32 s24, s24, 2
    v_mfma_f32_16x16x32_bf16 v[106:109], v[60:63], v[56:59], v[106:109]
    s_add_u32 s24, s24, s10
    v_mfma_f32_16x16x32_bf16 v[106:109], v[52:55], v[64:67], v[106:109]
    s_lshl_b32 s24, s24, 3
    v_mfma_f32_16x16x32_bf16 v[110:113], v[60:63], v[64:67], v[110:113]
    s_add_u32 s24, s24, 24576
    s_waitcnt lgkmcnt(1)
    v_mfma_f32_16x16x32_bf16 v[36:39], v[68:71], v[40:43], v[36:39]
    s_lshr_b32 s3, s45, 1
    s_waitcnt lgkmcnt(0)
    v_mfma_f32_16x16x32_bf16 v[36:39], v[14:17], v[72:75], v[36:39]
    ds_read_b64 v[76:77], v222 offset:2752
    ds_read_b64 v[78:79], v222 offset:2760
    v_mfma_f32_16x16x32_bf16 v[106:109], v[68:71], v[48:51], v[106:109]
    ds_read_b128 v[80:83], v223 offset:1216
    v_mfma_f32_16x16x32_bf16 v[106:109], v[44:47], v[72:75], v[106:109]
    s_lshl_b32 s3, s3, 9
    v_mfma_f32_16x16x32_bf16 v[110:113], v[68:71], v[56:59], v[110:113]
    s_add_u32 s3, s3, 16384
    v_mfma_f32_16x16x32_bf16 v[110:113], v[52:55], v[72:75], v[110:113]
    v_lshrrev_b32 v4, 1, v2
    v_mfma_f32_16x16x32_bf16 v[114:117], v[68:71], v[64:67], v[114:117]
    v_add_u32 v4, s3, v4
    v_mfma_f32_16x16x32_bf16 v[114:117], v[60:63], v[72:75], v[114:117]
    ds_read_b64 v[84:85], v222 offset:3264
    ds_read_b64 v[86:87], v222 offset:3272
    s_waitcnt lgkmcnt(3)
    v_mfma_f32_16x16x32_bf16 v[106:109], v[76:79], v[40:43], v[106:109]
    ds_read_b128 v[88:91], v223 offset:704
    s_waitcnt lgkmcnt(3)
    v_mfma_f32_16x16x32_bf16 v[106:109], v[14:17], v[80:83], v[106:109]
    v_and_b32 v8, 7, v1
    v_mfma_f32_16x16x32_bf16 v[110:113], v[76:79], v[48:51], v[110:113]
    v_lshrrev_b32 v7, 3, v1
    v_mfma_f32_16x16x32_bf16 v[110:113], v[44:47], v[80:83], v[110:113]
    ds_read_b64 v[68:69], v222 offset:3776
    ds_read_b64 v[70:71], v222 offset:3784
    v_mfma_f32_16x16x32_bf16 v[114:117], v[76:79], v[56:59], v[114:117]
    ds_read_b128 v[64:67], v223 offset:192
    v_mfma_f32_16x16x32_bf16 v[114:117], v[52:55], v[80:83], v[114:117]
    ds_read_b64 v[60:61], v222 offset:128
    ds_read_b64 v[62:63], v222 offset:136
    s_waitcnt lgkmcnt(6)
    v_mfma_f32_16x16x32_bf16 v[110:113], v[84:87], v[40:43], v[110:113]
    ds_read_b128 v[72:75], v223 offset:3712
    s_waitcnt lgkmcnt(6)
    v_mfma_f32_16x16x32_bf16 v[110:113], v[14:17], v[88:91], v[110:113]
    ds_read_b64 v[76:77], v222 offset:640
    ds_read_b64 v[78:79], v222 offset:648
    v_mfma_f32_16x16x32_bf16 v[114:117], v[84:87], v[48:51], v[114:117]
    ds_read_b128 v[56:59], v223 offset:3200
    v_mfma_f32_16x16x32_bf16 v[114:117], v[44:47], v[88:91], v[114:117]
    ds_read_b64 v[52:53], v222 offset:1152
    ds_read_b64 v[54:55], v222 offset:1160
    s_waitcnt lgkmcnt(9)
    v_mfma_f32_16x16x32_bf16 v[114:117], v[68:71], v[40:43], v[114:117]
    ds_read_b128 v[80:83], v223 offset:2688
    s_waitcnt lgkmcnt(9)
    v_mfma_f32_16x16x32_bf16 v[114:117], v[14:17], v[64:67], v[114:117]
    s_lshl_b32 s3, s10, 4
    s_waitcnt lgkmcnt(6)
    v_mfma_f32_16x16x32_bf16 v[18:21], v[60:63], v[72:75], v[18:21]
    s_add_u32 s3, s3, 0
    s_waitcnt lgkmcnt(4)
    v_mfma_f32_16x16x32_bf16 v[24:27], v[76:79], v[72:75], v[24:27]
    v_add_u32 v7, s3, v7
    s_waitcnt lgkmcnt(3)
    v_mfma_f32_16x16x32_bf16 v[24:27], v[60:63], v[56:59], v[24:27]
    ds_read_b64 v[84:85], v222 offset:1664
    ds_read_b64 v[86:87], v222 offset:1672
    v_mfma_f32_16x16x32_bf16 v[28:31], v[76:79], v[56:59], v[28:31]
    ds_read_b128 v[48:51], v223 offset:2176
    s_waitcnt lgkmcnt(4)
    v_mfma_f32_16x16x32_bf16 v[28:31], v[52:55], v[72:75], v[28:31]
    v_bfe_u32 v9, v7, 1, 3
    s_waitcnt lgkmcnt(3)
    v_mfma_f32_16x16x32_bf16 v[28:31], v[60:63], v[80:83], v[28:31]
    v_xor_b32 v9, v9, v8
    v_mfma_f32_16x16x32_bf16 v[32:35], v[52:55], v[56:59], v[32:35]
    v_lshlrev_b32 v9, 4, v9
    v_mfma_f32_16x16x32_bf16 v[32:35], v[76:79], v[80:83], v[32:35]
    s_lshr_b32 s3, s45, 1
    v_mfma_f32_16x16x32_bf16 v[36:39], v[52:55], v[80:83], v[36:39]
    s_lshl_b32 s3, s3, 7
    s_waitcnt lgkmcnt(1)
    v_mfma_f32_16x16x32_bf16 v[32:35], v[84:87], v[72:75], v[32:35]
    ds_read_b64 v[44:45], v222 offset:2176
    ds_read_b64 v[46:47], v222 offset:2184
    s_waitcnt lgkmcnt(2)
    v_mfma_f32_16x16x32_bf16 v[32:35], v[60:63], v[48:51], v[32:35]
    ds_read_b128 v[88:91], v223 offset:1664
    v_mfma_f32_16x16x32_bf16 v[36:39], v[84:87], v[56:59], v[36:39]
    v_add_u32 v7, s3, v7
    v_mfma_f32_16x16x32_bf16 v[36:39], v[76:79], v[48:51], v[36:39]
    v_lshl_add_u32 v5, v7, 12, v9
    v_mfma_f32_16x16x32_bf16 v[106:109], v[84:87], v[80:83], v[106:109]
    v_lshrrev_b32 v7, 3, v1
    v_mfma_f32_16x16x32_bf16 v[106:109], v[52:55], v[48:51], v[106:109]
    s_lshl_b32 s3, s10, 4
    v_mfma_f32_16x16x32_bf16 v[110:113], v[84:87], v[48:51], v[110:113]
    s_add_u32 s3, s3, 8
    s_waitcnt lgkmcnt(1)
    v_mfma_f32_16x16x32_bf16 v[36:39], v[44:47], v[72:75], v[36:39]
    v_add_u32 v7, s3, v7
    s_waitcnt lgkmcnt(0)
    v_mfma_f32_16x16x32_bf16 v[36:39], v[60:63], v[88:91], v[36:39]
    ds_read_b64 v[68:69], v222 offset:2688
    ds_read_b64 v[70:71], v222 offset:2696
    v_mfma_f32_16x16x32_bf16 v[106:109], v[44:47], v[56:59], v[106:109]
    ds_read_b128 v[40:43], v223 offset:1152
    v_mfma_f32_16x16x32_bf16 v[106:109], v[76:79], v[88:91], v[106:109]
    v_bfe_u32 v9, v7, 1, 3
    v_mfma_f32_16x16x32_bf16 v[110:113], v[44:47], v[80:83], v[110:113]
    v_xor_b32 v9, v9, v8
    v_mfma_f32_16x16x32_bf16 v[110:113], v[52:55], v[88:91], v[110:113]
    v_lshlrev_b32 v9, 4, v9
    v_mfma_f32_16x16x32_bf16 v[114:117], v[44:47], v[48:51], v[114:117]
    s_lshr_b32 s3, s45, 1
    v_mfma_f32_16x16x32_bf16 v[114:117], v[84:87], v[88:91], v[114:117]
    ds_read_b64 v[14:15], v222 offset:3200
    ds_read_b64 v[16:17], v222 offset:3208
    s_waitcnt lgkmcnt(3)
    v_mfma_f32_16x16x32_bf16 v[106:109], v[68:71], v[72:75], v[106:109]
    ds_read_b128 v[64:67], v223 offset:640
    s_waitcnt lgkmcnt(3)
    v_mfma_f32_16x16x32_bf16 v[106:109], v[60:63], v[40:43], v[106:109]
    s_lshl_b32 s3, s3, 7
    v_mfma_f32_16x16x32_bf16 v[110:113], v[68:71], v[56:59], v[110:113]
    v_add_u32 v7, s3, v7
    v_mfma_f32_16x16x32_bf16 v[110:113], v[76:79], v[40:43], v[110:113]
    ds_read_b64 v[44:45], v222 offset:3712
    ds_read_b64 v[46:47], v222 offset:3720
    v_mfma_f32_16x16x32_bf16 v[114:117], v[68:71], v[80:83], v[114:117]
    ds_read_b128 v[48:51], v223 offset:128
    v_mfma_f32_16x16x32_bf16 v[114:117], v[52:55], v[40:43], v[114:117]
    ds_read_b64 v[84:85], v222 offset:64
    ds_read_b64 v[86:87], v222 offset:72
    s_waitcnt lgkmcnt(6)
    v_mfma_f32_16x16x32_bf16 v[110:113], v[14:17], v[72:75], v[110:113]
    ds_read_b128 v[88:91], v223 offset:3648
    s_waitcnt lgkmcnt(6)
    v_mfma_f32_16x16x32_bf16 v[110:113], v[60:63], v[64:67], v[110:113]
    ds_read_b64 v[68:69], v222 offset:576
    ds_read_b64 v[70:71], v222 offset:584
    v_mfma_f32_16x16x32_bf16 v[114:117], v[14:17], v[56:59], v[114:117]
    ds_read_b128 v[80:83], v223 offset:3136
    v_mfma_f32_16x16x32_bf16 v[114:117], v[76:79], v[64:67], v[114:117]
    ds_read_b64 v[52:53], v222 offset:1088
    ds_read_b64 v[54:55], v222 offset:1096
    s_waitcnt lgkmcnt(9)
    v_mfma_f32_16x16x32_bf16 v[114:117], v[44:47], v[72:75], v[114:117]
    ds_read_b128 v[40:43], v223 offset:2624
    s_waitcnt lgkmcnt(9)
    v_mfma_f32_16x16x32_bf16 v[114:117], v[60:63], v[48:51], v[114:117]
    v_lshl_add_u32 v6, v7, 12, v9
    s_waitcnt lgkmcnt(6)
    v_mfma_f32_16x16x32_bf16 v[18:21], v[84:87], v[88:91], v[18:21]
    s_and_b32 s30, s45, 1
    s_waitcnt lgkmcnt(4)
    v_mfma_f32_16x16x32_bf16 v[24:27], v[68:71], v[88:91], v[24:27]
    s_lshl_b32 s3, s30, 11
    s_waitcnt lgkmcnt(3)
    v_mfma_f32_16x16x32_bf16 v[24:27], v[84:87], v[80:83], v[24:27]
    ds_read_b64 v[14:15], v222 offset:1600
    ds_read_b64 v[16:17], v222 offset:1608
    v_mfma_f32_16x16x32_bf16 v[28:31], v[68:71], v[80:83], v[28:31]
    ds_read_b128 v[56:59], v223 offset:2112
    s_waitcnt lgkmcnt(4)
    v_mfma_f32_16x16x32_bf16 v[28:31], v[52:55], v[88:91], v[28:31]
    s_lshl_b32 s29, s30, 18
    s_waitcnt lgkmcnt(3)
    v_mfma_f32_16x16x32_bf16 v[28:31], v[84:87], v[40:43], v[28:31]
    s_xor_b32 s28, s29, 262144
    v_mfma_f32_16x16x32_bf16 v[32:35], v[52:55], v[80:83], v[32:35]
    s_add_u32 s28, s28, s3
    v_mfma_f32_16x16x32_bf16 v[32:35], v[68:71], v[40:43], v[32:35]
    s_add_u32 s29, s29, s3
    v_mfma_f32_16x16x32_bf16 v[36:39], v[52:55], v[40:43], v[36:39]
    s_lshl_b32 s27, s10, 11
    s_waitcnt lgkmcnt(1)
    v_mfma_f32_16x16x32_bf16 v[32:35], v[14:17], v[88:91], v[32:35]
    ds_read_b64 v[76:77], v222 offset:2112
    ds_read_b64 v[78:79], v222 offset:2120
    s_waitcnt lgkmcnt(2)
    v_mfma_f32_16x16x32_bf16 v[32:35], v[84:87], v[56:59], v[32:35]
    ds_read_b128 v[64:67], v223 offset:1600
    v_mfma_f32_16x16x32_bf16 v[36:39], v[14:17], v[80:83], v[36:39]
    s_add_u32 s27, s27, 98304
    v_mfma_f32_16x16x32_bf16 v[36:39], v[68:71], v[56:59], v[36:39]
    v_and_b32 v7, 31, v1
    v_mfma_f32_16x16x32_bf16 v[106:109], v[14:17], v[40:43], v[106:109]
    v_bfe_u32 v8, v7, 1, 3
    v_mfma_f32_16x16x32_bf16 v[106:109], v[52:55], v[56:59], v[106:109]
    v_lshrrev_b32 v9, 5, v1
    v_mfma_f32_16x16x32_bf16 v[110:113], v[14:17], v[56:59], v[110:113]
    v_xor_b32 v8, v8, v9
    s_waitcnt lgkmcnt(1)
    v_mfma_f32_16x16x32_bf16 v[36:39], v[76:79], v[88:91], v[36:39]
    v_lshlrev_b32 v8, 4, v8
    s_waitcnt lgkmcnt(0)
    v_mfma_f32_16x16x32_bf16 v[36:39], v[84:87], v[64:67], v[36:39]
    ds_read_b64 v[44:45], v222 offset:2624
    ds_read_b64 v[46:47], v222 offset:2632
    v_mfma_f32_16x16x32_bf16 v[106:109], v[76:79], v[80:83], v[106:109]
    ds_read_b128 v[72:75], v223 offset:1088
    v_mfma_f32_16x16x32_bf16 v[106:109], v[68:71], v[64:67], v[106:109]
    v_lshl_add_u32 v8, v7, 7, v8
    v_mfma_f32_16x16x32_bf16 v[110:113], v[76:79], v[40:43], v[110:113]
    v_xor_b32 v10, 0, v8
    v_mfma_f32_16x16x32_bf16 v[110:113], v[52:55], v[64:67], v[110:113]
    v_add_u32 v10, 98304, v10
    v_mfma_f32_16x16x32_bf16 v[114:117], v[76:79], v[56:59], v[114:117]
    v_xor_b32 v11, 32, v8
    v_mfma_f32_16x16x32_bf16 v[114:117], v[14:17], v[64:67], v[114:117]
    ds_read_b64 v[60:61], v222 offset:3136
    ds_read_b64 v[62:63], v222 offset:3144
    s_waitcnt lgkmcnt(3)
    v_mfma_f32_16x16x32_bf16 v[106:109], v[44:47], v[88:91], v[106:109]
    ds_read_b128 v[48:51], v223 offset:576
    s_waitcnt lgkmcnt(3)
    v_mfma_f32_16x16x32_bf16 v[106:109], v[84:87], v[72:75], v[106:109]
    v_add_u32 v11, 98304, v11
    v_mfma_f32_16x16x32_bf16 v[110:113], v[44:47], v[80:83], v[110:113]
    v_xor_b32 v12, 64, v8
    v_mfma_f32_16x16x32_bf16 v[110:113], v[68:71], v[72:75], v[110:113]
    ds_read_b64 v[76:77], v222 offset:3648
    ds_read_b64 v[78:79], v222 offset:3656
    v_mfma_f32_16x16x32_bf16 v[114:117], v[44:47], v[40:43], v[114:117]
    ds_read_b128 v[56:59], v223 offset:64
    v_mfma_f32_16x16x32_bf16 v[114:117], v[52:55], v[72:75], v[114:117]
    ds_read_b64 v[14:15], v222 offset:0
    ds_read_b64 v[16:17], v222 offset:8
    s_waitcnt lgkmcnt(6)
    v_mfma_f32_16x16x32_bf16 v[110:113], v[60:63], v[88:91], v[110:113]
    ds_read_b128 v[64:67], v223 offset:3584
    s_waitcnt lgkmcnt(6)
    v_mfma_f32_16x16x32_bf16 v[110:113], v[84:87], v[48:51], v[110:113]
    ds_read_b64 v[44:45], v222 offset:512
    ds_read_b64 v[46:47], v222 offset:520
    v_mfma_f32_16x16x32_bf16 v[114:117], v[60:63], v[80:83], v[114:117]
    ds_read_b128 v[40:43], v223 offset:3072
    v_mfma_f32_16x16x32_bf16 v[114:117], v[68:71], v[48:51], v[114:117]
    ds_read_b64 v[52:53], v222 offset:1024
    ds_read_b64 v[54:55], v222 offset:1032
    s_waitcnt lgkmcnt(9)
    v_mfma_f32_16x16x32_bf16 v[114:117], v[76:79], v[88:91], v[114:117]
    ds_read_b128 v[72:75], v223 offset:2560
    s_waitcnt lgkmcnt(9)
    v_mfma_f32_16x16x32_bf16 v[114:117], v[84:87], v[56:59], v[114:117]
    v_add_u32 v12, 98304, v12
    s_waitcnt lgkmcnt(6)
    v_mfma_f32_16x16x32_bf16 v[18:21], v[14:17], v[64:67], v[18:21]
    v_xor_b32 v13, 96, v8
    s_waitcnt lgkmcnt(4)
    v_mfma_f32_16x16x32_bf16 v[24:27], v[44:47], v[64:67], v[24:27]
    v_add_u32 v13, 98304, v13
    s_waitcnt lgkmcnt(3)
    v_mfma_f32_16x16x32_bf16 v[24:27], v[14:17], v[40:43], v[24:27]
    ds_read_b64 v[60:61], v222 offset:1536
    ds_read_b64 v[62:63], v222 offset:1544
    v_mfma_f32_16x16x32_bf16 v[28:31], v[44:47], v[40:43], v[28:31]
    ds_read_b128 v[80:83], v223 offset:2048
    s_waitcnt lgkmcnt(4)
    v_mfma_f32_16x16x32_bf16 v[28:31], v[52:55], v[64:67], v[28:31]
    s_mov_b32 s6, 24576
    s_waitcnt lgkmcnt(3)
    v_mfma_f32_16x16x32_bf16 v[28:31], v[14:17], v[72:75], v[28:31]
    buffer_load_dwordx4 a[96:99], v2, s[12:15], s6 offen offset:0 sc0 sc1
    v_mfma_f32_16x16x32_bf16 v[32:35], v[52:55], v[40:43], v[32:35]
    buffer_load_dwordx4 a[100:103], v2, s[12:15], s6 offen offset:1024 sc0 sc1
    v_mfma_f32_16x16x32_bf16 v[32:35], v[44:47], v[72:75], v[32:35]
    buffer_load_dwordx4 a[104:107], v2, s[12:15], s6 offen offset:2048 sc0 sc1
    v_mfma_f32_16x16x32_bf16 v[36:39], v[52:55], v[72:75], v[36:39]
    buffer_load_dwordx4 a[108:111], v2, s[12:15], s6 offen offset:3072 sc0 sc1
    s_waitcnt lgkmcnt(1)
    v_mfma_f32_16x16x32_bf16 v[32:35], v[60:63], v[64:67], v[32:35]
    ds_read_b64 v[68:69], v222 offset:2048
    ds_read_b64 v[70:71], v222 offset:2056
    s_waitcnt lgkmcnt(2)
    v_mfma_f32_16x16x32_bf16 v[32:35], v[14:17], v[80:83], v[32:35]
    ds_read_b128 v[48:51], v223 offset:1536
    v_mfma_f32_16x16x32_bf16 v[36:39], v[60:63], v[40:43], v[36:39]
    s_mov_b32 s6, 28672
    v_mfma_f32_16x16x32_bf16 v[36:39], v[44:47], v[80:83], v[36:39]
    buffer_load_dwordx4 a[112:115], v2, s[12:15], s6 offen offset:0 sc0 sc1
    v_mfma_f32_16x16x32_bf16 v[106:109], v[60:63], v[72:75], v[106:109]
    buffer_load_dwordx4 a[116:119], v2, s[12:15], s6 offen offset:1024 sc0 sc1
    v_mfma_f32_16x16x32_bf16 v[106:109], v[52:55], v[80:83], v[106:109]
    buffer_load_dwordx4 a[120:123], v2, s[12:15], s6 offen offset:2048 sc0 sc1
    v_mfma_f32_16x16x32_bf16 v[110:113], v[60:63], v[80:83], v[110:113]
    buffer_load_dwordx4 a[124:127], v2, s[12:15], s6 offen offset:3072 sc0 sc1
    s_waitcnt lgkmcnt(1)
    v_mfma_f32_16x16x32_bf16 v[36:39], v[68:71], v[64:67], v[36:39]
    s_mov_b32 s6, 32768
    s_waitcnt lgkmcnt(0)
    v_mfma_f32_16x16x32_bf16 v[36:39], v[14:17], v[48:51], v[36:39]
    ds_read_b64 v[76:77], v222 offset:2560
    ds_read_b64 v[78:79], v222 offset:2568
    v_mfma_f32_16x16x32_bf16 v[106:109], v[68:71], v[40:43], v[106:109]
    ds_read_b128 v[88:91], v223 offset:1024
    v_mfma_f32_16x16x32_bf16 v[106:109], v[44:47], v[48:51], v[106:109]
    buffer_load_dwordx4 a[128:131], v2, s[12:15], s6 offen offset:0 sc0 sc1
    v_mfma_f32_16x16x32_bf16 v[110:113], v[68:71], v[72:75], v[110:113]
    buffer_load_dwordx4 a[132:135], v2, s[12:15], s6 offen offset:1024 sc0 sc1
    v_mfma_f32_16x16x32_bf16 v[110:113], v[52:55], v[48:51], v[110:113]
    s_waitcnt vmcnt(10)
    v_mfma_f32_16x16x32_bf16 v[114:117], v[68:71], v[80:83], v[114:117]
    v_mov_b32 v220, s8
    v_mov_b32 v221, s9
    s_mov_b64 s[32:33], exec
    s_mov_b64 exec, 1
    buffer_store_dwordx2 v[220:221], v3, s[72:75], s7 offen sc0 sc1
    s_mov_b64 exec, s[32:33]
    v_mfma_f32_16x16x32_bf16 v[114:117], v[60:63], v[48:51], v[114:117]
    ds_read_b64 v[84:85], v222 offset:3072
    ds_read_b64 v[86:87], v222 offset:3080
    s_waitcnt lgkmcnt(3)
    v_mfma_f32_16x16x32_bf16 v[106:109], v[76:79], v[64:67], v[106:109]
    ds_read_b128 v[56:59], v223 offset:512
    s_waitcnt lgkmcnt(3)
    v_mfma_f32_16x16x32_bf16 v[106:109], v[14:17], v[88:91], v[106:109]
    buffer_load_dwordx4 a[136:139], v2, s[12:15], s6 offen offset:2048 sc0 sc1
    v_mfma_f32_16x16x32_bf16 v[110:113], v[76:79], v[40:43], v[110:113]
    buffer_load_dwordx4 a[140:143], v2, s[12:15], s6 offen offset:3072 sc0 sc1
    v_mfma_f32_16x16x32_bf16 v[110:113], v[44:47], v[88:91], v[110:113]
    ds_read_b64 v[68:69], v222 offset:3584
    ds_read_b64 v[70:71], v222 offset:3592
    v_mfma_f32_16x16x32_bf16 v[114:117], v[76:79], v[72:75], v[114:117]
    ds_read_b128 v[80:83], v223 offset:0
    v_mfma_f32_16x16x32_bf16 v[114:117], v[52:55], v[88:91], v[114:117]
    s_mov_b32 s6, 36864
    s_waitcnt lgkmcnt(4)
    v_mfma_f32_16x16x32_bf16 v[110:113], v[84:87], v[64:67], v[110:113]
    buffer_load_dwordx4 a[144:147], v2, s[12:15], s6 offen offset:0 sc0 sc1
    s_waitcnt lgkmcnt(3)
    v_mfma_f32_16x16x32_bf16 v[110:113], v[14:17], v[56:59], v[110:113]
    buffer_load_dwordx4 a[148:151], v2, s[12:15], s6 offen offset:1024 sc0 sc1
    v_mfma_f32_16x16x32_bf16 v[114:117], v[84:87], v[40:43], v[114:117]
    buffer_load_dwordx4 a[152:155], v2, s[12:15], s6 offen offset:2048 sc0 sc1
    v_mfma_f32_16x16x32_bf16 v[114:117], v[44:47], v[56:59], v[114:117]
    buffer_load_dwordx4 a[156:159], v2, s[12:15], s6 offen offset:3072 sc0 sc1
    s_waitcnt lgkmcnt(1)
    v_mfma_f32_16x16x32_bf16 v[114:117], v[68:71], v[64:67], v[114:117]
    s_mov_b32 s6, 40960
    s_waitcnt lgkmcnt(0)
    v_mfma_f32_16x16x32_bf16 v[114:117], v[14:17], v[80:83], v[114:117]
    buffer_load_dwordx4 a[160:163], v2, s[12:15], s6 offen offset:0 sc0 sc1
    buffer_load_dwordx4 a[164:167], v2, s[12:15], s6 offen offset:1024 sc0 sc1
    buffer_load_dwordx4 a[168:171], v2, s[12:15], s6 offen offset:2048 sc0 sc1
    buffer_load_dwordx4 a[172:175], v2, s[12:15], s6 offen offset:3072 sc0 sc1
    s_mov_b32 s6, 45056
    buffer_load_dwordx4 a[176:179], v2, s[12:15], s6 offen offset:0 sc0 sc1
    buffer_load_dwordx4 a[180:183], v2, s[12:15], s6 offen offset:1024 sc0 sc1
    buffer_load_dwordx4 a[184:187], v2, s[12:15], s6 offen offset:2048 sc0 sc1
    buffer_load_dwordx4 a[188:191], v2, s[12:15], s6 offen offset:3072 sc0 sc1
    buffer_load_dwordx2 v[220:221], v4, s[72:75], 0 offen sc0 sc1
    s_mov_b32 s32, 0
    s_waitcnt vmcnt(0)
    v_cmp_ne_u64 vcc, s[8:9], v[220:221]
    s_nop 4
    s_cbranch_vccz Lfdone_gate_9
Lfpoll_gate_10:
    buffer_load_dwordx2 v[220:221], v4, s[72:75], 0 offen sc0 sc1
    s_waitcnt vmcnt(0)
    v_cmp_ne_u64 vcc, s[8:9], v[220:221]
    s_nop 4
    s_add_u32 s32, s32, 1
    s_cmp_gt_u32 s32, 20000
    s_cbranch_scc1 Lfdone_gate_9
    s_cbranch_vccnz Lfpoll_gate_10
Lfdone_gate_9:
    s_add_u32 s25, s28, 0
    s_add_u32 m0, s27, 32768
    s_nop 0
    buffer_load_dwordx4 v5, s[20:23], s25 offen offset:0 sc0 sc1 lds
    s_add_u32 m0, s27, 33792
    s_nop 0
    buffer_load_dwordx4 v6, s[20:23], s25 offen offset:0 sc0 sc1 lds
    s_add_u32 m0, s27, 40832
    s_nop 0
    buffer_load_dwordx4 v5, s[20:23], s25 offen offset:128 sc0 sc1 lds
    s_add_u32 m0, s27, 41856
    s_nop 0
    buffer_load_dwordx4 v6, s[20:23], s25 offen offset:128 sc0 sc1 lds
    s_add_u32 s25, s28, 256
    s_add_u32 m0, s27, 49152
    s_nop 0
    buffer_load_dwordx4 v5, s[20:23], s25 offen offset:0 sc0 sc1 lds
    s_add_u32 m0, s27, 50176
    s_nop 0
    buffer_load_dwordx4 v6, s[20:23], s25 offen offset:0 sc0 sc1 lds
    s_add_u32 m0, s27, 57216
    s_nop 0
    buffer_load_dwordx4 v5, s[20:23], s25 offen offset:128 sc0 sc1 lds
    s_add_u32 m0, s27, 58240
    s_nop 0
    buffer_load_dwordx4 v6, s[20:23], s25 offen offset:128 sc0 sc1 lds
    s_add_u32 s32, s4, 12582912
    s_addc_u32 s33, s5, 0
    s_mov_b32 s34, 4194304
    s_mov_b32 s35, 131072
    ds_read_b64 v[8:9], v236 offset:3584
    ds_read_b64 v[14:15], v236 offset:3072
    ds_read_b64 v[16:17], v236 offset:2560
    ds_read_b64 v[40:41], v236 offset:2048
    ds_read_b64 v[42:43], v236 offset:1536
    ds_read_b64 v[44:45], v236 offset:1024
    ds_read_b64 v[46:47], v236 offset:512
    ds_read_b64 v[48:49], v236 offset:0
    s_mov_b32 s7, s65
    s_waitcnt lgkmcnt(7)
    v_and_b32 v50, s47, v9
    v_lshlrev_b32 v51, 16, v9
    v_and_b32 v52, s47, v8
    v_lshlrev_b32 v53, 16, v8
    v_fmac_f32 v18, v23, v50
    v_fmac_f32 v19, v23, v51
    v_fmac_f32 v20, v23, v52
    v_fmac_f32 v21, v23, v53
    v_cvt_pk_bf16_f32 v54, v18, v19
    v_cvt_pk_bf16_f32 v55, v20, v21
    s_waitcnt lgkmcnt(6)
    v_and_b32 v50, s47, v15
    v_lshlrev_b32 v51, 16, v15
    v_and_b32 v52, s47, v14
    v_lshlrev_b32 v53, 16, v14
    v_fmac_f32 v24, v23, v50
    v_fmac_f32 v25, v23, v51
    v_fmac_f32 v26, v23, v52
    v_fmac_f32 v27, v23, v53
    v_cvt_pk_bf16_f32 v56, v24, v25
    v_cvt_pk_bf16_f32 v57, v26, v27
    s_nop 0
    v_permlane16_swap_b32 v54, v56
    v_permlane16_swap_b32 v55, v57
    buffer_store_dwordx4 v[54:57], v237, s[32:35], s7 offen offset:0 sc0 sc1
    s_waitcnt lgkmcnt(5)
    v_and_b32 v50, s47, v17
    v_lshlrev_b32 v51, 16, v17
    v_and_b32 v52, s47, v16
    v_lshlrev_b32 v53, 16, v16
    v_fmac_f32 v28, v23, v50
    v_fmac_f32 v29, v23, v51
    v_fmac_f32 v30, v23, v52
    v_fmac_f32 v31, v23, v53
    v_cvt_pk_bf16_f32 v58, v28, v29
    v_cvt_pk_bf16_f32 v59, v30, v31
    s_waitcnt lgkmcnt(4)
    v_and_b32 v50, s47, v41
    v_lshlrev_b32 v51, 16, v41
    v_and_b32 v52, s47, v40
    v_lshlrev_b32 v53, 16, v40
    v_fmac_f32 v32, v23, v50
    v_fmac_f32 v33, v23, v51
    v_fmac_f32 v34, v23, v52
    v_fmac_f32 v35, v23, v53
    v_cvt_pk_bf16_f32 v60, v32, v33
    v_cvt_pk_bf16_f32 v61, v34, v35
    s_nop 0
    v_permlane16_swap_b32 v58, v60
    v_permlane16_swap_b32 v59, v61
    buffer_store_dwordx4 v[58:61], v237, s[32:35], s7 offen offset:1024 sc0 sc1
    s_waitcnt lgkmcnt(3)
    v_and_b32 v50, s47, v43
    v_lshlrev_b32 v51, 16, v43
    v_and_b32 v52, s47, v42
    v_lshlrev_b32 v53, 16, v42
    v_fmac_f32 v36, v23, v50
    v_fmac_f32 v37, v23, v51
    v_fmac_f32 v38, v23, v52
    v_fmac_f32 v39, v23, v53
    v_cvt_pk_bf16_f32 v54, v36, v37
    v_cvt_pk_bf16_f32 v55, v38, v39
    s_waitcnt lgkmcnt(2)
    v_and_b32 v50, s47, v45
    v_lshlrev_b32 v51, 16, v45
    v_and_b32 v52, s47, v44
    v_lshlrev_b32 v53, 16, v44
    v_fmac_f32 v106, v23, v50
    v_fmac_f32 v107, v23, v51
    v_fmac_f32 v108, v23, v52
    v_fmac_f32 v109, v23, v53
    v_cvt_pk_bf16_f32 v56, v106, v107
    v_cvt_pk_bf16_f32 v57, v108, v109
    s_nop 0
    v_permlane16_swap_b32 v54, v56
    v_permlane16_swap_b32 v55, v57
    buffer_store_dwordx4 v[54:57], v237, s[32:35], s7 offen offset:2048 sc0 sc1
    s_waitcnt lgkmcnt(1)
    v_and_b32 v50, s47, v47
    v_lshlrev_b32 v51, 16, v47
    v_and_b32 v52, s47, v46
    v_lshlrev_b32 v53, 16, v46
    v_fmac_f32 v110, v23, v50
    v_fmac_f32 v111, v23, v51
    v_fmac_f32 v112, v23, v52
    v_fmac_f32 v113, v23, v53
    v_cvt_pk_bf16_f32 v58, v110, v111
    v_cvt_pk_bf16_f32 v59, v112, v113
    s_waitcnt lgkmcnt(0)
    v_and_b32 v50, s47, v49
    v_lshlrev_b32 v51, 16, v49
    v_and_b32 v52, s47, v48
    v_lshlrev_b32 v53, 16, v48
    v_fmac_f32 v114, v23, v50
    v_fmac_f32 v115, v23, v51
    v_fmac_f32 v116, v23, v52
    v_fmac_f32 v117, v23, v53
    v_cvt_pk_bf16_f32 v60, v114, v115
    v_cvt_pk_bf16_f32 v61, v116, v117
    s_nop 0
    v_permlane16_swap_b32 v58, v60
    v_permlane16_swap_b32 v59, v61
    buffer_store_dwordx4 v[58:61], v237, s[32:35], s7 offen offset:3072 sc0 sc1
    s_load_dwordx2 s[16:17], s[0:1], 0
    s_mov_b32 s18, 4194304
    s_mov_b32 s19, 131072
    s_load_dwordx2 s[36:37], s[0:1], 64
    s_mov_b32 s38, 2048
    s_mov_b32 s39, 131072
    s_load_dwordx2 s[40:41], s[0:1], 128
    s_mov_b32 s42, 8388608
    s_mov_b32 s43, 131072
    s_add_u32 s48, s4, 25165824
    s_addc_u32 s49, s5, 0
    s_mov_b32 s50, 8388608
    s_mov_b32 s51, 131072
    s_lshl_b32 s3, s46, 2
    s_add_u32 s3, s3, s10
    s_lshl_b32 s26, s45, 5
    s_add_u32 s26, s26, s3
    s_xor_b32 s7, s26, 32
    s_lshl_b32 s31, s26, 3
    s_add_u32 s31, s31, 32768
    s_lshl_b32 s30, s7, 3
    s_add_u32 s30, s30, 32768
    s_lshl_b32 s26, s26, 13
    s_lshl_b32 s7, s7, 13
    v_mov_b32 v4, 0
    v_lshrrev_b32 v7, 4, v1
    v_and_b32 v14, 15, v1
    v_lshlrev_b32 v15, 2, v7
    v_xor_b32 v14, v14, v15
    v_lshlrev_b32 v14, 4, v14
    v_lshl_add_u32 v128, v7, 11, v14
    s_lshl_b32 s53, s45, 17
    s_lshl_b32 s3, s10, 15
    s_add_u32 s53, s53, s3
    s_lshl_b32 s3, s46, 8
    s_add_u32 s53, s53, s3
    v_lshrrev_b32 v7, 4, v1
    v_and_b32 v14, 7, v1
    v_xor_b32 v14, v14, v7
    v_lshlrev_b32 v14, 4, v14
    v_lshrrev_b32 v7, 3, v1
    v_lshl_add_u32 v129, v7, 12, v14
    v_lshrrev_b32 v7, 4, v1
    v_add_u32 v7, 4, v7
    v_and_b32 v14, 7, v1
    v_xor_b32 v14, v14, v7
    v_lshlrev_b32 v14, 4, v14
    v_lshrrev_b32 v7, 3, v1
    v_lshl_add_u32 v130, v7, 12, v14
    s_lshl_b32 s54, s46, 19
    s_lshl_b32 s3, s10, 17
    s_add_u32 s54, s54, s3
    s_lshl_b32 s3, s45, 7
    s_add_u32 s54, s54, s3
    v_bfe_u32 v132, v1, 2, 2
    v_bfe_u32 v7, v1, 4, 1
    v_lshlrev_b32 v7, 1, v7
    v_bfe_u32 v14, v1, 1, 1
    v_add_u32 v7, v7, v14
    s_lshl_b32 s3, s10, 2
    v_add_u32 v7, s3, v7
    v_lshlrev_b32 v14, 2, v132
    v_xor_b32 v7, v7, v14
    v_lshlrev_b32 v7, 4, v7
    v_and_b32 v14, 1, v1
    v_lshl_add_u32 v7, v14, 3, v7
    v_lshrrev_b32 v14, 5, v1
    v_lshl_add_u32 v132, v14, 2, v132
    v_lshl_add_u32 v7, v132, 8, v7
    v_add_u32 v131, 0, v7
    v_and_b32 v7, 31, v1
    v_bfe_u32 v15, v7, 1, 3
    v_lshlrev_b32 v15, 4, v15
    v_lshl_add_u32 v15, v7, 7, v15
    v_lshrrev_b32 v14, 5, v1
    v_lshl_add_u32 v15, v14, 3, v15
    s_lshl_b32 s3, s10, 12
    s_add_u32 s3, s3, 16384
    v_add_u32 v133, s3, v15
    v_lshlrev_b32 v14, 4, v14
    s_lshl_b32 s3, s45, 8
    v_add_u32 v134, s3, v14
    v_and_b32 v7, 31, v1
    s_lshl_b32 s3, s46, 7
    v_add_u32 v7, s3, v7
    s_lshl_b32 s3, s10, 5
    v_add_u32 v7, s3, v7
    v_lshlrev_b32 v135, 1, v7
    v_lshrrev_b32 v14, 5, v1
    v_lshlrev_b32 v14, 14, v14
    v_lshl_add_u32 v136, v7, 2, v14
    s_lshl_b32 s55, s45, 18
    s_lshl_b32 s3, s46, 10
    s_add_u32 s3, s3, 24576
    v_add_u32 v137, s3, v2
    s_waitcnt vmcnt(8)
    s_barrier
    ds_read_b128 v[16:19], v10 offset:32768
    ds_read_b128 v[20:23], v10 offset:36864
    s_waitcnt lgkmcnt(0)
    v_mfma_f32_32x32x16_bf16 v[32:47], v[16:19], a[0:3], 0
    ds_read_b128 v[24:27], v11 offset:32768
    ds_read_b128 v[28:31], v11 offset:36864
    s_add_u32 s25, s28, 512
    s_add_u32 m0, s27, 0
    v_mfma_f32_32x32x16_bf16 v[48:63], v[20:23], a[0:3], 0
    buffer_load_dwordx4 v5, s[20:23], s25 offen offset:0 sc0 sc1 lds
    s_waitcnt lgkmcnt(1)
    v_mfma_f32_32x32x16_bf16 v[32:47], v[24:27], a[4:7], v[32:47]
    ds_read_b128 v[16:19], v12 offset:32768
    ds_read_b128 v[20:23], v12 offset:36864
    s_add_u32 m0, s27, 1024
    s_waitcnt lgkmcnt(2)
    v_mfma_f32_32x32x16_bf16 v[48:63], v[28:31], a[4:7], v[48:63]
    buffer_load_dwordx4 v6, s[20:23], s25 offen offset:0 sc0 sc1 lds
    s_waitcnt lgkmcnt(1)
    v_mfma_f32_32x32x16_bf16 v[32:47], v[16:19], a[8:11], v[32:47]
    ds_read_b128 v[24:27], v13 offset:32768
    ds_read_b128 v[28:31], v13 offset:36864
    s_add_u32 m0, s27, 8064
    s_waitcnt lgkmcnt(2)
    v_mfma_f32_32x32x16_bf16 v[48:63], v[20:23], a[8:11], v[48:63]
    buffer_load_dwordx4 v5, s[20:23], s25 offen offset:128 sc0 sc1 lds
    s_waitcnt lgkmcnt(1)
    v_mfma_f32_32x32x16_bf16 v[32:47], v[24:27], a[12:15], v[32:47]
    ds_read_b128 v[16:19], v10 offset:40960
    ds_read_b128 v[20:23], v10 offset:45056
    s_add_u32 m0, s27, 9088
    s_waitcnt lgkmcnt(2)
    v_mfma_f32_32x32x16_bf16 v[48:63], v[28:31], a[12:15], v[48:63]
    buffer_load_dwordx4 v6, s[20:23], s25 offen offset:128 sc0 sc1 lds
    s_waitcnt lgkmcnt(1)
    v_mfma_f32_32x32x16_bf16 v[32:47], v[16:19], a[16:19], v[32:47]
    ds_read_b128 v[24:27], v11 offset:40960
    ds_read_b128 v[28:31], v11 offset:45056
    s_add_u32 s25, s28, 768
    s_add_u32 m0, s27, 16384
    s_waitcnt lgkmcnt(2)
    v_mfma_f32_32x32x16_bf16 v[48:63], v[20:23], a[16:19], v[48:63]
    buffer_load_dwordx4 v5, s[20:23], s25 offen offset:0 sc0 sc1 lds
    s_waitcnt lgkmcnt(1)
    v_mfma_f32_32x32x16_bf16 v[32:47], v[24:27], a[20:23], v[32:47]
    ds_read_b128 v[16:19], v12 offset:40960
    ds_read_b128 v[20:23], v12 offset:45056
    s_add_u32 m0, s27, 17408
    s_waitcnt lgkmcnt(2)
    v_mfma_f32_32x32x16_bf16 v[48:63], v[28:31], a[20:23], v[48:63]
    buffer_load_dwordx4 v6, s[20:23], s25 offen offset:0 sc0 sc1 lds
    s_waitcnt lgkmcnt(1)
    v_mfma_f32_32x32x16_bf16 v[32:47], v[16:19], a[24:27], v[32:47]
    ds_read_b128 v[24:27], v13 offset:40960
    ds_read_b128 v[28:31], v13 offset:45056
    s_add_u32 m0, s27, 24448
    s_waitcnt lgkmcnt(2)
    v_mfma_f32_32x32x16_bf16 v[48:63], v[20:23], a[24:27], v[48:63]
    buffer_load_dwordx4 v5, s[20:23], s25 offen offset:128 sc0 sc1 lds
    s_waitcnt lgkmcnt(0)
    s_waitcnt vmcnt(11)
    s_barrier
    v_mfma_f32_32x32x16_bf16 v[32:47], v[24:27], a[28:31], v[32:47]
    ds_read_b128 v[16:19], v10 offset:49152
    ds_read_b128 v[20:23], v10 offset:53248
    s_add_u32 m0, s27, 25472
    v_mfma_f32_32x32x16_bf16 v[48:63], v[28:31], a[28:31], v[48:63]
    buffer_load_dwordx4 v6, s[20:23], s25 offen offset:128 sc0 sc1 lds
    s_waitcnt lgkmcnt(1)
    v_mfma_f32_32x32x16_bf16 v[32:47], v[16:19], a[32:35], v[32:47]
    ds_read_b128 v[24:27], v11 offset:49152
    ds_read_b128 v[28:31], v11 offset:53248
    s_lshl_b32 s56, s10, 12
    s_add_u32 s25, s28, 1024
    s_add_u32 m0, s27, 32768
    s_waitcnt lgkmcnt(2)
    v_mfma_f32_32x32x16_bf16 v[48:63], v[20:23], a[32:35], v[48:63]
    buffer_load_dwordx4 v5, s[20:23], s25 offen offset:0 sc0 sc1 lds
    s_waitcnt lgkmcnt(1)
    v_mfma_f32_32x32x16_bf16 v[32:47], v[24:27], a[36:39], v[32:47]
    ds_read_b128 v[16:19], v12 offset:49152
    ds_read_b128 v[20:23], v12 offset:53248
    s_add_u32 m0, s56, 0
    s_nop 0
    buffer_load_dwordx4 v128, s[16:19], s53 offen lds
    s_add_u32 m0, s27, 33792
    s_waitcnt lgkmcnt(2)
    v_mfma_f32_32x32x16_bf16 v[48:63], v[28:31], a[36:39], v[48:63]
    buffer_load_dwordx4 v6, s[20:23], s25 offen offset:0 sc0 sc1 lds
    s_add_u32 s53, s53, 8192
    s_waitcnt lgkmcnt(1)
    v_mfma_f32_32x32x16_bf16 v[32:47], v[16:19], a[40:43], v[32:47]
    ds_read_b128 v[24:27], v13 offset:49152
    ds_read_b128 v[28:31], v13 offset:53248
    s_add_u32 m0, s56, 1024
    s_nop 0
    buffer_load_dwordx4 v128, s[16:19], s53 offen lds
    s_add_u32 m0, s27, 40832
    s_waitcnt lgkmcnt(2)
    v_mfma_f32_32x32x16_bf16 v[48:63], v[20:23], a[40:43], v[48:63]
    buffer_load_dwordx4 v5, s[20:23], s25 offen offset:128 sc0 sc1 lds
    s_add_u32 s53, s53, 8192
    s_waitcnt lgkmcnt(1)
    v_mfma_f32_32x32x16_bf16 v[32:47], v[24:27], a[44:47], v[32:47]
    ds_read_b128 v[16:19], v10 offset:57344
    ds_read_b128 v[20:23], v10 offset:61440
    s_add_u32 m0, s56, 2048
    s_nop 0
    buffer_load_dwordx4 v128, s[16:19], s53 offen lds
    s_add_u32 m0, s27, 41856
    s_waitcnt lgkmcnt(2)
    v_mfma_f32_32x32x16_bf16 v[48:63], v[28:31], a[44:47], v[48:63]
    buffer_load_dwordx4 v6, s[20:23], s25 offen offset:128 sc0 sc1 lds
    s_add_u32 s53, s53, 8192
    s_waitcnt lgkmcnt(1)
    v_mfma_f32_32x32x16_bf16 v[32:47], v[16:19], a[48:51], v[32:47]
    ds_read_b128 v[24:27], v11 offset:57344
    ds_read_b128 v[28:31], v11 offset:61440
    s_add_u32 m0, s56, 3072
    s_nop 0
    buffer_load_dwordx4 v128, s[16:19], s53 offen lds
    s_mov_b32 s6, 49152
    s_waitcnt lgkmcnt(2)
    v_mfma_f32_32x32x16_bf16 v[48:63], v[20:23], a[48:51], v[48:63]
    buffer_load_dwordx4 a[192:195], v2, s[12:15], s6 offen offset:0 sc0 sc1
    s_waitcnt lgkmcnt(1)
    v_mfma_f32_32x32x16_bf16 v[32:47], v[24:27], a[52:55], v[32:47]
    ds_read_b128 v[16:19], v12 offset:57344
    ds_read_b128 v[20:23], v12 offset:61440
    s_waitcnt lgkmcnt(2)
    v_mfma_f32_32x32x16_bf16 v[48:63], v[28:31], a[52:55], v[48:63]
    buffer_load_dwordx4 a[196:199], v2, s[12:15], s6 offen offset:1024 sc0 sc1
    s_waitcnt lgkmcnt(1)
    v_mfma_f32_32x32x16_bf16 v[32:47], v[16:19], a[56:59], v[32:47]
    ds_read_b128 v[24:27], v13 offset:57344
    ds_read_b128 v[28:31], v13 offset:61440
    s_waitcnt lgkmcnt(2)
    v_mfma_f32_32x32x16_bf16 v[48:63], v[20:23], a[56:59], v[48:63]
    buffer_load_dwordx4 a[200:203], v2, s[12:15], s6 offen offset:2048 sc0 sc1
    s_waitcnt lgkmcnt(0)
    s_waitcnt vmcnt(15)
    s_barrier
    v_mfma_f32_32x32x16_bf16 v[32:47], v[24:27], a[60:63], v[32:47]
    ds_read_b128 v[16:19], v10 offset:0
    ds_read_b128 v[20:23], v10 offset:4096
    s_add_u32 s25, s28, 1280
    s_add_u32 m0, s27, 49152
    v_mfma_f32_32x32x16_bf16 v[48:63], v[28:31], a[60:63], v[48:63]
    buffer_load_dwordx4 v5, s[20:23], s25 offen offset:0 sc0 sc1 lds
    s_waitcnt lgkmcnt(1)
    v_mfma_f32_32x32x16_bf16 v[32:47], v[16:19], a[64:67], v[32:47]
    ds_read_b128 v[24:27], v11 offset:0
    ds_read_b128 v[28:31], v11 offset:4096
    s_add_u32 m0, s27, 50176
    s_waitcnt lgkmcnt(2)
    v_mfma_f32_32x32x16_bf16 v[48:63], v[20:23], a[64:67], v[48:63]
    buffer_load_dwordx4 v6, s[20:23], s25 offen offset:0 sc0 sc1 lds
    v_mov_b32 v220, s8
    v_mov_b32 v221, s9
    s_mov_b64 s[58:59], exec
    s_mov_b64 exec, 1
    buffer_store_dwordx2 v[220:221], v3, s[72:75], s24 offen sc0 sc1
    s_mov_b64 exec, s[58:59]
    s_waitcnt lgkmcnt(1)
    v_mfma_f32_32x32x16_bf16 v[32:47], v[24:27], a[68:71], v[32:47]
    ds_read_b128 v[16:19], v12 offset:0
    ds_read_b128 v[20:23], v12 offset:4096
    s_add_u32 m0, s27, 57216
    s_waitcnt lgkmcnt(2)
    v_mfma_f32_32x32x16_bf16 v[48:63], v[28:31], a[68:71], v[48:63]
    buffer_load_dwordx4 v5, s[20:23], s25 offen offset:128 sc0 sc1 lds
    s_waitcnt lgkmcnt(1)
    v_mfma_f32_32x32x16_bf16 v[32:47], v[16:19], a[72:75], v[32:47]
    ds_read_b128 v[24:27], v13 offset:0
    ds_read_b128 v[28:31], v13 offset:4096
    s_add_u32 m0, s27, 58240
    s_waitcnt lgkmcnt(2)
    v_mfma_f32_32x32x16_bf16 v[48:63], v[20:23], a[72:75], v[48:63]
    buffer_load_dwordx4 v6, s[20:23], s25 offen offset:128 sc0 sc1 lds
    s_waitcnt lgkmcnt(1)
    v_mfma_f32_32x32x16_bf16 v[32:47], v[24:27], a[76:79], v[32:47]
    ds_read_b128 v[16:19], v10 offset:8192
    ds_read_b128 v[20:23], v10 offset:12288
    s_waitcnt lgkmcnt(2)
    v_mfma_f32_32x32x16_bf16 v[48:63], v[28:31], a[76:79], v[48:63]
    buffer_load_dwordx4 a[204:207], v2, s[12:15], s6 offen offset:3072 sc0 sc1
    s_waitcnt lgkmcnt(1)
    v_mfma_f32_32x32x16_bf16 v[32:47], v[16:19], a[80:83], v[32:47]
    ds_read_b128 v[24:27], v11 offset:8192
    ds_read_b128 v[28:31], v11 offset:12288
    s_mov_b32 s6, 53248
    s_waitcnt lgkmcnt(2)
    v_mfma_f32_32x32x16_bf16 v[48:63], v[20:23], a[80:83], v[48:63]
    buffer_load_dwordx4 a[208:211], v2, s[12:15], s6 offen offset:0 sc0 sc1
    s_waitcnt lgkmcnt(1)
    v_mfma_f32_32x32x16_bf16 v[32:47], v[24:27], a[84:87], v[32:47]
    ds_read_b128 v[16:19], v12 offset:8192
    ds_read_b128 v[20:23], v12 offset:12288
    s_waitcnt lgkmcnt(2)
    v_mfma_f32_32x32x16_bf16 v[48:63], v[28:31], a[84:87], v[48:63]
    buffer_load_dwordx4 a[212:215], v2, s[12:15], s6 offen offset:1024 sc0 sc1
    s_waitcnt lgkmcnt(1)
    v_mfma_f32_32x32x16_bf16 v[32:47], v[16:19], a[88:91], v[32:47]
    ds_read_b128 v[24:27], v13 offset:8192
    ds_read_b128 v[28:31], v13 offset:12288
    s_waitcnt lgkmcnt(2)
    v_mfma_f32_32x32x16_bf16 v[48:63], v[20:23], a[88:91], v[48:63]
    buffer_load_dwordx4 a[216:219], v2, s[12:15], s6 offen offset:2048 sc0 sc1
    s_waitcnt lgkmcnt(0)
    s_waitcnt vmcnt(20)
    s_barrier
    v_mfma_f32_32x32x16_bf16 v[32:47], v[24:27], a[92:95], v[32:47]
    ds_read_b128 v[16:19], v10 offset:16384
    ds_read_b128 v[20:23], v10 offset:20480
    s_add_u32 s25, s28, 1536
    s_add_u32 m0, s27, 0
    v_mfma_f32_32x32x16_bf16 v[48:63], v[28:31], a[92:95], v[48:63]
    buffer_load_dwordx4 v5, s[20:23], s25 offen offset:0 sc0 sc1 lds
    s_waitcnt lgkmcnt(1)
    v_mfma_f32_32x32x16_bf16 v[32:47], v[16:19], a[96:99], v[32:47]
    ds_read_b128 v[24:27], v11 offset:16384
    ds_read_b128 v[28:31], v11 offset:20480
    s_add_u32 m0, s27, 1024
    s_waitcnt lgkmcnt(2)
    v_mfma_f32_32x32x16_bf16 v[48:63], v[20:23], a[96:99], v[48:63]
    buffer_load_dwordx4 v6, s[20:23], s25 offen offset:0 sc0 sc1 lds
    s_waitcnt lgkmcnt(1)
    v_mfma_f32_32x32x16_bf16 v[32:47], v[24:27], a[100:103], v[32:47]
    ds_read_b128 v[16:19], v12 offset:16384
    ds_read_b128 v[20:23], v12 offset:20480
    s_add_u32 m0, s27, 8064
    s_waitcnt lgkmcnt(2)
    v_mfma_f32_32x32x16_bf16 v[48:63], v[28:31], a[100:103], v[48:63]
    buffer_load_dwordx4 v5, s[20:23], s25 offen offset:128 sc0 sc1 lds
    s_waitcnt lgkmcnt(1)
    v_mfma_f32_32x32x16_bf16 v[32:47], v[16:19], a[104:107], v[32:47]
    ds_read_b128 v[24:27], v13 offset:16384
    ds_read_b128 v[28:31], v13 offset:20480
    s_add_u32 m0, s27, 9088
    s_waitcnt lgkmcnt(2)
    v_mfma_f32_32x32x16_bf16 v[48:63], v[20:23], a[104:107], v[48:63]
    buffer_load_dwordx4 v6, s[20:23], s25 offen offset:128 sc0 sc1 lds
    s_waitcnt lgkmcnt(1)
    v_mfma_f32_32x32x16_bf16 v[32:47], v[24:27], a[108:111], v[32:47]
    ds_read_b128 v[16:19], v10 offset:24576
    ds_read_b128 v[20:23], v10 offset:28672
    s_waitcnt lgkmcnt(2)
    v_mfma_f32_32x32x16_bf16 v[48:63], v[28:31], a[108:111], v[48:63]
    buffer_load_dwordx4 a[220:223], v2, s[12:15], s6 offen offset:3072 sc0 sc1
    s_waitcnt lgkmcnt(1)
    v_mfma_f32_32x32x16_bf16 v[32:47], v[16:19], a[112:115], v[32:47]
    ds_read_b128 v[24:27], v11 offset:24576
    ds_read_b128 v[28:31], v11 offset:28672
    s_mov_b32 s6, 57344
    s_waitcnt lgkmcnt(2)
    v_mfma_f32_32x32x16_bf16 v[48:63], v[20:23], a[112:115], v[48:63]
    buffer_load_dwordx4 a[224:227], v2, s[12:15], s6 offen offset:0 sc0 sc1
    s_waitcnt lgkmcnt(1)
    v_mfma_f32_32x32x16_bf16 v[32:47], v[24:27], a[116:119], v[32:47]
    ds_read_b128 v[16:19], v12 offset:24576
    ds_read_b128 v[20:23], v12 offset:28672
    s_waitcnt lgkmcnt(2)
    v_mfma_f32_32x32x16_bf16 v[48:63], v[28:31], a[116:119], v[48:63]
    buffer_load_dwordx4 a[228:231], v2, s[12:15], s6 offen offset:1024 sc0 sc1
    s_waitcnt lgkmcnt(1)
    v_mfma_f32_32x32x16_bf16 v[32:47], v[16:19], a[120:123], v[32:47]
    ds_read_b128 v[24:27], v13 offset:24576
    ds_read_b128 v[28:31], v13 offset:28672
    s_waitcnt lgkmcnt(2)
    v_mfma_f32_32x32x16_bf16 v[48:63], v[20:23], a[120:123], v[48:63]
    buffer_load_dwordx4 a[232:235], v2, s[12:15], s6 offen offset:2048 sc0 sc1
    s_waitcnt lgkmcnt(0)
    s_waitcnt vmcnt(21)
    s_barrier
    v_mfma_f32_32x32x16_bf16 v[32:47], v[24:27], a[124:127], v[32:47]
    ds_read_b128 v[16:19], v10 offset:32768
    ds_read_b128 v[20:23], v10 offset:36864
    s_add_u32 s25, s28, 1792
    s_add_u32 m0, s27, 16384
    v_mfma_f32_32x32x16_bf16 v[48:63], v[28:31], a[124:127], v[48:63]
    buffer_load_dwordx4 v5, s[20:23], s25 offen offset:0 sc0 sc1 lds
    s_waitcnt lgkmcnt(1)
    v_mfma_f32_32x32x16_bf16 v[32:47], v[16:19], a[128:131], v[32:47]
    ds_read_b128 v[24:27], v11 offset:32768
    ds_read_b128 v[28:31], v11 offset:36864
    s_add_u32 m0, s27, 17408
    s_waitcnt lgkmcnt(2)
    v_mfma_f32_32x32x16_bf16 v[48:63], v[20:23], a[128:131], v[48:63]
    buffer_load_dwordx4 v6, s[20:23], s25 offen offset:0 sc0 sc1 lds
    s_waitcnt lgkmcnt(1)
    v_mfma_f32_32x32x16_bf16 v[32:47], v[24:27], a[132:135], v[32:47]
    ds_read_b128 v[16:19], v12 offset:32768
    ds_read_b128 v[20:23], v12 offset:36864
    s_add_u32 m0, s27, 24448
    s_waitcnt lgkmcnt(2)
    v_mfma_f32_32x32x16_bf16 v[48:63], v[28:31], a[132:135], v[48:63]
    buffer_load_dwordx4 v5, s[20:23], s25 offen offset:128 sc0 sc1 lds
    s_waitcnt lgkmcnt(1)
    v_mfma_f32_32x32x16_bf16 v[32:47], v[16:19], a[136:139], v[32:47]
    ds_read_b128 v[24:27], v13 offset:32768
    ds_read_b128 v[28:31], v13 offset:36864
    s_add_u32 m0, s27, 25472
    s_waitcnt lgkmcnt(2)
    v_mfma_f32_32x32x16_bf16 v[48:63], v[20:23], a[136:139], v[48:63]
    buffer_load_dwordx4 v6, s[20:23], s25 offen offset:128 sc0 sc1 lds
    s_waitcnt lgkmcnt(1)
    v_mfma_f32_32x32x16_bf16 v[32:47], v[24:27], a[140:143], v[32:47]
    ds_read_b128 v[16:19], v10 offset:40960
    ds_read_b128 v[20:23], v10 offset:45056
    s_waitcnt lgkmcnt(2)
    v_mfma_f32_32x32x16_bf16 v[48:63], v[28:31], a[140:143], v[48:63]
    buffer_load_dwordx4 a[236:239], v2, s[12:15], s6 offen offset:3072 sc0 sc1
    s_waitcnt lgkmcnt(1)
    v_mfma_f32_32x32x16_bf16 v[32:47], v[16:19], a[144:147], v[32:47]
    ds_read_b128 v[24:27], v11 offset:40960
    ds_read_b128 v[28:31], v11 offset:45056
    s_mov_b32 s6, 61440
    s_waitcnt lgkmcnt(2)
    v_mfma_f32_32x32x16_bf16 v[48:63], v[20:23], a[144:147], v[48:63]
    buffer_load_dwordx4 a[240:243], v2, s[12:15], s6 offen offset:0 sc0 sc1
    s_waitcnt lgkmcnt(1)
    v_mfma_f32_32x32x16_bf16 v[32:47], v[24:27], a[148:151], v[32:47]
    ds_read_b128 v[16:19], v12 offset:40960
    ds_read_b128 v[20:23], v12 offset:45056
    s_waitcnt lgkmcnt(2)
    v_mfma_f32_32x32x16_bf16 v[48:63], v[28:31], a[148:151], v[48:63]
    buffer_load_dwordx4 a[244:247], v2, s[12:15], s6 offen offset:1024 sc0 sc1
    s_waitcnt lgkmcnt(1)
    v_mfma_f32_32x32x16_bf16 v[32:47], v[16:19], a[152:155], v[32:47]
    ds_read_b128 v[24:27], v13 offset:40960
    ds_read_b128 v[28:31], v13 offset:45056
    s_waitcnt lgkmcnt(2)
    v_mfma_f32_32x32x16_bf16 v[48:63], v[20:23], a[152:155], v[48:63]
    buffer_load_dwordx4 a[248:251], v2, s[12:15], s6 offen offset:2048 sc0 sc1
    s_waitcnt lgkmcnt(0)
    s_waitcnt vmcnt(20)
    s_barrier
    v_mfma_f32_32x32x16_bf16 v[32:47], v[24:27], a[156:159], v[32:47]
    ds_read_b128 v[16:19], v10 offset:49152
    ds_read_b128 v[20:23], v10 offset:53248
    s_add_u32 s25, s29, 0
    s_add_u32 m0, s27, 32768
    v_mfma_f32_32x32x16_bf16 v[48:63], v[28:31], a[156:159], v[48:63]
    buffer_load_dwordx4 v5, s[20:23], s25 offen offset:0 sc0 sc1 lds
    s_waitcnt lgkmcnt(1)
    v_mfma_f32_32x32x16_bf16 v[32:47], v[16:19], a[160:163], v[32:47]
    ds_read_b128 v[24:27], v11 offset:49152
    ds_read_b128 v[28:31], v11 offset:53248
    buffer_load_dwordx4 v[216:219], v137, s[72:75], 0 offen sc0 sc1
    s_add_u32 m0, s27, 33792
    s_waitcnt lgkmcnt(2)
    v_mfma_f32_32x32x16_bf16 v[48:63], v[20:23], a[160:163], v[48:63]
    buffer_load_dwordx4 v6, s[20:23], s25 offen offset:0 sc0 sc1 lds
    s_waitcnt lgkmcnt(1)
    v_mfma_f32_32x32x16_bf16 v[32:47], v[24:27], a[164:167], v[32:47]
    ds_read_b128 v[16:19], v12 offset:49152
    ds_read_b128 v[20:23], v12 offset:53248
    s_add_u32 m0, s27, 40832
    s_waitcnt lgkmcnt(2)
    v_mfma_f32_32x32x16_bf16 v[48:63], v[28:31], a[164:167], v[48:63]
    buffer_load_dwordx4 v5, s[20:23], s25 offen offset:128 sc0 sc1 lds
    s_waitcnt lgkmcnt(1)
    v_mfma_f32_32x32x16_bf16 v[32:47], v[16:19], a[168:171], v[32:47]
    ds_read_b128 v[24:27], v13 offset:49152
    ds_read_b128 v[28:31], v13 offset:53248
    s_add_u32 m0, s27, 41856
    s_waitcnt lgkmcnt(2)
    v_mfma_f32_32x32x16_bf16 v[48:63], v[20:23], a[168:171], v[48:63]
    buffer_load_dwordx4 v6, s[20:23], s25 offen offset:128 sc0 sc1 lds
    s_waitcnt lgkmcnt(1)
    v_mfma_f32_32x32x16_bf16 v[32:47], v[24:27], a[172:175], v[32:47]
    ds_read_b128 v[16:19], v10 offset:57344
    ds_read_b128 v[20:23], v10 offset:61440
    s_waitcnt lgkmcnt(2)
    v_mfma_f32_32x32x16_bf16 v[48:63], v[28:31], a[172:175], v[48:63]
    buffer_load_dwordx4 a[252:255], v2, s[12:15], s6 offen offset:3072 sc0 sc1
    s_waitcnt lgkmcnt(1)
    v_mfma_f32_32x32x16_bf16 v[32:47], v[16:19], a[176:179], v[32:47]
    ds_read_b128 v[24:27], v11 offset:57344
    ds_read_b128 v[28:31], v11 offset:61440
    s_waitcnt lgkmcnt(2)
    v_mfma_f32_32x32x16_bf16 v[48:63], v[20:23], a[176:179], v[48:63]
    s_waitcnt lgkmcnt(1)
    v_mfma_f32_32x32x16_bf16 v[32:47], v[24:27], a[180:183], v[32:47]
    ds_read_b128 v[16:19], v12 offset:57344
    ds_read_b128 v[20:23], v12 offset:61440
    s_waitcnt lgkmcnt(2)
    v_mfma_f32_32x32x16_bf16 v[48:63], v[28:31], a[180:183], v[48:63]
    s_waitcnt lgkmcnt(1)
    v_mfma_f32_32x32x16_bf16 v[32:47], v[16:19], a[184:187], v[32:47]
    ds_read_b128 v[24:27], v13 offset:57344
    ds_read_b128 v[28:31], v13 offset:61440
    s_waitcnt lgkmcnt(2)
    v_mfma_f32_32x32x16_bf16 v[48:63], v[20:23], a[184:187], v[48:63]
    s_waitcnt lgkmcnt(0)
    s_waitcnt vmcnt(18)
    s_barrier
    v_mfma_f32_32x32x16_bf16 v[32:47], v[24:27], a[188:191], v[32:47]
    ds_read_b128 v[16:19], v10 offset:0
    ds_read_b128 v[20:23], v10 offset:4096
    s_add_u32 s25, s29, 256
    s_add_u32 m0, s27, 49152
    v_mfma_f32_32x32x16_bf16 v[48:63], v[28:31], a[188:191], v[48:63]
    buffer_load_dwordx4 v5, s[20:23], s25 offen offset:0 sc0 sc1 lds
    s_waitcnt lgkmcnt(1)
    v_mfma_f32_32x32x16_bf16 v[32:47], v[16:19], a[192:195], v[32:47]
    ds_read_b128 v[24:27], v11 offset:0
    ds_read_b128 v[28:31], v11 offset:4096
    s_mov_b32 s57, 0
    s_waitcnt vmcnt(5)
    v_cmp_ne_u64 vcc, s[8:9], v[216:217]
    v_cmp_ne_u64 s[58:59], s[8:9], v[218:219]
    s_nop 3
    s_or_b64 vcc, vcc, s[58:59]
    s_cbranch_vccz Lfdone_gate_11
Lfpoll_gate_12:
    buffer_load_dwordx4 v[216:219], v137, s[72:75], 0 offen sc0 sc1
    s_waitcnt vmcnt(0)
    v_cmp_ne_u64 vcc, s[8:9], v[216:217]
    v_cmp_ne_u64 s[58:59], s[8:9], v[218:219]
    s_nop 4
    s_or_b64 vcc, vcc, s[58:59]
    s_nop 4
    s_add_u32 s57, s57, 1
    s_cmp_gt_u32 s57, 20000
    s_cbranch_scc1 Lfdone_gate_11
    s_cbranch_vccnz Lfpoll_gate_12
Lfdone_gate_11:
    s_add_u32 m0, s27, 50176
    s_waitcnt lgkmcnt(2)
    v_mfma_f32_32x32x16_bf16 v[48:63], v[20:23], a[192:195], v[48:63]
    buffer_load_dwordx4 v6, s[20:23], s25 offen offset:0 sc0 sc1 lds
    s_lshl_b32 s56, s10, 12
    s_waitcnt lgkmcnt(1)
    v_mfma_f32_32x32x16_bf16 v[32:47], v[24:27], a[196:199], v[32:47]
    ds_read_b128 v[16:19], v12 offset:0
    ds_read_b128 v[20:23], v12 offset:4096
    s_add_u32 m0, s56, 16384
    s_nop 0
    buffer_load_dwordx4 v129, s[32:35], s54 offen sc0 sc1 lds
    s_add_u32 m0, s27, 57216
    s_waitcnt lgkmcnt(2)
    v_mfma_f32_32x32x16_bf16 v[48:63], v[28:31], a[196:199], v[48:63]
    buffer_load_dwordx4 v5, s[20:23], s25 offen offset:128 sc0 sc1 lds
    s_add_u32 s54, s54, 32768
    s_waitcnt lgkmcnt(1)
    v_mfma_f32_32x32x16_bf16 v[32:47], v[16:19], a[200:203], v[32:47]
    ds_read_b128 v[24:27], v13 offset:0
    ds_read_b128 v[28:31], v13 offset:4096
    s_add_u32 m0, s56, 17408
    s_nop 0
    buffer_load_dwordx4 v130, s[32:35], s54 offen sc0 sc1 lds
    s_add_u32 m0, s27, 58240
    s_waitcnt lgkmcnt(2)
    v_mfma_f32_32x32x16_bf16 v[48:63], v[20:23], a[200:203], v[48:63]
    buffer_load_dwordx4 v6, s[20:23], s25 offen offset:128 sc0 sc1 lds
    s_add_u32 s54, s54, 32768
    s_waitcnt lgkmcnt(1)
    v_mfma_f32_32x32x16_bf16 v[32:47], v[24:27], a[204:207], v[32:47]
    ds_read_b128 v[16:19], v10 offset:8192
    ds_read_b128 v[20:23], v10 offset:12288
    s_add_u32 m0, s56, 18432
    s_nop 0
    buffer_load_dwordx4 v129, s[32:35], s54 offen sc0 sc1 lds
    s_waitcnt lgkmcnt(2)
    v_mfma_f32_32x32x16_bf16 v[48:63], v[28:31], a[204:207], v[48:63]
    s_add_u32 s54, s54, 32768
    s_add_u32 m0, s56, 19456
    s_nop 0
    buffer_load_dwordx4 v130, s[32:35], s54 offen sc0 sc1 lds
    buffer_load_ushort v7, v135, s[36:39], 0 offen
    s_waitcnt lgkmcnt(1)
    v_mfma_f32_32x32x16_bf16 v[32:47], v[16:19], a[208:211], v[32:47]
    ds_read_b128 v[24:27], v11 offset:8192
    ds_read_b128 v[28:31], v11 offset:12288
    buffer_load_dwordx4 v[138:141], v134, s[60:63], 0 offen offset:0 sc0 sc1
    s_waitcnt lgkmcnt(2)
    v_mfma_f32_32x32x16_bf16 v[48:63], v[20:23], a[208:211], v[48:63]
    s_nop 0
    buffer_load_dwordx4 v[142:145], v134, s[60:63], 0 offen offset:32 sc0 sc1
    s_nop 0
    s_waitcnt lgkmcnt(1)
    v_mfma_f32_32x32x16_bf16 v[32:47], v[24:27], a[212:215], v[32:47]
    ds_read_b128 v[16:19], v12 offset:8192
    ds_read_b128 v[20:23], v12 offset:12288
    buffer_load_dwordx4 v[146:149], v134, s[60:63], 0 offen offset:64 sc0 sc1
    s_waitcnt lgkmcnt(2)
    v_mfma_f32_32x32x16_bf16 v[48:63], v[28:31], a[212:215], v[48:63]
    s_nop 0
    buffer_load_dwordx4 v[150:153], v134, s[60:63], 0 offen offset:96 sc0 sc1
    s_nop 0
    s_waitcnt lgkmcnt(1)
    v_mfma_f32_32x32x16_bf16 v[32:47], v[16:19], a[216:219], v[32:47]
    ds_read_b128 v[24:27], v13 offset:8192
    ds_read_b128 v[28:31], v13 offset:12288
    buffer_load_dwordx4 v[154:157], v134, s[60:63], 0 offen offset:128 sc0 sc1
    s_waitcnt lgkmcnt(2)
    v_mfma_f32_32x32x16_bf16 v[48:63], v[20:23], a[216:219], v[48:63]
    s_nop 0
    buffer_load_dwordx4 v[158:161], v134, s[60:63], 0 offen offset:160 sc0 sc1
    s_nop 0
    s_waitcnt lgkmcnt(0)
    s_barrier
    v_mfma_f32_32x32x16_bf16 v[32:47], v[24:27], a[220:223], v[32:47]
    ds_read_b128 v[16:19], v10 offset:16384
    ds_read_b128 v[20:23], v10 offset:20480
    buffer_load_dwordx4 v[162:165], v134, s[60:63], 0 offen offset:192 sc0 sc1
    s_add_u32 s25, s29, 512
    s_add_u32 m0, s27, 0
    v_mfma_f32_32x32x16_bf16 v[48:63], v[28:31], a[220:223], v[48:63]
    buffer_load_dwordx4 v5, s[20:23], s25 offen offset:0 sc0 sc1 lds
    s_waitcnt lgkmcnt(1)
    v_mfma_f32_32x32x16_bf16 v[32:47], v[16:19], a[224:227], v[32:47]
    ds_read_b128 v[24:27], v11 offset:16384
    ds_read_b128 v[28:31], v11 offset:20480
    s_nop 0
    s_add_u32 m0, s27, 1024
    s_waitcnt lgkmcnt(2)
    v_mfma_f32_32x32x16_bf16 v[48:63], v[20:23], a[224:227], v[48:63]
    buffer_load_dwordx4 v6, s[20:23], s25 offen offset:0 sc0 sc1 lds
    buffer_load_dwordx4 v[166:169], v134, s[60:63], 0 offen offset:224 sc0 sc1
    s_waitcnt lgkmcnt(1)
    v_mfma_f32_32x32x16_bf16 v[32:47], v[24:27], a[228:231], v[32:47]
    ds_read_b128 v[16:19], v12 offset:16384
    ds_read_b128 v[20:23], v12 offset:20480
    s_nop 0
    s_add_u32 m0, s27, 8064
    s_waitcnt lgkmcnt(2)
    v_mfma_f32_32x32x16_bf16 v[48:63], v[28:31], a[228:231], v[48:63]
    buffer_load_dwordx4 v5, s[20:23], s25 offen offset:128 sc0 sc1 lds
    v_add_u32 v132, 8192, v134
    s_waitcnt lgkmcnt(1)
    v_mfma_f32_32x32x16_bf16 v[32:47], v[16:19], a[232:235], v[32:47]
    ds_read_b128 v[24:27], v13 offset:16384
    ds_read_b128 v[28:31], v13 offset:20480
    buffer_load_dwordx4 v[170:173], v132, s[60:63], 0 offen offset:0 sc0 sc1
    s_add_u32 m0, s27, 9088
    s_waitcnt lgkmcnt(2)
    v_mfma_f32_32x32x16_bf16 v[48:63], v[20:23], a[232:235], v[48:63]
    buffer_load_dwordx4 v6, s[20:23], s25 offen offset:128 sc0 sc1 lds
    buffer_load_dwordx4 v[174:177], v132, s[60:63], 0 offen offset:32 sc0 sc1
    s_waitcnt lgkmcnt(1)
    v_mfma_f32_32x32x16_bf16 v[32:47], v[24:27], a[236:239], v[32:47]
    ds_read_b128 v[16:19], v10 offset:24576
    ds_read_b128 v[20:23], v10 offset:28672
    buffer_load_dwordx4 v[178:181], v132, s[60:63], 0 offen offset:64 sc0 sc1
    s_waitcnt lgkmcnt(2)
    v_mfma_f32_32x32x16_bf16 v[48:63], v[28:31], a[236:239], v[48:63]
    buffer_load_dwordx4 v[182:185], v132, s[60:63], 0 offen offset:96 sc0 sc1
    buffer_load_dwordx4 v[186:189], v132, s[60:63], 0 offen offset:128 sc0 sc1
    buffer_load_dwordx4 v[190:193], v132, s[60:63], 0 offen offset:160 sc0 sc1
    s_waitcnt lgkmcnt(1)
    v_mfma_f32_32x32x16_bf16 v[32:47], v[16:19], a[240:243], v[32:47]
    ds_read_b128 v[24:27], v11 offset:24576
    ds_read_b128 v[28:31], v11 offset:28672
    buffer_load_dwordx4 v[194:197], v132, s[60:63], 0 offen offset:192 sc0 sc1
    s_waitcnt lgkmcnt(2)
    v_mfma_f32_32x32x16_bf16 v[48:63], v[20:23], a[240:243], v[48:63]
    buffer_load_dwordx4 v[198:201], v132, s[60:63], 0 offen offset:224 sc0 sc1
    s_waitcnt lgkmcnt(1)
    v_mfma_f32_32x32x16_bf16 v[32:47], v[24:27], a[244:247], v[32:47]
    ds_read_b128 v[16:19], v12 offset:24576
    ds_read_b128 v[20:23], v12 offset:28672
    s_waitcnt lgkmcnt(2)
    v_mfma_f32_32x32x16_bf16 v[48:63], v[28:31], a[244:247], v[48:63]
    s_waitcnt lgkmcnt(1)
    v_mfma_f32_32x32x16_bf16 v[32:47], v[16:19], a[248:251], v[32:47]
    ds_read_b128 v[24:27], v13 offset:24576
    ds_read_b128 v[28:31], v13 offset:28672
    s_waitcnt lgkmcnt(2)
    v_mfma_f32_32x32x16_bf16 v[48:63], v[20:23], a[248:251], v[48:63]
    s_waitcnt lgkmcnt(0)
    s_waitcnt vmcnt(30)
    s_barrier
    s_waitcnt vmcnt(29)
    v_mfma_f32_32x32x16_bf16 v[32:47], v[24:27], a[252:255], v[32:47]
    ds_read_b128 v[16:19], v10 offset:32768
    ds_read_b128 v[20:23], v10 offset:36864
    s_add_u32 s25, s29, 768
    s_add_u32 m0, s27, 16384
    v_mfma_f32_32x32x16_bf16 v[48:63], v[28:31], a[252:255], v[48:63]
    buffer_load_dwordx4 v5, s[20:23], s25 offen offset:0 sc0 sc1 lds
    s_waitcnt lgkmcnt(1)
    v_mfma_f32_32x32x16_bf16 v[64:79], v[16:19], a[0:3], 0
    ds_read_b128 v[24:27], v11 offset:32768
    ds_read_b128 v[28:31], v11 offset:36864
    s_add_u32 s52, s7, 0
    s_add_u32 m0, s27, 17408
    s_waitcnt lgkmcnt(2)
    v_mfma_f32_32x32x16_bf16 v[80:95], v[20:23], a[0:3], 0
    buffer_load_dwordx4 v6, s[20:23], s25 offen offset:0 sc0 sc1 lds
    buffer_store_dwordx4 v[32:35], v2, s[48:51], s52 offen offset:0 sc0 sc1
    s_waitcnt lgkmcnt(1)
    v_mfma_f32_32x32x16_bf16 v[64:79], v[24:27], a[4:7], v[64:79]
    ds_read_b128 v[16:19], v12 offset:32768
    ds_read_b128 v[20:23], v12 offset:36864
    buffer_store_dwordx4 v[36:39], v2, s[48:51], s52 offen offset:1024 sc0 sc1
    s_add_u32 m0, s27, 24448
    s_waitcnt lgkmcnt(2)
    v_mfma_f32_32x32x16_bf16 v[80:95], v[28:31], a[4:7], v[80:95]
    buffer_load_dwordx4 v5, s[20:23], s25 offen offset:128 sc0 sc1 lds
    buffer_store_dwordx4 v[40:43], v2, s[48:51], s52 offen offset:2048 sc0 sc1
    s_waitcnt lgkmcnt(1)
    v_mfma_f32_32x32x16_bf16 v[64:79], v[16:19], a[8:11], v[64:79]
    ds_read_b128 v[24:27], v13 offset:32768
    ds_read_b128 v[28:31], v13 offset:36864
    buffer_store_dwordx4 v[44:47], v2, s[48:51], s52 offen offset:3072 sc0 sc1
    s_add_u32 m0, s27, 25472
    s_waitcnt lgkmcnt(2)
    v_mfma_f32_32x32x16_bf16 v[80:95], v[20:23], a[8:11], v[80:95]
    buffer_load_dwordx4 v6, s[20:23], s25 offen offset:128 sc0 sc1 lds
    s_add_u32 s52, s7, 4096
    s_waitcnt lgkmcnt(1)
    v_mfma_f32_32x32x16_bf16 v[64:79], v[24:27], a[12:15], v[64:79]
    ds_read_b128 v[16:19], v10 offset:40960
    ds_read_b128 v[20:23], v10 offset:45056
    buffer_store_dwordx4 v[48:51], v2, s[48:51], s52 offen offset:0 sc0 sc1
    s_waitcnt lgkmcnt(2)
    v_mfma_f32_32x32x16_bf16 v[80:95], v[28:31], a[12:15], v[80:95]
    buffer_store_dwordx4 v[52:55], v2, s[48:51], s52 offen offset:1024 sc0 sc1
    buffer_store_dwordx4 v[56:59], v2, s[48:51], s52 offen offset:2048 sc0 sc1
    buffer_store_dwordx4 v[60:63], v2, s[48:51], s52 offen offset:3072 sc0 sc1
    s_waitcnt lgkmcnt(1)
    v_mfma_f32_32x32x16_bf16 v[64:79], v[16:19], a[16:19], v[64:79]
    ds_read_b128 v[24:27], v11 offset:40960
    ds_read_b128 v[28:31], v11 offset:45056
    s_waitcnt lgkmcnt(2)
    v_mfma_f32_32x32x16_bf16 v[80:95], v[20:23], a[16:19], v[80:95]
    s_waitcnt lgkmcnt(1)
    v_mfma_f32_32x32x16_bf16 v[64:79], v[24:27], a[20:23], v[64:79]
    ds_read_b128 v[16:19], v12 offset:40960
    ds_read_b128 v[20:23], v12 offset:45056
    s_waitcnt lgkmcnt(2)
    v_mfma_f32_32x32x16_bf16 v[80:95], v[28:31], a[20:23], v[80:95]
    s_waitcnt lgkmcnt(1)
    v_mfma_f32_32x32x16_bf16 v[64:79], v[16:19], a[24:27], v[64:79]
    ds_read_b128 v[24:27], v13 offset:40960
    ds_read_b128 v[28:31], v13 offset:45056
    s_waitcnt lgkmcnt(2)
    v_mfma_f32_32x32x16_bf16 v[80:95], v[20:23], a[24:27], v[80:95]
    s_waitcnt lgkmcnt(0)
    s_waitcnt vmcnt(35)
    s_barrier
    v_mfma_f32_32x32x16_bf16 v[64:79], v[24:27], a[28:31], v[64:79]
    ds_read_b128 v[16:19], v10 offset:49152
    ds_read_b128 v[20:23], v10 offset:53248
    s_add_u32 s25, s29, 1024
    s_add_u32 m0, s27, 32768
    v_mfma_f32_32x32x16_bf16 v[80:95], v[28:31], a[28:31], v[80:95]
    buffer_load_dwordx4 v5, s[20:23], s25 offen offset:0 sc0 sc1 lds
    s_waitcnt lgkmcnt(1)
    v_mfma_f32_32x32x16_bf16 v[64:79], v[16:19], a[32:35], v[64:79]
    ds_read_b128 v[24:27], v11 offset:49152
    ds_read_b128 v[28:31], v11 offset:53248
    s_add_u32 m0, s27, 33792
    s_waitcnt lgkmcnt(2)
    v_mfma_f32_32x32x16_bf16 v[80:95], v[20:23], a[32:35], v[80:95]
    buffer_load_dwordx4 v6, s[20:23], s25 offen offset:0 sc0 sc1 lds
    s_waitcnt lgkmcnt(1)
    v_mfma_f32_32x32x16_bf16 v[64:79], v[24:27], a[36:39], v[64:79]
    ds_read_b128 v[16:19], v12 offset:49152
    ds_read_b128 v[20:23], v12 offset:53248
    s_add_u32 m0, s27, 40832
    s_waitcnt lgkmcnt(2)
    v_mfma_f32_32x32x16_bf16 v[80:95], v[28:31], a[36:39], v[80:95]
    buffer_load_dwordx4 v5, s[20:23], s25 offen offset:128 sc0 sc1 lds
    s_waitcnt lgkmcnt(1)
    v_mfma_f32_32x32x16_bf16 v[64:79], v[16:19], a[40:43], v[64:79]
    ds_read_b128 v[24:27], v13 offset:49152
    ds_read_b128 v[28:31], v13 offset:53248
    s_add_u32 m0, s27, 41856
    s_waitcnt lgkmcnt(2)
    v_mfma_f32_32x32x16_bf16 v[80:95], v[20:23], a[40:43], v[80:95]
    buffer_load_dwordx4 v6, s[20:23], s25 offen offset:128 sc0 sc1 lds
    s_waitcnt lgkmcnt(1)
    v_mfma_f32_32x32x16_bf16 v[64:79], v[24:27], a[44:47], v[64:79]
    ds_read_b128 v[16:19], v10 offset:57344
    ds_read_b128 v[20:23], v10 offset:61440
    s_waitcnt lgkmcnt(2)
    v_mfma_f32_32x32x16_bf16 v[80:95], v[28:31], a[44:47], v[80:95]
    s_waitcnt lgkmcnt(1)
    v_mfma_f32_32x32x16_bf16 v[64:79], v[16:19], a[48:51], v[64:79]
    ds_read_b128 v[24:27], v11 offset:57344
    ds_read_b128 v[28:31], v11 offset:61440
    s_waitcnt lgkmcnt(2)
    v_mfma_f32_32x32x16_bf16 v[80:95], v[20:23], a[48:51], v[80:95]
    s_waitcnt lgkmcnt(1)
    v_mfma_f32_32x32x16_bf16 v[64:79], v[24:27], a[52:55], v[64:79]
    ds_read_b128 v[16:19], v12 offset:57344
    ds_read_b128 v[20:23], v12 offset:61440
    s_waitcnt lgkmcnt(2)
    v_mfma_f32_32x32x16_bf16 v[80:95], v[28:31], a[52:55], v[80:95]
    s_waitcnt lgkmcnt(1)
    v_mfma_f32_32x32x16_bf16 v[64:79], v[16:19], a[56:59], v[64:79]
    ds_read_b128 v[24:27], v13 offset:57344
    ds_read_b128 v[28:31], v13 offset:61440
    s_waitcnt lgkmcnt(2)
    v_mfma_f32_32x32x16_bf16 v[80:95], v[20:23], a[56:59], v[80:95]
    s_waitcnt lgkmcnt(0)
    s_waitcnt vmcnt(23)
    s_barrier
    v_mfma_f32_32x32x16_bf16 v[64:79], v[24:27], a[60:63], v[64:79]
    ds_read_b128 v[16:19], v10 offset:0
    ds_read_b128 v[20:23], v10 offset:4096
    s_add_u32 s25, s29, 1280
    s_add_u32 m0, s27, 49152
    v_mfma_f32_32x32x16_bf16 v[80:95], v[28:31], a[60:63], v[80:95]
    buffer_load_dwordx4 v5, s[20:23], s25 offen offset:0 sc0 sc1 lds
    s_waitcnt lgkmcnt(1)
    v_mfma_f32_32x32x16_bf16 v[64:79], v[16:19], a[64:67], v[64:79]
    ds_read_b128 v[24:27], v11 offset:0
    ds_read_b128 v[28:31], v11 offset:4096
    s_waitcnt vmcnt(5)
    s_add_u32 m0, s27, 50176
    s_waitcnt lgkmcnt(2)
    v_mfma_f32_32x32x16_bf16 v[80:95], v[20:23], a[64:67], v[80:95]
    buffer_load_dwordx4 v6, s[20:23], s25 offen offset:0 sc0 sc1 lds
    v_mov_b32 v8, s8
    v_mov_b32 v9, s9
    s_mov_b64 s[58:59], exec
    s_mov_b64 exec, 1
    buffer_store_dwordx2 v[8:9], v4, s[72:75], s30 offen sc0 sc1
    s_mov_b64 exec, s[58:59]
    s_waitcnt lgkmcnt(1)
    v_mfma_f32_32x32x16_bf16 v[64:79], v[24:27], a[68:71], v[64:79]
    ds_read_b128 v[16:19], v12 offset:0
    ds_read_b128 v[20:23], v12 offset:4096
    v_lshlrev_b32 v7, 16, v7
    s_add_u32 m0, s27, 57216
    s_waitcnt lgkmcnt(2)
    v_mfma_f32_32x32x16_bf16 v[80:95], v[28:31], a[68:71], v[80:95]
    buffer_load_dwordx4 v5, s[20:23], s25 offen offset:128 sc0 sc1 lds
    ds_read_b64_tr_b16 v[14:15], v131 offset:0
    s_waitcnt lgkmcnt(2)
    v_mfma_f32_32x32x16_bf16 v[64:79], v[16:19], a[72:75], v[64:79]
    ds_read_b128 v[24:27], v13 offset:0
    ds_read_b128 v[28:31], v13 offset:4096
    v_xor_b32 v132, 0, v133
    s_add_u32 m0, s27, 58240
    s_waitcnt lgkmcnt(3)
    v_mfma_f32_32x32x16_bf16 v[80:95], v[20:23], a[72:75], v[80:95]
    buffer_load_dwordx4 v6, s[20:23], s25 offen offset:128 sc0 sc1 lds
    ds_read_b64 v[204:205], v132
    s_waitcnt lgkmcnt(2)
    v_mfma_f32_32x32x16_bf16 v[64:79], v[24:27], a[76:79], v[64:79]
    ds_read_b128 v[16:19], v10 offset:8192
    ds_read_b128 v[20:23], v10 offset:12288
    s_waitcnt lgkmcnt(2)
    v_lshlrev_b32 v208, 16, v204
    v_mfma_f32_32x32x16_bf16 v[80:95], v[28:31], a[76:79], v[80:95]
    v_lshlrev_b32 v212, 16, v14
    v_and_b32 v209, s47, v204
    v_and_b32 v213, s47, v14
    s_waitcnt lgkmcnt(1)
    v_mfma_f32_32x32x16_bf16 v[64:79], v[16:19], a[80:83], v[64:79]
    ds_read_b128 v[24:27], v11 offset:8192
    ds_read_b128 v[28:31], v11 offset:12288
    v_lshlrev_b32 v210, 16, v205
    s_waitcnt lgkmcnt(2)
    v_mfma_f32_32x32x16_bf16 v[80:95], v[20:23], a[80:83], v[80:95]
    v_lshlrev_b32 v214, 16, v15
    v_and_b32 v211, s47, v205
    v_and_b32 v215, s47, v15
    s_waitcnt lgkmcnt(1)
    v_mfma_f32_32x32x16_bf16 v[64:79], v[24:27], a[84:87], v[64:79]
    ds_read_b128 v[16:19], v12 offset:8192
    ds_read_b128 v[20:23], v12 offset:12288
    v_mul_f32 v170, v170, v208
    s_waitcnt lgkmcnt(2)
    v_mfma_f32_32x32x16_bf16 v[80:95], v[28:31], a[84:87], v[80:95]
    v_mul_f32 v171, v171, v209
    v_mul_f32 v172, v172, v210
    v_mul_f32 v173, v173, v211
    s_waitcnt lgkmcnt(1)
    v_mfma_f32_32x32x16_bf16 v[64:79], v[16:19], a[88:91], v[64:79]
    ds_read_b128 v[24:27], v13 offset:8192
    ds_read_b128 v[28:31], v13 offset:12288
    v_fmac_f32 v170, v138, v7
    s_waitcnt lgkmcnt(2)
    v_mfma_f32_32x32x16_bf16 v[80:95], v[20:23], a[88:91], v[80:95]
    v_fmac_f32 v171, v139, v7
    v_fmac_f32 v172, v140, v7
    v_fmac_f32 v173, v141, v7
    s_waitcnt lgkmcnt(0)
    s_barrier
    v_mfma_f32_32x32x16_bf16 v[64:79], v[24:27], a[92:95], v[64:79]
    ds_read_b128 v[16:19], v10 offset:16384
    ds_read_b128 v[20:23], v10 offset:20480
    v_mul_f32 v170, v170, v212
    s_add_u32 s25, s29, 1536
    s_add_u32 m0, s27, 0
    v_mfma_f32_32x32x16_bf16 v[80:95], v[28:31], a[92:95], v[80:95]
    buffer_load_dwordx4 v5, s[20:23], s25 offen offset:0 sc0 sc1 lds
    s_waitcnt lgkmcnt(1)
    v_mfma_f32_32x32x16_bf16 v[64:79], v[16:19], a[96:99], v[64:79]
    ds_read_b128 v[24:27], v11 offset:16384
    ds_read_b128 v[28:31], v11 offset:20480
    v_mul_f32 v171, v171, v213
    s_add_u32 m0, s27, 1024
    s_waitcnt lgkmcnt(2)
    v_mfma_f32_32x32x16_bf16 v[80:95], v[20:23], a[96:99], v[80:95]
    buffer_load_dwordx4 v6, s[20:23], s25 offen offset:0 sc0 sc1 lds
    v_mul_f32 v172, v172, v214
    s_waitcnt lgkmcnt(1)
    v_mfma_f32_32x32x16_bf16 v[64:79], v[24:27], a[100:103], v[64:79]
    ds_read_b128 v[16:19], v12 offset:16384
    ds_read_b128 v[20:23], v12 offset:20480
    v_mul_f32 v173, v173, v215
    s_add_u32 m0, s27, 8064
    s_waitcnt lgkmcnt(2)
    v_mfma_f32_32x32x16_bf16 v[80:95], v[28:31], a[100:103], v[80:95]
    buffer_load_dwordx4 v5, s[20:23], s25 offen offset:128 sc0 sc1 lds
    ds_read_b64_tr_b16 v[202:203], v131 offset:2048
    s_waitcnt lgkmcnt(2)
    v_mfma_f32_32x32x16_bf16 v[64:79], v[16:19], a[104:107], v[64:79]
    ds_read_b128 v[24:27], v13 offset:16384
    ds_read_b128 v[28:31], v13 offset:20480
    v_xor_b32 v132, 16, v133
    s_add_u32 m0, s27, 9088
    s_waitcnt lgkmcnt(3)
    v_mfma_f32_32x32x16_bf16 v[80:95], v[20:23], a[104:107], v[80:95]
    buffer_load_dwordx4 v6, s[20:23], s25 offen offset:128 sc0 sc1 lds
    ds_read_b64 v[206:207], v132
    s_waitcnt lgkmcnt(2)
    v_mfma_f32_32x32x16_bf16 v[64:79], v[24:27], a[108:111], v[64:79]
    ds_read_b128 v[16:19], v10 offset:24576
    ds_read_b128 v[20:23], v10 offset:28672
    s_waitcnt lgkmcnt(2)
    v_lshlrev_b32 v208, 16, v206
    v_mfma_f32_32x32x16_bf16 v[80:95], v[28:31], a[108:111], v[80:95]
    v_lshlrev_b32 v212, 16, v202
    v_and_b32 v209, s47, v206
    v_and_b32 v213, s47, v202
    s_waitcnt lgkmcnt(1)
    v_mfma_f32_32x32x16_bf16 v[64:79], v[16:19], a[112:115], v[64:79]
    ds_read_b128 v[24:27], v11 offset:24576
    ds_read_b128 v[28:31], v11 offset:28672
    v_lshlrev_b32 v210, 16, v207
    s_waitcnt lgkmcnt(2)
    v_mfma_f32_32x32x16_bf16 v[80:95], v[20:23], a[112:115], v[80:95]
    v_lshlrev_b32 v214, 16, v203
    v_and_b32 v211, s47, v207
    v_and_b32 v215, s47, v203
    s_waitcnt lgkmcnt(1)
    v_mfma_f32_32x32x16_bf16 v[64:79], v[24:27], a[116:119], v[64:79]
    ds_read_b128 v[16:19], v12 offset:24576
    ds_read_b128 v[20:23], v12 offset:28672
    v_mul_f32 v174, v174, v208
    s_waitcnt lgkmcnt(2)
    v_mfma_f32_32x32x16_bf16 v[80:95], v[28:31], a[116:119], v[80:95]
    v_mul_f32 v175, v175, v209
    v_mul_f32 v176, v176, v210
    v_mul_f32 v177, v177, v211
    s_waitcnt lgkmcnt(1)
    v_mfma_f32_32x32x16_bf16 v[64:79], v[16:19], a[120:123], v[64:79]
    ds_read_b128 v[24:27], v13 offset:24576
    ds_read_b128 v[28:31], v13 offset:28672
    v_fmac_f32 v174, v142, v7
    s_waitcnt lgkmcnt(2)
    v_mfma_f32_32x32x16_bf16 v[80:95], v[20:23], a[120:123], v[80:95]
    v_fmac_f32 v175, v143, v7
    v_fmac_f32 v176, v144, v7
    v_fmac_f32 v177, v145, v7
    s_waitcnt lgkmcnt(0)
    s_waitcnt vmcnt(9)
    s_barrier
    v_mfma_f32_32x32x16_bf16 v[64:79], v[24:27], a[124:127], v[64:79]
    ds_read_b128 v[16:19], v10 offset:32768
    ds_read_b128 v[20:23], v10 offset:36864
    v_mul_f32 v174, v174, v212
    s_add_u32 s25, s29, 1792
    s_add_u32 m0, s27, 16384
    v_mfma_f32_32x32x16_bf16 v[80:95], v[28:31], a[124:127], v[80:95]
    buffer_load_dwordx4 v5, s[20:23], s25 offen offset:0 sc0 sc1 lds
    s_waitcnt lgkmcnt(1)
    v_mfma_f32_32x32x16_bf16 v[64:79], v[16:19], a[128:131], v[64:79]
    ds_read_b128 v[24:27], v11 offset:32768
    ds_read_b128 v[28:31], v11 offset:36864
    v_mul_f32 v175, v175, v213
    s_add_u32 m0, s27, 17408
    s_waitcnt lgkmcnt(2)
    v_mfma_f32_32x32x16_bf16 v[80:95], v[20:23], a[128:131], v[80:95]
    buffer_load_dwordx4 v6, s[20:23], s25 offen offset:0 sc0 sc1 lds
    v_mul_f32 v176, v176, v214
    s_waitcnt lgkmcnt(1)
    v_mfma_f32_32x32x16_bf16 v[64:79], v[24:27], a[132:135], v[64:79]
    ds_read_b128 v[16:19], v12 offset:32768
    ds_read_b128 v[20:23], v12 offset:36864
    v_mul_f32 v177, v177, v215
    s_add_u32 m0, s27, 24448
    s_waitcnt lgkmcnt(2)
    v_mfma_f32_32x32x16_bf16 v[80:95], v[28:31], a[132:135], v[80:95]
    buffer_load_dwordx4 v5, s[20:23], s25 offen offset:128 sc0 sc1 lds
    ds_read_b64_tr_b16 v[14:15], v131 offset:4096
    s_waitcnt lgkmcnt(2)
    v_mfma_f32_32x32x16_bf16 v[64:79], v[16:19], a[136:139], v[64:79]
    ds_read_b128 v[24:27], v13 offset:32768
    ds_read_b128 v[28:31], v13 offset:36864
    v_xor_b32 v132, 32, v133
    s_add_u32 m0, s27, 25472
    s_waitcnt lgkmcnt(3)
    v_mfma_f32_32x32x16_bf16 v[80:95], v[20:23], a[136:139], v[80:95]
    buffer_load_dwordx4 v6, s[20:23], s25 offen offset:128 sc0 sc1 lds
    ds_read_b64 v[204:205], v132
    s_waitcnt lgkmcnt(2)
    v_mfma_f32_32x32x16_bf16 v[64:79], v[24:27], a[140:143], v[64:79]
    ds_read_b128 v[16:19], v10 offset:40960
    ds_read_b128 v[20:23], v10 offset:45056
    s_waitcnt lgkmcnt(2)
    v_lshlrev_b32 v208, 16, v204
    v_mfma_f32_32x32x16_bf16 v[80:95], v[28:31], a[140:143], v[80:95]
    v_lshlrev_b32 v212, 16, v14
    v_and_b32 v209, s47, v204
    v_and_b32 v213, s47, v14
    s_waitcnt lgkmcnt(1)
    v_mfma_f32_32x32x16_bf16 v[64:79], v[16:19], a[144:147], v[64:79]
    ds_read_b128 v[24:27], v11 offset:40960
    ds_read_b128 v[28:31], v11 offset:45056
    v_lshlrev_b32 v210, 16, v205
    s_waitcnt lgkmcnt(2)
    v_mfma_f32_32x32x16_bf16 v[80:95], v[20:23], a[144:147], v[80:95]
    v_lshlrev_b32 v214, 16, v15
    v_and_b32 v211, s47, v205
    v_and_b32 v215, s47, v15
    s_waitcnt lgkmcnt(1)
    v_mfma_f32_32x32x16_bf16 v[64:79], v[24:27], a[148:151], v[64:79]
    ds_read_b128 v[16:19], v12 offset:40960
    ds_read_b128 v[20:23], v12 offset:45056
    v_mul_f32 v178, v178, v208
    s_waitcnt lgkmcnt(2)
    v_mfma_f32_32x32x16_bf16 v[80:95], v[28:31], a[148:151], v[80:95]
    v_mul_f32 v179, v179, v209
    v_mul_f32 v180, v180, v210
    v_mul_f32 v181, v181, v211
    s_waitcnt lgkmcnt(1)
    v_mfma_f32_32x32x16_bf16 v[64:79], v[16:19], a[152:155], v[64:79]
    ds_read_b128 v[24:27], v13 offset:40960
    ds_read_b128 v[28:31], v13 offset:45056
    v_fmac_f32 v178, v146, v7
    s_waitcnt lgkmcnt(2)
    v_mfma_f32_32x32x16_bf16 v[80:95], v[20:23], a[152:155], v[80:95]
    v_fmac_f32 v179, v147, v7
    v_fmac_f32 v180, v148, v7
    v_fmac_f32 v181, v149, v7
    s_waitcnt lgkmcnt(0)
    s_waitcnt vmcnt(8)
    s_barrier
    v_mfma_f32_32x32x16_bf16 v[64:79], v[24:27], a[156:159], v[64:79]
    ds_read_b128 v[16:19], v10 offset:49152
    ds_read_b128 v[20:23], v10 offset:53248
    v_mul_f32 v178, v178, v212
    v_mfma_f32_32x32x16_bf16 v[80:95], v[28:31], a[156:159], v[80:95]
    v_mul_f32 v179, v179, v213
    v_mul_f32 v180, v180, v214
    v_mul_f32 v181, v181, v215
    s_waitcnt lgkmcnt(1)
    v_mfma_f32_32x32x16_bf16 v[64:79], v[16:19], a[160:163], v[64:79]
    ds_read_b128 v[24:27], v11 offset:49152
    ds_read_b128 v[28:31], v11 offset:53248
    ds_read_b64_tr_b16 v[202:203], v131 offset:6144
    s_waitcnt lgkmcnt(3)
    v_mfma_f32_32x32x16_bf16 v[80:95], v[20:23], a[160:163], v[80:95]
    v_xor_b32 v132, 48, v133
    ds_read_b64 v[206:207], v132
    s_waitcnt lgkmcnt(0)
    v_lshlrev_b32 v208, 16, v206
    v_mfma_f32_32x32x16_bf16 v[64:79], v[24:27], a[164:167], v[64:79]
    ds_read_b128 v[16:19], v12 offset:49152
    ds_read_b128 v[20:23], v12 offset:53248
    v_lshlrev_b32 v212, 16, v202
    v_mfma_f32_32x32x16_bf16 v[80:95], v[28:31], a[164:167], v[80:95]
    v_and_b32 v209, s47, v206
    v_and_b32 v213, s47, v202
    v_lshlrev_b32 v210, 16, v207
    s_waitcnt lgkmcnt(1)
    v_mfma_f32_32x32x16_bf16 v[64:79], v[16:19], a[168:171], v[64:79]
    ds_read_b128 v[24:27], v13 offset:49152
    ds_read_b128 v[28:31], v13 offset:53248
    v_lshlrev_b32 v214, 16, v203
    s_waitcnt lgkmcnt(2)
    v_mfma_f32_32x32x16_bf16 v[80:95], v[20:23], a[168:171], v[80:95]
    v_and_b32 v211, s47, v207
    v_and_b32 v215, s47, v203
    v_mul_f32 v182, v182, v208
    s_waitcnt lgkmcnt(1)
    v_mfma_f32_32x32x16_bf16 v[64:79], v[24:27], a[172:175], v[64:79]
    ds_read_b128 v[16:19], v10 offset:57344
    ds_read_b128 v[20:23], v10 offset:61440
    v_mul_f32 v183, v183, v209
    s_waitcnt lgkmcnt(2)
    v_mfma_f32_32x32x16_bf16 v[80:95], v[28:31], a[172:175], v[80:95]
    v_mul_f32 v184, v184, v210
    v_mul_f32 v185, v185, v211
    v_fmac_f32 v182, v150, v7
    s_waitcnt lgkmcnt(1)
    v_mfma_f32_32x32x16_bf16 v[64:79], v[16:19], a[176:179], v[64:79]
    ds_read_b128 v[24:27], v11 offset:57344
    ds_read_b128 v[28:31], v11 offset:61440
    v_fmac_f32 v183, v151, v7
    s_waitcnt lgkmcnt(2)
    v_mfma_f32_32x32x16_bf16 v[80:95], v[20:23], a[176:179], v[80:95]
    v_fmac_f32 v184, v152, v7
    v_fmac_f32 v185, v153, v7
    v_mul_f32 v182, v182, v212
    s_waitcnt lgkmcnt(1)
    v_mfma_f32_32x32x16_bf16 v[64:79], v[24:27], a[180:183], v[64:79]
    ds_read_b128 v[16:19], v12 offset:57344
    ds_read_b128 v[20:23], v12 offset:61440
    v_mul_f32 v183, v183, v213
    s_waitcnt lgkmcnt(2)
    v_mfma_f32_32x32x16_bf16 v[80:95], v[28:31], a[180:183], v[80:95]
    v_mul_f32 v184, v184, v214
    v_mul_f32 v185, v185, v215
    ds_read_b64_tr_b16 v[14:15], v131 offset:8192
    s_waitcnt lgkmcnt(2)
    v_mfma_f32_32x32x16_bf16 v[64:79], v[16:19], a[184:187], v[64:79]
    ds_read_b128 v[24:27], v13 offset:57344
    ds_read_b128 v[28:31], v13 offset:61440
    v_xor_b32 v132, 64, v133
    s_waitcnt lgkmcnt(3)
    v_mfma_f32_32x32x16_bf16 v[80:95], v[20:23], a[184:187], v[80:95]
    ds_read_b64 v[204:205], v132
    s_waitcnt lgkmcnt(0)
    v_lshlrev_b32 v208, 16, v204
    v_lshlrev_b32 v212, 16, v14
    s_waitcnt vmcnt(4)
    s_barrier
    v_mfma_f32_32x32x16_bf16 v[64:79], v[24:27], a[188:191], v[64:79]
    ds_read_b128 v[16:19], v10 offset:0
    ds_read_b128 v[20:23], v10 offset:4096
    v_and_b32 v209, s47, v204
    v_mfma_f32_32x32x16_bf16 v[80:95], v[28:31], a[188:191], v[80:95]
    v_and_b32 v213, s47, v14
    v_lshlrev_b32 v210, 16, v205
    v_lshlrev_b32 v214, 16, v15
    s_waitcnt lgkmcnt(1)
    v_mfma_f32_32x32x16_bf16 v[64:79], v[16:19], a[192:195], v[64:79]
    ds_read_b128 v[24:27], v11 offset:0
    ds_read_b128 v[28:31], v11 offset:4096
    v_and_b32 v211, s47, v205
    s_waitcnt lgkmcnt(2)
    v_mfma_f32_32x32x16_bf16 v[80:95], v[20:23], a[192:195], v[80:95]
    v_and_b32 v215, s47, v15
    v_mul_f32 v186, v186, v208
    v_mul_f32 v187, v187, v209
    s_waitcnt lgkmcnt(1)
    v_mfma_f32_32x32x16_bf16 v[64:79], v[24:27], a[196:199], v[64:79]
    ds_read_b128 v[16:19], v12 offset:0
    ds_read_b128 v[20:23], v12 offset:4096
    v_mul_f32 v188, v188, v210
    s_waitcnt lgkmcnt(2)
    v_mfma_f32_32x32x16_bf16 v[80:95], v[28:31], a[196:199], v[80:95]
    v_mul_f32 v189, v189, v211
    v_fmac_f32 v186, v154, v7
    v_fmac_f32 v187, v155, v7
    s_waitcnt lgkmcnt(1)
    v_mfma_f32_32x32x16_bf16 v[64:79], v[16:19], a[200:203], v[64:79]
    ds_read_b128 v[24:27], v13 offset:0
    ds_read_b128 v[28:31], v13 offset:4096
    v_fmac_f32 v188, v156, v7
    s_waitcnt lgkmcnt(2)
    v_mfma_f32_32x32x16_bf16 v[80:95], v[20:23], a[200:203], v[80:95]
    v_fmac_f32 v189, v157, v7
    v_mul_f32 v186, v186, v212
    v_mul_f32 v187, v187, v213
    s_waitcnt lgkmcnt(1)
    v_mfma_f32_32x32x16_bf16 v[64:79], v[24:27], a[204:207], v[64:79]
    ds_read_b128 v[16:19], v10 offset:8192
    ds_read_b128 v[20:23], v10 offset:12288
    v_mul_f32 v188, v188, v214
    s_waitcnt lgkmcnt(2)
    v_mfma_f32_32x32x16_bf16 v[80:95], v[28:31], a[204:207], v[80:95]
    v_mul_f32 v189, v189, v215
    ds_read_b64_tr_b16 v[202:203], v131 offset:10240
    v_xor_b32 v132, 80, v133
    s_waitcnt lgkmcnt(2)
    v_mfma_f32_32x32x16_bf16 v[64:79], v[16:19], a[208:211], v[64:79]
    ds_read_b128 v[24:27], v11 offset:8192
    ds_read_b128 v[28:31], v11 offset:12288
    ds_read_b64 v[206:207], v132
    s_waitcnt lgkmcnt(4)
    v_mfma_f32_32x32x16_bf16 v[80:95], v[20:23], a[208:211], v[80:95]
    s_waitcnt lgkmcnt(0)
    v_lshlrev_b32 v208, 16, v206
    v_lshlrev_b32 v212, 16, v202
    v_and_b32 v209, s47, v206
    v_mfma_f32_32x32x16_bf16 v[64:79], v[24:27], a[212:215], v[64:79]
    ds_read_b128 v[16:19], v12 offset:8192
    ds_read_b128 v[20:23], v12 offset:12288
    v_and_b32 v213, s47, v202
    v_mfma_f32_32x32x16_bf16 v[80:95], v[28:31], a[212:215], v[80:95]
    v_lshlrev_b32 v210, 16, v207
    v_lshlrev_b32 v214, 16, v203
    v_and_b32 v211, s47, v207
    s_waitcnt lgkmcnt(1)
    v_mfma_f32_32x32x16_bf16 v[64:79], v[16:19], a[216:219], v[64:79]
    ds_read_b128 v[24:27], v13 offset:8192
    ds_read_b128 v[28:31], v13 offset:12288
    v_and_b32 v215, s47, v203
    s_waitcnt lgkmcnt(2)
    v_mfma_f32_32x32x16_bf16 v[80:95], v[20:23], a[216:219], v[80:95]
    v_mul_f32 v190, v190, v208
    v_mul_f32 v191, v191, v209
    v_mul_f32 v192, v192, v210
    s_waitcnt lgkmcnt(0)
    s_waitcnt vmcnt(0)
    s_barrier
    v_mfma_f32_32x32x16_bf16 v[64:79], v[24:27], a[220:223], v[64:79]
    ds_read_b128 v[16:19], v10 offset:16384
    ds_read_b128 v[20:23], v10 offset:20480
    v_mul_f32 v193, v193, v211
    v_mfma_f32_32x32x16_bf16 v[80:95], v[28:31], a[220:223], v[80:95]
    v_fmac_f32 v190, v158, v7
    v_fmac_f32 v191, v159, v7
    v_fmac_f32 v192, v160, v7
    s_waitcnt lgkmcnt(1)
    v_mfma_f32_32x32x16_bf16 v[64:79], v[16:19], a[224:227], v[64:79]
    ds_read_b128 v[24:27], v11 offset:16384
    ds_read_b128 v[28:31], v11 offset:20480
    v_fmac_f32 v193, v161, v7
    s_waitcnt lgkmcnt(2)
    v_mfma_f32_32x32x16_bf16 v[80:95], v[20:23], a[224:227], v[80:95]
    v_mul_f32 v190, v190, v212
    v_mul_f32 v191, v191, v213
    v_mul_f32 v192, v192, v214
    s_waitcnt lgkmcnt(1)
    v_mfma_f32_32x32x16_bf16 v[64:79], v[24:27], a[228:231], v[64:79]
    ds_read_b128 v[16:19], v12 offset:16384
    ds_read_b128 v[20:23], v12 offset:20480
    v_mul_f32 v193, v193, v215
    s_waitcnt lgkmcnt(2)
    v_mfma_f32_32x32x16_bf16 v[80:95], v[28:31], a[228:231], v[80:95]
    ds_read_b64_tr_b16 v[14:15], v131 offset:12288
    v_xor_b32 v132, 96, v133
    ds_read_b64 v[204:205], v132
    s_waitcnt lgkmcnt(3)
    v_mfma_f32_32x32x16_bf16 v[64:79], v[16:19], a[232:235], v[64:79]
    ds_read_b128 v[24:27], v13 offset:16384
    ds_read_b128 v[28:31], v13 offset:20480
    s_waitcnt lgkmcnt(2)
    v_lshlrev_b32 v208, 16, v204
    v_mfma_f32_32x32x16_bf16 v[80:95], v[20:23], a[232:235], v[80:95]
    v_lshlrev_b32 v212, 16, v14
    v_and_b32 v209, s47, v204
    v_and_b32 v213, s47, v14
    s_waitcnt lgkmcnt(1)
    v_mfma_f32_32x32x16_bf16 v[64:79], v[24:27], a[236:239], v[64:79]
    ds_read_b128 v[16:19], v10 offset:24576
    ds_read_b128 v[20:23], v10 offset:28672
    v_lshlrev_b32 v210, 16, v205
    s_waitcnt lgkmcnt(2)
    v_mfma_f32_32x32x16_bf16 v[80:95], v[28:31], a[236:239], v[80:95]
    v_lshlrev_b32 v214, 16, v15
    v_and_b32 v211, s47, v205
    v_and_b32 v215, s47, v15
    s_waitcnt lgkmcnt(1)
    v_mfma_f32_32x32x16_bf16 v[64:79], v[16:19], a[240:243], v[64:79]
    ds_read_b128 v[24:27], v11 offset:24576
    ds_read_b128 v[28:31], v11 offset:28672
    v_mul_f32 v194, v194, v208
    s_waitcnt lgkmcnt(2)
    v_mfma_f32_32x32x16_bf16 v[80:95], v[20:23], a[240:243], v[80:95]
    v_mul_f32 v195, v195, v209
    v_mul_f32 v196, v196, v210
    v_mul_f32 v197, v197, v211
    s_waitcnt lgkmcnt(1)
    v_mfma_f32_32x32x16_bf16 v[64:79], v[24:27], a[244:247], v[64:79]
    ds_read_b128 v[16:19], v12 offset:24576
    ds_read_b128 v[20:23], v12 offset:28672
    v_fmac_f32 v194, v162, v7
    s_waitcnt lgkmcnt(2)
    v_mfma_f32_32x32x16_bf16 v[80:95], v[28:31], a[244:247], v[80:95]
    v_fmac_f32 v195, v163, v7
    v_fmac_f32 v196, v164, v7
    v_fmac_f32 v197, v165, v7
    s_waitcnt lgkmcnt(1)
    v_mfma_f32_32x32x16_bf16 v[64:79], v[16:19], a[248:251], v[64:79]
    ds_read_b128 v[24:27], v13 offset:24576
    ds_read_b128 v[28:31], v13 offset:28672
    v_mul_f32 v194, v194, v212
    s_waitcnt lgkmcnt(2)
    v_mfma_f32_32x32x16_bf16 v[80:95], v[20:23], a[248:251], v[80:95]
    v_mul_f32 v195, v195, v213
    v_mul_f32 v196, v196, v214
    v_mul_f32 v197, v197, v215
    s_waitcnt lgkmcnt(0)
    s_barrier
    v_mfma_f32_32x32x16_bf16 v[64:79], v[24:27], a[252:255], v[64:79]
    ds_read_b64_tr_b16 v[202:203], v131 offset:14336
    v_xor_b32 v132, 112, v133
    ds_read_b64 v[206:207], v132
    v_mfma_f32_32x32x16_bf16 v[80:95], v[28:31], a[252:255], v[80:95]
    s_waitcnt lgkmcnt(0)
    v_lshlrev_b32 v208, 16, v206
    v_lshlrev_b32 v212, 16, v202
    v_and_b32 v209, s47, v206
    v_and_b32 v213, s47, v202
    v_lshlrev_b32 v210, 16, v207
    v_lshlrev_b32 v214, 16, v203
    v_and_b32 v211, s47, v207
    v_and_b32 v215, s47, v203
    v_mul_f32 v198, v198, v208
    v_mul_f32 v199, v199, v209
    v_mul_f32 v200, v200, v210
    v_mul_f32 v201, v201, v211
    v_fmac_f32 v198, v166, v7
    v_fmac_f32 v199, v167, v7
    v_fmac_f32 v200, v168, v7
    v_fmac_f32 v201, v169, v7
    v_mul_f32 v198, v198, v212
    v_mul_f32 v199, v199, v213
    v_mul_f32 v200, v200, v214
    v_mul_f32 v201, v201, v215
    buffer_load_dwordx2 v[8:9], v4, s[72:75], s31 offen sc0 sc1
    s_mov_b32 s57, 0
    s_waitcnt vmcnt(0)
    v_cmp_ne_u64 vcc, s[8:9], v[8:9]
    s_nop 4
    s_cbranch_vccz Lfdone_gate_13
Lfpoll_gate_14:
    buffer_load_dwordx2 v[8:9], v4, s[72:75], s31 offen sc0 sc1
    s_waitcnt vmcnt(0)
    v_cmp_ne_u64 vcc, s[8:9], v[8:9]
    s_nop 4
    s_add_u32 s57, s57, 1
    s_cmp_gt_u32 s57, 20000
    s_cbranch_scc1 Lfdone_gate_13
    s_cbranch_vccnz Lfpoll_gate_14
Lfdone_gate_13:
    s_add_u32 s52, s26, 0
    buffer_load_dwordx4 v[96:99], v2, s[48:51], s52 offen offset:0 sc0 sc1
    buffer_load_dwordx4 v[100:103], v2, s[48:51], s52 offen offset:1024 sc0 sc1
    buffer_load_dwordx4 v[104:107], v2, s[48:51], s52 offen offset:2048 sc0 sc1
    buffer_load_dwordx4 v[108:111], v2, s[48:51], s52 offen offset:3072 sc0 sc1
    s_add_u32 s52, s26, 4096
    buffer_load_dwordx4 v[112:115], v2, s[48:51], s52 offen offset:0 sc0 sc1
    buffer_load_dwordx4 v[116:119], v2, s[48:51], s52 offen offset:1024 sc0 sc1
    buffer_load_dwordx4 v[120:123], v2, s[48:51], s52 offen offset:2048 sc0 sc1
    buffer_load_dwordx4 v[124:127], v2, s[48:51], s52 offen offset:3072 sc0 sc1
    s_waitcnt vmcnt(7)
    v_fmac_f32 v170, v138, v96
    v_fmac_f32 v171, v139, v97
    v_fmac_f32 v172, v140, v98
    v_fmac_f32 v173, v141, v99
    s_waitcnt vmcnt(6)
    v_fmac_f32 v174, v142, v100
    v_fmac_f32 v175, v143, v101
    v_fmac_f32 v176, v144, v102
    v_fmac_f32 v177, v145, v103
    s_waitcnt vmcnt(5)
    v_fmac_f32 v178, v146, v104
    v_fmac_f32 v179, v147, v105
    v_fmac_f32 v180, v148, v106
    v_fmac_f32 v181, v149, v107
    s_waitcnt vmcnt(4)
    v_fmac_f32 v182, v150, v108
    v_fmac_f32 v183, v151, v109
    v_fmac_f32 v184, v152, v110
    v_fmac_f32 v185, v153, v111
    s_waitcnt vmcnt(3)
    v_fmac_f32 v186, v154, v112
    v_fmac_f32 v187, v155, v113
    v_fmac_f32 v188, v156, v114
    v_fmac_f32 v189, v157, v115
    s_waitcnt vmcnt(2)
    v_fmac_f32 v190, v158, v116
    v_fmac_f32 v191, v159, v117
    v_fmac_f32 v192, v160, v118
    v_fmac_f32 v193, v161, v119
    s_waitcnt vmcnt(1)
    v_fmac_f32 v194, v162, v120
    v_fmac_f32 v195, v163, v121
    v_fmac_f32 v196, v164, v122
    v_fmac_f32 v197, v165, v123
    s_waitcnt vmcnt(0)
    v_fmac_f32 v198, v166, v124
    v_fmac_f32 v199, v167, v125
    v_fmac_f32 v200, v168, v126
    v_fmac_f32 v201, v169, v127
    v_fma_f32 v64, v138, v64, v170
    v_fma_f32 v65, v139, v65, v171
    v_fma_f32 v66, v140, v66, v172
    v_fma_f32 v67, v141, v67, v173
    v_fma_f32 v68, v142, v68, v174
    v_fma_f32 v69, v143, v69, v175
    v_fma_f32 v70, v144, v70, v176
    v_fma_f32 v71, v145, v71, v177
    v_fma_f32 v72, v146, v72, v178
    v_fma_f32 v73, v147, v73, v179
    v_fma_f32 v74, v148, v74, v180
    v_fma_f32 v75, v149, v75, v181
    v_fma_f32 v76, v150, v76, v182
    v_fma_f32 v77, v151, v77, v183
    v_fma_f32 v78, v152, v78, v184
    v_fma_f32 v79, v153, v79, v185
    v_fma_f32 v80, v154, v80, v186
    v_fma_f32 v81, v155, v81, v187
    v_fma_f32 v82, v156, v82, v188
    v_fma_f32 v83, v157, v83, v189
    v_fma_f32 v84, v158, v84, v190
    v_fma_f32 v85, v159, v85, v191
    v_fma_f32 v86, v160, v86, v192
    v_fma_f32 v87, v161, v87, v193
    v_fma_f32 v88, v162, v88, v194
    v_fma_f32 v89, v163, v89, v195
    v_fma_f32 v90, v164, v90, v196
    v_fma_f32 v91, v165, v91, v197
    v_fma_f32 v92, v166, v92, v198
    v_fma_f32 v93, v167, v93, v199
    v_fma_f32 v94, v168, v94, v200
    v_fma_f32 v95, v169, v95, v201
    s_add_u32 s3, s55, 0
    buffer_store_dword v64, v136, s[40:43], s3 offen
    s_add_u32 s3, s55, 4096
    buffer_store_dword v65, v136, s[40:43], s3 offen
    s_add_u32 s3, s55, 8192
    buffer_store_dword v66, v136, s[40:43], s3 offen
    s_add_u32 s3, s55, 12288
    buffer_store_dword v67, v136, s[40:43], s3 offen
    s_add_u32 s3, s55, 32768
    buffer_store_dword v68, v136, s[40:43], s3 offen
    s_add_u32 s3, s55, 36864
    buffer_store_dword v69, v136, s[40:43], s3 offen
    s_add_u32 s3, s55, 40960
    buffer_store_dword v70, v136, s[40:43], s3 offen
    s_add_u32 s3, s55, 45056
    buffer_store_dword v71, v136, s[40:43], s3 offen
    s_add_u32 s3, s55, 65536
    buffer_store_dword v72, v136, s[40:43], s3 offen
    s_add_u32 s3, s55, 69632
    buffer_store_dword v73, v136, s[40:43], s3 offen
    s_add_u32 s3, s55, 73728
    buffer_store_dword v74, v136, s[40:43], s3 offen
    s_add_u32 s3, s55, 77824
    buffer_store_dword v75, v136, s[40:43], s3 offen
    s_add_u32 s3, s55, 98304
    buffer_store_dword v76, v136, s[40:43], s3 offen
    s_add_u32 s3, s55, 102400
    buffer_store_dword v77, v136, s[40:43], s3 offen
    s_add_u32 s3, s55, 106496
    buffer_store_dword v78, v136, s[40:43], s3 offen
    s_add_u32 s3, s55, 110592
    buffer_store_dword v79, v136, s[40:43], s3 offen
    s_add_u32 s3, s55, 131072
    buffer_store_dword v80, v136, s[40:43], s3 offen
    s_add_u32 s3, s55, 135168
    buffer_store_dword v81, v136, s[40:43], s3 offen
    s_add_u32 s3, s55, 139264
    buffer_store_dword v82, v136, s[40:43], s3 offen
    s_add_u32 s3, s55, 143360
    buffer_store_dword v83, v136, s[40:43], s3 offen
    s_add_u32 s3, s55, 163840
    buffer_store_dword v84, v136, s[40:43], s3 offen
    s_add_u32 s3, s55, 167936
    buffer_store_dword v85, v136, s[40:43], s3 offen
    s_add_u32 s3, s55, 172032
    buffer_store_dword v86, v136, s[40:43], s3 offen
    s_add_u32 s3, s55, 176128
    buffer_store_dword v87, v136, s[40:43], s3 offen
    s_add_u32 s3, s55, 196608
    buffer_store_dword v88, v136, s[40:43], s3 offen
    s_add_u32 s3, s55, 200704
    buffer_store_dword v89, v136, s[40:43], s3 offen
    s_add_u32 s3, s55, 204800
    buffer_store_dword v90, v136, s[40:43], s3 offen
    s_add_u32 s3, s55, 208896
    buffer_store_dword v91, v136, s[40:43], s3 offen
    s_add_u32 s3, s55, 229376
    buffer_store_dword v92, v136, s[40:43], s3 offen
    s_add_u32 s3, s55, 233472
    buffer_store_dword v93, v136, s[40:43], s3 offen
    s_add_u32 s3, s55, 237568
    buffer_store_dword v94, v136, s[40:43], s3 offen
    s_add_u32 s3, s55, 241664
    buffer_store_dword v95, v136, s[40:43], s3 offen
Lend_gated_mix__ssm_conv_s5__ssm_conv_h3__prompt_kernel:
    s_endpgm

.section .rodata,"a"
.p2align 6
.amdhsa_kernel gated_mix__ssm_conv_s5__ssm_conv_h3__prompt_kernel
  .amdhsa_next_free_vgpr 512
  .amdhsa_next_free_sgpr 77
  .amdhsa_accum_offset 256
  .amdhsa_group_segment_fixed_size 0
  .amdhsa_kernarg_size 152
  .amdhsa_user_sgpr_count 2
  .amdhsa_user_sgpr_kernarg_segment_ptr 1
  .amdhsa_system_sgpr_workgroup_id_x 1
  .amdhsa_float_denorm_mode_32 3
.end_amdhsa_kernel
```

```asm
; @launch grid=(256,1,1) block=(256,1,1) lds=163840
.amdgcn_target "amdgcn-amd-amdhsa--gfx950"
.text
.globl gated_mix__ssm_conv_s5__ssm_conv_h3__prompt_kernel
.p2align 8
.type gated_mix__ssm_conv_s5__ssm_conv_h3__prompt_kernel,@function
gated_mix__ssm_conv_s5__ssm_conv_h3__prompt_kernel:
    s_cmp_ge_u32 s2, 256
    s_cbranch_scc1 Lend_gated_mix__ssm_conv_s5__ssm_conv_h3__prompt_kernel
    s_load_dwordx16 s[4:19], s[0:1], 0
    s_load_dwordx16 s[20:35], s[0:1], 64
    s_load_dwordx4 s[36:39], s[0:1], 128
    s_load_dwordx2 s[40:41], s[0:1], 144
    s_waitcnt lgkmcnt(0)
    s_memrealtime s[22:23]
    v_lshrrev_b32 v1, 6, v0
    s_nop 0
    v_readfirstlane_b32 s42, v1
    v_and_b32 v1, 63, v0
    s_and_b32 s45, s2, 7
    s_lshr_b32 s43, s45, 1
    s_lshl_b32 s43, s43, 2
    s_and_b32 s44, s45, 1
    s_lshl_b32 s44, s44, 3
    s_lshr_b32 s45, s2, 3
    s_and_b32 s3, s45, 3
    s_add_u32 s43, s43, s3
    s_lshr_b32 s45, s45, 2
    s_add_u32 s44, s44, s45
    v_mov_b32 v4, 0
    v_mov_b32 v5, 0
    v_mov_b32 v6, 0
    v_mov_b32 v7, 0
    v_lshlrev_b32 v2, 4, v0
    v_add_u32 v2, 147456, v2
    ds_write_b128 v2, v[4:7]
    v_lshlrev_b32 v2, 2, v0
    v_add_u32 v2, 151552, v2
    ds_write_b32 v2, v4
    v_lshrrev_b32 v3, 4, v1
    v_and_b32 v16, 7, v1
    v_xor_b32 v16, v16, v3
    v_lshlrev_b32 v16, 4, v16
    v_lshrrev_b32 v3, 3, v1
    v_lshl_add_u32 v12, v3, 11, v16
    v_and_b32 v3, 32, v1
    v_lshl_add_u32 v8, v3, 11, v16
    v_and_b32 v3, 8, v1
    v_lshl_add_u32 v8, v3, 12, v8
    v_and_b32 v3, 16, v1
    v_lshl_add_u32 v8, v3, 7, v8
    v_xor_b32 v3, 64, v8
    v_xor_b32 v16, 64, v12
    v_add_u32 v9, 4096, v3
    v_add_u32 v10, 8192, v8
    v_add_u32 v11, 12288, v3
    v_add_u32 v13, 16384, v16
    v_add_u32 v14, 32768, v12
    v_add_u32 v15, 49152, v16
    s_lshr_b32 s48, s42, 1
    s_lshl_b32 s45, s43, 7
    s_lshl_b32 s3, s48, 6
    s_add_u32 s45, s45, s3
    s_and_b32 s3, s42, 1
    s_lshl_b32 s3, s3, 3
    s_add_u32 s45, s45, s3
    s_lshl_b32 s45, s45, 11
    s_lshl_b32 s46, s44, 6
    s_lshl_b32 s3, s48, 5
    s_add_u32 s46, s46, s3
    s_lshl_b32 s46, s46, 11
    s_lshl_b32 s47, s42, 12
    v_bfe_u32 v16, v1, 3, 2
    v_lshrrev_b32 v17, 5, v1
    v_lshlrev_b32 v17, 2, v17
    v_lshl_add_u32 v16, v16, 3, v17
    v_and_b32 v17, 7, v1
    v_lshlrev_b32 v17, 4, v17
    v_lshl_add_u32 v3, v16, 11, v17
    s_lshl_b32 s48, s43, 7
    s_lshl_b32 s3, s42, 5
    s_add_u32 s48, s48, s3
    s_lshl_b32 s48, s48, 11
    s_lshl_b32 s3, s44, 7
    s_add_u32 s48, s48, s3
    v_add_u32 v3, s48, v3
    v_subrev_u32 v16, 6144, v3
    v_min_u32 v16, 0x7fff0000, v16
    v_subrev_u32 v20, 4096, v3
    v_min_u32 v20, 0x7fff0000, v20
    v_subrev_u32 v24, 2048, v3
    v_min_u32 v24, 0x7fff0000, v24
    s_mov_b32 s48, 4096
    s_lshl_b32 s49, s44, 9
    v_lshlrev_b32 v60, 4, v1
    s_mov_b32 s52, s4
    s_mov_b32 s53, s5
    s_mov_b32 s54, 4194304
    s_mov_b32 s55, 131072
    s_and_b32 s3, s42, 1
    s_cmp_eq_u32 s3, 0
    s_cselect_b32 s56, s10, s12
    s_cselect_b32 s57, s11, s13
    s_mov_b32 s58, 2097152
    s_mov_b32 s59, 131072
    s_waitcnt lgkmcnt(0)
    s_add_u32 m0, s47, 0
    s_nop 0
    buffer_load_dwordx4 v8, s[52:55], s45 offen  lds
    s_add_u32 m0, s47, 1024
    s_nop 0
    buffer_load_dwordx4 v9, s[52:55], s45 offen  lds
    s_add_u32 m0, s47, 2048
    s_nop 0
    buffer_load_dwordx4 v10, s[52:55], s45 offen  lds
    s_add_u32 m0, s47, 3072
    s_nop 0
    buffer_load_dwordx4 v11, s[52:55], s45 offen  lds
    s_add_u32 m0, s47, 16384
    s_nop 0
    buffer_load_dwordx4 v12, s[56:59], s46 offen  lds
    s_add_u32 m0, s47, 17408
    s_nop 0
    buffer_load_dwordx4 v13, s[56:59], s46 offen  lds
    s_add_u32 m0, s47, 18432
    s_nop 0
    buffer_load_dwordx4 v14, s[56:59], s46 offen  lds
    s_add_u32 m0, s47, 19456
    s_nop 0
    buffer_load_dwordx4 v15, s[56:59], s46 offen  lds
    s_mov_b32 s60, s28
    s_mov_b32 s61, s29
    s_mov_b32 s62, 8192
    s_mov_b32 s63, 131072
    s_mov_b32 s64, s24
    s_mov_b32 s65, s25
    s_mov_b32 s66, 4194304
    s_mov_b32 s67, 131072
    s_mov_b32 s68, s26
    s_mov_b32 s69, s27
    s_mov_b32 s70, 4194304
    s_mov_b32 s71, 131072
    s_lshl_b32 s3, s42, 10
    s_add_u32 m0, s3, 156672
    s_nop 0
    buffer_load_dwordx4 v60, s[60:63], s49 offen lds
    buffer_load_dwordx4 v[16:19], v16, s[64:67], 0 offen
    buffer_load_dwordx4 v[20:23], v20, s[64:67], 0 offen
    buffer_load_dwordx4 v[24:27], v24, s[64:67], 0 offen
    buffer_load_dwordx4 v[28:31], v3, s[64:67], 0 offen offset:0
    buffer_load_dwordx4 v[32:35], v3, s[64:67], 0 offen offset:2048
    buffer_load_dwordx4 v[36:39], v3, s[64:67], s48 offen offset:0
    buffer_load_dwordx4 v[40:43], v3, s[64:67], s48 offen offset:2048
    buffer_load_dwordx4 v[44:47], v3, s[68:71], 0 offen offset:0
    buffer_load_dwordx4 v[48:51], v3, s[68:71], 0 offen offset:2048
    buffer_load_dwordx4 v[52:55], v3, s[68:71], s48 offen offset:0
    buffer_load_dwordx4 v[56:59], v3, s[68:71], s48 offen offset:2048
    s_add_u32 s45, s45, 128
    s_add_u32 m0, s47, 32768
    s_nop 0
    buffer_load_dwordx4 v8, s[52:55], s45 offen  lds
    s_add_u32 m0, s47, 33792
    s_nop 0
    buffer_load_dwordx4 v9, s[52:55], s45 offen  lds
    s_add_u32 m0, s47, 34816
    s_nop 0
    buffer_load_dwordx4 v10, s[52:55], s45 offen  lds
    s_add_u32 m0, s47, 35840
    s_nop 0
    buffer_load_dwordx4 v11, s[52:55], s45 offen  lds
    s_add_u32 s46, s46, 128
    s_add_u32 m0, s47, 49152
    s_nop 0
    buffer_load_dwordx4 v12, s[56:59], s46 offen  lds
    s_add_u32 m0, s47, 50176
    s_nop 0
    buffer_load_dwordx4 v13, s[56:59], s46 offen  lds
    s_add_u32 m0, s47, 51200
    s_nop 0
    buffer_load_dwordx4 v14, s[56:59], s46 offen  lds
    s_add_u32 m0, s47, 52224
    s_nop 0
    buffer_load_dwordx4 v15, s[56:59], s46 offen  lds
    s_add_u32 s45, s45, 128
    s_add_u32 m0, s47, 65536
    s_nop 0
    buffer_load_dwordx4 v8, s[52:55], s45 offen  lds
    s_add_u32 m0, s47, 66560
    s_nop 0
    buffer_load_dwordx4 v9, s[52:55], s45 offen  lds
    s_add_u32 m0, s47, 67584
    s_nop 0
    buffer_load_dwordx4 v10, s[52:55], s45 offen  lds
    s_add_u32 m0, s47, 68608
    s_nop 0
    buffer_load_dwordx4 v11, s[52:55], s45 offen  lds
    s_add_u32 s46, s46, 128
    s_add_u32 m0, s47, 81920
    s_nop 0
    buffer_load_dwordx4 v12, s[56:59], s46 offen  lds
    s_add_u32 m0, s47, 82944
    s_nop 0
    buffer_load_dwordx4 v13, s[56:59], s46 offen  lds
    s_add_u32 m0, s47, 83968
    s_nop 0
    buffer_load_dwordx4 v14, s[56:59], s46 offen  lds
    s_add_u32 m0, s47, 84992
    s_nop 0
    buffer_load_dwordx4 v15, s[56:59], s46 offen  lds
    s_add_u32 s45, s45, 128
    s_add_u32 m0, s47, 98304
    s_nop 0
    buffer_load_dwordx4 v8, s[52:55], s45 offen  lds
    s_add_u32 m0, s47, 99328
    s_nop 0
    buffer_load_dwordx4 v9, s[52:55], s45 offen  lds
    s_add_u32 m0, s47, 100352
    s_nop 0
    buffer_load_dwordx4 v10, s[52:55], s45 offen  lds
    s_add_u32 m0, s47, 101376
    s_nop 0
    buffer_load_dwordx4 v11, s[52:55], s45 offen  lds
    s_add_u32 s46, s46, 128
    s_add_u32 m0, s47, 114688
    s_nop 0
    buffer_load_dwordx4 v12, s[56:59], s46 offen  lds
    s_add_u32 m0, s47, 115712
    s_nop 0
    buffer_load_dwordx4 v13, s[56:59], s46 offen  lds
    s_add_u32 m0, s47, 116736
    s_nop 0
    buffer_load_dwordx4 v14, s[56:59], s46 offen  lds
    s_add_u32 m0, s47, 117760
    s_nop 0
    buffer_load_dwordx4 v15, s[56:59], s46 offen  lds
    s_mov_b32 s24, s38
    s_mov_b32 s25, s39
    s_mov_b32 s26, 256
    s_mov_b32 s27, 131072
    s_or_b32 s3, s2, s42
    s_cmp_lg_u32 s3, 0
    s_cbranch_scc1 Lnonce_gate_1
    v_mov_b32 v2, s22
    v_mov_b32 v3, s23
    v_mov_b32 v4, 0
    buffer_store_dwordx2 v[2:3], v4, s[24:27], 0 offen sc0 sc1
    s_nop 1
Lnonce_gate_1:
    s_mov_b32 s4, 0xffff0000
    v_mov_b32 v5, 0
    s_and_b32 s3, s42, 1
    s_lshl_b32 s3, s3, 5
    v_and_b32 v6, 31, v1
    v_add_u32 v6, s3, v6
    s_lshl_b32 s3, s44, 6
    v_add_u32 v7, s3, v6
    v_lshlrev_b32 v7, 1, v7
    s_mov_b32 s48, s6
    s_mov_b32 s49, s7
    s_mov_b32 s50, 2048
    s_mov_b32 s51, 131072
    buffer_load_ushort v61, v7, s[48:51], 0 offen
    s_mov_b32 s48, s8
    s_mov_b32 s49, s9
    s_mov_b32 s50, 2048
    s_mov_b32 s51, 131072
    buffer_load_ushort v62, v7, s[48:51], 0 offen
    s_mov_b32 s8, s18
    s_mov_b32 s9, s19
    s_mov_b32 s10, 2048
    s_mov_b32 s11, 131072
    buffer_load_ushort v63, v7, s[8:11], 0 offen
    v_and_b32 v80, 31, v1
    v_bfe_u32 v81, v80, 1, 3
    v_lshrrev_b32 v82, 5, v1
    v_xor_b32 v81, v81, v82
    v_lshlrev_b32 v81, 4, v81
    v_lshl_add_u32 v81, v80, 7, v81
    s_lshr_b32 s5, s42, 1
    s_lshl_b32 s5, s5, 13
    s_and_b32 s6, s42, 1
    s_lshl_b32 s6, s6, 13
    s_add_u32 s6, s6, 16384
    v_xor_b32 v82, 0, v81
    v_add_u32 v64, s5, v82
    v_add_u32 v72, s6, v82
    v_add_u32 v68, 0x10000, v64
    v_add_u32 v76, 0x10000, v72
    v_xor_b32 v82, 32, v81
    v_add_u32 v65, s5, v82
    v_add_u32 v73, s6, v82
    v_add_u32 v69, 0x10000, v65
    v_add_u32 v77, 0x10000, v73
    v_xor_b32 v82, 64, v81
    v_add_u32 v66, s5, v82
    v_add_u32 v74, s6, v82
    v_add_u32 v70, 0x10000, v66
    v_add_u32 v78, 0x10000, v74
    v_xor_b32 v82, 96, v81
    v_add_u32 v67, s5, v82
    v_add_u32 v75, s6, v82
    v_add_u32 v71, 0x10000, v67
    v_add_u32 v79, 0x10000, v75
    s_add_u32 s8, s40, 8388608
    s_addc_u32 s9, s41, 0
    s_mov_b32 s10, 4194304
    s_mov_b32 s11, 131072
    v_and_b32 v176, 7, v1
    s_lshl_b32 s3, s42, 10
    s_add_u32 s3, s3, 156672
    v_lshl_add_u32 v178, v176, 6, s3
    v_bfe_u32 v176, v1, 2, 1
    v_lshlrev_b32 v176, 3, v176
    v_lshrrev_b32 v177, 5, v1
    v_add_u32 v176, v176, v177
    v_lshlrev_b32 v179, 14, v176
    v_bfe_u32 v176, v1, 3, 2
    v_sub_u32 v176, 3, v176
    v_lshl_add_u32 v179, v176, 6, v179
    v_and_b32 v176, 3, v1
    v_lshl_add_u32 v179, v176, 4, v179
    s_lshl_b32 s5, s44, 18
    s_add_u32 s5, s5, 16128
    s_lshl_b32 s3, s43, 10
    s_sub_u32 s5, s5, s3
    s_lshl_b32 s3, s42, 8
    s_sub_u32 s5, s5, s3
    s_add_u32 s48, s40, 21495808
    s_addc_u32 s49, s41, 0
    s_mov_b32 s50, 40960
    s_mov_b32 s51, 131072
    s_lshl_b32 s6, s44, 4
    s_add_u32 s6, s6, s43
    s_lshl_b32 s6, s6, 2
    s_add_u32 s6, s6, s42
    s_lshl_b32 s6, s6, 3
    s_add_u32 s6, s6, 0
    s_lshl_b32 s7, s44, 2
    s_add_u32 s7, s7, s42
    s_lshl_b32 s7, s7, 4
    s_add_u32 s7, s7, s43
    s_lshl_b32 s7, s7, 3
    s_add_u32 s7, s7, 8192
    s_lshl_b32 s3, s44, 9
    s_add_u32 s3, s3, 0
    v_lshrrev_b32 v203, 1, v60
    v_add_u32 v203, s3, v203
    s_lshl_b32 s12, s44, 6
    s_lshr_b32 s3, s43, 3
    s_lshl_b32 s3, s3, 5
    s_add_u32 s12, s12, s3
    s_lshl_b32 s3, s42, 3
    s_add_u32 s12, s12, s3
    s_and_b32 s3, s43, 7
    s_add_u32 s12, s12, s3
    s_lshl_b32 s13, s12, 12
    s_add_u32 s60, s30, s13
    s_addc_u32 s61, s31, 0
    s_mov_b32 s62, 4096
    s_mov_b32 s63, 131072
    s_mov_b32 s64, s32
    s_mov_b32 s65, s33
    s_mov_b32 s66, 2048
    s_mov_b32 s67, 131072
    s_mul_i32 s18, s42, 16640
    v_lshrrev_b32 v221, 4, v1
    v_and_b32 v222, 3, v1
    v_xor_b32 v222, v222, v221
    v_lshlrev_b32 v222, 4, v222
    v_lshrrev_b32 v221, 2, v1
    v_lshl_add_u32 v220, v221, 6, v222
    s_lshl_b32 s19, s44, 4
    s_add_u32 s19, s19, s43
    s_lshl_b32 s19, s19, 14
    s_lshl_b32 s28, s42, 12
    s_add_u32 s19, s19, s28
    s_add_u32 s28, s28, 131072
    s_mov_b32 s68, s34
    s_mov_b32 s69, s35
    s_mov_b32 s70, 2048
    s_mov_b32 s71, 131072
    s_add_u32 s72, s40, 20971520
    s_addc_u32 s73, s41, 0
    s_mov_b32 s74, 16384
    s_mov_b32 s75, 131072
    s_lshl_b32 s29, s43, 7
    s_lshl_b32 s3, s44, 3
    s_add_u32 s29, s29, s3
    s_lshl_b32 s3, s42, 1
    s_add_u32 s29, s29, s3
    s_lshl_b32 s3, s29, 2
    v_mov_b32 v221, s3
    s_lshl_b32 s29, s29, 11
    s_mov_b32 s32, 8192
    s_waitcnt vmcnt(39)
    s_barrier
    ds_read_b128 v[80:83], v64 offset:0
    ds_read_b128 v[88:91], v72 offset:0
    ds_read_b128 v[92:95], v72 offset:4096
    ds_read_b128 v[84:87], v64 offset:4096
    s_waitcnt lgkmcnt(2)
    v_mfma_f32_32x32x16_bf16 v[112:127], v[80:83], v[88:91], 0
    ds_read_b128 v[96:99], v65 offset:0
    ds_read_b128 v[104:107], v73 offset:0
    s_waitcnt lgkmcnt(3)
    v_mfma_f32_32x32x16_bf16 v[128:143], v[80:83], v[92:95], 0
    ds_read_b128 v[108:111], v73 offset:4096
    ds_read_b128 v[100:103], v65 offset:4096
    s_waitcnt lgkmcnt(4)
    v_mfma_f32_32x32x16_bf16 v[144:159], v[84:87], v[88:91], 0
    v_mfma_f32_32x32x16_bf16 v[160:175], v[84:87], v[92:95], 0
    s_waitcnt lgkmcnt(2)
    v_mfma_f32_32x32x16_bf16 v[112:127], v[96:99], v[104:107], v[112:127]
    ds_read_b128 v[80:83], v66 offset:0
    ds_read_b128 v[88:91], v74 offset:0
    s_waitcnt lgkmcnt(3)
    v_mfma_f32_32x32x16_bf16 v[128:143], v[96:99], v[108:111], v[128:143]
    ds_read_b128 v[92:95], v74 offset:4096
    ds_read_b128 v[84:87], v66 offset:4096
    s_waitcnt lgkmcnt(4)
    v_mfma_f32_32x32x16_bf16 v[144:159], v[100:103], v[104:107], v[144:159]
    v_mfma_f32_32x32x16_bf16 v[160:175], v[100:103], v[108:111], v[160:175]
    s_waitcnt lgkmcnt(2)
    v_mfma_f32_32x32x16_bf16 v[112:127], v[80:83], v[88:91], v[112:127]
    ds_read_b128 v[96:99], v67 offset:0
    ds_read_b128 v[104:107], v75 offset:0
    s_waitcnt lgkmcnt(3)
    v_mfma_f32_32x32x16_bf16 v[128:143], v[80:83], v[92:95], v[128:143]
    ds_read_b128 v[108:111], v75 offset:4096
    ds_read_b128 v[100:103], v67 offset:4096
    s_waitcnt lgkmcnt(4)
    v_mfma_f32_32x32x16_bf16 v[144:159], v[84:87], v[88:91], v[144:159]
    v_mfma_f32_32x32x16_bf16 v[160:175], v[84:87], v[92:95], v[160:175]
    s_waitcnt lgkmcnt(0)
    s_waitcnt vmcnt(19)
    s_barrier
    v_mfma_f32_32x32x16_bf16 v[112:127], v[96:99], v[104:107], v[112:127]
    ds_read_b128 v[80:83], v64 offset:32768
    ds_read_b128 v[88:91], v72 offset:32768
    v_mfma_f32_32x32x16_bf16 v[128:143], v[96:99], v[108:111], v[128:143]
    ds_read_b128 v[92:95], v72 offset:36864
    ds_read_b128 v[84:87], v64 offset:36864
    s_add_u32 s45, s45, 128
    s_add_u32 m0, s47, 0
    v_mfma_f32_32x32x16_bf16 v[144:159], v[100:103], v[104:107], v[144:159]
    buffer_load_dwordx4 v8, s[52:55], s45 offen  lds
    s_add_u32 m0, s47, 1024
    v_mfma_f32_32x32x16_bf16 v[160:175], v[100:103], v[108:111], v[160:175]
    buffer_load_dwordx4 v9, s[52:55], s45 offen  lds
    s_waitcnt lgkmcnt(2)
    v_mfma_f32_32x32x16_bf16 v[112:127], v[80:83], v[88:91], v[112:127]
    ds_read_b128 v[96:99], v65 offset:32768
    ds_read_b128 v[104:107], v73 offset:32768
    ds_read_b128 v[180:183], v178 offset:0
    ds_read_b128 v[184:187], v178 offset:16
    v_lshlrev_b32 v192, 16, v16
    v_lshlrev_b32 v193, 16, v20
    s_waitcnt lgkmcnt(5)
    v_mfma_f32_32x32x16_bf16 v[128:143], v[80:83], v[92:95], v[128:143]
    ds_read_b128 v[108:111], v73 offset:36864
    ds_read_b128 v[100:103], v65 offset:36864
    v_lshlrev_b32 v194, 16, v24
    v_lshlrev_b32 v195, 16, v28
    v_lshlrev_b32 v196, 16, v32
    v_lshlrev_b32 v197, 16, v36
    s_add_u32 m0, s47, 2048
    s_waitcnt lgkmcnt(6)
    v_mfma_f32_32x32x16_bf16 v[144:159], v[84:87], v[88:91], v[144:159]
    buffer_load_dwordx4 v10, s[52:55], s45 offen  lds
    v_lshlrev_b32 v198, 16, v40
    s_waitcnt lgkmcnt(3)
    v_and_b32 v191, s4, v181
    v_lshlrev_b32 v190, 16, v181
    v_and_b32 v189, s4, v180
    v_lshlrev_b32 v188, 16, v180
    s_add_u32 m0, s47, 3072
    v_mfma_f32_32x32x16_bf16 v[160:175], v[84:87], v[92:95], v[160:175]
    buffer_load_dwordx4 v11, s[52:55], s45 offen  lds
    v_mul_f32 v199, v191, v192
    v_mul_f32 v200, v191, v193
    v_mul_f32 v201, v191, v194
    v_mul_f32 v202, v191, v195
    v_fmac_f32 v199, v190, v193
    v_fmac_f32 v200, v190, v194
    v_mfma_f32_32x32x16_bf16 v[112:127], v[96:99], v[104:107], v[112:127]
    ds_read_b128 v[80:83], v66 offset:32768
    ds_read_b128 v[88:91], v74 offset:32768
    v_fmac_f32 v201, v190, v195
    v_fmac_f32 v202, v190, v196
    v_fmac_f32 v199, v189, v194
    v_fmac_f32 v200, v189, v195
    v_fmac_f32 v201, v189, v196
    s_waitcnt lgkmcnt(3)
    v_mfma_f32_32x32x16_bf16 v[128:143], v[96:99], v[108:111], v[128:143]
    ds_read_b128 v[92:95], v74 offset:36864
    ds_read_b128 v[84:87], v66 offset:36864
    v_fmac_f32 v202, v189, v197
    v_fmac_f32 v199, v188, v195
    v_fmac_f32 v200, v188, v196
    s_add_u32 s46, s46, 128
    s_add_u32 m0, s47, 16384
    s_waitcnt lgkmcnt(4)
    v_mfma_f32_32x32x16_bf16 v[144:159], v[100:103], v[104:107], v[144:159]
    buffer_load_dwordx4 v12, s[56:59], s46 offen  lds
    v_fmac_f32 v201, v188, v197
    v_fmac_f32 v202, v188, v198
    v_lshlrev_b32 v192, 16, v44
    v_lshlrev_b32 v193, 16, v48
    v_lshlrev_b32 v194, 16, v52
    s_add_u32 m0, s47, 17408
    v_mfma_f32_32x32x16_bf16 v[160:175], v[100:103], v[108:111], v[160:175]
    buffer_load_dwordx4 v13, s[56:59], s46 offen  lds
    v_lshlrev_b32 v195, 16, v56
    v_mul_f32 v199, v199, v192
    v_mul_f32 v200, v200, v193
    v_mul_f32 v201, v201, v194
    v_mul_f32 v202, v202, v195
    v_cvt_pk_bf16_f32 v206, v202, v201
    s_waitcnt lgkmcnt(2)
    v_mfma_f32_32x32x16_bf16 v[112:127], v[80:83], v[88:91], v[112:127]
    ds_read_b128 v[96:99], v67 offset:32768
    ds_read_b128 v[104:107], v75 offset:32768
    v_cvt_pk_bf16_f32 v207, v200, v199
    v_and_b32 v192, s4, v16
    v_and_b32 v193, s4, v20
    v_and_b32 v194, s4, v24
    v_and_b32 v195, s4, v28
    s_waitcnt lgkmcnt(3)
    v_mfma_f32_32x32x16_bf16 v[128:143], v[80:83], v[92:95], v[128:143]
    ds_read_b128 v[108:111], v75 offset:36864
    ds_read_b128 v[100:103], v67 offset:36864
    v_and_b32 v196, s4, v32
    v_and_b32 v197, s4, v36
    v_and_b32 v198, s4, v40
    v_and_b32 v191, s4, v183
    s_add_u32 m0, s47, 18432
    s_waitcnt lgkmcnt(4)
    v_mfma_f32_32x32x16_bf16 v[144:159], v[84:87], v[88:91], v[144:159]
    buffer_load_dwordx4 v14, s[56:59], s46 offen  lds
    v_lshlrev_b32 v190, 16, v183
    v_and_b32 v189, s4, v182
    v_lshlrev_b32 v188, 16, v182
    v_mul_f32 v199, v191, v192
    v_mul_f32 v200, v191, v193
    s_add_u32 m0, s47, 19456
    v_mfma_f32_32x32x16_bf16 v[160:175], v[84:87], v[92:95], v[160:175]
    buffer_load_dwordx4 v15, s[56:59], s46 offen  lds
    v_mul_f32 v201, v191, v194
    v_mul_f32 v202, v191, v195
    v_fmac_f32 v199, v190, v193
    v_fmac_f32 v200, v190, v194
    v_fmac_f32 v201, v190, v195
    v_fmac_f32 v202, v190, v196
    s_waitcnt lgkmcnt(0)
    s_waitcnt vmcnt(19)
    s_barrier
    v_mfma_f32_32x32x16_bf16 v[112:127], v[96:99], v[104:107], v[112:127]
    ds_read_b128 v[80:83], v68 offset:0
    ds_read_b128 v[88:91], v76 offset:0
    v_fmac_f32 v199, v189, v194
    v_fmac_f32 v200, v189, v195
    v_fmac_f32 v201, v189, v196
    v_fmac_f32 v202, v189, v197
    v_fmac_f32 v199, v188, v195
    v_mfma_f32_32x32x16_bf16 v[128:143], v[96:99], v[108:111], v[128:143]
    ds_read_b128 v[92:95], v76 offset:4096
    ds_read_b128 v[84:87], v68 offset:4096
    v_fmac_f32 v200, v188, v196
    v_fmac_f32 v201, v188, v197
    v_fmac_f32 v202, v188, v198
    s_add_u32 s45, s45, 128
    s_add_u32 m0, s47, 32768
    v_mfma_f32_32x32x16_bf16 v[144:159], v[100:103], v[104:107], v[144:159]
    buffer_load_dwordx4 v8, s[52:55], s45 offen  lds
    v_and_b32 v192, s4, v44
    v_and_b32 v193, s4, v48
    v_and_b32 v194, s4, v52
    v_and_b32 v195, s4, v56
    v_mul_f32 v199, v199, v192
    s_add_u32 m0, s47, 33792
    v_mfma_f32_32x32x16_bf16 v[160:175], v[100:103], v[108:111], v[160:175]
    buffer_load_dwordx4 v9, s[52:55], s45 offen  lds
    v_mul_f32 v200, v200, v193
    v_mul_f32 v201, v201, v194
    v_mul_f32 v202, v202, v195
    v_cvt_pk_bf16_f32 v204, v202, v201
    v_cvt_pk_bf16_f32 v205, v200, v199
    ds_read_b128 v[180:183], v178 offset:32
    s_waitcnt lgkmcnt(3)
    v_mfma_f32_32x32x16_bf16 v[112:127], v[80:83], v[88:91], v[112:127]
    ds_read_b128 v[96:99], v69 offset:0
    ds_read_b128 v[104:107], v77 offset:0
    v_lshlrev_b32 v192, 16, v17
    v_lshlrev_b32 v193, 16, v21
    v_permlane32_swap_b32 v206, v204
    v_permlane32_swap_b32 v207, v205
    v_lshlrev_b32 v194, 16, v25
    s_waitcnt lgkmcnt(4)
    v_mfma_f32_32x32x16_bf16 v[128:143], v[80:83], v[92:95], v[128:143]
    ds_read_b128 v[108:111], v77 offset:4096
    ds_read_b128 v[100:103], v69 offset:4096
    v_lshlrev_b32 v195, 16, v29
    v_lshlrev_b32 v196, 16, v33
    v_lshlrev_b32 v197, 16, v37
    v_lshlrev_b32 v198, 16, v41
    s_add_u32 m0, s47, 34816
    s_waitcnt lgkmcnt(5)
    v_mfma_f32_32x32x16_bf16 v[144:159], v[84:87], v[88:91], v[144:159]
    buffer_load_dwordx4 v10, s[52:55], s45 offen  lds
    v_and_b32 v191, s4, v185
    v_lshlrev_b32 v190, 16, v185
    v_and_b32 v189, s4, v184
    v_lshlrev_b32 v188, 16, v184
    v_mul_f32 v199, v191, v192
    s_add_u32 m0, s47, 35840
    v_mfma_f32_32x32x16_bf16 v[160:175], v[84:87], v[92:95], v[160:175]
    buffer_load_dwordx4 v11, s[52:55], s45 offen  lds
    v_mul_f32 v200, v191, v193
    v_mul_f32 v201, v191, v194
    v_mul_f32 v202, v191, v195
    v_fmac_f32 v199, v190, v193
    v_fmac_f32 v200, v190, v194
    v_fmac_f32 v201, v190, v195
    s_waitcnt lgkmcnt(2)
    v_mfma_f32_32x32x16_bf16 v[112:127], v[96:99], v[104:107], v[112:127]
    ds_read_b128 v[80:83], v70 offset:0
    ds_read_b128 v[88:91], v78 offset:0
    v_fmac_f32 v202, v190, v196
    v_fmac_f32 v199, v189, v194
    v_fmac_f32 v200, v189, v195
    v_fmac_f32 v201, v189, v196
    v_fmac_f32 v202, v189, v197
    s_waitcnt lgkmcnt(3)
    v_mfma_f32_32x32x16_bf16 v[128:143], v[96:99], v[108:111], v[128:143]
    ds_read_b128 v[92:95], v78 offset:4096
    ds_read_b128 v[84:87], v70 offset:4096
    v_fmac_f32 v199, v188, v195
    v_fmac_f32 v200, v188, v196
    v_fmac_f32 v201, v188, v197
    s_add_u32 s46, s46, 128
    s_add_u32 m0, s47, 49152
    s_waitcnt lgkmcnt(4)
    v_mfma_f32_32x32x16_bf16 v[144:159], v[100:103], v[104:107], v[144:159]
    buffer_load_dwordx4 v12, s[56:59], s46 offen  lds
    v_fmac_f32 v202, v188, v198
    v_lshlrev_b32 v192, 16, v45
    v_lshlrev_b32 v193, 16, v49
    v_lshlrev_b32 v194, 16, v53
    v_lshlrev_b32 v195, 16, v57
    s_add_u32 m0, s47, 50176
    v_mfma_f32_32x32x16_bf16 v[160:175], v[100:103], v[108:111], v[160:175]
    buffer_load_dwordx4 v13, s[56:59], s46 offen  lds
    v_mul_f32 v199, v199, v192
    v_mul_f32 v200, v200, v193
    v_mul_f32 v201, v201, v194
    v_mul_f32 v202, v202, v195
    v_cvt_pk_bf16_f32 v210, v202, v201
    v_cvt_pk_bf16_f32 v211, v200, v199
    s_waitcnt lgkmcnt(2)
    v_mfma_f32_32x32x16_bf16 v[112:127], v[80:83], v[88:91], v[112:127]
    ds_read_b128 v[96:99], v71 offset:0
    ds_read_b128 v[104:107], v79 offset:0
    v_and_b32 v192, s4, v17
    v_and_b32 v193, s4, v21
    v_and_b32 v194, s4, v25
    v_and_b32 v195, s4, v29
    v_and_b32 v196, s4, v33
    s_waitcnt lgkmcnt(3)
    v_mfma_f32_32x32x16_bf16 v[128:143], v[80:83], v[92:95], v[128:143]
    ds_read_b128 v[108:111], v79 offset:4096
    ds_read_b128 v[100:103], v71 offset:4096
    v_and_b32 v197, s4, v37
    v_and_b32 v198, s4, v41
    v_and_b32 v191, s4, v187
    v_lshlrev_b32 v190, 16, v187
    s_add_u32 m0, s47, 51200
    s_waitcnt lgkmcnt(4)
    v_mfma_f32_32x32x16_bf16 v[144:159], v[84:87], v[88:91], v[144:159]
    buffer_load_dwordx4 v14, s[56:59], s46 offen  lds
    v_and_b32 v189, s4, v186
    v_lshlrev_b32 v188, 16, v186
    v_mul_f32 v199, v191, v192
    v_mul_f32 v200, v191, v193
    v_mul_f32 v201, v191, v194
    s_add_u32 m0, s47, 52224
    v_mfma_f32_32x32x16_bf16 v[160:175], v[84:87], v[92:95], v[160:175]
    buffer_load_dwordx4 v15, s[56:59], s46 offen  lds
    v_mul_f32 v202, v191, v195
    v_fmac_f32 v199, v190, v193
    v_fmac_f32 v200, v190, v194
    v_fmac_f32 v201, v190, v195
    v_fmac_f32 v202, v190, v196
    v_fmac_f32 v199, v189, v194
    s_waitcnt lgkmcnt(0)
    s_waitcnt vmcnt(19)
    s_barrier
    v_mfma_f32_32x32x16_bf16 v[112:127], v[96:99], v[104:107], v[112:127]
    ds_read_b128 v[80:83], v68 offset:32768
    ds_read_b128 v[88:91], v76 offset:32768
    v_fmac_f32 v200, v189, v195
    v_fmac_f32 v201, v189, v196
    v_fmac_f32 v202, v189, v197
    v_fmac_f32 v199, v188, v195
    v_fmac_f32 v200, v188, v196
    v_mfma_f32_32x32x16_bf16 v[128:143], v[96:99], v[108:111], v[128:143]
    ds_read_b128 v[92:95], v76 offset:36864
    ds_read_b128 v[84:87], v68 offset:36864
    v_fmac_f32 v201, v188, v197
    v_fmac_f32 v202, v188, v198
    v_and_b32 v192, s4, v45
    s_add_u32 s45, s45, 128
    s_add_u32 m0, s47, 65536
    v_mfma_f32_32x32x16_bf16 v[144:159], v[100:103], v[104:107], v[144:159]
    buffer_load_dwordx4 v8, s[52:55], s45 offen  lds
    v_and_b32 v193, s4, v49
    v_and_b32 v194, s4, v53
    v_and_b32 v195, s4, v57
    v_mul_f32 v199, v199, v192
    v_mul_f32 v200, v200, v193
    s_add_u32 m0, s47, 66560
    v_mfma_f32_32x32x16_bf16 v[160:175], v[100:103], v[108:111], v[160:175]
    buffer_load_dwordx4 v9, s[52:55], s45 offen  lds
    v_mul_f32 v201, v201, v194
    v_mul_f32 v202, v202, v195
    v_cvt_pk_bf16_f32 v208, v202, v201
    v_cvt_pk_bf16_f32 v209, v200, v199
    ds_read_b128 v[184:187], v178 offset:48
    v_lshlrev_b32 v192, 16, v18
    s_waitcnt lgkmcnt(3)
    v_mfma_f32_32x32x16_bf16 v[112:127], v[80:83], v[88:91], v[112:127]
    ds_read_b128 v[96:99], v69 offset:32768
    ds_read_b128 v[104:107], v77 offset:32768
    v_lshlrev_b32 v193, 16, v22
    v_permlane32_swap_b32 v210, v208
    v_permlane32_swap_b32 v211, v209
    v_lshlrev_b32 v194, 16, v26
    v_lshlrev_b32 v195, 16, v30
    s_waitcnt lgkmcnt(4)
    v_mfma_f32_32x32x16_bf16 v[128:143], v[80:83], v[92:95], v[128:143]
    ds_read_b128 v[108:111], v77 offset:36864
    ds_read_b128 v[100:103], v69 offset:36864
    v_lshlrev_b32 v196, 16, v34
    v_lshlrev_b32 v197, 16, v38
    v_lshlrev_b32 v198, 16, v42
    v_and_b32 v191, s4, v181
    s_add_u32 m0, s47, 67584
    s_waitcnt lgkmcnt(5)
    v_mfma_f32_32x32x16_bf16 v[144:159], v[84:87], v[88:91], v[144:159]
    buffer_load_dwordx4 v10, s[52:55], s45 offen  lds
    v_lshlrev_b32 v190, 16, v181
    v_and_b32 v189, s4, v180
    v_lshlrev_b32 v188, 16, v180
    v_mul_f32 v199, v191, v192
    v_mul_f32 v200, v191, v193
    s_add_u32 m0, s47, 68608
    v_mfma_f32_32x32x16_bf16 v[160:175], v[84:87], v[92:95], v[160:175]
    buffer_load_dwordx4 v11, s[52:55], s45 offen  lds
    v_mul_f32 v201, v191, v194
    v_mul_f32 v202, v191, v195
    v_fmac_f32 v199, v190, v193
    v_fmac_f32 v200, v190, v194
    v_fmac_f32 v201, v190, v195
    v_fmac_f32 v202, v190, v196
    s_waitcnt lgkmcnt(2)
    v_mfma_f32_32x32x16_bf16 v[112:127], v[96:99], v[104:107], v[112:127]
    ds_read_b128 v[80:83], v70 offset:32768
    ds_read_b128 v[88:91], v78 offset:32768
    v_fmac_f32 v199, v189, v194
    v_fmac_f32 v200, v189, v195
    v_fmac_f32 v201, v189, v196
    v_fmac_f32 v202, v189, v197
    v_fmac_f32 v199, v188, v195
    s_waitcnt lgkmcnt(3)
    v_mfma_f32_32x32x16_bf16 v[128:143], v[96:99], v[108:111], v[128:143]
    ds_read_b128 v[92:95], v78 offset:36864
    ds_read_b128 v[84:87], v70 offset:36864
    v_fmac_f32 v200, v188, v196
    v_fmac_f32 v201, v188, v197
    v_fmac_f32 v202, v188, v198
    s_add_u32 s46, s46, 128
    s_add_u32 m0, s47, 81920
    s_waitcnt lgkmcnt(4)
    v_mfma_f32_32x32x16_bf16 v[144:159], v[100:103], v[104:107], v[144:159]
    buffer_load_dwordx4 v12, s[56:59], s46 offen  lds
    v_lshlrev_b32 v192, 16, v46
    v_lshlrev_b32 v193, 16, v50
    v_lshlrev_b32 v194, 16, v54
    v_lshlrev_b32 v195, 16, v58
    v_mul_f32 v199, v199, v192
    s_add_u32 m0, s47, 82944
    v_mfma_f32_32x32x16_bf16 v[160:175], v[100:103], v[108:111], v[160:175]
    buffer_load_dwordx4 v13, s[56:59], s46 offen  lds
    v_mul_f32 v200, v200, v193
    v_mul_f32 v201, v201, v194
    v_mul_f32 v202, v202, v195
    v_cvt_pk_bf16_f32 v214, v202, v201
    v_cvt_pk_bf16_f32 v215, v200, v199
    v_and_b32 v192, s4, v18
    s_waitcnt lgkmcnt(2)
    v_mfma_f32_32x32x16_bf16 v[112:127], v[80:83], v[88:91], v[112:127]
    ds_read_b128 v[96:99], v71 offset:32768
    ds_read_b128 v[104:107], v79 offset:32768
    v_and_b32 v193, s4, v22
    v_and_b32 v194, s4, v26
    v_and_b32 v195, s4, v30
    v_and_b32 v196, s4, v34
    v_and_b32 v197, s4, v38
    s_waitcnt lgkmcnt(3)
    v_mfma_f32_32x32x16_bf16 v[128:143], v[80:83], v[92:95], v[128:143]
    ds_read_b128 v[108:111], v79 offset:36864
    ds_read_b128 v[100:103], v71 offset:36864
    v_and_b32 v198, s4, v42
    v_and_b32 v191, s4, v183
    v_lshlrev_b32 v190, 16, v183
    v_and_b32 v189, s4, v182
    s_add_u32 m0, s47, 83968
    s_waitcnt lgkmcnt(4)
    v_mfma_f32_32x32x16_bf16 v[144:159], v[84:87], v[88:91], v[144:159]
    buffer_load_dwordx4 v14, s[56:59], s46 offen  lds
    v_lshlrev_b32 v188, 16, v182
    v_mul_f32 v199, v191, v192
    v_mul_f32 v200, v191, v193
    v_mul_f32 v201, v191, v194
    v_mul_f32 v202, v191, v195
    s_add_u32 m0, s47, 84992
    v_mfma_f32_32x32x16_bf16 v[160:175], v[84:87], v[92:95], v[160:175]
    buffer_load_dwordx4 v15, s[56:59], s46 offen  lds
    v_fmac_f32 v199, v190, v193
    v_fmac_f32 v200, v190, v194
    v_fmac_f32 v201, v190, v195
    v_fmac_f32 v202, v190, v196
    v_fmac_f32 v199, v189, v194
    v_fmac_f32 v200, v189, v195
    s_waitcnt lgkmcnt(0)
    s_waitcnt vmcnt(16)
    s_barrier
    v_mfma_f32_32x32x16_bf16 v[112:127], v[96:99], v[104:107], v[112:127]
    ds_read_b128 v[80:83], v64 offset:0
    ds_read_b128 v[88:91], v72 offset:0
    v_fmac_f32 v201, v189, v196
    v_fmac_f32 v202, v189, v197
    v_fmac_f32 v199, v188, v195
    v_fmac_f32 v200, v188, v196
    v_fmac_f32 v201, v188, v197
    v_mfma_f32_32x32x16_bf16 v[128:143], v[96:99], v[108:111], v[128:143]
    ds_read_b128 v[92:95], v72 offset:4096
    ds_read_b128 v[84:87], v64 offset:4096
    v_fmac_f32 v202, v188, v198
    v_and_b32 v192, s4, v46
    v_and_b32 v193, s4, v50
    s_add_u32 s45, s45, 128
    s_add_u32 m0, s47, 98304
    v_mfma_f32_32x32x16_bf16 v[144:159], v[100:103], v[104:107], v[144:159]
    buffer_load_dwordx4 v8, s[52:55], s45 offen  lds
    v_and_b32 v194, s4, v54
    v_and_b32 v195, s4, v58
    v_mul_f32 v199, v199, v192
    v_mul_f32 v200, v200, v193
    v_mul_f32 v201, v201, v194
    s_add_u32 m0, s47, 99328
    v_mfma_f32_32x32x16_bf16 v[160:175], v[100:103], v[108:111], v[160:175]
    buffer_load_dwordx4 v9, s[52:55], s45 offen  lds
    v_mul_f32 v202, v202, v195
    v_cvt_pk_bf16_f32 v212, v202, v201
    v_cvt_pk_bf16_f32 v213, v200, v199
    v_lshlrev_b32 v192, 16, v19
    v_lshlrev_b32 v193, 16, v23
    v_permlane32_swap_b32 v214, v212
    s_waitcnt lgkmcnt(2)
    v_mfma_f32_32x32x16_bf16 v[112:127], v[80:83], v[88:91], v[112:127]
    ds_read_b128 v[96:99], v65 offset:0
    ds_read_b128 v[104:107], v73 offset:0
    v_permlane32_swap_b32 v215, v213
    v_lshlrev_b32 v194, 16, v27
    v_lshlrev_b32 v195, 16, v31
    v_lshlrev_b32 v196, 16, v35
    v_lshlrev_b32 v197, 16, v39
    s_waitcnt lgkmcnt(3)
    v_mfma_f32_32x32x16_bf16 v[128:143], v[80:83], v[92:95], v[128:143]
    ds_read_b128 v[108:111], v73 offset:4096
    ds_read_b128 v[100:103], v65 offset:4096
    v_lshlrev_b32 v198, 16, v43
    v_and_b32 v191, s4, v185
    v_lshlrev_b32 v190, 16, v185
    v_and_b32 v189, s4, v184
    s_add_u32 m0, s47, 100352
    s_waitcnt lgkmcnt(4)
    v_mfma_f32_32x32x16_bf16 v[144:159], v[84:87], v[88:91], v[144:159]
    buffer_load_dwordx4 v10, s[52:55], s45 offen  lds
    v_lshlrev_b32 v188, 16, v184
    v_mul_f32 v199, v191, v192
    v_mul_f32 v200, v191, v193
    v_mul_f32 v201, v191, v194
    v_mul_f32 v202, v191, v195
    s_add_u32 m0, s47, 101376
    v_mfma_f32_32x32x16_bf16 v[160:175], v[84:87], v[92:95], v[160:175]
    buffer_load_dwordx4 v11, s[52:55], s45 offen  lds
    v_fmac_f32 v199, v190, v193
    v_fmac_f32 v200, v190, v194
    v_fmac_f32 v201, v190, v195
    v_fmac_f32 v202, v190, v196
    v_fmac_f32 v199, v189, v194
    v_fmac_f32 v200, v189, v195
    s_waitcnt lgkmcnt(2)
    v_mfma_f32_32x32x16_bf16 v[112:127], v[96:99], v[104:107], v[112:127]
    ds_read_b128 v[80:83], v66 offset:0
    ds_read_b128 v[88:91], v74 offset:0
    v_fmac_f32 v201, v189, v196
    v_fmac_f32 v202, v189, v197
    v_fmac_f32 v199, v188, v195
    v_fmac_f32 v200, v188, v196
    v_fmac_f32 v201, v188, v197
    s_waitcnt lgkmcnt(3)
    v_mfma_f32_32x32x16_bf16 v[128:143], v[96:99], v[108:111], v[128:143]
    ds_read_b128 v[92:95], v74 offset:4096
    ds_read_b128 v[84:87], v66 offset:4096
    v_fmac_f32 v202, v188, v198
    v_lshlrev_b32 v192, 16, v47
    v_lshlrev_b32 v193, 16, v51
    s_add_u32 s46, s46, 128
    s_add_u32 m0, s47, 114688
    s_waitcnt lgkmcnt(4)
    v_mfma_f32_32x32x16_bf16 v[144:159], v[100:103], v[104:107], v[144:159]
    buffer_load_dwordx4 v12, s[56:59], s46 offen  lds
    v_lshlrev_b32 v194, 16, v55
    v_lshlrev_b32 v195, 16, v59
    v_mul_f32 v199, v199, v192
    v_mul_f32 v200, v200, v193
    v_mul_f32 v201, v201, v194
    s_add_u32 m0, s47, 115712
    v_mfma_f32_32x32x16_bf16 v[160:175], v[100:103], v[108:111], v[160:175]
    buffer_load_dwordx4 v13, s[56:59], s46 offen  lds
    v_mul_f32 v202, v202, v195
    v_cvt_pk_bf16_f32 v218, v202, v201
    v_cvt_pk_bf16_f32 v219, v200, v199
    v_and_b32 v192, s4, v19
    v_and_b32 v193, s4, v23
    v_and_b32 v194, s4, v27
    s_waitcnt lgkmcnt(2)
    v_mfma_f32_32x32x16_bf16 v[112:127], v[80:83], v[88:91], v[112:127]
    ds_read_b128 v[96:99], v67 offset:0
    ds_read_b128 v[104:107], v75 offset:0
    v_and_b32 v195, s4, v31
    v_and_b32 v196, s4, v35
    v_and_b32 v197, s4, v39
    v_and_b32 v198, s4, v43
    v_and_b32 v191, s4, v187
    s_waitcnt lgkmcnt(3)
    v_mfma_f32_32x32x16_bf16 v[128:143], v[80:83], v[92:95], v[128:143]
    ds_read_b128 v[108:111], v75 offset:4096
    ds_read_b128 v[100:103], v67 offset:4096
    v_lshlrev_b32 v190, 16, v187
    v_and_b32 v189, s4, v186
    v_lshlrev_b32 v188, 16, v186
    v_mul_f32 v199, v191, v192
    s_add_u32 m0, s47, 116736
    s_waitcnt lgkmcnt(4)
    v_mfma_f32_32x32x16_bf16 v[144:159], v[84:87], v[88:91], v[144:159]
    buffer_load_dwordx4 v14, s[56:59], s46 offen  lds
    v_mul_f32 v200, v191, v193
    v_mul_f32 v201, v191, v194
    v_mul_f32 v202, v191, v195
    v_fmac_f32 v199, v190, v193
    v_fmac_f32 v200, v190, v194
    s_add_u32 m0, s47, 117760
    v_mfma_f32_32x32x16_bf16 v[160:175], v[84:87], v[92:95], v[160:175]
    buffer_load_dwordx4 v15, s[56:59], s46 offen  lds
    v_fmac_f32 v201, v190, v195
    v_fmac_f32 v202, v190, v196
    v_fmac_f32 v199, v189, v194
    v_fmac_f32 v200, v189, v195
    v_fmac_f32 v201, v189, v196
    v_fmac_f32 v202, v189, v197
    s_waitcnt lgkmcnt(0)
    s_waitcnt vmcnt(16)
    s_barrier
    v_mfma_f32_32x32x16_bf16 v[112:127], v[96:99], v[104:107], v[112:127]
    ds_read_b128 v[80:83], v64 offset:32768
    ds_read_b128 v[88:91], v72 offset:32768
    v_fmac_f32 v199, v188, v195
    v_fmac_f32 v200, v188, v196
    v_fmac_f32 v201, v188, v197
    v_fmac_f32 v202, v188, v198
    v_and_b32 v192, s4, v47
    v_mfma_f32_32x32x16_bf16 v[128:143], v[96:99], v[108:111], v[128:143]
    ds_read_b128 v[92:95], v72 offset:36864
    ds_read_b128 v[84:87], v64 offset:36864
    v_and_b32 v193, s4, v51
    v_and_b32 v194, s4, v55
    v_and_b32 v195, s4, v59
    s_add_u32 s45, s45, 128
    s_add_u32 m0, s47, 0
    v_mfma_f32_32x32x16_bf16 v[144:159], v[100:103], v[104:107], v[144:159]
    buffer_load_dwordx4 v8, s[52:55], s45 offen  lds
    v_mul_f32 v199, v199, v192
    v_mul_f32 v200, v200, v193
    v_mul_f32 v201, v201, v194
    v_mul_f32 v202, v202, v195
    v_cvt_pk_bf16_f32 v216, v202, v201
    s_add_u32 m0, s47, 1024
    v_mfma_f32_32x32x16_bf16 v[160:175], v[100:103], v[108:111], v[160:175]
    buffer_load_dwordx4 v9, s[52:55], s45 offen  lds
    v_cvt_pk_bf16_f32 v217, v200, v199
    v_permlane32_swap_b32 v218, v216
    s_nop 0
    v_permlane32_swap_b32 v219, v217
    buffer_store_dwordx4 v[204:207], v179, s[8:11], s5 offen sc0 sc1
    s_add_u32 s5, s5, 32768
    buffer_store_dwordx4 v[208:211], v179, s[8:11], s5 offen sc0 sc1
    s_waitcnt lgkmcnt(2)
    v_mfma_f32_32x32x16_bf16 v[112:127], v[80:83], v[88:91], v[112:127]
    ds_read_b128 v[96:99], v65 offset:32768
    ds_read_b128 v[104:107], v73 offset:32768
    s_add_u32 s5, s5, 32768
    buffer_store_dwordx4 v[212:215], v179, s[8:11], s5 offen sc0 sc1
    s_add_u32 s5, s5, 32768
    buffer_store_dwordx4 v[216:219], v179, s[8:11], s5 offen sc0 sc1
    buffer_load_dwordx4 v[32:35], v60, s[68:71], 0 offen offset:0
    s_waitcnt lgkmcnt(3)
    v_mfma_f32_32x32x16_bf16 v[128:143], v[80:83], v[92:95], v[128:143]
    ds_read_b128 v[108:111], v73 offset:36864
    ds_read_b128 v[100:103], v65 offset:36864
    buffer_load_dwordx4 v[36:39], v60, s[68:71], 0 offen offset:1024
    buffer_load_dwordx4 v[16:19], v60, s[52:55], s29 offen offset:0
    buffer_load_dwordx4 v[20:23], v60, s[52:55], s29 offen offset:1024
    buffer_load_dwordx4 v[24:27], v60, s[52:55], s29 offen offset:2048
    s_add_u32 m0, s47, 2048
    s_waitcnt lgkmcnt(4)
    v_mfma_f32_32x32x16_bf16 v[144:159], v[84:87], v[88:91], v[144:159]
    buffer_load_dwordx4 v10, s[52:55], s45 offen  lds
    buffer_load_dwordx4 v[28:31], v60, s[52:55], s29 offen offset:3072
    v_lshlrev_b32 v61, 16, v61
    v_lshlrev_b32 v62, 16, v62
    v_lshlrev_b32 v63, 16, v63
    v_mul_f32 v178, 1069066811, v63
    s_add_u32 m0, s47, 3072
    v_mfma_f32_32x32x16_bf16 v[160:175], v[84:87], v[92:95], v[160:175]
    buffer_load_dwordx4 v11, s[52:55], s45 offen  lds
    v_exp_f32 v178, v178
    s_nop 0
    v_cvt_pk_bf16_f32 v178, v178, v178
    v_lshlrev_b32 v178, 16, v178
    v_mul_f32 v179, v178, v61
    v_mul_f32 v180, v178, v62
    v_mul_f32 v179, 1069066811, v179
    s_waitcnt lgkmcnt(2)
    v_mfma_f32_32x32x16_bf16 v[112:127], v[96:99], v[104:107], v[112:127]
    ds_read_b128 v[80:83], v66 offset:32768
    ds_read_b128 v[88:91], v74 offset:32768
    v_exp_f32 v179, v179
    v_mul_f32 v180, 1042479491, v180
    v_fract_f32 v180, v180
    v_cos_f32 v181, v180
    v_sin_f32 v182, v180
    s_waitcnt lgkmcnt(3)
    v_mfma_f32_32x32x16_bf16 v[128:143], v[96:99], v[108:111], v[128:143]
    ds_read_b128 v[92:95], v74 offset:36864
    ds_read_b128 v[84:87], v66 offset:36864
    v_mul_f32 v48, v179, v181
    v_mul_f32 v49, v179, v182
    v_add_f32 v178, -1.0, v48
    s_add_u32 s46, s46, 128
    s_add_u32 m0, s47, 16384
    s_waitcnt lgkmcnt(4)
    v_mfma_f32_32x32x16_bf16 v[144:159], v[100:103], v[104:107], v[144:159]
    buffer_load_dwordx4 v12, s[56:59], s46 offen  lds
    v_mul_f32 v179, v61, v61
    v_fmac_f32 v179, v62, v62
    v_rcp_f32 v179, v179
    s_nop 0
    v_add_f32 v179, v179, v179
    v_mul_f32 v180, v178, v61
    s_add_u32 m0, s47, 17408
    v_mfma_f32_32x32x16_bf16 v[160:175], v[100:103], v[108:111], v[160:175]
    buffer_load_dwordx4 v13, s[56:59], s46 offen  lds
    v_fmac_f32 v180, v49, v62
    v_mul_f32 v181, v49, v61
    v_fma_f32 v181, -v178, v62, v181
    v_mul_f32 v50, v180, v179
    v_mul_f32 v51, v181, v179
    v_mul_f32 v178, v49, v49
    s_waitcnt lgkmcnt(2)
    v_mfma_f32_32x32x16_bf16 v[112:127], v[80:83], v[88:91], v[112:127]
    ds_read_b128 v[96:99], v67 offset:32768
    ds_read_b128 v[104:107], v75 offset:32768
    v_fma_f32 v178, v48, v48, -v178
    v_mul_f32 v179, v48, v49
    v_add_f32 v179, v179, v179
    v_mul_f32 v180, v179, v179
    v_fma_f32 v180, v178, v178, -v180
    s_waitcnt lgkmcnt(3)
    v_mfma_f32_32x32x16_bf16 v[128:143], v[80:83], v[92:95], v[128:143]
    ds_read_b128 v[108:111], v75 offset:36864
    ds_read_b128 v[100:103], v67 offset:36864
    v_mul_f32 v181, v178, v179
    v_add_f32 v181, v181, v181
    v_mul_f32 v178, v181, v181
    v_fma_f32 v178, v180, v180, -v178
    s_add_u32 m0, s47, 18432
    s_waitcnt lgkmcnt(4)
    v_mfma_f32_32x32x16_bf16 v[144:159], v[84:87], v[88:91], v[144:159]
    buffer_load_dwordx4 v14, s[56:59], s46 offen  lds
    v_mul_f32 v179, v180, v181
    v_add_f32 v179, v179, v179
    v_mul_f32 v52, v179, v179
    v_fma_f32 v52, v178, v178, -v52
    v_mul_f32 v53, v178, v179
    s_add_u32 m0, s47, 19456
    v_mfma_f32_32x32x16_bf16 v[160:175], v[84:87], v[92:95], v[160:175]
    buffer_load_dwordx4 v15, s[56:59], s46 offen  lds
    v_add_f32 v53, v53, v53
    v_mul_f32 v178, v53, v53
    v_fma_f32 v178, v52, v52, -v178
    v_mul_f32 v179, v52, v53
    v_add_f32 v179, v179, v179
    v_mul_f32 v180, v179, v179
    s_waitcnt lgkmcnt(0)
    s_waitcnt vmcnt(26)
    s_barrier
    v_mfma_f32_32x32x16_bf16 v[112:127], v[96:99], v[104:107], v[112:127]
    ds_read_b128 v[80:83], v68 offset:0
    ds_read_b128 v[88:91], v76 offset:0
    v_fma_f32 v180, v178, v178, -v180
    v_mul_f32 v181, v178, v179
    v_add_f32 v181, v181, v181
    v_mul_f32 v54, v181, v181
    v_fma_f32 v54, v180, v180, -v54
    v_mfma_f32_32x32x16_bf16 v[128:143], v[96:99], v[108:111], v[128:143]
    ds_read_b128 v[92:95], v76 offset:4096
    ds_read_b128 v[84:87], v68 offset:4096
    v_mul_f32 v55, v180, v181
    v_add_f32 v55, v55, v55
    s_mov_b32 s34, 0
    s_add_u32 s45, s45, 128
    s_add_u32 m0, s47, 32768
    v_mfma_f32_32x32x16_bf16 v[144:159], v[100:103], v[104:107], v[144:159]
    buffer_load_dwordx4 v8, s[52:55], s45 offen  lds
    s_mov_b32 s35, -1
    s_lshr_b32 s3, s42, 1
    s_cmp_eq_u32 s3, 1
    s_cselect_b32 s38, -1, 0
    s_cselect_b32 s39, -1, 0
    v_cndmask_b32 v178, 1.0, v178, s[34:35]
    v_cndmask_b32 v179, 0, v179, s[34:35]
    s_add_u32 m0, s47, 33792
    v_mfma_f32_32x32x16_bf16 v[160:175], v[100:103], v[108:111], v[160:175]
    buffer_load_dwordx4 v9, s[52:55], s45 offen  lds
    v_cndmask_b32 v180, 1.0, v180, s[38:39]
    v_cndmask_b32 v181, 0, v181, s[38:39]
    v_mul_f32 v182, v179, v181
    v_fma_f32 v182, v178, v180, -v182
    v_mul_f32 v183, v178, v181
    v_fmac_f32 v183, v179, v180
    s_waitcnt lgkmcnt(2)
    v_mfma_f32_32x32x16_bf16 v[112:127], v[80:83], v[88:91], v[112:127]
    ds_read_b128 v[96:99], v69 offset:0
    ds_read_b128 v[104:107], v77 offset:0
    v_mul_f32 v178, v183, v53
    v_fma_f32 v178, v182, v52, -v178
    v_mul_f32 v179, v182, v53
    s_waitcnt lgkmcnt(3)
    v_mfma_f32_32x32x16_bf16 v[128:143], v[80:83], v[92:95], v[128:143]
    ds_read_b128 v[108:111], v77 offset:4096
    ds_read_b128 v[100:103], v69 offset:4096
    v_fmac_f32 v179, v183, v52
    v_mov_b32 v56, v182
    s_add_u32 m0, s47, 34816
    s_waitcnt lgkmcnt(4)
    v_mfma_f32_32x32x16_bf16 v[144:159], v[84:87], v[88:91], v[144:159]
    buffer_load_dwordx4 v10, s[52:55], s45 offen  lds
    v_mov_b32 v57, v178
    v_mov_b32 v58, v183
    v_mov_b32 v59, v179
    s_add_u32 m0, s47, 35840
    v_mfma_f32_32x32x16_bf16 v[160:175], v[84:87], v[92:95], v[160:175]
    buffer_load_dwordx4 v11, s[52:55], s45 offen  lds
    v_mov_b32 v4, 0
    buffer_load_dwordx2 v[2:3], v4, s[24:27], 0 offen sc0 sc1
    s_waitcnt lgkmcnt(2)
    v_mfma_f32_32x32x16_bf16 v[112:127], v[96:99], v[104:107], v[112:127]
    ds_read_b128 v[80:83], v70 offset:0
    ds_read_b128 v[88:91], v78 offset:0
    s_waitcnt lgkmcnt(3)
    v_mfma_f32_32x32x16_bf16 v[128:143], v[96:99], v[108:111], v[128:143]
    ds_read_b128 v[92:95], v78 offset:4096
    ds_read_b128 v[84:87], v70 offset:4096
    s_add_u32 s46, s46, 128
    s_add_u32 m0, s47, 49152
    s_waitcnt lgkmcnt(4)
    v_mfma_f32_32x32x16_bf16 v[144:159], v[100:103], v[104:107], v[144:159]
    buffer_load_dwordx4 v12, s[56:59], s46 offen  lds
    s_add_u32 m0, s47, 50176
    v_mfma_f32_32x32x16_bf16 v[160:175], v[100:103], v[108:111], v[160:175]
    buffer_load_dwordx4 v13, s[56:59], s46 offen  lds
    s_waitcnt lgkmcnt(2)
    v_mfma_f32_32x32x16_bf16 v[112:127], v[80:83], v[88:91], v[112:127]
    ds_read_b128 v[96:99], v71 offset:0
    ds_read_b128 v[104:107], v79 offset:0
    s_waitcnt lgkmcnt(3)
    v_mfma_f32_32x32x16_bf16 v[128:143], v[80:83], v[92:95], v[128:143]
    ds_read_b128 v[108:111], v79 offset:4096
    ds_read_b128 v[100:103], v71 offset:4096
    s_add_u32 m0, s47, 51200
    s_waitcnt lgkmcnt(4)
    v_mfma_f32_32x32x16_bf16 v[144:159], v[84:87], v[88:91], v[144:159]
    buffer_load_dwordx4 v14, s[56:59], s46 offen  lds
    s_add_u32 m0, s47, 52224
    v_mfma_f32_32x32x16_bf16 v[160:175], v[84:87], v[92:95], v[160:175]
    buffer_load_dwordx4 v15, s[56:59], s46 offen  lds
    s_waitcnt lgkmcnt(0)
    s_waitcnt vmcnt(27)
    s_barrier
    v_mfma_f32_32x32x16_bf16 v[112:127], v[96:99], v[104:107], v[112:127]
    ds_read_b128 v[80:83], v68 offset:32768
    ds_read_b128 v[88:91], v76 offset:32768
    v_mfma_f32_32x32x16_bf16 v[128:143], v[96:99], v[108:111], v[128:143]
    ds_read_b128 v[92:95], v76 offset:36864
    ds_read_b128 v[84:87], v68 offset:36864
    s_add_u32 s45, s45, 128
    s_add_u32 m0, s47, 65536
    v_mfma_f32_32x32x16_bf16 v[144:159], v[100:103], v[104:107], v[144:159]
    buffer_load_dwordx4 v8, s[52:55], s45 offen  lds
    s_add_u32 m0, s47, 66560
    v_mfma_f32_32x32x16_bf16 v[160:175], v[100:103], v[108:111], v[160:175]
    buffer_load_dwordx4 v9, s[52:55], s45 offen  lds
    s_waitcnt lgkmcnt(2)
    v_mfma_f32_32x32x16_bf16 v[112:127], v[80:83], v[88:91], v[112:127]
    ds_read_b128 v[96:99], v69 offset:32768
    ds_read_b128 v[104:107], v77 offset:32768
    s_waitcnt lgkmcnt(3)
    v_mfma_f32_32x32x16_bf16 v[128:143], v[80:83], v[92:95], v[128:143]
    ds_read_b128 v[108:111], v77 offset:36864
    ds_read_b128 v[100:103], v69 offset:36864
    s_add_u32 m0, s47, 67584
    s_waitcnt lgkmcnt(4)
    v_mfma_f32_32x32x16_bf16 v[144:159], v[84:87], v[88:91], v[144:159]
    buffer_load_dwordx4 v10, s[52:55], s45 offen  lds
    s_add_u32 m0, s47, 68608
    v_mfma_f32_32x32x16_bf16 v[160:175], v[84:87], v[92:95], v[160:175]
    buffer_load_dwordx4 v11, s[52:55], s45 offen  lds
    s_waitcnt lgkmcnt(2)
    v_mfma_f32_32x32x16_bf16 v[112:127], v[96:99], v[104:107], v[112:127]
    ds_read_b128 v[80:83], v70 offset:32768
    ds_read_b128 v[88:91], v78 offset:32768
    s_waitcnt lgkmcnt(3)
    v_mfma_f32_32x32x16_bf16 v[128:143], v[96:99], v[108:111], v[128:143]
    ds_read_b128 v[92:95], v78 offset:36864
    ds_read_b128 v[84:87], v70 offset:36864
    s_add_u32 s46, s46, 128
    s_add_u32 m0, s47, 81920
    s_waitcnt lgkmcnt(4)
    v_mfma_f32_32x32x16_bf16 v[144:159], v[100:103], v[104:107], v[144:159]
    buffer_load_dwordx4 v12, s[56:59], s46 offen  lds
    s_add_u32 m0, s47, 82944
    v_mfma_f32_32x32x16_bf16 v[160:175], v[100:103], v[108:111], v[160:175]
    buffer_load_dwordx4 v13, s[56:59], s46 offen  lds
    s_waitcnt lgkmcnt(2)
    v_mfma_f32_32x32x16_bf16 v[112:127], v[80:83], v[88:91], v[112:127]
    ds_read_b128 v[96:99], v71 offset:32768
    ds_read_b128 v[104:107], v79 offset:32768
    s_waitcnt lgkmcnt(3)
    v_mfma_f32_32x32x16_bf16 v[128:143], v[80:83], v[92:95], v[128:143]
    ds_read_b128 v[108:111], v79 offset:36864
    ds_read_b128 v[100:103], v71 offset:36864
    s_add_u32 m0, s47, 83968
    s_waitcnt lgkmcnt(4)
    v_mfma_f32_32x32x16_bf16 v[144:159], v[84:87], v[88:91], v[144:159]
    buffer_load_dwordx4 v14, s[56:59], s46 offen  lds
    s_add_u32 m0, s47, 84992
    v_mfma_f32_32x32x16_bf16 v[160:175], v[84:87], v[92:95], v[160:175]
    buffer_load_dwordx4 v15, s[56:59], s46 offen  lds
    s_waitcnt lgkmcnt(0)
    s_waitcnt vmcnt(17)
    s_barrier
    v_mfma_f32_32x32x16_bf16 v[112:127], v[96:99], v[104:107], v[112:127]
    ds_read_b128 v[80:83], v64 offset:0
    ds_read_b128 v[88:91], v72 offset:0
    v_mfma_f32_32x32x16_bf16 v[128:143], v[96:99], v[108:111], v[128:143]
    ds_read_b128 v[92:95], v72 offset:4096
    ds_read_b128 v[84:87], v64 offset:4096
    s_add_u32 s45, s45, 128
    s_add_u32 m0, s47, 98304
    v_mfma_f32_32x32x16_bf16 v[144:159], v[100:103], v[104:107], v[144:159]
    buffer_load_dwordx4 v8, s[52:55], s45 offen  lds
    s_add_u32 m0, s47, 99328
    v_mfma_f32_32x32x16_bf16 v[160:175], v[100:103], v[108:111], v[160:175]
    buffer_load_dwordx4 v9, s[52:55], s45 offen  lds
    s_waitcnt lgkmcnt(2)
    v_mfma_f32_32x32x16_bf16 v[112:127], v[80:83], v[88:91], v[112:127]
    ds_read_b128 v[96:99], v65 offset:0
    ds_read_b128 v[104:107], v73 offset:0
    v_lshlrev_b32 v42, 16, v32
    v_and_b32 v43, s4, v32
    v_lshlrev_b32 v44, 16, v16
    s_waitcnt lgkmcnt(3)
    v_mfma_f32_32x32x16_bf16 v[128:143], v[80:83], v[92:95], v[128:143]
    ds_read_b128 v[108:111], v73 offset:4096
    ds_read_b128 v[100:103], v65 offset:4096
    v_and_b32 v45, s4, v16
    v_mul_f32 v40, v42, v44
    s_add_u32 m0, s47, 100352
    s_waitcnt lgkmcnt(4)
    v_mfma_f32_32x32x16_bf16 v[144:159], v[84:87], v[88:91], v[144:159]
    buffer_load_dwordx4 v10, s[52:55], s45 offen  lds
    v_fmac_f32 v40, v43, v45
    v_lshlrev_b32 v44, 16, v24
    v_and_b32 v45, s4, v24
    s_add_u32 m0, s47, 101376
    v_mfma_f32_32x32x16_bf16 v[160:175], v[84:87], v[92:95], v[160:175]
    buffer_load_dwordx4 v11, s[52:55], s45 offen  lds
    v_mul_f32 v41, v42, v44
    v_fmac_f32 v41, v43, v45
    v_lshlrev_b32 v42, 16, v33
    v_and_b32 v43, s4, v33
    s_waitcnt lgkmcnt(2)
    v_mfma_f32_32x32x16_bf16 v[112:127], v[96:99], v[104:107], v[112:127]
    ds_read_b128 v[80:83], v66 offset:0
    ds_read_b128 v[88:91], v74 offset:0
    v_lshlrev_b32 v44, 16, v17
    v_and_b32 v45, s4, v17
    v_fmac_f32 v40, v42, v44
    s_waitcnt lgkmcnt(3)
    v_mfma_f32_32x32x16_bf16 v[128:143], v[96:99], v[108:111], v[128:143]
    ds_read_b128 v[92:95], v74 offset:4096
    ds_read_b128 v[84:87], v66 offset:4096
    v_fmac_f32 v40, v43, v45
    s_add_u32 s46, s46, 128
    s_add_u32 m0, s47, 114688
    s_waitcnt lgkmcnt(4)
    v_mfma_f32_32x32x16_bf16 v[144:159], v[100:103], v[104:107], v[144:159]
    buffer_load_dwordx4 v12, s[56:59], s46 offen  lds
    v_lshlrev_b32 v44, 16, v25
    v_and_b32 v45, s4, v25
    v_fmac_f32 v41, v42, v44
    s_add_u32 m0, s47, 115712
    v_mfma_f32_32x32x16_bf16 v[160:175], v[100:103], v[108:111], v[160:175]
    buffer_load_dwordx4 v13, s[56:59], s46 offen  lds
    v_fmac_f32 v41, v43, v45
    v_lshlrev_b32 v42, 16, v34
    v_and_b32 v43, s4, v34
    v_lshlrev_b32 v44, 16, v18
    s_waitcnt lgkmcnt(2)
    v_mfma_f32_32x32x16_bf16 v[112:127], v[80:83], v[88:91], v[112:127]
    ds_read_b128 v[96:99], v67 offset:0
    ds_read_b128 v[104:107], v75 offset:0
    v_and_b32 v45, s4, v18
    v_fmac_f32 v40, v42, v44
    v_fmac_f32 v40, v43, v45
    s_waitcnt lgkmcnt(3)
    v_mfma_f32_32x32x16_bf16 v[128:143], v[80:83], v[92:95], v[128:143]
    ds_read_b128 v[108:111], v75 offset:4096
    ds_read_b128 v[100:103], v67 offset:4096
    v_lshlrev_b32 v44, 16, v26
    v_and_b32 v45, s4, v26
    s_add_u32 m0, s47, 116736
    s_waitcnt lgkmcnt(4)
    v_mfma_f32_32x32x16_bf16 v[144:159], v[84:87], v[88:91], v[144:159]
    buffer_load_dwordx4 v14, s[56:59], s46 offen  lds
    v_fmac_f32 v41, v42, v44
    v_fmac_f32 v41, v43, v45
    v_lshlrev_b32 v42, 16, v35
    s_add_u32 m0, s47, 117760
    v_mfma_f32_32x32x16_bf16 v[160:175], v[84:87], v[92:95], v[160:175]
    buffer_load_dwordx4 v15, s[56:59], s46 offen  lds
    v_and_b32 v43, s4, v35
    v_lshlrev_b32 v44, 16, v19
    v_and_b32 v45, s4, v19
    v_fmac_f32 v40, v42, v44
    s_waitcnt lgkmcnt(0)
    s_waitcnt vmcnt(16)
    s_barrier
    v_mfma_f32_32x32x16_bf16 v[112:127], v[96:99], v[104:107], v[112:127]
    ds_read_b128 v[80:83], v64 offset:32768
    ds_read_b128 v[88:91], v72 offset:32768
    v_fmac_f32 v40, v43, v45
    v_lshlrev_b32 v44, 16, v27
    v_and_b32 v45, s4, v27
    v_mfma_f32_32x32x16_bf16 v[128:143], v[96:99], v[108:111], v[128:143]
    ds_read_b128 v[92:95], v72 offset:36864
    ds_read_b128 v[84:87], v64 offset:36864
    v_fmac_f32 v41, v42, v44
    s_add_u32 s45, s45, 128
    s_add_u32 m0, s47, 0
    v_mfma_f32_32x32x16_bf16 v[144:159], v[100:103], v[104:107], v[144:159]
    buffer_load_dwordx4 v8, s[52:55], s45 offen  lds
    v_fmac_f32 v41, v43, v45
    v_lshlrev_b32 v42, 16, v36
    v_and_b32 v43, s4, v36
    s_add_u32 m0, s47, 1024
    v_mfma_f32_32x32x16_bf16 v[160:175], v[100:103], v[108:111], v[160:175]
    buffer_load_dwordx4 v9, s[52:55], s45 offen  lds
    v_lshlrev_b32 v44, 16, v20
    v_and_b32 v45, s4, v20
    v_fmac_f32 v40, v42, v44
    v_fmac_f32 v40, v43, v45
    s_waitcnt lgkmcnt(2)
    v_mfma_f32_32x32x16_bf16 v[112:127], v[80:83], v[88:91], v[112:127]
    ds_read_b128 v[96:99], v65 offset:32768
    ds_read_b128 v[104:107], v73 offset:32768
    v_lshlrev_b32 v44, 16, v28
    v_and_b32 v45, s4, v28
    v_fmac_f32 v41, v42, v44
    s_waitcnt lgkmcnt(3)
    v_mfma_f32_32x32x16_bf16 v[128:143], v[80:83], v[92:95], v[128:143]
    ds_read_b128 v[108:111], v73 offset:36864
    ds_read_b128 v[100:103], v65 offset:36864
    v_fmac_f32 v41, v43, v45
    v_lshlrev_b32 v42, 16, v37
    s_add_u32 m0, s47, 2048
    s_waitcnt lgkmcnt(4)
    v_mfma_f32_32x32x16_bf16 v[144:159], v[84:87], v[88:91], v[144:159]
    buffer_load_dwordx4 v10, s[52:55], s45 offen  lds
    v_and_b32 v43, s4, v37
    v_lshlrev_b32 v44, 16, v21
    v_and_b32 v45, s4, v21
    s_add_u32 m0, s47, 3072
    v_mfma_f32_32x32x16_bf16 v[160:175], v[84:87], v[92:95], v[160:175]
    buffer_load_dwordx4 v11, s[52:55], s45 offen  lds
    v_fmac_f32 v40, v42, v44
    v_fmac_f32 v40, v43, v45
    v_lshlrev_b32 v44, 16, v29
    v_and_b32 v45, s4, v29
    s_waitcnt lgkmcnt(2)
    v_mfma_f32_32x32x16_bf16 v[112:127], v[96:99], v[104:107], v[112:127]
    ds_read_b128 v[80:83], v66 offset:32768
    ds_read_b128 v[88:91], v74 offset:32768
    v_fmac_f32 v41, v42, v44
    v_fmac_f32 v41, v43, v45
    v_lshlrev_b32 v42, 16, v38
    s_waitcnt lgkmcnt(3)
    v_mfma_f32_32x32x16_bf16 v[128:143], v[96:99], v[108:111], v[128:143]
    ds_read_b128 v[92:95], v74 offset:36864
    ds_read_b128 v[84:87], v66 offset:36864
    v_and_b32 v43, s4, v38
    s_add_u32 s46, s46, 128
    s_add_u32 m0, s47, 16384
    s_waitcnt lgkmcnt(4)
    v_mfma_f32_32x32x16_bf16 v[144:159], v[100:103], v[104:107], v[144:159]
    buffer_load_dwordx4 v12, s[56:59], s46 offen  lds
    v_lshlrev_b32 v44, 16, v22
    v_and_b32 v45, s4, v22
    v_fmac_f32 v40, v42, v44
    s_add_u32 m0, s47, 17408
    v_mfma_f32_32x32x16_bf16 v[160:175], v[100:103], v[108:111], v[160:175]
    buffer_load_dwordx4 v13, s[56:59], s46 offen  lds
    v_fmac_f32 v40, v43, v45
    v_lshlrev_b32 v44, 16, v30
    v_and_b32 v45, s4, v30
    v_fmac_f32 v41, v42, v44
    s_waitcnt lgkmcnt(2)
    v_mfma_f32_32x32x16_bf16 v[112:127], v[80:83], v[88:91], v[112:127]
    ds_read_b128 v[96:99], v67 offset:32768
    ds_read_b128 v[104:107], v75 offset:32768
    v_fmac_f32 v41, v43, v45
    v_lshlrev_b32 v42, 16, v39
    v_and_b32 v43, s4, v39
    s_waitcnt lgkmcnt(3)
    v_mfma_f32_32x32x16_bf16 v[128:143], v[80:83], v[92:95], v[128:143]
    ds_read_b128 v[108:111], v75 offset:36864
    ds_read_b128 v[100:103], v67 offset:36864
    v_lshlrev_b32 v44, 16, v23
    v_and_b32 v45, s4, v23
    s_add_u32 m0, s47, 18432
    s_waitcnt lgkmcnt(4)
    v_mfma_f32_32x32x16_bf16 v[144:159], v[84:87], v[88:91], v[144:159]
    buffer_load_dwordx4 v14, s[56:59], s46 offen  lds
    v_fmac_f32 v40, v42, v44
    v_fmac_f32 v40, v43, v45
    v_lshlrev_b32 v44, 16, v31
    s_add_u32 m0, s47, 19456
    v_mfma_f32_32x32x16_bf16 v[160:175], v[84:87], v[92:95], v[160:175]
    buffer_load_dwordx4 v15, s[56:59], s46 offen  lds
    v_and_b32 v45, s4, v31
    v_fmac_f32 v41, v42, v44
    v_fmac_f32 v41, v43, v45
    v_add_f32_dpp v40, v40, v40 row_shr:1 row_mask:0xf bank_mask:0xf bound_ctrl:0
    s_waitcnt lgkmcnt(0)
    s_waitcnt vmcnt(16)
    s_barrier
    v_mfma_f32_32x32x16_bf16 v[112:127], v[96:99], v[104:107], v[112:127]
    ds_read_b128 v[80:83], v68 offset:0
    ds_read_b128 v[88:91], v76 offset:0
    v_add_f32_dpp v41, v41, v41 row_shr:1 row_mask:0xf bank_mask:0xf bound_ctrl:0
    v_add_f32_dpp v40, v40, v40 row_shr:2 row_mask:0xf bank_mask:0xf bound_ctrl:0
    s_nop 0
    v_add_f32_dpp v41, v41, v41 row_shr:2 row_mask:0xf bank_mask:0xf bound_ctrl:0
    v_mfma_f32_32x32x16_bf16 v[128:143], v[96:99], v[108:111], v[128:143]
    ds_read_b128 v[92:95], v76 offset:4096
    ds_read_b128 v[84:87], v68 offset:4096
    v_add_f32_dpp v40, v40, v40 row_shr:4 row_mask:0xf bank_mask:0xf bound_ctrl:0
    s_add_u32 s45, s45, 128
    s_add_u32 m0, s47, 32768
    v_mfma_f32_32x32x16_bf16 v[144:159], v[100:103], v[104:107], v[144:159]
    buffer_load_dwordx4 v8, s[52:55], s45 offen  lds
    v_add_f32_dpp v41, v41, v41 row_shr:4 row_mask:0xf bank_mask:0xf bound_ctrl:0
    v_add_f32_dpp v40, v40, v40 row_shr:8 row_mask:0xf bank_mask:0xf bound_ctrl:0
    s_nop 0
    v_add_f32_dpp v41, v41, v41 row_shr:8 row_mask:0xf bank_mask:0xf bound_ctrl:0
    s_add_u32 m0, s47, 33792
    v_mfma_f32_32x32x16_bf16 v[160:175], v[100:103], v[108:111], v[160:175]
    buffer_load_dwordx4 v9, s[52:55], s45 offen  lds
    v_add_f32_dpp v40, v40, v40 row_bcast:15 row_mask:0xa bank_mask:0xf
    v_add_f32_dpp v41, v41, v41 row_bcast:15 row_mask:0xa bank_mask:0xf
    s_nop 0
    v_add_f32_dpp v40, v40, v40 row_bcast:31 row_mask:0xc bank_mask:0xf
    v_add_f32_dpp v41, v41, v41 row_bcast:31 row_mask:0xc bank_mask:0xf
    s_waitcnt lgkmcnt(2)
    v_mfma_f32_32x32x16_bf16 v[112:127], v[80:83], v[88:91], v[112:127]
    ds_read_b128 v[96:99], v69 offset:0
    ds_read_b128 v[104:107], v77 offset:0
    v_cvt_pk_bf16_f32 v42, v40, v41
    v_lshlrev_b32 v40, 16, v42
    v_and_b32 v41, s4, v42
    s_waitcnt lgkmcnt(3)
    v_mfma_f32_32x32x16_bf16 v[128:143], v[80:83], v[92:95], v[128:143]
    ds_read_b128 v[108:111], v77 offset:4096
    ds_read_b128 v[100:103], v69 offset:4096
    v_mul_f32 v40, 0xbfb8aa3b, v40
    v_mul_f32 v41, 0xbfb8aa3b, v41
    s_add_u32 m0, s47, 34816
    s_waitcnt lgkmcnt(4)
    v_mfma_f32_32x32x16_bf16 v[144:159], v[84:87], v[88:91], v[144:159]
    buffer_load_dwordx4 v10, s[52:55], s45 offen  lds
    v_exp_f32 v40, v40
    v_exp_f32 v41, v41
    v_add_f32 v40, 1.0, v40
    s_add_u32 m0, s47, 35840
    v_mfma_f32_32x32x16_bf16 v[160:175], v[84:87], v[92:95], v[160:175]
    buffer_load_dwordx4 v11, s[52:55], s45 offen  lds
    v_add_f32 v41, 1.0, v41
    v_rcp_f32 v40, v40
    v_rcp_f32 v41, v41
    s_nop 0
    v_cvt_pk_bf16_f32 v42, v40, v41
    s_waitcnt lgkmcnt(2)
    v_mfma_f32_32x32x16_bf16 v[112:127], v[96:99], v[104:107], v[112:127]
    ds_read_b128 v[80:83], v70 offset:0
    ds_read_b128 v[88:91], v78 offset:0
    v_lshlrev_b32 v40, 16, v42
    v_and_b32 v41, s4, v42
    v_sub_f32 v46, 1.0, v40
    s_waitcnt lgkmcnt(3)
    v_mfma_f32_32x32x16_bf16 v[128:143], v[96:99], v[108:111], v[128:143]
    ds_read_b128 v[92:95], v78 offset:4096
    ds_read_b128 v[84:87], v70 offset:4096
    v_sub_f32 v47, 1.0, v41
    s_add_u32 s46, s46, 128
    s_add_u32 m0, s47, 49152
    s_waitcnt lgkmcnt(4)
    v_mfma_f32_32x32x16_bf16 v[144:159], v[100:103], v[104:107], v[144:159]
    buffer_load_dwordx4 v12, s[56:59], s46 offen  lds
    v_cvt_pk_bf16_f32 v42, v46, v47
    v_lshlrev_b32 v46, 16, v42
    v_and_b32 v47, s4, v42
    s_add_u32 m0, s47, 50176
    v_mfma_f32_32x32x16_bf16 v[160:175], v[100:103], v[108:111], v[160:175]
    buffer_load_dwordx4 v13, s[56:59], s46 offen  lds
    s_mov_b64 s[30:31], exec
    s_mov_b32 exec_lo, 0
    s_mov_b32 exec_hi, 0x80000000
    buffer_store_dwordx2 v[40:41], v221, s[72:75], 0 offen sc0 sc1
    buffer_store_dwordx2 v[46:47], v221, s[72:75], s32 offen sc0 sc1
    s_mov_b64 exec, s[30:31]
    s_mov_b32 s32, 0
    v_readfirstlane_b32 s22, v2
    v_readfirstlane_b32 s23, v3
    s_nop 3
    s_or_b32 s3, s22, s23
    s_cmp_lg_u32 s3, 0
    s_cbranch_scc1 Lnok_gate_2
Lnretry_gate_3:
    buffer_load_dwordx2 v[2:3], v4, s[24:27], 0 offen sc0 sc1
    s_waitcnt vmcnt(0)
    v_readfirstlane_b32 s22, v2
    v_readfirstlane_b32 s23, v3
    s_add_u32 s32, s32, 1
    s_nop 3
    s_or_b32 s3, s22, s23
    s_cmp_gt_u32 s32, 20000
    s_cbranch_scc1 Lnok_gate_2
    s_cmp_eq_u32 s3, 0
    s_cbranch_scc1 Lnretry_gate_3
Lnok_gate_2:
    v_mov_b32 v176, s22
    v_mov_b32 v177, s23
    s_mov_b64 s[32:33], exec
    s_mov_b64 exec, 1
    buffer_store_dwordx2 v[176:177], v5, s[48:51], s6 offen sc0 sc1
    s_mov_b64 exec, s[32:33]
    s_waitcnt lgkmcnt(2)
    v_mfma_f32_32x32x16_bf16 v[112:127], v[80:83], v[88:91], v[112:127]
    ds_read_b128 v[96:99], v71 offset:0
    ds_read_b128 v[104:107], v79 offset:0
    s_mov_b32 s68, s14
    s_mov_b32 s69, s15
    s_mov_b32 s70, 2097152
    s_waitcnt lgkmcnt(3)
    v_mfma_f32_32x32x16_bf16 v[128:143], v[80:83], v[92:95], v[128:143]
    ds_read_b128 v[108:111], v79 offset:4096
    ds_read_b128 v[100:103], v71 offset:4096
    s_mov_b32 s71, 131072
    s_mov_b32 s76, s16
    s_add_u32 m0, s47, 51200
    s_waitcnt lgkmcnt(4)
    v_mfma_f32_32x32x16_bf16 v[144:159], v[84:87], v[88:91], v[144:159]
    buffer_load_dwordx4 v14, s[56:59], s46 offen  lds
    s_mov_b32 s77, s17
    s_mov_b32 s78, 2097152
    s_mov_b32 s79, 131072
    s_add_u32 m0, s47, 52224
    v_mfma_f32_32x32x16_bf16 v[160:175], v[84:87], v[92:95], v[160:175]
    buffer_load_dwordx4 v15, s[56:59], s46 offen  lds
    s_add_u32 s80, s40, 16777216
    s_addc_u32 s81, s41, 0
    s_mov_b32 s82, 4194304
    s_mov_b32 s83, 131072
    v_and_b32 v16, 31, v1
    s_waitcnt lgkmcnt(0)
    s_waitcnt vmcnt(19)
    s_barrier
    v_mfma_f32_32x32x16_bf16 v[112:127], v[96:99], v[104:107], v[112:127]
    ds_read_b128 v[80:83], v68 offset:32768
    ds_read_b128 v[88:91], v76 offset:32768
    v_lshlrev_b32 v7, 11, v16
    v_lshrrev_b32 v16, 5, v1
    v_lshl_add_u32 v7, v16, 5, v7
    v_mfma_f32_32x32x16_bf16 v[128:143], v[96:99], v[108:111], v[128:143]
    ds_read_b128 v[92:95], v76 offset:36864
    ds_read_b128 v[84:87], v68 offset:36864
    s_lshl_b32 s5, s44, 17
    s_add_u32 s45, s45, 128
    s_add_u32 m0, s47, 65536
    v_mfma_f32_32x32x16_bf16 v[144:159], v[100:103], v[104:107], v[144:159]
    buffer_load_dwordx4 v8, s[52:55], s45 offen  lds
    s_and_b32 s3, s42, 1
    s_lshl_b32 s3, s3, 16
    s_add_u32 s5, s5, s3
    s_add_u32 m0, s47, 66560
    v_mfma_f32_32x32x16_bf16 v[160:175], v[100:103], v[108:111], v[160:175]
    buffer_load_dwordx4 v9, s[52:55], s45 offen  lds
    s_lshl_b32 s3, s43, 7
    s_add_u32 s5, s5, s3
    s_lshr_b32 s3, s42, 1
    s_lshl_b32 s3, s3, 6
    s_waitcnt lgkmcnt(2)
    v_mfma_f32_32x32x16_bf16 v[112:127], v[80:83], v[88:91], v[112:127]
    ds_read_b128 v[96:99], v69 offset:32768
    ds_read_b128 v[104:107], v77 offset:32768
    s_add_u32 s5, s5, s3
    s_lshl_b32 s29, s44, 2
    s_add_u32 s29, s29, s42
    s_waitcnt lgkmcnt(3)
    v_mfma_f32_32x32x16_bf16 v[128:143], v[80:83], v[92:95], v[128:143]
    ds_read_b128 v[108:111], v77 offset:36864
    ds_read_b128 v[100:103], v69 offset:36864
    s_lshl_b32 s29, s29, 16
    s_lshl_b32 s3, s43, 12
    s_add_u32 m0, s47, 67584
    s_waitcnt lgkmcnt(4)
    v_mfma_f32_32x32x16_bf16 v[144:159], v[84:87], v[88:91], v[144:159]
    buffer_load_dwordx4 v10, s[52:55], s45 offen  lds
    s_add_u32 s29, s29, s3
    s_mov_b32 s30, 0x05040100
    s_mov_b32 s31, 0x07060302
    s_add_u32 m0, s47, 68608
    v_mfma_f32_32x32x16_bf16 v[160:175], v[84:87], v[92:95], v[160:175]
    buffer_load_dwordx4 v11, s[52:55], s45 offen  lds
    buffer_load_dwordx2 v[176:177], v203, s[48:51], 0 offen sc0 sc1
    s_waitcnt lgkmcnt(2)
    v_mfma_f32_32x32x16_bf16 v[112:127], v[96:99], v[104:107], v[112:127]
    ds_read_b128 v[80:83], v70 offset:32768
    ds_read_b128 v[88:91], v78 offset:32768
    s_waitcnt lgkmcnt(3)
    v_mfma_f32_32x32x16_bf16 v[128:143], v[96:99], v[108:111], v[128:143]
    ds_read_b128 v[92:95], v78 offset:36864
    ds_read_b128 v[84:87], v70 offset:36864
    s_add_u32 s46, s46, 128
    s_add_u32 m0, s47, 81920
    s_waitcnt lgkmcnt(4)
    v_mfma_f32_32x32x16_bf16 v[144:159], v[100:103], v[104:107], v[144:159]
    buffer_load_dwordx4 v12, s[56:59], s46 offen  lds
    s_add_u32 m0, s47, 82944
    v_mfma_f32_32x32x16_bf16 v[160:175], v[100:103], v[108:111], v[160:175]
    buffer_load_dwordx4 v13, s[56:59], s46 offen  lds
    s_waitcnt lgkmcnt(2)
    v_mfma_f32_32x32x16_bf16 v[112:127], v[80:83], v[88:91], v[112:127]
    ds_read_b128 v[96:99], v71 offset:32768
    ds_read_b128 v[104:107], v79 offset:32768
    s_waitcnt lgkmcnt(3)
    v_mfma_f32_32x32x16_bf16 v[128:143], v[80:83], v[92:95], v[128:143]
    ds_read_b128 v[108:111], v79 offset:36864
    ds_read_b128 v[100:103], v71 offset:36864
    s_add_u32 m0, s47, 83968
    s_waitcnt lgkmcnt(4)
    v_mfma_f32_32x32x16_bf16 v[144:159], v[84:87], v[88:91], v[144:159]
    buffer_load_dwordx4 v14, s[56:59], s46 offen  lds
    s_add_u32 m0, s47, 84992
    v_mfma_f32_32x32x16_bf16 v[160:175], v[84:87], v[92:95], v[160:175]
    buffer_load_dwordx4 v15, s[56:59], s46 offen  lds
    s_waitcnt lgkmcnt(0)
    s_waitcnt vmcnt(20)
    s_barrier
    v_mfma_f32_32x32x16_bf16 v[112:127], v[96:99], v[104:107], v[112:127]
    ds_read_b128 v[80:83], v64 offset:0
    ds_read_b128 v[88:91], v72 offset:0
    buffer_load_dwordx4 v[18:21], v7, s[68:71], s5 offen offset:0
    buffer_load_dwordx4 v[22:25], v7, s[68:71], s5 offen offset:16
    buffer_load_dwordx4 v[26:29], v7, s[76:79], s5 offen offset:0
    v_mfma_f32_32x32x16_bf16 v[128:143], v[96:99], v[108:111], v[128:143]
    ds_read_b128 v[92:95], v72 offset:4096
    ds_read_b128 v[84:87], v64 offset:4096
    buffer_load_dwordx4 v[30:33], v7, s[76:79], s5 offen offset:16
    s_add_u32 s45, s45, 128
    s_add_u32 m0, s47, 98304
    v_mfma_f32_32x32x16_bf16 v[144:159], v[100:103], v[104:107], v[144:159]
    buffer_load_dwordx4 v8, s[52:55], s45 offen  lds
    s_add_u32 m0, s47, 99328
    v_mfma_f32_32x32x16_bf16 v[160:175], v[100:103], v[108:111], v[160:175]
    buffer_load_dwordx4 v9, s[52:55], s45 offen  lds
    s_waitcnt lgkmcnt(2)
    v_mfma_f32_32x32x16_bf16 v[112:127], v[80:83], v[88:91], v[112:127]
    ds_read_b128 v[96:99], v65 offset:0
    ds_read_b128 v[104:107], v73 offset:0
    s_waitcnt lgkmcnt(3)
    v_mfma_f32_32x32x16_bf16 v[128:143], v[80:83], v[92:95], v[128:143]
    ds_read_b128 v[108:111], v73 offset:4096
    ds_read_b128 v[100:103], v65 offset:4096
    s_add_u32 m0, s47, 100352
    s_waitcnt lgkmcnt(4)
    v_mfma_f32_32x32x16_bf16 v[144:159], v[84:87], v[88:91], v[144:159]
    buffer_load_dwordx4 v10, s[52:55], s45 offen  lds
    s_add_u32 m0, s47, 101376
    v_mfma_f32_32x32x16_bf16 v[160:175], v[84:87], v[92:95], v[160:175]
    buffer_load_dwordx4 v11, s[52:55], s45 offen  lds
    s_waitcnt lgkmcnt(2)
    v_mfma_f32_32x32x16_bf16 v[112:127], v[96:99], v[104:107], v[112:127]
    ds_read_b128 v[80:83], v66 offset:0
    ds_read_b128 v[88:91], v74 offset:0
    s_waitcnt lgkmcnt(3)
    v_mfma_f32_32x32x16_bf16 v[128:143], v[96:99], v[108:111], v[128:143]
    ds_read_b128 v[92:95], v74 offset:4096
    ds_read_b128 v[84:87], v66 offset:4096
    s_add_u32 s46, s46, 128
    s_add_u32 m0, s47, 114688
    s_waitcnt lgkmcnt(4)
    v_mfma_f32_32x32x16_bf16 v[144:159], v[100:103], v[104:107], v[144:159]
    buffer_load_dwordx4 v12, s[56:59], s46 offen  lds
    s_add_u32 m0, s47, 115712
    v_mfma_f32_32x32x16_bf16 v[160:175], v[100:103], v[108:111], v[160:175]
    buffer_load_dwordx4 v13, s[56:59], s46 offen  lds
    s_waitcnt lgkmcnt(2)
    v_mfma_f32_32x32x16_bf16 v[112:127], v[80:83], v[88:91], v[112:127]
    ds_read_b128 v[96:99], v67 offset:0
    ds_read_b128 v[104:107], v75 offset:0
    s_waitcnt lgkmcnt(3)
    v_mfma_f32_32x32x16_bf16 v[128:143], v[80:83], v[92:95], v[128:143]
    ds_read_b128 v[108:111], v75 offset:4096
    ds_read_b128 v[100:103], v67 offset:4096
    s_add_u32 m0, s47, 116736
    s_waitcnt lgkmcnt(4)
    v_mfma_f32_32x32x16_bf16 v[144:159], v[84:87], v[88:91], v[144:159]
    buffer_load_dwordx4 v14, s[56:59], s46 offen  lds
    s_add_u32 m0, s47, 117760
    v_mfma_f32_32x32x16_bf16 v[160:175], v[84:87], v[92:95], v[160:175]
    buffer_load_dwordx4 v15, s[56:59], s46 offen  lds
    s_waitcnt lgkmcnt(0)
    s_waitcnt vmcnt(21)
    s_barrier
    v_mfma_f32_32x32x16_bf16 v[112:127], v[96:99], v[104:107], v[112:127]
    ds_read_b128 v[80:83], v64 offset:32768
    ds_read_b128 v[88:91], v72 offset:32768
    v_subrev_u32 v200, 32, v60
    v_min_u32 v200, 0x7fff0000, v200
    v_subrev_u32 v201, 16, v60
    v_min_u32 v201, 0x7fff0000, v201
    v_mfma_f32_32x32x16_bf16 v[128:143], v[96:99], v[108:111], v[128:143]
    ds_read_b128 v[92:95], v72 offset:36864
    ds_read_b128 v[84:87], v64 offset:36864
    v_add_u32 v17, s18, v60
    s_mov_b32 s38, 0
    s_waitcnt vmcnt(16)
    v_cmp_ne_u64 vcc, s[22:23], v[176:177]
    s_nop 4
    s_cbranch_vccz Lfdone_gate_4
Lfpoll_gate_5:
    buffer_load_dwordx2 v[176:177], v203, s[48:51], 0 offen sc0 sc1
    s_waitcnt vmcnt(0)
    v_cmp_ne_u64 vcc, s[22:23], v[176:177]
    s_nop 4
    s_add_u32 s38, s38, 1
    s_cmp_gt_u32 s38, 20000
    s_cbranch_scc1 Lfdone_gate_4
    s_cbranch_vccnz Lfpoll_gate_5
Lfdone_gate_4:
    s_mov_b32 m0, s28
    s_nop 0
    buffer_load_dwordx4 v220, s[8:11], s19 offen offset:0 sc0 sc1 lds
    buffer_load_dwordx4 v220, s[8:11], s19 offen offset:1024 sc0 sc1 lds
    buffer_load_dwordx4 v220, s[8:11], s19 offen offset:2048 sc0 sc1 lds
    buffer_load_dwordx4 v220, s[8:11], s19 offen offset:3072 sc0 sc1 lds
    buffer_load_dwordx4 v[182:185], v200, s[60:63], 0 offen
    v_mfma_f32_32x32x16_bf16 v[144:159], v[100:103], v[104:107], v[144:159]
    buffer_load_dwordx2 v[190:191], v201, s[60:63], 0 offen
    buffer_load_dwordx4 v[34:37], v60, s[60:63], 0 offen offset:0
    buffer_load_dwordx2 v[46:47], v60, s[60:63], 0 offen offset:16
    buffer_load_dwordx4 v[38:41], v60, s[60:63], 0 offen offset:1024
    buffer_load_dwordx2 v[62:63], v60, s[60:63], 0 offen offset:1040
    buffer_load_dwordx4 v[42:45], v60, s[60:63], 0 offen offset:2048
    v_mfma_f32_32x32x16_bf16 v[160:175], v[100:103], v[108:111], v[160:175]
    buffer_load_dwordx2 v[186:187], v60, s[60:63], 0 offen offset:2064
    buffer_load_dwordx4 v[178:181], v60, s[60:63], 0 offen offset:3072
    buffer_load_dwordx2 v[188:189], v60, s[60:63], 0 offen offset:3088
    s_lshl_b32 s3, s12, 1
    v_mov_b32 v61, s3
    buffer_load_ushort v61, v61, s[64:67], 0 offen
    s_waitcnt lgkmcnt(2)
    v_mfma_f32_32x32x16_bf16 v[112:127], v[80:83], v[88:91], v[112:127]
    ds_read_b128 v[96:99], v65 offset:32768
    ds_read_b128 v[104:107], v73 offset:32768
    s_waitcnt lgkmcnt(3)
    v_mfma_f32_32x32x16_bf16 v[128:143], v[80:83], v[92:95], v[128:143]
    ds_read_b128 v[108:111], v73 offset:36864
    ds_read_b128 v[100:103], v65 offset:36864
    s_waitcnt lgkmcnt(4)
    v_mfma_f32_32x32x16_bf16 v[144:159], v[84:87], v[88:91], v[144:159]
    v_mfma_f32_32x32x16_bf16 v[160:175], v[84:87], v[92:95], v[160:175]
    s_waitcnt lgkmcnt(2)
    v_mfma_f32_32x32x16_bf16 v[112:127], v[96:99], v[104:107], v[112:127]
    ds_read_b128 v[80:83], v66 offset:32768
    ds_read_b128 v[88:91], v74 offset:32768
    s_waitcnt lgkmcnt(3)
    v_mfma_f32_32x32x16_bf16 v[128:143], v[96:99], v[108:111], v[128:143]
    ds_read_b128 v[92:95], v74 offset:36864
    ds_read_b128 v[84:87], v66 offset:36864
    s_waitcnt lgkmcnt(4)
    v_mfma_f32_32x32x16_bf16 v[144:159], v[100:103], v[104:107], v[144:159]
    v_mfma_f32_32x32x16_bf16 v[160:175], v[100:103], v[108:111], v[160:175]
    s_waitcnt lgkmcnt(2)
    v_mfma_f32_32x32x16_bf16 v[112:127], v[80:83], v[88:91], v[112:127]
    ds_read_b128 v[96:99], v67 offset:32768
    ds_read_b128 v[104:107], v75 offset:32768
    s_waitcnt lgkmcnt(3)
    v_mfma_f32_32x32x16_bf16 v[128:143], v[80:83], v[92:95], v[128:143]
    ds_read_b128 v[108:111], v75 offset:36864
    ds_read_b128 v[100:103], v67 offset:36864
    s_waitcnt lgkmcnt(4)
    v_mfma_f32_32x32x16_bf16 v[144:159], v[84:87], v[88:91], v[144:159]
    v_mfma_f32_32x32x16_bf16 v[160:175], v[84:87], v[92:95], v[160:175]
    s_waitcnt lgkmcnt(0)
    s_waitcnt vmcnt(27)
    s_barrier
    v_mfma_f32_32x32x16_bf16 v[112:127], v[96:99], v[104:107], v[112:127]
    ds_read_b128 v[80:83], v68 offset:0
    ds_read_b128 v[88:91], v76 offset:0
    s_waitcnt vmcnt(24)
    v_perm_b32 v208, v26, v18, s30
    v_perm_b32 v209, v26, v18, s31
    v_perm_b32 v210, v27, v19, s30
    v_perm_b32 v211, v27, v19, s31
    v_mfma_f32_32x32x16_bf16 v[128:143], v[96:99], v[108:111], v[128:143]
    ds_read_b128 v[92:95], v76 offset:4096
    ds_read_b128 v[84:87], v68 offset:4096
    buffer_store_dwordx4 v[208:211], v60, s[80:83], s29 offen offset:0 sc0 sc1
    v_perm_b32 v212, v28, v20, s30
    v_perm_b32 v213, v28, v20, s31
    v_perm_b32 v214, v29, v21, s30
    v_mfma_f32_32x32x16_bf16 v[144:159], v[100:103], v[104:107], v[144:159]
    v_perm_b32 v215, v29, v21, s31
    buffer_store_dwordx4 v[212:215], v60, s[80:83], s29 offen offset:1024 sc0 sc1
    s_waitcnt vmcnt(25)
    v_perm_b32 v208, v30, v22, s30
    v_perm_b32 v209, v30, v22, s31
    v_perm_b32 v210, v31, v23, s30
    v_perm_b32 v211, v31, v23, s31
    v_mfma_f32_32x32x16_bf16 v[160:175], v[100:103], v[108:111], v[160:175]
    buffer_store_dwordx4 v[208:211], v60, s[80:83], s29 offen offset:2048 sc0 sc1
    v_perm_b32 v212, v32, v24, s30
    v_perm_b32 v213, v32, v24, s31
    v_perm_b32 v214, v33, v25, s30
    v_perm_b32 v215, v33, v25, s31
    buffer_store_dwordx4 v[212:215], v60, s[80:83], s29 offen offset:3072 sc0 sc1
    s_waitcnt lgkmcnt(2)
    v_mfma_f32_32x32x16_bf16 v[112:127], v[80:83], v[88:91], v[112:127]
    ds_read_b128 v[96:99], v69 offset:0
    ds_read_b128 v[104:107], v77 offset:0
    v_and_b32 v202, 15, v1
    v_lshrrev_b32 v216, 4, v1
    v_add_u32 v217, 1, v202
    v_and_b32 v218, 3, v217
    s_waitcnt lgkmcnt(3)
    v_mfma_f32_32x32x16_bf16 v[128:143], v[80:83], v[92:95], v[128:143]
    ds_read_b128 v[108:111], v77 offset:4096
    ds_read_b128 v[100:103], v69 offset:4096
    v_mul_u32_u24 v218, 4160, v218
    v_and_b32 v217, 28, v217
    v_lshl_add_u32 v218, v217, 1, v218
    v_lshl_add_u32 v218, v216, 4, v218
    s_waitcnt lgkmcnt(4)
    v_mfma_f32_32x32x16_bf16 v[144:159], v[84:87], v[88:91], v[144:159]
    v_add_u32 v219, s18, v218
    v_lshlrev_b32 v217, 1, v202
    v_sub_u32 v217, v216, v217
    v_add_u32 v217, 30, v217
    v_lshrrev_b32 v218, 2, v217
    v_lshlrev_b32 v217, 6, v217
    v_mfma_f32_32x32x16_bf16 v[160:175], v[84:87], v[92:95], v[160:175]
    v_add_u32 v217, 131072, v217
    v_add_u32 v221, 63, v218
    v_and_b32 v221, 3, v221
    v_xor_b32 v221, s42, v221
    v_lshl_add_u32 v221, v221, 4, v217
    v_add_u32 v222, 62, v218
    s_waitcnt lgkmcnt(2)
    v_mfma_f32_32x32x16_bf16 v[112:127], v[96:99], v[104:107], v[112:127]
    ds_read_b128 v[80:83], v70 offset:0
    ds_read_b128 v[88:91], v78 offset:0
    v_and_b32 v222, 3, v222
    v_xor_b32 v222, s42, v222
    v_lshl_add_u32 v222, v222, 4, v217
    v_add_u32 v223, 61, v218
    s_waitcnt lgkmcnt(3)
    v_mfma_f32_32x32x16_bf16 v[128:143], v[96:99], v[108:111], v[128:143]
    ds_read_b128 v[92:95], v78 offset:4096
    ds_read_b128 v[84:87], v70 offset:4096
    v_and_b32 v223, 3, v223
    v_xor_b32 v223, s42, v223
    v_lshl_add_u32 v223, v223, 4, v217
    v_add_u32 v224, 60, v218
    s_waitcnt lgkmcnt(4)
    v_mfma_f32_32x32x16_bf16 v[144:159], v[100:103], v[104:107], v[144:159]
    v_and_b32 v224, 3, v224
    v_xor_b32 v224, s42, v224
    v_lshl_add_u32 v224, v224, 4, v217
    v_lshlrev_b32 v217, 5, v202
    v_lshl_add_u32 v217, v216, 3, v217
    v_sub_u32 v217, 504, v217
    v_mfma_f32_32x32x16_bf16 v[160:175], v[100:103], v[108:111], v[160:175]
    v_and_b32 v225, 8, v217
    v_lshrrev_b32 v217, 4, v217
    v_lshl_add_u32 v225, v217, 6, v225
    v_bfe_u32 v217, v217, 2, 2
    v_xor_b32 v217, s42, v217
    v_lshl_add_u32 v225, v217, 4, v225
    s_waitcnt lgkmcnt(2)
    v_mfma_f32_32x32x16_bf16 v[112:127], v[80:83], v[88:91], v[112:127]
    ds_read_b128 v[96:99], v71 offset:0
    ds_read_b128 v[104:107], v79 offset:0
    v_add_u32 v225, 131072, v225
    v_and_b32 v217, 1, v216
    v_lshlrev_b32 v217, 9, v217
    v_lshl_add_u32 v217, v202, 5, v217
    s_waitcnt lgkmcnt(3)
    v_mfma_f32_32x32x16_bf16 v[128:143], v[80:83], v[92:95], v[128:143]
    ds_read_b128 v[108:111], v79 offset:4096
    ds_read_b128 v[100:103], v71 offset:4096
    v_lshrrev_b32 v218, 1, v216
    v_lshl_add_u32 v226, v218, 4, v217
    s_waitcnt lgkmcnt(4)
    v_mfma_f32_32x32x16_bf16 v[144:159], v[84:87], v[88:91], v[144:159]
    v_mfma_f32_32x32x16_bf16 v[160:175], v[84:87], v[92:95], v[160:175]
    s_waitcnt lgkmcnt(0)
    s_waitcnt vmcnt(19)
    s_barrier
    v_mfma_f32_32x32x16_bf16 v[112:127], v[96:99], v[104:107], v[112:127]
    ds_read_b128 v[80:83], v68 offset:32768
    ds_read_b128 v[88:91], v76 offset:32768
    s_waitcnt vmcnt(15)
    s_waitcnt vmcnt(14)
    ds_write_b128 v17, v[182:185] offset:0
    v_alignbit_b32 v192, v183, v182, 16
    v_alignbit_b32 v193, v184, v183, 16
    v_mfma_f32_32x32x16_bf16 v[128:143], v[96:99], v[108:111], v[128:143]
    ds_read_b128 v[92:95], v76 offset:36864
    ds_read_b128 v[84:87], v68 offset:36864
    v_alignbit_b32 v194, v185, v184, 16
    s_waitcnt vmcnt(13)
    v_alignbit_b32 v195, v190, v185, 16
    v_pk_mov_b32 v[196:197], v[182:183], v[184:185] op_sel:[1,0]
    v_pk_mov_b32 v[198:199], v[184:185], v[190:191] op_sel:[1,0]
    v_mfma_f32_32x32x16_bf16 v[144:159], v[100:103], v[104:107], v[144:159]
    ds_write_b128 v17, v[192:195] offset:4160
    v_pk_mov_b32 v[204:205], v[192:193], v[194:195] op_sel:[1,0]
    v_mov_b32 v206, v195
    v_alignbit_b32 v207, v191, v190, 16
    ds_write_b128 v17, v[196:199] offset:8320
    ds_write_b128 v17, v[204:207] offset:12480
    v_mfma_f32_32x32x16_bf16 v[160:175], v[100:103], v[108:111], v[160:175]
    s_waitcnt vmcnt(12)
    ds_write_b128 v17, v[34:37] offset:32
    v_alignbit_b32 v192, v35, v34, 16
    v_alignbit_b32 v193, v36, v35, 16
    v_alignbit_b32 v194, v37, v36, 16
    s_waitcnt vmcnt(11)
    v_alignbit_b32 v195, v46, v37, 16
    v_pk_mov_b32 v[196:197], v[34:35], v[36:37] op_sel:[1,0]
    s_waitcnt lgkmcnt(7)
    v_mfma_f32_32x32x16_bf16 v[112:127], v[80:83], v[88:91], v[112:127]
    ds_read_b128 v[96:99], v69 offset:32768
    ds_read_b128 v[104:107], v77 offset:32768
    v_pk_mov_b32 v[198:199], v[36:37], v[46:47] op_sel:[1,0]
    ds_write_b128 v17, v[192:195] offset:4192
    v_pk_mov_b32 v[204:205], v[192:193], v[194:195] op_sel:[1,0]
    v_mov_b32 v206, v195
    s_waitcnt lgkmcnt(8)
    v_mfma_f32_32x32x16_bf16 v[128:143], v[80:83], v[92:95], v[128:143]
    ds_read_b128 v[108:111], v77 offset:36864
    ds_read_b128 v[100:103], v69 offset:36864
    v_alignbit_b32 v207, v47, v46, 16
    ds_write_b128 v17, v[196:199] offset:8352
    ds_write_b128 v17, v[204:207] offset:12512
    s_waitcnt vmcnt(10)
    ds_write_b128 v17, v[38:41] offset:1056
    s_waitcnt lgkmcnt(12)
    v_mfma_f32_32x32x16_bf16 v[144:159], v[84:87], v[88:91], v[144:159]
    v_alignbit_b32 v192, v39, v38, 16
    v_alignbit_b32 v193, v40, v39, 16
    v_alignbit_b32 v194, v41, v40, 16
    s_waitcnt vmcnt(9)
    v_alignbit_b32 v195, v62, v41, 16
    v_pk_mov_b32 v[196:197], v[38:39], v[40:41] op_sel:[1,0]
    v_pk_mov_b32 v[198:199], v[40:41], v[62:63] op_sel:[1,0]
    v_mfma_f32_32x32x16_bf16 v[160:175], v[84:87], v[92:95], v[160:175]
    ds_write_b128 v17, v[192:195] offset:5216
    v_pk_mov_b32 v[204:205], v[192:193], v[194:195] op_sel:[1,0]
    v_mov_b32 v206, v195
    v_alignbit_b32 v207, v63, v62, 16
    ds_write_b128 v17, v[196:199] offset:9376
    ds_write_b128 v17, v[204:207] offset:13536
    s_waitcnt lgkmcnt(9)
    v_mfma_f32_32x32x16_bf16 v[112:127], v[96:99], v[104:107], v[112:127]
    ds_read_b128 v[80:83], v70 offset:32768
    ds_read_b128 v[88:91], v78 offset:32768
    s_waitcnt vmcnt(8)
    ds_write_b128 v17, v[42:45] offset:2080
    v_alignbit_b32 v192, v43, v42, 16
    v_alignbit_b32 v193, v44, v43, 16
    v_alignbit_b32 v194, v45, v44, 16
    s_waitcnt lgkmcnt(10)
    v_mfma_f32_32x32x16_bf16 v[128:143], v[96:99], v[108:111], v[128:143]
    ds_read_b128 v[92:95], v78 offset:36864
    ds_read_b128 v[84:87], v70 offset:36864
    s_waitcnt vmcnt(7)
    v_alignbit_b32 v195, v186, v45, 16
    v_pk_mov_b32 v[196:197], v[42:43], v[44:45] op_sel:[1,0]
    v_pk_mov_b32 v[198:199], v[44:45], v[186:187] op_sel:[1,0]
    ds_write_b128 v17, v[192:195] offset:6240
    s_waitcnt lgkmcnt(12)
    v_mfma_f32_32x32x16_bf16 v[144:159], v[100:103], v[104:107], v[144:159]
    v_pk_mov_b32 v[204:205], v[192:193], v[194:195] op_sel:[1,0]
    v_mov_b32 v206, v195
    v_alignbit_b32 v207, v187, v186, 16
    ds_write_b128 v17, v[196:199] offset:10400
    ds_write_b128 v17, v[204:207] offset:14560
    s_waitcnt vmcnt(6)
    ds_write_b128 v17, v[178:181] offset:3104
    v_mfma_f32_32x32x16_bf16 v[160:175], v[100:103], v[108:111], v[160:175]
    v_alignbit_b32 v192, v179, v178, 16
    v_alignbit_b32 v193, v180, v179, 16
    v_alignbit_b32 v194, v181, v180, 16
    s_waitcnt vmcnt(5)
    v_alignbit_b32 v195, v188, v181, 16
    v_pk_mov_b32 v[196:197], v[178:179], v[180:181] op_sel:[1,0]
    v_pk_mov_b32 v[198:199], v[180:181], v[188:189] op_sel:[1,0]
    s_waitcnt lgkmcnt(7)
    v_mfma_f32_32x32x16_bf16 v[112:127], v[80:83], v[88:91], v[112:127]
    ds_read_b128 v[96:99], v71 offset:32768
    ds_read_b128 v[104:107], v79 offset:32768
    ds_write_b128 v17, v[192:195] offset:7264
    v_pk_mov_b32 v[204:205], v[192:193], v[194:195] op_sel:[1,0]
    v_mov_b32 v206, v195
    v_alignbit_b32 v207, v189, v188, 16
    s_waitcnt lgkmcnt(8)
    v_mfma_f32_32x32x16_bf16 v[128:143], v[80:83], v[92:95], v[128:143]
    ds_read_b128 v[108:111], v79 offset:36864
    ds_read_b128 v[100:103], v71 offset:36864
    ds_write_b128 v17, v[196:199] offset:11424
    ds_write_b128 v17, v[204:207] offset:15584
    s_waitcnt vmcnt(4)
    v_lshlrev_b32 v61, 16, v61
    s_waitcnt lgkmcnt(11)
    v_mfma_f32_32x32x16_bf16 v[144:159], v[84:87], v[88:91], v[144:159]
    v_mfma_f32_32x32x16_bf16 v[160:175], v[84:87], v[92:95], v[160:175]
    s_waitcnt lgkmcnt(2)
    v_mfma_f32_32x32x16_bf16 v[112:127], v[96:99], v[104:107], v[112:127]
    v_mfma_f32_32x32x16_bf16 v[128:143], v[96:99], v[108:111], v[128:143]
    v_mfma_f32_32x32x16_bf16 v[144:159], v[100:103], v[104:107], v[144:159]
    v_mfma_f32_32x32x16_bf16 v[160:175], v[100:103], v[108:111], v[160:175]
    s_nop 9
    v_pk_fma_f32 v[10:11], v[128:129], v[48:49], v[114:115] op_sel:[0,1,0] op_sel_hi:[1,1,1] neg_lo:[0,1,0] neg_hi:[0,1,0]
    v_pk_fma_f32 v[12:13], v[112:113], v[48:49], v[130:131] op_sel:[0,1,0] op_sel_hi:[1,1,1]
    v_pk_fma_f32 v[2:3], v[112:113], v[48:49], v[10:11] op_sel:[0,0,0] op_sel_hi:[1,0,1]
    v_pk_fma_f32 v[8:9], v[128:129], v[48:49], v[12:13] op_sel:[0,0,0] op_sel_hi:[1,0,1]
    v_pk_fma_f32 v[10:11], v[8:9], v[48:49], v[116:117] op_sel:[0,1,0] op_sel_hi:[1,1,1] neg_lo:[0,1,0] neg_hi:[0,1,0]
    v_pk_fma_f32 v[12:13], v[2:3], v[48:49], v[132:133] op_sel:[0,1,0] op_sel_hi:[1,1,1]
    v_pk_fma_f32 v[2:3], v[2:3], v[48:49], v[10:11] op_sel:[0,0,0] op_sel_hi:[1,0,1]
    v_pk_fma_f32 v[8:9], v[8:9], v[48:49], v[12:13] op_sel:[0,0,0] op_sel_hi:[1,0,1]
    v_pk_fma_f32 v[10:11], v[8:9], v[48:49], v[118:119] op_sel:[0,1,0] op_sel_hi:[1,1,1] neg_lo:[0,1,0] neg_hi:[0,1,0]
    v_pk_fma_f32 v[12:13], v[2:3], v[48:49], v[134:135] op_sel:[0,1,0] op_sel_hi:[1,1,1]
    v_pk_fma_f32 v[2:3], v[2:3], v[48:49], v[10:11] op_sel:[0,0,0] op_sel_hi:[1,0,1]
    v_pk_fma_f32 v[8:9], v[8:9], v[48:49], v[12:13] op_sel:[0,0,0] op_sel_hi:[1,0,1]
    v_pk_fma_f32 v[10:11], v[8:9], v[48:49], v[120:121] op_sel:[0,1,0] op_sel_hi:[1,1,1] neg_lo:[0,1,0] neg_hi:[0,1,0]
    v_pk_fma_f32 v[12:13], v[2:3], v[48:49], v[136:137] op_sel:[0,1,0] op_sel_hi:[1,1,1]
    v_pk_fma_f32 v[2:3], v[2:3], v[48:49], v[10:11] op_sel:[0,0,0] op_sel_hi:[1,0,1]
    v_pk_fma_f32 v[8:9], v[8:9], v[48:49], v[12:13] op_sel:[0,0,0] op_sel_hi:[1,0,1]
    v_pk_fma_f32 v[10:11], v[8:9], v[48:49], v[122:123] op_sel:[0,1,0] op_sel_hi:[1,1,1] neg_lo:[0,1,0] neg_hi:[0,1,0]
    v_pk_fma_f32 v[12:13], v[2:3], v[48:49], v[138:139] op_sel:[0,1,0] op_sel_hi:[1,1,1]
    v_pk_fma_f32 v[2:3], v[2:3], v[48:49], v[10:11] op_sel:[0,0,0] op_sel_hi:[1,0,1]
    v_pk_fma_f32 v[8:9], v[8:9], v[48:49], v[12:13] op_sel:[0,0,0] op_sel_hi:[1,0,1]
    v_pk_fma_f32 v[10:11], v[8:9], v[48:49], v[124:125] op_sel:[0,1,0] op_sel_hi:[1,1,1] neg_lo:[0,1,0] neg_hi:[0,1,0]
    v_pk_fma_f32 v[12:13], v[2:3], v[48:49], v[140:141] op_sel:[0,1,0] op_sel_hi:[1,1,1]
    v_pk_fma_f32 v[2:3], v[2:3], v[48:49], v[10:11] op_sel:[0,0,0] op_sel_hi:[1,0,1]
    v_pk_fma_f32 v[8:9], v[8:9], v[48:49], v[12:13] op_sel:[0,0,0] op_sel_hi:[1,0,1]
    v_pk_fma_f32 v[10:11], v[8:9], v[48:49], v[126:127] op_sel:[0,1,0] op_sel_hi:[1,1,1] neg_lo:[0,1,0] neg_hi:[0,1,0]
    v_pk_fma_f32 v[12:13], v[2:3], v[48:49], v[142:143] op_sel:[0,1,0] op_sel_hi:[1,1,1]
    v_pk_fma_f32 v[2:3], v[2:3], v[48:49], v[10:11] op_sel:[0,0,0] op_sel_hi:[1,0,1]
    v_pk_fma_f32 v[8:9], v[8:9], v[48:49], v[12:13] op_sel:[0,0,0] op_sel_hi:[1,0,1]
    v_pk_fma_f32 v[10:11], v[8:9], v[48:49], v[144:145] op_sel:[0,1,0] op_sel_hi:[1,1,1] neg_lo:[0,1,0] neg_hi:[0,1,0]
    v_pk_fma_f32 v[12:13], v[2:3], v[48:49], v[160:161] op_sel:[0,1,0] op_sel_hi:[1,1,1]
    v_pk_fma_f32 v[2:3], v[2:3], v[48:49], v[10:11] op_sel:[0,0,0] op_sel_hi:[1,0,1]
    v_pk_fma_f32 v[8:9], v[8:9], v[48:49], v[12:13] op_sel:[0,0,0] op_sel_hi:[1,0,1]
    v_pk_fma_f32 v[10:11], v[8:9], v[48:49], v[146:147] op_sel:[0,1,0] op_sel_hi:[1,1,1] neg_lo:[0,1,0] neg_hi:[0,1,0]
    v_pk_fma_f32 v[12:13], v[2:3], v[48:49], v[162:163] op_sel:[0,1,0] op_sel_hi:[1,1,1]
    v_pk_fma_f32 v[2:3], v[2:3], v[48:49], v[10:11] op_sel:[0,0,0] op_sel_hi:[1,0,1]
    v_pk_fma_f32 v[8:9], v[8:9], v[48:49], v[12:13] op_sel:[0,0,0] op_sel_hi:[1,0,1]
    v_pk_fma_f32 v[10:11], v[8:9], v[48:49], v[148:149] op_sel:[0,1,0] op_sel_hi:[1,1,1] neg_lo:[0,1,0] neg_hi:[0,1,0]
    v_pk_fma_f32 v[12:13], v[2:3], v[48:49], v[164:165] op_sel:[0,1,0] op_sel_hi:[1,1,1]
    v_pk_fma_f32 v[2:3], v[2:3], v[48:49], v[10:11] op_sel:[0,0,0] op_sel_hi:[1,0,1]
    v_pk_fma_f32 v[8:9], v[8:9], v[48:49], v[12:13] op_sel:[0,0,0] op_sel_hi:[1,0,1]
    v_pk_fma_f32 v[10:11], v[8:9], v[48:49], v[150:151] op_sel:[0,1,0] op_sel_hi:[1,1,1] neg_lo:[0,1,0] neg_hi:[0,1,0]
    v_pk_fma_f32 v[12:13], v[2:3], v[48:49], v[166:167] op_sel:[0,1,0] op_sel_hi:[1,1,1]
    v_pk_fma_f32 v[2:3], v[2:3], v[48:49], v[10:11] op_sel:[0,0,0] op_sel_hi:[1,0,1]
    v_pk_fma_f32 v[8:9], v[8:9], v[48:49], v[12:13] op_sel:[0,0,0] op_sel_hi:[1,0,1]
    v_pk_fma_f32 v[10:11], v[8:9], v[48:49], v[152:153] op_sel:[0,1,0] op_sel_hi:[1,1,1] neg_lo:[0,1,0] neg_hi:[0,1,0]
    v_pk_fma_f32 v[12:13], v[2:3], v[48:49], v[168:169] op_sel:[0,1,0] op_sel_hi:[1,1,1]
    v_pk_fma_f32 v[2:3], v[2:3], v[48:49], v[10:11] op_sel:[0,0,0] op_sel_hi:[1,0,1]
    v_pk_fma_f32 v[8:9], v[8:9], v[48:49], v[12:13] op_sel:[0,0,0] op_sel_hi:[1,0,1]
    v_pk_fma_f32 v[10:11], v[8:9], v[48:49], v[154:155] op_sel:[0,1,0] op_sel_hi:[1,1,1] neg_lo:[0,1,0] neg_hi:[0,1,0]
    v_pk_fma_f32 v[12:13], v[2:3], v[48:49], v[170:171] op_sel:[0,1,0] op_sel_hi:[1,1,1]
    v_pk_fma_f32 v[2:3], v[2:3], v[48:49], v[10:11] op_sel:[0,0,0] op_sel_hi:[1,0,1]
    v_pk_fma_f32 v[8:9], v[8:9], v[48:49], v[12:13] op_sel:[0,0,0] op_sel_hi:[1,0,1]
    v_pk_fma_f32 v[10:11], v[8:9], v[48:49], v[156:157] op_sel:[0,1,0] op_sel_hi:[1,1,1] neg_lo:[0,1,0] neg_hi:[0,1,0]
    v_pk_fma_f32 v[12:13], v[2:3], v[48:49], v[172:173] op_sel:[0,1,0] op_sel_hi:[1,1,1]
    v_pk_fma_f32 v[2:3], v[2:3], v[48:49], v[10:11] op_sel:[0,0,0] op_sel_hi:[1,0,1]
    v_pk_fma_f32 v[8:9], v[8:9], v[48:49], v[12:13] op_sel:[0,0,0] op_sel_hi:[1,0,1]
    v_pk_fma_f32 v[10:11], v[8:9], v[48:49], v[158:159] op_sel:[0,1,0] op_sel_hi:[1,1,1] neg_lo:[0,1,0] neg_hi:[0,1,0]
    v_pk_fma_f32 v[12:13], v[2:3], v[48:49], v[174:175] op_sel:[0,1,0] op_sel_hi:[1,1,1]
    v_pk_fma_f32 v[2:3], v[2:3], v[48:49], v[10:11] op_sel:[0,0,0] op_sel_hi:[1,0,1]
    v_pk_fma_f32 v[8:9], v[8:9], v[48:49], v[12:13] op_sel:[0,0,0] op_sel_hi:[1,0,1]
    v_lshrrev_b32 v7, 5, v1
    v_lshlrev_b32 v7, 10, v7
    v_lshl_add_u32 v4, v6, 2, v7
    s_lshr_b32 s3, s42, 1
    s_lshl_b32 s3, s3, 11
    s_add_u32 s3, s3, 149504
    v_add_u32 v4, s3, v4
    ds_write2st64_b32 v4, v2, v8 offset0:12 offset1:13
    ds_write2st64_b32 v4, v3, v9 offset0:14 offset1:15
    s_waitcnt lgkmcnt(0)
    s_barrier
    ds_read2st64_b32 v[14:15], v4 offset0:0 offset1:1
    ds_read2st64_b32 v[16:17], v4 offset0:2 offset1:3
    ds_read2st64_b32 v[18:19], v4 offset0:4 offset1:5
    ds_read2st64_b32 v[20:21], v4 offset0:6 offset1:7
    ds_read2st64_b32 v[22:23], v4 offset0:8 offset1:9
    ds_read2st64_b32 v[24:25], v4 offset0:10 offset1:11
    s_waitcnt lgkmcnt(4)
    v_fma_f32 v30, -v53, v15, v16
    v_fma_f32 v31, v53, v14, v17
    v_fma_f32 v16, v52, v14, v30
    v_fma_f32 v17, v52, v15, v31
    s_waitcnt lgkmcnt(3)
    v_fma_f32 v30, -v53, v17, v18
    v_fma_f32 v31, v53, v16, v19
    v_fma_f32 v18, v52, v16, v30
    v_fma_f32 v19, v52, v17, v31
    s_waitcnt lgkmcnt(2)
    v_fma_f32 v30, -v53, v19, v20
    v_fma_f32 v31, v53, v18, v21
    v_fma_f32 v20, v52, v18, v30
    v_fma_f32 v21, v52, v19, v31
    s_waitcnt lgkmcnt(1)
    v_fma_f32 v30, -v53, v21, v22
    v_fma_f32 v31, v53, v20, v23
    v_fma_f32 v22, v52, v20, v30
    v_fma_f32 v23, v52, v21, v31
    s_waitcnt lgkmcnt(0)
    v_fma_f32 v30, -v53, v23, v24
    v_fma_f32 v31, v53, v22, v25
    v_fma_f32 v24, v52, v22, v30
    v_fma_f32 v25, v52, v23, v31
    v_fma_f32 v30, -v53, v25, v2
    v_fma_f32 v31, v53, v24, v8
    v_fma_f32 v28, v52, v24, v30
    v_fma_f32 v29, v52, v25, v31
    v_fma_f32 v30, -v53, v29, v3
    v_fma_f32 v31, v53, v28, v9
    v_fma_f32 v32, v52, v28, v30
    v_fma_f32 v33, v52, v29, v31
    v_mov_b32 v34, v24
    v_mov_b32 v35, v28
    v_mov_b32 v36, v25
    v_mov_b32 v37, v29
    s_lshl_b32 s3, s44, 14
    s_add_u32 s3, s3, 21037056
    s_add_u32 s28, s40, s3
    s_addc_u32 s29, s41, 0
    s_mov_b32 s30, 16384
    s_mov_b32 s31, 131072
    v_lshlrev_b32 v2, 4, v6
    s_lshl_b32 s5, s43, 10
    s_lshr_b32 s3, s42, 1
    s_cmp_eq_u32 s3, 0
    s_cbranch_scc1 Lnopub_gate_6
    v_mov_b32 v14, v32
    v_mov_b32 v15, v33
    v_mov_b32 v16, s22
    v_mov_b32 v17, s23
    s_mov_b64 s[14:15], exec
    s_mov_b64 exec, s[34:35]
    buffer_store_dwordx4 v[14:17], v2, s[28:31], s5 offen sc0 sc1
    s_mov_b64 exec, s[14:15]
    s_nop 1
Lnopub_gate_6:
    ds_read_b64 v[106:107], v219 offset:448
    ds_read_b64 v[108:109], v219 offset:456
    ds_read_b128 v[178:181], v221 offset:16128
    ds_read_b64 v[182:183], v219 offset:960
    ds_read_b64 v[184:185], v219 offset:968
    ds_read_b128 v[186:189], v221 offset:14080
    ds_read_b64 v[190:191], v219 offset:1472
    ds_read_b64 v[192:193], v219 offset:1480
    ds_read_b128 v[194:197], v221 offset:12032
    s_waitcnt lgkmcnt(6)
    v_mfma_f32_16x16x32_bf16 v[20:23], v[106:109], v[178:181], 0
    v_lshrrev_b32 v4, 5, v1
    v_lshlrev_b32 v4, 10, v4
    s_waitcnt lgkmcnt(4)
    v_mfma_f32_16x16x32_bf16 v[24:27], v[182:185], v[178:181], 0
    v_sub_u32 v4, v2, v4
    s_sub_u32 s3, s5, 1024
    v_add_u32 v3, s3, v4
    s_waitcnt lgkmcnt(3)
    v_mfma_f32_16x16x32_bf16 v[24:27], v[106:109], v[186:189], v[24:27]
    ds_read_b64 v[198:199], v219 offset:1984
    ds_read_b64 v[200:201], v219 offset:1992
    v_mul_f32 v8, v55, v55
    v_mfma_f32_16x16x32_bf16 v[28:31], v[182:185], v[186:189], 0
    ds_read_b128 v[204:207], v221 offset:9984
    v_fma_f32 v8, v54, v54, -v8
    s_waitcnt lgkmcnt(4)
    v_mfma_f32_16x16x32_bf16 v[28:31], v[190:193], v[178:181], v[28:31]
    v_mul_f32 v9, v54, v55
    v_add_f32 v9, v9, v9
    s_waitcnt lgkmcnt(3)
    v_mfma_f32_16x16x32_bf16 v[28:31], v[106:109], v[194:197], v[28:31]
    v_lshrrev_b32 v4, 5, v1
    v_sub_u32 v4, s43, v4
    v_mfma_f32_16x16x32_bf16 v[38:41], v[190:193], v[186:189], 0
    v_add_u32 v4, 1, v4
    v_lshrrev_b32 v7, 1, v4
    v_mfma_f32_16x16x32_bf16 v[38:41], v[182:185], v[194:197], v[38:41]
    s_waitcnt vmcnt(0)
    v_mov_b32 v176, s22
    v_mov_b32 v177, s23
    s_mov_b64 s[16:17], exec
    s_mov_b64 exec, 1
    buffer_store_dwordx2 v[176:177], v5, s[48:51], s7 offen sc0 sc1
    s_mov_b64 exec, s[16:17]
    v_mfma_f32_16x16x32_bf16 v[42:45], v[190:193], v[194:197], 0
    v_mul_f32 v10, v51, v128
    v_mul_f32 v12, v51, v112
    s_waitcnt lgkmcnt(1)
    v_mfma_f32_16x16x32_bf16 v[38:41], v[198:201], v[178:181], v[38:41]
    ds_read_b64 v[208:209], v219 offset:2496
    ds_read_b64 v[210:211], v219 offset:2504
    v_mul_f32 v11, v51, v129
    s_waitcnt lgkmcnt(2)
    v_mfma_f32_16x16x32_bf16 v[38:41], v[106:109], v[204:207], v[38:41]
    ds_read_b128 v[212:215], v221 offset:7936
    v_mul_f32 v13, v51, v113
    v_mfma_f32_16x16x32_bf16 v[42:45], v[198:201], v[186:189], v[42:45]
    v_fma_f32 v112, v50, v112, -v10
    v_fma_f32 v128, v50, v128, v12
    v_mfma_f32_16x16x32_bf16 v[42:45], v[182:185], v[204:207], v[42:45]
    v_fma_f32 v113, v50, v113, -v11
    v_fma_f32 v129, v50, v129, v13
    v_mfma_f32_16x16x32_bf16 v[94:97], v[198:201], v[194:197], 0
    v_mul_f32 v10, v51, v130
    v_mul_f32 v12, v51, v114
    v_mfma_f32_16x16x32_bf16 v[94:97], v[190:193], v[204:207], v[94:97]
    v_mul_f32 v11, v51, v131
    v_mul_f32 v13, v51, v115
    v_mfma_f32_16x16x32_bf16 v[98:101], v[198:201], v[204:207], 0
    v_fma_f32 v114, v50, v114, -v10
    v_fma_f32 v130, v50, v130, v12
    s_waitcnt lgkmcnt(1)
    v_mfma_f32_16x16x32_bf16 v[42:45], v[208:211], v[178:181], v[42:45]
    v_fma_f32 v115, v50, v115, -v11
    v_fma_f32 v131, v50, v131, v13
    s_waitcnt lgkmcnt(0)
    v_mfma_f32_16x16x32_bf16 v[42:45], v[106:109], v[212:215], v[42:45]
    ds_read_b64 v[228:229], v219 offset:3008
    ds_read_b64 v[230:231], v219 offset:3016
    v_mul_f32 v10, v51, v132
    v_mfma_f32_16x16x32_bf16 v[94:97], v[208:211], v[186:189], v[94:97]
    ds_read_b128 v[232:235], v221 offset:5888
    v_mul_f32 v12, v51, v116
    v_mfma_f32_16x16x32_bf16 v[94:97], v[182:185], v[212:215], v[94:97]
    v_mul_f32 v11, v51, v133
    v_mul_f32 v13, v51, v117
    v_mfma_f32_16x16x32_bf16 v[98:101], v[208:211], v[194:197], v[98:101]
    v_fma_f32 v116, v50, v116, -v10
    v_fma_f32 v132, v50, v132, v12
    v_mfma_f32_16x16x32_bf16 v[98:101], v[190:193], v[212:215], v[98:101]
    v_fma_f32 v117, v50, v117, -v11
    v_fma_f32 v133, v50, v133, v13
    v_mfma_f32_16x16x32_bf16 v[102:105], v[208:211], v[204:207], 0
    v_mul_f32 v10, v51, v134
    v_mul_f32 v12, v51, v118
    v_mfma_f32_16x16x32_bf16 v[102:105], v[198:201], v[212:215], v[102:105]
    ds_read_b64 v[236:237], v219 offset:3520
    ds_read_b64 v[238:239], v219 offset:3528
    v_mul_f32 v11, v51, v135
    s_waitcnt lgkmcnt(3)
    v_mfma_f32_16x16x32_bf16 v[94:97], v[228:231], v[178:181], v[94:97]
    ds_read_b128 v[208:211], v221 offset:3840
    v_mul_f32 v13, v51, v119
    s_waitcnt lgkmcnt(3)
    v_mfma_f32_16x16x32_bf16 v[94:97], v[106:109], v[232:235], v[94:97]
    v_fma_f32 v118, v50, v118, -v10
    v_fma_f32 v134, v50, v134, v12
    v_mfma_f32_16x16x32_bf16 v[98:101], v[228:231], v[186:189], v[98:101]
    v_fma_f32 v119, v50, v119, -v11
    v_fma_f32 v135, v50, v135, v13
    v_mfma_f32_16x16x32_bf16 v[98:101], v[182:185], v[232:235], v[98:101]
    ds_read_b64 v[204:205], v219 offset:4032
    ds_read_b64 v[206:207], v219 offset:4040
    v_mul_f32 v10, v51, v136
    v_mfma_f32_16x16x32_bf16 v[102:105], v[228:231], v[194:197], v[102:105]
    ds_read_b128 v[198:201], v221 offset:1792
    v_mul_f32 v12, v51, v120
    v_mfma_f32_16x16x32_bf16 v[102:105], v[190:193], v[232:235], v[102:105]
    ds_read_b64 v[212:213], v219 offset:384
    ds_read_b64 v[214:215], v219 offset:392
    v_mul_f32 v11, v51, v137
    s_waitcnt lgkmcnt(6)
    v_mfma_f32_16x16x32_bf16 v[98:101], v[236:239], v[178:181], v[98:101]
    ds_read_b128 v[228:231], v222 offset:15872
    v_mul_f32 v13, v51, v121
    s_waitcnt lgkmcnt(6)
    v_mfma_f32_16x16x32_bf16 v[98:101], v[106:109], v[208:211], v[98:101]
    ds_read_b64 v[194:195], v219 offset:896
    ds_read_b64 v[196:197], v219 offset:904
    v_fma_f32 v120, v50, v120, -v10
    v_mfma_f32_16x16x32_bf16 v[102:105], v[236:239], v[186:189], v[102:105]
    ds_read_b128 v[190:193], v222 offset:13824
    v_fma_f32 v136, v50, v136, v12
    v_mfma_f32_16x16x32_bf16 v[102:105], v[182:185], v[208:211], v[102:105]
    ds_read_b64 v[232:233], v219 offset:1408
    ds_read_b64 v[234:235], v219 offset:1416
    v_fma_f32 v121, v50, v121, -v11
    s_waitcnt lgkmcnt(9)
    v_mfma_f32_16x16x32_bf16 v[102:105], v[204:207], v[178:181], v[102:105]
    ds_read_b128 v[236:239], v222 offset:11776
    v_fma_f32 v137, v50, v137, v13
    s_waitcnt lgkmcnt(9)
    v_mfma_f32_16x16x32_bf16 v[102:105], v[106:109], v[198:201], v[102:105]
    v_mul_f32 v10, v51, v138
    v_mul_f32 v12, v51, v122
    s_waitcnt lgkmcnt(6)
    v_mfma_f32_16x16x32_bf16 v[20:23], v[212:215], v[228:231], v[20:23]
    v_mul_f32 v11, v51, v139
    v_mul_f32 v13, v51, v123
    s_waitcnt lgkmcnt(4)
    v_mfma_f32_16x16x32_bf16 v[24:27], v[194:197], v[228:231], v[24:27]
    v_fma_f32 v122, v50, v122, -v10
    v_fma_f32 v138, v50, v138, v12
    s_waitcnt lgkmcnt(3)
    v_mfma_f32_16x16x32_bf16 v[24:27], v[212:215], v[190:193], v[24:27]
    ds_read_b64 v[186:187], v219 offset:1920
    ds_read_b64 v[188:189], v219 offset:1928
    v_fma_f32 v123, v50, v123, -v11
    v_mfma_f32_16x16x32_bf16 v[28:31], v[194:197], v[190:193], v[28:31]
    ds_read_b128 v[182:185], v222 offset:9728
    v_fma_f32 v139, v50, v139, v13
    s_waitcnt lgkmcnt(4)
    v_mfma_f32_16x16x32_bf16 v[28:31], v[232:235], v[228:231], v[28:31]
    v_mul_f32 v10, v51, v140
    v_mul_f32 v12, v51, v124
    s_waitcnt lgkmcnt(3)
    v_mfma_f32_16x16x32_bf16 v[28:31], v[212:215], v[236:239], v[28:31]
    v_mul_f32 v11, v51, v141
    v_mul_f32 v13, v51, v125
    v_mfma_f32_16x16x32_bf16 v[38:41], v[232:235], v[190:193], v[38:41]
    v_fma_f32 v124, v50, v124, -v10
    v_fma_f32 v140, v50, v140, v12
    v_mfma_f32_16x16x32_bf16 v[38:41], v[194:197], v[236:239], v[38:41]
    v_fma_f32 v125, v50, v125, -v11
    v_fma_f32 v141, v50, v141, v13
    v_mfma_f32_16x16x32_bf16 v[42:45], v[232:235], v[236:239], v[42:45]
    v_mul_f32 v10, v51, v142
    v_mul_f32 v12, v51, v126
    s_waitcnt lgkmcnt(1)
    v_mfma_f32_16x16x32_bf16 v[38:41], v[186:189], v[228:231], v[38:41]
    ds_read_b64 v[208:209], v219 offset:2432
    ds_read_b64 v[210:211], v219 offset:2440
    v_mul_f32 v11, v51, v143
    s_waitcnt lgkmcnt(2)
    v_mfma_f32_16x16x32_bf16 v[38:41], v[212:215], v[182:185], v[38:41]
    ds_read_b128 v[204:207], v222 offset:7680
    v_mul_f32 v13, v51, v127
    v_mfma_f32_16x16x32_bf16 v[42:45], v[186:189], v[190:193], v[42:45]
    v_fma_f32 v126, v50, v126, -v10
    v_fma_f32 v142, v50, v142, v12
    v_mfma_f32_16x16x32_bf16 v[42:45], v[194:197], v[182:185], v[42:45]
    v_fma_f32 v127, v50, v127, -v11
    v_fma_f32 v143, v50, v143, v13
    v_mfma_f32_16x16x32_bf16 v[94:97], v[186:189], v[236:239], v[94:97]
    v_subrev_u32 v62, 0, v3
    v_min_u32 v62, 0x7fff0000, v62
    v_mfma_f32_16x16x32_bf16 v[94:97], v[232:235], v[182:185], v[94:97]
    buffer_load_dwordx4 v[62:65], v62, s[28:31], 0 offen sc0 sc1
    v_subrev_u32 v66, 2048, v3
    v_mfma_f32_16x16x32_bf16 v[98:101], v[186:189], v[182:185], v[98:101]
    v_min_u32 v66, 0x7fff0000, v66
    buffer_load_dwordx4 v[66:69], v66, s[28:31], 0 offen sc0 sc1
    s_waitcnt lgkmcnt(1)
    v_mfma_f32_16x16x32_bf16 v[42:45], v[208:211], v[228:231], v[42:45]
    v_subrev_u32 v70, 4096, v3
    v_min_u32 v70, 0x7fff0000, v70
    s_waitcnt lgkmcnt(0)
    v_mfma_f32_16x16x32_bf16 v[42:45], v[212:215], v[204:207], v[42:45]
    ds_read_b64 v[178:179], v219 offset:2944
    ds_read_b64 v[180:181], v219 offset:2952
    buffer_load_dwordx4 v[70:73], v70, s[28:31], 0 offen sc0 sc1
    v_mfma_f32_16x16x32_bf16 v[94:97], v[208:211], v[190:193], v[94:97]
    ds_read_b128 v[106:109], v222 offset:5632
    v_subrev_u32 v74, 6144, v3
    v_mfma_f32_16x16x32_bf16 v[94:97], v[194:197], v[204:207], v[94:97]
    v_min_u32 v74, 0x7fff0000, v74
    buffer_load_dwordx4 v[74:77], v74, s[28:31], 0 offen sc0 sc1
    v_mfma_f32_16x16x32_bf16 v[98:101], v[208:211], v[236:239], v[98:101]
    v_subrev_u32 v78, 8192, v3
    v_min_u32 v78, 0x7fff0000, v78
    v_mfma_f32_16x16x32_bf16 v[98:101], v[232:235], v[204:207], v[98:101]
    buffer_load_dwordx4 v[78:81], v78, s[28:31], 0 offen sc0 sc1
    v_subrev_u32 v82, 10240, v3
    v_mfma_f32_16x16x32_bf16 v[102:105], v[208:211], v[182:185], v[102:105]
    v_min_u32 v82, 0x7fff0000, v82
    buffer_load_dwordx4 v[82:85], v82, s[28:31], 0 offen sc0 sc1
    v_mfma_f32_16x16x32_bf16 v[102:105], v[186:189], v[204:207], v[102:105]
    ds_read_b64 v[198:199], v219 offset:3456
    ds_read_b64 v[200:201], v219 offset:3464
    v_subrev_u32 v86, 12288, v3
    s_waitcnt lgkmcnt(3)
    v_mfma_f32_16x16x32_bf16 v[94:97], v[178:181], v[228:231], v[94:97]
    ds_read_b128 v[208:211], v222 offset:3584
    v_min_u32 v86, 0x7fff0000, v86
    s_waitcnt lgkmcnt(3)
    v_mfma_f32_16x16x32_bf16 v[94:97], v[212:215], v[106:109], v[94:97]
    buffer_load_dwordx4 v[86:89], v86, s[28:31], 0 offen sc0 sc1
    v_subrev_u32 v90, 14336, v3
    v_mfma_f32_16x16x32_bf16 v[98:101], v[178:181], v[190:193], v[98:101]
    v_min_u32 v90, 0x7fff0000, v90
    buffer_load_dwordx4 v[90:93], v90, s[28:31], 0 offen sc0 sc1
    v_mfma_f32_16x16x32_bf16 v[98:101], v[194:197], v[106:109], v[98:101]
    ds_read_b64 v[182:183], v219 offset:3968
    ds_read_b64 v[184:185], v219 offset:3976
    s_lshl_b32 s3, s44, 2
    v_mfma_f32_16x16x32_bf16 v[102:105], v[178:181], v[236:239], v[102:105]
    ds_read_b128 v[186:189], v222 offset:1536
    s_add_u32 s3, s3, s42
    v_mfma_f32_16x16x32_bf16 v[102:105], v[232:235], v[106:109], v[102:105]
    ds_read_b64 v[204:205], v219 offset:320
    ds_read_b64 v[206:207], v219 offset:328
    s_lshl_b32 s3, s3, 7
    s_waitcnt lgkmcnt(6)
    v_mfma_f32_16x16x32_bf16 v[98:101], v[198:201], v[228:231], v[98:101]
    ds_read_b128 v[178:181], v223 offset:15616
    s_add_u32 s3, s3, 8192
    s_waitcnt lgkmcnt(6)
    v_mfma_f32_16x16x32_bf16 v[98:101], v[212:215], v[208:211], v[98:101]
    ds_read_b64 v[236:237], v219 offset:832
    ds_read_b64 v[238:239], v219 offset:840
    v_and_b32 v203, 15, v1
    v_mfma_f32_16x16x32_bf16 v[102:105], v[198:201], v[190:193], v[102:105]
    ds_read_b128 v[232:235], v223 offset:13568
    v_lshlrev_b32 v203, 3, v203
    v_mfma_f32_16x16x32_bf16 v[102:105], v[194:197], v[208:211], v[102:105]
    ds_read_b64 v[106:107], v219 offset:1344
    ds_read_b64 v[108:109], v219 offset:1352
    v_add_u32 v203, s3, v203
    s_waitcnt lgkmcnt(9)
    v_mfma_f32_16x16x32_bf16 v[102:105], v[182:185], v[228:231], v[102:105]
    ds_read_b128 v[198:201], v223 offset:11520
    buffer_load_dwordx2 v[176:177], v203, s[48:51], 0 offen sc0 sc1
    s_waitcnt lgkmcnt(9)
    v_mfma_f32_16x16x32_bf16 v[102:105], v[212:215], v[186:189], v[102:105]
    v_mul_f32 v10, v51, v160
    v_mul_f32 v12, v51, v144
    s_waitcnt lgkmcnt(6)
    v_mfma_f32_16x16x32_bf16 v[20:23], v[204:207], v[178:181], v[20:23]
    v_mul_f32 v11, v51, v161
    v_mul_f32 v13, v51, v145
    s_waitcnt lgkmcnt(4)
    v_mfma_f32_16x16x32_bf16 v[24:27], v[236:239], v[178:181], v[24:27]
    v_fma_f32 v144, v50, v144, -v10
    v_fma_f32 v160, v50, v160, v12
    s_waitcnt lgkmcnt(3)
    v_mfma_f32_16x16x32_bf16 v[24:27], v[204:207], v[232:235], v[24:27]
    ds_read_b64 v[190:191], v219 offset:1856
    ds_read_b64 v[192:193], v219 offset:1864
    v_fma_f32 v145, v50, v145, -v11
    v_mfma_f32_16x16x32_bf16 v[28:31], v[236:239], v[232:235], v[28:31]
    ds_read_b128 v[194:197], v223 offset:9472
    v_fma_f32 v161, v50, v161, v13
    s_waitcnt lgkmcnt(4)
    v_mfma_f32_16x16x32_bf16 v[28:31], v[106:109], v[178:181], v[28:31]
    v_mul_f32 v10, v51, v162
    v_mul_f32 v12, v51, v146
    s_waitcnt lgkmcnt(3)
    v_mfma_f32_16x16x32_bf16 v[28:31], v[204:207], v[198:201], v[28:31]
    v_mul_f32 v11, v51, v163
    v_mul_f32 v13, v51, v147
    v_mfma_f32_16x16x32_bf16 v[38:41], v[106:109], v[232:235], v[38:41]
    v_fma_f32 v146, v50, v146, -v10
    v_fma_f32 v162, v50, v162, v12
    v_mfma_f32_16x16x32_bf16 v[38:41], v[236:239], v[198:201], v[38:41]
    v_fma_f32 v147, v50, v147, -v11
    v_fma_f32 v163, v50, v163, v13
    v_mfma_f32_16x16x32_bf16 v[42:45], v[106:109], v[198:201], v[42:45]
    v_mul_f32 v10, v51, v164
    v_mul_f32 v12, v51, v148
    s_waitcnt lgkmcnt(1)
    v_mfma_f32_16x16x32_bf16 v[38:41], v[190:193], v[178:181], v[38:41]
    ds_read_b64 v[208:209], v219 offset:2368
    ds_read_b64 v[210:211], v219 offset:2376
    v_mul_f32 v11, v51, v165
    s_waitcnt lgkmcnt(2)
    v_mfma_f32_16x16x32_bf16 v[38:41], v[204:207], v[194:197], v[38:41]
    ds_read_b128 v[182:185], v223 offset:7424
    v_mul_f32 v13, v51, v149
    v_mfma_f32_16x16x32_bf16 v[42:45], v[190:193], v[232:235], v[42:45]
    v_fma_f32 v148, v50, v148, -v10
    v_fma_f32 v164, v50, v164, v12
    v_mfma_f32_16x16x32_bf16 v[42:45], v[236:239], v[194:197], v[42:45]
    v_fma_f32 v149, v50, v149, -v11
    v_fma_f32 v165, v50, v165, v13
    v_mfma_f32_16x16x32_bf16 v[94:97], v[190:193], v[198:201], v[94:97]
    v_mul_f32 v10, v51, v166
    v_mul_f32 v12, v51, v150
    v_mfma_f32_16x16x32_bf16 v[94:97], v[106:109], v[194:197], v[94:97]
    v_mul_f32 v11, v51, v167
    v_mul_f32 v13, v51, v151
    v_mfma_f32_16x16x32_bf16 v[98:101], v[190:193], v[194:197], v[98:101]
    v_fma_f32 v150, v50, v150, -v10
    v_fma_f32 v166, v50, v166, v12
    s_waitcnt lgkmcnt(1)
    v_mfma_f32_16x16x32_bf16 v[42:45], v[208:211], v[178:181], v[42:45]
    v_fma_f32 v151, v50, v151, -v11
    v_fma_f32 v167, v50, v167, v13
    s_waitcnt lgkmcnt(0)
    v_mfma_f32_16x16x32_bf16 v[42:45], v[204:207], v[182:185], v[42:45]
    ds_read_b64 v[228:229], v219 offset:2880
    ds_read_b64 v[230:231], v219 offset:2888
    v_mul_f32 v10, v51, v168
    v_mfma_f32_16x16x32_bf16 v[94:97], v[208:211], v[232:235], v[94:97]
    ds_read_b128 v[212:215], v223 offset:5376
    v_mul_f32 v12, v51, v152
    v_mfma_f32_16x16x32_bf16 v[94:97], v[236:239], v[182:185], v[94:97]
    v_mul_f32 v11, v51, v169
    v_mul_f32 v13, v51, v153
    v_mfma_f32_16x16x32_bf16 v[98:101], v[208:211], v[198:201], v[98:101]
    v_fma_f32 v152, v50, v152, -v10
    v_fma_f32 v168, v50, v168, v12
    v_mfma_f32_16x16x32_bf16 v[98:101], v[106:109], v[182:185], v[98:101]
    v_fma_f32 v153, v50, v153, -v11
    v_fma_f32 v169, v50, v169, v13
    v_mfma_f32_16x16x32_bf16 v[102:105], v[208:211], v[194:197], v[102:105]
    v_mul_f32 v10, v51, v170
    v_mul_f32 v12, v51, v154
    v_mfma_f32_16x16x32_bf16 v[102:105], v[190:193], v[182:185], v[102:105]
    ds_read_b64 v[186:187], v219 offset:3392
    ds_read_b64 v[188:189], v219 offset:3400
    v_mul_f32 v11, v51, v171
    s_waitcnt lgkmcnt(3)
    v_mfma_f32_16x16x32_bf16 v[94:97], v[228:231], v[178:181], v[94:97]
    ds_read_b128 v[208:211], v223 offset:3328
    v_mul_f32 v13, v51, v155
    s_waitcnt lgkmcnt(3)
    v_mfma_f32_16x16x32_bf16 v[94:97], v[204:207], v[212:215], v[94:97]
    v_fma_f32 v154, v50, v154, -v10
    v_fma_f32 v170, v50, v170, v12
    v_mfma_f32_16x16x32_bf16 v[98:101], v[228:231], v[232:235], v[98:101]
    v_fma_f32 v155, v50, v155, -v11
    v_fma_f32 v171, v50, v171, v13
    v_mfma_f32_16x16x32_bf16 v[98:101], v[236:239], v[212:215], v[98:101]
    ds_read_b64 v[194:195], v219 offset:3904
    ds_read_b64 v[196:197], v219 offset:3912
    v_mul_f32 v10, v51, v172
    v_mfma_f32_16x16x32_bf16 v[102:105], v[228:231], v[198:201], v[102:105]
    ds_read_b128 v[190:193], v223 offset:1280
    v_mul_f32 v12, v51, v156
    v_mfma_f32_16x16x32_bf16 v[102:105], v[106:109], v[212:215], v[102:105]
    v_mul_f32 v11, v51, v173
    v_mul_f32 v13, v51, v157
    s_waitcnt lgkmcnt(4)
    v_mfma_f32_16x16x32_bf16 v[98:101], v[186:189], v[178:181], v[98:101]
    v_fma_f32 v156, v50, v156, -v10
    v_fma_f32 v172, v50, v172, v12
    s_waitcnt lgkmcnt(3)
    v_mfma_f32_16x16x32_bf16 v[98:101], v[204:207], v[208:211], v[98:101]
    v_fma_f32 v157, v50, v157, -v11
    v_fma_f32 v173, v50, v173, v13
    v_mfma_f32_16x16x32_bf16 v[102:105], v[186:189], v[232:235], v[102:105]
    v_mul_f32 v10, v51, v174
    v_mul_f32 v12, v51, v158
    v_mfma_f32_16x16x32_bf16 v[102:105], v[236:239], v[208:211], v[102:105]
    v_mul_f32 v11, v51, v175
    v_mul_f32 v13, v51, v159
    s_waitcnt lgkmcnt(1)
    v_mfma_f32_16x16x32_bf16 v[102:105], v[194:197], v[178:181], v[102:105]
    v_fma_f32 v158, v50, v158, -v10
    v_fma_f32 v174, v50, v174, v12
    s_waitcnt lgkmcnt(0)
    v_mfma_f32_16x16x32_bf16 v[102:105], v[204:207], v[190:193], v[102:105]
    v_fma_f32 v159, v50, v159, -v11
    v_fma_f32 v175, v50, v175, v13
    s_mov_b32 s56, s40
    s_mov_b32 s57, s41
    s_mov_b32 s58, 8388608
    s_mov_b32 s59, 131072
    s_lshr_b32 s14, s42, 1
    v_lshrrev_b32 v17, 5, v1
    v_lshlrev_b32 v17, 13, v17
    v_lshl_add_u32 v14, v6, 2, v17
    s_lshl_b32 s3, s14, 14
    s_add_u32 s3, s3, 98304
    v_add_u32 v14, s3, v14
    v_lshrrev_b32 v17, 4, v1
    v_lshlrev_b32 v17, 4, v17
    v_bfe_u32 v18, v1, 3, 1
    v_add_u32 v17, v17, v18
    v_and_b32 v16, 7, v1
    v_xor_b32 v18, v18, v16
    s_and_b32 s3, s42, 1
    s_lshl_b32 s3, s3, 3
    v_or_b32 v18, s3, v18
    v_lshlrev_b32 v18, 4, v18
    v_lshl_add_u32 v15, v17, 8, v18
    s_lshl_b32 s3, s14, 14
    s_add_u32 s3, s3, 98304
    v_add_u32 v15, s3, v15
    v_lshlrev_b32 v16, 4, v16
    v_lshl_add_u32 v16, v17, 12, v16
    s_lshl_b32 s6, s43, 19
    s_lshl_b32 s3, s14, 18
    s_add_u32 s6, s6, s3
    s_lshl_b32 s3, s44, 8
    s_add_u32 s6, s6, s3
    s_and_b32 s3, s42, 1
    s_lshl_b32 s3, s3, 7
    s_add_u32 s6, s6, s3
    s_lshl_b32 s3, s44, 2
    s_add_u32 s3, s3, s42
    s_lshl_b32 s3, s3, 16
    s_add_u32 s3, s3, 16777216
    s_add_u32 s60, s40, s3
    s_addc_u32 s61, s41, 0
    s_mov_b32 s62, 65536
    s_mov_b32 s63, 131072
    s_lshl_b32 s15, s44, 12
    s_mov_b32 s7, 0
    v_mov_b32 v4, 0
    s_waitcnt vmcnt(8)
    v_cmp_eq_u64 s[64:65], s[22:23], v[64:65]
    s_waitcnt vmcnt(7)
    v_cmp_eq_u64 s[66:67], s[22:23], v[68:69]
    s_waitcnt vmcnt(6)
    v_cmp_eq_u64 s[68:69], s[22:23], v[72:73]
    s_waitcnt vmcnt(5)
    v_cmp_eq_u64 s[70:71], s[22:23], v[76:77]
    v_addc_co_u32 v4, vcc, 0, v4, s[64:65]
    v_addc_co_u32 v4, vcc, 0, v4, s[66:67]
    v_addc_co_u32 v4, vcc, 0, v4, s[68:69]
    v_addc_co_u32 v4, vcc, 0, v4, s[70:71]
    s_waitcnt vmcnt(4)
    v_cmp_eq_u64 s[64:65], s[22:23], v[80:81]
    s_waitcnt vmcnt(3)
    v_cmp_eq_u64 s[66:67], s[22:23], v[84:85]
    s_waitcnt vmcnt(2)
    v_cmp_eq_u64 s[68:69], s[22:23], v[88:89]
    s_waitcnt vmcnt(1)
    v_cmp_eq_u64 s[70:71], s[22:23], v[92:93]
    v_addc_co_u32 v4, vcc, 0, v4, s[64:65]
    v_addc_co_u32 v4, vcc, 0, v4, s[66:67]
    v_addc_co_u32 v4, vcc, 0, v4, s[68:69]
    v_addc_co_u32 v4, vcc, 0, v4, s[70:71]
    v_cmp_ne_u32 vcc, v7, v4
    s_nop 4
    s_cbranch_vccz Lpolldone_gate_7
Lpoll_gate_8:
    v_subrev_u32 v62, 0, v3
    v_min_u32 v62, 0x7fff0000, v62
    buffer_load_dwordx4 v[62:65], v62, s[28:31], 0 offen sc0 sc1
    v_subrev_u32 v66, 2048, v3
    v_min_u32 v66, 0x7fff0000, v66
    buffer_load_dwordx4 v[66:69], v66, s[28:31], 0 offen sc0 sc1
    v_subrev_u32 v70, 4096, v3
    v_min_u32 v70, 0x7fff0000, v70
    buffer_load_dwordx4 v[70:73], v70, s[28:31], 0 offen sc0 sc1
    v_subrev_u32 v74, 6144, v3
    v_min_u32 v74, 0x7fff0000, v74
    buffer_load_dwordx4 v[74:77], v74, s[28:31], 0 offen sc0 sc1
    v_subrev_u32 v78, 8192, v3
    v_min_u32 v78, 0x7fff0000, v78
    buffer_load_dwordx4 v[78:81], v78, s[28:31], 0 offen sc0 sc1
    v_subrev_u32 v82, 10240, v3
    v_min_u32 v82, 0x7fff0000, v82
    buffer_load_dwordx4 v[82:85], v82, s[28:31], 0 offen sc0 sc1
    v_subrev_u32 v86, 12288, v3
    v_min_u32 v86, 0x7fff0000, v86
    buffer_load_dwordx4 v[86:89], v86, s[28:31], 0 offen sc0 sc1
    v_subrev_u32 v90, 14336, v3
    v_min_u32 v90, 0x7fff0000, v90
    buffer_load_dwordx4 v[90:93], v90, s[28:31], 0 offen sc0 sc1
    s_waitcnt vmcnt(0)
    v_mov_b32 v4, 0
    v_cmp_eq_u64 s[64:65], s[22:23], v[64:65]
    v_cmp_eq_u64 s[66:67], s[22:23], v[68:69]
    v_cmp_eq_u64 s[68:69], s[22:23], v[72:73]
    v_cmp_eq_u64 s[70:71], s[22:23], v[76:77]
    v_addc_co_u32 v4, vcc, 0, v4, s[64:65]
    v_addc_co_u32 v4, vcc, 0, v4, s[66:67]
    v_addc_co_u32 v4, vcc, 0, v4, s[68:69]
    v_addc_co_u32 v4, vcc, 0, v4, s[70:71]
    v_cmp_eq_u64 s[64:65], s[22:23], v[80:81]
    v_cmp_eq_u64 s[66:67], s[22:23], v[84:85]
    v_cmp_eq_u64 s[68:69], s[22:23], v[88:89]
    v_cmp_eq_u64 s[70:71], s[22:23], v[92:93]
    v_addc_co_u32 v4, vcc, 0, v4, s[64:65]
    v_addc_co_u32 v4, vcc, 0, v4, s[66:67]
    v_addc_co_u32 v4, vcc, 0, v4, s[68:69]
    v_addc_co_u32 v4, vcc, 0, v4, s[70:71]
    v_cmp_ne_u32 vcc, v7, v4
    s_add_u32 s7, s7, 1
    s_cmp_gt_u32 s7, 20000
    s_cbranch_scc1 Lpolldone_gate_7
    s_nop 1
    s_cbranch_vccnz Lpoll_gate_8
Lpolldone_gate_7:
    s_nop 4
    v_fma_f32 v18, -v9, v91, v86
    v_fma_f32 v19, v9, v90, v87
    v_fma_f32 v86, v8, v90, v18
    v_fma_f32 v87, v8, v91, v19
    v_fma_f32 v18, -v9, v87, v82
    v_fma_f32 v19, v9, v86, v83
    v_fma_f32 v82, v8, v86, v18
    v_fma_f32 v83, v8, v87, v19
    v_fma_f32 v18, -v9, v83, v78
    v_fma_f32 v19, v9, v82, v79
    v_fma_f32 v78, v8, v82, v18
    v_fma_f32 v79, v8, v83, v19
    v_fma_f32 v18, -v9, v79, v74
    v_fma_f32 v19, v9, v78, v75
    v_fma_f32 v74, v8, v78, v18
    v_fma_f32 v75, v8, v79, v19
    v_fma_f32 v18, -v9, v75, v70
    v_fma_f32 v19, v9, v74, v71
    v_fma_f32 v70, v8, v74, v18
    v_fma_f32 v71, v8, v75, v19
    v_fma_f32 v18, -v9, v71, v66
    v_fma_f32 v19, v9, v70, v67
    v_fma_f32 v66, v8, v70, v18
    v_fma_f32 v67, v8, v71, v19
    v_fma_f32 v18, -v9, v67, v62
    v_fma_f32 v19, v9, v66, v63
    v_fma_f32 v62, v8, v66, v18
    v_fma_f32 v63, v8, v67, v19
    v_mov_b32 v66, v62
    v_mov_b32 v67, v63
    s_nop 0
    v_permlane32_swap_b32 v62, v66
    v_permlane32_swap_b32 v63, v67
    v_fma_f32 v18, -v55, v67, v62
    v_fma_f32 v19, v55, v66, v63
    v_fma_f32 v32, v54, v66, v18
    v_fma_f32 v33, v54, v67, v19
    s_mov_b32 s5, 0
    s_waitcnt vmcnt(0)
    v_cmp_ne_u64 vcc, s[22:23], v[176:177]
    s_nop 4
    s_cbranch_vccz Lfdone_gate_9
Lfpoll_gate_10:
    buffer_load_dwordx2 v[176:177], v203, s[48:51], 0 offen sc0 sc1
    s_waitcnt vmcnt(0)
    v_cmp_ne_u64 vcc, s[22:23], v[176:177]
    s_nop 4
    s_add_u32 s5, s5, 1
    s_cmp_gt_u32 s5, 20000
    s_cbranch_scc1 Lfdone_gate_9
    s_cbranch_vccnz Lfpoll_gate_10
Lfdone_gate_9:
    v_pk_fma_f32 v[10:11], v[58:59], v[32:33], v[34:35] op_sel:[0,1,0] op_sel_hi:[1,1,1] neg_lo:[0,1,0] neg_hi:[0,1,0]
    v_pk_fma_f32 v[12:13], v[56:57], v[32:33], v[36:37] op_sel:[0,1,0] op_sel_hi:[1,1,1]
    v_pk_fma_f32 v[2:3], v[56:57], v[32:33], v[10:11] op_sel:[0,0,0] op_sel_hi:[1,0,1]
    v_pk_fma_f32 v[8:9], v[58:59], v[32:33], v[12:13] op_sel:[0,0,0] op_sel_hi:[1,0,1]
    v_pk_mul_f32 v[10:11], v[8:9], v[50:51] op_sel:[0,1] op_sel_hi:[1,1] neg_lo:[0,1] neg_hi:[0,1]
    v_pk_mul_f32 v[12:13], v[2:3], v[50:51] op_sel:[0,1] op_sel_hi:[1,1]
    v_pk_fma_f32 v[2:3], v[2:3], v[50:51], v[10:11] op_sel:[0,0,0] op_sel_hi:[1,0,1]
    v_pk_fma_f32 v[8:9], v[8:9], v[50:51], v[12:13] op_sel:[0,0,0] op_sel_hi:[1,0,1]
    v_pk_fma_f32 v[10:11], v[8:9], v[48:49], v[112:113] op_sel:[0,1,0] op_sel_hi:[1,1,1] neg_lo:[0,1,0] neg_hi:[0,1,0]
    v_pk_fma_f32 v[12:13], v[2:3], v[48:49], v[128:129] op_sel:[0,1,0] op_sel_hi:[1,1,1]
    v_pk_fma_f32 v[112:113], v[2:3], v[48:49], v[10:11] op_sel:[0,0,0] op_sel_hi:[1,0,1]
    v_pk_fma_f32 v[128:129], v[8:9], v[48:49], v[12:13] op_sel:[0,0,0] op_sel_hi:[1,0,1]
    buffer_load_dwordx4 a[0:3], v60, s[60:63], s15 offen offset:0 sc0 sc1
    v_pk_fma_f32 v[10:11], v[128:129], v[48:49], v[114:115] op_sel:[0,1,0] op_sel_hi:[1,1,1] neg_lo:[0,1,0] neg_hi:[0,1,0]
    v_pk_fma_f32 v[12:13], v[112:113], v[48:49], v[130:131] op_sel:[0,1,0] op_sel_hi:[1,1,1]
    v_pk_fma_f32 v[114:115], v[112:113], v[48:49], v[10:11] op_sel:[0,0,0] op_sel_hi:[1,0,1]
    v_pk_fma_f32 v[130:131], v[128:129], v[48:49], v[12:13] op_sel:[0,0,0] op_sel_hi:[1,0,1]
    v_cvt_pk_bf16_f32 v17, v112, -v128
    v_cvt_pk_bf16_f32 v18, v113, -v129
    ds_write2st64_b32 v14, v17, v18 offset0:0 offset1:16
    buffer_load_dwordx4 a[4:7], v60, s[60:63], s15 offen offset:1024 sc0 sc1
    v_pk_fma_f32 v[10:11], v[130:131], v[48:49], v[116:117] op_sel:[0,1,0] op_sel_hi:[1,1,1] neg_lo:[0,1,0] neg_hi:[0,1,0]
    v_pk_fma_f32 v[12:13], v[114:115], v[48:49], v[132:133] op_sel:[0,1,0] op_sel_hi:[1,1,1]
    v_pk_fma_f32 v[116:117], v[114:115], v[48:49], v[10:11] op_sel:[0,0,0] op_sel_hi:[1,0,1]
    v_pk_fma_f32 v[132:133], v[130:131], v[48:49], v[12:13] op_sel:[0,0,0] op_sel_hi:[1,0,1]
    v_xor_b32 v7, 16, v14
    v_cvt_pk_bf16_f32 v46, v114, -v130
    v_cvt_pk_bf16_f32 v47, v115, -v131
    ds_write2st64_b32 v7, v46, v47 offset0:1 offset1:17
    ds_read_b128 v[64:67], v15 offset:0
    buffer_load_dwordx4 a[8:11], v60, s[60:63], s15 offen offset:2048 sc0 sc1
    v_pk_fma_f32 v[10:11], v[132:133], v[48:49], v[118:119] op_sel:[0,1,0] op_sel_hi:[1,1,1] neg_lo:[0,1,0] neg_hi:[0,1,0]
    v_pk_fma_f32 v[12:13], v[116:117], v[48:49], v[134:135] op_sel:[0,1,0] op_sel_hi:[1,1,1]
    v_pk_fma_f32 v[118:119], v[116:117], v[48:49], v[10:11] op_sel:[0,0,0] op_sel_hi:[1,0,1]
    v_pk_fma_f32 v[134:135], v[132:133], v[48:49], v[12:13] op_sel:[0,0,0] op_sel_hi:[1,0,1]
    v_xor_b32 v4, 32, v14
    v_cvt_pk_bf16_f32 v17, v116, -v132
    v_cvt_pk_bf16_f32 v18, v117, -v133
    ds_write2st64_b32 v4, v17, v18 offset0:2 offset1:18
    s_waitcnt lgkmcnt(1)
    buffer_store_dwordx4 v[64:67], v16, s[56:59], s6 offen sc0 sc1
    buffer_load_dwordx4 a[12:15], v60, s[60:63], s15 offen offset:3072 sc0 sc1
    v_pk_fma_f32 v[10:11], v[134:135], v[48:49], v[120:121] op_sel:[0,1,0] op_sel_hi:[1,1,1] neg_lo:[0,1,0] neg_hi:[0,1,0]
    v_pk_fma_f32 v[12:13], v[118:119], v[48:49], v[136:137] op_sel:[0,1,0] op_sel_hi:[1,1,1]
    v_pk_fma_f32 v[120:121], v[118:119], v[48:49], v[10:11] op_sel:[0,0,0] op_sel_hi:[1,0,1]
    v_pk_fma_f32 v[136:137], v[134:135], v[48:49], v[12:13] op_sel:[0,0,0] op_sel_hi:[1,0,1]
    v_xor_b32 v7, 48, v14
    v_cvt_pk_bf16_f32 v46, v118, -v134
    v_cvt_pk_bf16_f32 v47, v119, -v135
    ds_write2st64_b32 v7, v46, v47 offset0:3 offset1:19
    v_xor_b32 v19, 32, v15
    ds_read_b128 v[68:71], v19 offset:512
    s_add_u32 s15, s15, 4096
    s_and_b32 s15, s15, 0xffff
    buffer_load_dwordx4 a[16:19], v60, s[60:63], s15 offen offset:0 sc0 sc1
    v_pk_fma_f32 v[10:11], v[136:137], v[48:49], v[122:123] op_sel:[0,1,0] op_sel_hi:[1,1,1] neg_lo:[0,1,0] neg_hi:[0,1,0]
    v_pk_fma_f32 v[12:13], v[120:121], v[48:49], v[138:139] op_sel:[0,1,0] op_sel_hi:[1,1,1]
    v_pk_fma_f32 v[122:123], v[120:121], v[48:49], v[10:11] op_sel:[0,0,0] op_sel_hi:[1,0,1]
    v_pk_fma_f32 v[138:139], v[136:137], v[48:49], v[12:13] op_sel:[0,0,0] op_sel_hi:[1,0,1]
    v_xor_b32 v4, 64, v14
    v_cvt_pk_bf16_f32 v17, v120, -v136
    v_cvt_pk_bf16_f32 v18, v121, -v137
    ds_write2st64_b32 v4, v17, v18 offset0:4 offset1:20
    s_add_u32 s6, s6, 8192
    s_waitcnt lgkmcnt(1)
    buffer_store_dwordx4 v[68:71], v16, s[56:59], s6 offen sc0 sc1
    buffer_load_dwordx4 a[20:23], v60, s[60:63], s15 offen offset:1024 sc0 sc1
    v_pk_fma_f32 v[10:11], v[138:139], v[48:49], v[124:125] op_sel:[0,1,0] op_sel_hi:[1,1,1] neg_lo:[0,1,0] neg_hi:[0,1,0]
    v_pk_fma_f32 v[12:13], v[122:123], v[48:49], v[140:141] op_sel:[0,1,0] op_sel_hi:[1,1,1]
    v_pk_fma_f32 v[124:125], v[122:123], v[48:49], v[10:11] op_sel:[0,0,0] op_sel_hi:[1,0,1]
    v_pk_fma_f32 v[140:141], v[138:139], v[48:49], v[12:13] op_sel:[0,0,0] op_sel_hi:[1,0,1]
    v_xor_b32 v7, 80, v14
    v_cvt_pk_bf16_f32 v46, v122, -v138
    v_cvt_pk_bf16_f32 v47, v123, -v139
    ds_write2st64_b32 v7, v46, v47 offset0:5 offset1:21
    v_xor_b32 v19, 64, v15
    ds_read_b128 v[64:67], v19 offset:1024
    buffer_load_dwordx4 a[24:27], v60, s[60:63], s15 offen offset:2048 sc0 sc1
    v_pk_fma_f32 v[10:11], v[140:141], v[48:49], v[126:127] op_sel:[0,1,0] op_sel_hi:[1,1,1] neg_lo:[0,1,0] neg_hi:[0,1,0]
    v_pk_fma_f32 v[12:13], v[124:125], v[48:49], v[142:143] op_sel:[0,1,0] op_sel_hi:[1,1,1]
    v_pk_fma_f32 v[126:127], v[124:125], v[48:49], v[10:11] op_sel:[0,0,0] op_sel_hi:[1,0,1]
    v_pk_fma_f32 v[142:143], v[140:141], v[48:49], v[12:13] op_sel:[0,0,0] op_sel_hi:[1,0,1]
    v_xor_b32 v4, 96, v14
    v_cvt_pk_bf16_f32 v17, v124, -v140
    v_cvt_pk_bf16_f32 v18, v125, -v141
    ds_write2st64_b32 v4, v17, v18 offset0:6 offset1:22
    s_add_u32 s6, s6, 8192
    s_waitcnt lgkmcnt(1)
    buffer_store_dwordx4 v[64:67], v16, s[56:59], s6 offen sc0 sc1
    buffer_load_dwordx4 a[28:31], v60, s[60:63], s15 offen offset:3072 sc0 sc1
    v_pk_fma_f32 v[10:11], v[142:143], v[48:49], v[144:145] op_sel:[0,1,0] op_sel_hi:[1,1,1] neg_lo:[0,1,0] neg_hi:[0,1,0]
    v_pk_fma_f32 v[12:13], v[126:127], v[48:49], v[160:161] op_sel:[0,1,0] op_sel_hi:[1,1,1]
    v_pk_fma_f32 v[144:145], v[126:127], v[48:49], v[10:11] op_sel:[0,0,0] op_sel_hi:[1,0,1]
    v_pk_fma_f32 v[160:161], v[142:143], v[48:49], v[12:13] op_sel:[0,0,0] op_sel_hi:[1,0,1]
    v_xor_b32 v7, 112, v14
    v_cvt_pk_bf16_f32 v46, v126, -v142
    v_cvt_pk_bf16_f32 v47, v127, -v143
    ds_write2st64_b32 v7, v46, v47 offset0:7 offset1:23
    v_xor_b32 v19, 96, v15
    ds_read_b128 v[68:71], v19 offset:1536
    v_pk_fma_f32 v[10:11], v[160:161], v[48:49], v[146:147] op_sel:[0,1,0] op_sel_hi:[1,1,1] neg_lo:[0,1,0] neg_hi:[0,1,0]
    v_pk_fma_f32 v[12:13], v[144:145], v[48:49], v[162:163] op_sel:[0,1,0] op_sel_hi:[1,1,1]
    v_pk_fma_f32 v[146:147], v[144:145], v[48:49], v[10:11] op_sel:[0,0,0] op_sel_hi:[1,0,1]
    v_pk_fma_f32 v[162:163], v[160:161], v[48:49], v[12:13] op_sel:[0,0,0] op_sel_hi:[1,0,1]
    v_xor_b32 v4, 128, v14
    v_cvt_pk_bf16_f32 v17, v144, -v160
    v_cvt_pk_bf16_f32 v18, v145, -v161
    ds_write2st64_b32 v4, v17, v18 offset0:8 offset1:24
    s_add_u32 s6, s6, 8192
    s_waitcnt lgkmcnt(1)
    buffer_store_dwordx4 v[68:71], v16, s[56:59], s6 offen sc0 sc1
    v_pk_fma_f32 v[10:11], v[162:163], v[48:49], v[148:149] op_sel:[0,1,0] op_sel_hi:[1,1,1] neg_lo:[0,1,0] neg_hi:[0,1,0]
    v_pk_fma_f32 v[12:13], v[146:147], v[48:49], v[164:165] op_sel:[0,1,0] op_sel_hi:[1,1,1]
    v_pk_fma_f32 v[148:149], v[146:147], v[48:49], v[10:11] op_sel:[0,0,0] op_sel_hi:[1,0,1]
    v_pk_fma_f32 v[164:165], v[162:163], v[48:49], v[12:13] op_sel:[0,0,0] op_sel_hi:[1,0,1]
    v_xor_b32 v7, 144, v14
    v_cvt_pk_bf16_f32 v46, v146, -v162
    v_cvt_pk_bf16_f32 v47, v147, -v163
    ds_write2st64_b32 v7, v46, v47 offset0:9 offset1:25
    v_xor_b32 v19, 128, v15
    ds_read_b128 v[64:67], v19 offset:2048
    v_pk_fma_f32 v[10:11], v[164:165], v[48:49], v[150:151] op_sel:[0,1,0] op_sel_hi:[1,1,1] neg_lo:[0,1,0] neg_hi:[0,1,0]
    v_pk_fma_f32 v[12:13], v[148:149], v[48:49], v[166:167] op_sel:[0,1,0] op_sel_hi:[1,1,1]
    v_pk_fma_f32 v[150:151], v[148:149], v[48:49], v[10:11] op_sel:[0,0,0] op_sel_hi:[1,0,1]
    v_pk_fma_f32 v[166:167], v[164:165], v[48:49], v[12:13] op_sel:[0,0,0] op_sel_hi:[1,0,1]
    v_xor_b32 v4, 160, v14
    v_cvt_pk_bf16_f32 v17, v148, -v164
    v_cvt_pk_bf16_f32 v18, v149, -v165
    ds_write2st64_b32 v4, v17, v18 offset0:10 offset1:26
    s_add_u32 s6, s6, 8192
    s_waitcnt lgkmcnt(1)
    buffer_store_dwordx4 v[64:67], v16, s[56:59], s6 offen sc0 sc1
    v_pk_fma_f32 v[10:11], v[166:167], v[48:49], v[152:153] op_sel:[0,1,0] op_sel_hi:[1,1,1] neg_lo:[0,1,0] neg_hi:[0,1,0]
    v_pk_fma_f32 v[12:13], v[150:151], v[48:49], v[168:169] op_sel:[0,1,0] op_sel_hi:[1,1,1]
    v_pk_fma_f32 v[152:153], v[150:151], v[48:49], v[10:11] op_sel:[0,0,0] op_sel_hi:[1,0,1]
    v_pk_fma_f32 v[168:169], v[166:167], v[48:49], v[12:13] op_sel:[0,0,0] op_sel_hi:[1,0,1]
    v_xor_b32 v7, 176, v14
    v_cvt_pk_bf16_f32 v46, v150, -v166
    v_cvt_pk_bf16_f32 v47, v151, -v167
    ds_write2st64_b32 v7, v46, v47 offset0:11 offset1:27
    v_xor_b32 v19, 160, v15
    ds_read_b128 v[68:71], v19 offset:2560
    v_pk_fma_f32 v[10:11], v[168:169], v[48:49], v[154:155] op_sel:[0,1,0] op_sel_hi:[1,1,1] neg_lo:[0,1,0] neg_hi:[0,1,0]
    v_pk_fma_f32 v[12:13], v[152:153], v[48:49], v[170:171] op_sel:[0,1,0] op_sel_hi:[1,1,1]
    v_pk_fma_f32 v[154:155], v[152:153], v[48:49], v[10:11] op_sel:[0,0,0] op_sel_hi:[1,0,1]
    v_pk_fma_f32 v[170:171], v[168:169], v[48:49], v[12:13] op_sel:[0,0,0] op_sel_hi:[1,0,1]
    v_xor_b32 v4, 192, v14
    v_cvt_pk_bf16_f32 v17, v152, -v168
    v_cvt_pk_bf16_f32 v18, v153, -v169
    ds_write2st64_b32 v4, v17, v18 offset0:12 offset1:28
    s_add_u32 s6, s6, 8192
    s_waitcnt lgkmcnt(1)
    buffer_store_dwordx4 v[68:71], v16, s[56:59], s6 offen sc0 sc1
    v_pk_fma_f32 v[10:11], v[170:171], v[48:49], v[156:157] op_sel:[0,1,0] op_sel_hi:[1,1,1] neg_lo:[0,1,0] neg_hi:[0,1,0]
    v_pk_fma_f32 v[12:13], v[154:155], v[48:49], v[172:173] op_sel:[0,1,0] op_sel_hi:[1,1,1]
    v_pk_fma_f32 v[156:157], v[154:155], v[48:49], v[10:11] op_sel:[0,0,0] op_sel_hi:[1,0,1]
    v_pk_fma_f32 v[172:173], v[170:171], v[48:49], v[12:13] op_sel:[0,0,0] op_sel_hi:[1,0,1]
    v_xor_b32 v7, 208, v14
    v_cvt_pk_bf16_f32 v46, v154, -v170
    v_cvt_pk_bf16_f32 v47, v155, -v171
    ds_write2st64_b32 v7, v46, v47 offset0:13 offset1:29
    v_xor_b32 v19, 192, v15
    ds_read_b128 v[64:67], v19 offset:3072
    v_pk_fma_f32 v[10:11], v[172:173], v[48:49], v[158:159] op_sel:[0,1,0] op_sel_hi:[1,1,1] neg_lo:[0,1,0] neg_hi:[0,1,0]
    v_pk_fma_f32 v[12:13], v[156:157], v[48:49], v[174:175] op_sel:[0,1,0] op_sel_hi:[1,1,1]
    v_pk_fma_f32 v[158:159], v[156:157], v[48:49], v[10:11] op_sel:[0,0,0] op_sel_hi:[1,0,1]
    v_pk_fma_f32 v[174:175], v[172:173], v[48:49], v[12:13] op_sel:[0,0,0] op_sel_hi:[1,0,1]
    v_xor_b32 v4, 224, v14
    v_cvt_pk_bf16_f32 v17, v156, -v172
    v_cvt_pk_bf16_f32 v18, v157, -v173
    ds_write2st64_b32 v4, v17, v18 offset0:14 offset1:30
    s_add_u32 s6, s6, 8192
    s_waitcnt lgkmcnt(1)
    buffer_store_dwordx4 v[64:67], v16, s[56:59], s6 offen sc0 sc1
    v_xor_b32 v7, 240, v14
    v_cvt_pk_bf16_f32 v46, v158, -v174
    v_cvt_pk_bf16_f32 v47, v159, -v175
    ds_write2st64_b32 v7, v46, v47 offset0:15 offset1:31
    v_xor_b32 v19, 224, v15
    ds_read_b128 v[68:71], v19 offset:3584
    s_add_u32 s6, s6, 8192
    s_waitcnt lgkmcnt(0)
    buffer_store_dwordx4 v[68:71], v16, s[56:59], s6 offen sc0 sc1
    ds_read_b64 v[48:49], v219 offset:256
    ds_read_b64 v[50:51], v219 offset:264
    ds_read_b128 v[52:55], v224 offset:15360
    ds_read_b64 v[56:57], v219 offset:768
    ds_read_b64 v[58:59], v219 offset:776
    ds_read_b128 v[62:65], v224 offset:13312
    ds_read_b64 v[66:67], v219 offset:1280
    ds_read_b64 v[68:69], v219 offset:1288
    ds_read_b128 v[70:73], v224 offset:11264
    s_waitcnt lgkmcnt(6)
    v_mfma_f32_16x16x32_bf16 v[20:23], v[48:51], v[52:55], v[20:23]
    s_add_u32 s15, s15, 4096
    s_and_b32 s15, s15, 0xffff
    buffer_load_dwordx4 a[32:35], v60, s[60:63], s15 offen offset:0 sc0 sc1
    s_waitcnt lgkmcnt(4)
    v_mfma_f32_16x16x32_bf16 v[24:27], v[56:59], v[52:55], v[24:27]
    s_lshl_b32 s5, s43, 4
    s_waitcnt lgkmcnt(3)
    v_mfma_f32_16x16x32_bf16 v[24:27], v[48:51], v[62:65], v[24:27]
    ds_read_b64 v[74:75], v219 offset:1792
    ds_read_b64 v[76:77], v219 offset:1800
    v_mfma_f32_16x16x32_bf16 v[28:31], v[56:59], v[62:65], v[28:31]
    ds_read_b128 v[78:81], v224 offset:9216
    s_waitcnt lgkmcnt(4)
    v_mfma_f32_16x16x32_bf16 v[28:31], v[66:69], v[52:55], v[28:31]
    s_add_u32 s5, s5, s44
    s_waitcnt lgkmcnt(3)
    v_mfma_f32_16x16x32_bf16 v[28:31], v[48:51], v[70:73], v[28:31]
    buffer_load_dwordx4 a[36:39], v60, s[60:63], s15 offen offset:1024 sc0 sc1
    v_mfma_f32_16x16x32_bf16 v[38:41], v[66:69], v[62:65], v[38:41]
    s_lshl_b32 s5, s5, 2
    v_mfma_f32_16x16x32_bf16 v[38:41], v[56:59], v[70:73], v[38:41]
    s_add_u32 s5, s5, s42
    v_mfma_f32_16x16x32_bf16 v[42:45], v[66:69], v[70:73], v[42:45]
    buffer_load_dwordx4 a[40:43], v60, s[60:63], s15 offen offset:2048 sc0 sc1
    s_waitcnt lgkmcnt(1)
    v_mfma_f32_16x16x32_bf16 v[38:41], v[74:77], v[52:55], v[38:41]
    ds_read_b64 v[82:83], v219 offset:2304
    ds_read_b64 v[84:85], v219 offset:2312
    s_waitcnt lgkmcnt(2)
    v_mfma_f32_16x16x32_bf16 v[38:41], v[48:51], v[78:81], v[38:41]
    ds_read_b128 v[86:89], v224 offset:7168
    v_mfma_f32_16x16x32_bf16 v[42:45], v[74:77], v[62:65], v[42:45]
    s_lshl_b32 s5, s5, 3
    v_mfma_f32_16x16x32_bf16 v[42:45], v[56:59], v[78:81], v[42:45]
    s_add_u32 s5, s5, 16384
    v_mfma_f32_16x16x32_bf16 v[94:97], v[74:77], v[70:73], v[94:97]
    buffer_load_dwordx4 a[44:47], v60, s[60:63], s15 offen offset:3072 sc0 sc1
    v_mfma_f32_16x16x32_bf16 v[94:97], v[66:69], v[78:81], v[94:97]
    s_lshl_b32 s6, s44, 4
    v_mfma_f32_16x16x32_bf16 v[98:101], v[74:77], v[78:81], v[98:101]
    s_add_u32 s6, s6, s43
    s_waitcnt lgkmcnt(1)
    v_mfma_f32_16x16x32_bf16 v[42:45], v[82:85], v[52:55], v[42:45]
    s_add_u32 s15, s15, 4096
    s_and_b32 s15, s15, 0xffff
    buffer_load_dwordx4 a[48:51], v60, s[60:63], s15 offen offset:0 sc0 sc1
    s_waitcnt lgkmcnt(0)
    v_mfma_f32_16x16x32_bf16 v[42:45], v[48:51], v[86:89], v[42:45]
    ds_read_b64 v[90:91], v219 offset:2816
    ds_read_b64 v[92:93], v219 offset:2824
    v_mfma_f32_16x16x32_bf16 v[94:97], v[82:85], v[62:65], v[94:97]
    ds_read_b128 v[106:109], v224 offset:5120
    v_mfma_f32_16x16x32_bf16 v[94:97], v[56:59], v[86:89], v[94:97]
    s_lshl_b32 s6, s6, 2
    v_mfma_f32_16x16x32_bf16 v[98:101], v[82:85], v[70:73], v[98:101]
    s_add_u32 s6, s6, s42
    v_mfma_f32_16x16x32_bf16 v[98:101], v[66:69], v[86:89], v[98:101]
    buffer_load_dwordx4 a[52:55], v60, s[60:63], s15 offen offset:1024 sc0 sc1
    v_mfma_f32_16x16x32_bf16 v[102:105], v[82:85], v[78:81], v[102:105]
    s_lshl_b32 s6, s6, 3
    v_mfma_f32_16x16x32_bf16 v[102:105], v[74:77], v[86:89], v[102:105]
    ds_read_b64 v[110:111], v219 offset:3328
    ds_read_b64 v[112:113], v219 offset:3336
    s_waitcnt lgkmcnt(3)
    v_mfma_f32_16x16x32_bf16 v[94:97], v[90:93], v[52:55], v[94:97]
    ds_read_b128 v[114:117], v224 offset:3072
    s_waitcnt lgkmcnt(3)
    v_mfma_f32_16x16x32_bf16 v[94:97], v[48:51], v[106:109], v[94:97]
    s_add_u32 s6, s6, 24576
    v_mfma_f32_16x16x32_bf16 v[98:101], v[90:93], v[62:65], v[98:101]
    buffer_load_dwordx4 a[56:59], v60, s[60:63], s15 offen offset:2048 sc0 sc1
    v_mfma_f32_16x16x32_bf16 v[98:101], v[56:59], v[106:109], v[98:101]
    ds_read_b64 v[82:83], v219 offset:3840
    ds_read_b64 v[84:85], v219 offset:3848
    v_mfma_f32_16x16x32_bf16 v[102:105], v[90:93], v[70:73], v[102:105]
    ds_read_b128 v[78:81], v224 offset:1024
    v_mfma_f32_16x16x32_bf16 v[102:105], v[66:69], v[106:109], v[102:105]
    ds_read_b64 v[74:75], v219 offset:192
    ds_read_b64 v[76:77], v219 offset:200
    s_waitcnt lgkmcnt(6)
    v_mfma_f32_16x16x32_bf16 v[98:101], v[110:113], v[52:55], v[98:101]
    ds_read_b128 v[86:89], v221 offset:15104
    s_waitcnt lgkmcnt(6)
    v_mfma_f32_16x16x32_bf16 v[98:101], v[48:51], v[114:117], v[98:101]
    ds_read_b64 v[90:91], v219 offset:704
    ds_read_b64 v[92:93], v219 offset:712
    v_mfma_f32_16x16x32_bf16 v[102:105], v[110:113], v[62:65], v[102:105]
    ds_read_b128 v[70:73], v221 offset:13056
    v_mfma_f32_16x16x32_bf16 v[102:105], v[56:59], v[114:117], v[102:105]
    ds_read_b64 v[66:67], v219 offset:1216
    ds_read_b64 v[68:69], v219 offset:1224
    s_waitcnt lgkmcnt(9)
    v_mfma_f32_16x16x32_bf16 v[102:105], v[82:85], v[52:55], v[102:105]
    ds_read_b128 v[106:109], v221 offset:11008
    s_waitcnt lgkmcnt(9)
    v_mfma_f32_16x16x32_bf16 v[102:105], v[48:51], v[78:81], v[102:105]
    s_lshl_b32 s3, s43, 9
    s_waitcnt lgkmcnt(6)
    v_mfma_f32_16x16x32_bf16 v[20:23], v[74:77], v[86:89], v[20:23]
    s_add_u32 s3, s3, 16384
    s_waitcnt lgkmcnt(4)
    v_mfma_f32_16x16x32_bf16 v[24:27], v[90:93], v[86:89], v[24:27]
    buffer_load_dwordx4 a[60:63], v60, s[60:63], s15 offen offset:3072 sc0 sc1
    s_waitcnt lgkmcnt(3)
    v_mfma_f32_16x16x32_bf16 v[24:27], v[74:77], v[70:73], v[24:27]
    ds_read_b64 v[110:111], v219 offset:1728
    ds_read_b64 v[112:113], v219 offset:1736
    v_mfma_f32_16x16x32_bf16 v[28:31], v[90:93], v[70:73], v[28:31]
    ds_read_b128 v[62:65], v221 offset:8960
    s_waitcnt lgkmcnt(4)
    v_mfma_f32_16x16x32_bf16 v[28:31], v[66:69], v[86:89], v[28:31]
    v_lshrrev_b32 v203, 1, v60
    s_waitcnt lgkmcnt(3)
    v_mfma_f32_16x16x32_bf16 v[28:31], v[74:77], v[106:109], v[28:31]
    v_add_u32 v203, s3, v203
    v_mfma_f32_16x16x32_bf16 v[38:41], v[66:69], v[70:73], v[38:41]
    s_add_u32 s15, s15, 4096
    s_and_b32 s15, s15, 0xffff
    buffer_load_dwordx4 a[64:67], v60, s[60:63], s15 offen offset:0 sc0 sc1
    v_mfma_f32_16x16x32_bf16 v[38:41], v[90:93], v[106:109], v[38:41]
    v_lshrrev_b32 v2, 4, v1
    v_mfma_f32_16x16x32_bf16 v[42:45], v[66:69], v[106:109], v[42:45]
    v_and_b32 v3, 15, v1
    s_waitcnt lgkmcnt(1)
    v_mfma_f32_16x16x32_bf16 v[38:41], v[110:113], v[86:89], v[38:41]
    ds_read_b64 v[56:57], v219 offset:2240
    ds_read_b64 v[58:59], v219 offset:2248
    s_waitcnt lgkmcnt(2)
    v_mfma_f32_16x16x32_bf16 v[38:41], v[74:77], v[62:65], v[38:41]
    ds_read_b128 v[114:117], v221 offset:6912
    v_mfma_f32_16x16x32_bf16 v[42:45], v[110:113], v[70:73], v[42:45]
    buffer_load_dwordx4 a[68:71], v60, s[60:63], s15 offen offset:1024 sc0 sc1
    v_mfma_f32_16x16x32_bf16 v[42:45], v[90:93], v[62:65], v[42:45]
    v_xor_b32 v3, v3, v2
    v_mfma_f32_16x16x32_bf16 v[94:97], v[110:113], v[106:109], v[94:97]
    v_lshlrev_b32 v3, 4, v3
    v_mfma_f32_16x16x32_bf16 v[94:97], v[66:69], v[62:65], v[94:97]
    buffer_load_dwordx4 a[72:75], v60, s[60:63], s15 offen offset:2048 sc0 sc1
    v_mfma_f32_16x16x32_bf16 v[98:101], v[110:113], v[62:65], v[98:101]
    v_lshl_add_u32 v6, v2, 12, v3
    s_waitcnt lgkmcnt(1)
    v_mfma_f32_16x16x32_bf16 v[42:45], v[56:59], v[86:89], v[42:45]
    v_xor_b32 v2, 64, v6
    s_waitcnt lgkmcnt(0)
    v_mfma_f32_16x16x32_bf16 v[42:45], v[74:77], v[114:117], v[42:45]
    ds_read_b64 v[82:83], v219 offset:2752
    ds_read_b64 v[84:85], v219 offset:2760
    v_mfma_f32_16x16x32_bf16 v[94:97], v[56:59], v[70:73], v[94:97]
    ds_read_b128 v[52:55], v221 offset:4864
    v_mfma_f32_16x16x32_bf16 v[94:97], v[90:93], v[114:117], v[94:97]
    buffer_load_dwordx4 a[76:79], v60, s[60:63], s15 offen offset:3072 sc0 sc1
    v_mfma_f32_16x16x32_bf16 v[98:101], v[56:59], v[106:109], v[98:101]
    v_add_u32 v7, 16384, v2
    v_mfma_f32_16x16x32_bf16 v[98:101], v[66:69], v[114:117], v[98:101]
    v_xor_b32 v2, 128, v6
    v_mfma_f32_16x16x32_bf16 v[102:105], v[56:59], v[62:65], v[102:105]
    s_add_u32 s15, s15, 4096
    s_and_b32 s15, s15, 0xffff
    buffer_load_dwordx4 a[80:83], v60, s[60:63], s15 offen offset:0 sc0 sc1
    v_mfma_f32_16x16x32_bf16 v[102:105], v[110:113], v[114:117], v[102:105]
    ds_read_b64 v[48:49], v219 offset:3264
    ds_read_b64 v[50:51], v219 offset:3272
    s_waitcnt lgkmcnt(3)
    v_mfma_f32_16x16x32_bf16 v[94:97], v[82:85], v[86:89], v[94:97]
    ds_read_b128 v[78:81], v221 offset:2816
    s_waitcnt lgkmcnt(3)
    v_mfma_f32_16x16x32_bf16 v[94:97], v[74:77], v[52:55], v[94:97]
    v_add_u32 v8, 32768, v2
    v_mfma_f32_16x16x32_bf16 v[98:101], v[82:85], v[70:73], v[98:101]
    v_xor_b32 v2, 192, v6
    v_mfma_f32_16x16x32_bf16 v[98:101], v[90:93], v[52:55], v[98:101]
    ds_read_b64 v[56:57], v219 offset:3776
    ds_read_b64 v[58:59], v219 offset:3784
    v_mfma_f32_16x16x32_bf16 v[102:105], v[82:85], v[106:109], v[102:105]
    ds_read_b128 v[62:65], v221 offset:768
    v_mfma_f32_16x16x32_bf16 v[102:105], v[66:69], v[52:55], v[102:105]
    ds_read_b64 v[110:111], v219 offset:128
    ds_read_b64 v[112:113], v219 offset:136
    s_waitcnt lgkmcnt(6)
    v_mfma_f32_16x16x32_bf16 v[98:101], v[48:51], v[86:89], v[98:101]
    ds_read_b128 v[114:117], v222 offset:14848
    s_waitcnt lgkmcnt(6)
    v_mfma_f32_16x16x32_bf16 v[98:101], v[74:77], v[78:81], v[98:101]
    ds_read_b64 v[82:83], v219 offset:640
    ds_read_b64 v[84:85], v219 offset:648
    v_mfma_f32_16x16x32_bf16 v[102:105], v[48:51], v[70:73], v[102:105]
    ds_read_b128 v[106:109], v222 offset:12800
    v_mfma_f32_16x16x32_bf16 v[102:105], v[90:93], v[78:81], v[102:105]
    ds_read_b64 v[66:67], v219 offset:1152
    ds_read_b64 v[68:69], v219 offset:1160
    s_waitcnt lgkmcnt(9)
    v_mfma_f32_16x16x32_bf16 v[102:105], v[56:59], v[86:89], v[102:105]
    ds_read_b128 v[52:55], v222 offset:10752
    s_waitcnt lgkmcnt(9)
    v_mfma_f32_16x16x32_bf16 v[102:105], v[74:77], v[62:65], v[102:105]
    buffer_load_dwordx4 a[84:87], v60, s[60:63], s15 offen offset:1024 sc0 sc1
    s_waitcnt lgkmcnt(6)
    v_mfma_f32_16x16x32_bf16 v[20:23], v[110:113], v[114:117], v[20:23]
    v_add_u32 v9, 49152, v2
    s_waitcnt lgkmcnt(4)
    v_mfma_f32_16x16x32_bf16 v[24:27], v[82:85], v[114:117], v[24:27]
    s_lshl_b32 s7, s43, 19
    s_waitcnt lgkmcnt(3)
    v_mfma_f32_16x16x32_bf16 v[24:27], v[110:113], v[106:109], v[24:27]
    ds_read_b64 v[48:49], v219 offset:1664
    ds_read_b64 v[50:51], v219 offset:1672
    v_mfma_f32_16x16x32_bf16 v[28:31], v[82:85], v[106:109], v[28:31]
    ds_read_b128 v[70:73], v222 offset:8704
    s_waitcnt lgkmcnt(4)
    v_mfma_f32_16x16x32_bf16 v[28:31], v[66:69], v[114:117], v[28:31]
    buffer_load_dwordx4 a[88:91], v60, s[60:63], s15 offen offset:2048 sc0 sc1
    s_waitcnt lgkmcnt(3)
    v_mfma_f32_16x16x32_bf16 v[28:31], v[110:113], v[52:55], v[28:31]
    s_lshl_b32 s3, s42, 17
    v_mfma_f32_16x16x32_bf16 v[38:41], v[66:69], v[106:109], v[38:41]
    s_add_u32 s7, s7, s3
    v_mfma_f32_16x16x32_bf16 v[38:41], v[82:85], v[52:55], v[38:41]
    buffer_load_dwordx4 a[92:95], v60, s[60:63], s15 offen offset:3072 sc0 sc1
    v_mfma_f32_16x16x32_bf16 v[42:45], v[66:69], v[52:55], v[42:45]
    s_lshl_b32 s14, s44, 8
    s_waitcnt lgkmcnt(1)
    v_mfma_f32_16x16x32_bf16 v[38:41], v[48:51], v[114:117], v[38:41]
    ds_read_b64 v[90:91], v219 offset:2176
    ds_read_b64 v[92:93], v219 offset:2184
    s_waitcnt lgkmcnt(2)
    v_mfma_f32_16x16x32_bf16 v[38:41], v[110:113], v[70:73], v[38:41]
    ds_read_b128 v[78:81], v222 offset:6656
    v_mfma_f32_16x16x32_bf16 v[42:45], v[48:51], v[106:109], v[42:45]
    s_lshl_b32 s19, s42, 13
    v_mfma_f32_16x16x32_bf16 v[42:45], v[82:85], v[70:73], v[42:45]
    s_add_u32 s15, s15, 4096
    s_and_b32 s15, s15, 0xffff
    buffer_load_dwordx4 a[96:99], v60, s[60:63], s15 offen offset:0 sc0 sc1
    v_mfma_f32_16x16x32_bf16 v[94:97], v[48:51], v[52:55], v[94:97]
    s_lshr_b32 s28, s42, 1
    v_mfma_f32_16x16x32_bf16 v[94:97], v[66:69], v[70:73], v[94:97]
    v_and_b32 v37, 31, v1
    v_mfma_f32_16x16x32_bf16 v[98:101], v[48:51], v[70:73], v[98:101]
    buffer_load_dwordx4 a[100:103], v60, s[60:63], s15 offen offset:1024 sc0 sc1
    s_waitcnt lgkmcnt(1)
    v_mfma_f32_16x16x32_bf16 v[42:45], v[90:93], v[114:117], v[42:45]
    v_lshrrev_b32 v46, 5, v1
    s_waitcnt lgkmcnt(0)
    v_mfma_f32_16x16x32_bf16 v[42:45], v[110:113], v[78:81], v[42:45]
    ds_read_b64 v[56:57], v219 offset:2688
    ds_read_b64 v[58:59], v219 offset:2696
    v_mfma_f32_16x16x32_bf16 v[94:97], v[90:93], v[106:109], v[94:97]
    ds_read_b128 v[86:89], v222 offset:4608
    v_mfma_f32_16x16x32_bf16 v[94:97], v[82:85], v[78:81], v[94:97]
    v_lshlrev_b32 v46, 2, v46
    v_mfma_f32_16x16x32_bf16 v[98:101], v[90:93], v[52:55], v[98:101]
    buffer_load_dwordx4 a[104:107], v60, s[60:63], s15 offen offset:2048 sc0 sc1
    v_mfma_f32_16x16x32_bf16 v[98:101], v[66:69], v[78:81], v[98:101]
    s_lshl_b32 s3, s28, 3
    v_mfma_f32_16x16x32_bf16 v[102:105], v[90:93], v[70:73], v[102:105]
    v_add_u32 v46, s3, v46
    v_mfma_f32_16x16x32_bf16 v[102:105], v[48:51], v[78:81], v[102:105]
    ds_read_b64 v[74:75], v219 offset:3200
    ds_read_b64 v[76:77], v219 offset:3208
    s_waitcnt lgkmcnt(3)
    v_mfma_f32_16x16x32_bf16 v[94:97], v[56:59], v[114:117], v[94:97]
    ds_read_b128 v[62:65], v222 offset:2560
    s_waitcnt lgkmcnt(3)
    v_mfma_f32_16x16x32_bf16 v[94:97], v[110:113], v[86:89], v[94:97]
    buffer_load_dwordx4 a[108:111], v60, s[60:63], s15 offen offset:3072 sc0 sc1
    v_mfma_f32_16x16x32_bf16 v[98:101], v[56:59], v[106:109], v[98:101]
    v_and_b32 v47, 15, v37
    v_mfma_f32_16x16x32_bf16 v[98:101], v[82:85], v[86:89], v[98:101]
    ds_read_b64 v[90:91], v219 offset:3712
    ds_read_b64 v[92:93], v219 offset:3720
    v_mfma_f32_16x16x32_bf16 v[102:105], v[56:59], v[52:55], v[102:105]
    ds_read_b128 v[70:73], v222 offset:512
    v_mfma_f32_16x16x32_bf16 v[102:105], v[66:69], v[86:89], v[102:105]
    ds_read_b64 v[48:49], v219 offset:64
    ds_read_b64 v[50:51], v219 offset:72
    s_waitcnt lgkmcnt(6)
    v_mfma_f32_16x16x32_bf16 v[98:101], v[74:77], v[114:117], v[98:101]
    ds_read_b128 v[78:81], v223 offset:14592
    s_waitcnt lgkmcnt(6)
    v_mfma_f32_16x16x32_bf16 v[98:101], v[110:113], v[62:65], v[98:101]
    ds_read_b64 v[56:57], v219 offset:576
    ds_read_b64 v[58:59], v219 offset:584
    v_mfma_f32_16x16x32_bf16 v[102:105], v[74:77], v[106:109], v[102:105]
    ds_read_b128 v[52:55], v223 offset:12544
    v_mfma_f32_16x16x32_bf16 v[102:105], v[82:85], v[62:65], v[102:105]
    ds_read_b64 v[66:67], v219 offset:1088
    ds_read_b64 v[68:69], v219 offset:1096
    s_waitcnt lgkmcnt(9)
    v_mfma_f32_16x16x32_bf16 v[102:105], v[90:93], v[114:117], v[102:105]
    ds_read_b128 v[86:89], v223 offset:10496
    s_waitcnt lgkmcnt(9)
    v_mfma_f32_16x16x32_bf16 v[102:105], v[110:113], v[70:73], v[102:105]
    v_xor_b32 v46, v46, v47
    s_waitcnt lgkmcnt(6)
    v_mfma_f32_16x16x32_bf16 v[20:23], v[48:51], v[78:81], v[20:23]
    s_add_u32 s15, s15, 4096
    s_and_b32 s15, s15, 0xffff
    buffer_load_dwordx4 a[112:115], v60, s[60:63], s15 offen offset:0 sc0 sc1
    s_waitcnt lgkmcnt(4)
    v_mfma_f32_16x16x32_bf16 v[24:27], v[56:59], v[78:81], v[24:27]
    v_lshlrev_b32 v46, 4, v46
    s_waitcnt lgkmcnt(3)
    v_mfma_f32_16x16x32_bf16 v[24:27], v[48:51], v[52:55], v[24:27]
    ds_read_b64 v[74:75], v219 offset:1600
    ds_read_b64 v[76:77], v219 offset:1608
    v_mfma_f32_16x16x32_bf16 v[28:31], v[56:59], v[52:55], v[28:31]
    ds_read_b128 v[106:109], v223 offset:8448
    s_waitcnt lgkmcnt(4)
    v_mfma_f32_16x16x32_bf16 v[28:31], v[66:69], v[78:81], v[28:31]
    v_lshl_add_u32 v46, v37, 8, v46
    s_waitcnt lgkmcnt(3)
    v_mfma_f32_16x16x32_bf16 v[28:31], v[48:51], v[86:89], v[28:31]
    buffer_load_dwordx4 a[116:119], v60, s[60:63], s15 offen offset:1024 sc0 sc1
    v_mfma_f32_16x16x32_bf16 v[38:41], v[66:69], v[52:55], v[38:41]
    s_lshl_b32 s3, s28, 14
    v_mfma_f32_16x16x32_bf16 v[38:41], v[56:59], v[86:89], v[38:41]
    v_add_u32 v46, s3, v46
    v_mfma_f32_16x16x32_bf16 v[42:45], v[66:69], v[86:89], v[42:45]
    buffer_load_dwordx4 a[120:123], v60, s[60:63], s15 offen offset:2048 sc0 sc1
    s_waitcnt lgkmcnt(1)
    v_mfma_f32_16x16x32_bf16 v[38:41], v[74:77], v[78:81], v[38:41]
    ds_read_b64 v[82:83], v219 offset:2112
    ds_read_b64 v[84:85], v219 offset:2120
    s_waitcnt lgkmcnt(2)
    v_mfma_f32_16x16x32_bf16 v[38:41], v[48:51], v[106:109], v[38:41]
    ds_read_b128 v[62:65], v223 offset:6400
    v_mfma_f32_16x16x32_bf16 v[42:45], v[74:77], v[52:55], v[42:45]
    v_xor_b32 v4, 0, v46
    v_mfma_f32_16x16x32_bf16 v[42:45], v[56:59], v[106:109], v[42:45]
    v_xor_b32 v17, 0x4000, v4
    v_mfma_f32_16x16x32_bf16 v[94:97], v[74:77], v[86:89], v[94:97]
    buffer_load_dwordx4 a[124:127], v60, s[60:63], s15 offen offset:3072 sc0 sc1
    v_mfma_f32_16x16x32_bf16 v[94:97], v[66:69], v[106:109], v[94:97]
    v_add_u32 v13, 65536, v4
    v_mfma_f32_16x16x32_bf16 v[98:101], v[74:77], v[106:109], v[98:101]
    v_add_u32 v33, 65536, v17
    s_waitcnt lgkmcnt(1)
    v_mfma_f32_16x16x32_bf16 v[42:45], v[82:85], v[78:81], v[42:45]
    v_xor_b32 v10, 16, v46
    s_waitcnt lgkmcnt(0)
    v_mfma_f32_16x16x32_bf16 v[42:45], v[48:51], v[62:65], v[42:45]
    ds_read_b64 v[90:91], v219 offset:2624
    ds_read_b64 v[92:93], v219 offset:2632
    v_mfma_f32_16x16x32_bf16 v[94:97], v[82:85], v[52:55], v[94:97]
    ds_read_b128 v[114:117], v223 offset:4352
    v_mfma_f32_16x16x32_bf16 v[94:97], v[56:59], v[62:65], v[94:97]
    v_xor_b32 v18, 0x4000, v10
    v_mfma_f32_16x16x32_bf16 v[98:101], v[82:85], v[86:89], v[98:101]
    v_add_u32 v14, 65536, v10
    v_mfma_f32_16x16x32_bf16 v[98:101], v[66:69], v[62:65], v[98:101]
    v_add_u32 v34, 65536, v18
    v_mfma_f32_16x16x32_bf16 v[102:105], v[82:85], v[106:109], v[102:105]
    v_xor_b32 v11, 32, v46
    v_mfma_f32_16x16x32_bf16 v[102:105], v[74:77], v[62:65], v[102:105]
    ds_read_b64 v[110:111], v219 offset:3136
    ds_read_b64 v[112:113], v219 offset:3144
    s_waitcnt lgkmcnt(3)
    v_mfma_f32_16x16x32_bf16 v[94:97], v[90:93], v[78:81], v[94:97]
    ds_read_b128 v[70:73], v223 offset:2304
    s_waitcnt lgkmcnt(3)
    v_mfma_f32_16x16x32_bf16 v[94:97], v[48:51], v[114:117], v[94:97]
    v_xor_b32 v19, 0x4000, v11
    v_mfma_f32_16x16x32_bf16 v[98:101], v[90:93], v[52:55], v[98:101]
    v_add_u32 v15, 65536, v11
    v_mfma_f32_16x16x32_bf16 v[98:101], v[56:59], v[114:117], v[98:101]
    ds_read_b64 v[82:83], v219 offset:3648
    ds_read_b64 v[84:85], v219 offset:3656
    v_mfma_f32_16x16x32_bf16 v[102:105], v[90:93], v[86:89], v[102:105]
    ds_read_b128 v[106:109], v223 offset:256
    v_mfma_f32_16x16x32_bf16 v[102:105], v[66:69], v[114:117], v[102:105]
    ds_read_b64 v[74:75], v219 offset:0
    ds_read_b64 v[76:77], v219 offset:8
    s_waitcnt lgkmcnt(6)
    v_mfma_f32_16x16x32_bf16 v[98:101], v[110:113], v[78:81], v[98:101]
    ds_read_b128 v[62:65], v224 offset:14336
    s_waitcnt lgkmcnt(6)
    v_mfma_f32_16x16x32_bf16 v[98:101], v[48:51], v[70:73], v[98:101]
    ds_read_b64 v[90:91], v219 offset:512
    ds_read_b64 v[92:93], v219 offset:520
    v_mfma_f32_16x16x32_bf16 v[102:105], v[110:113], v[52:55], v[102:105]
    ds_read_b128 v[86:89], v224 offset:12288
    v_mfma_f32_16x16x32_bf16 v[102:105], v[56:59], v[70:73], v[102:105]
    ds_read_b64 v[66:67], v219 offset:1024
    ds_read_b64 v[68:69], v219 offset:1032
    s_waitcnt lgkmcnt(9)
    v_mfma_f32_16x16x32_bf16 v[102:105], v[82:85], v[78:81], v[102:105]
    ds_read_b128 v[114:117], v224 offset:10240
    s_waitcnt lgkmcnt(9)
    v_mfma_f32_16x16x32_bf16 v[102:105], v[48:51], v[106:109], v[102:105]
    v_add_u32 v35, 65536, v19
    s_waitcnt lgkmcnt(6)
    v_mfma_f32_16x16x32_bf16 v[20:23], v[74:77], v[62:65], v[20:23]
    v_xor_b32 v12, 48, v46
    s_waitcnt lgkmcnt(4)
    v_mfma_f32_16x16x32_bf16 v[24:27], v[90:93], v[62:65], v[24:27]
    v_xor_b32 v32, 0x4000, v12
    s_waitcnt lgkmcnt(3)
    v_mfma_f32_16x16x32_bf16 v[24:27], v[74:77], v[86:89], v[24:27]
    ds_read_b64 v[110:111], v219 offset:1536
    ds_read_b64 v[112:113], v219 offset:1544
    v_mfma_f32_16x16x32_bf16 v[28:31], v[90:93], v[86:89], v[28:31]
    ds_read_b128 v[52:55], v224 offset:8192
    s_waitcnt lgkmcnt(4)
    v_mfma_f32_16x16x32_bf16 v[28:31], v[66:69], v[62:65], v[28:31]
    v_add_u32 v16, 65536, v12
    s_waitcnt lgkmcnt(3)
    v_mfma_f32_16x16x32_bf16 v[28:31], v[74:77], v[114:117], v[28:31]
    v_add_u32 v36, 65536, v32
    v_mfma_f32_16x16x32_bf16 v[38:41], v[66:69], v[86:89], v[38:41]
    s_waitcnt vmcnt(24)
    v_mfma_f32_16x16x32_bf16 v[38:41], v[90:93], v[114:117], v[38:41]
    v_mov_b32 v176, s22
    v_mov_b32 v177, s23
    s_mov_b64 s[30:31], exec
    s_mov_b64 exec, 1
    buffer_store_dwordx2 v[176:177], v5, s[48:51], s5 offen sc0 sc1
    s_mov_b64 exec, s[30:31]
    v_mfma_f32_16x16x32_bf16 v[42:45], v[66:69], v[114:117], v[42:45]
    s_add_u32 s15, s15, 4096
    s_and_b32 s15, s15, 0xffff
    buffer_load_dwordx4 a[128:131], v60, s[60:63], s15 offen offset:0 sc0 sc1
    s_waitcnt lgkmcnt(1)
    v_mfma_f32_16x16x32_bf16 v[38:41], v[110:113], v[62:65], v[38:41]
    ds_read_b64 v[56:57], v219 offset:2048
    ds_read_b64 v[58:59], v219 offset:2056
    s_waitcnt lgkmcnt(2)
    v_mfma_f32_16x16x32_bf16 v[38:41], v[74:77], v[52:55], v[38:41]
    ds_read_b128 v[70:73], v224 offset:6144
    v_mfma_f32_16x16x32_bf16 v[42:45], v[110:113], v[86:89], v[42:45]
    v_mfma_f32_16x16x32_bf16 v[42:45], v[90:93], v[52:55], v[42:45]
    v_mfma_f32_16x16x32_bf16 v[94:97], v[110:113], v[114:117], v[94:97]
    buffer_load_dwordx4 a[132:135], v60, s[60:63], s15 offen offset:1024 sc0 sc1
    v_mfma_f32_16x16x32_bf16 v[94:97], v[66:69], v[52:55], v[94:97]
    v_mfma_f32_16x16x32_bf16 v[98:101], v[110:113], v[52:55], v[98:101]
    s_waitcnt lgkmcnt(1)
    v_mfma_f32_16x16x32_bf16 v[42:45], v[56:59], v[62:65], v[42:45]
    buffer_load_dwordx4 a[136:139], v60, s[60:63], s15 offen offset:2048 sc0 sc1
    s_waitcnt lgkmcnt(0)
    v_mfma_f32_16x16x32_bf16 v[42:45], v[74:77], v[70:73], v[42:45]
    ds_read_b64 v[82:83], v219 offset:2560
    ds_read_b64 v[84:85], v219 offset:2568
    v_mfma_f32_16x16x32_bf16 v[94:97], v[56:59], v[86:89], v[94:97]
    ds_read_b128 v[78:81], v224 offset:4096
    v_mfma_f32_16x16x32_bf16 v[94:97], v[90:93], v[70:73], v[94:97]
    v_mfma_f32_16x16x32_bf16 v[98:101], v[56:59], v[114:117], v[98:101]
    v_mfma_f32_16x16x32_bf16 v[98:101], v[66:69], v[70:73], v[98:101]
    buffer_load_dwordx4 a[140:143], v60, s[60:63], s15 offen offset:3072 sc0 sc1
    v_mfma_f32_16x16x32_bf16 v[102:105], v[56:59], v[52:55], v[102:105]
    v_mfma_f32_16x16x32_bf16 v[102:105], v[110:113], v[70:73], v[102:105]
    ds_read_b64 v[48:49], v219 offset:3072
    ds_read_b64 v[50:51], v219 offset:3080
    s_waitcnt lgkmcnt(3)
    v_mfma_f32_16x16x32_bf16 v[94:97], v[82:85], v[62:65], v[94:97]
    ds_read_b128 v[106:109], v224 offset:2048
    s_waitcnt lgkmcnt(3)
    v_mfma_f32_16x16x32_bf16 v[94:97], v[74:77], v[78:81], v[94:97]
    v_mfma_f32_16x16x32_bf16 v[98:101], v[82:85], v[86:89], v[98:101]
    s_add_u32 s15, s15, 4096
    s_and_b32 s15, s15, 0xffff
    buffer_load_dwordx4 a[144:147], v60, s[60:63], s15 offen offset:0 sc0 sc1
    v_mfma_f32_16x16x32_bf16 v[98:101], v[90:93], v[78:81], v[98:101]
    ds_read_b64 v[56:57], v219 offset:3584
    ds_read_b64 v[58:59], v219 offset:3592
    v_mfma_f32_16x16x32_bf16 v[102:105], v[82:85], v[114:117], v[102:105]
    ds_read_b128 v[52:55], v224 offset:0
    v_mfma_f32_16x16x32_bf16 v[102:105], v[66:69], v[78:81], v[102:105]
    s_waitcnt lgkmcnt(4)
    v_mfma_f32_16x16x32_bf16 v[98:101], v[48:51], v[62:65], v[98:101]
    s_waitcnt lgkmcnt(3)
    v_mfma_f32_16x16x32_bf16 v[98:101], v[74:77], v[106:109], v[98:101]
    buffer_load_dwordx4 a[148:151], v60, s[60:63], s15 offen offset:1024 sc0 sc1
    v_mfma_f32_16x16x32_bf16 v[102:105], v[48:51], v[86:89], v[102:105]
    v_mfma_f32_16x16x32_bf16 v[102:105], v[90:93], v[106:109], v[102:105]
    s_waitcnt lgkmcnt(1)
    v_mfma_f32_16x16x32_bf16 v[102:105], v[56:59], v[62:65], v[102:105]
    buffer_load_dwordx4 a[152:155], v60, s[60:63], s15 offen offset:2048 sc0 sc1
    s_waitcnt lgkmcnt(0)
    v_mfma_f32_16x16x32_bf16 v[102:105], v[74:77], v[52:55], v[102:105]
    buffer_load_dwordx4 a[156:159], v60, s[60:63], s15 offen offset:3072 sc0 sc1
    s_add_u32 s15, s15, 4096
    s_and_b32 s15, s15, 0xffff
    buffer_load_dwordx4 a[160:163], v60, s[60:63], s15 offen offset:0 sc0 sc1
    buffer_load_dwordx4 a[164:167], v60, s[60:63], s15 offen offset:1024 sc0 sc1
    buffer_load_dwordx4 a[168:171], v60, s[60:63], s15 offen offset:2048 sc0 sc1
    buffer_load_dwordx4 a[172:175], v60, s[60:63], s15 offen offset:3072 sc0 sc1
    s_add_u32 s15, s15, 4096
    s_and_b32 s15, s15, 0xffff
    buffer_load_dwordx4 a[176:179], v60, s[60:63], s15 offen offset:0 sc0 sc1
    buffer_load_dwordx4 a[180:183], v60, s[60:63], s15 offen offset:1024 sc0 sc1
    buffer_load_dwordx4 a[184:187], v60, s[60:63], s15 offen offset:2048 sc0 sc1
    buffer_load_dwordx4 a[188:191], v60, s[60:63], s15 offen offset:3072 sc0 sc1
    buffer_load_dwordx2 v[176:177], v203, s[48:51], 0 offen sc0 sc1
    s_barrier
    s_mov_b32 s30, 0
    s_waitcnt vmcnt(0)
    v_cmp_ne_u64 vcc, s[22:23], v[176:177]
    s_nop 4
    s_cbranch_vccz Lfdone_gate_11
Lfpoll_gate_12:
    buffer_load_dwordx2 v[176:177], v203, s[48:51], 0 offen sc0 sc1
    s_waitcnt vmcnt(0)
    v_cmp_ne_u64 vcc, s[22:23], v[176:177]
    s_nop 4
    s_add_u32 s30, s30, 1
    s_cmp_gt_u32 s30, 20000
    s_cbranch_scc1 Lfdone_gate_11
    s_cbranch_vccnz Lfpoll_gate_12
Lfdone_gate_11:
    s_add_u32 s14, s14, 256
    s_and_b32 s14, s14, 0xfff
    s_add_u32 s16, s7, s14
    s_add_u32 m0, s19, 0
    s_nop 0
    buffer_load_dwordx4 v6, s[56:59], s16 offen sc0 sc1 lds
    s_add_u32 m0, s19, 1024
    s_nop 0
    buffer_load_dwordx4 v7, s[56:59], s16 offen sc0 sc1 lds
    s_add_u32 m0, s19, 2048
    s_nop 0
    buffer_load_dwordx4 v8, s[56:59], s16 offen sc0 sc1 lds
    s_add_u32 m0, s19, 3072
    s_nop 0
    buffer_load_dwordx4 v9, s[56:59], s16 offen sc0 sc1 lds
    s_add_u32 s17, s16, 65536
    s_add_u32 m0, s19, 4096
    s_nop 0
    buffer_load_dwordx4 v6, s[56:59], s17 offen sc0 sc1 lds
    s_add_u32 m0, s19, 5120
    s_nop 0
    buffer_load_dwordx4 v7, s[56:59], s17 offen sc0 sc1 lds
    s_add_u32 m0, s19, 6144
    s_nop 0
    buffer_load_dwordx4 v8, s[56:59], s17 offen sc0 sc1 lds
    s_add_u32 m0, s19, 7168
    s_nop 0
    buffer_load_dwordx4 v9, s[56:59], s17 offen sc0 sc1 lds
    s_add_u32 s14, s14, 256
    s_and_b32 s14, s14, 0xfff
    s_add_u32 s16, s7, s14
    s_add_u32 m0, s19, 32768
    s_nop 0
    buffer_load_dwordx4 v6, s[56:59], s16 offen sc0 sc1 lds
    s_add_u32 m0, s19, 33792
    s_nop 0
    buffer_load_dwordx4 v7, s[56:59], s16 offen sc0 sc1 lds
    s_add_u32 m0, s19, 34816
    s_nop 0
    buffer_load_dwordx4 v8, s[56:59], s16 offen sc0 sc1 lds
    s_add_u32 m0, s19, 35840
    s_nop 0
    buffer_load_dwordx4 v9, s[56:59], s16 offen sc0 sc1 lds
    s_add_u32 s17, s16, 65536
    s_add_u32 m0, s19, 36864
    s_nop 0
    buffer_load_dwordx4 v6, s[56:59], s17 offen sc0 sc1 lds
    s_add_u32 m0, s19, 37888
    s_nop 0
    buffer_load_dwordx4 v7, s[56:59], s17 offen sc0 sc1 lds
    s_add_u32 m0, s19, 38912
    s_nop 0
    buffer_load_dwordx4 v8, s[56:59], s17 offen sc0 sc1 lds
    s_add_u32 m0, s19, 39936
    s_nop 0
    buffer_load_dwordx4 v9, s[56:59], s17 offen sc0 sc1 lds
    s_add_u32 s28, s40, 12582912
    s_addc_u32 s29, s41, 0
    s_mov_b32 s30, 4194304
    s_mov_b32 s31, 131072
    ds_read_b64 v[2:3], v225 offset:14336
    ds_read_b64 v[46:47], v225 offset:12288
    ds_read_b64 v[48:49], v225 offset:10240
    ds_read_b64 v[50:51], v225 offset:8192
    ds_read_b64 v[52:53], v225 offset:6144
    ds_read_b64 v[54:55], v225 offset:4096
    ds_read_b64 v[56:57], v225 offset:2048
    ds_read_b64 v[58:59], v225 offset:0
    s_mov_b32 s5, s13
    s_waitcnt lgkmcnt(7)
    v_and_b32 v62, s4, v3
    v_lshlrev_b32 v63, 16, v3
    v_and_b32 v64, s4, v2
    v_lshlrev_b32 v65, 16, v2
    v_fmac_f32 v20, v61, v62
    v_fmac_f32 v21, v61, v63
    v_fmac_f32 v22, v61, v64
    v_fmac_f32 v23, v61, v65
    v_cvt_pk_bf16_f32 v66, v20, v21
    v_cvt_pk_bf16_f32 v67, v22, v23
    s_waitcnt lgkmcnt(6)
    v_and_b32 v62, s4, v47
    v_lshlrev_b32 v63, 16, v47
    v_and_b32 v64, s4, v46
    v_lshlrev_b32 v65, 16, v46
    v_fmac_f32 v24, v61, v62
    v_fmac_f32 v25, v61, v63
    v_fmac_f32 v26, v61, v64
    v_fmac_f32 v27, v61, v65
    v_cvt_pk_bf16_f32 v68, v24, v25
    v_cvt_pk_bf16_f32 v69, v26, v27
    s_nop 0
    v_permlane16_swap_b32 v66, v68
    v_permlane16_swap_b32 v67, v69
    buffer_store_dwordx4 v[66:69], v226, s[28:31], s5 offen offset:0 sc0 sc1
    s_waitcnt lgkmcnt(5)
    v_and_b32 v62, s4, v49
    v_lshlrev_b32 v63, 16, v49
    v_and_b32 v64, s4, v48
    v_lshlrev_b32 v65, 16, v48
    v_fmac_f32 v28, v61, v62
    v_fmac_f32 v29, v61, v63
    v_fmac_f32 v30, v61, v64
    v_fmac_f32 v31, v61, v65
    v_cvt_pk_bf16_f32 v70, v28, v29
    v_cvt_pk_bf16_f32 v71, v30, v31
    s_waitcnt lgkmcnt(4)
    v_and_b32 v62, s4, v51
    v_lshlrev_b32 v63, 16, v51
    v_and_b32 v64, s4, v50
    v_lshlrev_b32 v65, 16, v50
    v_fmac_f32 v38, v61, v62
    v_fmac_f32 v39, v61, v63
    v_fmac_f32 v40, v61, v64
    v_fmac_f32 v41, v61, v65
    v_cvt_pk_bf16_f32 v72, v38, v39
    v_cvt_pk_bf16_f32 v73, v40, v41
    s_nop 0
    v_permlane16_swap_b32 v70, v72
    v_permlane16_swap_b32 v71, v73
    buffer_store_dwordx4 v[70:73], v226, s[28:31], s5 offen offset:1024 sc0 sc1
    s_waitcnt lgkmcnt(3)
    v_and_b32 v62, s4, v53
    v_lshlrev_b32 v63, 16, v53
    v_and_b32 v64, s4, v52
    v_lshlrev_b32 v65, 16, v52
    v_fmac_f32 v42, v61, v62
    v_fmac_f32 v43, v61, v63
    v_fmac_f32 v44, v61, v64
    v_fmac_f32 v45, v61, v65
    v_cvt_pk_bf16_f32 v66, v42, v43
    v_cvt_pk_bf16_f32 v67, v44, v45
    s_waitcnt lgkmcnt(2)
    v_and_b32 v62, s4, v55
    v_lshlrev_b32 v63, 16, v55
    v_and_b32 v64, s4, v54
    v_lshlrev_b32 v65, 16, v54
    v_fmac_f32 v94, v61, v62
    v_fmac_f32 v95, v61, v63
    v_fmac_f32 v96, v61, v64
    v_fmac_f32 v97, v61, v65
    v_cvt_pk_bf16_f32 v68, v94, v95
    v_cvt_pk_bf16_f32 v69, v96, v97
    s_nop 0
    v_permlane16_swap_b32 v66, v68
    v_permlane16_swap_b32 v67, v69
    buffer_store_dwordx4 v[66:69], v226, s[28:31], s5 offen offset:2048 sc0 sc1
    s_waitcnt lgkmcnt(1)
    v_and_b32 v62, s4, v57
    v_lshlrev_b32 v63, 16, v57
    v_and_b32 v64, s4, v56
    v_lshlrev_b32 v65, 16, v56
    v_fmac_f32 v98, v61, v62
    v_fmac_f32 v99, v61, v63
    v_fmac_f32 v100, v61, v64
    v_fmac_f32 v101, v61, v65
    v_cvt_pk_bf16_f32 v70, v98, v99
    v_cvt_pk_bf16_f32 v71, v100, v101
    s_waitcnt lgkmcnt(0)
    v_and_b32 v62, s4, v59
    v_lshlrev_b32 v63, 16, v59
    v_and_b32 v64, s4, v58
    v_lshlrev_b32 v65, 16, v58
    v_fmac_f32 v102, v61, v62
    v_fmac_f32 v103, v61, v63
    v_fmac_f32 v104, v61, v64
    v_fmac_f32 v105, v61, v65
    v_cvt_pk_bf16_f32 v72, v102, v103
    v_cvt_pk_bf16_f32 v73, v104, v105
    s_nop 0
    v_permlane16_swap_b32 v70, v72
    v_permlane16_swap_b32 v71, v73
    buffer_store_dwordx4 v[70:73], v226, s[28:31], s5 offen offset:3072 sc0 sc1
    s_barrier
    ds_read_b128 v[20:23], v13 offset:32768
    ds_read_b128 v[24:27], v13 offset:40960
    ds_read_b128 v[28:31], v33 offset:32768
    ds_read_b128 v[40:43], v33 offset:40960
    s_waitcnt lgkmcnt(3)
    v_mfma_f32_32x32x16_bf16 v[64:79], v[20:23], a[0:3], 0
    ds_read_b128 v[44:47], v14 offset:32768
    ds_read_b128 v[48:51], v14 offset:40960
    s_add_u32 s15, s15, 4096
    s_and_b32 s15, s15, 0xffff
    buffer_load_dwordx4 a[192:195], v60, s[60:63], s15 offen offset:0 sc0 sc1
    buffer_load_dwordx4 a[196:199], v60, s[60:63], s15 offen offset:1024 sc0 sc1
    buffer_load_dwordx4 a[200:203], v60, s[60:63], s15 offen offset:2048 sc0 sc1
    s_waitcnt lgkmcnt(4)
    v_mfma_f32_32x32x16_bf16 v[80:95], v[24:27], a[0:3], 0
    ds_read_b128 v[52:55], v34 offset:32768
    ds_read_b128 v[56:59], v34 offset:40960
    s_add_u32 s14, s14, 256
    s_and_b32 s14, s14, 0xfff
    s_add_u32 s16, s7, s14
    s_add_u32 m0, s19, 65536
    s_waitcnt lgkmcnt(5)
    v_mfma_f32_32x32x16_bf16 v[96:111], v[28:31], a[0:3], 0
    buffer_load_dwordx4 v6, s[56:59], s16 offen sc0 sc1 lds
    buffer_load_dwordx4 a[204:207], v60, s[60:63], s15 offen offset:3072 sc0 sc1
    s_add_u32 s15, s15, 4096
    s_and_b32 s15, s15, 0xffff
    buffer_load_dwordx4 a[208:211], v60, s[60:63], s15 offen offset:0 sc0 sc1
    buffer_load_dwordx4 a[212:215], v60, s[60:63], s15 offen offset:1024 sc0 sc1
    s_add_u32 m0, s19, 66560
    s_waitcnt lgkmcnt(4)
    v_mfma_f32_32x32x16_bf16 v[112:127], v[40:43], a[0:3], 0
    buffer_load_dwordx4 v7, s[56:59], s16 offen sc0 sc1 lds
    buffer_load_dwordx4 a[216:219], v60, s[60:63], s15 offen offset:2048 sc0 sc1
    buffer_load_dwordx4 a[220:223], v60, s[60:63], s15 offen offset:3072 sc0 sc1
    s_add_u32 s15, s15, 4096
    s_and_b32 s15, s15, 0xffff
    buffer_load_dwordx4 a[224:227], v60, s[60:63], s15 offen offset:0 sc0 sc1
    buffer_load_dwordx4 a[228:231], v60, s[60:63], s15 offen offset:1024 sc0 sc1
    s_waitcnt lgkmcnt(3)
    v_mfma_f32_32x32x16_bf16 v[64:79], v[44:47], a[4:7], v[64:79]
    ds_read_b128 v[20:23], v15 offset:32768
    ds_read_b128 v[24:27], v15 offset:40960
    buffer_load_dwordx4 a[232:235], v60, s[60:63], s15 offen offset:2048 sc0 sc1
    buffer_load_dwordx4 a[236:239], v60, s[60:63], s15 offen offset:3072 sc0 sc1
    s_add_u32 s15, s15, 4096
    s_and_b32 s15, s15, 0xffff
    buffer_load_dwordx4 a[240:243], v60, s[60:63], s15 offen offset:0 sc0 sc1
    s_waitcnt lgkmcnt(4)
    v_mfma_f32_32x32x16_bf16 v[80:95], v[48:51], a[4:7], v[80:95]
    ds_read_b128 v[28:31], v35 offset:32768
    ds_read_b128 v[40:43], v35 offset:40960
    buffer_load_dwordx4 a[244:247], v60, s[60:63], s15 offen offset:1024 sc0 sc1
    buffer_load_dwordx4 a[248:251], v60, s[60:63], s15 offen offset:2048 sc0 sc1
    s_add_u32 m0, s19, 67584
    s_waitcnt lgkmcnt(5)
    v_mfma_f32_32x32x16_bf16 v[96:111], v[52:55], a[4:7], v[96:111]
    buffer_load_dwordx4 v8, s[56:59], s16 offen sc0 sc1 lds
    buffer_load_dwordx4 a[252:255], v60, s[60:63], s15 offen offset:3072 sc0 sc1
    s_mov_b32 s8, s20
    s_mov_b32 s9, s21
    s_add_u32 m0, s19, 68608
    s_waitcnt lgkmcnt(4)
    v_mfma_f32_32x32x16_bf16 v[112:127], v[56:59], a[4:7], v[112:127]
    buffer_load_dwordx4 v9, s[56:59], s16 offen sc0 sc1 lds
    s_mov_b32 s10, 2048
    s_mov_b32 s11, 131072
    s_mov_b32 s32, s36
    s_mov_b32 s33, s37
    s_waitcnt lgkmcnt(3)
    v_mfma_f32_32x32x16_bf16 v[64:79], v[20:23], a[8:11], v[64:79]
    ds_read_b128 v[44:47], v16 offset:32768
    ds_read_b128 v[48:51], v16 offset:40960
    s_mov_b32 s34, 8388608
    s_mov_b32 s35, 131072
    s_lshr_b32 s5, s42, 1
    s_waitcnt lgkmcnt(4)
    v_mfma_f32_32x32x16_bf16 v[80:95], v[24:27], a[8:11], v[80:95]
    ds_read_b128 v[52:55], v36 offset:32768
    ds_read_b128 v[56:59], v36 offset:40960
    s_and_b32 s12, s42, 1
    s_add_u32 s17, s16, 65536
    s_add_u32 m0, s19, 69632
    s_waitcnt lgkmcnt(5)
    v_mfma_f32_32x32x16_bf16 v[96:111], v[28:31], a[8:11], v[96:111]
    buffer_load_dwordx4 v6, s[56:59], s17 offen sc0 sc1 lds
    v_bfe_u32 v2, v1, 4, 1
    v_lshlrev_b32 v2, 2, v2
    v_and_b32 v3, 7, v1
    s_add_u32 m0, s19, 70656
    s_waitcnt lgkmcnt(4)
    v_mfma_f32_32x32x16_bf16 v[112:127], v[40:43], a[8:11], v[112:127]
    buffer_load_dwordx4 v7, s[56:59], s17 offen sc0 sc1 lds
    v_xor_b32 v3, v3, v2
    v_lshlrev_b32 v3, 4, v3
    v_lshrrev_b32 v2, 3, v1
    v_lshl_add_u32 v38, v2, 11, v3
    s_waitcnt lgkmcnt(0)
    s_waitcnt vmcnt(34)
    s_barrier
    v_mfma_f32_32x32x16_bf16 v[64:79], v[44:47], a[12:15], v[64:79]
    ds_read_b128 v[20:23], v4 offset:0
    ds_read_b128 v[24:27], v4 offset:8192
    s_lshl_b32 s13, s43, 18
    s_lshl_b32 s3, s42, 16
    s_add_u32 s13, s13, s3
    v_mfma_f32_32x32x16_bf16 v[80:95], v[48:51], a[12:15], v[80:95]
    ds_read_b128 v[28:31], v17 offset:0
    ds_read_b128 v[40:43], v17 offset:8192
    s_lshl_b32 s3, s44, 7
    s_add_u32 s13, s13, s3
    s_add_u32 m0, s19, 71680
    v_mfma_f32_32x32x16_bf16 v[96:111], v[52:55], a[12:15], v[96:111]
    buffer_load_dwordx4 v8, s[56:59], s17 offen sc0 sc1 lds
    s_lshl_b32 s18, s44, 18
    s_lshl_b32 s3, s42, 16
    s_add_u32 s18, s18, s3
    s_add_u32 m0, s19, 72704
    v_mfma_f32_32x32x16_bf16 v[112:127], v[56:59], a[12:15], v[112:127]
    buffer_load_dwordx4 v9, s[56:59], s17 offen sc0 sc1 lds
    s_lshl_b32 s3, s43, 8
    s_add_u32 s18, s18, s3
    v_bfe_u32 v37, v1, 2, 2
    v_bfe_u32 v2, v1, 4, 1
    s_waitcnt lgkmcnt(3)
    v_mfma_f32_32x32x16_bf16 v[64:79], v[20:23], a[16:19], v[64:79]
    ds_read_b128 v[44:47], v10 offset:0
    ds_read_b128 v[48:51], v10 offset:8192
    v_lshlrev_b32 v2, 1, v2
    v_bfe_u32 v3, v1, 1, 1
    v_add_u32 v2, v2, v3
    s_waitcnt lgkmcnt(4)
    v_mfma_f32_32x32x16_bf16 v[80:95], v[24:27], a[16:19], v[80:95]
    ds_read_b128 v[52:55], v18 offset:0
    ds_read_b128 v[56:59], v18 offset:8192
    s_add_u32 s14, s14, 256
    s_and_b32 s14, s14, 0xfff
    s_add_u32 s16, s7, s14
    s_add_u32 m0, s19, 98304
    s_waitcnt lgkmcnt(5)
    v_mfma_f32_32x32x16_bf16 v[96:111], v[28:31], a[16:19], v[96:111]
    buffer_load_dwordx4 v6, s[56:59], s16 offen sc0 sc1 lds
    s_lshl_b32 s3, s12, 2
    v_add_u32 v2, s3, v2
    v_bfe_u32 v3, v1, 3, 1
    s_add_u32 m0, s19, 99328
    s_waitcnt lgkmcnt(4)
    v_mfma_f32_32x32x16_bf16 v[112:127], v[40:43], a[16:19], v[112:127]
    buffer_load_dwordx4 v7, s[56:59], s16 offen sc0 sc1 lds
    v_lshlrev_b32 v3, 2, v3
    v_xor_b32 v2, v2, v3
    v_lshlrev_b32 v2, 4, v2
    v_and_b32 v3, 1, v1
    s_waitcnt lgkmcnt(3)
    v_mfma_f32_32x32x16_bf16 v[64:79], v[44:47], a[20:23], v[64:79]
    ds_read_b128 v[20:23], v11 offset:0
    ds_read_b128 v[24:27], v11 offset:8192
    v_lshl_add_u32 v2, v3, 3, v2
    v_lshrrev_b32 v3, 5, v1
    v_lshl_add_u32 v37, v3, 2, v37
    s_waitcnt lgkmcnt(4)
    v_mfma_f32_32x32x16_bf16 v[80:95], v[48:51], a[20:23], v[80:95]
    ds_read_b128 v[28:31], v19 offset:0
    ds_read_b128 v[40:43], v19 offset:8192
    v_lshl_add_u32 v2, v37, 7, v2
    s_lshl_b32 s3, s5, 13
    s_add_u32 m0, s19, 100352
    s_waitcnt lgkmcnt(5)
    v_mfma_f32_32x32x16_bf16 v[96:111], v[52:55], a[20:23], v[96:111]
    buffer_load_dwordx4 v8, s[56:59], s16 offen sc0 sc1 lds
    s_add_u32 s3, s3, 131072
    v_add_u32 v39, s3, v2
    v_and_b32 v2, 15, v1
    s_add_u32 m0, s19, 101376
    s_waitcnt lgkmcnt(4)
    v_mfma_f32_32x32x16_bf16 v[112:127], v[56:59], a[20:23], v[112:127]
    buffer_load_dwordx4 v9, s[56:59], s16 offen sc0 sc1 lds
    s_lshl_b32 s3, s5, 3
    v_xor_b32 v2, s3, v2
    v_lshlrev_b32 v2, 4, v2
    v_and_b32 v37, 31, v1
    s_waitcnt lgkmcnt(3)
    v_mfma_f32_32x32x16_bf16 v[64:79], v[20:23], a[24:27], v[64:79]
    ds_read_b128 v[44:47], v12 offset:0
    ds_read_b128 v[48:51], v12 offset:8192
    v_lshl_add_u32 v2, v37, 8, v2
    v_lshl_add_u32 v2, v3, 3, v2
    s_lshl_b32 s3, s12, 13
    s_waitcnt lgkmcnt(4)
    v_mfma_f32_32x32x16_bf16 v[80:95], v[24:27], a[24:27], v[80:95]
    ds_read_b128 v[52:55], v32 offset:0
    ds_read_b128 v[56:59], v32 offset:8192
    s_add_u32 s3, s3, 147456
    s_add_u32 s17, s16, 65536
    s_add_u32 m0, s19, 102400
    s_waitcnt lgkmcnt(5)
    v_mfma_f32_32x32x16_bf16 v[96:111], v[28:31], a[24:27], v[96:111]
    buffer_load_dwordx4 v6, s[56:59], s17 offen sc0 sc1 lds
    v_add_u32 v61, s3, v2
    v_and_b32 v2, 15, v1
    v_lshlrev_b32 v2, 4, v2
    s_add_u32 m0, s19, 103424
    s_waitcnt lgkmcnt(4)
    v_mfma_f32_32x32x16_bf16 v[112:127], v[40:43], a[24:27], v[112:127]
    buffer_load_dwordx4 v7, s[56:59], s17 offen sc0 sc1 lds
    v_and_b32 v37, 16, v1
    v_lshl_add_u32 v2, v37, 9, v2
    s_lshl_b32 s3, s43, 9
    v_add_u32 v2, s3, v2
    s_waitcnt lgkmcnt(0)
    s_waitcnt vmcnt(34)
    s_barrier
    v_mfma_f32_32x32x16_bf16 v[64:79], v[44:47], a[28:31], v[64:79]
    ds_read_b128 v[20:23], v4 offset:32768
    ds_read_b128 v[24:27], v4 offset:40960
    s_lshl_b32 s3, s5, 8
    v_add_u32 v62, s3, v2
    s_lshl_b32 s3, s42, 10
    v_mfma_f32_32x32x16_bf16 v[80:95], v[48:51], a[28:31], v[80:95]
    ds_read_b128 v[28:31], v17 offset:32768
    ds_read_b128 v[40:43], v17 offset:40960
    s_add_u32 s3, s3, 147456
    v_lshl_add_u32 v63, v3, 4, s3
    s_add_u32 m0, s19, 104448
    v_mfma_f32_32x32x16_bf16 v[96:111], v[52:55], a[28:31], v[96:111]
    buffer_load_dwordx4 v8, s[56:59], s17 offen sc0 sc1 lds
    v_and_b32 v2, 31, v1
    s_lshl_b32 s3, s12, 5
    v_add_u32 v2, s3, v2
    s_add_u32 m0, s19, 105472
    v_mfma_f32_32x32x16_bf16 v[112:127], v[56:59], a[28:31], v[112:127]
    buffer_load_dwordx4 v9, s[56:59], s17 offen sc0 sc1 lds
    s_lshl_b32 s3, s44, 6
    v_add_u32 v2, s3, v2
    v_lshlrev_b32 v128, 1, v2
    v_lshlrev_b32 v3, 14, v3
    s_waitcnt lgkmcnt(3)
    v_mfma_f32_32x32x16_bf16 v[64:79], v[20:23], a[32:35], v[64:79]
    ds_read_b128 v[44:47], v10 offset:32768
    ds_read_b128 v[48:51], v10 offset:40960
    v_lshl_add_u32 v129, v2, 2, v3
    v_add_u32 v130, 4096, v129
    v_add_u32 v131, 8192, v129
    s_waitcnt lgkmcnt(4)
    v_mfma_f32_32x32x16_bf16 v[80:95], v[24:27], a[32:35], v[80:95]
    ds_read_b128 v[52:55], v18 offset:32768
    ds_read_b128 v[56:59], v18 offset:40960
    s_add_u32 s14, s14, 256
    s_and_b32 s14, s14, 0xfff
    s_add_u32 s16, s7, s14
    s_add_u32 m0, s19, 0
    s_waitcnt lgkmcnt(5)
    v_mfma_f32_32x32x16_bf16 v[96:111], v[28:31], a[32:35], v[96:111]
    buffer_load_dwordx4 v6, s[56:59], s16 offen sc0 sc1 lds
    v_add_u32 v132, 12288, v129
    s_lshl_b32 s38, s43, 19
    s_lshl_b32 s3, s5, 18
    s_add_u32 m0, s19, 1024
    s_waitcnt lgkmcnt(4)
    v_mfma_f32_32x32x16_bf16 v[112:127], v[40:43], a[32:35], v[112:127]
    buffer_load_dwordx4 v7, s[56:59], s16 offen sc0 sc1 lds
    s_add_u32 s38, s38, s3
    s_lshl_b32 s39, s42, 12
    s_lshl_b32 s3, s42, 13
    s_add_u32 s3, s3, 98304
    s_waitcnt lgkmcnt(3)
    v_mfma_f32_32x32x16_bf16 v[64:79], v[44:47], a[36:39], v[64:79]
    ds_read_b128 v[20:23], v11 offset:32768
    ds_read_b128 v[24:27], v11 offset:40960
    v_add_u32 v218, s3, v60
    v_xor_b32 v219, 0x4000, v218
    s_lshl_b32 s3, s44, 9
    s_waitcnt lgkmcnt(4)
    v_mfma_f32_32x32x16_bf16 v[80:95], v[48:51], a[36:39], v[80:95]
    ds_read_b128 v[28:31], v19 offset:32768
    ds_read_b128 v[40:43], v19 offset:40960
    s_add_u32 s3, s3, 24576
    v_lshrrev_b32 v203, 1, v60
    s_add_u32 m0, s19, 2048
    s_waitcnt lgkmcnt(5)
    v_mfma_f32_32x32x16_bf16 v[96:111], v[52:55], a[36:39], v[96:111]
    buffer_load_dwordx4 v8, s[56:59], s16 offen sc0 sc1 lds
    v_add_u32 v203, s3, v203
    s_add_u32 m0, s39, 131072
    s_nop 0
    buffer_load_dwordx4 v38, s[52:55], s13 offen lds
    s_add_u32 s13, s13, 16384
    s_add_u32 m0, s19, 3072
    s_waitcnt lgkmcnt(4)
    v_mfma_f32_32x32x16_bf16 v[112:127], v[56:59], a[36:39], v[112:127]
    buffer_load_dwordx4 v9, s[56:59], s16 offen sc0 sc1 lds
    s_add_u32 m0, s39, 132096
    s_nop 0
    buffer_load_dwordx4 v38, s[52:55], s13 offen lds
    s_add_u32 s13, s13, 16384
    s_add_u32 m0, s39, 133120
    s_nop 0
    buffer_load_dwordx4 v38, s[52:55], s13 offen lds
    s_add_u32 s13, s13, 16384
    s_waitcnt lgkmcnt(3)
    v_mfma_f32_32x32x16_bf16 v[64:79], v[20:23], a[40:43], v[64:79]
    ds_read_b128 v[44:47], v12 offset:32768
    ds_read_b128 v[48:51], v12 offset:40960
    s_add_u32 m0, s39, 134144
    s_nop 0
    buffer_load_dwordx4 v38, s[52:55], s13 offen lds
    s_lshr_b32 s3, s39, 2
    s_add_u32 m0, s3, 147456
    s_nop 0
    buffer_load_dwordx4 v62, s[72:75], 0 offen sc0 sc1 lds
    buffer_load_ushort v133, v128, s[8:11], 0 offen
    s_waitcnt lgkmcnt(4)
    v_mfma_f32_32x32x16_bf16 v[80:95], v[24:27], a[40:43], v[80:95]
    ds_read_b128 v[52:55], v32 offset:32768
    ds_read_b128 v[56:59], v32 offset:40960
    s_waitcnt vmcnt(42)
    s_add_u32 s17, s16, 65536
    s_add_u32 m0, s19, 4096
    s_waitcnt lgkmcnt(5)
    v_mfma_f32_32x32x16_bf16 v[96:111], v[28:31], a[40:43], v[96:111]
    buffer_load_dwordx4 v6, s[56:59], s17 offen sc0 sc1 lds
    v_mov_b32 v176, s22
    v_mov_b32 v177, s23
    s_mov_b64 s[20:21], exec
    s_mov_b64 exec, 1
    buffer_store_dwordx2 v[176:177], v5, s[48:51], s6 offen sc0 sc1
    s_mov_b64 exec, s[20:21]
    s_add_u32 m0, s19, 5120
    s_waitcnt lgkmcnt(4)
    v_mfma_f32_32x32x16_bf16 v[112:127], v[40:43], a[40:43], v[112:127]
    buffer_load_dwordx4 v7, s[56:59], s17 offen sc0 sc1 lds
    s_waitcnt lgkmcnt(0)
    s_waitcnt vmcnt(21)
    s_barrier
    v_mfma_f32_32x32x16_bf16 v[64:79], v[44:47], a[44:47], v[64:79]
    ds_read_b128 v[20:23], v13 offset:0
    ds_read_b128 v[24:27], v13 offset:8192
    v_mfma_f32_32x32x16_bf16 v[80:95], v[48:51], a[44:47], v[80:95]
    ds_read_b128 v[28:31], v33 offset:0
    ds_read_b128 v[40:43], v33 offset:8192
    s_add_u32 m0, s19, 6144
    v_mfma_f32_32x32x16_bf16 v[96:111], v[52:55], a[44:47], v[96:111]
    buffer_load_dwordx4 v8, s[56:59], s17 offen sc0 sc1 lds
    s_add_u32 m0, s19, 7168
    v_mfma_f32_32x32x16_bf16 v[112:127], v[56:59], a[44:47], v[112:127]
    buffer_load_dwordx4 v9, s[56:59], s17 offen sc0 sc1 lds
    s_waitcnt lgkmcnt(3)
    v_mfma_f32_32x32x16_bf16 v[64:79], v[20:23], a[48:51], v[64:79]
    ds_read_b128 v[44:47], v14 offset:0
    ds_read_b128 v[48:51], v14 offset:8192
    s_waitcnt lgkmcnt(4)
    v_mfma_f32_32x32x16_bf16 v[80:95], v[24:27], a[48:51], v[80:95]
    ds_read_b128 v[52:55], v34 offset:0
    ds_read_b128 v[56:59], v34 offset:8192
    s_add_u32 s14, s14, 256
    s_and_b32 s14, s14, 0xfff
    s_add_u32 s16, s7, s14
    s_add_u32 m0, s19, 32768
    s_waitcnt lgkmcnt(5)
    v_mfma_f32_32x32x16_bf16 v[96:111], v[28:31], a[48:51], v[96:111]
    buffer_load_dwordx4 v6, s[56:59], s16 offen sc0 sc1 lds
    s_add_u32 m0, s19, 33792
    s_waitcnt lgkmcnt(4)
    v_mfma_f32_32x32x16_bf16 v[112:127], v[40:43], a[48:51], v[112:127]
    buffer_load_dwordx4 v7, s[56:59], s16 offen sc0 sc1 lds
    s_waitcnt lgkmcnt(3)
    v_mfma_f32_32x32x16_bf16 v[64:79], v[44:47], a[52:55], v[64:79]
    ds_read_b128 v[20:23], v15 offset:0
    ds_read_b128 v[24:27], v15 offset:8192
    s_waitcnt lgkmcnt(4)
    v_mfma_f32_32x32x16_bf16 v[80:95], v[48:51], a[52:55], v[80:95]
    ds_read_b128 v[28:31], v35 offset:0
    ds_read_b128 v[40:43], v35 offset:8192
    s_add_u32 m0, s19, 34816
    s_waitcnt lgkmcnt(5)
    v_mfma_f32_32x32x16_bf16 v[96:111], v[52:55], a[52:55], v[96:111]
    buffer_load_dwordx4 v8, s[56:59], s16 offen sc0 sc1 lds
    s_add_u32 m0, s19, 35840
    s_waitcnt lgkmcnt(4)
    v_mfma_f32_32x32x16_bf16 v[112:127], v[56:59], a[52:55], v[112:127]
    buffer_load_dwordx4 v9, s[56:59], s16 offen sc0 sc1 lds
    s_waitcnt lgkmcnt(3)
    v_mfma_f32_32x32x16_bf16 v[64:79], v[20:23], a[56:59], v[64:79]
    ds_read_b128 v[44:47], v16 offset:0
    ds_read_b128 v[48:51], v16 offset:8192
    s_waitcnt lgkmcnt(4)
    v_mfma_f32_32x32x16_bf16 v[80:95], v[24:27], a[56:59], v[80:95]
    ds_read_b128 v[52:55], v36 offset:0
    ds_read_b128 v[56:59], v36 offset:8192
    s_add_u32 s17, s16, 65536
    s_add_u32 m0, s19, 36864
    s_waitcnt lgkmcnt(5)
    v_mfma_f32_32x32x16_bf16 v[96:111], v[28:31], a[56:59], v[96:111]
    buffer_load_dwordx4 v6, s[56:59], s17 offen sc0 sc1 lds
    s_add_u32 m0, s19, 37888
    s_waitcnt lgkmcnt(4)
    v_mfma_f32_32x32x16_bf16 v[112:127], v[40:43], a[56:59], v[112:127]
    buffer_load_dwordx4 v7, s[56:59], s17 offen sc0 sc1 lds
    s_waitcnt lgkmcnt(0)
    s_waitcnt vmcnt(21)
    s_barrier
    v_mfma_f32_32x32x16_bf16 v[64:79], v[44:47], a[60:63], v[64:79]
    ds_read_b128 v[20:23], v13 offset:32768
    ds_read_b128 v[24:27], v13 offset:40960
    v_mfma_f32_32x32x16_bf16 v[80:95], v[48:51], a[60:63], v[80:95]
    ds_read_b128 v[28:31], v33 offset:32768
    ds_read_b128 v[40:43], v33 offset:40960
    s_add_u32 m0, s19, 38912
    v_mfma_f32_32x32x16_bf16 v[96:111], v[52:55], a[60:63], v[96:111]
    buffer_load_dwordx4 v8, s[56:59], s17 offen sc0 sc1 lds
    s_add_u32 m0, s19, 39936
    v_mfma_f32_32x32x16_bf16 v[112:127], v[56:59], a[60:63], v[112:127]
    buffer_load_dwordx4 v9, s[56:59], s17 offen sc0 sc1 lds
    s_waitcnt lgkmcnt(3)
    v_mfma_f32_32x32x16_bf16 v[64:79], v[20:23], a[64:67], v[64:79]
    ds_read_b128 v[44:47], v14 offset:32768
    ds_read_b128 v[48:51], v14 offset:40960
    s_waitcnt vmcnt(14)
    ds_read_b128 v[134:137], v63 offset:0
    ds_read_b128 v[166:169], v63 offset:256
    s_waitcnt lgkmcnt(6)
    v_mfma_f32_32x32x16_bf16 v[80:95], v[24:27], a[64:67], v[80:95]
    ds_read_b128 v[52:55], v34 offset:32768
    ds_read_b128 v[56:59], v34 offset:40960
    s_add_u32 s14, s14, 256
    s_and_b32 s14, s14, 0xfff
    s_add_u32 s16, s7, s14
    s_add_u32 m0, s19, 65536
    s_waitcnt lgkmcnt(7)
    v_mfma_f32_32x32x16_bf16 v[96:111], v[28:31], a[64:67], v[96:111]
    buffer_load_dwordx4 v6, s[56:59], s16 offen sc0 sc1 lds
    ds_read_b128 v[138:141], v63 offset:32
    ds_read_b128 v[170:173], v63 offset:288
    ds_read_b128 v[142:145], v63 offset:64
    s_add_u32 m0, s19, 66560
    s_waitcnt lgkmcnt(9)
    v_mfma_f32_32x32x16_bf16 v[112:127], v[40:43], a[64:67], v[112:127]
    buffer_load_dwordx4 v7, s[56:59], s16 offen sc0 sc1 lds
    ds_read_b128 v[178:181], v63 offset:320
    ds_read_b128 v[146:149], v63 offset:96
    ds_read_b128 v[182:185], v63 offset:352
    ds_read_b128 v[150:153], v63 offset:128
    s_waitcnt lgkmcnt(12)
    v_mfma_f32_32x32x16_bf16 v[64:79], v[44:47], a[68:71], v[64:79]
    ds_read_b128 v[20:23], v15 offset:32768
    ds_read_b128 v[24:27], v15 offset:40960
    ds_read_b128 v[186:189], v63 offset:384
    ds_read_b128 v[154:157], v63 offset:160
    ds_read_b128 v[190:193], v63 offset:416
    s_waitcnt lgkmcnt(15)
    v_mfma_f32_32x32x16_bf16 v[80:95], v[48:51], a[68:71], v[80:95]
    ds_read_b128 v[28:31], v35 offset:32768
    ds_read_b128 v[40:43], v35 offset:40960
    ds_read_b128 v[158:161], v63 offset:192
    ds_read_b128 v[194:197], v63 offset:448
    s_add_u32 m0, s19, 67584
    s_waitcnt lgkmcnt(15)
    v_mfma_f32_32x32x16_bf16 v[96:111], v[52:55], a[68:71], v[96:111]
    buffer_load_dwordx4 v8, s[56:59], s16 offen sc0 sc1 lds
    ds_read_b128 v[162:165], v63 offset:224
    ds_read_b128 v[198:201], v63 offset:480
    s_add_u32 m0, s19, 68608
    v_mfma_f32_32x32x16_bf16 v[112:127], v[56:59], a[68:71], v[112:127]
    buffer_load_dwordx4 v9, s[56:59], s16 offen sc0 sc1 lds
    s_waitcnt lgkmcnt(10)
    v_mfma_f32_32x32x16_bf16 v[64:79], v[20:23], a[72:75], v[64:79]
    ds_read_b128 v[44:47], v16 offset:32768
    ds_read_b128 v[48:51], v16 offset:40960
    s_waitcnt lgkmcnt(11)
    v_mfma_f32_32x32x16_bf16 v[80:95], v[24:27], a[72:75], v[80:95]
    ds_read_b128 v[52:55], v36 offset:32768
    ds_read_b128 v[56:59], v36 offset:40960
    s_add_u32 s17, s16, 65536
    s_add_u32 m0, s19, 69632
    s_waitcnt lgkmcnt(9)
    v_mfma_f32_32x32x16_bf16 v[96:111], v[28:31], a[72:75], v[96:111]
    buffer_load_dwordx4 v6, s[56:59], s17 offen sc0 sc1 lds
    s_add_u32 m0, s19, 70656
    s_waitcnt lgkmcnt(8)
    v_mfma_f32_32x32x16_bf16 v[112:127], v[40:43], a[72:75], v[112:127]
    buffer_load_dwordx4 v7, s[56:59], s17 offen sc0 sc1 lds
    s_waitcnt lgkmcnt(0)
    s_waitcnt vmcnt(14)
    s_barrier
    v_mfma_f32_32x32x16_bf16 v[64:79], v[44:47], a[76:79], v[64:79]
    ds_read_b128 v[20:23], v4 offset:0
    ds_read_b128 v[24:27], v4 offset:8192
    v_mfma_f32_32x32x16_bf16 v[80:95], v[48:51], a[76:79], v[80:95]
    ds_read_b128 v[28:31], v17 offset:0
    ds_read_b128 v[40:43], v17 offset:8192
    s_add_u32 m0, s19, 71680
    v_mfma_f32_32x32x16_bf16 v[96:111], v[52:55], a[76:79], v[96:111]
    buffer_load_dwordx4 v8, s[56:59], s17 offen sc0 sc1 lds
    s_add_u32 m0, s19, 72704
    v_mfma_f32_32x32x16_bf16 v[112:127], v[56:59], a[76:79], v[112:127]
    buffer_load_dwordx4 v9, s[56:59], s17 offen sc0 sc1 lds
    s_waitcnt lgkmcnt(3)
    v_mfma_f32_32x32x16_bf16 v[64:79], v[20:23], a[80:83], v[64:79]
    ds_read_b128 v[44:47], v10 offset:0
    ds_read_b128 v[48:51], v10 offset:8192
    s_waitcnt lgkmcnt(4)
    v_mfma_f32_32x32x16_bf16 v[80:95], v[24:27], a[80:83], v[80:95]
    ds_read_b128 v[52:55], v18 offset:0
    ds_read_b128 v[56:59], v18 offset:8192
    s_add_u32 s14, s14, 256
    s_and_b32 s14, s14, 0xfff
    s_add_u32 s16, s7, s14
    s_add_u32 m0, s19, 98304
    s_waitcnt lgkmcnt(5)
    v_mfma_f32_32x32x16_bf16 v[96:111], v[28:31], a[80:83], v[96:111]
    buffer_load_dwordx4 v6, s[56:59], s16 offen sc0 sc1 lds
    s_add_u32 m0, s19, 99328
    s_waitcnt lgkmcnt(4)
    v_mfma_f32_32x32x16_bf16 v[112:127], v[40:43], a[80:83], v[112:127]
    buffer_load_dwordx4 v7, s[56:59], s16 offen sc0 sc1 lds
    s_waitcnt lgkmcnt(3)
    v_mfma_f32_32x32x16_bf16 v[64:79], v[44:47], a[84:87], v[64:79]
    ds_read_b128 v[20:23], v11 offset:0
    ds_read_b128 v[24:27], v11 offset:8192
    s_waitcnt lgkmcnt(4)
    v_mfma_f32_32x32x16_bf16 v[80:95], v[48:51], a[84:87], v[80:95]
    ds_read_b128 v[28:31], v19 offset:0
    ds_read_b128 v[40:43], v19 offset:8192
    s_add_u32 m0, s19, 100352
    s_waitcnt lgkmcnt(5)
    v_mfma_f32_32x32x16_bf16 v[96:111], v[52:55], a[84:87], v[96:111]
    buffer_load_dwordx4 v8, s[56:59], s16 offen sc0 sc1 lds
    s_add_u32 m0, s19, 101376
    s_waitcnt lgkmcnt(4)
    v_mfma_f32_32x32x16_bf16 v[112:127], v[56:59], a[84:87], v[112:127]
    buffer_load_dwordx4 v9, s[56:59], s16 offen sc0 sc1 lds
    s_waitcnt lgkmcnt(3)
    v_mfma_f32_32x32x16_bf16 v[64:79], v[20:23], a[88:91], v[64:79]
    ds_read_b128 v[44:47], v12 offset:0
    ds_read_b128 v[48:51], v12 offset:8192
    s_waitcnt lgkmcnt(4)
    v_mfma_f32_32x32x16_bf16 v[80:95], v[24:27], a[88:91], v[80:95]
    ds_read_b128 v[52:55], v32 offset:0
    ds_read_b128 v[56:59], v32 offset:8192
    s_add_u32 s17, s16, 65536
    s_add_u32 m0, s19, 102400
    s_waitcnt lgkmcnt(5)
    v_mfma_f32_32x32x16_bf16 v[96:111], v[28:31], a[88:91], v[96:111]
    buffer_load_dwordx4 v6, s[56:59], s17 offen sc0 sc1 lds
    s_add_u32 m0, s19, 103424
    s_waitcnt lgkmcnt(4)
    v_mfma_f32_32x32x16_bf16 v[112:127], v[40:43], a[88:91], v[112:127]
    buffer_load_dwordx4 v7, s[56:59], s17 offen sc0 sc1 lds
    s_waitcnt lgkmcnt(0)
    s_waitcnt vmcnt(14)
    s_barrier
    v_mfma_f32_32x32x16_bf16 v[64:79], v[44:47], a[92:95], v[64:79]
    ds_read_b128 v[20:23], v4 offset:32768
    ds_read_b128 v[24:27], v4 offset:40960
    v_mfma_f32_32x32x16_bf16 v[80:95], v[48:51], a[92:95], v[80:95]
    ds_read_b128 v[28:31], v17 offset:32768
    ds_read_b128 v[40:43], v17 offset:40960
    s_add_u32 m0, s19, 104448
    v_mfma_f32_32x32x16_bf16 v[96:111], v[52:55], a[92:95], v[96:111]
    buffer_load_dwordx4 v8, s[56:59], s17 offen sc0 sc1 lds
    s_add_u32 m0, s19, 105472
    v_mfma_f32_32x32x16_bf16 v[112:127], v[56:59], a[92:95], v[112:127]
    buffer_load_dwordx4 v9, s[56:59], s17 offen sc0 sc1 lds
    s_waitcnt lgkmcnt(3)
    v_mfma_f32_32x32x16_bf16 v[64:79], v[20:23], a[96:99], v[64:79]
    ds_read_b128 v[44:47], v10 offset:32768
    ds_read_b128 v[48:51], v10 offset:40960
    buffer_load_dwordx2 v[220:221], v203, s[48:51], 0 offen sc0 sc1
    s_waitcnt lgkmcnt(4)
    v_mfma_f32_32x32x16_bf16 v[80:95], v[24:27], a[96:99], v[80:95]
    ds_read_b128 v[52:55], v18 offset:32768
    ds_read_b128 v[56:59], v18 offset:40960
    s_add_u32 s14, s14, 256
    s_and_b32 s14, s14, 0xfff
    s_add_u32 s16, s7, s14
    s_add_u32 m0, s19, 0
    s_waitcnt lgkmcnt(5)
    v_mfma_f32_32x32x16_bf16 v[96:111], v[28:31], a[96:99], v[96:111]
    buffer_load_dwordx4 v6, s[56:59], s16 offen sc0 sc1 lds
    s_add_u32 m0, s19, 1024
    s_waitcnt lgkmcnt(4)
    v_mfma_f32_32x32x16_bf16 v[112:127], v[40:43], a[96:99], v[112:127]
    buffer_load_dwordx4 v7, s[56:59], s16 offen sc0 sc1 lds
    s_waitcnt lgkmcnt(3)
    v_mfma_f32_32x32x16_bf16 v[64:79], v[44:47], a[100:103], v[64:79]
    ds_read_b128 v[20:23], v11 offset:32768
    ds_read_b128 v[24:27], v11 offset:40960
    s_waitcnt lgkmcnt(4)
    v_mfma_f32_32x32x16_bf16 v[80:95], v[48:51], a[100:103], v[80:95]
    ds_read_b128 v[28:31], v19 offset:32768
    ds_read_b128 v[40:43], v19 offset:40960
    s_add_u32 m0, s19, 2048
    s_waitcnt lgkmcnt(5)
    v_mfma_f32_32x32x16_bf16 v[96:111], v[52:55], a[100:103], v[96:111]
    buffer_load_dwordx4 v8, s[56:59], s16 offen sc0 sc1 lds
    s_add_u32 m0, s19, 3072
    s_waitcnt lgkmcnt(4)
    v_mfma_f32_32x32x16_bf16 v[112:127], v[56:59], a[100:103], v[112:127]
    buffer_load_dwordx4 v9, s[56:59], s16 offen sc0 sc1 lds
    s_waitcnt lgkmcnt(3)
    v_mfma_f32_32x32x16_bf16 v[64:79], v[20:23], a[104:107], v[64:79]
    ds_read_b128 v[44:47], v12 offset:32768
    ds_read_b128 v[48:51], v12 offset:40960
    s_waitcnt lgkmcnt(4)
    v_mfma_f32_32x32x16_bf16 v[80:95], v[24:27], a[104:107], v[80:95]
    ds_read_b128 v[52:55], v32 offset:32768
    ds_read_b128 v[56:59], v32 offset:40960
    s_add_u32 s17, s16, 65536
    s_add_u32 m0, s19, 4096
    s_waitcnt lgkmcnt(5)
    v_mfma_f32_32x32x16_bf16 v[96:111], v[28:31], a[104:107], v[96:111]
    buffer_load_dwordx4 v6, s[56:59], s17 offen sc0 sc1 lds
    s_add_u32 m0, s19, 5120
    s_waitcnt lgkmcnt(4)
    v_mfma_f32_32x32x16_bf16 v[112:127], v[40:43], a[104:107], v[112:127]
    buffer_load_dwordx4 v7, s[56:59], s17 offen sc0 sc1 lds
    s_waitcnt lgkmcnt(0)
    s_waitcnt vmcnt(15)
    s_barrier
    v_mfma_f32_32x32x16_bf16 v[64:79], v[44:47], a[108:111], v[64:79]
    ds_read_b128 v[20:23], v13 offset:0
    ds_read_b128 v[24:27], v13 offset:8192
    v_mfma_f32_32x32x16_bf16 v[80:95], v[48:51], a[108:111], v[80:95]
    ds_read_b128 v[28:31], v33 offset:0
    ds_read_b128 v[40:43], v33 offset:8192
    s_add_u32 m0, s19, 6144
    v_mfma_f32_32x32x16_bf16 v[96:111], v[52:55], a[108:111], v[96:111]
    buffer_load_dwordx4 v8, s[56:59], s17 offen sc0 sc1 lds
    s_add_u32 m0, s19, 7168
    v_mfma_f32_32x32x16_bf16 v[112:127], v[56:59], a[108:111], v[112:127]
    buffer_load_dwordx4 v9, s[56:59], s17 offen sc0 sc1 lds
    s_waitcnt lgkmcnt(3)
    v_mfma_f32_32x32x16_bf16 v[64:79], v[20:23], a[112:115], v[64:79]
    ds_read_b128 v[44:47], v14 offset:0
    ds_read_b128 v[48:51], v14 offset:8192
    s_waitcnt lgkmcnt(4)
    v_mfma_f32_32x32x16_bf16 v[80:95], v[24:27], a[112:115], v[80:95]
    ds_read_b128 v[52:55], v34 offset:0
    ds_read_b128 v[56:59], v34 offset:8192
    s_add_u32 s14, s14, 256
    s_and_b32 s14, s14, 0xfff
    s_add_u32 s16, s7, s14
    s_add_u32 m0, s19, 32768
    s_waitcnt lgkmcnt(5)
    v_mfma_f32_32x32x16_bf16 v[96:111], v[28:31], a[112:115], v[96:111]
    buffer_load_dwordx4 v6, s[56:59], s16 offen sc0 sc1 lds
    s_add_u32 m0, s19, 33792
    s_waitcnt lgkmcnt(4)
    v_mfma_f32_32x32x16_bf16 v[112:127], v[40:43], a[112:115], v[112:127]
    buffer_load_dwordx4 v7, s[56:59], s16 offen sc0 sc1 lds
    s_waitcnt lgkmcnt(3)
    v_mfma_f32_32x32x16_bf16 v[64:79], v[44:47], a[116:119], v[64:79]
    ds_read_b128 v[20:23], v15 offset:0
    ds_read_b128 v[24:27], v15 offset:8192
    s_waitcnt lgkmcnt(4)
    v_mfma_f32_32x32x16_bf16 v[80:95], v[48:51], a[116:119], v[80:95]
    ds_read_b128 v[28:31], v35 offset:0
    ds_read_b128 v[40:43], v35 offset:8192
    s_add_u32 m0, s19, 34816
    s_waitcnt lgkmcnt(5)
    v_mfma_f32_32x32x16_bf16 v[96:111], v[52:55], a[116:119], v[96:111]
    buffer_load_dwordx4 v8, s[56:59], s16 offen sc0 sc1 lds
    s_add_u32 m0, s19, 35840
    s_waitcnt lgkmcnt(4)
    v_mfma_f32_32x32x16_bf16 v[112:127], v[56:59], a[116:119], v[112:127]
    buffer_load_dwordx4 v9, s[56:59], s16 offen sc0 sc1 lds
    s_waitcnt lgkmcnt(3)
    v_mfma_f32_32x32x16_bf16 v[64:79], v[20:23], a[120:123], v[64:79]
    ds_read_b128 v[44:47], v16 offset:0
    ds_read_b128 v[48:51], v16 offset:8192
    s_waitcnt lgkmcnt(4)
    v_mfma_f32_32x32x16_bf16 v[80:95], v[24:27], a[120:123], v[80:95]
    ds_read_b128 v[52:55], v36 offset:0
    ds_read_b128 v[56:59], v36 offset:8192
    s_add_u32 s17, s16, 65536
    s_add_u32 m0, s19, 36864
    s_waitcnt lgkmcnt(5)
    v_mfma_f32_32x32x16_bf16 v[96:111], v[28:31], a[120:123], v[96:111]
    buffer_load_dwordx4 v6, s[56:59], s17 offen sc0 sc1 lds
    s_add_u32 m0, s19, 37888
    s_waitcnt lgkmcnt(4)
    v_mfma_f32_32x32x16_bf16 v[112:127], v[40:43], a[120:123], v[112:127]
    buffer_load_dwordx4 v7, s[56:59], s17 offen sc0 sc1 lds
    s_waitcnt lgkmcnt(0)
    s_waitcnt vmcnt(15)
    s_barrier
    v_mfma_f32_32x32x16_bf16 v[64:79], v[44:47], a[124:127], v[64:79]
    ds_read_b128 v[20:23], v13 offset:32768
    ds_read_b128 v[24:27], v13 offset:40960
    v_mfma_f32_32x32x16_bf16 v[80:95], v[48:51], a[124:127], v[80:95]
    ds_read_b128 v[28:31], v33 offset:32768
    ds_read_b128 v[40:43], v33 offset:40960
    s_add_u32 m0, s19, 38912
    v_mfma_f32_32x32x16_bf16 v[96:111], v[52:55], a[124:127], v[96:111]
    buffer_load_dwordx4 v8, s[56:59], s17 offen sc0 sc1 lds
    s_add_u32 m0, s19, 39936
    v_mfma_f32_32x32x16_bf16 v[112:127], v[56:59], a[124:127], v[112:127]
    buffer_load_dwordx4 v9, s[56:59], s17 offen sc0 sc1 lds
    s_waitcnt lgkmcnt(3)
    v_mfma_f32_32x32x16_bf16 v[64:79], v[20:23], a[128:131], v[64:79]
    ds_read_b128 v[44:47], v14 offset:32768
    ds_read_b128 v[48:51], v14 offset:40960
    s_mov_b32 s36, 0
    s_waitcnt vmcnt(16)
    v_cmp_ne_u64 vcc, s[22:23], v[220:221]
    s_nop 4
    s_cbranch_vccz Lfdone_gate_13
Lfpoll_gate_14:
    buffer_load_dwordx2 v[220:221], v203, s[48:51], 0 offen sc0 sc1
    s_waitcnt vmcnt(0)
    v_cmp_ne_u64 vcc, s[22:23], v[220:221]
    s_nop 4
    s_add_u32 s36, s36, 1
    s_cmp_gt_u32 s36, 20000
    s_cbranch_scc1 Lfdone_gate_13
    s_cbranch_vccnz Lfpoll_gate_14
Lfdone_gate_13:
    s_add_u32 m0, s39, 147456
    s_nop 0
    buffer_load_dwordx4 v6, s[28:31], s18 offen sc0 sc1 lds
    s_add_u32 m0, s39, 148480
    s_nop 0
    buffer_load_dwordx4 v7, s[28:31], s18 offen sc0 sc1 lds
    s_waitcnt lgkmcnt(4)
    v_mfma_f32_32x32x16_bf16 v[80:95], v[24:27], a[128:131], v[80:95]
    ds_read_b128 v[52:55], v34 offset:32768
    ds_read_b128 v[56:59], v34 offset:40960
    s_add_u32 s14, s14, 256
    s_and_b32 s14, s14, 0xfff
    s_add_u32 s16, s7, s14
    s_add_u32 m0, s19, 65536
    s_waitcnt lgkmcnt(5)
    v_mfma_f32_32x32x16_bf16 v[96:111], v[28:31], a[128:131], v[96:111]
    buffer_load_dwordx4 v6, s[56:59], s16 offen sc0 sc1 lds
    s_add_u32 m0, s39, 149504
    s_nop 0
    buffer_load_dwordx4 v8, s[28:31], s18 offen sc0 sc1 lds
    s_add_u32 m0, s39, 150528
    s_nop 0
    buffer_load_dwordx4 v9, s[28:31], s18 offen sc0 sc1 lds
    s_add_u32 m0, s19, 66560
    s_waitcnt lgkmcnt(4)
    v_mfma_f32_32x32x16_bf16 v[112:127], v[40:43], a[128:131], v[112:127]
    buffer_load_dwordx4 v7, s[56:59], s16 offen sc0 sc1 lds
    s_waitcnt lgkmcnt(3)
    v_mfma_f32_32x32x16_bf16 v[64:79], v[44:47], a[132:135], v[64:79]
    ds_read_b128 v[20:23], v15 offset:32768
    ds_read_b128 v[24:27], v15 offset:40960
    s_waitcnt lgkmcnt(4)
    v_mfma_f32_32x32x16_bf16 v[80:95], v[48:51], a[132:135], v[80:95]
    ds_read_b128 v[28:31], v35 offset:32768
    ds_read_b128 v[40:43], v35 offset:40960
    s_add_u32 m0, s19, 67584
    s_waitcnt lgkmcnt(5)
    v_mfma_f32_32x32x16_bf16 v[96:111], v[52:55], a[132:135], v[96:111]
    buffer_load_dwordx4 v8, s[56:59], s16 offen sc0 sc1 lds
    s_add_u32 m0, s19, 68608
    s_waitcnt lgkmcnt(4)
    v_mfma_f32_32x32x16_bf16 v[112:127], v[56:59], a[132:135], v[112:127]
    buffer_load_dwordx4 v9, s[56:59], s16 offen sc0 sc1 lds
    s_waitcnt lgkmcnt(3)
    v_mfma_f32_32x32x16_bf16 v[64:79], v[20:23], a[136:139], v[64:79]
    ds_read_b128 v[44:47], v16 offset:32768
    ds_read_b128 v[48:51], v16 offset:40960
    s_waitcnt lgkmcnt(4)
    v_mfma_f32_32x32x16_bf16 v[80:95], v[24:27], a[136:139], v[80:95]
    ds_read_b128 v[52:55], v36 offset:32768
    ds_read_b128 v[56:59], v36 offset:40960
    s_add_u32 s17, s16, 65536
    s_add_u32 m0, s19, 69632
    s_waitcnt lgkmcnt(5)
    v_mfma_f32_32x32x16_bf16 v[96:111], v[28:31], a[136:139], v[96:111]
    buffer_load_dwordx4 v6, s[56:59], s17 offen sc0 sc1 lds
    s_add_u32 m0, s19, 70656
    s_waitcnt lgkmcnt(4)
    v_mfma_f32_32x32x16_bf16 v[112:127], v[40:43], a[136:139], v[112:127]
    buffer_load_dwordx4 v7, s[56:59], s17 offen sc0 sc1 lds
    s_waitcnt lgkmcnt(0)
    s_waitcnt vmcnt(18)
    s_barrier
    v_mfma_f32_32x32x16_bf16 v[64:79], v[44:47], a[140:143], v[64:79]
    ds_read_b128 v[20:23], v4 offset:0
    ds_read_b128 v[24:27], v4 offset:8192
    v_mfma_f32_32x32x16_bf16 v[80:95], v[48:51], a[140:143], v[80:95]
    ds_read_b128 v[28:31], v17 offset:0
    ds_read_b128 v[40:43], v17 offset:8192
    s_add_u32 m0, s19, 71680
    v_mfma_f32_32x32x16_bf16 v[96:111], v[52:55], a[140:143], v[96:111]
    buffer_load_dwordx4 v8, s[56:59], s17 offen sc0 sc1 lds
    s_add_u32 m0, s19, 72704
    v_mfma_f32_32x32x16_bf16 v[112:127], v[56:59], a[140:143], v[112:127]
    buffer_load_dwordx4 v9, s[56:59], s17 offen sc0 sc1 lds
    s_waitcnt lgkmcnt(3)
    v_mfma_f32_32x32x16_bf16 v[64:79], v[20:23], a[144:147], v[64:79]
    ds_read_b128 v[44:47], v10 offset:0
    ds_read_b128 v[48:51], v10 offset:8192
    s_waitcnt lgkmcnt(4)
    v_mfma_f32_32x32x16_bf16 v[80:95], v[24:27], a[144:147], v[80:95]
    ds_read_b128 v[52:55], v18 offset:0
    ds_read_b128 v[56:59], v18 offset:8192
    s_add_u32 s14, s14, 256
    s_and_b32 s14, s14, 0xfff
    s_add_u32 s16, s7, s14
    s_add_u32 m0, s19, 98304
    s_waitcnt lgkmcnt(5)
    v_mfma_f32_32x32x16_bf16 v[96:111], v[28:31], a[144:147], v[96:111]
    buffer_load_dwordx4 v6, s[56:59], s16 offen sc0 sc1 lds
    s_add_u32 m0, s19, 99328
    s_waitcnt lgkmcnt(4)
    v_mfma_f32_32x32x16_bf16 v[112:127], v[40:43], a[144:147], v[112:127]
    buffer_load_dwordx4 v7, s[56:59], s16 offen sc0 sc1 lds
    s_waitcnt lgkmcnt(3)
    v_mfma_f32_32x32x16_bf16 v[64:79], v[44:47], a[148:151], v[64:79]
    ds_read_b128 v[20:23], v11 offset:0
    ds_read_b128 v[24:27], v11 offset:8192
    s_waitcnt lgkmcnt(4)
    v_mfma_f32_32x32x16_bf16 v[80:95], v[48:51], a[148:151], v[80:95]
    ds_read_b128 v[28:31], v19 offset:0
    ds_read_b128 v[40:43], v19 offset:8192
    s_add_u32 m0, s19, 100352
    s_waitcnt lgkmcnt(5)
    v_mfma_f32_32x32x16_bf16 v[96:111], v[52:55], a[148:151], v[96:111]
    buffer_load_dwordx4 v8, s[56:59], s16 offen sc0 sc1 lds
    s_add_u32 m0, s19, 101376
    s_waitcnt lgkmcnt(4)
    v_mfma_f32_32x32x16_bf16 v[112:127], v[56:59], a[148:151], v[112:127]
    buffer_load_dwordx4 v9, s[56:59], s16 offen sc0 sc1 lds
    s_waitcnt lgkmcnt(3)
    v_mfma_f32_32x32x16_bf16 v[64:79], v[20:23], a[152:155], v[64:79]
    ds_read_b128 v[44:47], v12 offset:0
    ds_read_b128 v[48:51], v12 offset:8192
    s_waitcnt lgkmcnt(4)
    v_mfma_f32_32x32x16_bf16 v[80:95], v[24:27], a[152:155], v[80:95]
    ds_read_b128 v[52:55], v32 offset:0
    ds_read_b128 v[56:59], v32 offset:8192
    s_add_u32 s17, s16, 65536
    s_add_u32 m0, s19, 102400
    s_waitcnt lgkmcnt(5)
    v_mfma_f32_32x32x16_bf16 v[96:111], v[28:31], a[152:155], v[96:111]
    buffer_load_dwordx4 v6, s[56:59], s17 offen sc0 sc1 lds
    s_add_u32 m0, s19, 103424
    s_waitcnt lgkmcnt(4)
    v_mfma_f32_32x32x16_bf16 v[112:127], v[40:43], a[152:155], v[112:127]
    buffer_load_dwordx4 v7, s[56:59], s17 offen sc0 sc1 lds
    s_waitcnt lgkmcnt(0)
    s_waitcnt vmcnt(18)
    s_barrier
    v_mfma_f32_32x32x16_bf16 v[64:79], v[44:47], a[156:159], v[64:79]
    ds_read_b128 v[20:23], v4 offset:32768
    ds_read_b128 v[24:27], v4 offset:40960
    v_mfma_f32_32x32x16_bf16 v[80:95], v[48:51], a[156:159], v[80:95]
    ds_read_b128 v[28:31], v17 offset:32768
    ds_read_b128 v[40:43], v17 offset:40960
    s_add_u32 m0, s19, 104448
    v_mfma_f32_32x32x16_bf16 v[96:111], v[52:55], a[156:159], v[96:111]
    buffer_load_dwordx4 v8, s[56:59], s17 offen sc0 sc1 lds
    s_add_u32 m0, s19, 105472
    v_mfma_f32_32x32x16_bf16 v[112:127], v[56:59], a[156:159], v[112:127]
    buffer_load_dwordx4 v9, s[56:59], s17 offen sc0 sc1 lds
    s_waitcnt lgkmcnt(3)
    v_mfma_f32_32x32x16_bf16 v[64:79], v[20:23], a[160:163], v[64:79]
    ds_read_b128 v[44:47], v10 offset:32768
    ds_read_b128 v[48:51], v10 offset:40960
    s_waitcnt lgkmcnt(4)
    v_mfma_f32_32x32x16_bf16 v[80:95], v[24:27], a[160:163], v[80:95]
    ds_read_b128 v[52:55], v18 offset:32768
    ds_read_b128 v[56:59], v18 offset:40960
    s_add_u32 s14, s14, 256
    s_and_b32 s14, s14, 0xfff
    s_add_u32 s16, s7, s14
    s_add_u32 m0, s19, 0
    s_waitcnt lgkmcnt(5)
    v_mfma_f32_32x32x16_bf16 v[96:111], v[28:31], a[160:163], v[96:111]
    buffer_load_dwordx4 v6, s[56:59], s16 offen sc0 sc1 lds
    s_add_u32 m0, s19, 1024
    s_waitcnt lgkmcnt(4)
    v_mfma_f32_32x32x16_bf16 v[112:127], v[40:43], a[160:163], v[112:127]
    buffer_load_dwordx4 v7, s[56:59], s16 offen sc0 sc1 lds
    s_waitcnt lgkmcnt(3)
    v_mfma_f32_32x32x16_bf16 v[64:79], v[44:47], a[164:167], v[64:79]
    ds_read_b128 v[20:23], v11 offset:32768
    ds_read_b128 v[24:27], v11 offset:40960
    s_waitcnt lgkmcnt(4)
    v_mfma_f32_32x32x16_bf16 v[80:95], v[48:51], a[164:167], v[80:95]
    ds_read_b128 v[28:31], v19 offset:32768
    ds_read_b128 v[40:43], v19 offset:40960
    s_add_u32 m0, s19, 2048
    s_waitcnt lgkmcnt(5)
    v_mfma_f32_32x32x16_bf16 v[96:111], v[52:55], a[164:167], v[96:111]
    buffer_load_dwordx4 v8, s[56:59], s16 offen sc0 sc1 lds
    s_add_u32 m0, s19, 3072
    s_waitcnt lgkmcnt(4)
    v_mfma_f32_32x32x16_bf16 v[112:127], v[56:59], a[164:167], v[112:127]
    buffer_load_dwordx4 v9, s[56:59], s16 offen sc0 sc1 lds
    s_waitcnt lgkmcnt(3)
    v_mfma_f32_32x32x16_bf16 v[64:79], v[20:23], a[168:171], v[64:79]
    ds_read_b128 v[44:47], v12 offset:32768
    ds_read_b128 v[48:51], v12 offset:40960
    s_waitcnt lgkmcnt(4)
    v_mfma_f32_32x32x16_bf16 v[80:95], v[24:27], a[168:171], v[80:95]
    ds_read_b128 v[52:55], v32 offset:32768
    ds_read_b128 v[56:59], v32 offset:40960
    s_add_u32 s17, s16, 65536
    s_add_u32 m0, s19, 4096
    s_waitcnt lgkmcnt(5)
    v_mfma_f32_32x32x16_bf16 v[96:111], v[28:31], a[168:171], v[96:111]
    buffer_load_dwordx4 v6, s[56:59], s17 offen sc0 sc1 lds
    s_add_u32 m0, s19, 5120
    s_waitcnt lgkmcnt(4)
    v_mfma_f32_32x32x16_bf16 v[112:127], v[40:43], a[168:171], v[112:127]
    buffer_load_dwordx4 v7, s[56:59], s17 offen sc0 sc1 lds
    s_waitcnt lgkmcnt(0)
    s_waitcnt vmcnt(14)
    s_barrier
    v_mfma_f32_32x32x16_bf16 v[64:79], v[44:47], a[172:175], v[64:79]
    ds_read_b128 v[20:23], v13 offset:0
    ds_read_b128 v[24:27], v13 offset:8192
    v_mfma_f32_32x32x16_bf16 v[80:95], v[48:51], a[172:175], v[80:95]
    ds_read_b128 v[28:31], v33 offset:0
    ds_read_b128 v[40:43], v33 offset:8192
    s_add_u32 m0, s19, 6144
    v_mfma_f32_32x32x16_bf16 v[96:111], v[52:55], a[172:175], v[96:111]
    buffer_load_dwordx4 v8, s[56:59], s17 offen sc0 sc1 lds
    s_add_u32 m0, s19, 7168
    v_mfma_f32_32x32x16_bf16 v[112:127], v[56:59], a[172:175], v[112:127]
    buffer_load_dwordx4 v9, s[56:59], s17 offen sc0 sc1 lds
    s_waitcnt lgkmcnt(3)
    v_mfma_f32_32x32x16_bf16 v[64:79], v[20:23], a[176:179], v[64:79]
    ds_read_b128 v[44:47], v14 offset:0
    ds_read_b128 v[48:51], v14 offset:8192
    v_lshlrev_b32 v133, 16, v133
    ds_read_b64_tr_b16 v[174:175], v39 offset:0
    v_xor_b32 v202, 0, v61
    s_waitcnt lgkmcnt(5)
    v_mfma_f32_32x32x16_bf16 v[80:95], v[24:27], a[176:179], v[80:95]
    ds_read_b128 v[52:55], v34 offset:0
    ds_read_b128 v[56:59], v34 offset:8192
    s_add_u32 s14, s14, 256
    s_and_b32 s14, s14, 0xfff
    s_add_u32 s16, s7, s14
    s_add_u32 m0, s19, 32768
    s_waitcnt lgkmcnt(6)
    v_mfma_f32_32x32x16_bf16 v[96:111], v[28:31], a[176:179], v[96:111]
    buffer_load_dwordx4 v6, s[56:59], s16 offen sc0 sc1 lds
    ds_read_b64 v[206:207], v202
    s_waitcnt lgkmcnt(0)
    v_lshlrev_b32 v210, 16, v206
    v_lshlrev_b32 v214, 16, v174
    s_add_u32 m0, s19, 33792
    v_mfma_f32_32x32x16_bf16 v[112:127], v[40:43], a[176:179], v[112:127]
    buffer_load_dwordx4 v7, s[56:59], s16 offen sc0 sc1 lds
    v_and_b32 v211, s4, v206
    v_and_b32 v215, s4, v174
    v_lshlrev_b32 v212, 16, v207
    v_lshlrev_b32 v216, 16, v175
    v_mfma_f32_32x32x16_bf16 v[64:79], v[44:47], a[180:183], v[64:79]
    ds_read_b128 v[20:23], v15 offset:0
    ds_read_b128 v[24:27], v15 offset:8192
    v_and_b32 v213, s4, v207
    v_and_b32 v217, s4, v175
    ds_read_b64_tr_b16 v[204:205], v39 offset:1024
    v_mfma_f32_32x32x16_bf16 v[80:95], v[48:51], a[180:183], v[80:95]
    ds_read_b128 v[28:31], v35 offset:0
    ds_read_b128 v[40:43], v35 offset:8192
    v_xor_b32 v202, 16, v61
    ds_read_b64 v[208:209], v202
    s_add_u32 m0, s19, 34816
    v_mfma_f32_32x32x16_bf16 v[96:111], v[52:55], a[180:183], v[96:111]
    buffer_load_dwordx4 v8, s[56:59], s16 offen sc0 sc1 lds
    v_mul_f32 v166, v166, v210
    v_mul_f32 v167, v167, v211
    v_mul_f32 v168, v168, v212
    s_add_u32 m0, s19, 35840
    v_mfma_f32_32x32x16_bf16 v[112:127], v[56:59], a[180:183], v[112:127]
    buffer_load_dwordx4 v9, s[56:59], s16 offen sc0 sc1 lds
    v_mul_f32 v169, v169, v213
    v_fmac_f32 v166, v134, v133
    v_fmac_f32 v167, v135, v133
    v_fmac_f32 v168, v136, v133
    s_waitcnt lgkmcnt(5)
    v_mfma_f32_32x32x16_bf16 v[64:79], v[20:23], a[184:187], v[64:79]
    ds_read_b128 v[44:47], v16 offset:0
    ds_read_b128 v[48:51], v16 offset:8192
    v_fmac_f32 v169, v137, v133
    v_mul_f32 v166, v166, v214
    v_mul_f32 v167, v167, v215
    s_waitcnt lgkmcnt(6)
    v_mfma_f32_32x32x16_bf16 v[80:95], v[24:27], a[184:187], v[80:95]
    ds_read_b128 v[52:55], v36 offset:0
    ds_read_b128 v[56:59], v36 offset:8192
    v_mul_f32 v168, v168, v216
    s_add_u32 s17, s16, 65536
    s_add_u32 m0, s19, 36864
    s_waitcnt lgkmcnt(6)
    v_mfma_f32_32x32x16_bf16 v[96:111], v[28:31], a[184:187], v[96:111]
    buffer_load_dwordx4 v6, s[56:59], s17 offen sc0 sc1 lds
    v_mul_f32 v169, v169, v217
    s_waitcnt lgkmcnt(4)
    v_lshlrev_b32 v210, 16, v208
    v_lshlrev_b32 v214, 16, v204
    s_add_u32 m0, s19, 37888
    v_mfma_f32_32x32x16_bf16 v[112:127], v[40:43], a[184:187], v[112:127]
    buffer_load_dwordx4 v7, s[56:59], s17 offen sc0 sc1 lds
    v_and_b32 v211, s4, v208
    v_and_b32 v215, s4, v204
    v_lshlrev_b32 v212, 16, v209
    v_lshlrev_b32 v216, 16, v205
    s_waitcnt lgkmcnt(0)
    s_waitcnt vmcnt(14)
    s_barrier
    v_mfma_f32_32x32x16_bf16 v[64:79], v[44:47], a[188:191], v[64:79]
    ds_read_b128 v[20:23], v13 offset:32768
    ds_read_b128 v[24:27], v13 offset:40960
    v_and_b32 v213, s4, v209
    v_and_b32 v217, s4, v205
    ds_read_b64_tr_b16 v[174:175], v39 offset:2048
    v_mfma_f32_32x32x16_bf16 v[80:95], v[48:51], a[188:191], v[80:95]
    ds_read_b128 v[28:31], v33 offset:32768
    ds_read_b128 v[40:43], v33 offset:40960
    v_xor_b32 v202, 32, v61
    ds_read_b64 v[206:207], v202
    s_add_u32 m0, s19, 38912
    v_mfma_f32_32x32x16_bf16 v[96:111], v[52:55], a[188:191], v[96:111]
    buffer_load_dwordx4 v8, s[56:59], s17 offen sc0 sc1 lds
    v_mul_f32 v170, v170, v210
    v_mul_f32 v171, v171, v211
    v_mul_f32 v172, v172, v212
    s_add_u32 m0, s19, 39936
    v_mfma_f32_32x32x16_bf16 v[112:127], v[56:59], a[188:191], v[112:127]
    buffer_load_dwordx4 v9, s[56:59], s17 offen sc0 sc1 lds
    v_mul_f32 v173, v173, v213
    v_fmac_f32 v170, v138, v133
    v_fmac_f32 v171, v139, v133
    v_fmac_f32 v172, v140, v133
    s_waitcnt lgkmcnt(5)
    v_mfma_f32_32x32x16_bf16 v[64:79], v[20:23], a[192:195], v[64:79]
    ds_read_b128 v[44:47], v14 offset:32768
    ds_read_b128 v[48:51], v14 offset:40960
    v_fmac_f32 v173, v141, v133
    v_mul_f32 v170, v170, v214
    v_mul_f32 v171, v171, v215
    s_waitcnt lgkmcnt(6)
    v_mfma_f32_32x32x16_bf16 v[80:95], v[24:27], a[192:195], v[80:95]
    ds_read_b128 v[52:55], v34 offset:32768
    ds_read_b128 v[56:59], v34 offset:40960
    s_add_u32 s14, s14, 256
    s_and_b32 s14, s14, 0xfff
    s_add_u32 s16, s7, s14
    s_add_u32 m0, s19, 65536
    s_waitcnt lgkmcnt(6)
    v_mfma_f32_32x32x16_bf16 v[96:111], v[28:31], a[192:195], v[96:111]
    buffer_load_dwordx4 v6, s[56:59], s16 offen sc0 sc1 lds
    v_mul_f32 v172, v172, v216
    v_mul_f32 v173, v173, v217
    s_waitcnt lgkmcnt(4)
    v_lshlrev_b32 v210, 16, v206
    s_add_u32 m0, s19, 66560
    v_mfma_f32_32x32x16_bf16 v[112:127], v[40:43], a[192:195], v[112:127]
    buffer_load_dwordx4 v7, s[56:59], s16 offen sc0 sc1 lds
    v_lshlrev_b32 v214, 16, v174
    v_and_b32 v211, s4, v206
    v_and_b32 v215, s4, v174
    v_lshlrev_b32 v212, 16, v207
    s_waitcnt lgkmcnt(3)
    v_mfma_f32_32x32x16_bf16 v[64:79], v[44:47], a[196:199], v[64:79]
    ds_read_b128 v[20:23], v15 offset:32768
    ds_read_b128 v[24:27], v15 offset:40960
    v_lshlrev_b32 v216, 16, v175
    v_and_b32 v213, s4, v207
    v_and_b32 v217, s4, v175
    s_waitcnt lgkmcnt(4)
    v_mfma_f32_32x32x16_bf16 v[80:95], v[48:51], a[196:199], v[80:95]
    ds_read_b128 v[28:31], v35 offset:32768
    ds_read_b128 v[40:43], v35 offset:40960
    ds_read_b64_tr_b16 v[204:205], v39 offset:3072
    v_xor_b32 v202, 48, v61
    s_add_u32 m0, s19, 67584
    s_waitcnt lgkmcnt(6)
    v_mfma_f32_32x32x16_bf16 v[96:111], v[52:55], a[196:199], v[96:111]
    buffer_load_dwordx4 v8, s[56:59], s16 offen sc0 sc1 lds
    ds_read_b64 v[208:209], v202
    v_mul_f32 v178, v178, v210
    v_mul_f32 v179, v179, v211
    s_add_u32 m0, s19, 68608
    s_waitcnt lgkmcnt(6)
    v_mfma_f32_32x32x16_bf16 v[112:127], v[56:59], a[196:199], v[112:127]
    buffer_load_dwordx4 v9, s[56:59], s16 offen sc0 sc1 lds
    v_mul_f32 v180, v180, v212
    v_mul_f32 v181, v181, v213
    v_fmac_f32 v178, v142, v133
    v_fmac_f32 v179, v143, v133
    s_waitcnt lgkmcnt(5)
    v_mfma_f32_32x32x16_bf16 v[64:79], v[20:23], a[200:203], v[64:79]
    ds_read_b128 v[44:47], v16 offset:32768
    ds_read_b128 v[48:51], v16 offset:40960
    v_fmac_f32 v180, v144, v133
    v_fmac_f32 v181, v145, v133
    v_mul_f32 v178, v178, v214
    s_waitcnt lgkmcnt(6)
    v_mfma_f32_32x32x16_bf16 v[80:95], v[24:27], a[200:203], v[80:95]
    ds_read_b128 v[52:55], v36 offset:32768
    ds_read_b128 v[56:59], v36 offset:40960
    v_mul_f32 v179, v179, v215
    s_add_u32 s17, s16, 65536
    s_add_u32 m0, s19, 69632
    s_waitcnt lgkmcnt(7)
    v_mfma_f32_32x32x16_bf16 v[96:111], v[28:31], a[200:203], v[96:111]
    buffer_load_dwordx4 v6, s[56:59], s17 offen sc0 sc1 lds
    v_mul_f32 v180, v180, v216
    v_mul_f32 v181, v181, v217
    s_waitcnt lgkmcnt(4)
    v_lshlrev_b32 v210, 16, v208
    s_add_u32 m0, s19, 70656
    v_mfma_f32_32x32x16_bf16 v[112:127], v[40:43], a[200:203], v[112:127]
    buffer_load_dwordx4 v7, s[56:59], s17 offen sc0 sc1 lds
    v_lshlrev_b32 v214, 16, v204
    v_and_b32 v211, s4, v208
    v_and_b32 v215, s4, v204
    v_lshlrev_b32 v212, 16, v209
    s_waitcnt lgkmcnt(0)
    s_waitcnt vmcnt(14)
    s_barrier
    v_mfma_f32_32x32x16_bf16 v[64:79], v[44:47], a[204:207], v[64:79]
    ds_read_b128 v[20:23], v4 offset:0
    ds_read_b128 v[24:27], v4 offset:8192
    v_lshlrev_b32 v216, 16, v205
    v_and_b32 v213, s4, v209
    v_and_b32 v217, s4, v205
    v_mfma_f32_32x32x16_bf16 v[80:95], v[48:51], a[204:207], v[80:95]
    ds_read_b128 v[28:31], v17 offset:0
    ds_read_b128 v[40:43], v17 offset:8192
    ds_read_b64_tr_b16 v[174:175], v39 offset:4096
    v_xor_b32 v202, 64, v61
    s_add_u32 m0, s19, 71680
    v_mfma_f32_32x32x16_bf16 v[96:111], v[52:55], a[204:207], v[96:111]
    buffer_load_dwordx4 v8, s[56:59], s17 offen sc0 sc1 lds
    ds_read_b64 v[206:207], v202
    v_mul_f32 v182, v182, v210
    v_mul_f32 v183, v183, v211
    s_add_u32 m0, s19, 72704
    v_mfma_f32_32x32x16_bf16 v[112:127], v[56:59], a[204:207], v[112:127]
    buffer_load_dwordx4 v9, s[56:59], s17 offen sc0 sc1 lds
    v_mul_f32 v184, v184, v212
    v_mul_f32 v185, v185, v213
    v_fmac_f32 v182, v146, v133
    v_fmac_f32 v183, v147, v133
    s_waitcnt lgkmcnt(5)
    v_mfma_f32_32x32x16_bf16 v[64:79], v[20:23], a[208:211], v[64:79]
    ds_read_b128 v[44:47], v10 offset:0
    ds_read_b128 v[48:51], v10 offset:8192
    v_fmac_f32 v184, v148, v133
    v_fmac_f32 v185, v149, v133
    v_mul_f32 v182, v182, v214
    s_waitcnt lgkmcnt(6)
    v_mfma_f32_32x32x16_bf16 v[80:95], v[24:27], a[208:211], v[80:95]
    ds_read_b128 v[52:55], v18 offset:0
    ds_read_b128 v[56:59], v18 offset:8192
    v_mul_f32 v183, v183, v215
    v_mul_f32 v184, v184, v216
    v_mul_f32 v185, v185, v217
    s_waitcnt lgkmcnt(7)
    v_mfma_f32_32x32x16_bf16 v[96:111], v[28:31], a[208:211], v[96:111]
    s_waitcnt lgkmcnt(4)
    v_lshlrev_b32 v210, 16, v206
    v_lshlrev_b32 v214, 16, v174
    v_and_b32 v211, s4, v206
    v_and_b32 v215, s4, v174
    v_lshlrev_b32 v212, 16, v207
    v_mfma_f32_32x32x16_bf16 v[112:127], v[40:43], a[208:211], v[112:127]
    v_lshlrev_b32 v216, 16, v175
    v_and_b32 v213, s4, v207
    v_and_b32 v217, s4, v175
    ds_read_b64_tr_b16 v[204:205], v39 offset:5120
    v_xor_b32 v202, 80, v61
    s_waitcnt lgkmcnt(4)
    v_mfma_f32_32x32x16_bf16 v[64:79], v[44:47], a[212:215], v[64:79]
    ds_read_b128 v[20:23], v11 offset:0
    ds_read_b128 v[24:27], v11 offset:8192
    ds_read_b64 v[208:209], v202
    v_mul_f32 v186, v186, v210
    v_mul_f32 v187, v187, v211
    s_waitcnt lgkmcnt(6)
    v_mfma_f32_32x32x16_bf16 v[80:95], v[48:51], a[212:215], v[80:95]
    ds_read_b128 v[28:31], v19 offset:0
    ds_read_b128 v[40:43], v19 offset:8192
    v_mul_f32 v188, v188, v212
    v_mul_f32 v189, v189, v213
    v_fmac_f32 v186, v150, v133
    s_waitcnt lgkmcnt(7)
    v_mfma_f32_32x32x16_bf16 v[96:111], v[52:55], a[212:215], v[96:111]
    v_fmac_f32 v187, v151, v133
    v_fmac_f32 v188, v152, v133
    v_fmac_f32 v189, v153, v133
    v_mul_f32 v186, v186, v214
    v_mul_f32 v187, v187, v215
    s_waitcnt lgkmcnt(6)
    v_mfma_f32_32x32x16_bf16 v[112:127], v[56:59], a[212:215], v[112:127]
    v_mul_f32 v188, v188, v216
    v_mul_f32 v189, v189, v217
    s_waitcnt lgkmcnt(2)
    v_lshlrev_b32 v210, 16, v208
    v_lshlrev_b32 v214, 16, v204
    v_and_b32 v211, s4, v208
    v_mfma_f32_32x32x16_bf16 v[64:79], v[20:23], a[216:219], v[64:79]
    ds_read_b128 v[44:47], v12 offset:0
    ds_read_b128 v[48:51], v12 offset:8192
    v_and_b32 v215, s4, v204
    v_lshlrev_b32 v212, 16, v209
    v_lshlrev_b32 v216, 16, v205
    v_mfma_f32_32x32x16_bf16 v[80:95], v[24:27], a[216:219], v[80:95]
    ds_read_b128 v[52:55], v32 offset:0
    ds_read_b128 v[56:59], v32 offset:8192
    v_and_b32 v213, s4, v209
    v_and_b32 v217, s4, v205
    ds_read_b64_tr_b16 v[174:175], v39 offset:6144
    s_waitcnt lgkmcnt(6)
    v_mfma_f32_32x32x16_bf16 v[96:111], v[28:31], a[216:219], v[96:111]
    v_xor_b32 v202, 96, v61
    ds_read_b64 v[206:207], v202
    v_mul_f32 v190, v190, v210
    v_mul_f32 v191, v191, v211
    v_mul_f32 v192, v192, v212
    s_waitcnt lgkmcnt(6)
    v_mfma_f32_32x32x16_bf16 v[112:127], v[40:43], a[216:219], v[112:127]
    v_mul_f32 v193, v193, v213
    v_fmac_f32 v190, v154, v133
    v_fmac_f32 v191, v155, v133
    v_fmac_f32 v192, v156, v133
    v_fmac_f32 v193, v157, v133
    s_waitcnt lgkmcnt(2)
    s_waitcnt vmcnt(8)
    s_barrier
    v_mfma_f32_32x32x16_bf16 v[64:79], v[44:47], a[220:223], v[64:79]
    ds_read_b128 v[20:23], v4 offset:32768
    ds_read_b128 v[24:27], v4 offset:40960
    v_mul_f32 v190, v190, v214
    v_mul_f32 v191, v191, v215
    v_mul_f32 v192, v192, v216
    v_mfma_f32_32x32x16_bf16 v[80:95], v[48:51], a[220:223], v[80:95]
    ds_read_b128 v[28:31], v17 offset:32768
    ds_read_b128 v[40:43], v17 offset:40960
    v_mul_f32 v193, v193, v217
    s_waitcnt lgkmcnt(4)
    v_lshlrev_b32 v210, 16, v206
    v_lshlrev_b32 v214, 16, v174
    v_mfma_f32_32x32x16_bf16 v[96:111], v[52:55], a[220:223], v[96:111]
    v_and_b32 v211, s4, v206
    v_and_b32 v215, s4, v174
    v_lshlrev_b32 v212, 16, v207
    v_lshlrev_b32 v216, 16, v175
    v_and_b32 v213, s4, v207
    v_mfma_f32_32x32x16_bf16 v[112:127], v[56:59], a[220:223], v[112:127]
    v_and_b32 v217, s4, v175
    ds_read_b64_tr_b16 v[204:205], v39 offset:7168
    v_xor_b32 v202, 112, v61
    ds_read_b64 v[208:209], v202
    v_mul_f32 v194, v194, v210
    s_waitcnt lgkmcnt(5)
    v_mfma_f32_32x32x16_bf16 v[64:79], v[20:23], a[224:227], v[64:79]
    ds_read_b128 v[44:47], v10 offset:32768
    ds_read_b128 v[48:51], v10 offset:40960
    v_mul_f32 v195, v195, v211
    v_mul_f32 v196, v196, v212
    v_mul_f32 v197, v197, v213
    s_waitcnt lgkmcnt(6)
    v_mfma_f32_32x32x16_bf16 v[80:95], v[24:27], a[224:227], v[80:95]
    ds_read_b128 v[52:55], v18 offset:32768
    ds_read_b128 v[56:59], v18 offset:40960
    v_fmac_f32 v194, v158, v133
    v_fmac_f32 v195, v159, v133
    v_fmac_f32 v196, v160, v133
    s_waitcnt lgkmcnt(7)
    v_mfma_f32_32x32x16_bf16 v[96:111], v[28:31], a[224:227], v[96:111]
    v_fmac_f32 v197, v161, v133
    v_mul_f32 v194, v194, v214
    v_mul_f32 v195, v195, v215
    v_mul_f32 v196, v196, v216
    v_mul_f32 v197, v197, v217
    s_waitcnt lgkmcnt(6)
    v_mfma_f32_32x32x16_bf16 v[112:127], v[40:43], a[224:227], v[112:127]
    s_waitcnt lgkmcnt(4)
    v_lshlrev_b32 v210, 16, v208
    v_lshlrev_b32 v214, 16, v204
    v_and_b32 v211, s4, v208
    v_and_b32 v215, s4, v204
    v_lshlrev_b32 v212, 16, v209
    s_waitcnt lgkmcnt(3)
    v_mfma_f32_32x32x16_bf16 v[64:79], v[44:47], a[228:231], v[64:79]
    ds_read_b128 v[20:23], v11 offset:32768
    ds_read_b128 v[24:27], v11 offset:40960
    v_lshlrev_b32 v216, 16, v205
    v_and_b32 v213, s4, v209
    v_and_b32 v217, s4, v205
    s_waitcnt lgkmcnt(4)
    v_mfma_f32_32x32x16_bf16 v[80:95], v[48:51], a[228:231], v[80:95]
    ds_read_b128 v[28:31], v19 offset:32768
    ds_read_b128 v[40:43], v19 offset:40960
    v_mul_f32 v198, v198, v210
    v_mul_f32 v199, v199, v211
    v_mul_f32 v200, v200, v212
    s_waitcnt lgkmcnt(5)
    v_mfma_f32_32x32x16_bf16 v[96:111], v[52:55], a[228:231], v[96:111]
    v_mul_f32 v201, v201, v213
    v_fmac_f32 v198, v162, v133
    v_fmac_f32 v199, v163, v133
    v_fmac_f32 v200, v164, v133
    v_fmac_f32 v201, v165, v133
    s_waitcnt lgkmcnt(4)
    v_mfma_f32_32x32x16_bf16 v[112:127], v[56:59], a[228:231], v[112:127]
    v_mul_f32 v198, v198, v214
    v_mul_f32 v199, v199, v215
    v_mul_f32 v200, v200, v216
    v_mul_f32 v201, v201, v217
    s_waitcnt lgkmcnt(3)
    v_mfma_f32_32x32x16_bf16 v[64:79], v[20:23], a[232:235], v[64:79]
    ds_read_b128 v[44:47], v12 offset:32768
    ds_read_b128 v[48:51], v12 offset:40960
    s_waitcnt lgkmcnt(4)
    v_mfma_f32_32x32x16_bf16 v[80:95], v[24:27], a[232:235], v[80:95]
    ds_read_b128 v[52:55], v32 offset:32768
    ds_read_b128 v[56:59], v32 offset:40960
    s_waitcnt lgkmcnt(5)
    v_mfma_f32_32x32x16_bf16 v[96:111], v[28:31], a[232:235], v[96:111]
    s_waitcnt lgkmcnt(4)
    v_mfma_f32_32x32x16_bf16 v[112:127], v[40:43], a[232:235], v[112:127]
    s_waitcnt lgkmcnt(0)
    s_waitcnt vmcnt(0)
    s_barrier
    v_mfma_f32_32x32x16_bf16 v[64:79], v[44:47], a[236:239], v[64:79]
    ds_read_b128 v[20:23], v33 offset:0
    ds_read_b128 v[24:27], v33 offset:8192
    v_mfma_f32_32x32x16_bf16 v[80:95], v[48:51], a[236:239], v[80:95]
    ds_read_b128 v[28:31], v34 offset:0
    ds_read_b128 v[40:43], v34 offset:8192
    v_mfma_f32_32x32x16_bf16 v[96:111], v[52:55], a[236:239], v[96:111]
    v_mfma_f32_32x32x16_bf16 v[112:127], v[56:59], a[236:239], v[112:127]
    s_waitcnt lgkmcnt(3)
    v_mfma_f32_32x32x16_bf16 v[96:111], v[20:23], a[240:243], v[96:111]
    ds_read_b128 v[44:47], v35 offset:0
    ds_read_b128 v[48:51], v35 offset:8192
    s_waitcnt lgkmcnt(4)
    v_mfma_f32_32x32x16_bf16 v[112:127], v[24:27], a[240:243], v[112:127]
    ds_read_b128 v[52:55], v36 offset:0
    ds_read_b128 v[56:59], v36 offset:8192
    s_waitcnt lgkmcnt(5)
    v_mfma_f32_32x32x16_bf16 v[96:111], v[28:31], a[244:247], v[96:111]
    s_waitcnt lgkmcnt(4)
    v_mfma_f32_32x32x16_bf16 v[112:127], v[40:43], a[244:247], v[112:127]
    s_waitcnt lgkmcnt(3)
    v_mfma_f32_32x32x16_bf16 v[96:111], v[44:47], a[248:251], v[96:111]
    ds_read_b128 v[20:23], v13 offset:0
    ds_read_b128 v[24:27], v13 offset:8192
    s_waitcnt lgkmcnt(4)
    v_mfma_f32_32x32x16_bf16 v[112:127], v[48:51], a[248:251], v[112:127]
    ds_read_b128 v[28:31], v14 offset:0
    ds_read_b128 v[40:43], v14 offset:8192
    s_waitcnt lgkmcnt(5)
    v_mfma_f32_32x32x16_bf16 v[96:111], v[52:55], a[252:255], v[96:111]
    s_waitcnt lgkmcnt(4)
    v_mfma_f32_32x32x16_bf16 v[112:127], v[56:59], a[252:255], v[112:127]
    s_waitcnt lgkmcnt(3)
    v_mfma_f32_32x32x16_bf16 v[64:79], v[20:23], a[240:243], v[64:79]
    ds_read_b128 v[44:47], v15 offset:0
    ds_read_b128 v[48:51], v15 offset:8192
    s_nop 5
    ds_write_b128 v218, v[96:99] offset:0
    s_waitcnt lgkmcnt(5)
    v_mfma_f32_32x32x16_bf16 v[80:95], v[24:27], a[240:243], v[80:95]
    ds_read_b128 v[52:55], v16 offset:0
    ds_read_b128 v[56:59], v16 offset:8192
    ds_write_b128 v218, v[100:103] offset:1024
    s_waitcnt lgkmcnt(7)
    v_mfma_f32_32x32x16_bf16 v[64:79], v[28:31], a[244:247], v[64:79]
    ds_write_b128 v218, v[104:107] offset:2048
    s_waitcnt lgkmcnt(7)
    v_mfma_f32_32x32x16_bf16 v[80:95], v[40:43], a[244:247], v[80:95]
    ds_write_b128 v218, v[108:111] offset:3072
    s_waitcnt lgkmcnt(3)
    v_mfma_f32_32x32x16_bf16 v[64:79], v[44:47], a[248:251], v[64:79]
    ds_write_b128 v218, v[112:115] offset:4096
    v_mfma_f32_32x32x16_bf16 v[80:95], v[48:51], a[248:251], v[80:95]
    ds_write_b128 v218, v[116:119] offset:5120
    v_mfma_f32_32x32x16_bf16 v[64:79], v[52:55], a[252:255], v[64:79]
    ds_write_b128 v218, v[120:123] offset:6144
    v_mfma_f32_32x32x16_bf16 v[80:95], v[56:59], a[252:255], v[80:95]
    ds_write_b128 v218, v[124:127] offset:7168
    s_waitcnt lgkmcnt(0)
    s_barrier
    ds_read_b128 v[20:23], v219 offset:0
    ds_read_b128 v[24:27], v219 offset:1024
    ds_read_b128 v[28:31], v219 offset:2048
    ds_read_b128 v[40:43], v219 offset:3072
    ds_read_b128 v[44:47], v219 offset:4096
    ds_read_b128 v[48:51], v219 offset:5120
    ds_read_b128 v[52:55], v219 offset:6144
    ds_read_b128 v[56:59], v219 offset:7168
    s_waitcnt lgkmcnt(7)
    v_add_f32 v64, v64, v20
    v_add_f32 v65, v65, v21
    v_add_f32 v66, v66, v22
    v_add_f32 v67, v67, v23
    v_fma_f32 v64, v134, v64, v166
    v_fma_f32 v65, v135, v65, v167
    v_fma_f32 v66, v136, v66, v168
    v_fma_f32 v67, v137, v67, v169
    buffer_store_dword v64, v129, s[32:35], s38 offen
    buffer_store_dword v65, v130, s[32:35], s38 offen
    buffer_store_dword v66, v131, s[32:35], s38 offen
    buffer_store_dword v67, v132, s[32:35], s38 offen
    s_waitcnt lgkmcnt(6)
    v_add_f32 v68, v68, v24
    v_add_f32 v69, v69, v25
    v_add_f32 v70, v70, v26
    v_add_f32 v71, v71, v27
    v_fma_f32 v68, v138, v68, v170
    v_fma_f32 v69, v139, v69, v171
    v_fma_f32 v70, v140, v70, v172
    v_fma_f32 v71, v141, v71, v173
    s_add_u32 s38, s38, 32768
    buffer_store_dword v68, v129, s[32:35], s38 offen
    buffer_store_dword v69, v130, s[32:35], s38 offen
    buffer_store_dword v70, v131, s[32:35], s38 offen
    buffer_store_dword v71, v132, s[32:35], s38 offen
    s_waitcnt lgkmcnt(5)
    v_add_f32 v72, v72, v28
    v_add_f32 v73, v73, v29
    v_add_f32 v74, v74, v30
    v_add_f32 v75, v75, v31
    v_fma_f32 v72, v142, v72, v178
    v_fma_f32 v73, v143, v73, v179
    v_fma_f32 v74, v144, v74, v180
    v_fma_f32 v75, v145, v75, v181
    s_add_u32 s38, s38, 32768
    buffer_store_dword v72, v129, s[32:35], s38 offen
    buffer_store_dword v73, v130, s[32:35], s38 offen
    buffer_store_dword v74, v131, s[32:35], s38 offen
    buffer_store_dword v75, v132, s[32:35], s38 offen
    s_waitcnt lgkmcnt(4)
    v_add_f32 v76, v76, v40
    v_add_f32 v77, v77, v41
    v_add_f32 v78, v78, v42
    v_add_f32 v79, v79, v43
    v_fma_f32 v76, v146, v76, v182
    v_fma_f32 v77, v147, v77, v183
    v_fma_f32 v78, v148, v78, v184
    v_fma_f32 v79, v149, v79, v185
    s_add_u32 s38, s38, 32768
    buffer_store_dword v76, v129, s[32:35], s38 offen
    buffer_store_dword v77, v130, s[32:35], s38 offen
    buffer_store_dword v78, v131, s[32:35], s38 offen
    buffer_store_dword v79, v132, s[32:35], s38 offen
    s_waitcnt lgkmcnt(3)
    v_add_f32 v80, v80, v44
    v_add_f32 v81, v81, v45
    v_add_f32 v82, v82, v46
    v_add_f32 v83, v83, v47
    v_fma_f32 v80, v150, v80, v186
    v_fma_f32 v81, v151, v81, v187
    v_fma_f32 v82, v152, v82, v188
    v_fma_f32 v83, v153, v83, v189
    s_add_u32 s38, s38, 32768
    buffer_store_dword v80, v129, s[32:35], s38 offen
    buffer_store_dword v81, v130, s[32:35], s38 offen
    buffer_store_dword v82, v131, s[32:35], s38 offen
    buffer_store_dword v83, v132, s[32:35], s38 offen
    s_waitcnt lgkmcnt(2)
    v_add_f32 v84, v84, v48
    v_add_f32 v85, v85, v49
    v_add_f32 v86, v86, v50
    v_add_f32 v87, v87, v51
    v_fma_f32 v84, v154, v84, v190
    v_fma_f32 v85, v155, v85, v191
    v_fma_f32 v86, v156, v86, v192
    v_fma_f32 v87, v157, v87, v193
    s_add_u32 s38, s38, 32768
    buffer_store_dword v84, v129, s[32:35], s38 offen
    buffer_store_dword v85, v130, s[32:35], s38 offen
    buffer_store_dword v86, v131, s[32:35], s38 offen
    buffer_store_dword v87, v132, s[32:35], s38 offen
    s_waitcnt lgkmcnt(1)
    v_add_f32 v88, v88, v52
    v_add_f32 v89, v89, v53
    v_add_f32 v90, v90, v54
    v_add_f32 v91, v91, v55
    v_fma_f32 v88, v158, v88, v194
    v_fma_f32 v89, v159, v89, v195
    v_fma_f32 v90, v160, v90, v196
    v_fma_f32 v91, v161, v91, v197
    s_add_u32 s38, s38, 32768
    buffer_store_dword v88, v129, s[32:35], s38 offen
    buffer_store_dword v89, v130, s[32:35], s38 offen
    buffer_store_dword v90, v131, s[32:35], s38 offen
    buffer_store_dword v91, v132, s[32:35], s38 offen
    s_waitcnt lgkmcnt(0)
    v_add_f32 v92, v92, v56
    v_add_f32 v93, v93, v57
    v_add_f32 v94, v94, v58
    v_add_f32 v95, v95, v59
    v_fma_f32 v92, v162, v92, v198
    v_fma_f32 v93, v163, v93, v199
    v_fma_f32 v94, v164, v94, v200
    v_fma_f32 v95, v165, v95, v201
    s_add_u32 s38, s38, 32768
    buffer_store_dword v92, v129, s[32:35], s38 offen
    buffer_store_dword v93, v130, s[32:35], s38 offen
    buffer_store_dword v94, v131, s[32:35], s38 offen
    buffer_store_dword v95, v132, s[32:35], s38 offen
Lend_gated_mix__ssm_conv_s5__ssm_conv_h3__prompt_kernel:
    s_endpgm

.section .rodata,"a"
.p2align 6
.amdhsa_kernel gated_mix__ssm_conv_s5__ssm_conv_h3__prompt_kernel
  .amdhsa_next_free_vgpr 496
  .amdhsa_next_free_sgpr 84
  .amdhsa_accum_offset 240
  .amdhsa_group_segment_fixed_size 0
  .amdhsa_kernarg_size 152
  .amdhsa_user_sgpr_count 2
  .amdhsa_user_sgpr_kernarg_segment_ptr 1
  .amdhsa_system_sgpr_workgroup_id_x 1
  .amdhsa_float_denorm_mode_32 3
.end_amdhsa_kernel
```

```asm
; @launch grid=(256,1,1) block=(256,1,1) lds=163840
.amdgcn_target "amdgcn-amd-amdhsa--gfx950"
.text
.globl gated_mix__ssm_conv_s5__ssm_conv_h3__prompt_kernel
.p2align 8
.type gated_mix__ssm_conv_s5__ssm_conv_h3__prompt_kernel,@function
gated_mix__ssm_conv_s5__ssm_conv_h3__prompt_kernel:
    s_cmp_ge_u32 s2, 256
    s_cbranch_scc1 Lend_gated_mix__ssm_conv_s5__ssm_conv_h3__prompt_kernel
    s_load_dwordx16 s[4:19], s[0:1], 0
    s_load_dwordx16 s[20:35], s[0:1], 64
    s_load_dwordx4 s[36:39], s[0:1], 128
    s_load_dwordx2 s[40:41], s[0:1], 144
    s_waitcnt lgkmcnt(0)
    s_memrealtime s[22:23]
    v_lshrrev_b32 v1, 6, v0
    s_nop 0
    v_readfirstlane_b32 s42, v1
    v_and_b32 v1, 63, v0
    s_and_b32 s45, s2, 7
    s_lshr_b32 s43, s45, 1
    s_lshl_b32 s43, s43, 2
    s_and_b32 s44, s45, 1
    s_lshl_b32 s44, s44, 3
    s_lshr_b32 s45, s2, 3
    s_and_b32 s3, s45, 3
    s_add_u32 s43, s43, s3
    s_lshr_b32 s45, s45, 2
    s_add_u32 s44, s44, s45
    v_mov_b32 v4, 0
    v_mov_b32 v5, 0
    v_mov_b32 v6, 0
    v_mov_b32 v7, 0
    v_lshlrev_b32 v2, 4, v0
    v_add_u32 v2, 147456, v2
    ds_write_b128 v2, v[4:7]
    v_lshlrev_b32 v2, 2, v0
    v_add_u32 v2, 151552, v2
    ds_write_b32 v2, v4
    v_lshrrev_b32 v3, 4, v1
    v_and_b32 v16, 7, v1
    v_xor_b32 v16, v16, v3
    v_lshlrev_b32 v16, 4, v16
    v_lshrrev_b32 v3, 3, v1
    v_lshl_add_u32 v12, v3, 11, v16
    v_and_b32 v3, 32, v1
    v_lshl_add_u32 v8, v3, 11, v16
    v_and_b32 v3, 8, v1
    v_lshl_add_u32 v8, v3, 12, v8
    v_and_b32 v3, 16, v1
    v_lshl_add_u32 v8, v3, 7, v8
    v_xor_b32 v3, 64, v8
    v_xor_b32 v16, 64, v12
    v_add_u32 v9, 4096, v3
    v_add_u32 v10, 8192, v8
    v_add_u32 v11, 12288, v3
    v_add_u32 v13, 16384, v16
    v_add_u32 v14, 32768, v12
    v_add_u32 v15, 49152, v16
    s_lshr_b32 s48, s42, 1
    s_lshl_b32 s45, s43, 7
    s_lshl_b32 s3, s48, 6
    s_add_u32 s45, s45, s3
    s_and_b32 s3, s42, 1
    s_lshl_b32 s3, s3, 3
    s_add_u32 s45, s45, s3
    s_lshl_b32 s45, s45, 11
    s_lshl_b32 s46, s44, 6
    s_lshl_b32 s3, s48, 5
    s_add_u32 s46, s46, s3
    s_lshl_b32 s46, s46, 11
    s_lshl_b32 s47, s42, 12
    s_lshl_b32 s3, s43, 2
    s_add_u32 s3, s3, s44
    s_and_b32 s3, s3, 15
    s_lshl_b32 s49, s3, 7
    v_bfe_u32 v16, v1, 3, 2
    v_lshrrev_b32 v17, 5, v1
    v_lshlrev_b32 v17, 2, v17
    v_lshl_add_u32 v16, v16, 3, v17
    v_and_b32 v17, 7, v1
    v_lshlrev_b32 v17, 4, v17
    v_lshl_add_u32 v3, v16, 11, v17
    s_lshl_b32 s48, s43, 7
    s_lshl_b32 s3, s42, 5
    s_add_u32 s48, s48, s3
    s_lshl_b32 s48, s48, 11
    s_lshl_b32 s3, s44, 7
    s_add_u32 s48, s48, s3
    v_add_u32 v3, s48, v3
    v_subrev_u32 v16, 6144, v3
    v_min_u32 v16, 0x7fff0000, v16
    v_subrev_u32 v20, 4096, v3
    v_min_u32 v20, 0x7fff0000, v20
    v_subrev_u32 v24, 2048, v3
    v_min_u32 v24, 0x7fff0000, v24
    s_mov_b32 s48, 4096
    s_lshl_b32 s52, s44, 9
    v_lshlrev_b32 v60, 4, v1
    s_mov_b32 s56, s4
    s_mov_b32 s57, s5
    s_mov_b32 s58, 4194304
    s_mov_b32 s59, 131072
    s_and_b32 s3, s42, 1
    s_cmp_eq_u32 s3, 0
    s_cselect_b32 s60, s10, s12
    s_cselect_b32 s61, s11, s13
    s_mov_b32 s62, 2097152
    s_mov_b32 s63, 131072
    s_waitcnt lgkmcnt(0)
    s_add_u32 s50, s45, s49
    s_add_u32 m0, s47, 0
    s_nop 0
    buffer_load_dwordx4 v8, s[56:59], s50 offen  lds
    s_add_u32 m0, s47, 1024
    s_nop 0
    buffer_load_dwordx4 v9, s[56:59], s50 offen  lds
    s_add_u32 m0, s47, 2048
    s_nop 0
    buffer_load_dwordx4 v10, s[56:59], s50 offen  lds
    s_add_u32 m0, s47, 3072
    s_nop 0
    buffer_load_dwordx4 v11, s[56:59], s50 offen  lds
    s_add_u32 s51, s46, s49
    s_add_u32 m0, s47, 16384
    s_nop 0
    buffer_load_dwordx4 v12, s[60:63], s51 offen  lds
    s_add_u32 m0, s47, 17408
    s_nop 0
    buffer_load_dwordx4 v13, s[60:63], s51 offen  lds
    s_add_u32 m0, s47, 18432
    s_nop 0
    buffer_load_dwordx4 v14, s[60:63], s51 offen  lds
    s_add_u32 m0, s47, 19456
    s_nop 0
    buffer_load_dwordx4 v15, s[60:63], s51 offen  lds
    s_add_u32 s49, s49, 128
    s_and_b32 s49, s49, 0x7ff
    s_add_u32 s50, s45, s49
    s_add_u32 m0, s47, 32768
    s_nop 0
    buffer_load_dwordx4 v8, s[56:59], s50 offen  lds
    s_add_u32 m0, s47, 33792
    s_nop 0
    buffer_load_dwordx4 v9, s[56:59], s50 offen  lds
    s_add_u32 m0, s47, 34816
    s_nop 0
    buffer_load_dwordx4 v10, s[56:59], s50 offen  lds
    s_add_u32 m0, s47, 35840
    s_nop 0
    buffer_load_dwordx4 v11, s[56:59], s50 offen  lds
    s_add_u32 s51, s46, s49
    s_add_u32 m0, s47, 49152
    s_nop 0
    buffer_load_dwordx4 v12, s[60:63], s51 offen  lds
    s_add_u32 m0, s47, 50176
    s_nop 0
    buffer_load_dwordx4 v13, s[60:63], s51 offen  lds
    s_add_u32 m0, s47, 51200
    s_nop 0
    buffer_load_dwordx4 v14, s[60:63], s51 offen  lds
    s_add_u32 m0, s47, 52224
    s_nop 0
    buffer_load_dwordx4 v15, s[60:63], s51 offen  lds
    s_mov_b32 s64, s28
    s_mov_b32 s65, s29
    s_mov_b32 s66, 8192
    s_mov_b32 s67, 131072
    s_mov_b32 s68, s24
    s_mov_b32 s69, s25
    s_mov_b32 s70, 4194304
    s_mov_b32 s71, 131072
    s_mov_b32 s72, s26
    s_mov_b32 s73, s27
    s_mov_b32 s74, 4194304
    s_mov_b32 s75, 131072
    s_lshl_b32 s3, s42, 10
    s_add_u32 s4, s3, 156672
    s_mov_b32 s24, s38
    s_mov_b32 s25, s39
    s_mov_b32 s26, 256
    s_mov_b32 s27, 131072
    s_or_b32 s3, s2, s42
    s_cmp_lg_u32 s3, 0
    s_cbranch_scc1 Lnonce_gate_1
    v_mov_b32 v4, s22
    v_mov_b32 v5, s23
    v_mov_b32 v2, 0
    buffer_store_dwordx2 v[4:5], v2, s[24:27], 0 offen sc0 sc1
    s_nop 1
Lnonce_gate_1:
    s_mov_b32 s5, 0xffff0000
    v_mov_b32 v6, 0
    s_and_b32 s3, s42, 1
    s_lshl_b32 s3, s3, 5
    v_and_b32 v7, 31, v1
    v_add_u32 v7, s3, v7
    s_lshl_b32 s3, s44, 6
    v_add_u32 v61, s3, v7
    v_lshlrev_b32 v61, 1, v61
    s_mov_b32 s76, s6
    s_mov_b32 s77, s7
    s_mov_b32 s78, 2048
    s_mov_b32 s79, 131072
    buffer_load_ushort v62, v61, s[76:79], 0 offen
    s_mov_b32 s76, s8
    s_mov_b32 s77, s9
    s_mov_b32 s78, 2048
    s_mov_b32 s79, 131072
    buffer_load_ushort v63, v61, s[76:79], 0 offen
    s_mov_b32 s8, s18
    s_mov_b32 s9, s19
    s_mov_b32 s10, 2048
    s_mov_b32 s11, 131072
    buffer_load_ushort v64, v61, s[8:11], 0 offen
    v_and_b32 v81, 31, v1
    v_bfe_u32 v82, v81, 1, 3
    v_lshrrev_b32 v83, 5, v1
    v_xor_b32 v82, v82, v83
    v_lshlrev_b32 v82, 4, v82
    v_lshl_add_u32 v82, v81, 7, v82
    s_lshr_b32 s6, s42, 1
    s_lshl_b32 s6, s6, 13
    s_and_b32 s7, s42, 1
    s_lshl_b32 s7, s7, 13
    s_add_u32 s7, s7, 16384
    v_xor_b32 v83, 0, v82
    v_add_u32 v65, s6, v83
    v_add_u32 v73, s7, v83
    v_add_u32 v69, 0x10000, v65
    v_add_u32 v77, 0x10000, v73
    v_xor_b32 v83, 32, v82
    v_add_u32 v66, s6, v83
    v_add_u32 v74, s7, v83
    v_add_u32 v70, 0x10000, v66
    v_add_u32 v78, 0x10000, v74
    v_xor_b32 v83, 64, v82
    v_add_u32 v67, s6, v83
    v_add_u32 v75, s7, v83
    v_add_u32 v71, 0x10000, v67
    v_add_u32 v79, 0x10000, v75
    v_xor_b32 v83, 96, v82
    v_add_u32 v68, s6, v83
    v_add_u32 v76, s7, v83
    v_add_u32 v72, 0x10000, v68
    v_add_u32 v80, 0x10000, v76
    s_mov_b32 s8, s40
    s_mov_b32 s9, s41
    s_mov_b32 s10, 33554432
    s_mov_b32 s11, 131072
    v_and_b32 v81, 7, v1
    s_lshl_b32 s3, s42, 10
    s_add_u32 s3, s3, 156672
    v_lshl_add_u32 v83, v81, 6, s3
    v_bfe_u32 v81, v1, 2, 1
    v_lshlrev_b32 v81, 3, v81
    v_lshrrev_b32 v82, 5, v1
    v_add_u32 v81, v81, v82
    v_lshlrev_b32 v180, 14, v81
    v_bfe_u32 v81, v1, 3, 2
    v_sub_u32 v81, 3, v81
    v_lshl_add_u32 v180, v81, 6, v180
    v_and_b32 v81, 3, v1
    v_lshl_add_u32 v180, v81, 4, v180
    s_lshl_b32 s6, s44, 18
    s_add_u32 s6, s6, 8404736
    s_lshl_b32 s3, s43, 10
    s_sub_u32 s6, s6, s3
    s_lshl_b32 s3, s42, 8
    s_sub_u32 s6, s6, s3
    s_lshl_b32 s7, s44, 4
    s_add_u32 s7, s7, s43
    s_lshl_b32 s7, s7, 2
    s_add_u32 s7, s7, s42
    s_lshl_b32 s7, s7, 3
    s_add_u32 s7, s7, 21495808
    s_lshl_b32 s12, s44, 2
    s_add_u32 s12, s12, s42
    s_lshl_b32 s12, s12, 4
    s_add_u32 s12, s12, s43
    s_lshl_b32 s12, s12, 3
    s_add_u32 s12, s12, 21504000
    s_lshl_b32 s3, s44, 9
    s_add_u32 s3, s3, 21495808
    v_lshrrev_b32 v81, 1, v60
    v_add_u32 v81, s3, v81
    s_lshl_b32 s13, s44, 6
    s_lshr_b32 s3, s43, 3
    s_lshl_b32 s3, s3, 5
    s_add_u32 s13, s13, s3
    s_lshl_b32 s3, s42, 3
    s_add_u32 s13, s13, s3
    s_and_b32 s3, s43, 7
    s_add_u32 s13, s13, s3
    s_lshl_b32 s18, s13, 12
    s_add_u32 s76, s30, s18
    s_addc_u32 s77, s31, 0
    s_mov_b32 s78, 4096
    s_mov_b32 s79, 131072
    s_mov_b32 s80, s32
    s_mov_b32 s81, s33
    s_mov_b32 s82, 2048
    s_mov_b32 s83, 131072
    s_lshl_b32 s3, s13, 1
    v_mov_b32 v82, s3
    buffer_load_ushort v82, v82, s[80:83], 0 offen
    s_mul_i32 s19, s42, 16640
    v_lshrrev_b32 v207, 4, v1
    v_and_b32 v224, 3, v1
    v_xor_b32 v224, v224, v207
    v_lshlrev_b32 v224, 4, v224
    v_lshrrev_b32 v207, 2, v1
    v_lshl_add_u32 v181, v207, 6, v224
    s_lshl_b32 s28, s44, 4
    s_add_u32 s28, s28, s43
    s_lshl_b32 s28, s28, 14
    s_lshl_b32 s29, s42, 12
    s_add_u32 s28, s28, s29
    s_add_u32 s28, s28, 8388608
    s_add_u32 s29, s29, 131072
    s_mov_b32 s80, s34
    s_mov_b32 s81, s35
    s_mov_b32 s82, 2048
    s_mov_b32 s83, 131072
    s_lshl_b32 s30, s43, 7
    s_lshl_b32 s3, s44, 3
    s_add_u32 s30, s30, s3
    s_lshl_b32 s3, s42, 1
    s_add_u32 s30, s30, s3
    s_lshl_b32 s3, s30, 2
    s_add_u32 s3, s3, 20971520
    v_mov_b32 v207, s3
    s_lshl_b32 s30, s30, 11
    s_mov_b32 s31, 8192
    s_waitcnt vmcnt(12)
    s_barrier
    ds_read_b128 v[84:87], v65 offset:0
    ds_read_b128 v[92:95], v73 offset:0
    ds_read_b128 v[96:99], v73 offset:4096
    ds_read_b128 v[88:91], v65 offset:4096
    s_add_u32 s49, s49, 128
    s_and_b32 s49, s49, 0x7ff
    s_add_u32 s50, s45, s49
    s_add_u32 m0, s47, 65536
    s_waitcnt lgkmcnt(2)
    v_mfma_f32_32x32x16_bf16 v[116:131], v[84:87], v[92:95], 0
    ds_read_b128 v[100:103], v66 offset:0
    ds_read_b128 v[108:111], v74 offset:0
    buffer_load_dwordx4 v8, s[56:59], s50 offen  lds
    s_add_u32 m0, s47, 66560
    s_waitcnt lgkmcnt(3)
    v_mfma_f32_32x32x16_bf16 v[132:147], v[84:87], v[96:99], 0
    ds_read_b128 v[112:115], v74 offset:4096
    ds_read_b128 v[104:107], v66 offset:4096
    buffer_load_dwordx4 v9, s[56:59], s50 offen  lds
    s_add_u32 m0, s47, 67584
    s_waitcnt lgkmcnt(4)
    v_mfma_f32_32x32x16_bf16 v[148:163], v[88:91], v[92:95], 0
    buffer_load_dwordx4 v10, s[56:59], s50 offen  lds
    s_add_u32 m0, s47, 68608
    v_mfma_f32_32x32x16_bf16 v[164:179], v[88:91], v[96:99], 0
    buffer_load_dwordx4 v11, s[56:59], s50 offen  lds
    s_add_u32 s51, s46, s49
    s_add_u32 m0, s47, 81920
    s_waitcnt lgkmcnt(2)
    v_mfma_f32_32x32x16_bf16 v[116:131], v[100:103], v[108:111], v[116:131]
    ds_read_b128 v[84:87], v67 offset:0
    ds_read_b128 v[92:95], v75 offset:0
    buffer_load_dwordx4 v12, s[60:63], s51 offen  lds
    s_add_u32 m0, s47, 82944
    s_waitcnt lgkmcnt(3)
    v_mfma_f32_32x32x16_bf16 v[132:147], v[100:103], v[112:115], v[132:147]
    ds_read_b128 v[96:99], v75 offset:4096
    ds_read_b128 v[88:91], v67 offset:4096
    buffer_load_dwordx4 v13, s[60:63], s51 offen  lds
    s_add_u32 m0, s47, 83968
    s_waitcnt lgkmcnt(4)
    v_mfma_f32_32x32x16_bf16 v[148:163], v[104:107], v[108:111], v[148:163]
    buffer_load_dwordx4 v14, s[60:63], s51 offen  lds
    s_add_u32 m0, s47, 84992
    v_mfma_f32_32x32x16_bf16 v[164:179], v[104:107], v[112:115], v[164:179]
    buffer_load_dwordx4 v15, s[60:63], s51 offen  lds
    s_add_u32 s49, s49, 128
    s_and_b32 s49, s49, 0x7ff
    s_add_u32 s50, s45, s49
    s_add_u32 m0, s47, 98304
    s_waitcnt lgkmcnt(2)
    v_mfma_f32_32x32x16_bf16 v[116:131], v[84:87], v[92:95], v[116:131]
    ds_read_b128 v[100:103], v68 offset:0
    ds_read_b128 v[108:111], v76 offset:0
    buffer_load_dwordx4 v8, s[56:59], s50 offen  lds
    s_add_u32 m0, s47, 99328
    s_waitcnt lgkmcnt(3)
    v_mfma_f32_32x32x16_bf16 v[132:147], v[84:87], v[96:99], v[132:147]
    ds_read_b128 v[112:115], v76 offset:4096
    ds_read_b128 v[104:107], v68 offset:4096
    buffer_load_dwordx4 v9, s[56:59], s50 offen  lds
    s_add_u32 m0, s47, 100352
    s_waitcnt lgkmcnt(4)
    v_mfma_f32_32x32x16_bf16 v[148:163], v[88:91], v[92:95], v[148:163]
    buffer_load_dwordx4 v10, s[56:59], s50 offen  lds
    s_add_u32 m0, s47, 101376
    v_mfma_f32_32x32x16_bf16 v[164:179], v[88:91], v[96:99], v[164:179]
    buffer_load_dwordx4 v11, s[56:59], s50 offen  lds
    s_waitcnt lgkmcnt(0)
    s_waitcnt vmcnt(16)
    s_barrier
    s_add_u32 s51, s46, s49
    s_add_u32 m0, s47, 114688
    v_mfma_f32_32x32x16_bf16 v[116:131], v[100:103], v[108:111], v[116:131]
    ds_read_b128 v[84:87], v65 offset:32768
    ds_read_b128 v[92:95], v73 offset:32768
    buffer_load_dwordx4 v12, s[60:63], s51 offen  lds
    s_add_u32 m0, s47, 115712
    v_mfma_f32_32x32x16_bf16 v[132:147], v[100:103], v[112:115], v[132:147]
    ds_read_b128 v[96:99], v73 offset:36864
    ds_read_b128 v[88:91], v65 offset:36864
    buffer_load_dwordx4 v13, s[60:63], s51 offen  lds
    s_add_u32 m0, s47, 116736
    v_mfma_f32_32x32x16_bf16 v[148:163], v[104:107], v[108:111], v[148:163]
    buffer_load_dwordx4 v14, s[60:63], s51 offen  lds
    s_add_u32 m0, s47, 117760
    v_mfma_f32_32x32x16_bf16 v[164:179], v[104:107], v[112:115], v[164:179]
    buffer_load_dwordx4 v15, s[60:63], s51 offen  lds
    s_mov_b32 m0, s4
    s_waitcnt lgkmcnt(2)
    v_mfma_f32_32x32x16_bf16 v[116:131], v[84:87], v[92:95], v[116:131]
    ds_read_b128 v[100:103], v66 offset:32768
    ds_read_b128 v[108:111], v74 offset:32768
    buffer_load_dwordx4 v60, s[64:67], s52 offen lds
    s_waitcnt lgkmcnt(3)
    v_mfma_f32_32x32x16_bf16 v[132:147], v[84:87], v[96:99], v[132:147]
    ds_read_b128 v[112:115], v74 offset:36864
    ds_read_b128 v[104:107], v66 offset:36864
    buffer_load_dwordx4 v[16:19], v16, s[68:71], 0 offen
    s_waitcnt lgkmcnt(4)
    v_mfma_f32_32x32x16_bf16 v[148:163], v[88:91], v[92:95], v[148:163]
    buffer_load_dwordx4 v[20:23], v20, s[68:71], 0 offen
    v_mfma_f32_32x32x16_bf16 v[164:179], v[88:91], v[96:99], v[164:179]
    buffer_load_dwordx4 v[24:27], v24, s[68:71], 0 offen
    s_waitcnt lgkmcnt(2)
    v_mfma_f32_32x32x16_bf16 v[116:131], v[100:103], v[108:111], v[116:131]
    ds_read_b128 v[84:87], v67 offset:32768
    ds_read_b128 v[92:95], v75 offset:32768
    buffer_load_dwordx4 v[28:31], v3, s[68:71], 0 offen offset:0
    s_waitcnt lgkmcnt(3)
    v_mfma_f32_32x32x16_bf16 v[132:147], v[100:103], v[112:115], v[132:147]
    ds_read_b128 v[96:99], v75 offset:36864
    ds_read_b128 v[88:91], v67 offset:36864
    buffer_load_dwordx4 v[32:35], v3, s[68:71], 0 offen offset:2048
    s_waitcnt lgkmcnt(4)
    v_mfma_f32_32x32x16_bf16 v[148:163], v[104:107], v[108:111], v[148:163]
    buffer_load_dwordx4 v[36:39], v3, s[68:71], s48 offen offset:0
    v_mfma_f32_32x32x16_bf16 v[164:179], v[104:107], v[112:115], v[164:179]
    buffer_load_dwordx4 v[40:43], v3, s[68:71], s48 offen offset:2048
    s_waitcnt lgkmcnt(2)
    v_mfma_f32_32x32x16_bf16 v[116:131], v[84:87], v[92:95], v[116:131]
    ds_read_b128 v[100:103], v68 offset:32768
    ds_read_b128 v[108:111], v76 offset:32768
    buffer_load_dwordx4 v[44:47], v3, s[72:75], 0 offen offset:0
    s_waitcnt lgkmcnt(3)
    v_mfma_f32_32x32x16_bf16 v[132:147], v[84:87], v[96:99], v[132:147]
    ds_read_b128 v[112:115], v76 offset:36864
    ds_read_b128 v[104:107], v68 offset:36864
    buffer_load_dwordx4 v[48:51], v3, s[72:75], 0 offen offset:2048
    s_waitcnt lgkmcnt(4)
    v_mfma_f32_32x32x16_bf16 v[148:163], v[88:91], v[92:95], v[148:163]
    buffer_load_dwordx4 v[52:55], v3, s[72:75], s48 offen offset:0
    v_mfma_f32_32x32x16_bf16 v[164:179], v[88:91], v[96:99], v[164:179]
    buffer_load_dwordx4 v[56:59], v3, s[72:75], s48 offen offset:2048
    s_waitcnt lgkmcnt(0)
    s_waitcnt vmcnt(20)
    s_barrier
    s_add_u32 s49, s49, 128
    s_and_b32 s49, s49, 0x7ff
    s_add_u32 s50, s45, s49
    s_add_u32 m0, s47, 0
    v_mfma_f32_32x32x16_bf16 v[116:131], v[100:103], v[108:111], v[116:131]
    ds_read_b128 v[84:87], v69 offset:0
    ds_read_b128 v[92:95], v77 offset:0
    buffer_load_dwordx4 v8, s[56:59], s50 offen  lds
    s_add_u32 m0, s47, 1024
    v_mfma_f32_32x32x16_bf16 v[132:147], v[100:103], v[112:115], v[132:147]
    ds_read_b128 v[96:99], v77 offset:4096
    ds_read_b128 v[88:91], v69 offset:4096
    buffer_load_dwordx4 v9, s[56:59], s50 offen  lds
    s_add_u32 m0, s47, 2048
    v_mfma_f32_32x32x16_bf16 v[148:163], v[104:107], v[108:111], v[148:163]
    buffer_load_dwordx4 v10, s[56:59], s50 offen  lds
    s_add_u32 m0, s47, 3072
    v_mfma_f32_32x32x16_bf16 v[164:179], v[104:107], v[112:115], v[164:179]
    buffer_load_dwordx4 v11, s[56:59], s50 offen  lds
    s_add_u32 s51, s46, s49
    s_add_u32 m0, s47, 16384
    s_waitcnt lgkmcnt(2)
    v_mfma_f32_32x32x16_bf16 v[116:131], v[84:87], v[92:95], v[116:131]
    ds_read_b128 v[100:103], v70 offset:0
    ds_read_b128 v[108:111], v78 offset:0
    buffer_load_dwordx4 v12, s[60:63], s51 offen  lds
    s_waitcnt vmcnt(16)
    ds_read_b128 v[184:187], v83 offset:0
    ds_read_b128 v[188:191], v83 offset:16
    s_add_u32 m0, s47, 17408
    s_waitcnt lgkmcnt(5)
    v_mfma_f32_32x32x16_bf16 v[132:147], v[84:87], v[96:99], v[132:147]
    ds_read_b128 v[112:115], v78 offset:4096
    ds_read_b128 v[104:107], v70 offset:4096
    buffer_load_dwordx4 v13, s[60:63], s51 offen  lds
    s_waitcnt vmcnt(16)
    v_lshlrev_b32 v196, 16, v16
    s_waitcnt vmcnt(15)
    v_lshlrev_b32 v197, 16, v20
    s_waitcnt vmcnt(14)
    v_lshlrev_b32 v198, 16, v24
    s_add_u32 m0, s47, 18432
    s_waitcnt lgkmcnt(6)
    v_mfma_f32_32x32x16_bf16 v[148:163], v[88:91], v[92:95], v[148:163]
    buffer_load_dwordx4 v14, s[60:63], s51 offen  lds
    s_waitcnt vmcnt(14)
    v_lshlrev_b32 v199, 16, v28
    s_waitcnt vmcnt(13)
    v_lshlrev_b32 v200, 16, v32
    s_waitcnt vmcnt(12)
    v_lshlrev_b32 v201, 16, v36
    s_waitcnt vmcnt(11)
    v_lshlrev_b32 v202, 16, v40
    s_waitcnt lgkmcnt(3)
    v_and_b32 v195, s5, v185
    s_add_u32 m0, s47, 19456
    v_mfma_f32_32x32x16_bf16 v[164:179], v[88:91], v[96:99], v[164:179]
    buffer_load_dwordx4 v15, s[60:63], s51 offen  lds
    v_lshlrev_b32 v194, 16, v185
    v_and_b32 v193, s5, v184
    v_lshlrev_b32 v192, 16, v184
    v_mul_f32 v203, v195, v196
    v_mul_f32 v204, v195, v197
    v_mul_f32 v205, v195, v198
    s_add_u32 s49, s49, 128
    s_and_b32 s49, s49, 0x7ff
    s_add_u32 s50, s45, s49
    s_add_u32 m0, s47, 32768
    v_mfma_f32_32x32x16_bf16 v[116:131], v[100:103], v[108:111], v[116:131]
    ds_read_b128 v[84:87], v71 offset:0
    ds_read_b128 v[92:95], v79 offset:0
    buffer_load_dwordx4 v8, s[56:59], s50 offen  lds
    v_mul_f32 v206, v195, v199
    v_fmac_f32 v203, v194, v197
    v_fmac_f32 v204, v194, v198
    s_add_u32 m0, s47, 33792
    s_waitcnt lgkmcnt(3)
    v_mfma_f32_32x32x16_bf16 v[132:147], v[100:103], v[112:115], v[132:147]
    ds_read_b128 v[96:99], v79 offset:4096
    ds_read_b128 v[88:91], v71 offset:4096
    buffer_load_dwordx4 v9, s[56:59], s50 offen  lds
    v_fmac_f32 v205, v194, v199
    v_fmac_f32 v206, v194, v200
    v_fmac_f32 v203, v193, v198
    s_add_u32 m0, s47, 34816
    s_waitcnt lgkmcnt(4)
    v_mfma_f32_32x32x16_bf16 v[148:163], v[104:107], v[108:111], v[148:163]
    buffer_load_dwordx4 v10, s[56:59], s50 offen  lds
    v_fmac_f32 v204, v193, v199
    v_fmac_f32 v205, v193, v200
    v_fmac_f32 v206, v193, v201
    v_fmac_f32 v203, v192, v199
    v_fmac_f32 v204, v192, v200
    s_add_u32 m0, s47, 35840
    v_mfma_f32_32x32x16_bf16 v[164:179], v[104:107], v[112:115], v[164:179]
    buffer_load_dwordx4 v11, s[56:59], s50 offen  lds
    v_fmac_f32 v205, v192, v201
    v_fmac_f32 v206, v192, v202
    s_waitcnt vmcnt(15)
    v_lshlrev_b32 v196, 16, v44
    s_waitcnt vmcnt(14)
    v_lshlrev_b32 v197, 16, v48
    s_waitcnt vmcnt(13)
    v_lshlrev_b32 v198, 16, v52
    s_waitcnt vmcnt(12)
    v_lshlrev_b32 v199, 16, v56
    s_add_u32 s51, s46, s49
    s_add_u32 m0, s47, 49152
    s_waitcnt lgkmcnt(2)
    v_mfma_f32_32x32x16_bf16 v[116:131], v[84:87], v[92:95], v[116:131]
    ds_read_b128 v[100:103], v72 offset:0
    ds_read_b128 v[108:111], v80 offset:0
    buffer_load_dwordx4 v12, s[60:63], s51 offen  lds
    v_mul_f32 v203, v203, v196
    v_mul_f32 v204, v204, v197
    v_mul_f32 v205, v205, v198
    s_add_u32 m0, s47, 50176
    s_waitcnt lgkmcnt(3)
    v_mfma_f32_32x32x16_bf16 v[132:147], v[84:87], v[96:99], v[132:147]
    ds_read_b128 v[112:115], v80 offset:4096
    ds_read_b128 v[104:107], v72 offset:4096
    buffer_load_dwordx4 v13, s[60:63], s51 offen  lds
    v_mul_f32 v206, v206, v199
    v_cvt_pk_bf16_f32 v210, v206, v205
    v_cvt_pk_bf16_f32 v211, v204, v203
    s_add_u32 m0, s47, 51200
    s_waitcnt lgkmcnt(4)
    v_mfma_f32_32x32x16_bf16 v[148:163], v[88:91], v[92:95], v[148:163]
    buffer_load_dwordx4 v14, s[60:63], s51 offen  lds
    v_and_b32 v196, s5, v16
    v_and_b32 v197, s5, v20
    v_and_b32 v198, s5, v24
    v_and_b32 v199, s5, v28
    v_and_b32 v200, s5, v32
    s_add_u32 m0, s47, 52224
    v_mfma_f32_32x32x16_bf16 v[164:179], v[88:91], v[96:99], v[164:179]
    buffer_load_dwordx4 v15, s[60:63], s51 offen  lds
    v_and_b32 v201, s5, v36
    v_and_b32 v202, s5, v40
    v_and_b32 v195, s5, v187
    v_lshlrev_b32 v194, 16, v187
    v_and_b32 v193, s5, v186
    v_lshlrev_b32 v192, 16, v186
    s_waitcnt lgkmcnt(0)
    s_barrier
    s_add_u32 s49, s49, 128
    s_and_b32 s49, s49, 0x7ff
    s_add_u32 s50, s45, s49
    s_add_u32 m0, s47, 65536
    v_mfma_f32_32x32x16_bf16 v[116:131], v[100:103], v[108:111], v[116:131]
    ds_read_b128 v[84:87], v69 offset:32768
    ds_read_b128 v[92:95], v77 offset:32768
    buffer_load_dwordx4 v8, s[56:59], s50 offen  lds
    v_mul_f32 v203, v195, v196
    v_mul_f32 v204, v195, v197
    v_mul_f32 v205, v195, v198
    s_add_u32 m0, s47, 66560
    v_mfma_f32_32x32x16_bf16 v[132:147], v[100:103], v[112:115], v[132:147]
    ds_read_b128 v[96:99], v77 offset:36864
    ds_read_b128 v[88:91], v69 offset:36864
    buffer_load_dwordx4 v9, s[56:59], s50 offen  lds
    v_mul_f32 v206, v195, v199
    v_fmac_f32 v203, v194, v197
    v_fmac_f32 v204, v194, v198
    s_add_u32 m0, s47, 67584
    v_mfma_f32_32x32x16_bf16 v[148:163], v[104:107], v[108:111], v[148:163]
    buffer_load_dwordx4 v10, s[56:59], s50 offen  lds
    v_fmac_f32 v205, v194, v199
    v_fmac_f32 v206, v194, v200
    v_fmac_f32 v203, v193, v198
    v_fmac_f32 v204, v193, v199
    v_fmac_f32 v205, v193, v200
    s_add_u32 m0, s47, 68608
    v_mfma_f32_32x32x16_bf16 v[164:179], v[104:107], v[112:115], v[164:179]
    buffer_load_dwordx4 v11, s[56:59], s50 offen  lds
    v_fmac_f32 v206, v193, v201
    v_fmac_f32 v203, v192, v199
    v_fmac_f32 v204, v192, v200
    v_fmac_f32 v205, v192, v201
    v_fmac_f32 v206, v192, v202
    v_and_b32 v196, s5, v44
    s_waitcnt lgkmcnt(2)
    v_mfma_f32_32x32x16_bf16 v[116:131], v[84:87], v[92:95], v[116:131]
    ds_read_b128 v[100:103], v70 offset:32768
    ds_read_b128 v[108:111], v78 offset:32768
    v_and_b32 v197, s5, v48
    v_and_b32 v198, s5, v52
    v_and_b32 v199, s5, v56
    v_mul_f32 v203, v203, v196
    v_mul_f32 v204, v204, v197
    s_waitcnt lgkmcnt(3)
    v_mfma_f32_32x32x16_bf16 v[132:147], v[84:87], v[96:99], v[132:147]
    ds_read_b128 v[112:115], v78 offset:36864
    ds_read_b128 v[104:107], v70 offset:36864
    v_mul_f32 v205, v205, v198
    v_mul_f32 v206, v206, v199
    v_cvt_pk_bf16_f32 v208, v206, v205
    s_add_u32 s51, s46, s49
    s_add_u32 m0, s47, 81920
    s_waitcnt lgkmcnt(4)
    v_mfma_f32_32x32x16_bf16 v[148:163], v[88:91], v[92:95], v[148:163]
    buffer_load_dwordx4 v12, s[60:63], s51 offen  lds
    v_cvt_pk_bf16_f32 v209, v204, v203
    ds_read_b128 v[184:187], v83 offset:32
    v_lshlrev_b32 v196, 16, v17
    v_lshlrev_b32 v197, 16, v21
    v_permlane32_swap_b32 v210, v208
    s_add_u32 m0, s47, 82944
    v_mfma_f32_32x32x16_bf16 v[164:179], v[88:91], v[96:99], v[164:179]
    buffer_load_dwordx4 v13, s[60:63], s51 offen  lds
    v_permlane32_swap_b32 v211, v209
    v_lshlrev_b32 v198, 16, v25
    v_lshlrev_b32 v199, 16, v29
    v_lshlrev_b32 v200, 16, v33
    v_lshlrev_b32 v201, 16, v37
    v_lshlrev_b32 v202, 16, v41
    s_waitcnt lgkmcnt(3)
    v_mfma_f32_32x32x16_bf16 v[116:131], v[100:103], v[108:111], v[116:131]
    ds_read_b128 v[84:87], v71 offset:32768
    ds_read_b128 v[92:95], v79 offset:32768
    v_and_b32 v195, s5, v189
    v_lshlrev_b32 v194, 16, v189
    v_and_b32 v193, s5, v188
    v_lshlrev_b32 v192, 16, v188
    v_mul_f32 v203, v195, v196
    s_waitcnt lgkmcnt(4)
    v_mfma_f32_32x32x16_bf16 v[132:147], v[100:103], v[112:115], v[132:147]
    ds_read_b128 v[96:99], v79 offset:36864
    ds_read_b128 v[88:91], v71 offset:36864
    v_mul_f32 v204, v195, v197
    v_mul_f32 v205, v195, v198
    v_mul_f32 v206, v195, v199
    v_fmac_f32 v203, v194, v197
    s_add_u32 m0, s47, 83968
    s_waitcnt lgkmcnt(5)
    v_mfma_f32_32x32x16_bf16 v[148:163], v[104:107], v[108:111], v[148:163]
    buffer_load_dwordx4 v14, s[60:63], s51 offen  lds
    v_fmac_f32 v204, v194, v198
    v_fmac_f32 v205, v194, v199
    v_fmac_f32 v206, v194, v200
    v_fmac_f32 v203, v193, v198
    v_fmac_f32 v204, v193, v199
    s_add_u32 m0, s47, 84992
    v_mfma_f32_32x32x16_bf16 v[164:179], v[104:107], v[112:115], v[164:179]
    buffer_load_dwordx4 v15, s[60:63], s51 offen  lds
    v_fmac_f32 v205, v193, v200
    v_fmac_f32 v206, v193, v201
    v_fmac_f32 v203, v192, v199
    v_fmac_f32 v204, v192, v200
    v_fmac_f32 v205, v192, v201
    v_fmac_f32 v206, v192, v202
    s_waitcnt lgkmcnt(2)
    v_mfma_f32_32x32x16_bf16 v[116:131], v[84:87], v[92:95], v[116:131]
    ds_read_b128 v[100:103], v72 offset:32768
    ds_read_b128 v[108:111], v80 offset:32768
    v_lshlrev_b32 v196, 16, v45
    v_lshlrev_b32 v197, 16, v49
    v_lshlrev_b32 v198, 16, v53
    v_lshlrev_b32 v199, 16, v57
    v_mul_f32 v203, v203, v196
    s_waitcnt lgkmcnt(3)
    v_mfma_f32_32x32x16_bf16 v[132:147], v[84:87], v[96:99], v[132:147]
    ds_read_b128 v[112:115], v80 offset:36864
    ds_read_b128 v[104:107], v72 offset:36864
    v_mul_f32 v204, v204, v197
    v_mul_f32 v205, v205, v198
    v_mul_f32 v206, v206, v199
    v_cvt_pk_bf16_f32 v214, v206, v205
    v_cvt_pk_bf16_f32 v215, v204, v203
    s_waitcnt lgkmcnt(4)
    v_mfma_f32_32x32x16_bf16 v[148:163], v[88:91], v[92:95], v[148:163]
    v_and_b32 v196, s5, v17
    v_and_b32 v197, s5, v21
    v_and_b32 v198, s5, v25
    v_and_b32 v199, s5, v29
    v_and_b32 v200, s5, v33
    v_and_b32 v201, s5, v37
    v_and_b32 v202, s5, v41
    v_mfma_f32_32x32x16_bf16 v[164:179], v[88:91], v[96:99], v[164:179]
    v_and_b32 v195, s5, v191
    v_lshlrev_b32 v194, 16, v191
    v_and_b32 v193, s5, v190
    v_lshlrev_b32 v192, 16, v190
    v_mul_f32 v203, v195, v196
    v_mul_f32 v204, v195, v197
    v_mul_f32 v205, v195, v198
    s_waitcnt lgkmcnt(0)
    s_waitcnt vmcnt(16)
    s_barrier
    v_mfma_f32_32x32x16_bf16 v[116:131], v[100:103], v[108:111], v[116:131]
    ds_read_b128 v[84:87], v65 offset:0
    ds_read_b128 v[92:95], v73 offset:0
    v_mul_f32 v206, v195, v199
    v_fmac_f32 v203, v194, v197
    v_fmac_f32 v204, v194, v198
    v_fmac_f32 v205, v194, v199
    v_fmac_f32 v206, v194, v200
    v_mfma_f32_32x32x16_bf16 v[132:147], v[100:103], v[112:115], v[132:147]
    ds_read_b128 v[96:99], v73 offset:4096
    ds_read_b128 v[88:91], v65 offset:4096
    v_fmac_f32 v203, v193, v198
    s_add_u32 s49, s49, 128
    s_and_b32 s49, s49, 0x7ff
    s_add_u32 s50, s45, s49
    s_add_u32 m0, s47, 98304
    v_mfma_f32_32x32x16_bf16 v[148:163], v[104:107], v[108:111], v[148:163]
    buffer_load_dwordx4 v8, s[56:59], s50 offen  lds
    v_fmac_f32 v204, v193, v199
    v_fmac_f32 v205, v193, v200
    v_fmac_f32 v206, v193, v201
    v_fmac_f32 v203, v192, v199
    v_fmac_f32 v204, v192, v200
    s_add_u32 m0, s47, 99328
    v_mfma_f32_32x32x16_bf16 v[164:179], v[104:107], v[112:115], v[164:179]
    buffer_load_dwordx4 v9, s[56:59], s50 offen  lds
    v_fmac_f32 v205, v192, v201
    v_fmac_f32 v206, v192, v202
    v_and_b32 v196, s5, v45
    v_and_b32 v197, s5, v49
    v_and_b32 v198, s5, v53
    v_and_b32 v199, s5, v57
    s_waitcnt lgkmcnt(2)
    v_mfma_f32_32x32x16_bf16 v[116:131], v[84:87], v[92:95], v[116:131]
    ds_read_b128 v[100:103], v66 offset:0
    ds_read_b128 v[108:111], v74 offset:0
    v_mul_f32 v203, v203, v196
    v_mul_f32 v204, v204, v197
    v_mul_f32 v205, v205, v198
    v_mul_f32 v206, v206, v199
    v_cvt_pk_bf16_f32 v212, v206, v205
    s_waitcnt lgkmcnt(3)
    v_mfma_f32_32x32x16_bf16 v[132:147], v[84:87], v[96:99], v[132:147]
    ds_read_b128 v[112:115], v74 offset:4096
    ds_read_b128 v[104:107], v66 offset:4096
    v_cvt_pk_bf16_f32 v213, v204, v203
    ds_read_b128 v[188:191], v83 offset:48
    v_lshlrev_b32 v196, 16, v18
    v_lshlrev_b32 v197, 16, v22
    s_add_u32 m0, s47, 100352
    s_waitcnt lgkmcnt(5)
    v_mfma_f32_32x32x16_bf16 v[148:163], v[88:91], v[92:95], v[148:163]
    buffer_load_dwordx4 v10, s[56:59], s50 offen  lds
    v_permlane32_swap_b32 v214, v212
    v_permlane32_swap_b32 v215, v213
    v_lshlrev_b32 v198, 16, v26
    v_lshlrev_b32 v199, 16, v30
    v_lshlrev_b32 v200, 16, v34
    s_add_u32 m0, s47, 101376
    v_mfma_f32_32x32x16_bf16 v[164:179], v[88:91], v[96:99], v[164:179]
    buffer_load_dwordx4 v11, s[56:59], s50 offen  lds
    v_lshlrev_b32 v201, 16, v38
    v_lshlrev_b32 v202, 16, v42
    v_and_b32 v195, s5, v185
    v_lshlrev_b32 v194, 16, v185
    v_and_b32 v193, s5, v184
    v_lshlrev_b32 v192, 16, v184
    s_waitcnt lgkmcnt(3)
    v_mfma_f32_32x32x16_bf16 v[116:131], v[100:103], v[108:111], v[116:131]
    ds_read_b128 v[84:87], v67 offset:0
    ds_read_b128 v[92:95], v75 offset:0
    v_mul_f32 v203, v195, v196
    v_mul_f32 v204, v195, v197
    v_mul_f32 v205, v195, v198
    v_mul_f32 v206, v195, v199
    v_fmac_f32 v203, v194, v197
    s_waitcnt lgkmcnt(4)
    v_mfma_f32_32x32x16_bf16 v[132:147], v[100:103], v[112:115], v[132:147]
    ds_read_b128 v[96:99], v75 offset:4096
    ds_read_b128 v[88:91], v67 offset:4096
    v_fmac_f32 v204, v194, v198
    v_fmac_f32 v205, v194, v199
    v_fmac_f32 v206, v194, v200
    s_add_u32 s51, s46, s49
    s_add_u32 m0, s47, 114688
    s_waitcnt lgkmcnt(5)
    v_mfma_f32_32x32x16_bf16 v[148:163], v[104:107], v[108:111], v[148:163]
    buffer_load_dwordx4 v12, s[60:63], s51 offen  lds
    v_fmac_f32 v203, v193, v198
    v_fmac_f32 v204, v193, v199
    v_fmac_f32 v205, v193, v200
    v_fmac_f32 v206, v193, v201
    v_fmac_f32 v203, v192, v199
    s_add_u32 m0, s47, 115712
    v_mfma_f32_32x32x16_bf16 v[164:179], v[104:107], v[112:115], v[164:179]
    buffer_load_dwordx4 v13, s[60:63], s51 offen  lds
    v_fmac_f32 v204, v192, v200
    v_fmac_f32 v205, v192, v201
    v_fmac_f32 v206, v192, v202
    v_lshlrev_b32 v196, 16, v46
    v_lshlrev_b32 v197, 16, v50
    v_lshlrev_b32 v198, 16, v54
    s_waitcnt lgkmcnt(2)
    v_mfma_f32_32x32x16_bf16 v[116:131], v[84:87], v[92:95], v[116:131]
    ds_read_b128 v[100:103], v68 offset:0
    ds_read_b128 v[108:111], v76 offset:0
    v_lshlrev_b32 v199, 16, v58
    v_mul_f32 v203, v203, v196
    v_mul_f32 v204, v204, v197
    v_mul_f32 v205, v205, v198
    v_mul_f32 v206, v206, v199
    s_waitcnt lgkmcnt(3)
    v_mfma_f32_32x32x16_bf16 v[132:147], v[84:87], v[96:99], v[132:147]
    ds_read_b128 v[112:115], v76 offset:4096
    ds_read_b128 v[104:107], v68 offset:4096
    v_cvt_pk_bf16_f32 v218, v206, v205
    v_cvt_pk_bf16_f32 v219, v204, v203
    v_and_b32 v196, s5, v18
    v_and_b32 v197, s5, v22
    s_add_u32 m0, s47, 116736
    s_waitcnt lgkmcnt(4)
    v_mfma_f32_32x32x16_bf16 v[148:163], v[88:91], v[92:95], v[148:163]
    buffer_load_dwordx4 v14, s[60:63], s51 offen  lds
    v_and_b32 v198, s5, v26
    v_and_b32 v199, s5, v30
    v_and_b32 v200, s5, v34
    v_and_b32 v201, s5, v38
    v_and_b32 v202, s5, v42
    s_add_u32 m0, s47, 117760
    v_mfma_f32_32x32x16_bf16 v[164:179], v[88:91], v[96:99], v[164:179]
    buffer_load_dwordx4 v15, s[60:63], s51 offen  lds
    v_and_b32 v195, s5, v187
    v_lshlrev_b32 v194, 16, v187
    v_and_b32 v193, s5, v186
    v_lshlrev_b32 v192, 16, v186
    v_mul_f32 v203, v195, v196
    v_mul_f32 v204, v195, v197
    s_waitcnt lgkmcnt(0)
    s_waitcnt vmcnt(16)
    s_barrier
    v_mfma_f32_32x32x16_bf16 v[116:131], v[100:103], v[108:111], v[116:131]
    ds_read_b128 v[84:87], v65 offset:32768
    ds_read_b128 v[92:95], v73 offset:32768
    v_mul_f32 v205, v195, v198
    v_mul_f32 v206, v195, v199
    v_fmac_f32 v203, v194, v197
    v_fmac_f32 v204, v194, v198
    v_fmac_f32 v205, v194, v199
    v_mfma_f32_32x32x16_bf16 v[132:147], v[100:103], v[112:115], v[132:147]
    ds_read_b128 v[96:99], v73 offset:36864
    ds_read_b128 v[88:91], v65 offset:36864
    v_fmac_f32 v206, v194, v200
    s_add_u32 s49, s49, 128
    s_and_b32 s49, s49, 0x7ff
    s_add_u32 s50, s45, s49
    s_add_u32 m0, s47, 0
    v_mfma_f32_32x32x16_bf16 v[148:163], v[104:107], v[108:111], v[148:163]
    buffer_load_dwordx4 v8, s[56:59], s50 offen  lds
    v_fmac_f32 v203, v193, v198
    v_fmac_f32 v204, v193, v199
    v_fmac_f32 v205, v193, v200
    v_fmac_f32 v206, v193, v201
    v_fmac_f32 v203, v192, v199
    s_add_u32 m0, s47, 1024
    v_mfma_f32_32x32x16_bf16 v[164:179], v[104:107], v[112:115], v[164:179]
    buffer_load_dwordx4 v9, s[56:59], s50 offen  lds
    v_fmac_f32 v204, v192, v200
    v_fmac_f32 v205, v192, v201
    v_fmac_f32 v206, v192, v202
    v_and_b32 v196, s5, v46
    v_and_b32 v197, s5, v50
    v_and_b32 v198, s5, v54
    s_waitcnt lgkmcnt(2)
    v_mfma_f32_32x32x16_bf16 v[116:131], v[84:87], v[92:95], v[116:131]
    ds_read_b128 v[100:103], v66 offset:32768
    ds_read_b128 v[108:111], v74 offset:32768
    v_and_b32 v199, s5, v58
    v_mul_f32 v203, v203, v196
    v_mul_f32 v204, v204, v197
    v_mul_f32 v205, v205, v198
    v_mul_f32 v206, v206, v199
    s_waitcnt lgkmcnt(3)
    v_mfma_f32_32x32x16_bf16 v[132:147], v[84:87], v[96:99], v[132:147]
    ds_read_b128 v[112:115], v74 offset:36864
    ds_read_b128 v[104:107], v66 offset:36864
    v_cvt_pk_bf16_f32 v216, v206, v205
    v_cvt_pk_bf16_f32 v217, v204, v203
    v_lshlrev_b32 v196, 16, v19
    v_lshlrev_b32 v197, 16, v23
    s_add_u32 m0, s47, 2048
    s_waitcnt lgkmcnt(4)
    v_mfma_f32_32x32x16_bf16 v[148:163], v[88:91], v[92:95], v[148:163]
    buffer_load_dwordx4 v10, s[56:59], s50 offen  lds
    v_permlane32_swap_b32 v218, v216
    v_permlane32_swap_b32 v219, v217
    v_lshlrev_b32 v198, 16, v27
    v_lshlrev_b32 v199, 16, v31
    v_lshlrev_b32 v200, 16, v35
    s_add_u32 m0, s47, 3072
    v_mfma_f32_32x32x16_bf16 v[164:179], v[88:91], v[96:99], v[164:179]
    buffer_load_dwordx4 v11, s[56:59], s50 offen  lds
    v_lshlrev_b32 v201, 16, v39
    v_lshlrev_b32 v202, 16, v43
    v_and_b32 v195, s5, v189
    v_lshlrev_b32 v194, 16, v189
    v_and_b32 v193, s5, v188
    v_lshlrev_b32 v192, 16, v188
    s_waitcnt lgkmcnt(2)
    v_mfma_f32_32x32x16_bf16 v[116:131], v[100:103], v[108:111], v[116:131]
    ds_read_b128 v[84:87], v67 offset:32768
    ds_read_b128 v[92:95], v75 offset:32768
    v_mul_f32 v203, v195, v196
    v_mul_f32 v204, v195, v197
    v_mul_f32 v205, v195, v198
    v_mul_f32 v206, v195, v199
    v_fmac_f32 v203, v194, v197
    s_waitcnt lgkmcnt(3)
    v_mfma_f32_32x32x16_bf16 v[132:147], v[100:103], v[112:115], v[132:147]
    ds_read_b128 v[96:99], v75 offset:36864
    ds_read_b128 v[88:91], v67 offset:36864
    v_fmac_f32 v204, v194, v198
    v_fmac_f32 v205, v194, v199
    v_fmac_f32 v206, v194, v200
    s_add_u32 s51, s46, s49
    s_add_u32 m0, s47, 16384
    s_waitcnt lgkmcnt(4)
    v_mfma_f32_32x32x16_bf16 v[148:163], v[104:107], v[108:111], v[148:163]
    buffer_load_dwordx4 v12, s[60:63], s51 offen  lds
    v_fmac_f32 v203, v193, v198
    v_fmac_f32 v204, v193, v199
    v_fmac_f32 v205, v193, v200
    v_fmac_f32 v206, v193, v201
    v_fmac_f32 v203, v192, v199
    s_add_u32 m0, s47, 17408
    v_mfma_f32_32x32x16_bf16 v[164:179], v[104:107], v[112:115], v[164:179]
    buffer_load_dwordx4 v13, s[60:63], s51 offen  lds
    v_fmac_f32 v204, v192, v200
    v_fmac_f32 v205, v192, v201
    v_fmac_f32 v206, v192, v202
    v_lshlrev_b32 v196, 16, v47
    v_lshlrev_b32 v197, 16, v51
    v_lshlrev_b32 v198, 16, v55
    s_waitcnt lgkmcnt(2)
    v_mfma_f32_32x32x16_bf16 v[116:131], v[84:87], v[92:95], v[116:131]
    ds_read_b128 v[100:103], v68 offset:32768
    ds_read_b128 v[108:111], v76 offset:32768
    v_lshlrev_b32 v199, 16, v59
    v_mul_f32 v203, v203, v196
    v_mul_f32 v204, v204, v197
    v_mul_f32 v205, v205, v198
    v_mul_f32 v206, v206, v199
    s_waitcnt lgkmcnt(3)
    v_mfma_f32_32x32x16_bf16 v[132:147], v[84:87], v[96:99], v[132:147]
    ds_read_b128 v[112:115], v76 offset:36864
    ds_read_b128 v[104:107], v68 offset:36864
    v_cvt_pk_bf16_f32 v222, v206, v205
    v_cvt_pk_bf16_f32 v223, v204, v203
    v_and_b32 v196, s5, v19
    v_and_b32 v197, s5, v23
    s_add_u32 m0, s47, 18432
    s_waitcnt lgkmcnt(4)
    v_mfma_f32_32x32x16_bf16 v[148:163], v[88:91], v[92:95], v[148:163]
    buffer_load_dwordx4 v14, s[60:63], s51 offen  lds
    v_and_b32 v198, s5, v27
    v_and_b32 v199, s5, v31
    v_and_b32 v200, s5, v35
    v_and_b32 v201, s5, v39
    v_and_b32 v202, s5, v43
    s_add_u32 m0, s47, 19456
    v_mfma_f32_32x32x16_bf16 v[164:179], v[88:91], v[96:99], v[164:179]
    buffer_load_dwordx4 v15, s[60:63], s51 offen  lds
    v_and_b32 v195, s5, v191
    v_lshlrev_b32 v194, 16, v191
    v_and_b32 v193, s5, v190
    v_lshlrev_b32 v192, 16, v190
    v_mul_f32 v203, v195, v196
    v_mul_f32 v204, v195, v197
    s_waitcnt lgkmcnt(0)
    s_waitcnt vmcnt(16)
    s_barrier
    v_mfma_f32_32x32x16_bf16 v[116:131], v[100:103], v[108:111], v[116:131]
    ds_read_b128 v[84:87], v69 offset:0
    ds_read_b128 v[92:95], v77 offset:0
    v_mul_f32 v205, v195, v198
    v_mul_f32 v206, v195, v199
    v_fmac_f32 v203, v194, v197
    v_fmac_f32 v204, v194, v198
    v_fmac_f32 v205, v194, v199
    v_mfma_f32_32x32x16_bf16 v[132:147], v[100:103], v[112:115], v[132:147]
    ds_read_b128 v[96:99], v77 offset:4096
    ds_read_b128 v[88:91], v69 offset:4096
    v_fmac_f32 v206, v194, v200
    s_add_u32 s49, s49, 128
    s_and_b32 s49, s49, 0x7ff
    s_add_u32 s50, s45, s49
    s_add_u32 m0, s47, 32768
    v_mfma_f32_32x32x16_bf16 v[148:163], v[104:107], v[108:111], v[148:163]
    buffer_load_dwordx4 v8, s[56:59], s50 offen  lds
    v_fmac_f32 v203, v193, v198
    v_fmac_f32 v204, v193, v199
    v_fmac_f32 v205, v193, v200
    v_fmac_f32 v206, v193, v201
    v_fmac_f32 v203, v192, v199
    s_add_u32 m0, s47, 33792
    v_mfma_f32_32x32x16_bf16 v[164:179], v[104:107], v[112:115], v[164:179]
    buffer_load_dwordx4 v9, s[56:59], s50 offen  lds
    v_fmac_f32 v204, v192, v200
    v_fmac_f32 v205, v192, v201
    v_fmac_f32 v206, v192, v202
    v_and_b32 v196, s5, v47
    v_and_b32 v197, s5, v51
    v_and_b32 v198, s5, v55
    s_waitcnt lgkmcnt(2)
    v_mfma_f32_32x32x16_bf16 v[116:131], v[84:87], v[92:95], v[116:131]
    ds_read_b128 v[100:103], v70 offset:0
    ds_read_b128 v[108:111], v78 offset:0
    v_and_b32 v199, s5, v59
    v_mul_f32 v203, v203, v196
    v_mul_f32 v204, v204, v197
    v_mul_f32 v205, v205, v198
    v_mul_f32 v206, v206, v199
    s_waitcnt lgkmcnt(3)
    v_mfma_f32_32x32x16_bf16 v[132:147], v[84:87], v[96:99], v[132:147]
    ds_read_b128 v[112:115], v78 offset:4096
    ds_read_b128 v[104:107], v70 offset:4096
    v_cvt_pk_bf16_f32 v220, v206, v205
    v_cvt_pk_bf16_f32 v221, v204, v203
    s_nop 0
    v_permlane32_swap_b32 v222, v220
    v_permlane32_swap_b32 v223, v221
    s_add_u32 m0, s47, 34816
    s_waitcnt lgkmcnt(4)
    v_mfma_f32_32x32x16_bf16 v[148:163], v[88:91], v[92:95], v[148:163]
    buffer_load_dwordx4 v10, s[56:59], s50 offen  lds
    buffer_store_dwordx4 v[208:211], v180, s[8:11], s6 offen sc0 sc1
    s_add_u32 s6, s6, 32768
    buffer_store_dwordx4 v[212:215], v180, s[8:11], s6 offen sc0 sc1
    s_add_u32 s6, s6, 32768
    s_add_u32 m0, s47, 35840
    v_mfma_f32_32x32x16_bf16 v[164:179], v[88:91], v[96:99], v[164:179]
    buffer_load_dwordx4 v11, s[56:59], s50 offen  lds
    buffer_store_dwordx4 v[216:219], v180, s[8:11], s6 offen sc0 sc1
    s_add_u32 s6, s6, 32768
    buffer_store_dwordx4 v[220:223], v180, s[8:11], s6 offen sc0 sc1
    buffer_load_dwordx4 v[32:35], v60, s[80:83], 0 offen offset:0
    buffer_load_dwordx4 v[36:39], v60, s[80:83], 0 offen offset:1024
    s_waitcnt lgkmcnt(2)
    v_mfma_f32_32x32x16_bf16 v[116:131], v[100:103], v[108:111], v[116:131]
    ds_read_b128 v[84:87], v71 offset:0
    ds_read_b128 v[92:95], v79 offset:0
    buffer_load_dwordx4 v[16:19], v60, s[56:59], s30 offen offset:0
    buffer_load_dwordx4 v[20:23], v60, s[56:59], s30 offen offset:1024
    buffer_load_dwordx4 v[24:27], v60, s[56:59], s30 offen offset:2048
    buffer_load_dwordx4 v[28:31], v60, s[56:59], s30 offen offset:3072
    s_waitcnt lgkmcnt(3)
    v_mfma_f32_32x32x16_bf16 v[132:147], v[100:103], v[112:115], v[132:147]
    ds_read_b128 v[96:99], v79 offset:4096
    ds_read_b128 v[88:91], v71 offset:4096
    v_lshlrev_b32 v62, 16, v62
    v_lshlrev_b32 v63, 16, v63
    v_lshlrev_b32 v64, 16, v64
    s_add_u32 s51, s46, s49
    s_add_u32 m0, s47, 49152
    s_waitcnt lgkmcnt(4)
    v_mfma_f32_32x32x16_bf16 v[148:163], v[104:107], v[108:111], v[148:163]
    buffer_load_dwordx4 v12, s[60:63], s51 offen  lds
    v_mul_f32 v184, 1069066811, v64
    v_exp_f32 v184, v184
    s_nop 0
    v_cvt_pk_bf16_f32 v184, v184, v184
    v_lshlrev_b32 v184, 16, v184
    v_mul_f32 v185, v184, v62
    s_add_u32 m0, s47, 50176
    v_mfma_f32_32x32x16_bf16 v[164:179], v[104:107], v[112:115], v[164:179]
    buffer_load_dwordx4 v13, s[60:63], s51 offen  lds
    v_mul_f32 v186, v184, v63
    v_mul_f32 v185, 1069066811, v185
    v_exp_f32 v185, v185
    v_mul_f32 v186, 1042479491, v186
    v_fract_f32 v186, v186
    v_cos_f32 v187, v186
    s_waitcnt lgkmcnt(2)
    v_mfma_f32_32x32x16_bf16 v[116:131], v[84:87], v[92:95], v[116:131]
    ds_read_b128 v[100:103], v72 offset:0
    ds_read_b128 v[108:111], v80 offset:0
    v_sin_f32 v188, v186
    v_mul_f32 v48, v185, v187
    v_mul_f32 v49, v185, v188
    v_add_f32 v184, -1.0, v48
    v_mul_f32 v185, v62, v62
    s_waitcnt lgkmcnt(3)
    v_mfma_f32_32x32x16_bf16 v[132:147], v[84:87], v[96:99], v[132:147]
    ds_read_b128 v[112:115], v80 offset:4096
    ds_read_b128 v[104:107], v72 offset:4096
    v_fmac_f32 v185, v63, v63
    v_rcp_f32 v185, v185
    s_nop 0
    v_add_f32 v185, v185, v185
    v_mul_f32 v186, v184, v62
    s_add_u32 m0, s47, 51200
    s_waitcnt lgkmcnt(4)
    v_mfma_f32_32x32x16_bf16 v[148:163], v[88:91], v[92:95], v[148:163]
    buffer_load_dwordx4 v14, s[60:63], s51 offen  lds
    v_fmac_f32 v186, v49, v63
    v_mul_f32 v187, v49, v62
    v_fma_f32 v187, -v184, v63, v187
    v_mul_f32 v50, v186, v185
    v_mul_f32 v51, v187, v185
    s_add_u32 m0, s47, 52224
    v_mfma_f32_32x32x16_bf16 v[164:179], v[88:91], v[96:99], v[164:179]
    buffer_load_dwordx4 v15, s[60:63], s51 offen  lds
    v_mul_f32 v184, v49, v49
    v_fma_f32 v184, v48, v48, -v184
    v_mul_f32 v185, v48, v49
    v_add_f32 v185, v185, v185
    v_mul_f32 v186, v185, v185
    v_fma_f32 v186, v184, v184, -v186
    s_waitcnt lgkmcnt(0)
    s_waitcnt vmcnt(26)
    s_barrier
    v_mfma_f32_32x32x16_bf16 v[116:131], v[100:103], v[108:111], v[116:131]
    ds_read_b128 v[84:87], v69 offset:32768
    ds_read_b128 v[92:95], v77 offset:32768
    v_mul_f32 v187, v184, v185
    v_add_f32 v187, v187, v187
    v_mul_f32 v184, v187, v187
    v_fma_f32 v184, v186, v186, -v184
    v_mul_f32 v185, v186, v187
    v_mfma_f32_32x32x16_bf16 v[132:147], v[100:103], v[112:115], v[132:147]
    ds_read_b128 v[96:99], v77 offset:36864
    ds_read_b128 v[88:91], v69 offset:36864
    v_add_f32 v185, v185, v185
    s_add_u32 s49, s49, 128
    s_and_b32 s49, s49, 0x7ff
    s_add_u32 s50, s45, s49
    s_add_u32 m0, s47, 65536
    v_mfma_f32_32x32x16_bf16 v[148:163], v[104:107], v[108:111], v[148:163]
    buffer_load_dwordx4 v8, s[56:59], s50 offen  lds
    v_mul_f32 v52, v185, v185
    v_fma_f32 v52, v184, v184, -v52
    v_mul_f32 v53, v184, v185
    v_add_f32 v53, v53, v53
    v_mul_f32 v184, v53, v53
    s_add_u32 m0, s47, 66560
    v_mfma_f32_32x32x16_bf16 v[164:179], v[104:107], v[112:115], v[164:179]
    buffer_load_dwordx4 v9, s[56:59], s50 offen  lds
    v_fma_f32 v184, v52, v52, -v184
    v_mul_f32 v185, v52, v53
    v_add_f32 v185, v185, v185
    v_mul_f32 v186, v185, v185
    v_fma_f32 v186, v184, v184, -v186
    v_mul_f32 v187, v184, v185
    s_waitcnt lgkmcnt(2)
    v_mfma_f32_32x32x16_bf16 v[116:131], v[84:87], v[92:95], v[116:131]
    ds_read_b128 v[100:103], v70 offset:32768
    ds_read_b128 v[108:111], v78 offset:32768
    v_add_f32 v187, v187, v187
    v_mul_f32 v54, v187, v187
    s_waitcnt lgkmcnt(3)
    v_mfma_f32_32x32x16_bf16 v[132:147], v[84:87], v[96:99], v[132:147]
    ds_read_b128 v[112:115], v78 offset:36864
    ds_read_b128 v[104:107], v70 offset:36864
    v_fma_f32 v54, v186, v186, -v54
    s_add_u32 m0, s47, 67584
    s_waitcnt lgkmcnt(4)
    v_mfma_f32_32x32x16_bf16 v[148:163], v[88:91], v[92:95], v[148:163]
    buffer_load_dwordx4 v10, s[56:59], s50 offen  lds
    v_mul_f32 v55, v186, v187
    v_add_f32 v55, v55, v55
    s_add_u32 m0, s47, 68608
    v_mfma_f32_32x32x16_bf16 v[164:179], v[88:91], v[96:99], v[164:179]
    buffer_load_dwordx4 v11, s[56:59], s50 offen  lds
    s_mov_b32 s34, 0
    s_mov_b32 s35, -1
    s_lshr_b32 s3, s42, 1
    s_waitcnt lgkmcnt(2)
    v_mfma_f32_32x32x16_bf16 v[116:131], v[100:103], v[108:111], v[116:131]
    ds_read_b128 v[84:87], v71 offset:32768
    ds_read_b128 v[92:95], v79 offset:32768
    s_cmp_eq_u32 s3, 1
    s_cselect_b32 s38, -1, 0
    s_cselect_b32 s39, -1, 0
    v_cndmask_b32 v184, 1.0, v184, s[34:35]
    s_waitcnt lgkmcnt(3)
    v_mfma_f32_32x32x16_bf16 v[132:147], v[100:103], v[112:115], v[132:147]
    ds_read_b128 v[96:99], v79 offset:36864
    ds_read_b128 v[88:91], v71 offset:36864
    s_add_u32 s51, s46, s49
    s_add_u32 m0, s47, 81920
    s_waitcnt lgkmcnt(4)
    v_mfma_f32_32x32x16_bf16 v[148:163], v[104:107], v[108:111], v[148:163]
    buffer_load_dwordx4 v12, s[60:63], s51 offen  lds
    v_cndmask_b32 v185, 0, v185, s[34:35]
    v_cndmask_b32 v186, 1.0, v186, s[38:39]
    s_add_u32 m0, s47, 82944
    v_mfma_f32_32x32x16_bf16 v[164:179], v[104:107], v[112:115], v[164:179]
    buffer_load_dwordx4 v13, s[60:63], s51 offen  lds
    v_cndmask_b32 v187, 0, v187, s[38:39]
    v_mul_f32 v188, v185, v187
    v_fma_f32 v188, v184, v186, -v188
    s_waitcnt lgkmcnt(2)
    v_mfma_f32_32x32x16_bf16 v[116:131], v[84:87], v[92:95], v[116:131]
    ds_read_b128 v[100:103], v72 offset:32768
    ds_read_b128 v[108:111], v80 offset:32768
    v_mul_f32 v189, v184, v187
    v_fmac_f32 v189, v185, v186
    s_waitcnt lgkmcnt(3)
    v_mfma_f32_32x32x16_bf16 v[132:147], v[84:87], v[96:99], v[132:147]
    ds_read_b128 v[112:115], v80 offset:36864
    ds_read_b128 v[104:107], v72 offset:36864
    v_mul_f32 v184, v189, v53
    s_add_u32 m0, s47, 83968
    s_waitcnt lgkmcnt(4)
    v_mfma_f32_32x32x16_bf16 v[148:163], v[88:91], v[92:95], v[148:163]
    buffer_load_dwordx4 v14, s[60:63], s51 offen  lds
    v_fma_f32 v184, v188, v52, -v184
    v_mul_f32 v185, v188, v53
    s_add_u32 m0, s47, 84992
    v_mfma_f32_32x32x16_bf16 v[164:179], v[88:91], v[96:99], v[164:179]
    buffer_load_dwordx4 v15, s[60:63], s51 offen  lds
    v_fmac_f32 v185, v189, v52
    v_mov_b32 v56, v188
    v_mov_b32 v57, v184
    s_waitcnt lgkmcnt(0)
    s_waitcnt vmcnt(26)
    s_barrier
    v_mfma_f32_32x32x16_bf16 v[116:131], v[100:103], v[108:111], v[116:131]
    ds_read_b128 v[84:87], v65 offset:0
    ds_read_b128 v[92:95], v73 offset:0
    v_mov_b32 v58, v189
    v_mov_b32 v59, v185
    v_mfma_f32_32x32x16_bf16 v[132:147], v[100:103], v[112:115], v[132:147]
    ds_read_b128 v[96:99], v73 offset:4096
    ds_read_b128 v[88:91], v65 offset:4096
    s_add_u32 s49, s49, 128
    s_and_b32 s49, s49, 0x7ff
    s_add_u32 s50, s45, s49
    s_add_u32 m0, s47, 98304
    v_mfma_f32_32x32x16_bf16 v[148:163], v[104:107], v[108:111], v[148:163]
    buffer_load_dwordx4 v8, s[56:59], s50 offen  lds
    v_mov_b32 v2, 0
    buffer_load_dwordx2 v[4:5], v2, s[24:27], 0 offen sc0 sc1
    s_add_u32 m0, s47, 99328
    v_mfma_f32_32x32x16_bf16 v[164:179], v[104:107], v[112:115], v[164:179]
    buffer_load_dwordx4 v9, s[56:59], s50 offen  lds
    s_waitcnt lgkmcnt(2)
    v_mfma_f32_32x32x16_bf16 v[116:131], v[84:87], v[92:95], v[116:131]
    ds_read_b128 v[100:103], v66 offset:0
    ds_read_b128 v[108:111], v74 offset:0
    s_waitcnt lgkmcnt(3)
    v_mfma_f32_32x32x16_bf16 v[132:147], v[84:87], v[96:99], v[132:147]
    ds_read_b128 v[112:115], v74 offset:4096
    ds_read_b128 v[104:107], v66 offset:4096
    s_add_u32 m0, s47, 100352
    s_waitcnt lgkmcnt(4)
    v_mfma_f32_32x32x16_bf16 v[148:163], v[88:91], v[92:95], v[148:163]
    buffer_load_dwordx4 v10, s[56:59], s50 offen  lds
    s_add_u32 m0, s47, 101376
    v_mfma_f32_32x32x16_bf16 v[164:179], v[88:91], v[96:99], v[164:179]
    buffer_load_dwordx4 v11, s[56:59], s50 offen  lds
    s_waitcnt lgkmcnt(2)
    v_mfma_f32_32x32x16_bf16 v[116:131], v[100:103], v[108:111], v[116:131]
    ds_read_b128 v[84:87], v67 offset:0
    ds_read_b128 v[92:95], v75 offset:0
    s_waitcnt lgkmcnt(3)
    v_mfma_f32_32x32x16_bf16 v[132:147], v[100:103], v[112:115], v[132:147]
    ds_read_b128 v[96:99], v75 offset:4096
    ds_read_b128 v[88:91], v67 offset:4096
    s_add_u32 s51, s46, s49
    s_add_u32 m0, s47, 114688
    s_waitcnt lgkmcnt(4)
    v_mfma_f32_32x32x16_bf16 v[148:163], v[104:107], v[108:111], v[148:163]
    buffer_load_dwordx4 v12, s[60:63], s51 offen  lds
    s_add_u32 m0, s47, 115712
    v_mfma_f32_32x32x16_bf16 v[164:179], v[104:107], v[112:115], v[164:179]
    buffer_load_dwordx4 v13, s[60:63], s51 offen  lds
    s_waitcnt lgkmcnt(2)
    v_mfma_f32_32x32x16_bf16 v[116:131], v[84:87], v[92:95], v[116:131]
    ds_read_b128 v[100:103], v68 offset:0
    ds_read_b128 v[108:111], v76 offset:0
    s_waitcnt lgkmcnt(3)
    v_mfma_f32_32x32x16_bf16 v[132:147], v[84:87], v[96:99], v[132:147]
    ds_read_b128 v[112:115], v76 offset:4096
    ds_read_b128 v[104:107], v68 offset:4096
    s_add_u32 m0, s47, 116736
    s_waitcnt lgkmcnt(4)
    v_mfma_f32_32x32x16_bf16 v[148:163], v[88:91], v[92:95], v[148:163]
    buffer_load_dwordx4 v14, s[60:63], s51 offen  lds
    s_add_u32 m0, s47, 117760
    v_mfma_f32_32x32x16_bf16 v[164:179], v[88:91], v[96:99], v[164:179]
    buffer_load_dwordx4 v15, s[60:63], s51 offen  lds
    s_waitcnt lgkmcnt(0)
    s_waitcnt vmcnt(17)
    s_barrier
    v_mfma_f32_32x32x16_bf16 v[116:131], v[100:103], v[108:111], v[116:131]
    ds_read_b128 v[84:87], v65 offset:32768
    ds_read_b128 v[92:95], v73 offset:32768
    v_mfma_f32_32x32x16_bf16 v[132:147], v[100:103], v[112:115], v[132:147]
    ds_read_b128 v[96:99], v73 offset:36864
    ds_read_b128 v[88:91], v65 offset:36864
    s_add_u32 s49, s49, 128
    s_and_b32 s49, s49, 0x7ff
    s_add_u32 s50, s45, s49
    s_add_u32 m0, s47, 0
    v_mfma_f32_32x32x16_bf16 v[148:163], v[104:107], v[108:111], v[148:163]
    buffer_load_dwordx4 v8, s[56:59], s50 offen  lds
    s_add_u32 m0, s47, 1024
    v_mfma_f32_32x32x16_bf16 v[164:179], v[104:107], v[112:115], v[164:179]
    buffer_load_dwordx4 v9, s[56:59], s50 offen  lds
    s_waitcnt lgkmcnt(2)
    v_mfma_f32_32x32x16_bf16 v[116:131], v[84:87], v[92:95], v[116:131]
    ds_read_b128 v[100:103], v66 offset:32768
    ds_read_b128 v[108:111], v74 offset:32768
    s_waitcnt lgkmcnt(3)
    v_mfma_f32_32x32x16_bf16 v[132:147], v[84:87], v[96:99], v[132:147]
    ds_read_b128 v[112:115], v74 offset:36864
    ds_read_b128 v[104:107], v66 offset:36864
    s_add_u32 m0, s47, 2048
    s_waitcnt lgkmcnt(4)
    v_mfma_f32_32x32x16_bf16 v[148:163], v[88:91], v[92:95], v[148:163]
    buffer_load_dwordx4 v10, s[56:59], s50 offen  lds
    s_add_u32 m0, s47, 3072
    v_mfma_f32_32x32x16_bf16 v[164:179], v[88:91], v[96:99], v[164:179]
    buffer_load_dwordx4 v11, s[56:59], s50 offen  lds
    s_waitcnt lgkmcnt(2)
    v_mfma_f32_32x32x16_bf16 v[116:131], v[100:103], v[108:111], v[116:131]
    ds_read_b128 v[84:87], v67 offset:32768
    ds_read_b128 v[92:95], v75 offset:32768
    s_waitcnt lgkmcnt(3)
    v_mfma_f32_32x32x16_bf16 v[132:147], v[100:103], v[112:115], v[132:147]
    ds_read_b128 v[96:99], v75 offset:36864
    ds_read_b128 v[88:91], v67 offset:36864
    s_add_u32 s51, s46, s49
    s_add_u32 m0, s47, 16384
    s_waitcnt lgkmcnt(4)
    v_mfma_f32_32x32x16_bf16 v[148:163], v[104:107], v[108:111], v[148:163]
    buffer_load_dwordx4 v12, s[60:63], s51 offen  lds
    s_add_u32 m0, s47, 17408
    v_mfma_f32_32x32x16_bf16 v[164:179], v[104:107], v[112:115], v[164:179]
    buffer_load_dwordx4 v13, s[60:63], s51 offen  lds
    s_waitcnt lgkmcnt(2)
    v_mfma_f32_32x32x16_bf16 v[116:131], v[84:87], v[92:95], v[116:131]
    ds_read_b128 v[100:103], v68 offset:32768
    ds_read_b128 v[108:111], v76 offset:32768
    s_waitcnt lgkmcnt(3)
    v_mfma_f32_32x32x16_bf16 v[132:147], v[84:87], v[96:99], v[132:147]
    ds_read_b128 v[112:115], v76 offset:36864
    ds_read_b128 v[104:107], v68 offset:36864
    s_add_u32 m0, s47, 18432
    s_waitcnt lgkmcnt(4)
    v_mfma_f32_32x32x16_bf16 v[148:163], v[88:91], v[92:95], v[148:163]
    buffer_load_dwordx4 v14, s[60:63], s51 offen  lds
    s_add_u32 m0, s47, 19456
    v_mfma_f32_32x32x16_bf16 v[164:179], v[88:91], v[96:99], v[164:179]
    buffer_load_dwordx4 v15, s[60:63], s51 offen  lds
    s_waitcnt lgkmcnt(0)
    s_waitcnt vmcnt(17)
    s_barrier
    v_mfma_f32_32x32x16_bf16 v[116:131], v[100:103], v[108:111], v[116:131]
    ds_read_b128 v[84:87], v69 offset:0
    ds_read_b128 v[92:95], v77 offset:0
    s_mov_b32 s33, 0
    s_waitcnt vmcnt(15)
    v_readfirstlane_b32 s22, v4
    v_readfirstlane_b32 s23, v5
    s_nop 3
    s_or_b32 s3, s22, s23
    s_cmp_lg_u32 s3, 0
    s_cbranch_scc1 Lnok_gate_2
Lnretry_gate_3:
    buffer_load_dwordx2 v[4:5], v2, s[24:27], 0 offen sc0 sc1
    s_waitcnt vmcnt(0)
    v_readfirstlane_b32 s22, v4
    v_readfirstlane_b32 s23, v5
    s_add_u32 s33, s33, 1
    s_nop 3
    s_or_b32 s3, s22, s23
    s_cmp_gt_u32 s33, 20000
    s_cbranch_scc1 Lnok_gate_2
    s_cmp_eq_u32 s3, 0
    s_cbranch_scc1 Lnretry_gate_3
Lnok_gate_2:
    v_mfma_f32_32x32x16_bf16 v[132:147], v[100:103], v[112:115], v[132:147]
    ds_read_b128 v[96:99], v77 offset:4096
    ds_read_b128 v[88:91], v69 offset:4096
    s_add_u32 s49, s49, 128
    s_and_b32 s49, s49, 0x7ff
    s_add_u32 s50, s45, s49
    s_add_u32 m0, s47, 32768
    v_mfma_f32_32x32x16_bf16 v[148:163], v[104:107], v[108:111], v[148:163]
    buffer_load_dwordx4 v8, s[56:59], s50 offen  lds
    s_add_u32 m0, s47, 33792
    v_mfma_f32_32x32x16_bf16 v[164:179], v[104:107], v[112:115], v[164:179]
    buffer_load_dwordx4 v9, s[56:59], s50 offen  lds
    v_mov_b32 v182, s22
    v_mov_b32 v183, s23
    s_mov_b64 s[38:39], exec
    s_mov_b64 exec, 1
    buffer_store_dwordx2 v[182:183], v6, s[8:11], s7 offen sc0 sc1
    s_mov_b64 exec, s[38:39]
    s_waitcnt lgkmcnt(2)
    v_mfma_f32_32x32x16_bf16 v[116:131], v[84:87], v[92:95], v[116:131]
    ds_read_b128 v[100:103], v70 offset:0
    ds_read_b128 v[108:111], v78 offset:0
    v_lshlrev_b32 v42, 16, v32
    v_and_b32 v43, s5, v32
    s_waitcnt lgkmcnt(3)
    v_mfma_f32_32x32x16_bf16 v[132:147], v[84:87], v[96:99], v[132:147]
    ds_read_b128 v[112:115], v78 offset:4096
    ds_read_b128 v[104:107], v70 offset:4096
    v_lshlrev_b32 v44, 16, v16
    s_add_u32 m0, s47, 34816
    s_waitcnt lgkmcnt(4)
    v_mfma_f32_32x32x16_bf16 v[148:163], v[88:91], v[92:95], v[148:163]
    buffer_load_dwordx4 v10, s[56:59], s50 offen  lds
    v_and_b32 v45, s5, v16
    v_mul_f32 v40, v42, v44
    s_add_u32 m0, s47, 35840
    v_mfma_f32_32x32x16_bf16 v[164:179], v[88:91], v[96:99], v[164:179]
    buffer_load_dwordx4 v11, s[56:59], s50 offen  lds
    v_fmac_f32 v40, v43, v45
    v_lshlrev_b32 v44, 16, v24
    v_and_b32 v45, s5, v24
    s_waitcnt lgkmcnt(2)
    v_mfma_f32_32x32x16_bf16 v[116:131], v[100:103], v[108:111], v[116:131]
    ds_read_b128 v[84:87], v71 offset:0
    ds_read_b128 v[92:95], v79 offset:0
    v_mul_f32 v41, v42, v44
    v_fmac_f32 v41, v43, v45
    s_waitcnt lgkmcnt(3)
    v_mfma_f32_32x32x16_bf16 v[132:147], v[100:103], v[112:115], v[132:147]
    ds_read_b128 v[96:99], v79 offset:4096
    ds_read_b128 v[88:91], v71 offset:4096
    s_add_u32 s51, s46, s49
    s_add_u32 m0, s47, 49152
    s_waitcnt lgkmcnt(4)
    v_mfma_f32_32x32x16_bf16 v[148:163], v[104:107], v[108:111], v[148:163]
    buffer_load_dwordx4 v12, s[60:63], s51 offen  lds
    v_lshlrev_b32 v42, 16, v33
    v_and_b32 v43, s5, v33
    s_add_u32 m0, s47, 50176
    v_mfma_f32_32x32x16_bf16 v[164:179], v[104:107], v[112:115], v[164:179]
    buffer_load_dwordx4 v13, s[60:63], s51 offen  lds
    v_lshlrev_b32 v44, 16, v17
    v_and_b32 v45, s5, v17
    v_fmac_f32 v40, v42, v44
    s_waitcnt lgkmcnt(2)
    v_mfma_f32_32x32x16_bf16 v[116:131], v[84:87], v[92:95], v[116:131]
    ds_read_b128 v[100:103], v72 offset:0
    ds_read_b128 v[108:111], v80 offset:0
    v_fmac_f32 v40, v43, v45
    v_lshlrev_b32 v44, 16, v25
    s_waitcnt lgkmcnt(3)
    v_mfma_f32_32x32x16_bf16 v[132:147], v[84:87], v[96:99], v[132:147]
    ds_read_b128 v[112:115], v80 offset:4096
    ds_read_b128 v[104:107], v72 offset:4096
    v_and_b32 v45, s5, v25
    s_add_u32 m0, s47, 51200
    s_waitcnt lgkmcnt(4)
    v_mfma_f32_32x32x16_bf16 v[148:163], v[88:91], v[92:95], v[148:163]
    buffer_load_dwordx4 v14, s[60:63], s51 offen  lds
    v_fmac_f32 v41, v42, v44
    v_fmac_f32 v41, v43, v45
    s_add_u32 m0, s47, 52224
    v_mfma_f32_32x32x16_bf16 v[164:179], v[88:91], v[96:99], v[164:179]
    buffer_load_dwordx4 v15, s[60:63], s51 offen  lds
    v_lshlrev_b32 v42, 16, v34
    v_and_b32 v43, s5, v34
    v_lshlrev_b32 v44, 16, v18
    s_waitcnt lgkmcnt(0)
    s_waitcnt vmcnt(17)
    s_barrier
    v_mfma_f32_32x32x16_bf16 v[116:131], v[100:103], v[108:111], v[116:131]
    ds_read_b128 v[84:87], v69 offset:32768
    ds_read_b128 v[92:95], v77 offset:32768
    v_and_b32 v45, s5, v18
    v_fmac_f32 v40, v42, v44
    v_mfma_f32_32x32x16_bf16 v[132:147], v[100:103], v[112:115], v[132:147]
    ds_read_b128 v[96:99], v77 offset:36864
    ds_read_b128 v[88:91], v69 offset:36864
    s_add_u32 s49, s49, 128
    s_and_b32 s49, s49, 0x7ff
    s_add_u32 s50, s45, s49
    s_add_u32 m0, s47, 65536
    v_mfma_f32_32x32x16_bf16 v[148:163], v[104:107], v[108:111], v[148:163]
    buffer_load_dwordx4 v8, s[56:59], s50 offen  lds
    v_fmac_f32 v40, v43, v45
    v_lshlrev_b32 v44, 16, v26
    s_add_u32 m0, s47, 66560
    v_mfma_f32_32x32x16_bf16 v[164:179], v[104:107], v[112:115], v[164:179]
    buffer_load_dwordx4 v9, s[56:59], s50 offen  lds
    v_and_b32 v45, s5, v26
    v_fmac_f32 v41, v42, v44
    v_fmac_f32 v41, v43, v45
    s_waitcnt lgkmcnt(2)
    v_mfma_f32_32x32x16_bf16 v[116:131], v[84:87], v[92:95], v[116:131]
    ds_read_b128 v[100:103], v70 offset:32768
    ds_read_b128 v[108:111], v78 offset:32768
    v_lshlrev_b32 v42, 16, v35
    v_and_b32 v43, s5, v35
    s_waitcnt lgkmcnt(3)
    v_mfma_f32_32x32x16_bf16 v[132:147], v[84:87], v[96:99], v[132:147]
    ds_read_b128 v[112:115], v78 offset:36864
    ds_read_b128 v[104:107], v70 offset:36864
    v_lshlrev_b32 v44, 16, v19
    s_add_u32 m0, s47, 67584
    s_waitcnt lgkmcnt(4)
    v_mfma_f32_32x32x16_bf16 v[148:163], v[88:91], v[92:95], v[148:163]
    buffer_load_dwordx4 v10, s[56:59], s50 offen  lds
    v_and_b32 v45, s5, v19
    v_fmac_f32 v40, v42, v44
    s_add_u32 m0, s47, 68608
    v_mfma_f32_32x32x16_bf16 v[164:179], v[88:91], v[96:99], v[164:179]
    buffer_load_dwordx4 v11, s[56:59], s50 offen  lds
    v_fmac_f32 v40, v43, v45
    v_lshlrev_b32 v44, 16, v27
    v_and_b32 v45, s5, v27
    s_waitcnt lgkmcnt(2)
    v_mfma_f32_32x32x16_bf16 v[116:131], v[100:103], v[108:111], v[116:131]
    ds_read_b128 v[84:87], v71 offset:32768
    ds_read_b128 v[92:95], v79 offset:32768
    v_fmac_f32 v41, v42, v44
    v_fmac_f32 v41, v43, v45
    s_waitcnt lgkmcnt(3)
    v_mfma_f32_32x32x16_bf16 v[132:147], v[100:103], v[112:115], v[132:147]
    ds_read_b128 v[96:99], v79 offset:36864
    ds_read_b128 v[88:91], v71 offset:36864
    s_add_u32 s51, s46, s49
    s_add_u32 m0, s47, 81920
    s_waitcnt lgkmcnt(4)
    v_mfma_f32_32x32x16_bf16 v[148:163], v[104:107], v[108:111], v[148:163]
    buffer_load_dwordx4 v12, s[60:63], s51 offen  lds
    v_lshlrev_b32 v42, 16, v36
    v_and_b32 v43, s5, v36
    s_add_u32 m0, s47, 82944
    v_mfma_f32_32x32x16_bf16 v[164:179], v[104:107], v[112:115], v[164:179]
    buffer_load_dwordx4 v13, s[60:63], s51 offen  lds
    v_lshlrev_b32 v44, 16, v20
    v_and_b32 v45, s5, v20
    v_fmac_f32 v40, v42, v44
    s_waitcnt lgkmcnt(2)
    v_mfma_f32_32x32x16_bf16 v[116:131], v[84:87], v[92:95], v[116:131]
    ds_read_b128 v[100:103], v72 offset:32768
    ds_read_b128 v[108:111], v80 offset:32768
    v_fmac_f32 v40, v43, v45
    v_lshlrev_b32 v44, 16, v28
    s_waitcnt lgkmcnt(3)
    v_mfma_f32_32x32x16_bf16 v[132:147], v[84:87], v[96:99], v[132:147]
    ds_read_b128 v[112:115], v80 offset:36864
    ds_read_b128 v[104:107], v72 offset:36864
    v_and_b32 v45, s5, v28
    s_add_u32 m0, s47, 83968
    s_waitcnt lgkmcnt(4)
    v_mfma_f32_32x32x16_bf16 v[148:163], v[88:91], v[92:95], v[148:163]
    buffer_load_dwordx4 v14, s[60:63], s51 offen  lds
    v_fmac_f32 v41, v42, v44
    v_fmac_f32 v41, v43, v45
    s_add_u32 m0, s47, 84992
    v_mfma_f32_32x32x16_bf16 v[164:179], v[88:91], v[96:99], v[164:179]
    buffer_load_dwordx4 v15, s[60:63], s51 offen  lds
    v_lshlrev_b32 v42, 16, v37
    v_and_b32 v43, s5, v37
    v_lshlrev_b32 v44, 16, v21
    s_waitcnt lgkmcnt(0)
    s_waitcnt vmcnt(17)
    s_barrier
    v_mfma_f32_32x32x16_bf16 v[116:131], v[100:103], v[108:111], v[116:131]
    ds_read_b128 v[84:87], v65 offset:0
    ds_read_b128 v[92:95], v73 offset:0
    v_and_b32 v45, s5, v21
    v_fmac_f32 v40, v42, v44
    v_mfma_f32_32x32x16_bf16 v[132:147], v[100:103], v[112:115], v[132:147]
    ds_read_b128 v[96:99], v73 offset:4096
    ds_read_b128 v[88:91], v65 offset:4096
    s_add_u32 s49, s49, 128
    s_and_b32 s49, s49, 0x7ff
    s_add_u32 s50, s45, s49
    s_add_u32 m0, s47, 98304
    v_mfma_f32_32x32x16_bf16 v[148:163], v[104:107], v[108:111], v[148:163]
    buffer_load_dwordx4 v8, s[56:59], s50 offen  lds
    v_fmac_f32 v40, v43, v45
    v_lshlrev_b32 v44, 16, v29
    s_add_u32 m0, s47, 99328
    v_mfma_f32_32x32x16_bf16 v[164:179], v[104:107], v[112:115], v[164:179]
    buffer_load_dwordx4 v9, s[56:59], s50 offen  lds
    v_and_b32 v45, s5, v29
    v_fmac_f32 v41, v42, v44
    v_fmac_f32 v41, v43, v45
    s_waitcnt lgkmcnt(2)
    v_mfma_f32_32x32x16_bf16 v[116:131], v[84:87], v[92:95], v[116:131]
    ds_read_b128 v[100:103], v66 offset:0
    ds_read_b128 v[108:111], v74 offset:0
    v_lshlrev_b32 v42, 16, v38
    v_and_b32 v43, s5, v38
    v_lshlrev_b32 v44, 16, v22
    v_and_b32 v45, s5, v22
    s_waitcnt lgkmcnt(3)
    v_mfma_f32_32x32x16_bf16 v[132:147], v[84:87], v[96:99], v[132:147]
    ds_read_b128 v[112:115], v74 offset:4096
    ds_read_b128 v[104:107], v66 offset:4096
    v_fmac_f32 v40, v42, v44
    v_fmac_f32 v40, v43, v45
    v_lshlrev_b32 v44, 16, v30
    s_add_u32 m0, s47, 100352
    s_waitcnt lgkmcnt(4)
    v_mfma_f32_32x32x16_bf16 v[148:163], v[88:91], v[92:95], v[148:163]
    buffer_load_dwordx4 v10, s[56:59], s50 offen  lds
    v_and_b32 v45, s5, v30
    v_fmac_f32 v41, v42, v44
    v_fmac_f32 v41, v43, v45
    v_lshlrev_b32 v42, 16, v39
    s_add_u32 m0, s47, 101376
    v_mfma_f32_32x32x16_bf16 v[164:179], v[88:91], v[96:99], v[164:179]
    buffer_load_dwordx4 v11, s[56:59], s50 offen  lds
    v_and_b32 v43, s5, v39
    v_lshlrev_b32 v44, 16, v23
    v_and_b32 v45, s5, v23
    v_fmac_f32 v40, v42, v44
    v_fmac_f32 v40, v43, v45
    s_waitcnt lgkmcnt(2)
    v_mfma_f32_32x32x16_bf16 v[116:131], v[100:103], v[108:111], v[116:131]
    ds_read_b128 v[84:87], v67 offset:0
    ds_read_b128 v[92:95], v75 offset:0
    v_lshlrev_b32 v44, 16, v31
    v_and_b32 v45, s5, v31
    v_fmac_f32 v41, v42, v44
    v_fmac_f32 v41, v43, v45
    s_waitcnt lgkmcnt(3)
    v_mfma_f32_32x32x16_bf16 v[132:147], v[100:103], v[112:115], v[132:147]
    ds_read_b128 v[96:99], v75 offset:4096
    ds_read_b128 v[88:91], v67 offset:4096
    v_add_f32_dpp v40, v40, v40 row_shr:1 row_mask:0xf bank_mask:0xf bound_ctrl:0
    v_add_f32_dpp v41, v41, v41 row_shr:1 row_mask:0xf bank_mask:0xf bound_ctrl:0
    s_add_u32 s51, s46, s49
    s_add_u32 m0, s47, 114688
    s_waitcnt lgkmcnt(4)
    v_mfma_f32_32x32x16_bf16 v[148:163], v[104:107], v[108:111], v[148:163]
    buffer_load_dwordx4 v12, s[60:63], s51 offen  lds
    v_add_f32_dpp v40, v40, v40 row_shr:2 row_mask:0xf bank_mask:0xf bound_ctrl:0
    v_add_f32_dpp v41, v41, v41 row_shr:2 row_mask:0xf bank_mask:0xf bound_ctrl:0
    s_nop 0
    v_add_f32_dpp v40, v40, v40 row_shr:4 row_mask:0xf bank_mask:0xf bound_ctrl:0
    v_add_f32_dpp v41, v41, v41 row_shr:4 row_mask:0xf bank_mask:0xf bound_ctrl:0
    s_add_u32 m0, s47, 115712
    v_mfma_f32_32x32x16_bf16 v[164:179], v[104:107], v[112:115], v[164:179]
    buffer_load_dwordx4 v13, s[60:63], s51 offen  lds
    v_add_f32_dpp v40, v40, v40 row_shr:8 row_mask:0xf bank_mask:0xf bound_ctrl:0
    v_add_f32_dpp v41, v41, v41 row_shr:8 row_mask:0xf bank_mask:0xf bound_ctrl:0
    s_nop 0
    v_add_f32_dpp v40, v40, v40 row_bcast:15 row_mask:0xa bank_mask:0xf
    v_add_f32_dpp v41, v41, v41 row_bcast:15 row_mask:0xa bank_mask:0xf
    s_nop 0
    v_add_f32_dpp v40, v40, v40 row_bcast:31 row_mask:0xc bank_mask:0xf
    s_waitcnt lgkmcnt(2)
    v_mfma_f32_32x32x16_bf16 v[116:131], v[84:87], v[92:95], v[116:131]
    ds_read_b128 v[100:103], v68 offset:0
    ds_read_b128 v[108:111], v76 offset:0
    v_add_f32_dpp v41, v41, v41 row_bcast:31 row_mask:0xc bank_mask:0xf
    v_cvt_pk_bf16_f32 v42, v40, v41
    v_lshlrev_b32 v40, 16, v42
    v_and_b32 v41, s5, v42
    s_waitcnt lgkmcnt(3)
    v_mfma_f32_32x32x16_bf16 v[132:147], v[84:87], v[96:99], v[132:147]
    ds_read_b128 v[112:115], v76 offset:4096
    ds_read_b128 v[104:107], v68 offset:4096
    v_mul_f32 v40, 0xbfb8aa3b, v40
    v_mul_f32 v41, 0xbfb8aa3b, v41
    v_exp_f32 v40, v40
    s_add_u32 m0, s47, 116736
    s_waitcnt lgkmcnt(4)
    v_mfma_f32_32x32x16_bf16 v[148:163], v[88:91], v[92:95], v[148:163]
    buffer_load_dwordx4 v14, s[60:63], s51 offen  lds
    v_exp_f32 v41, v41
    v_add_f32 v40, 1.0, v40
    v_add_f32 v41, 1.0, v41
    v_rcp_f32 v40, v40
    s_add_u32 m0, s47, 117760
    v_mfma_f32_32x32x16_bf16 v[164:179], v[88:91], v[96:99], v[164:179]
    buffer_load_dwordx4 v15, s[60:63], s51 offen  lds
    v_rcp_f32 v41, v41
    s_nop 0
    v_cvt_pk_bf16_f32 v42, v40, v41
    v_lshlrev_b32 v40, 16, v42
    v_and_b32 v41, s5, v42
    v_sub_f32 v46, 1.0, v40
    s_waitcnt lgkmcnt(0)
    s_waitcnt vmcnt(16)
    s_barrier
    v_mfma_f32_32x32x16_bf16 v[116:131], v[100:103], v[108:111], v[116:131]
    ds_read_b128 v[84:87], v65 offset:32768
    ds_read_b128 v[92:95], v73 offset:32768
    v_sub_f32 v47, 1.0, v41
    v_cvt_pk_bf16_f32 v42, v46, v47
    v_lshlrev_b32 v46, 16, v42
    v_and_b32 v47, s5, v42
    v_mfma_f32_32x32x16_bf16 v[132:147], v[100:103], v[112:115], v[132:147]
    ds_read_b128 v[96:99], v73 offset:36864
    ds_read_b128 v[88:91], v65 offset:36864
    s_mov_b64 s[32:33], exec
    s_mov_b32 exec_lo, 0
    s_mov_b32 exec_hi, 0x80000000
    buffer_store_dwordx2 v[40:41], v207, s[8:11], 0 offen sc0 sc1
    buffer_store_dwordx2 v[46:47], v207, s[8:11], s31 offen sc0 sc1
    s_mov_b64 exec, s[32:33]
    s_mov_b32 s80, s14
    s_mov_b32 s81, s15
    s_mov_b32 s82, 2097152
    v_mfma_f32_32x32x16_bf16 v[148:163], v[104:107], v[108:111], v[148:163]
    s_mov_b32 s83, 131072
    v_and_b32 v17, 31, v1
    v_lshlrev_b32 v16, 11, v17
    v_lshrrev_b32 v17, 5, v1
    v_lshl_add_u32 v16, v17, 5, v16
    s_lshl_b32 s6, s44, 17
    v_mfma_f32_32x32x16_bf16 v[164:179], v[104:107], v[112:115], v[164:179]
    s_and_b32 s3, s42, 1
    s_lshl_b32 s3, s3, 16
    s_add_u32 s6, s6, s3
    s_lshl_b32 s3, s43, 7
    s_add_u32 s6, s6, s3
    s_lshr_b32 s3, s42, 1
    s_waitcnt lgkmcnt(2)
    v_mfma_f32_32x32x16_bf16 v[116:131], v[84:87], v[92:95], v[116:131]
    ds_read_b128 v[100:103], v66 offset:32768
    ds_read_b128 v[108:111], v74 offset:32768
    s_lshl_b32 s3, s3, 6
    s_add_u32 s6, s6, s3
    s_lshl_b32 s30, s44, 2
    s_add_u32 s30, s30, s42
    s_waitcnt lgkmcnt(3)
    v_mfma_f32_32x32x16_bf16 v[132:147], v[84:87], v[96:99], v[132:147]
    ds_read_b128 v[112:115], v74 offset:36864
    ds_read_b128 v[104:107], v66 offset:36864
    s_lshl_b32 s30, s30, 16
    s_lshl_b32 s3, s43, 12
    s_add_u32 s30, s30, s3
    s_add_u32 s30, s30, 16777216
    s_waitcnt lgkmcnt(4)
    v_mfma_f32_32x32x16_bf16 v[148:163], v[88:91], v[92:95], v[148:163]
    s_mov_b32 s31, 0x05040100
    s_mov_b32 s32, 0x07060302
    buffer_load_dwordx2 v[182:183], v81, s[8:11], 0 offen sc0 sc1
    buffer_load_dwordx4 v[18:21], v16, s[80:83], s6 offen offset:0
    buffer_load_dwordx4 v[22:25], v16, s[80:83], s6 offen offset:16
    s_mov_b32 s80, s16
    v_mfma_f32_32x32x16_bf16 v[164:179], v[88:91], v[96:99], v[164:179]
    s_mov_b32 s81, s17
    buffer_load_dwordx4 v[26:29], v16, s[80:83], s6 offen offset:0
    buffer_load_dwordx4 v[30:33], v16, s[80:83], s6 offen offset:16
    v_subrev_u32 v210, 32, v60
    v_min_u32 v210, 0x7fff0000, v210
    v_subrev_u32 v211, 16, v60
    s_waitcnt lgkmcnt(2)
    v_mfma_f32_32x32x16_bf16 v[116:131], v[100:103], v[108:111], v[116:131]
    ds_read_b128 v[84:87], v67 offset:32768
    ds_read_b128 v[92:95], v75 offset:32768
    v_min_u32 v211, 0x7fff0000, v211
    v_add_u32 v61, s19, v60
    s_mov_b32 s33, 0
    s_waitcnt vmcnt(4)
    v_cmp_ne_u64 vcc, s[22:23], v[182:183]
    s_nop 4
    s_cbranch_vccz Lfdone_gate_4
Lfpoll_gate_5:
    buffer_load_dwordx2 v[182:183], v81, s[8:11], 0 offen sc0 sc1
    s_waitcnt vmcnt(0)
    v_cmp_ne_u64 vcc, s[22:23], v[182:183]
    s_nop 4
    s_add_u32 s33, s33, 1
    s_cmp_gt_u32 s33, 20000
    s_cbranch_scc1 Lfdone_gate_4
    s_cbranch_vccnz Lfpoll_gate_5
Lfdone_gate_4:
    s_waitcnt lgkmcnt(3)
    v_mfma_f32_32x32x16_bf16 v[132:147], v[100:103], v[112:115], v[132:147]
    ds_read_b128 v[96:99], v75 offset:36864
    ds_read_b128 v[88:91], v67 offset:36864
    s_mov_b32 m0, s29
    s_nop 0
    buffer_load_dwordx4 v181, s[8:11], s28 offen offset:0 sc0 sc1 lds
    buffer_load_dwordx4 v181, s[8:11], s28 offen offset:1024 sc0 sc1 lds
    buffer_load_dwordx4 v181, s[8:11], s28 offen offset:2048 sc0 sc1 lds
    buffer_load_dwordx4 v181, s[8:11], s28 offen offset:3072 sc0 sc1 lds
    buffer_load_dwordx4 v[188:191], v210, s[76:79], 0 offen
    buffer_load_dwordx2 v[196:197], v211, s[76:79], 0 offen
    s_waitcnt lgkmcnt(4)
    v_mfma_f32_32x32x16_bf16 v[148:163], v[104:107], v[108:111], v[148:163]
    buffer_load_dwordx4 v[34:37], v60, s[76:79], 0 offen offset:0
    buffer_load_dwordx2 v[46:47], v60, s[76:79], 0 offen offset:16
    buffer_load_dwordx4 v[38:41], v60, s[76:79], 0 offen offset:1024
    buffer_load_dwordx2 v[62:63], v60, s[76:79], 0 offen offset:1040
    buffer_load_dwordx4 v[42:45], v60, s[76:79], 0 offen offset:2048
    buffer_load_dwordx2 v[192:193], v60, s[76:79], 0 offen offset:2064
    v_mfma_f32_32x32x16_bf16 v[164:179], v[104:107], v[112:115], v[164:179]
    buffer_load_dwordx4 v[184:187], v60, s[76:79], 0 offen offset:3072
    buffer_load_dwordx2 v[194:195], v60, s[76:79], 0 offen offset:3088
    s_waitcnt lgkmcnt(2)
    v_mfma_f32_32x32x16_bf16 v[116:131], v[84:87], v[92:95], v[116:131]
    ds_read_b128 v[100:103], v68 offset:32768
    ds_read_b128 v[108:111], v76 offset:32768
    s_waitcnt lgkmcnt(3)
    v_mfma_f32_32x32x16_bf16 v[132:147], v[84:87], v[96:99], v[132:147]
    ds_read_b128 v[112:115], v76 offset:36864
    ds_read_b128 v[104:107], v68 offset:36864
    s_waitcnt lgkmcnt(4)
    v_mfma_f32_32x32x16_bf16 v[148:163], v[88:91], v[92:95], v[148:163]
    v_mfma_f32_32x32x16_bf16 v[164:179], v[88:91], v[96:99], v[164:179]
    s_waitcnt lgkmcnt(0)
    s_barrier
    v_mfma_f32_32x32x16_bf16 v[116:131], v[100:103], v[108:111], v[116:131]
    ds_read_b128 v[84:87], v69 offset:0
    ds_read_b128 v[92:95], v77 offset:0
    s_waitcnt vmcnt(15)
    v_perm_b32 v212, v26, v18, s31
    v_perm_b32 v213, v26, v18, s32
    v_perm_b32 v214, v27, v19, s31
    v_perm_b32 v215, v27, v19, s32
    v_mfma_f32_32x32x16_bf16 v[132:147], v[100:103], v[112:115], v[132:147]
    ds_read_b128 v[96:99], v77 offset:4096
    ds_read_b128 v[88:91], v69 offset:4096
    buffer_store_dwordx4 v[212:215], v60, s[8:11], s30 offen offset:0 sc0 sc1
    v_perm_b32 v216, v28, v20, s31
    v_perm_b32 v217, v28, v20, s32
    v_perm_b32 v218, v29, v21, s31
    v_mfma_f32_32x32x16_bf16 v[148:163], v[104:107], v[108:111], v[148:163]
    v_perm_b32 v219, v29, v21, s32
    buffer_store_dwordx4 v[216:219], v60, s[8:11], s30 offen offset:1024 sc0 sc1
    s_waitcnt vmcnt(16)
    v_perm_b32 v212, v30, v22, s31
    v_perm_b32 v213, v30, v22, s32
    v_perm_b32 v214, v31, v23, s31
    v_perm_b32 v215, v31, v23, s32
    v_mfma_f32_32x32x16_bf16 v[164:179], v[104:107], v[112:115], v[164:179]
    buffer_store_dwordx4 v[212:215], v60, s[8:11], s30 offen offset:2048 sc0 sc1
    v_perm_b32 v216, v32, v24, s31
    v_perm_b32 v217, v32, v24, s32
    v_perm_b32 v218, v33, v25, s31
    v_perm_b32 v219, v33, v25, s32
    buffer_store_dwordx4 v[216:219], v60, s[8:11], s30 offen offset:3072 sc0 sc1
    s_waitcnt lgkmcnt(2)
    v_mfma_f32_32x32x16_bf16 v[116:131], v[84:87], v[92:95], v[116:131]
    ds_read_b128 v[100:103], v70 offset:0
    ds_read_b128 v[108:111], v78 offset:0
    v_and_b32 v64, 15, v1
    v_lshrrev_b32 v83, 4, v1
    v_add_u32 v180, 1, v64
    v_and_b32 v220, 3, v180
    s_waitcnt lgkmcnt(3)
    v_mfma_f32_32x32x16_bf16 v[132:147], v[84:87], v[96:99], v[132:147]
    ds_read_b128 v[112:115], v78 offset:4096
    ds_read_b128 v[104:107], v70 offset:4096
    v_mul_u32_u24 v220, 4160, v220
    v_and_b32 v180, 28, v180
    v_lshl_add_u32 v220, v180, 1, v220
    v_lshl_add_u32 v220, v83, 4, v220
    s_waitcnt lgkmcnt(4)
    v_mfma_f32_32x32x16_bf16 v[148:163], v[88:91], v[92:95], v[148:163]
    v_add_u32 v221, s19, v220
    v_lshlrev_b32 v180, 1, v64
    v_sub_u32 v180, v83, v180
    v_add_u32 v180, 30, v180
    v_lshrrev_b32 v220, 2, v180
    v_lshlrev_b32 v180, 6, v180
    v_mfma_f32_32x32x16_bf16 v[164:179], v[88:91], v[96:99], v[164:179]
    v_add_u32 v180, 131072, v180
    v_add_u32 v222, 63, v220
    v_and_b32 v222, 3, v222
    v_xor_b32 v222, s42, v222
    v_lshl_add_u32 v222, v222, 4, v180
    v_add_u32 v223, 62, v220
    s_waitcnt lgkmcnt(2)
    v_mfma_f32_32x32x16_bf16 v[116:131], v[100:103], v[108:111], v[116:131]
    ds_read_b128 v[84:87], v71 offset:0
    ds_read_b128 v[92:95], v79 offset:0
    v_and_b32 v223, 3, v223
    v_xor_b32 v223, s42, v223
    v_lshl_add_u32 v223, v223, 4, v180
    v_add_u32 v224, 61, v220
    s_waitcnt lgkmcnt(3)
    v_mfma_f32_32x32x16_bf16 v[132:147], v[100:103], v[112:115], v[132:147]
    ds_read_b128 v[96:99], v79 offset:4096
    ds_read_b128 v[88:91], v71 offset:4096
    v_and_b32 v224, 3, v224
    v_xor_b32 v224, s42, v224
    v_lshl_add_u32 v224, v224, 4, v180
    v_add_u32 v225, 60, v220
    s_waitcnt lgkmcnt(4)
    v_mfma_f32_32x32x16_bf16 v[148:163], v[104:107], v[108:111], v[148:163]
    v_and_b32 v225, 3, v225
    v_xor_b32 v225, s42, v225
    v_lshl_add_u32 v225, v225, 4, v180
    v_lshlrev_b32 v180, 5, v64
    v_lshl_add_u32 v180, v83, 3, v180
    v_sub_u32 v180, 504, v180
    v_mfma_f32_32x32x16_bf16 v[164:179], v[104:107], v[112:115], v[164:179]
    v_and_b32 v226, 8, v180
    v_lshrrev_b32 v180, 4, v180
    v_lshl_add_u32 v226, v180, 6, v226
    v_bfe_u32 v180, v180, 2, 2
    v_xor_b32 v180, s42, v180
    v_lshl_add_u32 v226, v180, 4, v226
    s_waitcnt lgkmcnt(2)
    v_mfma_f32_32x32x16_bf16 v[116:131], v[84:87], v[92:95], v[116:131]
    ds_read_b128 v[100:103], v72 offset:0
    ds_read_b128 v[108:111], v80 offset:0
    v_add_u32 v226, 131072, v226
    v_and_b32 v180, 1, v83
    v_lshlrev_b32 v180, 9, v180
    v_lshl_add_u32 v180, v64, 5, v180
    s_waitcnt lgkmcnt(3)
    v_mfma_f32_32x32x16_bf16 v[132:147], v[84:87], v[96:99], v[132:147]
    ds_read_b128 v[112:115], v80 offset:4096
    ds_read_b128 v[104:107], v72 offset:4096
    v_lshrrev_b32 v220, 1, v83
    v_lshl_add_u32 v227, v220, 4, v180
    s_waitcnt lgkmcnt(4)
    v_mfma_f32_32x32x16_bf16 v[148:163], v[88:91], v[92:95], v[148:163]
    v_mfma_f32_32x32x16_bf16 v[164:179], v[88:91], v[96:99], v[164:179]
    s_waitcnt lgkmcnt(0)
    s_barrier
    v_mfma_f32_32x32x16_bf16 v[116:131], v[100:103], v[108:111], v[116:131]
    ds_read_b128 v[84:87], v69 offset:32768
    ds_read_b128 v[92:95], v77 offset:32768
    s_waitcnt vmcnt(14)
    s_waitcnt vmcnt(13)
    ds_write_b128 v61, v[188:191] offset:0
    v_alignbit_b32 v198, v189, v188, 16
    v_alignbit_b32 v199, v190, v189, 16
    v_mfma_f32_32x32x16_bf16 v[132:147], v[100:103], v[112:115], v[132:147]
    ds_read_b128 v[96:99], v77 offset:36864
    ds_read_b128 v[88:91], v69 offset:36864
    v_alignbit_b32 v200, v191, v190, 16
    s_waitcnt vmcnt(12)
    v_alignbit_b32 v201, v196, v191, 16
    v_pk_mov_b32 v[202:203], v[188:189], v[190:191] op_sel:[1,0]
    v_pk_mov_b32 v[204:205], v[190:191], v[196:197] op_sel:[1,0]
    v_mfma_f32_32x32x16_bf16 v[148:163], v[104:107], v[108:111], v[148:163]
    ds_write_b128 v61, v[198:201] offset:4160
    v_pk_mov_b32 v[206:207], v[198:199], v[200:201] op_sel:[1,0]
    v_mov_b32 v208, v201
    v_alignbit_b32 v209, v197, v196, 16
    ds_write_b128 v61, v[202:205] offset:8320
    ds_write_b128 v61, v[206:209] offset:12480
    v_mfma_f32_32x32x16_bf16 v[164:179], v[104:107], v[112:115], v[164:179]
    s_waitcnt vmcnt(11)
    ds_write_b128 v61, v[34:37] offset:32
    v_alignbit_b32 v198, v35, v34, 16
    v_alignbit_b32 v199, v36, v35, 16
    v_alignbit_b32 v200, v37, v36, 16
    s_waitcnt vmcnt(10)
    v_alignbit_b32 v201, v46, v37, 16
    v_pk_mov_b32 v[202:203], v[34:35], v[36:37] op_sel:[1,0]
    s_waitcnt lgkmcnt(7)
    v_mfma_f32_32x32x16_bf16 v[116:131], v[84:87], v[92:95], v[116:131]
    ds_read_b128 v[100:103], v70 offset:32768
    ds_read_b128 v[108:111], v78 offset:32768
    v_pk_mov_b32 v[204:205], v[36:37], v[46:47] op_sel:[1,0]
    ds_write_b128 v61, v[198:201] offset:4192
    v_pk_mov_b32 v[206:207], v[198:199], v[200:201] op_sel:[1,0]
    v_mov_b32 v208, v201
    s_waitcnt lgkmcnt(8)
    v_mfma_f32_32x32x16_bf16 v[132:147], v[84:87], v[96:99], v[132:147]
    ds_read_b128 v[112:115], v78 offset:36864
    ds_read_b128 v[104:107], v70 offset:36864
    v_alignbit_b32 v209, v47, v46, 16
    ds_write_b128 v61, v[202:205] offset:8352
    ds_write_b128 v61, v[206:209] offset:12512
    s_waitcnt vmcnt(9)
    ds_write_b128 v61, v[38:41] offset:1056
    s_waitcnt lgkmcnt(12)
    v_mfma_f32_32x32x16_bf16 v[148:163], v[88:91], v[92:95], v[148:163]
    v_alignbit_b32 v198, v39, v38, 16
    v_alignbit_b32 v199, v40, v39, 16
    v_alignbit_b32 v200, v41, v40, 16
    s_waitcnt vmcnt(8)
    v_alignbit_b32 v201, v62, v41, 16
    v_pk_mov_b32 v[202:203], v[38:39], v[40:41] op_sel:[1,0]
    v_pk_mov_b32 v[204:205], v[40:41], v[62:63] op_sel:[1,0]
    v_mfma_f32_32x32x16_bf16 v[164:179], v[88:91], v[96:99], v[164:179]
    ds_write_b128 v61, v[198:201] offset:5216
    v_pk_mov_b32 v[206:207], v[198:199], v[200:201] op_sel:[1,0]
    v_mov_b32 v208, v201
    v_alignbit_b32 v209, v63, v62, 16
    ds_write_b128 v61, v[202:205] offset:9376
    ds_write_b128 v61, v[206:209] offset:13536
    s_waitcnt lgkmcnt(9)
    v_mfma_f32_32x32x16_bf16 v[116:131], v[100:103], v[108:111], v[116:131]
    ds_read_b128 v[84:87], v71 offset:32768
    ds_read_b128 v[92:95], v79 offset:32768
    s_waitcnt vmcnt(7)
    ds_write_b128 v61, v[42:45] offset:2080
    v_alignbit_b32 v198, v43, v42, 16
    v_alignbit_b32 v199, v44, v43, 16
    v_alignbit_b32 v200, v45, v44, 16
    s_waitcnt lgkmcnt(10)
    v_mfma_f32_32x32x16_bf16 v[132:147], v[100:103], v[112:115], v[132:147]
    ds_read_b128 v[96:99], v79 offset:36864
    ds_read_b128 v[88:91], v71 offset:36864
    s_waitcnt vmcnt(6)
    v_alignbit_b32 v201, v192, v45, 16
    v_pk_mov_b32 v[202:203], v[42:43], v[44:45] op_sel:[1,0]
    v_pk_mov_b32 v[204:205], v[44:45], v[192:193] op_sel:[1,0]
    ds_write_b128 v61, v[198:201] offset:6240
    s_waitcnt lgkmcnt(12)
    v_mfma_f32_32x32x16_bf16 v[148:163], v[104:107], v[108:111], v[148:163]
    v_pk_mov_b32 v[206:207], v[198:199], v[200:201] op_sel:[1,0]
    v_mov_b32 v208, v201
    v_alignbit_b32 v209, v193, v192, 16
    ds_write_b128 v61, v[202:205] offset:10400
    ds_write_b128 v61, v[206:209] offset:14560
    s_waitcnt vmcnt(5)
    ds_write_b128 v61, v[184:187] offset:3104
    v_mfma_f32_32x32x16_bf16 v[164:179], v[104:107], v[112:115], v[164:179]
    v_alignbit_b32 v198, v185, v184, 16
    v_alignbit_b32 v199, v186, v185, 16
    v_alignbit_b32 v200, v187, v186, 16
    s_waitcnt vmcnt(4)
    v_alignbit_b32 v201, v194, v187, 16
    v_pk_mov_b32 v[202:203], v[184:185], v[186:187] op_sel:[1,0]
    v_pk_mov_b32 v[204:205], v[186:187], v[194:195] op_sel:[1,0]
    s_waitcnt lgkmcnt(7)
    v_mfma_f32_32x32x16_bf16 v[116:131], v[84:87], v[92:95], v[116:131]
    ds_read_b128 v[100:103], v72 offset:32768
    ds_read_b128 v[108:111], v80 offset:32768
    ds_write_b128 v61, v[198:201] offset:7264
    v_pk_mov_b32 v[206:207], v[198:199], v[200:201] op_sel:[1,0]
    v_mov_b32 v208, v201
    v_alignbit_b32 v209, v195, v194, 16
    s_waitcnt lgkmcnt(8)
    v_mfma_f32_32x32x16_bf16 v[132:147], v[84:87], v[96:99], v[132:147]
    ds_read_b128 v[112:115], v80 offset:36864
    ds_read_b128 v[104:107], v72 offset:36864
    ds_write_b128 v61, v[202:205] offset:11424
    ds_write_b128 v61, v[206:209] offset:15584
    v_lshlrev_b32 v82, 16, v82
    s_waitcnt lgkmcnt(11)
    v_mfma_f32_32x32x16_bf16 v[148:163], v[88:91], v[92:95], v[148:163]
    v_mfma_f32_32x32x16_bf16 v[164:179], v[88:91], v[96:99], v[164:179]
    s_waitcnt lgkmcnt(2)
    v_mfma_f32_32x32x16_bf16 v[116:131], v[100:103], v[108:111], v[116:131]
    v_mfma_f32_32x32x16_bf16 v[132:147], v[100:103], v[112:115], v[132:147]
    v_mfma_f32_32x32x16_bf16 v[148:163], v[104:107], v[108:111], v[148:163]
    v_mfma_f32_32x32x16_bf16 v[164:179], v[104:107], v[112:115], v[164:179]
    s_nop 9
    v_pk_fma_f32 v[8:9], v[132:133], v[48:49], v[118:119] op_sel:[0,1,0] op_sel_hi:[1,1,1] neg_lo:[0,1,0] neg_hi:[0,1,0]
    v_pk_fma_f32 v[10:11], v[116:117], v[48:49], v[134:135] op_sel:[0,1,0] op_sel_hi:[1,1,1]
    v_pk_fma_f32 v[2:3], v[116:117], v[48:49], v[8:9] op_sel:[0,0,0] op_sel_hi:[1,0,1]
    v_pk_fma_f32 v[4:5], v[132:133], v[48:49], v[10:11] op_sel:[0,0,0] op_sel_hi:[1,0,1]
    v_pk_fma_f32 v[8:9], v[4:5], v[48:49], v[120:121] op_sel:[0,1,0] op_sel_hi:[1,1,1] neg_lo:[0,1,0] neg_hi:[0,1,0]
    v_pk_fma_f32 v[10:11], v[2:3], v[48:49], v[136:137] op_sel:[0,1,0] op_sel_hi:[1,1,1]
    v_pk_fma_f32 v[2:3], v[2:3], v[48:49], v[8:9] op_sel:[0,0,0] op_sel_hi:[1,0,1]
    v_pk_fma_f32 v[4:5], v[4:5], v[48:49], v[10:11] op_sel:[0,0,0] op_sel_hi:[1,0,1]
    v_pk_fma_f32 v[8:9], v[4:5], v[48:49], v[122:123] op_sel:[0,1,0] op_sel_hi:[1,1,1] neg_lo:[0,1,0] neg_hi:[0,1,0]
    v_pk_fma_f32 v[10:11], v[2:3], v[48:49], v[138:139] op_sel:[0,1,0] op_sel_hi:[1,1,1]
    v_pk_fma_f32 v[2:3], v[2:3], v[48:49], v[8:9] op_sel:[0,0,0] op_sel_hi:[1,0,1]
    v_pk_fma_f32 v[4:5], v[4:5], v[48:49], v[10:11] op_sel:[0,0,0] op_sel_hi:[1,0,1]
    v_pk_fma_f32 v[8:9], v[4:5], v[48:49], v[124:125] op_sel:[0,1,0] op_sel_hi:[1,1,1] neg_lo:[0,1,0] neg_hi:[0,1,0]
    v_pk_fma_f32 v[10:11], v[2:3], v[48:49], v[140:141] op_sel:[0,1,0] op_sel_hi:[1,1,1]
    v_pk_fma_f32 v[2:3], v[2:3], v[48:49], v[8:9] op_sel:[0,0,0] op_sel_hi:[1,0,1]
    v_pk_fma_f32 v[4:5], v[4:5], v[48:49], v[10:11] op_sel:[0,0,0] op_sel_hi:[1,0,1]
    v_pk_fma_f32 v[8:9], v[4:5], v[48:49], v[126:127] op_sel:[0,1,0] op_sel_hi:[1,1,1] neg_lo:[0,1,0] neg_hi:[0,1,0]
    v_pk_fma_f32 v[10:11], v[2:3], v[48:49], v[142:143] op_sel:[0,1,0] op_sel_hi:[1,1,1]
    v_pk_fma_f32 v[2:3], v[2:3], v[48:49], v[8:9] op_sel:[0,0,0] op_sel_hi:[1,0,1]
    v_pk_fma_f32 v[4:5], v[4:5], v[48:49], v[10:11] op_sel:[0,0,0] op_sel_hi:[1,0,1]
    v_pk_fma_f32 v[8:9], v[4:5], v[48:49], v[128:129] op_sel:[0,1,0] op_sel_hi:[1,1,1] neg_lo:[0,1,0] neg_hi:[0,1,0]
    v_pk_fma_f32 v[10:11], v[2:3], v[48:49], v[144:145] op_sel:[0,1,0] op_sel_hi:[1,1,1]
    v_pk_fma_f32 v[2:3], v[2:3], v[48:49], v[8:9] op_sel:[0,0,0] op_sel_hi:[1,0,1]
    v_pk_fma_f32 v[4:5], v[4:5], v[48:49], v[10:11] op_sel:[0,0,0] op_sel_hi:[1,0,1]
    v_pk_fma_f32 v[8:9], v[4:5], v[48:49], v[130:131] op_sel:[0,1,0] op_sel_hi:[1,1,1] neg_lo:[0,1,0] neg_hi:[0,1,0]
    v_pk_fma_f32 v[10:11], v[2:3], v[48:49], v[146:147] op_sel:[0,1,0] op_sel_hi:[1,1,1]
    v_pk_fma_f32 v[2:3], v[2:3], v[48:49], v[8:9] op_sel:[0,0,0] op_sel_hi:[1,0,1]
    v_pk_fma_f32 v[4:5], v[4:5], v[48:49], v[10:11] op_sel:[0,0,0] op_sel_hi:[1,0,1]
    v_pk_fma_f32 v[8:9], v[4:5], v[48:49], v[148:149] op_sel:[0,1,0] op_sel_hi:[1,1,1] neg_lo:[0,1,0] neg_hi:[0,1,0]
    v_pk_fma_f32 v[10:11], v[2:3], v[48:49], v[164:165] op_sel:[0,1,0] op_sel_hi:[1,1,1]
    v_pk_fma_f32 v[2:3], v[2:3], v[48:49], v[8:9] op_sel:[0,0,0] op_sel_hi:[1,0,1]
    v_pk_fma_f32 v[4:5], v[4:5], v[48:49], v[10:11] op_sel:[0,0,0] op_sel_hi:[1,0,1]
    v_pk_fma_f32 v[8:9], v[4:5], v[48:49], v[150:151] op_sel:[0,1,0] op_sel_hi:[1,1,1] neg_lo:[0,1,0] neg_hi:[0,1,0]
    v_pk_fma_f32 v[10:11], v[2:3], v[48:49], v[166:167] op_sel:[0,1,0] op_sel_hi:[1,1,1]
    v_pk_fma_f32 v[2:3], v[2:3], v[48:49], v[8:9] op_sel:[0,0,0] op_sel_hi:[1,0,1]
    v_pk_fma_f32 v[4:5], v[4:5], v[48:49], v[10:11] op_sel:[0,0,0] op_sel_hi:[1,0,1]
    v_pk_fma_f32 v[8:9], v[4:5], v[48:49], v[152:153] op_sel:[0,1,0] op_sel_hi:[1,1,1] neg_lo:[0,1,0] neg_hi:[0,1,0]
    v_pk_fma_f32 v[10:11], v[2:3], v[48:49], v[168:169] op_sel:[0,1,0] op_sel_hi:[1,1,1]
    v_pk_fma_f32 v[2:3], v[2:3], v[48:49], v[8:9] op_sel:[0,0,0] op_sel_hi:[1,0,1]
    v_pk_fma_f32 v[4:5], v[4:5], v[48:49], v[10:11] op_sel:[0,0,0] op_sel_hi:[1,0,1]
    v_pk_fma_f32 v[8:9], v[4:5], v[48:49], v[154:155] op_sel:[0,1,0] op_sel_hi:[1,1,1] neg_lo:[0,1,0] neg_hi:[0,1,0]
    v_pk_fma_f32 v[10:11], v[2:3], v[48:49], v[170:171] op_sel:[0,1,0] op_sel_hi:[1,1,1]
    v_pk_fma_f32 v[2:3], v[2:3], v[48:49], v[8:9] op_sel:[0,0,0] op_sel_hi:[1,0,1]
    v_pk_fma_f32 v[4:5], v[4:5], v[48:49], v[10:11] op_sel:[0,0,0] op_sel_hi:[1,0,1]
    v_pk_fma_f32 v[8:9], v[4:5], v[48:49], v[156:157] op_sel:[0,1,0] op_sel_hi:[1,1,1] neg_lo:[0,1,0] neg_hi:[0,1,0]
    v_pk_fma_f32 v[10:11], v[2:3], v[48:49], v[172:173] op_sel:[0,1,0] op_sel_hi:[1,1,1]
    v_pk_fma_f32 v[2:3], v[2:3], v[48:49], v[8:9] op_sel:[0,0,0] op_sel_hi:[1,0,1]
    v_pk_fma_f32 v[4:5], v[4:5], v[48:49], v[10:11] op_sel:[0,0,0] op_sel_hi:[1,0,1]
    v_pk_fma_f32 v[8:9], v[4:5], v[48:49], v[158:159] op_sel:[0,1,0] op_sel_hi:[1,1,1] neg_lo:[0,1,0] neg_hi:[0,1,0]
    v_pk_fma_f32 v[10:11], v[2:3], v[48:49], v[174:175] op_sel:[0,1,0] op_sel_hi:[1,1,1]
    v_pk_fma_f32 v[2:3], v[2:3], v[48:49], v[8:9] op_sel:[0,0,0] op_sel_hi:[1,0,1]
    v_pk_fma_f32 v[4:5], v[4:5], v[48:49], v[10:11] op_sel:[0,0,0] op_sel_hi:[1,0,1]
    v_pk_fma_f32 v[8:9], v[4:5], v[48:49], v[160:161] op_sel:[0,1,0] op_sel_hi:[1,1,1] neg_lo:[0,1,0] neg_hi:[0,1,0]
    v_pk_fma_f32 v[10:11], v[2:3], v[48:49], v[176:177] op_sel:[0,1,0] op_sel_hi:[1,1,1]
    v_pk_fma_f32 v[2:3], v[2:3], v[48:49], v[8:9] op_sel:[0,0,0] op_sel_hi:[1,0,1]
    v_pk_fma_f32 v[4:5], v[4:5], v[48:49], v[10:11] op_sel:[0,0,0] op_sel_hi:[1,0,1]
    v_pk_fma_f32 v[8:9], v[4:5], v[48:49], v[162:163] op_sel:[0,1,0] op_sel_hi:[1,1,1] neg_lo:[0,1,0] neg_hi:[0,1,0]
    v_pk_fma_f32 v[10:11], v[2:3], v[48:49], v[178:179] op_sel:[0,1,0] op_sel_hi:[1,1,1]
    v_pk_fma_f32 v[2:3], v[2:3], v[48:49], v[8:9] op_sel:[0,0,0] op_sel_hi:[1,0,1]
    v_pk_fma_f32 v[4:5], v[4:5], v[48:49], v[10:11] op_sel:[0,0,0] op_sel_hi:[1,0,1]
    v_lshrrev_b32 v13, 5, v1
    v_lshlrev_b32 v13, 10, v13
    v_lshl_add_u32 v12, v7, 2, v13
    s_lshr_b32 s3, s42, 1
    s_lshl_b32 s3, s3, 11
    s_add_u32 s3, s3, 149504
    v_add_u32 v12, s3, v12
    ds_write2st64_b32 v12, v2, v4 offset0:12 offset1:13
    ds_write2st64_b32 v12, v3, v5 offset0:14 offset1:15
    s_waitcnt lgkmcnt(0)
    s_barrier
    ds_read2st64_b32 v[14:15], v12 offset0:0 offset1:1
    ds_read2st64_b32 v[16:17], v12 offset0:2 offset1:3
    ds_read2st64_b32 v[18:19], v12 offset0:4 offset1:5
    ds_read2st64_b32 v[20:21], v12 offset0:6 offset1:7
    ds_read2st64_b32 v[22:23], v12 offset0:8 offset1:9
    ds_read2st64_b32 v[24:25], v12 offset0:10 offset1:11
    s_waitcnt lgkmcnt(4)
    v_fma_f32 v30, -v53, v15, v16
    v_fma_f32 v31, v53, v14, v17
    v_fma_f32 v16, v52, v14, v30
    v_fma_f32 v17, v52, v15, v31
    s_waitcnt lgkmcnt(3)
    v_fma_f32 v30, -v53, v17, v18
    v_fma_f32 v31, v53, v16, v19
    v_fma_f32 v18, v52, v16, v30
    v_fma_f32 v19, v52, v17, v31
    s_waitcnt lgkmcnt(2)
    v_fma_f32 v30, -v53, v19, v20
    v_fma_f32 v31, v53, v18, v21
    v_fma_f32 v20, v52, v18, v30
    v_fma_f32 v21, v52, v19, v31
    s_waitcnt lgkmcnt(1)
    v_fma_f32 v30, -v53, v21, v22
    v_fma_f32 v31, v53, v20, v23
    v_fma_f32 v22, v52, v20, v30
    v_fma_f32 v23, v52, v21, v31
    s_waitcnt lgkmcnt(0)
    v_fma_f32 v30, -v53, v23, v24
    v_fma_f32 v31, v53, v22, v25
    v_fma_f32 v24, v52, v22, v30
    v_fma_f32 v25, v52, v23, v31
    v_fma_f32 v30, -v53, v25, v2
    v_fma_f32 v31, v53, v24, v4
    v_fma_f32 v28, v52, v24, v30
    v_fma_f32 v29, v52, v25, v31
    v_fma_f32 v30, -v53, v29, v3
    v_fma_f32 v31, v53, v28, v5
    v_fma_f32 v32, v52, v28, v30
    v_fma_f32 v33, v52, v29, v31
    v_mov_b32 v34, v24
    v_mov_b32 v35, v28
    v_mov_b32 v36, v25
    v_mov_b32 v37, v29
    s_lshl_b32 s3, s44, 14
    s_add_u32 s3, s3, 21037056
    s_add_u32 s28, s40, s3
    s_addc_u32 s29, s41, 0
    s_mov_b32 s30, 16384
    s_mov_b32 s31, 131072
    v_lshlrev_b32 v2, 4, v7
    s_lshl_b32 s4, s43, 10
    s_lshr_b32 s3, s42, 1
    s_cmp_eq_u32 s3, 0
    s_cbranch_scc1 Lnopub_gate_6
    v_mov_b32 v12, v32
    v_mov_b32 v13, v33
    v_mov_b32 v14, s22
    v_mov_b32 v15, s23
    s_mov_b64 s[6:7], exec
    s_mov_b64 exec, s[34:35]
    buffer_store_dwordx4 v[12:15], v2, s[28:31], s4 offen sc0 sc1
    s_mov_b64 exec, s[6:7]
    s_nop 1
Lnopub_gate_6:
    ds_read_b64 v[74:75], v221 offset:448
    ds_read_b64 v[76:77], v221 offset:456
    ds_read_b128 v[184:187], v222 offset:16128
    ds_read_b64 v[188:189], v221 offset:960
    ds_read_b64 v[190:191], v221 offset:968
    ds_read_b128 v[192:195], v222 offset:14080
    ds_read_b64 v[196:197], v221 offset:1472
    ds_read_b64 v[198:199], v221 offset:1480
    ds_read_b128 v[200:203], v222 offset:12032
    s_waitcnt lgkmcnt(6)
    v_mfma_f32_16x16x32_bf16 v[20:23], v[74:77], v[184:187], 0
    v_lshrrev_b32 v12, 5, v1
    v_lshlrev_b32 v12, 10, v12
    s_waitcnt lgkmcnt(4)
    v_mfma_f32_16x16x32_bf16 v[24:27], v[188:191], v[184:187], 0
    v_sub_u32 v12, v2, v12
    s_sub_u32 s3, s4, 1024
    v_add_u32 v3, s3, v12
    s_waitcnt lgkmcnt(3)
    v_mfma_f32_16x16x32_bf16 v[24:27], v[74:77], v[192:195], v[24:27]
    ds_read_b64 v[204:205], v221 offset:1984
    ds_read_b64 v[206:207], v221 offset:1992
    v_mul_f32 v4, v55, v55
    v_mfma_f32_16x16x32_bf16 v[28:31], v[188:191], v[192:195], 0
    ds_read_b128 v[208:211], v222 offset:9984
    v_fma_f32 v4, v54, v54, -v4
    s_waitcnt lgkmcnt(4)
    v_mfma_f32_16x16x32_bf16 v[28:31], v[196:199], v[184:187], v[28:31]
    v_mul_f32 v5, v54, v55
    v_add_f32 v5, v5, v5
    s_waitcnt lgkmcnt(3)
    v_mfma_f32_16x16x32_bf16 v[28:31], v[74:77], v[200:203], v[28:31]
    v_lshrrev_b32 v12, 5, v1
    v_sub_u32 v12, s43, v12
    v_mfma_f32_16x16x32_bf16 v[38:41], v[196:199], v[192:195], 0
    v_add_u32 v12, 1, v12
    v_lshrrev_b32 v13, 1, v12
    v_mfma_f32_16x16x32_bf16 v[38:41], v[188:191], v[200:203], v[38:41]
    s_waitcnt vmcnt(0)
    v_mov_b32 v182, s22
    v_mov_b32 v183, s23
    s_mov_b64 s[32:33], exec
    s_mov_b64 exec, 1
    buffer_store_dwordx2 v[182:183], v6, s[8:11], s12 offen sc0 sc1
    s_mov_b64 exec, s[32:33]
    v_mfma_f32_16x16x32_bf16 v[42:45], v[196:199], v[200:203], 0
    v_mul_f32 v8, v51, v132
    v_mul_f32 v10, v51, v116
    s_waitcnt lgkmcnt(1)
    v_mfma_f32_16x16x32_bf16 v[38:41], v[204:207], v[184:187], v[38:41]
    ds_read_b64 v[212:213], v221 offset:2496
    ds_read_b64 v[214:215], v221 offset:2504
    v_mul_f32 v9, v51, v133
    s_waitcnt lgkmcnt(2)
    v_mfma_f32_16x16x32_bf16 v[38:41], v[74:77], v[208:211], v[38:41]
    ds_read_b128 v[216:219], v222 offset:7936
    v_mul_f32 v11, v51, v117
    v_mfma_f32_16x16x32_bf16 v[42:45], v[204:207], v[192:195], v[42:45]
    v_fma_f32 v116, v50, v116, -v8
    v_fma_f32 v132, v50, v132, v10
    v_mfma_f32_16x16x32_bf16 v[42:45], v[188:191], v[208:211], v[42:45]
    v_fma_f32 v117, v50, v117, -v9
    v_fma_f32 v133, v50, v133, v11
    v_mfma_f32_16x16x32_bf16 v[62:65], v[204:207], v[200:203], 0
    v_mul_f32 v8, v51, v134
    v_mul_f32 v10, v51, v118
    v_mfma_f32_16x16x32_bf16 v[62:65], v[196:199], v[208:211], v[62:65]
    v_mul_f32 v9, v51, v135
    v_mul_f32 v11, v51, v119
    v_mfma_f32_16x16x32_bf16 v[66:69], v[204:207], v[208:211], 0
    v_fma_f32 v118, v50, v118, -v8
    v_fma_f32 v134, v50, v134, v10
    s_waitcnt lgkmcnt(1)
    v_mfma_f32_16x16x32_bf16 v[42:45], v[212:215], v[184:187], v[42:45]
    v_fma_f32 v119, v50, v119, -v9
    v_fma_f32 v135, v50, v135, v11
    s_waitcnt lgkmcnt(0)
    v_mfma_f32_16x16x32_bf16 v[42:45], v[74:77], v[216:219], v[42:45]
    ds_read_b64 v[228:229], v221 offset:3008
    ds_read_b64 v[230:231], v221 offset:3016
    v_mul_f32 v8, v51, v136
    v_mfma_f32_16x16x32_bf16 v[62:65], v[212:215], v[192:195], v[62:65]
    ds_read_b128 v[232:235], v222 offset:5888
    v_mul_f32 v10, v51, v120
    v_mfma_f32_16x16x32_bf16 v[62:65], v[188:191], v[216:219], v[62:65]
    v_mul_f32 v9, v51, v137
    v_mul_f32 v11, v51, v121
    v_mfma_f32_16x16x32_bf16 v[66:69], v[212:215], v[200:203], v[66:69]
    v_fma_f32 v120, v50, v120, -v8
    v_fma_f32 v136, v50, v136, v10
    v_mfma_f32_16x16x32_bf16 v[66:69], v[196:199], v[216:219], v[66:69]
    v_fma_f32 v121, v50, v121, -v9
    v_fma_f32 v137, v50, v137, v11
    v_mfma_f32_16x16x32_bf16 v[70:73], v[212:215], v[208:211], 0
    v_mul_f32 v8, v51, v138
    v_mul_f32 v10, v51, v122
    v_mfma_f32_16x16x32_bf16 v[70:73], v[204:207], v[216:219], v[70:73]
    ds_read_b64 v[236:237], v221 offset:3520
    ds_read_b64 v[238:239], v221 offset:3528
    v_mul_f32 v9, v51, v139
    s_waitcnt lgkmcnt(3)
    v_mfma_f32_16x16x32_bf16 v[62:65], v[228:231], v[184:187], v[62:65]
    ds_read_b128 v[212:215], v222 offset:3840
    v_mul_f32 v11, v51, v123
    s_waitcnt lgkmcnt(3)
    v_mfma_f32_16x16x32_bf16 v[62:65], v[74:77], v[232:235], v[62:65]
    v_fma_f32 v122, v50, v122, -v8
    v_fma_f32 v138, v50, v138, v10
    v_mfma_f32_16x16x32_bf16 v[66:69], v[228:231], v[192:195], v[66:69]
    v_fma_f32 v123, v50, v123, -v9
    v_fma_f32 v139, v50, v139, v11
    v_mfma_f32_16x16x32_bf16 v[66:69], v[188:191], v[232:235], v[66:69]
    ds_read_b64 v[208:209], v221 offset:4032
    ds_read_b64 v[210:211], v221 offset:4040
    v_mul_f32 v8, v51, v140
    v_mfma_f32_16x16x32_bf16 v[70:73], v[228:231], v[200:203], v[70:73]
    ds_read_b128 v[204:207], v222 offset:1792
    v_mul_f32 v10, v51, v124
    v_mfma_f32_16x16x32_bf16 v[70:73], v[196:199], v[232:235], v[70:73]
    ds_read_b64 v[216:217], v221 offset:384
    ds_read_b64 v[218:219], v221 offset:392
    v_mul_f32 v9, v51, v141
    s_waitcnt lgkmcnt(6)
    v_mfma_f32_16x16x32_bf16 v[66:69], v[236:239], v[184:187], v[66:69]
    ds_read_b128 v[228:231], v223 offset:15872
    v_mul_f32 v11, v51, v125
    s_waitcnt lgkmcnt(6)
    v_mfma_f32_16x16x32_bf16 v[66:69], v[74:77], v[212:215], v[66:69]
    ds_read_b64 v[200:201], v221 offset:896
    ds_read_b64 v[202:203], v221 offset:904
    v_fma_f32 v124, v50, v124, -v8
    v_mfma_f32_16x16x32_bf16 v[70:73], v[236:239], v[192:195], v[70:73]
    ds_read_b128 v[196:199], v223 offset:13824
    v_fma_f32 v140, v50, v140, v10
    v_mfma_f32_16x16x32_bf16 v[70:73], v[188:191], v[212:215], v[70:73]
    ds_read_b64 v[232:233], v221 offset:1408
    ds_read_b64 v[234:235], v221 offset:1416
    v_fma_f32 v125, v50, v125, -v9
    s_waitcnt lgkmcnt(9)
    v_mfma_f32_16x16x32_bf16 v[70:73], v[208:211], v[184:187], v[70:73]
    ds_read_b128 v[236:239], v223 offset:11776
    v_fma_f32 v141, v50, v141, v11
    s_waitcnt lgkmcnt(9)
    v_mfma_f32_16x16x32_bf16 v[70:73], v[74:77], v[204:207], v[70:73]
    v_mul_f32 v8, v51, v142
    v_mul_f32 v10, v51, v126
    s_waitcnt lgkmcnt(6)
    v_mfma_f32_16x16x32_bf16 v[20:23], v[216:219], v[228:231], v[20:23]
    v_mul_f32 v9, v51, v143
    v_mul_f32 v11, v51, v127
    s_waitcnt lgkmcnt(4)
    v_mfma_f32_16x16x32_bf16 v[24:27], v[200:203], v[228:231], v[24:27]
    v_fma_f32 v126, v50, v126, -v8
    v_fma_f32 v142, v50, v142, v10
    s_waitcnt lgkmcnt(3)
    v_mfma_f32_16x16x32_bf16 v[24:27], v[216:219], v[196:199], v[24:27]
    ds_read_b64 v[192:193], v221 offset:1920
    ds_read_b64 v[194:195], v221 offset:1928
    v_fma_f32 v127, v50, v127, -v9
    v_mfma_f32_16x16x32_bf16 v[28:31], v[200:203], v[196:199], v[28:31]
    ds_read_b128 v[188:191], v223 offset:9728
    v_fma_f32 v143, v50, v143, v11
    s_waitcnt lgkmcnt(4)
    v_mfma_f32_16x16x32_bf16 v[28:31], v[232:235], v[228:231], v[28:31]
    v_mul_f32 v8, v51, v144
    v_mul_f32 v10, v51, v128
    s_waitcnt lgkmcnt(3)
    v_mfma_f32_16x16x32_bf16 v[28:31], v[216:219], v[236:239], v[28:31]
    v_mul_f32 v9, v51, v145
    v_mul_f32 v11, v51, v129
    v_mfma_f32_16x16x32_bf16 v[38:41], v[232:235], v[196:199], v[38:41]
    v_fma_f32 v128, v50, v128, -v8
    v_fma_f32 v144, v50, v144, v10
    v_mfma_f32_16x16x32_bf16 v[38:41], v[200:203], v[236:239], v[38:41]
    v_fma_f32 v129, v50, v129, -v9
    v_fma_f32 v145, v50, v145, v11
    v_mfma_f32_16x16x32_bf16 v[42:45], v[232:235], v[236:239], v[42:45]
    v_mul_f32 v8, v51, v146
    v_mul_f32 v10, v51, v130
    s_waitcnt lgkmcnt(1)
    v_mfma_f32_16x16x32_bf16 v[38:41], v[192:195], v[228:231], v[38:41]
    ds_read_b64 v[212:213], v221 offset:2432
    ds_read_b64 v[214:215], v221 offset:2440
    v_mul_f32 v9, v51, v147
    s_waitcnt lgkmcnt(2)
    v_mfma_f32_16x16x32_bf16 v[38:41], v[216:219], v[188:191], v[38:41]
    ds_read_b128 v[208:211], v223 offset:7680
    v_mul_f32 v11, v51, v131
    v_mfma_f32_16x16x32_bf16 v[42:45], v[192:195], v[196:199], v[42:45]
    v_fma_f32 v130, v50, v130, -v8
    v_fma_f32 v146, v50, v146, v10
    v_mfma_f32_16x16x32_bf16 v[42:45], v[200:203], v[188:191], v[42:45]
    v_fma_f32 v131, v50, v131, -v9
    v_fma_f32 v147, v50, v147, v11
    v_mfma_f32_16x16x32_bf16 v[62:65], v[192:195], v[236:239], v[62:65]
    v_subrev_u32 v84, 0, v3
    v_min_u32 v84, 0x7fff0000, v84
    v_mfma_f32_16x16x32_bf16 v[62:65], v[232:235], v[188:191], v[62:65]
    buffer_load_dwordx4 v[84:87], v84, s[28:31], 0 offen sc0 sc1
    v_subrev_u32 v88, 2048, v3
    v_mfma_f32_16x16x32_bf16 v[66:69], v[192:195], v[188:191], v[66:69]
    v_min_u32 v88, 0x7fff0000, v88
    buffer_load_dwordx4 v[88:91], v88, s[28:31], 0 offen sc0 sc1
    s_waitcnt lgkmcnt(1)
    v_mfma_f32_16x16x32_bf16 v[42:45], v[212:215], v[228:231], v[42:45]
    v_subrev_u32 v92, 4096, v3
    v_min_u32 v92, 0x7fff0000, v92
    s_waitcnt lgkmcnt(0)
    v_mfma_f32_16x16x32_bf16 v[42:45], v[216:219], v[208:211], v[42:45]
    ds_read_b64 v[184:185], v221 offset:2944
    ds_read_b64 v[186:187], v221 offset:2952
    buffer_load_dwordx4 v[92:95], v92, s[28:31], 0 offen sc0 sc1
    v_mfma_f32_16x16x32_bf16 v[62:65], v[212:215], v[196:199], v[62:65]
    ds_read_b128 v[74:77], v223 offset:5632
    v_subrev_u32 v96, 6144, v3
    v_mfma_f32_16x16x32_bf16 v[62:65], v[200:203], v[208:211], v[62:65]
    v_min_u32 v96, 0x7fff0000, v96
    buffer_load_dwordx4 v[96:99], v96, s[28:31], 0 offen sc0 sc1
    v_mfma_f32_16x16x32_bf16 v[66:69], v[212:215], v[236:239], v[66:69]
    v_subrev_u32 v100, 8192, v3
    v_min_u32 v100, 0x7fff0000, v100
    v_mfma_f32_16x16x32_bf16 v[66:69], v[232:235], v[208:211], v[66:69]
    buffer_load_dwordx4 v[100:103], v100, s[28:31], 0 offen sc0 sc1
    v_subrev_u32 v104, 10240, v3
    v_mfma_f32_16x16x32_bf16 v[70:73], v[212:215], v[188:191], v[70:73]
    v_min_u32 v104, 0x7fff0000, v104
    buffer_load_dwordx4 v[104:107], v104, s[28:31], 0 offen sc0 sc1
    v_mfma_f32_16x16x32_bf16 v[70:73], v[192:195], v[208:211], v[70:73]
    ds_read_b64 v[204:205], v221 offset:3456
    ds_read_b64 v[206:207], v221 offset:3464
    v_subrev_u32 v108, 12288, v3
    s_waitcnt lgkmcnt(3)
    v_mfma_f32_16x16x32_bf16 v[62:65], v[184:187], v[228:231], v[62:65]
    ds_read_b128 v[212:215], v223 offset:3584
    v_min_u32 v108, 0x7fff0000, v108
    s_waitcnt lgkmcnt(3)
    v_mfma_f32_16x16x32_bf16 v[62:65], v[216:219], v[74:77], v[62:65]
    buffer_load_dwordx4 v[108:111], v108, s[28:31], 0 offen sc0 sc1
    v_subrev_u32 v112, 14336, v3
    v_mfma_f32_16x16x32_bf16 v[66:69], v[184:187], v[196:199], v[66:69]
    v_min_u32 v112, 0x7fff0000, v112
    buffer_load_dwordx4 v[112:115], v112, s[28:31], 0 offen sc0 sc1
    v_mfma_f32_16x16x32_bf16 v[66:69], v[200:203], v[74:77], v[66:69]
    ds_read_b64 v[188:189], v221 offset:3968
    ds_read_b64 v[190:191], v221 offset:3976
    s_lshl_b32 s3, s44, 2
    v_mfma_f32_16x16x32_bf16 v[70:73], v[184:187], v[236:239], v[70:73]
    ds_read_b128 v[192:195], v223 offset:1536
    s_add_u32 s3, s3, s42
    v_mfma_f32_16x16x32_bf16 v[70:73], v[232:235], v[74:77], v[70:73]
    ds_read_b64 v[208:209], v221 offset:320
    ds_read_b64 v[210:211], v221 offset:328
    s_lshl_b32 s3, s3, 7
    s_waitcnt lgkmcnt(6)
    v_mfma_f32_16x16x32_bf16 v[66:69], v[204:207], v[228:231], v[66:69]
    ds_read_b128 v[184:187], v224 offset:15616
    s_add_u32 s3, s3, 21504000
    s_waitcnt lgkmcnt(6)
    v_mfma_f32_16x16x32_bf16 v[66:69], v[216:219], v[212:215], v[66:69]
    ds_read_b64 v[236:237], v221 offset:832
    ds_read_b64 v[238:239], v221 offset:840
    v_and_b32 v81, 15, v1
    v_mfma_f32_16x16x32_bf16 v[70:73], v[204:207], v[196:199], v[70:73]
    ds_read_b128 v[232:235], v224 offset:13568
    v_lshlrev_b32 v81, 3, v81
    v_mfma_f32_16x16x32_bf16 v[70:73], v[200:203], v[212:215], v[70:73]
    ds_read_b64 v[74:75], v221 offset:1344
    ds_read_b64 v[76:77], v221 offset:1352
    v_add_u32 v81, s3, v81
    s_waitcnt lgkmcnt(9)
    v_mfma_f32_16x16x32_bf16 v[70:73], v[188:191], v[228:231], v[70:73]
    ds_read_b128 v[204:207], v224 offset:11520
    buffer_load_dwordx2 v[182:183], v81, s[8:11], 0 offen sc0 sc1
    s_waitcnt lgkmcnt(9)
    v_mfma_f32_16x16x32_bf16 v[70:73], v[216:219], v[192:195], v[70:73]
    v_mul_f32 v8, v51, v164
    v_mul_f32 v10, v51, v148
    s_waitcnt lgkmcnt(6)
    v_mfma_f32_16x16x32_bf16 v[20:23], v[208:211], v[184:187], v[20:23]
    v_mul_f32 v9, v51, v165
    v_mul_f32 v11, v51, v149
    s_waitcnt lgkmcnt(4)
    v_mfma_f32_16x16x32_bf16 v[24:27], v[236:239], v[184:187], v[24:27]
    v_fma_f32 v148, v50, v148, -v8
    v_fma_f32 v164, v50, v164, v10
    s_waitcnt lgkmcnt(3)
    v_mfma_f32_16x16x32_bf16 v[24:27], v[208:211], v[232:235], v[24:27]
    ds_read_b64 v[196:197], v221 offset:1856
    ds_read_b64 v[198:199], v221 offset:1864
    v_fma_f32 v149, v50, v149, -v9
    v_mfma_f32_16x16x32_bf16 v[28:31], v[236:239], v[232:235], v[28:31]
    ds_read_b128 v[200:203], v224 offset:9472
    v_fma_f32 v165, v50, v165, v11
    s_waitcnt lgkmcnt(4)
    v_mfma_f32_16x16x32_bf16 v[28:31], v[74:77], v[184:187], v[28:31]
    v_mul_f32 v8, v51, v166
    v_mul_f32 v10, v51, v150
    s_waitcnt lgkmcnt(3)
    v_mfma_f32_16x16x32_bf16 v[28:31], v[208:211], v[204:207], v[28:31]
    v_mul_f32 v9, v51, v167
    v_mul_f32 v11, v51, v151
    v_mfma_f32_16x16x32_bf16 v[38:41], v[74:77], v[232:235], v[38:41]
    v_fma_f32 v150, v50, v150, -v8
    v_fma_f32 v166, v50, v166, v10
    v_mfma_f32_16x16x32_bf16 v[38:41], v[236:239], v[204:207], v[38:41]
    v_fma_f32 v151, v50, v151, -v9
    v_fma_f32 v167, v50, v167, v11
    v_mfma_f32_16x16x32_bf16 v[42:45], v[74:77], v[204:207], v[42:45]
    v_mul_f32 v8, v51, v168
    v_mul_f32 v10, v51, v152
    s_waitcnt lgkmcnt(1)
    v_mfma_f32_16x16x32_bf16 v[38:41], v[196:199], v[184:187], v[38:41]
    ds_read_b64 v[212:213], v221 offset:2368
    ds_read_b64 v[214:215], v221 offset:2376
    v_mul_f32 v9, v51, v169
    s_waitcnt lgkmcnt(2)
    v_mfma_f32_16x16x32_bf16 v[38:41], v[208:211], v[200:203], v[38:41]
    ds_read_b128 v[188:191], v224 offset:7424
    v_mul_f32 v11, v51, v153
    v_mfma_f32_16x16x32_bf16 v[42:45], v[196:199], v[232:235], v[42:45]
    v_fma_f32 v152, v50, v152, -v8
    v_fma_f32 v168, v50, v168, v10
    v_mfma_f32_16x16x32_bf16 v[42:45], v[236:239], v[200:203], v[42:45]
    v_fma_f32 v153, v50, v153, -v9
    v_fma_f32 v169, v50, v169, v11
    v_mfma_f32_16x16x32_bf16 v[62:65], v[196:199], v[204:207], v[62:65]
    v_mul_f32 v8, v51, v170
    v_mul_f32 v10, v51, v154
    v_mfma_f32_16x16x32_bf16 v[62:65], v[74:77], v[200:203], v[62:65]
    v_mul_f32 v9, v51, v171
    v_mul_f32 v11, v51, v155
    v_mfma_f32_16x16x32_bf16 v[66:69], v[196:199], v[200:203], v[66:69]
    v_fma_f32 v154, v50, v154, -v8
    v_fma_f32 v170, v50, v170, v10
    s_waitcnt lgkmcnt(1)
    v_mfma_f32_16x16x32_bf16 v[42:45], v[212:215], v[184:187], v[42:45]
    v_fma_f32 v155, v50, v155, -v9
    v_fma_f32 v171, v50, v171, v11
    s_waitcnt lgkmcnt(0)
    v_mfma_f32_16x16x32_bf16 v[42:45], v[208:211], v[188:191], v[42:45]
    ds_read_b64 v[228:229], v221 offset:2880
    ds_read_b64 v[230:231], v221 offset:2888
    v_mul_f32 v8, v51, v172
    v_mfma_f32_16x16x32_bf16 v[62:65], v[212:215], v[232:235], v[62:65]
    ds_read_b128 v[216:219], v224 offset:5376
    v_mul_f32 v10, v51, v156
    v_mfma_f32_16x16x32_bf16 v[62:65], v[236:239], v[188:191], v[62:65]
    v_mul_f32 v9, v51, v173
    v_mul_f32 v11, v51, v157
    v_mfma_f32_16x16x32_bf16 v[66:69], v[212:215], v[204:207], v[66:69]
    v_fma_f32 v156, v50, v156, -v8
    v_fma_f32 v172, v50, v172, v10
    v_mfma_f32_16x16x32_bf16 v[66:69], v[74:77], v[188:191], v[66:69]
    v_fma_f32 v157, v50, v157, -v9
    v_fma_f32 v173, v50, v173, v11
    v_mfma_f32_16x16x32_bf16 v[70:73], v[212:215], v[200:203], v[70:73]
    v_mul_f32 v8, v51, v174
    v_mul_f32 v10, v51, v158
    v_mfma_f32_16x16x32_bf16 v[70:73], v[196:199], v[188:191], v[70:73]
    ds_read_b64 v[192:193], v221 offset:3392
    ds_read_b64 v[194:195], v221 offset:3400
    v_mul_f32 v9, v51, v175
    s_waitcnt lgkmcnt(3)
    v_mfma_f32_16x16x32_bf16 v[62:65], v[228:231], v[184:187], v[62:65]
    ds_read_b128 v[212:215], v224 offset:3328
    v_mul_f32 v11, v51, v159
    s_waitcnt lgkmcnt(3)
    v_mfma_f32_16x16x32_bf16 v[62:65], v[208:211], v[216:219], v[62:65]
    v_fma_f32 v158, v50, v158, -v8
    v_fma_f32 v174, v50, v174, v10
    v_mfma_f32_16x16x32_bf16 v[66:69], v[228:231], v[232:235], v[66:69]
    v_fma_f32 v159, v50, v159, -v9
    v_fma_f32 v175, v50, v175, v11
    v_mfma_f32_16x16x32_bf16 v[66:69], v[236:239], v[216:219], v[66:69]
    ds_read_b64 v[200:201], v221 offset:3904
    ds_read_b64 v[202:203], v221 offset:3912
    v_mul_f32 v8, v51, v176
    v_mfma_f32_16x16x32_bf16 v[70:73], v[228:231], v[204:207], v[70:73]
    ds_read_b128 v[196:199], v224 offset:1280
    v_mul_f32 v10, v51, v160
    v_mfma_f32_16x16x32_bf16 v[70:73], v[74:77], v[216:219], v[70:73]
    v_mul_f32 v9, v51, v177
    v_mul_f32 v11, v51, v161
    s_waitcnt lgkmcnt(4)
    v_mfma_f32_16x16x32_bf16 v[66:69], v[192:195], v[184:187], v[66:69]
    v_fma_f32 v160, v50, v160, -v8
    v_fma_f32 v176, v50, v176, v10
    s_waitcnt lgkmcnt(3)
    v_mfma_f32_16x16x32_bf16 v[66:69], v[208:211], v[212:215], v[66:69]
    v_fma_f32 v161, v50, v161, -v9
    v_fma_f32 v177, v50, v177, v11
    v_mfma_f32_16x16x32_bf16 v[70:73], v[192:195], v[232:235], v[70:73]
    v_mul_f32 v8, v51, v178
    v_mul_f32 v10, v51, v162
    v_mfma_f32_16x16x32_bf16 v[70:73], v[236:239], v[212:215], v[70:73]
    v_mul_f32 v9, v51, v179
    v_mul_f32 v11, v51, v163
    s_waitcnt lgkmcnt(1)
    v_mfma_f32_16x16x32_bf16 v[70:73], v[200:203], v[184:187], v[70:73]
    v_fma_f32 v162, v50, v162, -v8
    v_fma_f32 v178, v50, v178, v10
    s_waitcnt lgkmcnt(0)
    v_mfma_f32_16x16x32_bf16 v[70:73], v[208:211], v[196:199], v[70:73]
    v_fma_f32 v163, v50, v163, -v9
    v_fma_f32 v179, v50, v179, v11
    s_lshr_b32 s7, s42, 1
    v_lshrrev_b32 v17, 5, v1
    v_lshlrev_b32 v17, 13, v17
    v_lshl_add_u32 v14, v7, 2, v17
    s_lshl_b32 s3, s7, 14
    s_add_u32 s3, s3, 98304
    v_add_u32 v14, s3, v14
    v_lshrrev_b32 v17, 4, v1
    v_lshlrev_b32 v17, 4, v17
    v_bfe_u32 v18, v1, 3, 1
    v_add_u32 v17, v17, v18
    v_and_b32 v16, 7, v1
    v_xor_b32 v18, v18, v16
    s_and_b32 s3, s42, 1
    s_lshl_b32 s3, s3, 3
    v_or_b32 v18, s3, v18
    v_lshlrev_b32 v18, 4, v18
    v_lshl_add_u32 v15, v17, 8, v18
    s_lshl_b32 s3, s7, 14
    s_add_u32 s3, s3, 98304
    v_add_u32 v15, s3, v15
    v_lshlrev_b32 v16, 4, v16
    v_lshl_add_u32 v16, v17, 12, v16
    s_lshl_b32 s6, s43, 19
    s_lshl_b32 s3, s7, 18
    s_add_u32 s6, s6, s3
    s_lshl_b32 s3, s44, 8
    s_add_u32 s6, s6, s3
    s_and_b32 s3, s42, 1
    s_lshl_b32 s3, s3, 7
    s_add_u32 s6, s6, s3
    s_lshl_b32 s3, s44, 2
    s_add_u32 s3, s3, s42
    s_lshl_b32 s14, s3, 16
    s_add_u32 s14, s14, 16777216
    s_lshl_b32 s15, s44, 12
    s_mov_b32 s7, 0
    v_mov_b32 v12, 0
    s_waitcnt vmcnt(8)
    v_cmp_eq_u64 s[46:47], s[22:23], v[86:87]
    s_waitcnt vmcnt(7)
    v_cmp_eq_u64 s[48:49], s[22:23], v[90:91]
    s_waitcnt vmcnt(6)
    v_cmp_eq_u64 s[50:51], s[22:23], v[94:95]
    s_waitcnt vmcnt(5)
    v_cmp_eq_u64 s[52:53], s[22:23], v[98:99]
    v_addc_co_u32 v12, vcc, 0, v12, s[46:47]
    v_addc_co_u32 v12, vcc, 0, v12, s[48:49]
    v_addc_co_u32 v12, vcc, 0, v12, s[50:51]
    v_addc_co_u32 v12, vcc, 0, v12, s[52:53]
    s_waitcnt vmcnt(4)
    v_cmp_eq_u64 s[46:47], s[22:23], v[102:103]
    s_waitcnt vmcnt(3)
    v_cmp_eq_u64 s[48:49], s[22:23], v[106:107]
    s_waitcnt vmcnt(2)
    v_cmp_eq_u64 s[50:51], s[22:23], v[110:111]
    s_waitcnt vmcnt(1)
    v_cmp_eq_u64 s[52:53], s[22:23], v[114:115]
    v_addc_co_u32 v12, vcc, 0, v12, s[46:47]
    v_addc_co_u32 v12, vcc, 0, v12, s[48:49]
    v_addc_co_u32 v12, vcc, 0, v12, s[50:51]
    v_addc_co_u32 v12, vcc, 0, v12, s[52:53]
    v_cmp_ne_u32 vcc, v13, v12
    s_nop 4
    s_cbranch_vccz Lpolldone_gate_7
Lpoll_gate_8:
    v_subrev_u32 v84, 0, v3
    v_min_u32 v84, 0x7fff0000, v84
    buffer_load_dwordx4 v[84:87], v84, s[28:31], 0 offen sc0 sc1
    v_subrev_u32 v88, 2048, v3
    v_min_u32 v88, 0x7fff0000, v88
    buffer_load_dwordx4 v[88:91], v88, s[28:31], 0 offen sc0 sc1
    v_subrev_u32 v92, 4096, v3
    v_min_u32 v92, 0x7fff0000, v92
    buffer_load_dwordx4 v[92:95], v92, s[28:31], 0 offen sc0 sc1
    v_subrev_u32 v96, 6144, v3
    v_min_u32 v96, 0x7fff0000, v96
    buffer_load_dwordx4 v[96:99], v96, s[28:31], 0 offen sc0 sc1
    v_subrev_u32 v100, 8192, v3
    v_min_u32 v100, 0x7fff0000, v100
    buffer_load_dwordx4 v[100:103], v100, s[28:31], 0 offen sc0 sc1
    v_subrev_u32 v104, 10240, v3
    v_min_u32 v104, 0x7fff0000, v104
    buffer_load_dwordx4 v[104:107], v104, s[28:31], 0 offen sc0 sc1
    v_subrev_u32 v108, 12288, v3
    v_min_u32 v108, 0x7fff0000, v108
    buffer_load_dwordx4 v[108:111], v108, s[28:31], 0 offen sc0 sc1
    v_subrev_u32 v112, 14336, v3
    v_min_u32 v112, 0x7fff0000, v112
    buffer_load_dwordx4 v[112:115], v112, s[28:31], 0 offen sc0 sc1
    s_waitcnt vmcnt(0)
    v_mov_b32 v12, 0
    v_cmp_eq_u64 s[46:47], s[22:23], v[86:87]
    v_cmp_eq_u64 s[48:49], s[22:23], v[90:91]
    v_cmp_eq_u64 s[50:51], s[22:23], v[94:95]
    v_cmp_eq_u64 s[52:53], s[22:23], v[98:99]
    v_addc_co_u32 v12, vcc, 0, v12, s[46:47]
    v_addc_co_u32 v12, vcc, 0, v12, s[48:49]
    v_addc_co_u32 v12, vcc, 0, v12, s[50:51]
    v_addc_co_u32 v12, vcc, 0, v12, s[52:53]
    v_cmp_eq_u64 s[46:47], s[22:23], v[102:103]
    v_cmp_eq_u64 s[48:49], s[22:23], v[106:107]
    v_cmp_eq_u64 s[50:51], s[22:23], v[110:111]
    v_cmp_eq_u64 s[52:53], s[22:23], v[114:115]
    v_addc_co_u32 v12, vcc, 0, v12, s[46:47]
    v_addc_co_u32 v12, vcc, 0, v12, s[48:49]
    v_addc_co_u32 v12, vcc, 0, v12, s[50:51]
    v_addc_co_u32 v12, vcc, 0, v12, s[52:53]
    v_cmp_ne_u32 vcc, v13, v12
    s_add_u32 s7, s7, 1
    s_cmp_gt_u32 s7, 20000
    s_cbranch_scc1 Lpolldone_gate_7
    s_nop 1
    s_cbranch_vccnz Lpoll_gate_8
Lpolldone_gate_7:
    s_nop 4
    v_fma_f32 v18, -v5, v113, v108
    v_fma_f32 v19, v5, v112, v109
    v_fma_f32 v108, v4, v112, v18
    v_fma_f32 v109, v4, v113, v19
    v_fma_f32 v18, -v5, v109, v104
    v_fma_f32 v19, v5, v108, v105
    v_fma_f32 v104, v4, v108, v18
    v_fma_f32 v105, v4, v109, v19
    v_fma_f32 v18, -v5, v105, v100
    v_fma_f32 v19, v5, v104, v101
    v_fma_f32 v100, v4, v104, v18
    v_fma_f32 v101, v4, v105, v19
    v_fma_f32 v18, -v5, v101, v96
    v_fma_f32 v19, v5, v100, v97
    v_fma_f32 v96, v4, v100, v18
    v_fma_f32 v97, v4, v101, v19
    v_fma_f32 v18, -v5, v97, v92
    v_fma_f32 v19, v5, v96, v93
    v_fma_f32 v92, v4, v96, v18
    v_fma_f32 v93, v4, v97, v19
    v_fma_f32 v18, -v5, v93, v88
    v_fma_f32 v19, v5, v92, v89
    v_fma_f32 v88, v4, v92, v18
    v_fma_f32 v89, v4, v93, v19
    v_fma_f32 v18, -v5, v89, v84
    v_fma_f32 v19, v5, v88, v85
    v_fma_f32 v84, v4, v88, v18
    v_fma_f32 v85, v4, v89, v19
    v_mov_b32 v88, v84
    v_mov_b32 v89, v85
    s_nop 0
    v_permlane32_swap_b32 v84, v88
    v_permlane32_swap_b32 v85, v89
    v_fma_f32 v18, -v55, v89, v84
    v_fma_f32 v19, v55, v88, v85
    v_fma_f32 v32, v54, v88, v18
    v_fma_f32 v33, v54, v89, v19
    s_mov_b32 s4, 0
    s_waitcnt vmcnt(0)
    v_cmp_ne_u64 vcc, s[22:23], v[182:183]
    s_nop 4
    s_cbranch_vccz Lfdone_gate_9
Lfpoll_gate_10:
    buffer_load_dwordx2 v[182:183], v81, s[8:11], 0 offen sc0 sc1
    s_waitcnt vmcnt(0)
    v_cmp_ne_u64 vcc, s[22:23], v[182:183]
    s_nop 4
    s_add_u32 s4, s4, 1
    s_cmp_gt_u32 s4, 20000
    s_cbranch_scc1 Lfdone_gate_9
    s_cbranch_vccnz Lfpoll_gate_10
Lfdone_gate_9:
    v_pk_fma_f32 v[8:9], v[58:59], v[32:33], v[34:35] op_sel:[0,1,0] op_sel_hi:[1,1,1] neg_lo:[0,1,0] neg_hi:[0,1,0]
    v_pk_fma_f32 v[10:11], v[56:57], v[32:33], v[36:37] op_sel:[0,1,0] op_sel_hi:[1,1,1]
    v_pk_fma_f32 v[2:3], v[56:57], v[32:33], v[8:9] op_sel:[0,0,0] op_sel_hi:[1,0,1]
    v_pk_fma_f32 v[4:5], v[58:59], v[32:33], v[10:11] op_sel:[0,0,0] op_sel_hi:[1,0,1]
    v_pk_mul_f32 v[8:9], v[4:5], v[50:51] op_sel:[0,1] op_sel_hi:[1,1] neg_lo:[0,1] neg_hi:[0,1]
    v_pk_mul_f32 v[10:11], v[2:3], v[50:51] op_sel:[0,1] op_sel_hi:[1,1]
    v_pk_fma_f32 v[2:3], v[2:3], v[50:51], v[8:9] op_sel:[0,0,0] op_sel_hi:[1,0,1]
    v_pk_fma_f32 v[4:5], v[4:5], v[50:51], v[10:11] op_sel:[0,0,0] op_sel_hi:[1,0,1]
    v_pk_fma_f32 v[8:9], v[4:5], v[48:49], v[116:117] op_sel:[0,1,0] op_sel_hi:[1,1,1] neg_lo:[0,1,0] neg_hi:[0,1,0]
    v_pk_fma_f32 v[10:11], v[2:3], v[48:49], v[132:133] op_sel:[0,1,0] op_sel_hi:[1,1,1]
    v_pk_fma_f32 v[116:117], v[2:3], v[48:49], v[8:9] op_sel:[0,0,0] op_sel_hi:[1,0,1]
    v_pk_fma_f32 v[132:133], v[4:5], v[48:49], v[10:11] op_sel:[0,0,0] op_sel_hi:[1,0,1]
    v_pk_fma_f32 v[8:9], v[132:133], v[48:49], v[118:119] op_sel:[0,1,0] op_sel_hi:[1,1,1] neg_lo:[0,1,0] neg_hi:[0,1,0]
    v_pk_fma_f32 v[10:11], v[116:117], v[48:49], v[134:135] op_sel:[0,1,0] op_sel_hi:[1,1,1]
    v_pk_fma_f32 v[118:119], v[116:117], v[48:49], v[8:9] op_sel:[0,0,0] op_sel_hi:[1,0,1]
    v_pk_fma_f32 v[134:135], v[132:133], v[48:49], v[10:11] op_sel:[0,0,0] op_sel_hi:[1,0,1]
    v_cvt_pk_bf16_f32 v12, v116, -v132
    v_cvt_pk_bf16_f32 v13, v117, -v133
    ds_write2st64_b32 v14, v12, v13 offset0:0 offset1:16
    v_pk_fma_f32 v[8:9], v[134:135], v[48:49], v[120:121] op_sel:[0,1,0] op_sel_hi:[1,1,1] neg_lo:[0,1,0] neg_hi:[0,1,0]
    v_pk_fma_f32 v[10:11], v[118:119], v[48:49], v[136:137] op_sel:[0,1,0] op_sel_hi:[1,1,1]
    v_pk_fma_f32 v[120:121], v[118:119], v[48:49], v[8:9] op_sel:[0,0,0] op_sel_hi:[1,0,1]
    v_pk_fma_f32 v[136:137], v[134:135], v[48:49], v[10:11] op_sel:[0,0,0] op_sel_hi:[1,0,1]
    v_xor_b32 v46, 16, v14
    v_cvt_pk_bf16_f32 v17, v118, -v134
    v_cvt_pk_bf16_f32 v18, v119, -v135
    ds_write2st64_b32 v46, v17, v18 offset0:1 offset1:17
    ds_read_b128 v[76:79], v15 offset:0
    v_pk_fma_f32 v[8:9], v[136:137], v[48:49], v[122:123] op_sel:[0,1,0] op_sel_hi:[1,1,1] neg_lo:[0,1,0] neg_hi:[0,1,0]
    v_pk_fma_f32 v[10:11], v[120:121], v[48:49], v[138:139] op_sel:[0,1,0] op_sel_hi:[1,1,1]
    v_pk_fma_f32 v[122:123], v[120:121], v[48:49], v[8:9] op_sel:[0,0,0] op_sel_hi:[1,0,1]
    v_pk_fma_f32 v[138:139], v[136:137], v[48:49], v[10:11] op_sel:[0,0,0] op_sel_hi:[1,0,1]
    v_xor_b32 v19, 32, v14
    v_cvt_pk_bf16_f32 v12, v120, -v136
    v_cvt_pk_bf16_f32 v13, v121, -v137
    ds_write2st64_b32 v19, v12, v13 offset0:2 offset1:18
    s_waitcnt lgkmcnt(1)
    buffer_store_dwordx4 v[76:79], v16, s[8:11], s6 offen sc0 sc1
    v_pk_fma_f32 v[8:9], v[138:139], v[48:49], v[124:125] op_sel:[0,1,0] op_sel_hi:[1,1,1] neg_lo:[0,1,0] neg_hi:[0,1,0]
    v_pk_fma_f32 v[10:11], v[122:123], v[48:49], v[140:141] op_sel:[0,1,0] op_sel_hi:[1,1,1]
    v_pk_fma_f32 v[124:125], v[122:123], v[48:49], v[8:9] op_sel:[0,0,0] op_sel_hi:[1,0,1]
    v_pk_fma_f32 v[140:141], v[138:139], v[48:49], v[10:11] op_sel:[0,0,0] op_sel_hi:[1,0,1]
    v_xor_b32 v46, 48, v14
    v_cvt_pk_bf16_f32 v17, v122, -v138
    v_cvt_pk_bf16_f32 v18, v123, -v139
    ds_write2st64_b32 v46, v17, v18 offset0:3 offset1:19
    v_xor_b32 v47, 32, v15
    ds_read_b128 v[84:87], v47 offset:512
    v_pk_fma_f32 v[8:9], v[140:141], v[48:49], v[126:127] op_sel:[0,1,0] op_sel_hi:[1,1,1] neg_lo:[0,1,0] neg_hi:[0,1,0]
    v_pk_fma_f32 v[10:11], v[124:125], v[48:49], v[142:143] op_sel:[0,1,0] op_sel_hi:[1,1,1]
    v_pk_fma_f32 v[126:127], v[124:125], v[48:49], v[8:9] op_sel:[0,0,0] op_sel_hi:[1,0,1]
    v_pk_fma_f32 v[142:143], v[140:141], v[48:49], v[10:11] op_sel:[0,0,0] op_sel_hi:[1,0,1]
    v_xor_b32 v19, 64, v14
    v_cvt_pk_bf16_f32 v12, v124, -v140
    v_cvt_pk_bf16_f32 v13, v125, -v141
    ds_write2st64_b32 v19, v12, v13 offset0:4 offset1:20
    s_add_u32 s6, s6, 8192
    s_waitcnt lgkmcnt(1)
    buffer_store_dwordx4 v[84:87], v16, s[8:11], s6 offen sc0 sc1
    v_pk_fma_f32 v[8:9], v[142:143], v[48:49], v[128:129] op_sel:[0,1,0] op_sel_hi:[1,1,1] neg_lo:[0,1,0] neg_hi:[0,1,0]
    v_pk_fma_f32 v[10:11], v[126:127], v[48:49], v[144:145] op_sel:[0,1,0] op_sel_hi:[1,1,1]
    v_pk_fma_f32 v[128:129], v[126:127], v[48:49], v[8:9] op_sel:[0,0,0] op_sel_hi:[1,0,1]
    v_pk_fma_f32 v[144:145], v[142:143], v[48:49], v[10:11] op_sel:[0,0,0] op_sel_hi:[1,0,1]
    v_xor_b32 v46, 80, v14
    v_cvt_pk_bf16_f32 v17, v126, -v142
    v_cvt_pk_bf16_f32 v18, v127, -v143
    ds_write2st64_b32 v46, v17, v18 offset0:5 offset1:21
    v_xor_b32 v47, 64, v15
    ds_read_b128 v[76:79], v47 offset:1024
    v_pk_fma_f32 v[8:9], v[144:145], v[48:49], v[130:131] op_sel:[0,1,0] op_sel_hi:[1,1,1] neg_lo:[0,1,0] neg_hi:[0,1,0]
    v_pk_fma_f32 v[10:11], v[128:129], v[48:49], v[146:147] op_sel:[0,1,0] op_sel_hi:[1,1,1]
    v_pk_fma_f32 v[130:131], v[128:129], v[48:49], v[8:9] op_sel:[0,0,0] op_sel_hi:[1,0,1]
    v_pk_fma_f32 v[146:147], v[144:145], v[48:49], v[10:11] op_sel:[0,0,0] op_sel_hi:[1,0,1]
    v_xor_b32 v19, 96, v14
    v_cvt_pk_bf16_f32 v12, v128, -v144
    v_cvt_pk_bf16_f32 v13, v129, -v145
    ds_write2st64_b32 v19, v12, v13 offset0:6 offset1:22
    s_add_u32 s6, s6, 8192
    s_waitcnt lgkmcnt(1)
    buffer_store_dwordx4 v[76:79], v16, s[8:11], s6 offen sc0 sc1
    v_pk_fma_f32 v[8:9], v[146:147], v[48:49], v[148:149] op_sel:[0,1,0] op_sel_hi:[1,1,1] neg_lo:[0,1,0] neg_hi:[0,1,0]
    v_pk_fma_f32 v[10:11], v[130:131], v[48:49], v[164:165] op_sel:[0,1,0] op_sel_hi:[1,1,1]
    v_pk_fma_f32 v[148:149], v[130:131], v[48:49], v[8:9] op_sel:[0,0,0] op_sel_hi:[1,0,1]
    v_pk_fma_f32 v[164:165], v[146:147], v[48:49], v[10:11] op_sel:[0,0,0] op_sel_hi:[1,0,1]
    v_xor_b32 v46, 112, v14
    v_cvt_pk_bf16_f32 v17, v130, -v146
    v_cvt_pk_bf16_f32 v18, v131, -v147
    ds_write2st64_b32 v46, v17, v18 offset0:7 offset1:23
    v_xor_b32 v47, 96, v15
    ds_read_b128 v[84:87], v47 offset:1536
    v_pk_fma_f32 v[8:9], v[164:165], v[48:49], v[150:151] op_sel:[0,1,0] op_sel_hi:[1,1,1] neg_lo:[0,1,0] neg_hi:[0,1,0]
    v_pk_fma_f32 v[10:11], v[148:149], v[48:49], v[166:167] op_sel:[0,1,0] op_sel_hi:[1,1,1]
    v_pk_fma_f32 v[150:151], v[148:149], v[48:49], v[8:9] op_sel:[0,0,0] op_sel_hi:[1,0,1]
    v_pk_fma_f32 v[166:167], v[164:165], v[48:49], v[10:11] op_sel:[0,0,0] op_sel_hi:[1,0,1]
    v_xor_b32 v19, 128, v14
    v_cvt_pk_bf16_f32 v12, v148, -v164
    v_cvt_pk_bf16_f32 v13, v149, -v165
    ds_write2st64_b32 v19, v12, v13 offset0:8 offset1:24
    s_add_u32 s6, s6, 8192
    s_waitcnt lgkmcnt(1)
    buffer_store_dwordx4 v[84:87], v16, s[8:11], s6 offen sc0 sc1
    v_pk_fma_f32 v[8:9], v[166:167], v[48:49], v[152:153] op_sel:[0,1,0] op_sel_hi:[1,1,1] neg_lo:[0,1,0] neg_hi:[0,1,0]
    v_pk_fma_f32 v[10:11], v[150:151], v[48:49], v[168:169] op_sel:[0,1,0] op_sel_hi:[1,1,1]
    v_pk_fma_f32 v[152:153], v[150:151], v[48:49], v[8:9] op_sel:[0,0,0] op_sel_hi:[1,0,1]
    v_pk_fma_f32 v[168:169], v[166:167], v[48:49], v[10:11] op_sel:[0,0,0] op_sel_hi:[1,0,1]
    v_xor_b32 v46, 144, v14
    v_cvt_pk_bf16_f32 v17, v150, -v166
    v_cvt_pk_bf16_f32 v18, v151, -v167
    ds_write2st64_b32 v46, v17, v18 offset0:9 offset1:25
    v_xor_b32 v47, 128, v15
    ds_read_b128 v[76:79], v47 offset:2048
    v_pk_fma_f32 v[8:9], v[168:169], v[48:49], v[154:155] op_sel:[0,1,0] op_sel_hi:[1,1,1] neg_lo:[0,1,0] neg_hi:[0,1,0]
    v_pk_fma_f32 v[10:11], v[152:153], v[48:49], v[170:171] op_sel:[0,1,0] op_sel_hi:[1,1,1]
    v_pk_fma_f32 v[154:155], v[152:153], v[48:49], v[8:9] op_sel:[0,0,0] op_sel_hi:[1,0,1]
    v_pk_fma_f32 v[170:171], v[168:169], v[48:49], v[10:11] op_sel:[0,0,0] op_sel_hi:[1,0,1]
    v_xor_b32 v19, 160, v14
    v_cvt_pk_bf16_f32 v12, v152, -v168
    v_cvt_pk_bf16_f32 v13, v153, -v169
    ds_write2st64_b32 v19, v12, v13 offset0:10 offset1:26
    s_add_u32 s6, s6, 8192
    s_waitcnt lgkmcnt(1)
    buffer_store_dwordx4 v[76:79], v16, s[8:11], s6 offen sc0 sc1
    v_pk_fma_f32 v[8:9], v[170:171], v[48:49], v[156:157] op_sel:[0,1,0] op_sel_hi:[1,1,1] neg_lo:[0,1,0] neg_hi:[0,1,0]
    v_pk_fma_f32 v[10:11], v[154:155], v[48:49], v[172:173] op_sel:[0,1,0] op_sel_hi:[1,1,1]
    v_pk_fma_f32 v[156:157], v[154:155], v[48:49], v[8:9] op_sel:[0,0,0] op_sel_hi:[1,0,1]
    v_pk_fma_f32 v[172:173], v[170:171], v[48:49], v[10:11] op_sel:[0,0,0] op_sel_hi:[1,0,1]
    v_xor_b32 v46, 176, v14
    v_cvt_pk_bf16_f32 v17, v154, -v170
    v_cvt_pk_bf16_f32 v18, v155, -v171
    ds_write2st64_b32 v46, v17, v18 offset0:11 offset1:27
    v_xor_b32 v47, 160, v15
    ds_read_b128 v[84:87], v47 offset:2560
    v_pk_fma_f32 v[8:9], v[172:173], v[48:49], v[158:159] op_sel:[0,1,0] op_sel_hi:[1,1,1] neg_lo:[0,1,0] neg_hi:[0,1,0]
    v_pk_fma_f32 v[10:11], v[156:157], v[48:49], v[174:175] op_sel:[0,1,0] op_sel_hi:[1,1,1]
    v_pk_fma_f32 v[158:159], v[156:157], v[48:49], v[8:9] op_sel:[0,0,0] op_sel_hi:[1,0,1]
    v_pk_fma_f32 v[174:175], v[172:173], v[48:49], v[10:11] op_sel:[0,0,0] op_sel_hi:[1,0,1]
    v_xor_b32 v19, 192, v14
    v_cvt_pk_bf16_f32 v12, v156, -v172
    v_cvt_pk_bf16_f32 v13, v157, -v173
    ds_write2st64_b32 v19, v12, v13 offset0:12 offset1:28
    s_add_u32 s6, s6, 8192
    s_waitcnt lgkmcnt(1)
    buffer_store_dwordx4 v[84:87], v16, s[8:11], s6 offen sc0 sc1
    v_pk_fma_f32 v[8:9], v[174:175], v[48:49], v[160:161] op_sel:[0,1,0] op_sel_hi:[1,1,1] neg_lo:[0,1,0] neg_hi:[0,1,0]
    v_pk_fma_f32 v[10:11], v[158:159], v[48:49], v[176:177] op_sel:[0,1,0] op_sel_hi:[1,1,1]
    v_pk_fma_f32 v[160:161], v[158:159], v[48:49], v[8:9] op_sel:[0,0,0] op_sel_hi:[1,0,1]
    v_pk_fma_f32 v[176:177], v[174:175], v[48:49], v[10:11] op_sel:[0,0,0] op_sel_hi:[1,0,1]
    v_xor_b32 v46, 208, v14
    v_cvt_pk_bf16_f32 v17, v158, -v174
    v_cvt_pk_bf16_f32 v18, v159, -v175
    ds_write2st64_b32 v46, v17, v18 offset0:13 offset1:29
    v_xor_b32 v47, 192, v15
    ds_read_b128 v[76:79], v47 offset:3072
    v_pk_fma_f32 v[8:9], v[176:177], v[48:49], v[162:163] op_sel:[0,1,0] op_sel_hi:[1,1,1] neg_lo:[0,1,0] neg_hi:[0,1,0]
    v_pk_fma_f32 v[10:11], v[160:161], v[48:49], v[178:179] op_sel:[0,1,0] op_sel_hi:[1,1,1]
    v_pk_fma_f32 v[162:163], v[160:161], v[48:49], v[8:9] op_sel:[0,0,0] op_sel_hi:[1,0,1]
    v_pk_fma_f32 v[178:179], v[176:177], v[48:49], v[10:11] op_sel:[0,0,0] op_sel_hi:[1,0,1]
    v_xor_b32 v19, 224, v14
    v_cvt_pk_bf16_f32 v12, v160, -v176
    v_cvt_pk_bf16_f32 v13, v161, -v177
    ds_write2st64_b32 v19, v12, v13 offset0:14 offset1:30
    s_add_u32 s6, s6, 8192
    s_waitcnt lgkmcnt(1)
    buffer_store_dwordx4 v[76:79], v16, s[8:11], s6 offen sc0 sc1
    v_xor_b32 v46, 240, v14
    v_cvt_pk_bf16_f32 v17, v162, -v178
    v_cvt_pk_bf16_f32 v18, v163, -v179
    ds_write2st64_b32 v46, v17, v18 offset0:15 offset1:31
    v_xor_b32 v47, 224, v15
    ds_read_b128 v[84:87], v47 offset:3584
    s_add_u32 s6, s6, 8192
    s_waitcnt lgkmcnt(0)
    buffer_store_dwordx4 v[84:87], v16, s[8:11], s6 offen sc0 sc1
    ds_read_b64 v[48:49], v221 offset:256
    ds_read_b64 v[50:51], v221 offset:264
    ds_read_b128 v[52:55], v225 offset:15360
    ds_read_b64 v[56:57], v221 offset:768
    ds_read_b64 v[58:59], v221 offset:776
    ds_read_b128 v[74:77], v225 offset:13312
    ds_read_b64 v[84:85], v221 offset:1280
    ds_read_b64 v[86:87], v221 offset:1288
    ds_read_b128 v[88:91], v225 offset:11264
    s_waitcnt lgkmcnt(6)
    v_mfma_f32_16x16x32_bf16 v[20:23], v[48:51], v[52:55], v[20:23]
    s_lshl_b32 s4, s43, 4
    s_waitcnt lgkmcnt(4)
    v_mfma_f32_16x16x32_bf16 v[24:27], v[56:59], v[52:55], v[24:27]
    s_add_u32 s4, s4, s44
    s_waitcnt lgkmcnt(3)
    v_mfma_f32_16x16x32_bf16 v[24:27], v[48:51], v[74:77], v[24:27]
    ds_read_b64 v[92:93], v221 offset:1792
    ds_read_b64 v[94:95], v221 offset:1800
    v_mfma_f32_16x16x32_bf16 v[28:31], v[56:59], v[74:77], v[28:31]
    ds_read_b128 v[96:99], v225 offset:9216
    s_waitcnt lgkmcnt(4)
    v_mfma_f32_16x16x32_bf16 v[28:31], v[84:87], v[52:55], v[28:31]
    s_lshl_b32 s4, s4, 2
    s_waitcnt lgkmcnt(3)
    v_mfma_f32_16x16x32_bf16 v[28:31], v[48:51], v[88:91], v[28:31]
    s_add_u32 s4, s4, s42
    v_mfma_f32_16x16x32_bf16 v[38:41], v[84:87], v[74:77], v[38:41]
    s_lshl_b32 s4, s4, 3
    v_mfma_f32_16x16x32_bf16 v[38:41], v[56:59], v[88:91], v[38:41]
    s_add_u32 s4, s4, 21512192
    v_mfma_f32_16x16x32_bf16 v[42:45], v[84:87], v[88:91], v[42:45]
    s_lshl_b32 s6, s44, 4
    s_waitcnt lgkmcnt(1)
    v_mfma_f32_16x16x32_bf16 v[38:41], v[92:95], v[52:55], v[38:41]
    ds_read_b64 v[100:101], v221 offset:2304
    ds_read_b64 v[102:103], v221 offset:2312
    s_waitcnt lgkmcnt(2)
    v_mfma_f32_16x16x32_bf16 v[38:41], v[48:51], v[96:99], v[38:41]
    ds_read_b128 v[104:107], v225 offset:7168
    v_mfma_f32_16x16x32_bf16 v[42:45], v[92:95], v[74:77], v[42:45]
    s_add_u32 s6, s6, s43
    v_mfma_f32_16x16x32_bf16 v[42:45], v[56:59], v[96:99], v[42:45]
    s_lshl_b32 s6, s6, 2
    v_mfma_f32_16x16x32_bf16 v[62:65], v[92:95], v[88:91], v[62:65]
    s_add_u32 s6, s6, s42
    v_mfma_f32_16x16x32_bf16 v[62:65], v[84:87], v[96:99], v[62:65]
    s_lshl_b32 s6, s6, 3
    v_mfma_f32_16x16x32_bf16 v[66:69], v[92:95], v[96:99], v[66:69]
    s_add_u32 s6, s6, 21520384
    s_waitcnt lgkmcnt(1)
    v_mfma_f32_16x16x32_bf16 v[42:45], v[100:103], v[52:55], v[42:45]
    s_lshl_b32 s3, s43, 9
    s_waitcnt lgkmcnt(0)
    v_mfma_f32_16x16x32_bf16 v[42:45], v[48:51], v[104:107], v[42:45]
    ds_read_b64 v[108:109], v221 offset:2816
    ds_read_b64 v[110:111], v221 offset:2824
    v_mfma_f32_16x16x32_bf16 v[62:65], v[100:103], v[74:77], v[62:65]
    ds_read_b128 v[112:115], v225 offset:5120
    v_mfma_f32_16x16x32_bf16 v[62:65], v[56:59], v[104:107], v[62:65]
    s_add_u32 s3, s3, 21512192
    v_mfma_f32_16x16x32_bf16 v[66:69], v[100:103], v[88:91], v[66:69]
    v_lshrrev_b32 v81, 1, v60
    v_mfma_f32_16x16x32_bf16 v[66:69], v[84:87], v[104:107], v[66:69]
    v_add_u32 v81, s3, v81
    v_mfma_f32_16x16x32_bf16 v[70:73], v[100:103], v[96:99], v[70:73]
    v_lshrrev_b32 v7, 4, v1
    v_mfma_f32_16x16x32_bf16 v[70:73], v[92:95], v[104:107], v[70:73]
    ds_read_b64 v[116:117], v221 offset:3328
    ds_read_b64 v[118:119], v221 offset:3336
    s_waitcnt lgkmcnt(3)
    v_mfma_f32_16x16x32_bf16 v[62:65], v[108:111], v[52:55], v[62:65]
    ds_read_b128 v[120:123], v225 offset:3072
    s_waitcnt lgkmcnt(3)
    v_mfma_f32_16x16x32_bf16 v[62:65], v[48:51], v[112:115], v[62:65]
    v_and_b32 v8, 15, v1
    v_mfma_f32_16x16x32_bf16 v[66:69], v[108:111], v[74:77], v[66:69]
    v_xor_b32 v8, v8, v7
    v_mfma_f32_16x16x32_bf16 v[66:69], v[56:59], v[112:115], v[66:69]
    ds_read_b64 v[100:101], v221 offset:3840
    ds_read_b64 v[102:103], v221 offset:3848
    v_mfma_f32_16x16x32_bf16 v[70:73], v[108:111], v[88:91], v[70:73]
    ds_read_b128 v[96:99], v225 offset:1024
    v_mfma_f32_16x16x32_bf16 v[70:73], v[84:87], v[112:115], v[70:73]
    ds_read_b64 v[92:93], v221 offset:192
    ds_read_b64 v[94:95], v221 offset:200
    s_waitcnt lgkmcnt(6)
    v_mfma_f32_16x16x32_bf16 v[66:69], v[116:119], v[52:55], v[66:69]
    ds_read_b128 v[104:107], v222 offset:15104
    s_waitcnt lgkmcnt(6)
    v_mfma_f32_16x16x32_bf16 v[66:69], v[48:51], v[120:123], v[66:69]
    ds_read_b64 v[108:109], v221 offset:704
    ds_read_b64 v[110:111], v221 offset:712
    v_mfma_f32_16x16x32_bf16 v[70:73], v[116:119], v[74:77], v[70:73]
    ds_read_b128 v[88:91], v222 offset:13056
    v_mfma_f32_16x16x32_bf16 v[70:73], v[56:59], v[120:123], v[70:73]
    ds_read_b64 v[84:85], v221 offset:1216
    ds_read_b64 v[86:87], v221 offset:1224
    s_waitcnt lgkmcnt(9)
    v_mfma_f32_16x16x32_bf16 v[70:73], v[100:103], v[52:55], v[70:73]
    ds_read_b128 v[112:115], v222 offset:11008
    s_waitcnt lgkmcnt(9)
    v_mfma_f32_16x16x32_bf16 v[70:73], v[48:51], v[96:99], v[70:73]
    v_lshlrev_b32 v8, 4, v8
    s_waitcnt lgkmcnt(6)
    v_mfma_f32_16x16x32_bf16 v[20:23], v[92:95], v[104:107], v[20:23]
    v_lshl_add_u32 v2, v7, 12, v8
    s_waitcnt lgkmcnt(4)
    v_mfma_f32_16x16x32_bf16 v[24:27], v[108:111], v[104:107], v[24:27]
    v_xor_b32 v7, 64, v2
    s_waitcnt lgkmcnt(3)
    v_mfma_f32_16x16x32_bf16 v[24:27], v[92:95], v[88:91], v[24:27]
    ds_read_b64 v[116:117], v221 offset:1728
    ds_read_b64 v[118:119], v221 offset:1736
    v_mfma_f32_16x16x32_bf16 v[28:31], v[108:111], v[88:91], v[28:31]
    ds_read_b128 v[74:77], v222 offset:8960
    s_waitcnt lgkmcnt(4)
    v_mfma_f32_16x16x32_bf16 v[28:31], v[84:87], v[104:107], v[28:31]
    v_add_u32 v3, 16384, v7
    s_waitcnt lgkmcnt(3)
    v_mfma_f32_16x16x32_bf16 v[28:31], v[92:95], v[112:115], v[28:31]
    v_xor_b32 v7, 128, v2
    v_mfma_f32_16x16x32_bf16 v[38:41], v[84:87], v[88:91], v[38:41]
    v_add_u32 v4, 32768, v7
    v_mfma_f32_16x16x32_bf16 v[38:41], v[108:111], v[112:115], v[38:41]
    v_xor_b32 v7, 192, v2
    v_mfma_f32_16x16x32_bf16 v[42:45], v[84:87], v[112:115], v[42:45]
    v_add_u32 v5, 49152, v7
    s_waitcnt lgkmcnt(1)
    v_mfma_f32_16x16x32_bf16 v[38:41], v[116:119], v[104:107], v[38:41]
    ds_read_b64 v[56:57], v221 offset:2240
    ds_read_b64 v[58:59], v221 offset:2248
    s_waitcnt lgkmcnt(2)
    v_mfma_f32_16x16x32_bf16 v[38:41], v[92:95], v[74:77], v[38:41]
    ds_read_b128 v[120:123], v222 offset:6912
    v_mfma_f32_16x16x32_bf16 v[42:45], v[116:119], v[88:91], v[42:45]
    s_lshl_b32 s7, s43, 19
    v_mfma_f32_16x16x32_bf16 v[42:45], v[108:111], v[74:77], v[42:45]
    s_lshl_b32 s3, s42, 17
    v_mfma_f32_16x16x32_bf16 v[62:65], v[116:119], v[112:115], v[62:65]
    s_add_u32 s7, s7, s3
    v_mfma_f32_16x16x32_bf16 v[62:65], v[84:87], v[74:77], v[62:65]
    s_lshl_b32 s12, s44, 8
    v_mfma_f32_16x16x32_bf16 v[66:69], v[116:119], v[74:77], v[66:69]
    s_lshl_b32 s17, s42, 13
    s_waitcnt lgkmcnt(1)
    v_mfma_f32_16x16x32_bf16 v[42:45], v[56:59], v[104:107], v[42:45]
    s_lshr_b32 s30, s42, 1
    s_waitcnt lgkmcnt(0)
    v_mfma_f32_16x16x32_bf16 v[42:45], v[92:95], v[120:123], v[42:45]
    ds_read_b64 v[100:101], v221 offset:2752
    ds_read_b64 v[102:103], v221 offset:2760
    v_mfma_f32_16x16x32_bf16 v[62:65], v[56:59], v[88:91], v[62:65]
    ds_read_b128 v[52:55], v222 offset:4864
    v_mfma_f32_16x16x32_bf16 v[62:65], v[108:111], v[120:123], v[62:65]
    v_and_b32 v37, 31, v1
    v_mfma_f32_16x16x32_bf16 v[66:69], v[56:59], v[112:115], v[66:69]
    v_lshrrev_b32 v46, 5, v1
    v_mfma_f32_16x16x32_bf16 v[66:69], v[84:87], v[120:123], v[66:69]
    v_lshlrev_b32 v46, 2, v46
    v_mfma_f32_16x16x32_bf16 v[70:73], v[56:59], v[74:77], v[70:73]
    s_lshl_b32 s3, s30, 3
    v_mfma_f32_16x16x32_bf16 v[70:73], v[116:119], v[120:123], v[70:73]
    ds_read_b64 v[48:49], v221 offset:3264
    ds_read_b64 v[50:51], v221 offset:3272
    s_waitcnt lgkmcnt(3)
    v_mfma_f32_16x16x32_bf16 v[62:65], v[100:103], v[104:107], v[62:65]
    ds_read_b128 v[96:99], v222 offset:2816
    s_waitcnt lgkmcnt(3)
    v_mfma_f32_16x16x32_bf16 v[62:65], v[92:95], v[52:55], v[62:65]
    v_add_u32 v46, s3, v46
    v_mfma_f32_16x16x32_bf16 v[66:69], v[100:103], v[88:91], v[66:69]
    v_and_b32 v47, 15, v37
    v_mfma_f32_16x16x32_bf16 v[66:69], v[108:111], v[52:55], v[66:69]
    ds_read_b64 v[56:57], v221 offset:3776
    ds_read_b64 v[58:59], v221 offset:3784
    v_mfma_f32_16x16x32_bf16 v[70:73], v[100:103], v[112:115], v[70:73]
    ds_read_b128 v[74:77], v222 offset:768
    v_mfma_f32_16x16x32_bf16 v[70:73], v[84:87], v[52:55], v[70:73]
    ds_read_b64 v[116:117], v221 offset:128
    ds_read_b64 v[118:119], v221 offset:136
    s_waitcnt lgkmcnt(6)
    v_mfma_f32_16x16x32_bf16 v[66:69], v[48:51], v[104:107], v[66:69]
    ds_read_b128 v[120:123], v223 offset:14848
    s_waitcnt lgkmcnt(6)
    v_mfma_f32_16x16x32_bf16 v[66:69], v[92:95], v[96:99], v[66:69]
    ds_read_b64 v[100:101], v221 offset:640
    ds_read_b64 v[102:103], v221 offset:648
    v_mfma_f32_16x16x32_bf16 v[70:73], v[48:51], v[88:91], v[70:73]
    ds_read_b128 v[112:115], v223 offset:12800
    v_mfma_f32_16x16x32_bf16 v[70:73], v[108:111], v[96:99], v[70:73]
    ds_read_b64 v[84:85], v221 offset:1152
    ds_read_b64 v[86:87], v221 offset:1160
    s_waitcnt lgkmcnt(9)
    v_mfma_f32_16x16x32_bf16 v[70:73], v[56:59], v[104:107], v[70:73]
    ds_read_b128 v[52:55], v223 offset:10752
    s_waitcnt lgkmcnt(9)
    v_mfma_f32_16x16x32_bf16 v[70:73], v[92:95], v[74:77], v[70:73]
    v_xor_b32 v46, v46, v47
    s_waitcnt lgkmcnt(6)
    v_mfma_f32_16x16x32_bf16 v[20:23], v[116:119], v[120:123], v[20:23]
    v_lshlrev_b32 v46, 4, v46
    s_waitcnt lgkmcnt(4)
    v_mfma_f32_16x16x32_bf16 v[24:27], v[100:103], v[120:123], v[24:27]
    v_lshl_add_u32 v46, v37, 8, v46
    s_waitcnt lgkmcnt(3)
    v_mfma_f32_16x16x32_bf16 v[24:27], v[116:119], v[112:115], v[24:27]
    ds_read_b64 v[48:49], v221 offset:1664
    ds_read_b64 v[50:51], v221 offset:1672
    v_mfma_f32_16x16x32_bf16 v[28:31], v[100:103], v[112:115], v[28:31]
    ds_read_b128 v[88:91], v223 offset:8704
    s_waitcnt lgkmcnt(4)
    v_mfma_f32_16x16x32_bf16 v[28:31], v[84:87], v[120:123], v[28:31]
    s_lshl_b32 s3, s30, 14
    s_waitcnt lgkmcnt(3)
    v_mfma_f32_16x16x32_bf16 v[28:31], v[116:119], v[52:55], v[28:31]
    v_add_u32 v46, s3, v46
    v_mfma_f32_16x16x32_bf16 v[38:41], v[84:87], v[112:115], v[38:41]
    v_xor_b32 v9, 0, v46
    v_mfma_f32_16x16x32_bf16 v[38:41], v[100:103], v[52:55], v[38:41]
    v_xor_b32 v17, 0x4000, v9
    v_mfma_f32_16x16x32_bf16 v[42:45], v[84:87], v[52:55], v[42:45]
    v_add_u32 v13, 65536, v9
    s_waitcnt lgkmcnt(1)
    v_mfma_f32_16x16x32_bf16 v[38:41], v[48:51], v[120:123], v[38:41]
    ds_read_b64 v[108:109], v221 offset:2176
    ds_read_b64 v[110:111], v221 offset:2184
    s_waitcnt lgkmcnt(2)
    v_mfma_f32_16x16x32_bf16 v[38:41], v[116:119], v[88:91], v[38:41]
    ds_read_b128 v[96:99], v223 offset:6656
    v_mfma_f32_16x16x32_bf16 v[42:45], v[48:51], v[112:115], v[42:45]
    v_add_u32 v33, 65536, v17
    v_mfma_f32_16x16x32_bf16 v[42:45], v[100:103], v[88:91], v[42:45]
    v_xor_b32 v10, 16, v46
    v_mfma_f32_16x16x32_bf16 v[62:65], v[48:51], v[52:55], v[62:65]
    v_xor_b32 v18, 0x4000, v10
    v_mfma_f32_16x16x32_bf16 v[62:65], v[84:87], v[88:91], v[62:65]
    v_add_u32 v14, 65536, v10
    v_mfma_f32_16x16x32_bf16 v[66:69], v[48:51], v[88:91], v[66:69]
    v_add_u32 v34, 65536, v18
    s_waitcnt lgkmcnt(1)
    v_mfma_f32_16x16x32_bf16 v[42:45], v[108:111], v[120:123], v[42:45]
    v_xor_b32 v11, 32, v46
    s_waitcnt lgkmcnt(0)
    v_mfma_f32_16x16x32_bf16 v[42:45], v[116:119], v[96:99], v[42:45]
    ds_read_b64 v[56:57], v221 offset:2688
    ds_read_b64 v[58:59], v221 offset:2696
    v_mfma_f32_16x16x32_bf16 v[62:65], v[108:111], v[112:115], v[62:65]
    ds_read_b128 v[104:107], v223 offset:4608
    v_mfma_f32_16x16x32_bf16 v[62:65], v[100:103], v[96:99], v[62:65]
    v_xor_b32 v19, 0x4000, v11
    v_mfma_f32_16x16x32_bf16 v[66:69], v[108:111], v[52:55], v[66:69]
    v_add_u32 v15, 65536, v11
    v_mfma_f32_16x16x32_bf16 v[66:69], v[84:87], v[96:99], v[66:69]
    v_add_u32 v35, 65536, v19
    v_mfma_f32_16x16x32_bf16 v[70:73], v[108:111], v[88:91], v[70:73]
    v_xor_b32 v12, 48, v46
    v_mfma_f32_16x16x32_bf16 v[70:73], v[48:51], v[96:99], v[70:73]
    ds_read_b64 v[92:93], v221 offset:3200
    ds_read_b64 v[94:95], v221 offset:3208
    s_waitcnt lgkmcnt(3)
    v_mfma_f32_16x16x32_bf16 v[62:65], v[56:59], v[120:123], v[62:65]
    ds_read_b128 v[74:77], v223 offset:2560
    s_waitcnt lgkmcnt(3)
    v_mfma_f32_16x16x32_bf16 v[62:65], v[116:119], v[104:107], v[62:65]
    v_xor_b32 v32, 0x4000, v12
    v_mfma_f32_16x16x32_bf16 v[66:69], v[56:59], v[112:115], v[66:69]
    v_add_u32 v16, 65536, v12
    v_mfma_f32_16x16x32_bf16 v[66:69], v[100:103], v[104:107], v[66:69]
    ds_read_b64 v[108:109], v221 offset:3712
    ds_read_b64 v[110:111], v221 offset:3720
    v_mfma_f32_16x16x32_bf16 v[70:73], v[56:59], v[52:55], v[70:73]
    ds_read_b128 v[88:91], v223 offset:512
    v_mfma_f32_16x16x32_bf16 v[70:73], v[84:87], v[104:107], v[70:73]
    ds_read_b64 v[48:49], v221 offset:64
    ds_read_b64 v[50:51], v221 offset:72
    s_waitcnt lgkmcnt(6)
    v_mfma_f32_16x16x32_bf16 v[66:69], v[92:95], v[120:123], v[66:69]
    ds_read_b128 v[96:99], v224 offset:14592
    s_waitcnt lgkmcnt(6)
    v_mfma_f32_16x16x32_bf16 v[66:69], v[116:119], v[74:77], v[66:69]
    ds_read_b64 v[56:57], v221 offset:576
    ds_read_b64 v[58:59], v221 offset:584
    v_mfma_f32_16x16x32_bf16 v[70:73], v[92:95], v[112:115], v[70:73]
    ds_read_b128 v[52:55], v224 offset:12544
    v_mfma_f32_16x16x32_bf16 v[70:73], v[100:103], v[74:77], v[70:73]
    ds_read_b64 v[84:85], v221 offset:1088
    ds_read_b64 v[86:87], v221 offset:1096
    s_waitcnt lgkmcnt(9)
    v_mfma_f32_16x16x32_bf16 v[70:73], v[108:111], v[120:123], v[70:73]
    ds_read_b128 v[104:107], v224 offset:10496
    s_waitcnt lgkmcnt(9)
    v_mfma_f32_16x16x32_bf16 v[70:73], v[116:119], v[88:91], v[70:73]
    v_add_u32 v36, 65536, v32
    s_waitcnt lgkmcnt(6)
    v_mfma_f32_16x16x32_bf16 v[20:23], v[48:51], v[96:99], v[20:23]
    s_waitcnt lgkmcnt(4)
    v_mfma_f32_16x16x32_bf16 v[24:27], v[56:59], v[96:99], v[24:27]
    s_waitcnt vmcnt(0)
    s_waitcnt lgkmcnt(3)
    v_mfma_f32_16x16x32_bf16 v[24:27], v[48:51], v[52:55], v[24:27]
    ds_read_b64 v[92:93], v221 offset:1600
    ds_read_b64 v[94:95], v221 offset:1608
    v_mfma_f32_16x16x32_bf16 v[28:31], v[56:59], v[52:55], v[28:31]
    ds_read_b128 v[112:115], v224 offset:8448
    s_waitcnt lgkmcnt(4)
    v_mfma_f32_16x16x32_bf16 v[28:31], v[84:87], v[96:99], v[28:31]
    s_waitcnt lgkmcnt(3)
    v_mfma_f32_16x16x32_bf16 v[28:31], v[48:51], v[104:107], v[28:31]
    v_mov_b32 v182, s22
    v_mov_b32 v183, s23
    s_mov_b64 s[32:33], exec
    s_mov_b64 exec, 1
    buffer_store_dwordx2 v[182:183], v6, s[8:11], s4 offen sc0 sc1
    s_mov_b64 exec, s[32:33]
    v_mfma_f32_16x16x32_bf16 v[38:41], v[84:87], v[52:55], v[38:41]
    s_add_u32 s16, s14, s15
    buffer_load_dwordx4 a[0:3], v60, s[8:11], s16 offen offset:0 sc0 sc1
    v_mfma_f32_16x16x32_bf16 v[38:41], v[56:59], v[104:107], v[38:41]
    v_mfma_f32_16x16x32_bf16 v[42:45], v[84:87], v[104:107], v[42:45]
    buffer_load_dwordx4 a[4:7], v60, s[8:11], s16 offen offset:1024 sc0 sc1
    s_waitcnt lgkmcnt(1)
    v_mfma_f32_16x16x32_bf16 v[38:41], v[92:95], v[96:99], v[38:41]
    ds_read_b64 v[100:101], v221 offset:2112
    ds_read_b64 v[102:103], v221 offset:2120
    s_waitcnt lgkmcnt(2)
    v_mfma_f32_16x16x32_bf16 v[38:41], v[48:51], v[112:115], v[38:41]
    ds_read_b128 v[74:77], v224 offset:6400
    v_mfma_f32_16x16x32_bf16 v[42:45], v[92:95], v[52:55], v[42:45]
    v_mfma_f32_16x16x32_bf16 v[42:45], v[56:59], v[112:115], v[42:45]
    buffer_load_dwordx4 a[8:11], v60, s[8:11], s16 offen offset:2048 sc0 sc1
    v_mfma_f32_16x16x32_bf16 v[62:65], v[92:95], v[104:107], v[62:65]
    v_mfma_f32_16x16x32_bf16 v[62:65], v[84:87], v[112:115], v[62:65]
    buffer_load_dwordx4 a[12:15], v60, s[8:11], s16 offen offset:3072 sc0 sc1
    v_mfma_f32_16x16x32_bf16 v[66:69], v[92:95], v[112:115], v[66:69]
    s_waitcnt lgkmcnt(1)
    v_mfma_f32_16x16x32_bf16 v[42:45], v[100:103], v[96:99], v[42:45]
    s_add_u32 s15, s15, 4096
    s_and_b32 s15, s15, 0xffff
    s_add_u32 s16, s14, s15
    buffer_load_dwordx4 a[16:19], v60, s[8:11], s16 offen offset:0 sc0 sc1
    s_waitcnt lgkmcnt(0)
    v_mfma_f32_16x16x32_bf16 v[42:45], v[48:51], v[74:77], v[42:45]
    ds_read_b64 v[108:109], v221 offset:2624
    ds_read_b64 v[110:111], v221 offset:2632
    v_mfma_f32_16x16x32_bf16 v[62:65], v[100:103], v[52:55], v[62:65]
    ds_read_b128 v[120:123], v224 offset:4352
    v_mfma_f32_16x16x32_bf16 v[62:65], v[56:59], v[74:77], v[62:65]
    v_mfma_f32_16x16x32_bf16 v[66:69], v[100:103], v[104:107], v[66:69]
    buffer_load_dwordx4 a[20:23], v60, s[8:11], s16 offen offset:1024 sc0 sc1
    v_mfma_f32_16x16x32_bf16 v[66:69], v[84:87], v[74:77], v[66:69]
    v_mfma_f32_16x16x32_bf16 v[70:73], v[100:103], v[112:115], v[70:73]
    buffer_load_dwordx4 a[24:27], v60, s[8:11], s16 offen offset:2048 sc0 sc1
    v_mfma_f32_16x16x32_bf16 v[70:73], v[92:95], v[74:77], v[70:73]
    ds_read_b64 v[116:117], v221 offset:3136
    ds_read_b64 v[118:119], v221 offset:3144
    s_waitcnt lgkmcnt(3)
    v_mfma_f32_16x16x32_bf16 v[62:65], v[108:111], v[96:99], v[62:65]
    ds_read_b128 v[88:91], v224 offset:2304
    s_waitcnt lgkmcnt(3)
    v_mfma_f32_16x16x32_bf16 v[62:65], v[48:51], v[120:123], v[62:65]
    v_mfma_f32_16x16x32_bf16 v[66:69], v[108:111], v[52:55], v[66:69]
    buffer_load_dwordx4 a[28:31], v60, s[8:11], s16 offen offset:3072 sc0 sc1
    v_mfma_f32_16x16x32_bf16 v[66:69], v[56:59], v[120:123], v[66:69]
    ds_read_b64 v[100:101], v221 offset:3648
    ds_read_b64 v[102:103], v221 offset:3656
    v_mfma_f32_16x16x32_bf16 v[70:73], v[108:111], v[104:107], v[70:73]
    ds_read_b128 v[112:115], v224 offset:256
    v_mfma_f32_16x16x32_bf16 v[70:73], v[84:87], v[120:123], v[70:73]
    ds_read_b64 v[92:93], v221 offset:0
    ds_read_b64 v[94:95], v221 offset:8
    s_waitcnt lgkmcnt(6)
    v_mfma_f32_16x16x32_bf16 v[66:69], v[116:119], v[96:99], v[66:69]
    ds_read_b128 v[74:77], v225 offset:14336
    s_waitcnt lgkmcnt(6)
    v_mfma_f32_16x16x32_bf16 v[66:69], v[48:51], v[88:91], v[66:69]
    ds_read_b64 v[108:109], v221 offset:512
    ds_read_b64 v[110:111], v221 offset:520
    v_mfma_f32_16x16x32_bf16 v[70:73], v[116:119], v[52:55], v[70:73]
    ds_read_b128 v[104:107], v225 offset:12288
    v_mfma_f32_16x16x32_bf16 v[70:73], v[56:59], v[88:91], v[70:73]
    ds_read_b64 v[84:85], v221 offset:1024
    ds_read_b64 v[86:87], v221 offset:1032
    s_waitcnt lgkmcnt(9)
    v_mfma_f32_16x16x32_bf16 v[70:73], v[100:103], v[96:99], v[70:73]
    ds_read_b128 v[120:123], v225 offset:10240
    s_waitcnt lgkmcnt(9)
    v_mfma_f32_16x16x32_bf16 v[70:73], v[48:51], v[112:115], v[70:73]
    s_waitcnt lgkmcnt(6)
    v_mfma_f32_16x16x32_bf16 v[20:23], v[92:95], v[74:77], v[20:23]
    s_add_u32 s15, s15, 4096
    s_and_b32 s15, s15, 0xffff
    s_add_u32 s16, s14, s15
    buffer_load_dwordx4 a[32:35], v60, s[8:11], s16 offen offset:0 sc0 sc1
    s_waitcnt lgkmcnt(4)
    v_mfma_f32_16x16x32_bf16 v[24:27], v[108:111], v[74:77], v[24:27]
    s_waitcnt lgkmcnt(3)
    v_mfma_f32_16x16x32_bf16 v[24:27], v[92:95], v[104:107], v[24:27]
    ds_read_b64 v[116:117], v221 offset:1536
    ds_read_b64 v[118:119], v221 offset:1544
    v_mfma_f32_16x16x32_bf16 v[28:31], v[108:111], v[104:107], v[28:31]
    ds_read_b128 v[52:55], v225 offset:8192
    s_waitcnt lgkmcnt(4)
    v_mfma_f32_16x16x32_bf16 v[28:31], v[84:87], v[74:77], v[28:31]
    buffer_load_dwordx4 a[36:39], v60, s[8:11], s16 offen offset:1024 sc0 sc1
    s_waitcnt lgkmcnt(3)
    v_mfma_f32_16x16x32_bf16 v[28:31], v[92:95], v[120:123], v[28:31]
    v_mfma_f32_16x16x32_bf16 v[38:41], v[84:87], v[104:107], v[38:41]
    buffer_load_dwordx4 a[40:43], v60, s[8:11], s16 offen offset:2048 sc0 sc1
    v_mfma_f32_16x16x32_bf16 v[38:41], v[108:111], v[120:123], v[38:41]
    v_mfma_f32_16x16x32_bf16 v[42:45], v[84:87], v[120:123], v[42:45]
    buffer_load_dwordx4 a[44:47], v60, s[8:11], s16 offen offset:3072 sc0 sc1
    s_waitcnt lgkmcnt(1)
    v_mfma_f32_16x16x32_bf16 v[38:41], v[116:119], v[74:77], v[38:41]
    ds_read_b64 v[56:57], v221 offset:2048
    ds_read_b64 v[58:59], v221 offset:2056
    s_waitcnt lgkmcnt(2)
    v_mfma_f32_16x16x32_bf16 v[38:41], v[92:95], v[52:55], v[38:41]
    ds_read_b128 v[88:91], v225 offset:6144
    v_mfma_f32_16x16x32_bf16 v[42:45], v[116:119], v[104:107], v[42:45]
    v_mfma_f32_16x16x32_bf16 v[42:45], v[108:111], v[52:55], v[42:45]
    s_add_u32 s15, s15, 4096
    s_and_b32 s15, s15, 0xffff
    s_add_u32 s16, s14, s15
    buffer_load_dwordx4 a[48:51], v60, s[8:11], s16 offen offset:0 sc0 sc1
    v_mfma_f32_16x16x32_bf16 v[62:65], v[116:119], v[120:123], v[62:65]
    v_mfma_f32_16x16x32_bf16 v[62:65], v[84:87], v[52:55], v[62:65]
    buffer_load_dwordx4 a[52:55], v60, s[8:11], s16 offen offset:1024 sc0 sc1
    v_mfma_f32_16x16x32_bf16 v[66:69], v[116:119], v[52:55], v[66:69]
    s_waitcnt lgkmcnt(1)
    v_mfma_f32_16x16x32_bf16 v[42:45], v[56:59], v[74:77], v[42:45]
    buffer_load_dwordx4 a[56:59], v60, s[8:11], s16 offen offset:2048 sc0 sc1
    s_waitcnt lgkmcnt(0)
    v_mfma_f32_16x16x32_bf16 v[42:45], v[92:95], v[88:91], v[42:45]
    ds_read_b64 v[100:101], v221 offset:2560
    ds_read_b64 v[102:103], v221 offset:2568
    v_mfma_f32_16x16x32_bf16 v[62:65], v[56:59], v[104:107], v[62:65]
    ds_read_b128 v[96:99], v225 offset:4096
    v_mfma_f32_16x16x32_bf16 v[62:65], v[108:111], v[88:91], v[62:65]
    v_mfma_f32_16x16x32_bf16 v[66:69], v[56:59], v[120:123], v[66:69]
    buffer_load_dwordx4 a[60:63], v60, s[8:11], s16 offen offset:3072 sc0 sc1
    v_mfma_f32_16x16x32_bf16 v[66:69], v[84:87], v[88:91], v[66:69]
    v_mfma_f32_16x16x32_bf16 v[70:73], v[56:59], v[52:55], v[70:73]
    s_add_u32 s15, s15, 4096
    s_and_b32 s15, s15, 0xffff
    s_add_u32 s16, s14, s15
    buffer_load_dwordx4 a[64:67], v60, s[8:11], s16 offen offset:0 sc0 sc1
    v_mfma_f32_16x16x32_bf16 v[70:73], v[116:119], v[88:91], v[70:73]
    ds_read_b64 v[48:49], v221 offset:3072
    ds_read_b64 v[50:51], v221 offset:3080
    s_waitcnt lgkmcnt(3)
    v_mfma_f32_16x16x32_bf16 v[62:65], v[100:103], v[74:77], v[62:65]
    ds_read_b128 v[112:115], v225 offset:2048
    s_waitcnt lgkmcnt(3)
    v_mfma_f32_16x16x32_bf16 v[62:65], v[92:95], v[96:99], v[62:65]
    v_mfma_f32_16x16x32_bf16 v[66:69], v[100:103], v[104:107], v[66:69]
    buffer_load_dwordx4 a[68:71], v60, s[8:11], s16 offen offset:1024 sc0 sc1
    v_mfma_f32_16x16x32_bf16 v[66:69], v[108:111], v[96:99], v[66:69]
    ds_read_b64 v[56:57], v221 offset:3584
    ds_read_b64 v[58:59], v221 offset:3592
    v_mfma_f32_16x16x32_bf16 v[70:73], v[100:103], v[120:123], v[70:73]
    ds_read_b128 v[52:55], v225 offset:0
    v_mfma_f32_16x16x32_bf16 v[70:73], v[84:87], v[96:99], v[70:73]
    s_waitcnt lgkmcnt(4)
    v_mfma_f32_16x16x32_bf16 v[66:69], v[48:51], v[74:77], v[66:69]
    buffer_load_dwordx4 a[72:75], v60, s[8:11], s16 offen offset:2048 sc0 sc1
    s_waitcnt lgkmcnt(3)
    v_mfma_f32_16x16x32_bf16 v[66:69], v[92:95], v[112:115], v[66:69]
    v_mfma_f32_16x16x32_bf16 v[70:73], v[48:51], v[104:107], v[70:73]
    buffer_load_dwordx4 a[76:79], v60, s[8:11], s16 offen offset:3072 sc0 sc1
    v_mfma_f32_16x16x32_bf16 v[70:73], v[108:111], v[112:115], v[70:73]
    s_waitcnt lgkmcnt(1)
    v_mfma_f32_16x16x32_bf16 v[70:73], v[56:59], v[74:77], v[70:73]
    s_add_u32 s15, s15, 4096
    s_and_b32 s15, s15, 0xffff
    s_add_u32 s16, s14, s15
    buffer_load_dwordx4 a[80:83], v60, s[8:11], s16 offen offset:0 sc0 sc1
    s_waitcnt lgkmcnt(0)
    v_mfma_f32_16x16x32_bf16 v[70:73], v[92:95], v[52:55], v[70:73]
    buffer_load_dwordx4 a[84:87], v60, s[8:11], s16 offen offset:1024 sc0 sc1
    buffer_load_dwordx4 a[88:91], v60, s[8:11], s16 offen offset:2048 sc0 sc1
    buffer_load_dwordx4 a[92:95], v60, s[8:11], s16 offen offset:3072 sc0 sc1
    s_add_u32 s15, s15, 4096
    s_and_b32 s15, s15, 0xffff
    s_add_u32 s16, s14, s15
    buffer_load_dwordx4 a[96:99], v60, s[8:11], s16 offen offset:0 sc0 sc1
    buffer_load_dwordx4 a[100:103], v60, s[8:11], s16 offen offset:1024 sc0 sc1
    buffer_load_dwordx4 a[104:107], v60, s[8:11], s16 offen offset:2048 sc0 sc1
    buffer_load_dwordx4 a[108:111], v60, s[8:11], s16 offen offset:3072 sc0 sc1
    s_add_u32 s15, s15, 4096
    s_and_b32 s15, s15, 0xffff
    s_add_u32 s16, s14, s15
    buffer_load_dwordx4 a[112:115], v60, s[8:11], s16 offen offset:0 sc0 sc1
    buffer_load_dwordx4 a[116:119], v60, s[8:11], s16 offen offset:1024 sc0 sc1
    buffer_load_dwordx4 a[120:123], v60, s[8:11], s16 offen offset:2048 sc0 sc1
    buffer_load_dwordx4 a[124:127], v60, s[8:11], s16 offen offset:3072 sc0 sc1
    s_add_u32 s15, s15, 4096
    s_and_b32 s15, s15, 0xffff
    s_add_u32 s16, s14, s15
    buffer_load_dwordx4 a[128:131], v60, s[8:11], s16 offen offset:0 sc0 sc1
    buffer_load_dwordx4 a[132:135], v60, s[8:11], s16 offen offset:1024 sc0 sc1
    buffer_load_dwordx4 a[136:139], v60, s[8:11], s16 offen offset:2048 sc0 sc1
    buffer_load_dwordx4 a[140:143], v60, s[8:11], s16 offen offset:3072 sc0 sc1
    s_add_u32 s15, s15, 4096
    s_and_b32 s15, s15, 0xffff
    s_add_u32 s16, s14, s15
    buffer_load_dwordx4 a[144:147], v60, s[8:11], s16 offen offset:0 sc0 sc1
    buffer_load_dwordx4 a[148:151], v60, s[8:11], s16 offen offset:1024 sc0 sc1
    buffer_load_dwordx4 a[152:155], v60, s[8:11], s16 offen offset:2048 sc0 sc1
    buffer_load_dwordx4 a[156:159], v60, s[8:11], s16 offen offset:3072 sc0 sc1
    s_add_u32 s15, s15, 4096
    s_and_b32 s15, s15, 0xffff
    s_add_u32 s16, s14, s15
    buffer_load_dwordx4 a[160:163], v60, s[8:11], s16 offen offset:0 sc0 sc1
    buffer_load_dwordx4 a[164:167], v60, s[8:11], s16 offen offset:1024 sc0 sc1
    buffer_load_dwordx4 a[168:171], v60, s[8:11], s16 offen offset:2048 sc0 sc1
    buffer_load_dwordx4 a[172:175], v60, s[8:11], s16 offen offset:3072 sc0 sc1
    s_add_u32 s15, s15, 4096
    s_and_b32 s15, s15, 0xffff
    s_add_u32 s16, s14, s15
    buffer_load_dwordx4 a[176:179], v60, s[8:11], s16 offen offset:0 sc0 sc1
    buffer_load_dwordx4 a[180:183], v60, s[8:11], s16 offen offset:1024 sc0 sc1
    buffer_load_dwordx4 a[184:187], v60, s[8:11], s16 offen offset:2048 sc0 sc1
    buffer_load_dwordx4 a[188:191], v60, s[8:11], s16 offen offset:3072 sc0 sc1
    s_add_u32 s15, s15, 4096
    s_and_b32 s15, s15, 0xffff
    s_add_u32 s16, s14, s15
    buffer_load_dwordx4 a[192:195], v60, s[8:11], s16 offen offset:0 sc0 sc1
    buffer_load_dwordx4 a[196:199], v60, s[8:11], s16 offen offset:1024 sc0 sc1
    buffer_load_dwordx4 a[200:203], v60, s[8:11], s16 offen offset:2048 sc0 sc1
    buffer_load_dwordx4 a[204:207], v60, s[8:11], s16 offen offset:3072 sc0 sc1
    s_add_u32 s15, s15, 4096
    s_and_b32 s15, s15, 0xffff
    s_add_u32 s16, s14, s15
    buffer_load_dwordx4 a[208:211], v60, s[8:11], s16 offen offset:0 sc0 sc1
    buffer_load_dwordx4 a[212:215], v60, s[8:11], s16 offen offset:1024 sc0 sc1
    buffer_load_dwordx4 a[216:219], v60, s[8:11], s16 offen offset:2048 sc0 sc1
    buffer_load_dwordx4 a[220:223], v60, s[8:11], s16 offen offset:3072 sc0 sc1
    buffer_load_dwordx2 v[182:183], v81, s[8:11], 0 offen sc0 sc1
    s_barrier
    s_mov_b32 s32, 0
    s_waitcnt vmcnt(0)
    v_cmp_ne_u64 vcc, s[22:23], v[182:183]
    s_nop 4
    s_cbranch_vccz Lfdone_gate_11
Lfpoll_gate_12:
    buffer_load_dwordx2 v[182:183], v81, s[8:11], 0 offen sc0 sc1
    s_waitcnt vmcnt(0)
    v_cmp_ne_u64 vcc, s[22:23], v[182:183]
    s_nop 4
    s_add_u32 s32, s32, 1
    s_cmp_gt_u32 s32, 20000
    s_cbranch_scc1 Lfdone_gate_11
    s_cbranch_vccnz Lfpoll_gate_12
Lfdone_gate_11:
    s_add_u32 s12, s12, 256
    s_and_b32 s12, s12, 0xfff
    s_add_u32 s28, s7, s12
    s_add_u32 m0, s17, 0
    s_nop 0
    buffer_load_dwordx4 v2, s[8:11], s28 offen sc0 sc1 lds
    s_add_u32 m0, s17, 1024
    s_nop 0
    buffer_load_dwordx4 v3, s[8:11], s28 offen sc0 sc1 lds
    s_add_u32 m0, s17, 2048
    s_nop 0
    buffer_load_dwordx4 v4, s[8:11], s28 offen sc0 sc1 lds
    s_add_u32 m0, s17, 3072
    s_nop 0
    buffer_load_dwordx4 v5, s[8:11], s28 offen sc0 sc1 lds
    s_add_u32 s29, s28, 65536
    s_add_u32 m0, s17, 4096
    s_nop 0
    buffer_load_dwordx4 v2, s[8:11], s29 offen sc0 sc1 lds
    s_add_u32 m0, s17, 5120
    s_nop 0
    buffer_load_dwordx4 v3, s[8:11], s29 offen sc0 sc1 lds
    s_add_u32 m0, s17, 6144
    s_nop 0
    buffer_load_dwordx4 v4, s[8:11], s29 offen sc0 sc1 lds
    s_add_u32 m0, s17, 7168
    s_nop 0
    buffer_load_dwordx4 v5, s[8:11], s29 offen sc0 sc1 lds
    s_add_u32 s12, s12, 256
    s_and_b32 s12, s12, 0xfff
    s_add_u32 s28, s7, s12
    s_add_u32 m0, s17, 32768
    s_nop 0
    buffer_load_dwordx4 v2, s[8:11], s28 offen sc0 sc1 lds
    s_add_u32 m0, s17, 33792
    s_nop 0
    buffer_load_dwordx4 v3, s[8:11], s28 offen sc0 sc1 lds
    s_add_u32 m0, s17, 34816
    s_nop 0
    buffer_load_dwordx4 v4, s[8:11], s28 offen sc0 sc1 lds
    s_add_u32 m0, s17, 35840
    s_nop 0
    buffer_load_dwordx4 v5, s[8:11], s28 offen sc0 sc1 lds
    s_add_u32 s29, s28, 65536
    s_add_u32 m0, s17, 36864
    s_nop 0
    buffer_load_dwordx4 v2, s[8:11], s29 offen sc0 sc1 lds
    s_add_u32 m0, s17, 37888
    s_nop 0
    buffer_load_dwordx4 v3, s[8:11], s29 offen sc0 sc1 lds
    s_add_u32 m0, s17, 38912
    s_nop 0
    buffer_load_dwordx4 v4, s[8:11], s29 offen sc0 sc1 lds
    s_add_u32 m0, s17, 39936
    s_nop 0
    buffer_load_dwordx4 v5, s[8:11], s29 offen sc0 sc1 lds
    s_add_u32 s12, s12, 256
    s_and_b32 s12, s12, 0xfff
    s_add_u32 s28, s7, s12
    s_add_u32 m0, s17, 65536
    s_nop 0
    buffer_load_dwordx4 v2, s[8:11], s28 offen sc0 sc1 lds
    s_add_u32 m0, s17, 66560
    s_nop 0
    buffer_load_dwordx4 v3, s[8:11], s28 offen sc0 sc1 lds
    s_add_u32 m0, s17, 67584
    s_nop 0
    buffer_load_dwordx4 v4, s[8:11], s28 offen sc0 sc1 lds
    s_add_u32 m0, s17, 68608
    s_nop 0
    buffer_load_dwordx4 v5, s[8:11], s28 offen sc0 sc1 lds
    s_add_u32 s29, s28, 65536
    s_add_u32 m0, s17, 69632
    s_nop 0
    buffer_load_dwordx4 v2, s[8:11], s29 offen sc0 sc1 lds
    s_add_u32 m0, s17, 70656
    s_nop 0
    buffer_load_dwordx4 v3, s[8:11], s29 offen sc0 sc1 lds
    s_add_u32 m0, s17, 71680
    s_nop 0
    buffer_load_dwordx4 v4, s[8:11], s29 offen sc0 sc1 lds
    s_add_u32 m0, s17, 72704
    s_nop 0
    buffer_load_dwordx4 v5, s[8:11], s29 offen sc0 sc1 lds
    ds_read_b64 v[46:47], v226 offset:14336
    ds_read_b64 v[48:49], v226 offset:12288
    ds_read_b64 v[50:51], v226 offset:10240
    ds_read_b64 v[52:53], v226 offset:8192
    ds_read_b64 v[54:55], v226 offset:6144
    ds_read_b64 v[56:57], v226 offset:4096
    ds_read_b64 v[58:59], v226 offset:2048
    ds_read_b64 v[74:75], v226 offset:0
    s_add_u32 s4, s18, 12582912
    s_waitcnt lgkmcnt(7)
    v_and_b32 v76, s5, v47
    v_lshlrev_b32 v77, 16, v47
    v_and_b32 v78, s5, v46
    v_lshlrev_b32 v79, 16, v46
    v_fmac_f32 v20, v82, v76
    v_fmac_f32 v21, v82, v77
    v_fmac_f32 v22, v82, v78
    v_fmac_f32 v23, v82, v79
    v_cvt_pk_bf16_f32 v84, v20, v21
    v_cvt_pk_bf16_f32 v85, v22, v23
    s_waitcnt lgkmcnt(6)
    v_and_b32 v76, s5, v49
    v_lshlrev_b32 v77, 16, v49
    v_and_b32 v78, s5, v48
    v_lshlrev_b32 v79, 16, v48
    v_fmac_f32 v24, v82, v76
    v_fmac_f32 v25, v82, v77
    v_fmac_f32 v26, v82, v78
    v_fmac_f32 v27, v82, v79
    v_cvt_pk_bf16_f32 v86, v24, v25
    v_cvt_pk_bf16_f32 v87, v26, v27
    s_nop 0
    v_permlane16_swap_b32 v84, v86
    v_permlane16_swap_b32 v85, v87
    buffer_store_dwordx4 v[84:87], v227, s[8:11], s4 offen offset:0 sc0 sc1
    s_waitcnt lgkmcnt(5)
    v_and_b32 v76, s5, v51
    v_lshlrev_b32 v77, 16, v51
    v_and_b32 v78, s5, v50
    v_lshlrev_b32 v79, 16, v50
    v_fmac_f32 v28, v82, v76
    v_fmac_f32 v29, v82, v77
    v_fmac_f32 v30, v82, v78
    v_fmac_f32 v31, v82, v79
    v_cvt_pk_bf16_f32 v88, v28, v29
    v_cvt_pk_bf16_f32 v89, v30, v31
    s_waitcnt lgkmcnt(4)
    v_and_b32 v76, s5, v53
    v_lshlrev_b32 v77, 16, v53
    v_and_b32 v78, s5, v52
    v_lshlrev_b32 v79, 16, v52
    v_fmac_f32 v38, v82, v76
    v_fmac_f32 v39, v82, v77
    v_fmac_f32 v40, v82, v78
    v_fmac_f32 v41, v82, v79
    v_cvt_pk_bf16_f32 v90, v38, v39
    v_cvt_pk_bf16_f32 v91, v40, v41
    s_nop 0
    v_permlane16_swap_b32 v88, v90
    v_permlane16_swap_b32 v89, v91
    buffer_store_dwordx4 v[88:91], v227, s[8:11], s4 offen offset:1024 sc0 sc1
    s_waitcnt lgkmcnt(3)
    v_and_b32 v76, s5, v55
    v_lshlrev_b32 v77, 16, v55
    v_and_b32 v78, s5, v54
    v_lshlrev_b32 v79, 16, v54
    v_fmac_f32 v42, v82, v76
    v_fmac_f32 v43, v82, v77
    v_fmac_f32 v44, v82, v78
    v_fmac_f32 v45, v82, v79
    v_cvt_pk_bf16_f32 v84, v42, v43
    v_cvt_pk_bf16_f32 v85, v44, v45
    s_waitcnt lgkmcnt(2)
    v_and_b32 v76, s5, v57
    v_lshlrev_b32 v77, 16, v57
    v_and_b32 v78, s5, v56
    v_lshlrev_b32 v79, 16, v56
    v_fmac_f32 v62, v82, v76
    v_fmac_f32 v63, v82, v77
    v_fmac_f32 v64, v82, v78
    v_fmac_f32 v65, v82, v79
    v_cvt_pk_bf16_f32 v86, v62, v63
    v_cvt_pk_bf16_f32 v87, v64, v65
    s_nop 0
    v_permlane16_swap_b32 v84, v86
    v_permlane16_swap_b32 v85, v87
    buffer_store_dwordx4 v[84:87], v227, s[8:11], s4 offen offset:2048 sc0 sc1
    s_waitcnt lgkmcnt(1)
    v_and_b32 v76, s5, v59
    v_lshlrev_b32 v77, 16, v59
    v_and_b32 v78, s5, v58
    v_lshlrev_b32 v79, 16, v58
    v_fmac_f32 v66, v82, v76
    v_fmac_f32 v67, v82, v77
    v_fmac_f32 v68, v82, v78
    v_fmac_f32 v69, v82, v79
    v_cvt_pk_bf16_f32 v88, v66, v67
    v_cvt_pk_bf16_f32 v89, v68, v69
    s_waitcnt lgkmcnt(0)
    v_and_b32 v76, s5, v75
    v_lshlrev_b32 v77, 16, v75
    v_and_b32 v78, s5, v74
    v_lshlrev_b32 v79, 16, v74
    v_fmac_f32 v70, v82, v76
    v_fmac_f32 v71, v82, v77
    v_fmac_f32 v72, v82, v78
    v_fmac_f32 v73, v82, v79
    v_cvt_pk_bf16_f32 v90, v70, v71
    v_cvt_pk_bf16_f32 v91, v72, v73
    s_nop 0
    v_permlane16_swap_b32 v88, v90
    v_permlane16_swap_b32 v89, v91
    buffer_store_dwordx4 v[88:91], v227, s[8:11], s4 offen offset:3072 sc0 sc1
    s_barrier
    ds_read_b128 v[20:23], v13 offset:32768
    ds_read_b128 v[24:27], v13 offset:40960
    ds_read_b128 v[28:31], v33 offset:32768
    ds_read_b128 v[40:43], v33 offset:40960
    s_waitcnt lgkmcnt(3)
    v_mfma_f32_32x32x16_bf16 v[64:79], v[20:23], a[0:3], 0
    ds_read_b128 v[44:47], v14 offset:32768
    ds_read_b128 v[48:51], v14 offset:40960
    s_add_u32 s15, s15, 4096
    s_and_b32 s15, s15, 0xffff
    s_add_u32 s16, s14, s15
    buffer_load_dwordx4 a[224:227], v60, s[8:11], s16 offen offset:0 sc0 sc1
    buffer_load_dwordx4 a[228:231], v60, s[8:11], s16 offen offset:1024 sc0 sc1
    buffer_load_dwordx4 a[232:235], v60, s[8:11], s16 offen offset:2048 sc0 sc1
    s_waitcnt lgkmcnt(4)
    v_mfma_f32_32x32x16_bf16 v[84:99], v[24:27], a[0:3], 0
    ds_read_b128 v[52:55], v34 offset:32768
    ds_read_b128 v[56:59], v34 offset:40960
    buffer_load_dwordx4 a[236:239], v60, s[8:11], s16 offen offset:3072 sc0 sc1
    s_add_u32 s15, s15, 4096
    s_and_b32 s15, s15, 0xffff
    s_add_u32 s16, s14, s15
    buffer_load_dwordx4 a[240:243], v60, s[8:11], s16 offen offset:0 sc0 sc1
    buffer_load_dwordx4 a[244:247], v60, s[8:11], s16 offen offset:1024 sc0 sc1
    s_waitcnt lgkmcnt(5)
    v_mfma_f32_32x32x16_bf16 v[100:115], v[28:31], a[0:3], 0
    buffer_load_dwordx4 a[248:251], v60, s[8:11], s16 offen offset:2048 sc0 sc1
    buffer_load_dwordx4 a[252:255], v60, s[8:11], s16 offen offset:3072 sc0 sc1
    s_mov_b32 s32, s20
    s_mov_b32 s33, s21
    s_mov_b32 s34, 2048
    s_waitcnt lgkmcnt(4)
    v_mfma_f32_32x32x16_bf16 v[116:131], v[40:43], a[0:3], 0
    s_mov_b32 s35, 131072
    s_mov_b32 s48, s36
    s_mov_b32 s49, s37
    s_mov_b32 s50, 8388608
    s_mov_b32 s51, 131072
    s_waitcnt lgkmcnt(3)
    v_mfma_f32_32x32x16_bf16 v[64:79], v[44:47], a[4:7], v[64:79]
    ds_read_b128 v[20:23], v15 offset:32768
    ds_read_b128 v[24:27], v15 offset:40960
    s_lshr_b32 s4, s42, 1
    s_and_b32 s13, s42, 1
    v_bfe_u32 v7, v1, 4, 1
    s_waitcnt lgkmcnt(4)
    v_mfma_f32_32x32x16_bf16 v[84:99], v[48:51], a[4:7], v[84:99]
    ds_read_b128 v[28:31], v35 offset:32768
    ds_read_b128 v[40:43], v35 offset:40960
    v_lshlrev_b32 v7, 2, v7
    v_and_b32 v8, 7, v1
    v_xor_b32 v8, v8, v7
    s_waitcnt lgkmcnt(5)
    v_mfma_f32_32x32x16_bf16 v[100:115], v[52:55], a[4:7], v[100:115]
    v_lshlrev_b32 v8, 4, v8
    v_lshrrev_b32 v7, 3, v1
    v_lshl_add_u32 v38, v7, 11, v8
    s_lshl_b32 s18, s43, 18
    s_lshl_b32 s3, s42, 16
    s_waitcnt lgkmcnt(4)
    v_mfma_f32_32x32x16_bf16 v[116:131], v[56:59], a[4:7], v[116:131]
    s_add_u32 s18, s18, s3
    s_lshl_b32 s3, s44, 7
    s_add_u32 s18, s18, s3
    s_lshl_b32 s19, s44, 18
    s_lshl_b32 s3, s42, 16
    s_waitcnt lgkmcnt(3)
    v_mfma_f32_32x32x16_bf16 v[64:79], v[20:23], a[8:11], v[64:79]
    ds_read_b128 v[44:47], v16 offset:32768
    ds_read_b128 v[48:51], v16 offset:40960
    s_add_u32 s19, s19, s3
    s_lshl_b32 s3, s43, 8
    s_add_u32 s19, s19, s3
    s_waitcnt lgkmcnt(4)
    v_mfma_f32_32x32x16_bf16 v[84:99], v[24:27], a[8:11], v[84:99]
    ds_read_b128 v[52:55], v36 offset:32768
    ds_read_b128 v[56:59], v36 offset:40960
    s_add_u32 s19, s19, 12582912
    v_bfe_u32 v37, v1, 2, 2
    v_bfe_u32 v7, v1, 4, 1
    s_waitcnt lgkmcnt(5)
    v_mfma_f32_32x32x16_bf16 v[100:115], v[28:31], a[8:11], v[100:115]
    v_lshlrev_b32 v7, 1, v7
    v_bfe_u32 v8, v1, 1, 1
    v_add_u32 v7, v7, v8
    s_lshl_b32 s3, s13, 2
    v_add_u32 v7, s3, v7
    s_waitcnt lgkmcnt(4)
    v_mfma_f32_32x32x16_bf16 v[116:131], v[40:43], a[8:11], v[116:131]
    v_bfe_u32 v8, v1, 3, 1
    v_lshlrev_b32 v8, 2, v8
    v_xor_b32 v7, v7, v8
    v_lshlrev_b32 v7, 4, v7
    v_and_b32 v8, 1, v1
    s_waitcnt lgkmcnt(0)
    s_waitcnt vmcnt(28)
    s_barrier
    v_mfma_f32_32x32x16_bf16 v[64:79], v[44:47], a[12:15], v[64:79]
    ds_read_b128 v[20:23], v9 offset:0
    ds_read_b128 v[24:27], v9 offset:8192
    v_lshl_add_u32 v7, v8, 3, v7
    v_lshrrev_b32 v8, 5, v1
    v_lshl_add_u32 v37, v8, 2, v37
    v_mfma_f32_32x32x16_bf16 v[84:99], v[48:51], a[12:15], v[84:99]
    ds_read_b128 v[28:31], v17 offset:0
    ds_read_b128 v[40:43], v17 offset:8192
    s_add_u32 s12, s12, 256
    s_and_b32 s12, s12, 0xfff
    s_add_u32 s28, s7, s12
    s_add_u32 m0, s17, 98304
    v_mfma_f32_32x32x16_bf16 v[100:115], v[52:55], a[12:15], v[100:115]
    buffer_load_dwordx4 v2, s[8:11], s28 offen sc0 sc1 lds
    v_lshl_add_u32 v7, v37, 7, v7
    s_lshl_b32 s3, s4, 13
    s_add_u32 s3, s3, 131072
    s_add_u32 m0, s17, 99328
    v_mfma_f32_32x32x16_bf16 v[116:131], v[56:59], a[12:15], v[116:131]
    buffer_load_dwordx4 v3, s[8:11], s28 offen sc0 sc1 lds
    v_add_u32 v39, s3, v7
    v_and_b32 v7, 15, v1
    s_lshl_b32 s3, s4, 3
    v_xor_b32 v7, s3, v7
    s_waitcnt lgkmcnt(3)
    v_mfma_f32_32x32x16_bf16 v[64:79], v[20:23], a[16:19], v[64:79]
    ds_read_b128 v[44:47], v10 offset:0
    ds_read_b128 v[48:51], v10 offset:8192
    v_lshlrev_b32 v7, 4, v7
    v_and_b32 v37, 31, v1
    v_lshl_add_u32 v7, v37, 8, v7
    s_waitcnt lgkmcnt(4)
    v_mfma_f32_32x32x16_bf16 v[84:99], v[24:27], a[16:19], v[84:99]
    ds_read_b128 v[52:55], v18 offset:0
    ds_read_b128 v[56:59], v18 offset:8192
    v_lshl_add_u32 v7, v8, 3, v7
    s_lshl_b32 s3, s13, 13
    s_add_u32 m0, s17, 100352
    s_waitcnt lgkmcnt(5)
    v_mfma_f32_32x32x16_bf16 v[100:115], v[28:31], a[16:19], v[100:115]
    buffer_load_dwordx4 v4, s[8:11], s28 offen sc0 sc1 lds
    s_add_u32 s3, s3, 147456
    v_add_u32 v61, s3, v7
    v_and_b32 v7, 15, v1
    s_add_u32 m0, s17, 101376
    s_waitcnt lgkmcnt(4)
    v_mfma_f32_32x32x16_bf16 v[116:131], v[40:43], a[16:19], v[116:131]
    buffer_load_dwordx4 v5, s[8:11], s28 offen sc0 sc1 lds
    v_lshlrev_b32 v7, 4, v7
    v_and_b32 v37, 16, v1
    v_lshl_add_u32 v7, v37, 9, v7
    s_lshl_b32 s3, s43, 9
    s_waitcnt lgkmcnt(3)
    v_mfma_f32_32x32x16_bf16 v[64:79], v[44:47], a[20:23], v[64:79]
    ds_read_b128 v[20:23], v11 offset:0
    ds_read_b128 v[24:27], v11 offset:8192
    s_add_u32 s3, s3, 20971520
    v_add_u32 v7, s3, v7
    s_lshl_b32 s3, s4, 8
    s_waitcnt lgkmcnt(4)
    v_mfma_f32_32x32x16_bf16 v[84:99], v[48:51], a[20:23], v[84:99]
    ds_read_b128 v[28:31], v19 offset:0
    ds_read_b128 v[40:43], v19 offset:8192
    v_add_u32 v62, s3, v7
    s_add_u32 s29, s28, 65536
    s_add_u32 m0, s17, 102400
    s_waitcnt lgkmcnt(5)
    v_mfma_f32_32x32x16_bf16 v[100:115], v[52:55], a[20:23], v[100:115]
    buffer_load_dwordx4 v2, s[8:11], s29 offen sc0 sc1 lds
    s_lshl_b32 s3, s42, 10
    s_add_u32 s3, s3, 147456
    v_lshl_add_u32 v63, v8, 4, s3
    s_add_u32 m0, s17, 103424
    s_waitcnt lgkmcnt(4)
    v_mfma_f32_32x32x16_bf16 v[116:131], v[56:59], a[20:23], v[116:131]
    buffer_load_dwordx4 v3, s[8:11], s29 offen sc0 sc1 lds
    v_and_b32 v7, 31, v1
    s_lshl_b32 s3, s13, 5
    v_add_u32 v7, s3, v7
    s_lshl_b32 s3, s44, 6
    s_waitcnt lgkmcnt(3)
    v_mfma_f32_32x32x16_bf16 v[64:79], v[20:23], a[24:27], v[64:79]
    ds_read_b128 v[44:47], v12 offset:0
    ds_read_b128 v[48:51], v12 offset:8192
    v_add_u32 v7, s3, v7
    v_lshlrev_b32 v80, 1, v7
    v_lshlrev_b32 v8, 14, v8
    s_waitcnt lgkmcnt(4)
    v_mfma_f32_32x32x16_bf16 v[84:99], v[24:27], a[24:27], v[84:99]
    ds_read_b128 v[52:55], v32 offset:0
    ds_read_b128 v[56:59], v32 offset:8192
    v_lshl_add_u32 v132, v7, 2, v8
    v_add_u32 v133, 4096, v132
    s_add_u32 m0, s17, 104448
    s_waitcnt lgkmcnt(5)
    v_mfma_f32_32x32x16_bf16 v[100:115], v[28:31], a[24:27], v[100:115]
    buffer_load_dwordx4 v4, s[8:11], s29 offen sc0 sc1 lds
    v_add_u32 v134, 8192, v132
    v_add_u32 v135, 12288, v132
    s_lshl_b32 s30, s43, 19
    s_add_u32 m0, s17, 105472
    s_waitcnt lgkmcnt(4)
    v_mfma_f32_32x32x16_bf16 v[116:131], v[40:43], a[24:27], v[116:131]
    buffer_load_dwordx4 v5, s[8:11], s29 offen sc0 sc1 lds
    s_lshl_b32 s3, s4, 18
    s_add_u32 s30, s30, s3
    s_lshl_b32 s31, s42, 12
    s_lshl_b32 s3, s42, 13
    s_waitcnt lgkmcnt(0)
    s_waitcnt vmcnt(28)
    s_barrier
    v_mfma_f32_32x32x16_bf16 v[64:79], v[44:47], a[28:31], v[64:79]
    ds_read_b128 v[20:23], v9 offset:32768
    ds_read_b128 v[24:27], v9 offset:40960
    s_add_u32 s3, s3, 98304
    v_add_u32 v218, s3, v60
    v_xor_b32 v219, 0x4000, v218
    v_mfma_f32_32x32x16_bf16 v[84:99], v[48:51], a[28:31], v[84:99]
    ds_read_b128 v[28:31], v17 offset:32768
    ds_read_b128 v[40:43], v17 offset:40960
    s_add_u32 s12, s12, 256
    s_and_b32 s12, s12, 0xfff
    s_add_u32 s28, s7, s12
    s_add_u32 m0, s17, 0
    v_mfma_f32_32x32x16_bf16 v[100:115], v[52:55], a[28:31], v[100:115]
    buffer_load_dwordx4 v2, s[8:11], s28 offen sc0 sc1 lds
    s_lshl_b32 s3, s44, 9
    s_add_u32 s3, s3, 21520384
    v_lshrrev_b32 v81, 1, v60
    s_add_u32 m0, s17, 1024
    v_mfma_f32_32x32x16_bf16 v[116:131], v[56:59], a[28:31], v[116:131]
    buffer_load_dwordx4 v3, s[8:11], s28 offen sc0 sc1 lds
    v_add_u32 v81, s3, v81
    s_add_u32 m0, s31, 131072
    s_nop 0
    buffer_load_dwordx4 v38, s[56:59], s18 offen lds
    s_add_u32 s18, s18, 16384
    s_add_u32 m0, s31, 132096
    s_nop 0
    buffer_load_dwordx4 v38, s[56:59], s18 offen lds
    s_waitcnt lgkmcnt(3)
    v_mfma_f32_32x32x16_bf16 v[64:79], v[20:23], a[32:35], v[64:79]
    ds_read_b128 v[44:47], v10 offset:32768
    ds_read_b128 v[48:51], v10 offset:40960
    s_add_u32 s18, s18, 16384
    s_add_u32 m0, s31, 133120
    s_nop 0
    buffer_load_dwordx4 v38, s[56:59], s18 offen lds
    s_add_u32 s18, s18, 16384
    s_waitcnt lgkmcnt(4)
    v_mfma_f32_32x32x16_bf16 v[84:99], v[24:27], a[32:35], v[84:99]
    ds_read_b128 v[52:55], v18 offset:32768
    ds_read_b128 v[56:59], v18 offset:40960
    s_add_u32 m0, s31, 134144
    s_nop 0
    buffer_load_dwordx4 v38, s[56:59], s18 offen lds
    s_lshr_b32 s3, s31, 2
    s_add_u32 m0, s3, 147456
    s_nop 0
    buffer_load_dwordx4 v62, s[8:11], 0 offen sc0 sc1 lds
    s_add_u32 m0, s17, 2048
    s_waitcnt lgkmcnt(5)
    v_mfma_f32_32x32x16_bf16 v[100:115], v[28:31], a[32:35], v[100:115]
    buffer_load_dwordx4 v4, s[8:11], s28 offen sc0 sc1 lds
    buffer_load_ushort v82, v80, s[32:35], 0 offen
    s_waitcnt vmcnt(25)
    v_mov_b32 v182, s22
    v_mov_b32 v183, s23
    s_mov_b64 s[20:21], exec
    s_mov_b64 exec, 1
    buffer_store_dwordx2 v[182:183], v6, s[8:11], s6 offen sc0 sc1
    s_mov_b64 exec, s[20:21]
    s_add_u32 m0, s17, 3072
    s_waitcnt lgkmcnt(4)
    v_mfma_f32_32x32x16_bf16 v[116:131], v[40:43], a[32:35], v[116:131]
    buffer_load_dwordx4 v5, s[8:11], s28 offen sc0 sc1 lds
    s_waitcnt lgkmcnt(3)
    v_mfma_f32_32x32x16_bf16 v[64:79], v[44:47], a[36:39], v[64:79]
    ds_read_b128 v[20:23], v11 offset:32768
    ds_read_b128 v[24:27], v11 offset:40960
    s_waitcnt lgkmcnt(4)
    v_mfma_f32_32x32x16_bf16 v[84:99], v[48:51], a[36:39], v[84:99]
    ds_read_b128 v[28:31], v19 offset:32768
    ds_read_b128 v[40:43], v19 offset:40960
    s_add_u32 s29, s28, 65536
    s_add_u32 m0, s17, 4096
    s_waitcnt lgkmcnt(5)
    v_mfma_f32_32x32x16_bf16 v[100:115], v[52:55], a[36:39], v[100:115]
    buffer_load_dwordx4 v2, s[8:11], s29 offen sc0 sc1 lds
    s_add_u32 m0, s17, 5120
    s_waitcnt lgkmcnt(4)
    v_mfma_f32_32x32x16_bf16 v[116:131], v[56:59], a[36:39], v[116:131]
    buffer_load_dwordx4 v3, s[8:11], s29 offen sc0 sc1 lds
    s_waitcnt lgkmcnt(3)
    v_mfma_f32_32x32x16_bf16 v[64:79], v[20:23], a[40:43], v[64:79]
    ds_read_b128 v[44:47], v12 offset:32768
    ds_read_b128 v[48:51], v12 offset:40960
    s_waitcnt lgkmcnt(4)
    v_mfma_f32_32x32x16_bf16 v[84:99], v[24:27], a[40:43], v[84:99]
    ds_read_b128 v[52:55], v32 offset:32768
    ds_read_b128 v[56:59], v32 offset:40960
    s_add_u32 m0, s17, 6144
    s_waitcnt lgkmcnt(5)
    v_mfma_f32_32x32x16_bf16 v[100:115], v[28:31], a[40:43], v[100:115]
    buffer_load_dwordx4 v4, s[8:11], s29 offen sc0 sc1 lds
    s_add_u32 m0, s17, 7168
    s_waitcnt lgkmcnt(4)
    v_mfma_f32_32x32x16_bf16 v[116:131], v[40:43], a[40:43], v[116:131]
    buffer_load_dwordx4 v5, s[8:11], s29 offen sc0 sc1 lds
    s_waitcnt lgkmcnt(0)
    s_barrier
    v_mfma_f32_32x32x16_bf16 v[64:79], v[44:47], a[44:47], v[64:79]
    ds_read_b128 v[20:23], v13 offset:0
    ds_read_b128 v[24:27], v13 offset:8192
    v_mfma_f32_32x32x16_bf16 v[84:99], v[48:51], a[44:47], v[84:99]
    ds_read_b128 v[28:31], v33 offset:0
    ds_read_b128 v[40:43], v33 offset:8192
    s_add_u32 s12, s12, 256
    s_and_b32 s12, s12, 0xfff
    s_add_u32 s28, s7, s12
    s_add_u32 m0, s17, 32768
    v_mfma_f32_32x32x16_bf16 v[100:115], v[52:55], a[44:47], v[100:115]
    buffer_load_dwordx4 v2, s[8:11], s28 offen sc0 sc1 lds
    s_add_u32 m0, s17, 33792
    v_mfma_f32_32x32x16_bf16 v[116:131], v[56:59], a[44:47], v[116:131]
    buffer_load_dwordx4 v3, s[8:11], s28 offen sc0 sc1 lds
    s_waitcnt lgkmcnt(3)
    v_mfma_f32_32x32x16_bf16 v[64:79], v[20:23], a[48:51], v[64:79]
    ds_read_b128 v[44:47], v14 offset:0
    ds_read_b128 v[48:51], v14 offset:8192
    s_waitcnt lgkmcnt(4)
    v_mfma_f32_32x32x16_bf16 v[84:99], v[24:27], a[48:51], v[84:99]
    ds_read_b128 v[52:55], v34 offset:0
    ds_read_b128 v[56:59], v34 offset:8192
    s_add_u32 m0, s17, 34816
    s_waitcnt lgkmcnt(5)
    v_mfma_f32_32x32x16_bf16 v[100:115], v[28:31], a[48:51], v[100:115]
    buffer_load_dwordx4 v4, s[8:11], s28 offen sc0 sc1 lds
    s_add_u32 m0, s17, 35840
    s_waitcnt lgkmcnt(4)
    v_mfma_f32_32x32x16_bf16 v[116:131], v[40:43], a[48:51], v[116:131]
    buffer_load_dwordx4 v5, s[8:11], s28 offen sc0 sc1 lds
    s_waitcnt lgkmcnt(3)
    v_mfma_f32_32x32x16_bf16 v[64:79], v[44:47], a[52:55], v[64:79]
    ds_read_b128 v[20:23], v15 offset:0
    ds_read_b128 v[24:27], v15 offset:8192
    s_waitcnt lgkmcnt(4)
    v_mfma_f32_32x32x16_bf16 v[84:99], v[48:51], a[52:55], v[84:99]
    ds_read_b128 v[28:31], v35 offset:0
    ds_read_b128 v[40:43], v35 offset:8192
    s_add_u32 s29, s28, 65536
    s_add_u32 m0, s17, 36864
    s_waitcnt lgkmcnt(5)
    v_mfma_f32_32x32x16_bf16 v[100:115], v[52:55], a[52:55], v[100:115]
    buffer_load_dwordx4 v2, s[8:11], s29 offen sc0 sc1 lds
    s_add_u32 m0, s17, 37888
    s_waitcnt lgkmcnt(4)
    v_mfma_f32_32x32x16_bf16 v[116:131], v[56:59], a[52:55], v[116:131]
    buffer_load_dwordx4 v3, s[8:11], s29 offen sc0 sc1 lds
    s_waitcnt lgkmcnt(3)
    v_mfma_f32_32x32x16_bf16 v[64:79], v[20:23], a[56:59], v[64:79]
    ds_read_b128 v[44:47], v16 offset:0
    ds_read_b128 v[48:51], v16 offset:8192
    s_waitcnt lgkmcnt(4)
    v_mfma_f32_32x32x16_bf16 v[84:99], v[24:27], a[56:59], v[84:99]
    ds_read_b128 v[52:55], v36 offset:0
    ds_read_b128 v[56:59], v36 offset:8192
    s_add_u32 m0, s17, 38912
    s_waitcnt lgkmcnt(5)
    v_mfma_f32_32x32x16_bf16 v[100:115], v[28:31], a[56:59], v[100:115]
    buffer_load_dwordx4 v4, s[8:11], s29 offen sc0 sc1 lds
    s_add_u32 m0, s17, 39936
    s_waitcnt lgkmcnt(4)
    v_mfma_f32_32x32x16_bf16 v[116:131], v[40:43], a[56:59], v[116:131]
    buffer_load_dwordx4 v5, s[8:11], s29 offen sc0 sc1 lds
    s_waitcnt lgkmcnt(0)
    s_waitcnt vmcnt(23)
    s_barrier
    v_mfma_f32_32x32x16_bf16 v[64:79], v[44:47], a[60:63], v[64:79]
    ds_read_b128 v[20:23], v13 offset:32768
    ds_read_b128 v[24:27], v13 offset:40960
    v_mfma_f32_32x32x16_bf16 v[84:99], v[48:51], a[60:63], v[84:99]
    ds_read_b128 v[28:31], v33 offset:32768
    ds_read_b128 v[40:43], v33 offset:40960
    s_add_u32 s12, s12, 256
    s_and_b32 s12, s12, 0xfff
    s_add_u32 s28, s7, s12
    s_add_u32 m0, s17, 65536
    v_mfma_f32_32x32x16_bf16 v[100:115], v[52:55], a[60:63], v[100:115]
    buffer_load_dwordx4 v2, s[8:11], s28 offen sc0 sc1 lds
    s_add_u32 m0, s17, 66560
    v_mfma_f32_32x32x16_bf16 v[116:131], v[56:59], a[60:63], v[116:131]
    buffer_load_dwordx4 v3, s[8:11], s28 offen sc0 sc1 lds
    s_waitcnt lgkmcnt(3)
    v_mfma_f32_32x32x16_bf16 v[64:79], v[20:23], a[64:67], v[64:79]
    ds_read_b128 v[44:47], v14 offset:32768
    ds_read_b128 v[48:51], v14 offset:40960
    s_waitcnt vmcnt(18)
    ds_read_b128 v[136:139], v63 offset:0
    ds_read_b128 v[168:171], v63 offset:256
    s_waitcnt lgkmcnt(6)
    v_mfma_f32_32x32x16_bf16 v[84:99], v[24:27], a[64:67], v[84:99]
    ds_read_b128 v[52:55], v34 offset:32768
    ds_read_b128 v[56:59], v34 offset:40960
    ds_read_b128 v[140:143], v63 offset:32
    ds_read_b128 v[172:175], v63 offset:288
    s_add_u32 m0, s17, 67584
    s_waitcnt lgkmcnt(9)
    v_mfma_f32_32x32x16_bf16 v[100:115], v[28:31], a[64:67], v[100:115]
    buffer_load_dwordx4 v4, s[8:11], s28 offen sc0 sc1 lds
    ds_read_b128 v[144:147], v63 offset:64
    ds_read_b128 v[176:179], v63 offset:320
    ds_read_b128 v[148:151], v63 offset:96
    s_add_u32 m0, s17, 68608
    s_waitcnt lgkmcnt(11)
    v_mfma_f32_32x32x16_bf16 v[116:131], v[40:43], a[64:67], v[116:131]
    buffer_load_dwordx4 v5, s[8:11], s28 offen sc0 sc1 lds
    ds_read_b128 v[184:187], v63 offset:352
    ds_read_b128 v[152:155], v63 offset:128
    ds_read_b128 v[188:191], v63 offset:384
    ds_read_b128 v[156:159], v63 offset:160
    s_waitcnt lgkmcnt(14)
    v_mfma_f32_32x32x16_bf16 v[64:79], v[44:47], a[68:71], v[64:79]
    ds_read_b128 v[20:23], v15 offset:32768
    ds_read_b128 v[24:27], v15 offset:40960
    ds_read_b128 v[192:195], v63 offset:416
    ds_read_b128 v[160:163], v63 offset:192
    ds_read_b128 v[196:199], v63 offset:448
    s_waitcnt lgkmcnt(15)
    v_mfma_f32_32x32x16_bf16 v[84:99], v[48:51], a[68:71], v[84:99]
    ds_read_b128 v[28:31], v35 offset:32768
    ds_read_b128 v[40:43], v35 offset:40960
    ds_read_b128 v[164:167], v63 offset:224
    s_add_u32 s29, s28, 65536
    s_add_u32 m0, s17, 69632
    v_mfma_f32_32x32x16_bf16 v[100:115], v[52:55], a[68:71], v[100:115]
    buffer_load_dwordx4 v2, s[8:11], s29 offen sc0 sc1 lds
    ds_read_b128 v[200:203], v63 offset:480
    s_add_u32 m0, s17, 70656
    s_waitcnt lgkmcnt(15)
    v_mfma_f32_32x32x16_bf16 v[116:131], v[56:59], a[68:71], v[116:131]
    buffer_load_dwordx4 v3, s[8:11], s29 offen sc0 sc1 lds
    s_waitcnt lgkmcnt(8)
    v_mfma_f32_32x32x16_bf16 v[64:79], v[20:23], a[72:75], v[64:79]
    ds_read_b128 v[44:47], v16 offset:32768
    ds_read_b128 v[48:51], v16 offset:40960
    s_waitcnt lgkmcnt(9)
    v_mfma_f32_32x32x16_bf16 v[84:99], v[24:27], a[72:75], v[84:99]
    ds_read_b128 v[52:55], v36 offset:32768
    ds_read_b128 v[56:59], v36 offset:40960
    s_add_u32 m0, s17, 71680
    s_waitcnt lgkmcnt(7)
    v_mfma_f32_32x32x16_bf16 v[100:115], v[28:31], a[72:75], v[100:115]
    buffer_load_dwordx4 v4, s[8:11], s29 offen sc0 sc1 lds
    s_add_u32 m0, s17, 72704
    s_waitcnt lgkmcnt(6)
    v_mfma_f32_32x32x16_bf16 v[116:131], v[40:43], a[72:75], v[116:131]
    buffer_load_dwordx4 v5, s[8:11], s29 offen sc0 sc1 lds
    s_waitcnt lgkmcnt(0)
    s_waitcnt vmcnt(16)
    s_barrier
    v_mfma_f32_32x32x16_bf16 v[64:79], v[44:47], a[76:79], v[64:79]
    ds_read_b128 v[20:23], v9 offset:0
    ds_read_b128 v[24:27], v9 offset:8192
    v_mfma_f32_32x32x16_bf16 v[84:99], v[48:51], a[76:79], v[84:99]
    ds_read_b128 v[28:31], v17 offset:0
    ds_read_b128 v[40:43], v17 offset:8192
    s_add_u32 s12, s12, 256
    s_and_b32 s12, s12, 0xfff
    s_add_u32 s28, s7, s12
    s_add_u32 m0, s17, 98304
    v_mfma_f32_32x32x16_bf16 v[100:115], v[52:55], a[76:79], v[100:115]
    buffer_load_dwordx4 v2, s[8:11], s28 offen sc0 sc1 lds
    s_add_u32 m0, s17, 99328
    v_mfma_f32_32x32x16_bf16 v[116:131], v[56:59], a[76:79], v[116:131]
    buffer_load_dwordx4 v3, s[8:11], s28 offen sc0 sc1 lds
    s_waitcnt lgkmcnt(3)
    v_mfma_f32_32x32x16_bf16 v[64:79], v[20:23], a[80:83], v[64:79]
    ds_read_b128 v[44:47], v10 offset:0
    ds_read_b128 v[48:51], v10 offset:8192
    s_waitcnt lgkmcnt(4)
    v_mfma_f32_32x32x16_bf16 v[84:99], v[24:27], a[80:83], v[84:99]
    ds_read_b128 v[52:55], v18 offset:0
    ds_read_b128 v[56:59], v18 offset:8192
    s_add_u32 m0, s17, 100352
    s_waitcnt lgkmcnt(5)
    v_mfma_f32_32x32x16_bf16 v[100:115], v[28:31], a[80:83], v[100:115]
    buffer_load_dwordx4 v4, s[8:11], s28 offen sc0 sc1 lds
    s_add_u32 m0, s17, 101376
    s_waitcnt lgkmcnt(4)
    v_mfma_f32_32x32x16_bf16 v[116:131], v[40:43], a[80:83], v[116:131]
    buffer_load_dwordx4 v5, s[8:11], s28 offen sc0 sc1 lds
    s_waitcnt lgkmcnt(3)
    v_mfma_f32_32x32x16_bf16 v[64:79], v[44:47], a[84:87], v[64:79]
    ds_read_b128 v[20:23], v11 offset:0
    ds_read_b128 v[24:27], v11 offset:8192
    s_waitcnt lgkmcnt(4)
    v_mfma_f32_32x32x16_bf16 v[84:99], v[48:51], a[84:87], v[84:99]
    ds_read_b128 v[28:31], v19 offset:0
    ds_read_b128 v[40:43], v19 offset:8192
    s_add_u32 s29, s28, 65536
    s_add_u32 m0, s17, 102400
    s_waitcnt lgkmcnt(5)
    v_mfma_f32_32x32x16_bf16 v[100:115], v[52:55], a[84:87], v[100:115]
    buffer_load_dwordx4 v2, s[8:11], s29 offen sc0 sc1 lds
    s_add_u32 m0, s17, 103424
    s_waitcnt lgkmcnt(4)
    v_mfma_f32_32x32x16_bf16 v[116:131], v[56:59], a[84:87], v[116:131]
    buffer_load_dwordx4 v3, s[8:11], s29 offen sc0 sc1 lds
    s_waitcnt lgkmcnt(3)
    v_mfma_f32_32x32x16_bf16 v[64:79], v[20:23], a[88:91], v[64:79]
    ds_read_b128 v[44:47], v12 offset:0
    ds_read_b128 v[48:51], v12 offset:8192
    s_waitcnt lgkmcnt(4)
    v_mfma_f32_32x32x16_bf16 v[84:99], v[24:27], a[88:91], v[84:99]
    ds_read_b128 v[52:55], v32 offset:0
    ds_read_b128 v[56:59], v32 offset:8192
    s_add_u32 m0, s17, 104448
    s_waitcnt lgkmcnt(5)
    v_mfma_f32_32x32x16_bf16 v[100:115], v[28:31], a[88:91], v[100:115]
    buffer_load_dwordx4 v4, s[8:11], s29 offen sc0 sc1 lds
    s_add_u32 m0, s17, 105472
    s_waitcnt lgkmcnt(4)
    v_mfma_f32_32x32x16_bf16 v[116:131], v[40:43], a[88:91], v[116:131]
    buffer_load_dwordx4 v5, s[8:11], s29 offen sc0 sc1 lds
    s_waitcnt lgkmcnt(0)
    s_waitcnt vmcnt(16)
    s_barrier
    v_mfma_f32_32x32x16_bf16 v[64:79], v[44:47], a[92:95], v[64:79]
    ds_read_b128 v[20:23], v9 offset:32768
    ds_read_b128 v[24:27], v9 offset:40960
    v_mfma_f32_32x32x16_bf16 v[84:99], v[48:51], a[92:95], v[84:99]
    ds_read_b128 v[28:31], v17 offset:32768
    ds_read_b128 v[40:43], v17 offset:40960
    s_add_u32 s12, s12, 256
    s_and_b32 s12, s12, 0xfff
    s_add_u32 s28, s7, s12
    s_add_u32 m0, s17, 0
    v_mfma_f32_32x32x16_bf16 v[100:115], v[52:55], a[92:95], v[100:115]
    buffer_load_dwordx4 v2, s[8:11], s28 offen sc0 sc1 lds
    s_add_u32 m0, s17, 1024
    v_mfma_f32_32x32x16_bf16 v[116:131], v[56:59], a[92:95], v[116:131]
    buffer_load_dwordx4 v3, s[8:11], s28 offen sc0 sc1 lds
    s_waitcnt lgkmcnt(3)
    v_mfma_f32_32x32x16_bf16 v[64:79], v[20:23], a[96:99], v[64:79]
    ds_read_b128 v[44:47], v10 offset:32768
    ds_read_b128 v[48:51], v10 offset:40960
    buffer_load_dwordx2 v[220:221], v81, s[8:11], 0 offen sc0 sc1
    s_waitcnt lgkmcnt(4)
    v_mfma_f32_32x32x16_bf16 v[84:99], v[24:27], a[96:99], v[84:99]
    ds_read_b128 v[52:55], v18 offset:32768
    ds_read_b128 v[56:59], v18 offset:40960
    s_add_u32 m0, s17, 2048
    s_waitcnt lgkmcnt(5)
    v_mfma_f32_32x32x16_bf16 v[100:115], v[28:31], a[96:99], v[100:115]
    buffer_load_dwordx4 v4, s[8:11], s28 offen sc0 sc1 lds
    s_add_u32 m0, s17, 3072
    s_waitcnt lgkmcnt(4)
    v_mfma_f32_32x32x16_bf16 v[116:131], v[40:43], a[96:99], v[116:131]
    buffer_load_dwordx4 v5, s[8:11], s28 offen sc0 sc1 lds
    s_waitcnt lgkmcnt(3)
    v_mfma_f32_32x32x16_bf16 v[64:79], v[44:47], a[100:103], v[64:79]
    ds_read_b128 v[20:23], v11 offset:32768
    ds_read_b128 v[24:27], v11 offset:40960
    s_waitcnt lgkmcnt(4)
    v_mfma_f32_32x32x16_bf16 v[84:99], v[48:51], a[100:103], v[84:99]
    ds_read_b128 v[28:31], v19 offset:32768
    ds_read_b128 v[40:43], v19 offset:40960
    s_add_u32 s29, s28, 65536
    s_add_u32 m0, s17, 4096
    s_waitcnt lgkmcnt(5)
    v_mfma_f32_32x32x16_bf16 v[100:115], v[52:55], a[100:103], v[100:115]
    buffer_load_dwordx4 v2, s[8:11], s29 offen sc0 sc1 lds
    s_add_u32 m0, s17, 5120
    s_waitcnt lgkmcnt(4)
    v_mfma_f32_32x32x16_bf16 v[116:131], v[56:59], a[100:103], v[116:131]
    buffer_load_dwordx4 v3, s[8:11], s29 offen sc0 sc1 lds
    s_waitcnt lgkmcnt(3)
    v_mfma_f32_32x32x16_bf16 v[64:79], v[20:23], a[104:107], v[64:79]
    ds_read_b128 v[44:47], v12 offset:32768
    ds_read_b128 v[48:51], v12 offset:40960
    s_waitcnt lgkmcnt(4)
    v_mfma_f32_32x32x16_bf16 v[84:99], v[24:27], a[104:107], v[84:99]
    ds_read_b128 v[52:55], v32 offset:32768
    ds_read_b128 v[56:59], v32 offset:40960
    s_add_u32 m0, s17, 6144
    s_waitcnt lgkmcnt(5)
    v_mfma_f32_32x32x16_bf16 v[100:115], v[28:31], a[104:107], v[100:115]
    buffer_load_dwordx4 v4, s[8:11], s29 offen sc0 sc1 lds
    s_add_u32 m0, s17, 7168
    s_waitcnt lgkmcnt(4)
    v_mfma_f32_32x32x16_bf16 v[116:131], v[40:43], a[104:107], v[116:131]
    buffer_load_dwordx4 v5, s[8:11], s29 offen sc0 sc1 lds
    s_waitcnt lgkmcnt(0)
    s_waitcnt vmcnt(17)
    s_barrier
    v_mfma_f32_32x32x16_bf16 v[64:79], v[44:47], a[108:111], v[64:79]
    ds_read_b128 v[20:23], v13 offset:0
    ds_read_b128 v[24:27], v13 offset:8192
    v_mfma_f32_32x32x16_bf16 v[84:99], v[48:51], a[108:111], v[84:99]
    ds_read_b128 v[28:31], v33 offset:0
    ds_read_b128 v[40:43], v33 offset:8192
    s_add_u32 s12, s12, 256
    s_and_b32 s12, s12, 0xfff
    s_add_u32 s28, s7, s12
    s_add_u32 m0, s17, 32768
    v_mfma_f32_32x32x16_bf16 v[100:115], v[52:55], a[108:111], v[100:115]
    buffer_load_dwordx4 v2, s[8:11], s28 offen sc0 sc1 lds
    s_add_u32 m0, s17, 33792
    v_mfma_f32_32x32x16_bf16 v[116:131], v[56:59], a[108:111], v[116:131]
    buffer_load_dwordx4 v3, s[8:11], s28 offen sc0 sc1 lds
    s_waitcnt lgkmcnt(3)
    v_mfma_f32_32x32x16_bf16 v[64:79], v[20:23], a[112:115], v[64:79]
    ds_read_b128 v[44:47], v14 offset:0
    ds_read_b128 v[48:51], v14 offset:8192
    s_waitcnt lgkmcnt(4)
    v_mfma_f32_32x32x16_bf16 v[84:99], v[24:27], a[112:115], v[84:99]
    ds_read_b128 v[52:55], v34 offset:0
    ds_read_b128 v[56:59], v34 offset:8192
    s_add_u32 m0, s17, 34816
    s_waitcnt lgkmcnt(5)
    v_mfma_f32_32x32x16_bf16 v[100:115], v[28:31], a[112:115], v[100:115]
    buffer_load_dwordx4 v4, s[8:11], s28 offen sc0 sc1 lds
    s_add_u32 m0, s17, 35840
    s_waitcnt lgkmcnt(4)
    v_mfma_f32_32x32x16_bf16 v[116:131], v[40:43], a[112:115], v[116:131]
    buffer_load_dwordx4 v5, s[8:11], s28 offen sc0 sc1 lds
    s_waitcnt lgkmcnt(3)
    v_mfma_f32_32x32x16_bf16 v[64:79], v[44:47], a[116:119], v[64:79]
    ds_read_b128 v[20:23], v15 offset:0
    ds_read_b128 v[24:27], v15 offset:8192
    s_waitcnt lgkmcnt(4)
    v_mfma_f32_32x32x16_bf16 v[84:99], v[48:51], a[116:119], v[84:99]
    ds_read_b128 v[28:31], v35 offset:0
    ds_read_b128 v[40:43], v35 offset:8192
    s_add_u32 s29, s28, 65536
    s_add_u32 m0, s17, 36864
    s_waitcnt lgkmcnt(5)
    v_mfma_f32_32x32x16_bf16 v[100:115], v[52:55], a[116:119], v[100:115]
    buffer_load_dwordx4 v2, s[8:11], s29 offen sc0 sc1 lds
    s_add_u32 m0, s17, 37888
    s_waitcnt lgkmcnt(4)
    v_mfma_f32_32x32x16_bf16 v[116:131], v[56:59], a[116:119], v[116:131]
    buffer_load_dwordx4 v3, s[8:11], s29 offen sc0 sc1 lds
    s_waitcnt lgkmcnt(3)
    v_mfma_f32_32x32x16_bf16 v[64:79], v[20:23], a[120:123], v[64:79]
    ds_read_b128 v[44:47], v16 offset:0
    ds_read_b128 v[48:51], v16 offset:8192
    s_waitcnt lgkmcnt(4)
    v_mfma_f32_32x32x16_bf16 v[84:99], v[24:27], a[120:123], v[84:99]
    ds_read_b128 v[52:55], v36 offset:0
    ds_read_b128 v[56:59], v36 offset:8192
    s_add_u32 m0, s17, 38912
    s_waitcnt lgkmcnt(5)
    v_mfma_f32_32x32x16_bf16 v[100:115], v[28:31], a[120:123], v[100:115]
    buffer_load_dwordx4 v4, s[8:11], s29 offen sc0 sc1 lds
    s_add_u32 m0, s17, 39936
    s_waitcnt lgkmcnt(4)
    v_mfma_f32_32x32x16_bf16 v[116:131], v[40:43], a[120:123], v[116:131]
    buffer_load_dwordx4 v5, s[8:11], s29 offen sc0 sc1 lds
    s_waitcnt lgkmcnt(0)
    s_waitcnt vmcnt(17)
    s_barrier
    v_mfma_f32_32x32x16_bf16 v[64:79], v[44:47], a[124:127], v[64:79]
    ds_read_b128 v[20:23], v13 offset:32768
    ds_read_b128 v[24:27], v13 offset:40960
    v_mfma_f32_32x32x16_bf16 v[84:99], v[48:51], a[124:127], v[84:99]
    ds_read_b128 v[28:31], v33 offset:32768
    ds_read_b128 v[40:43], v33 offset:40960
    s_add_u32 s12, s12, 256
    s_and_b32 s12, s12, 0xfff
    s_add_u32 s28, s7, s12
    s_add_u32 m0, s17, 65536
    v_mfma_f32_32x32x16_bf16 v[100:115], v[52:55], a[124:127], v[100:115]
    buffer_load_dwordx4 v2, s[8:11], s28 offen sc0 sc1 lds
    s_add_u32 m0, s17, 66560
    v_mfma_f32_32x32x16_bf16 v[116:131], v[56:59], a[124:127], v[116:131]
    buffer_load_dwordx4 v3, s[8:11], s28 offen sc0 sc1 lds
    s_waitcnt lgkmcnt(3)
    v_mfma_f32_32x32x16_bf16 v[64:79], v[20:23], a[128:131], v[64:79]
    ds_read_b128 v[44:47], v14 offset:32768
    ds_read_b128 v[48:51], v14 offset:40960
    s_mov_b32 s36, 0
    s_waitcnt vmcnt(16)
    v_cmp_ne_u64 vcc, s[22:23], v[220:221]
    s_nop 4
    s_cbranch_vccz Lfdone_gate_13
Lfpoll_gate_14:
    buffer_load_dwordx2 v[220:221], v81, s[8:11], 0 offen sc0 sc1
    s_waitcnt vmcnt(0)
    v_cmp_ne_u64 vcc, s[22:23], v[220:221]
    s_nop 4
    s_add_u32 s36, s36, 1
    s_cmp_gt_u32 s36, 20000
    s_cbranch_scc1 Lfdone_gate_13
    s_cbranch_vccnz Lfpoll_gate_14
Lfdone_gate_13:
    s_add_u32 m0, s31, 147456
    s_nop 0
    buffer_load_dwordx4 v2, s[8:11], s19 offen sc0 sc1 lds
    s_add_u32 m0, s31, 148480
    s_nop 0
    buffer_load_dwordx4 v3, s[8:11], s19 offen sc0 sc1 lds
    s_waitcnt lgkmcnt(4)
    v_mfma_f32_32x32x16_bf16 v[84:99], v[24:27], a[128:131], v[84:99]
    ds_read_b128 v[52:55], v34 offset:32768
    ds_read_b128 v[56:59], v34 offset:40960
    s_add_u32 m0, s31, 149504
    s_nop 0
    buffer_load_dwordx4 v4, s[8:11], s19 offen sc0 sc1 lds
    s_add_u32 m0, s31, 150528
    s_nop 0
    buffer_load_dwordx4 v5, s[8:11], s19 offen sc0 sc1 lds
    s_add_u32 m0, s17, 67584
    s_waitcnt lgkmcnt(5)
    v_mfma_f32_32x32x16_bf16 v[100:115], v[28:31], a[128:131], v[100:115]
    buffer_load_dwordx4 v4, s[8:11], s28 offen sc0 sc1 lds
    s_add_u32 m0, s17, 68608
    s_waitcnt lgkmcnt(4)
    v_mfma_f32_32x32x16_bf16 v[116:131], v[40:43], a[128:131], v[116:131]
    buffer_load_dwordx4 v5, s[8:11], s28 offen sc0 sc1 lds
    s_waitcnt lgkmcnt(3)
    v_mfma_f32_32x32x16_bf16 v[64:79], v[44:47], a[132:135], v[64:79]
    ds_read_b128 v[20:23], v15 offset:32768
    ds_read_b128 v[24:27], v15 offset:40960
    s_waitcnt lgkmcnt(4)
    v_mfma_f32_32x32x16_bf16 v[84:99], v[48:51], a[132:135], v[84:99]
    ds_read_b128 v[28:31], v35 offset:32768
    ds_read_b128 v[40:43], v35 offset:40960
    s_add_u32 s29, s28, 65536
    s_add_u32 m0, s17, 69632
    s_waitcnt lgkmcnt(5)
    v_mfma_f32_32x32x16_bf16 v[100:115], v[52:55], a[132:135], v[100:115]
    buffer_load_dwordx4 v2, s[8:11], s29 offen sc0 sc1 lds
    s_add_u32 m0, s17, 70656
    s_waitcnt lgkmcnt(4)
    v_mfma_f32_32x32x16_bf16 v[116:131], v[56:59], a[132:135], v[116:131]
    buffer_load_dwordx4 v3, s[8:11], s29 offen sc0 sc1 lds
    s_waitcnt lgkmcnt(3)
    v_mfma_f32_32x32x16_bf16 v[64:79], v[20:23], a[136:139], v[64:79]
    ds_read_b128 v[44:47], v16 offset:32768
    ds_read_b128 v[48:51], v16 offset:40960
    s_waitcnt lgkmcnt(4)
    v_mfma_f32_32x32x16_bf16 v[84:99], v[24:27], a[136:139], v[84:99]
    ds_read_b128 v[52:55], v36 offset:32768
    ds_read_b128 v[56:59], v36 offset:40960
    s_add_u32 m0, s17, 71680
    s_waitcnt lgkmcnt(5)
    v_mfma_f32_32x32x16_bf16 v[100:115], v[28:31], a[136:139], v[100:115]
    buffer_load_dwordx4 v4, s[8:11], s29 offen sc0 sc1 lds
    s_add_u32 m0, s17, 72704
    s_waitcnt lgkmcnt(4)
    v_mfma_f32_32x32x16_bf16 v[116:131], v[40:43], a[136:139], v[116:131]
    buffer_load_dwordx4 v5, s[8:11], s29 offen sc0 sc1 lds
    s_waitcnt lgkmcnt(0)
    s_waitcnt vmcnt(20)
    s_barrier
    v_mfma_f32_32x32x16_bf16 v[64:79], v[44:47], a[140:143], v[64:79]
    ds_read_b128 v[20:23], v9 offset:0
    ds_read_b128 v[24:27], v9 offset:8192
    v_mfma_f32_32x32x16_bf16 v[84:99], v[48:51], a[140:143], v[84:99]
    ds_read_b128 v[28:31], v17 offset:0
    ds_read_b128 v[40:43], v17 offset:8192
    s_add_u32 s12, s12, 256
    s_and_b32 s12, s12, 0xfff
    s_add_u32 s28, s7, s12
    s_add_u32 m0, s17, 98304
    v_mfma_f32_32x32x16_bf16 v[100:115], v[52:55], a[140:143], v[100:115]
    buffer_load_dwordx4 v2, s[8:11], s28 offen sc0 sc1 lds
    s_add_u32 m0, s17, 99328
    v_mfma_f32_32x32x16_bf16 v[116:131], v[56:59], a[140:143], v[116:131]
    buffer_load_dwordx4 v3, s[8:11], s28 offen sc0 sc1 lds
    s_waitcnt lgkmcnt(3)
    v_mfma_f32_32x32x16_bf16 v[64:79], v[20:23], a[144:147], v[64:79]
    ds_read_b128 v[44:47], v10 offset:0
    ds_read_b128 v[48:51], v10 offset:8192
    s_waitcnt lgkmcnt(4)
    v_mfma_f32_32x32x16_bf16 v[84:99], v[24:27], a[144:147], v[84:99]
    ds_read_b128 v[52:55], v18 offset:0
    ds_read_b128 v[56:59], v18 offset:8192
    s_add_u32 m0, s17, 100352
    s_waitcnt lgkmcnt(5)
    v_mfma_f32_32x32x16_bf16 v[100:115], v[28:31], a[144:147], v[100:115]
    buffer_load_dwordx4 v4, s[8:11], s28 offen sc0 sc1 lds
    s_add_u32 m0, s17, 101376
    s_waitcnt lgkmcnt(4)
    v_mfma_f32_32x32x16_bf16 v[116:131], v[40:43], a[144:147], v[116:131]
    buffer_load_dwordx4 v5, s[8:11], s28 offen sc0 sc1 lds
    s_waitcnt lgkmcnt(3)
    v_mfma_f32_32x32x16_bf16 v[64:79], v[44:47], a[148:151], v[64:79]
    ds_read_b128 v[20:23], v11 offset:0
    ds_read_b128 v[24:27], v11 offset:8192
    s_waitcnt lgkmcnt(4)
    v_mfma_f32_32x32x16_bf16 v[84:99], v[48:51], a[148:151], v[84:99]
    ds_read_b128 v[28:31], v19 offset:0
    ds_read_b128 v[40:43], v19 offset:8192
    s_add_u32 s29, s28, 65536
    s_add_u32 m0, s17, 102400
    s_waitcnt lgkmcnt(5)
    v_mfma_f32_32x32x16_bf16 v[100:115], v[52:55], a[148:151], v[100:115]
    buffer_load_dwordx4 v2, s[8:11], s29 offen sc0 sc1 lds
    s_add_u32 m0, s17, 103424
    s_waitcnt lgkmcnt(4)
    v_mfma_f32_32x32x16_bf16 v[116:131], v[56:59], a[148:151], v[116:131]
    buffer_load_dwordx4 v3, s[8:11], s29 offen sc0 sc1 lds
    s_waitcnt lgkmcnt(3)
    v_mfma_f32_32x32x16_bf16 v[64:79], v[20:23], a[152:155], v[64:79]
    ds_read_b128 v[44:47], v12 offset:0
    ds_read_b128 v[48:51], v12 offset:8192
    s_waitcnt lgkmcnt(4)
    v_mfma_f32_32x32x16_bf16 v[84:99], v[24:27], a[152:155], v[84:99]
    ds_read_b128 v[52:55], v32 offset:0
    ds_read_b128 v[56:59], v32 offset:8192
    s_add_u32 m0, s17, 104448
    s_waitcnt lgkmcnt(5)
    v_mfma_f32_32x32x16_bf16 v[100:115], v[28:31], a[152:155], v[100:115]
    buffer_load_dwordx4 v4, s[8:11], s29 offen sc0 sc1 lds
    s_add_u32 m0, s17, 105472
    s_waitcnt lgkmcnt(4)
    v_mfma_f32_32x32x16_bf16 v[116:131], v[40:43], a[152:155], v[116:131]
    buffer_load_dwordx4 v5, s[8:11], s29 offen sc0 sc1 lds
    s_waitcnt lgkmcnt(0)
    s_waitcnt vmcnt(20)
    s_barrier
    v_mfma_f32_32x32x16_bf16 v[64:79], v[44:47], a[156:159], v[64:79]
    ds_read_b128 v[20:23], v9 offset:32768
    ds_read_b128 v[24:27], v9 offset:40960
    v_mfma_f32_32x32x16_bf16 v[84:99], v[48:51], a[156:159], v[84:99]
    ds_read_b128 v[28:31], v17 offset:32768
    ds_read_b128 v[40:43], v17 offset:40960
    s_add_u32 s12, s12, 256
    s_and_b32 s12, s12, 0xfff
    s_add_u32 s28, s7, s12
    s_add_u32 m0, s17, 0
    v_mfma_f32_32x32x16_bf16 v[100:115], v[52:55], a[156:159], v[100:115]
    buffer_load_dwordx4 v2, s[8:11], s28 offen sc0 sc1 lds
    s_add_u32 m0, s17, 1024
    v_mfma_f32_32x32x16_bf16 v[116:131], v[56:59], a[156:159], v[116:131]
    buffer_load_dwordx4 v3, s[8:11], s28 offen sc0 sc1 lds
    s_waitcnt lgkmcnt(3)
    v_mfma_f32_32x32x16_bf16 v[64:79], v[20:23], a[160:163], v[64:79]
    ds_read_b128 v[44:47], v10 offset:32768
    ds_read_b128 v[48:51], v10 offset:40960
    s_waitcnt lgkmcnt(4)
    v_mfma_f32_32x32x16_bf16 v[84:99], v[24:27], a[160:163], v[84:99]
    ds_read_b128 v[52:55], v18 offset:32768
    ds_read_b128 v[56:59], v18 offset:40960
    s_add_u32 m0, s17, 2048
    s_waitcnt lgkmcnt(5)
    v_mfma_f32_32x32x16_bf16 v[100:115], v[28:31], a[160:163], v[100:115]
    buffer_load_dwordx4 v4, s[8:11], s28 offen sc0 sc1 lds
    s_add_u32 m0, s17, 3072
    s_waitcnt lgkmcnt(4)
    v_mfma_f32_32x32x16_bf16 v[116:131], v[40:43], a[160:163], v[116:131]
    buffer_load_dwordx4 v5, s[8:11], s28 offen sc0 sc1 lds
    s_waitcnt lgkmcnt(3)
    v_mfma_f32_32x32x16_bf16 v[64:79], v[44:47], a[164:167], v[64:79]
    ds_read_b128 v[20:23], v11 offset:32768
    ds_read_b128 v[24:27], v11 offset:40960
    s_waitcnt lgkmcnt(4)
    v_mfma_f32_32x32x16_bf16 v[84:99], v[48:51], a[164:167], v[84:99]
    ds_read_b128 v[28:31], v19 offset:32768
    ds_read_b128 v[40:43], v19 offset:40960
    s_add_u32 s29, s28, 65536
    s_add_u32 m0, s17, 4096
    s_waitcnt lgkmcnt(5)
    v_mfma_f32_32x32x16_bf16 v[100:115], v[52:55], a[164:167], v[100:115]
    buffer_load_dwordx4 v2, s[8:11], s29 offen sc0 sc1 lds
    s_add_u32 m0, s17, 5120
    s_waitcnt lgkmcnt(4)
    v_mfma_f32_32x32x16_bf16 v[116:131], v[56:59], a[164:167], v[116:131]
    buffer_load_dwordx4 v3, s[8:11], s29 offen sc0 sc1 lds
    s_waitcnt lgkmcnt(3)
    v_mfma_f32_32x32x16_bf16 v[64:79], v[20:23], a[168:171], v[64:79]
    ds_read_b128 v[44:47], v12 offset:32768
    ds_read_b128 v[48:51], v12 offset:40960
    s_waitcnt lgkmcnt(4)
    v_mfma_f32_32x32x16_bf16 v[84:99], v[24:27], a[168:171], v[84:99]
    ds_read_b128 v[52:55], v32 offset:32768
    ds_read_b128 v[56:59], v32 offset:40960
    s_add_u32 m0, s17, 6144
    s_waitcnt lgkmcnt(5)
    v_mfma_f32_32x32x16_bf16 v[100:115], v[28:31], a[168:171], v[100:115]
    buffer_load_dwordx4 v4, s[8:11], s29 offen sc0 sc1 lds
    s_add_u32 m0, s17, 7168
    s_waitcnt lgkmcnt(4)
    v_mfma_f32_32x32x16_bf16 v[116:131], v[40:43], a[168:171], v[116:131]
    buffer_load_dwordx4 v5, s[8:11], s29 offen sc0 sc1 lds
    s_waitcnt lgkmcnt(0)
    s_waitcnt vmcnt(16)
    s_barrier
    v_mfma_f32_32x32x16_bf16 v[64:79], v[44:47], a[172:175], v[64:79]
    ds_read_b128 v[20:23], v13 offset:0
    ds_read_b128 v[24:27], v13 offset:8192
    v_mfma_f32_32x32x16_bf16 v[84:99], v[48:51], a[172:175], v[84:99]
    ds_read_b128 v[28:31], v33 offset:0
    ds_read_b128 v[40:43], v33 offset:8192
    s_add_u32 s12, s12, 256
    s_and_b32 s12, s12, 0xfff
    s_add_u32 s28, s7, s12
    s_add_u32 m0, s17, 32768
    v_mfma_f32_32x32x16_bf16 v[100:115], v[52:55], a[172:175], v[100:115]
    buffer_load_dwordx4 v2, s[8:11], s28 offen sc0 sc1 lds
    s_add_u32 m0, s17, 33792
    v_mfma_f32_32x32x16_bf16 v[116:131], v[56:59], a[172:175], v[116:131]
    buffer_load_dwordx4 v3, s[8:11], s28 offen sc0 sc1 lds
    s_waitcnt lgkmcnt(3)
    v_mfma_f32_32x32x16_bf16 v[64:79], v[20:23], a[176:179], v[64:79]
    ds_read_b128 v[44:47], v14 offset:0
    ds_read_b128 v[48:51], v14 offset:8192
    v_lshlrev_b32 v82, 16, v82
    ds_read_b64_tr_b16 v[180:181], v39 offset:0
    v_xor_b32 v83, 0, v61
    s_waitcnt lgkmcnt(5)
    v_mfma_f32_32x32x16_bf16 v[84:99], v[24:27], a[176:179], v[84:99]
    ds_read_b128 v[52:55], v34 offset:0
    ds_read_b128 v[56:59], v34 offset:8192
    ds_read_b64 v[206:207], v83
    s_waitcnt lgkmcnt(0)
    v_lshlrev_b32 v210, 16, v206
    s_add_u32 m0, s17, 34816
    v_mfma_f32_32x32x16_bf16 v[100:115], v[28:31], a[176:179], v[100:115]
    buffer_load_dwordx4 v4, s[8:11], s28 offen sc0 sc1 lds
    v_lshlrev_b32 v214, 16, v180
    v_and_b32 v211, s5, v206
    v_and_b32 v215, s5, v180
    s_add_u32 m0, s17, 35840
    v_mfma_f32_32x32x16_bf16 v[116:131], v[40:43], a[176:179], v[116:131]
    buffer_load_dwordx4 v5, s[8:11], s28 offen sc0 sc1 lds
    v_lshlrev_b32 v212, 16, v207
    v_lshlrev_b32 v216, 16, v181
    v_and_b32 v213, s5, v207
    v_and_b32 v217, s5, v181
    v_mfma_f32_32x32x16_bf16 v[64:79], v[44:47], a[180:183], v[64:79]
    ds_read_b128 v[20:23], v15 offset:0
    ds_read_b128 v[24:27], v15 offset:8192
    ds_read_b64_tr_b16 v[204:205], v39 offset:1024
    v_xor_b32 v83, 16, v61
    ds_read_b64 v[208:209], v83
    v_mfma_f32_32x32x16_bf16 v[84:99], v[48:51], a[180:183], v[84:99]
    ds_read_b128 v[28:31], v35 offset:0
    ds_read_b128 v[40:43], v35 offset:8192
    v_mul_f32 v168, v168, v210
    s_add_u32 s29, s28, 65536
    s_add_u32 m0, s17, 36864
    v_mfma_f32_32x32x16_bf16 v[100:115], v[52:55], a[180:183], v[100:115]
    buffer_load_dwordx4 v2, s[8:11], s29 offen sc0 sc1 lds
    v_mul_f32 v169, v169, v211
    v_mul_f32 v170, v170, v212
    v_mul_f32 v171, v171, v213
    s_add_u32 m0, s17, 37888
    v_mfma_f32_32x32x16_bf16 v[116:131], v[56:59], a[180:183], v[116:131]
    buffer_load_dwordx4 v3, s[8:11], s29 offen sc0 sc1 lds
    v_fmac_f32 v168, v136, v82
    v_fmac_f32 v169, v137, v82
    v_fmac_f32 v170, v138, v82
    v_fmac_f32 v171, v139, v82
    s_waitcnt lgkmcnt(5)
    v_mfma_f32_32x32x16_bf16 v[64:79], v[20:23], a[184:187], v[64:79]
    ds_read_b128 v[44:47], v16 offset:0
    ds_read_b128 v[48:51], v16 offset:8192
    v_mul_f32 v168, v168, v214
    v_mul_f32 v169, v169, v215
    v_mul_f32 v170, v170, v216
    s_waitcnt lgkmcnt(6)
    v_mfma_f32_32x32x16_bf16 v[84:99], v[24:27], a[184:187], v[84:99]
    ds_read_b128 v[52:55], v36 offset:0
    ds_read_b128 v[56:59], v36 offset:8192
    v_mul_f32 v171, v171, v217
    s_waitcnt lgkmcnt(6)
    v_lshlrev_b32 v210, 16, v208
    s_add_u32 m0, s17, 38912
    s_waitcnt lgkmcnt(5)
    v_mfma_f32_32x32x16_bf16 v[100:115], v[28:31], a[184:187], v[100:115]
    buffer_load_dwordx4 v4, s[8:11], s29 offen sc0 sc1 lds
    v_lshlrev_b32 v214, 16, v204
    v_and_b32 v211, s5, v208
    v_and_b32 v215, s5, v204
    s_add_u32 m0, s17, 39936
    s_waitcnt lgkmcnt(4)
    v_mfma_f32_32x32x16_bf16 v[116:131], v[40:43], a[184:187], v[116:131]
    buffer_load_dwordx4 v5, s[8:11], s29 offen sc0 sc1 lds
    v_lshlrev_b32 v212, 16, v209
    v_lshlrev_b32 v216, 16, v205
    v_and_b32 v213, s5, v209
    v_and_b32 v217, s5, v205
    s_waitcnt lgkmcnt(0)
    s_waitcnt vmcnt(16)
    s_barrier
    v_mfma_f32_32x32x16_bf16 v[64:79], v[44:47], a[188:191], v[64:79]
    ds_read_b128 v[20:23], v13 offset:32768
    ds_read_b128 v[24:27], v13 offset:40960
    ds_read_b64_tr_b16 v[180:181], v39 offset:2048
    v_xor_b32 v83, 32, v61
    ds_read_b64 v[206:207], v83
    v_mfma_f32_32x32x16_bf16 v[84:99], v[48:51], a[188:191], v[84:99]
    ds_read_b128 v[28:31], v33 offset:32768
    ds_read_b128 v[40:43], v33 offset:40960
    s_add_u32 s12, s12, 256
    s_and_b32 s12, s12, 0xfff
    s_add_u32 s28, s7, s12
    s_add_u32 m0, s17, 65536
    v_mfma_f32_32x32x16_bf16 v[100:115], v[52:55], a[188:191], v[100:115]
    buffer_load_dwordx4 v2, s[8:11], s28 offen sc0 sc1 lds
    v_mul_f32 v172, v172, v210
    v_mul_f32 v173, v173, v211
    v_mul_f32 v174, v174, v212
    s_add_u32 m0, s17, 66560
    v_mfma_f32_32x32x16_bf16 v[116:131], v[56:59], a[188:191], v[116:131]
    buffer_load_dwordx4 v3, s[8:11], s28 offen sc0 sc1 lds
    v_mul_f32 v175, v175, v213
    v_fmac_f32 v172, v140, v82
    v_fmac_f32 v173, v141, v82
    v_fmac_f32 v174, v142, v82
    s_waitcnt lgkmcnt(5)
    v_mfma_f32_32x32x16_bf16 v[64:79], v[20:23], a[192:195], v[64:79]
    ds_read_b128 v[44:47], v14 offset:32768
    ds_read_b128 v[48:51], v14 offset:40960
    v_fmac_f32 v175, v143, v82
    v_mul_f32 v172, v172, v214
    v_mul_f32 v173, v173, v215
    s_waitcnt lgkmcnt(6)
    v_mfma_f32_32x32x16_bf16 v[84:99], v[24:27], a[192:195], v[84:99]
    ds_read_b128 v[52:55], v34 offset:32768
    ds_read_b128 v[56:59], v34 offset:40960
    v_mul_f32 v174, v174, v216
    v_mul_f32 v175, v175, v217
    s_add_u32 m0, s17, 67584
    s_waitcnt lgkmcnt(5)
    v_mfma_f32_32x32x16_bf16 v[100:115], v[28:31], a[192:195], v[100:115]
    buffer_load_dwordx4 v4, s[8:11], s28 offen sc0 sc1 lds
    v_lshlrev_b32 v210, 16, v206
    v_lshlrev_b32 v214, 16, v180
    v_and_b32 v211, s5, v206
    s_add_u32 m0, s17, 68608
    s_waitcnt lgkmcnt(4)
    v_mfma_f32_32x32x16_bf16 v[116:131], v[40:43], a[192:195], v[116:131]
    buffer_load_dwordx4 v5, s[8:11], s28 offen sc0 sc1 lds
    v_and_b32 v215, s5, v180
    v_lshlrev_b32 v212, 16, v207
    v_lshlrev_b32 v216, 16, v181
    v_and_b32 v213, s5, v207
    s_waitcnt lgkmcnt(3)
    v_mfma_f32_32x32x16_bf16 v[64:79], v[44:47], a[196:199], v[64:79]
    ds_read_b128 v[20:23], v15 offset:32768
    ds_read_b128 v[24:27], v15 offset:40960
    v_and_b32 v217, s5, v181
    ds_read_b64_tr_b16 v[204:205], v39 offset:3072
    v_xor_b32 v83, 48, v61
    s_waitcnt lgkmcnt(5)
    v_mfma_f32_32x32x16_bf16 v[84:99], v[48:51], a[196:199], v[84:99]
    ds_read_b128 v[28:31], v35 offset:32768
    ds_read_b128 v[40:43], v35 offset:40960
    ds_read_b64 v[208:209], v83
    s_add_u32 s29, s28, 65536
    s_add_u32 m0, s17, 69632
    s_waitcnt lgkmcnt(7)
    v_mfma_f32_32x32x16_bf16 v[100:115], v[52:55], a[196:199], v[100:115]
    buffer_load_dwordx4 v2, s[8:11], s29 offen sc0 sc1 lds
    v_mul_f32 v176, v176, v210
    v_mul_f32 v177, v177, v211
    v_mul_f32 v178, v178, v212
    s_add_u32 m0, s17, 70656
    s_waitcnt lgkmcnt(6)
    v_mfma_f32_32x32x16_bf16 v[116:131], v[56:59], a[196:199], v[116:131]
    buffer_load_dwordx4 v3, s[8:11], s29 offen sc0 sc1 lds
    v_mul_f32 v179, v179, v213
    v_fmac_f32 v176, v144, v82
    v_fmac_f32 v177, v145, v82
    v_fmac_f32 v178, v146, v82
    s_waitcnt lgkmcnt(5)
    v_mfma_f32_32x32x16_bf16 v[64:79], v[20:23], a[200:203], v[64:79]
    ds_read_b128 v[44:47], v16 offset:32768
    ds_read_b128 v[48:51], v16 offset:40960
    v_fmac_f32 v179, v147, v82
    v_mul_f32 v176, v176, v214
    v_mul_f32 v177, v177, v215
    s_waitcnt lgkmcnt(6)
    v_mfma_f32_32x32x16_bf16 v[84:99], v[24:27], a[200:203], v[84:99]
    ds_read_b128 v[52:55], v36 offset:32768
    ds_read_b128 v[56:59], v36 offset:40960
    v_mul_f32 v178, v178, v216
    v_mul_f32 v179, v179, v217
    s_add_u32 m0, s17, 71680
    s_waitcnt lgkmcnt(6)
    v_mfma_f32_32x32x16_bf16 v[100:115], v[28:31], a[200:203], v[100:115]
    buffer_load_dwordx4 v4, s[8:11], s29 offen sc0 sc1 lds
    s_waitcnt lgkmcnt(4)
    v_lshlrev_b32 v210, 16, v208
    v_lshlrev_b32 v214, 16, v204
    v_and_b32 v211, s5, v208
    s_add_u32 m0, s17, 72704
    v_mfma_f32_32x32x16_bf16 v[116:131], v[40:43], a[200:203], v[116:131]
    buffer_load_dwordx4 v5, s[8:11], s29 offen sc0 sc1 lds
    v_and_b32 v215, s5, v204
    v_lshlrev_b32 v212, 16, v209
    v_lshlrev_b32 v216, 16, v205
    v_and_b32 v213, s5, v209
    s_waitcnt lgkmcnt(0)
    s_waitcnt vmcnt(16)
    s_barrier
    v_mfma_f32_32x32x16_bf16 v[64:79], v[44:47], a[204:207], v[64:79]
    ds_read_b128 v[20:23], v9 offset:0
    ds_read_b128 v[24:27], v9 offset:8192
    v_and_b32 v217, s5, v205
    ds_read_b64_tr_b16 v[180:181], v39 offset:4096
    v_xor_b32 v83, 64, v61
    v_mfma_f32_32x32x16_bf16 v[84:99], v[48:51], a[204:207], v[84:99]
    ds_read_b128 v[28:31], v17 offset:0
    ds_read_b128 v[40:43], v17 offset:8192
    ds_read_b64 v[206:207], v83
    v_mul_f32 v184, v184, v210
    v_mul_f32 v185, v185, v211
    v_mfma_f32_32x32x16_bf16 v[100:115], v[52:55], a[204:207], v[100:115]
    v_mul_f32 v186, v186, v212
    v_mul_f32 v187, v187, v213
    v_fmac_f32 v184, v148, v82
    v_fmac_f32 v185, v149, v82
    v_fmac_f32 v186, v150, v82
    v_mfma_f32_32x32x16_bf16 v[116:131], v[56:59], a[204:207], v[116:131]
    v_fmac_f32 v187, v151, v82
    v_mul_f32 v184, v184, v214
    v_mul_f32 v185, v185, v215
    v_mul_f32 v186, v186, v216
    v_mul_f32 v187, v187, v217
    s_waitcnt lgkmcnt(5)
    v_mfma_f32_32x32x16_bf16 v[64:79], v[20:23], a[208:211], v[64:79]
    ds_read_b128 v[44:47], v10 offset:0
    ds_read_b128 v[48:51], v10 offset:8192
    s_waitcnt lgkmcnt(2)
    v_lshlrev_b32 v210, 16, v206
    v_lshlrev_b32 v214, 16, v180
    v_and_b32 v211, s5, v206
    v_mfma_f32_32x32x16_bf16 v[84:99], v[24:27], a[208:211], v[84:99]
    ds_read_b128 v[52:55], v18 offset:0
    ds_read_b128 v[56:59], v18 offset:8192
    v_and_b32 v215, s5, v180
    v_lshlrev_b32 v212, 16, v207
    v_lshlrev_b32 v216, 16, v181
    v_mfma_f32_32x32x16_bf16 v[100:115], v[28:31], a[208:211], v[100:115]
    v_and_b32 v213, s5, v207
    v_and_b32 v217, s5, v181
    ds_read_b64_tr_b16 v[204:205], v39 offset:5120
    v_xor_b32 v83, 80, v61
    ds_read_b64 v[208:209], v83
    v_mfma_f32_32x32x16_bf16 v[116:131], v[40:43], a[208:211], v[116:131]
    v_mul_f32 v188, v188, v210
    v_mul_f32 v189, v189, v211
    v_mul_f32 v190, v190, v212
    v_mul_f32 v191, v191, v213
    v_fmac_f32 v188, v152, v82
    s_waitcnt lgkmcnt(5)
    v_mfma_f32_32x32x16_bf16 v[64:79], v[44:47], a[212:215], v[64:79]
    ds_read_b128 v[20:23], v11 offset:0
    ds_read_b128 v[24:27], v11 offset:8192
    v_fmac_f32 v189, v153, v82
    v_fmac_f32 v190, v154, v82
    v_fmac_f32 v191, v155, v82
    s_waitcnt lgkmcnt(6)
    v_mfma_f32_32x32x16_bf16 v[84:99], v[48:51], a[212:215], v[84:99]
    ds_read_b128 v[28:31], v19 offset:0
    ds_read_b128 v[40:43], v19 offset:8192
    v_mul_f32 v188, v188, v214
    v_mul_f32 v189, v189, v215
    v_mul_f32 v190, v190, v216
    s_waitcnt lgkmcnt(7)
    v_mfma_f32_32x32x16_bf16 v[100:115], v[52:55], a[212:215], v[100:115]
    v_mul_f32 v191, v191, v217
    s_waitcnt lgkmcnt(4)
    v_lshlrev_b32 v210, 16, v208
    v_lshlrev_b32 v214, 16, v204
    v_and_b32 v211, s5, v208
    v_and_b32 v215, s5, v204
    v_mfma_f32_32x32x16_bf16 v[116:131], v[56:59], a[212:215], v[116:131]
    v_lshlrev_b32 v212, 16, v209
    v_lshlrev_b32 v216, 16, v205
    v_and_b32 v213, s5, v209
    v_and_b32 v217, s5, v205
    ds_read_b64_tr_b16 v[180:181], v39 offset:6144
    s_waitcnt lgkmcnt(4)
    v_mfma_f32_32x32x16_bf16 v[64:79], v[20:23], a[216:219], v[64:79]
    ds_read_b128 v[44:47], v12 offset:0
    ds_read_b128 v[48:51], v12 offset:8192
    v_xor_b32 v83, 96, v61
    ds_read_b64 v[206:207], v83
    v_mul_f32 v192, v192, v210
    s_waitcnt lgkmcnt(6)
    v_mfma_f32_32x32x16_bf16 v[84:99], v[24:27], a[216:219], v[84:99]
    ds_read_b128 v[52:55], v32 offset:0
    ds_read_b128 v[56:59], v32 offset:8192
    v_mul_f32 v193, v193, v211
    v_mul_f32 v194, v194, v212
    v_mul_f32 v195, v195, v213
    s_waitcnt lgkmcnt(7)
    v_mfma_f32_32x32x16_bf16 v[100:115], v[28:31], a[216:219], v[100:115]
    v_fmac_f32 v192, v156, v82
    v_fmac_f32 v193, v157, v82
    v_fmac_f32 v194, v158, v82
    v_fmac_f32 v195, v159, v82
    v_mul_f32 v192, v192, v214
    s_waitcnt lgkmcnt(6)
    v_mfma_f32_32x32x16_bf16 v[116:131], v[40:43], a[216:219], v[116:131]
    v_mul_f32 v193, v193, v215
    v_mul_f32 v194, v194, v216
    v_mul_f32 v195, v195, v217
    s_waitcnt lgkmcnt(2)
    v_lshlrev_b32 v210, 16, v206
    v_lshlrev_b32 v214, 16, v180
    s_waitcnt lgkmcnt(0)
    s_waitcnt vmcnt(8)
    s_barrier
    v_mfma_f32_32x32x16_bf16 v[64:79], v[44:47], a[220:223], v[64:79]
    ds_read_b128 v[20:23], v9 offset:32768
    ds_read_b128 v[24:27], v9 offset:40960
    v_and_b32 v211, s5, v206
    v_and_b32 v215, s5, v180
    v_lshlrev_b32 v212, 16, v207
    v_mfma_f32_32x32x16_bf16 v[84:99], v[48:51], a[220:223], v[84:99]
    ds_read_b128 v[28:31], v17 offset:32768
    ds_read_b128 v[40:43], v17 offset:40960
    v_lshlrev_b32 v216, 16, v181
    v_and_b32 v213, s5, v207
    v_and_b32 v217, s5, v181
    v_mfma_f32_32x32x16_bf16 v[100:115], v[52:55], a[220:223], v[100:115]
    ds_read_b64_tr_b16 v[204:205], v39 offset:7168
    v_xor_b32 v83, 112, v61
    ds_read_b64 v[208:209], v83
    v_mul_f32 v196, v196, v210
    v_mul_f32 v197, v197, v211
    v_mfma_f32_32x32x16_bf16 v[116:131], v[56:59], a[220:223], v[116:131]
    v_mul_f32 v198, v198, v212
    v_mul_f32 v199, v199, v213
    v_fmac_f32 v196, v160, v82
    v_fmac_f32 v197, v161, v82
    v_fmac_f32 v198, v162, v82
    s_waitcnt lgkmcnt(5)
    v_mfma_f32_32x32x16_bf16 v[64:79], v[20:23], a[224:227], v[64:79]
    ds_read_b128 v[44:47], v10 offset:32768
    ds_read_b128 v[48:51], v10 offset:40960
    v_fmac_f32 v199, v163, v82
    v_mul_f32 v196, v196, v214
    v_mul_f32 v197, v197, v215
    s_waitcnt lgkmcnt(6)
    v_mfma_f32_32x32x16_bf16 v[84:99], v[24:27], a[224:227], v[84:99]
    ds_read_b128 v[52:55], v18 offset:32768
    ds_read_b128 v[56:59], v18 offset:40960
    v_mul_f32 v198, v198, v216
    v_mul_f32 v199, v199, v217
    s_waitcnt lgkmcnt(4)
    v_lshlrev_b32 v210, 16, v208
    v_mfma_f32_32x32x16_bf16 v[100:115], v[28:31], a[224:227], v[100:115]
    v_lshlrev_b32 v214, 16, v204
    v_and_b32 v211, s5, v208
    v_and_b32 v215, s5, v204
    v_lshlrev_b32 v212, 16, v209
    v_lshlrev_b32 v216, 16, v205
    v_mfma_f32_32x32x16_bf16 v[116:131], v[40:43], a[224:227], v[116:131]
    v_and_b32 v213, s5, v209
    v_and_b32 v217, s5, v205
    v_mul_f32 v200, v200, v210
    v_mul_f32 v201, v201, v211
    v_mul_f32 v202, v202, v212
    s_waitcnt lgkmcnt(3)
    v_mfma_f32_32x32x16_bf16 v[64:79], v[44:47], a[228:231], v[64:79]
    ds_read_b128 v[20:23], v11 offset:32768
    ds_read_b128 v[24:27], v11 offset:40960
    v_mul_f32 v203, v203, v213
    v_fmac_f32 v200, v164, v82
    v_fmac_f32 v201, v165, v82
    s_waitcnt lgkmcnt(4)
    v_mfma_f32_32x32x16_bf16 v[84:99], v[48:51], a[228:231], v[84:99]
    ds_read_b128 v[28:31], v19 offset:32768
    ds_read_b128 v[40:43], v19 offset:40960
    v_fmac_f32 v202, v166, v82
    v_fmac_f32 v203, v167, v82
    v_mul_f32 v200, v200, v214
    s_waitcnt lgkmcnt(5)
    v_mfma_f32_32x32x16_bf16 v[100:115], v[52:55], a[228:231], v[100:115]
    v_mul_f32 v201, v201, v215
    v_mul_f32 v202, v202, v216
    v_mul_f32 v203, v203, v217
    s_waitcnt lgkmcnt(4)
    v_mfma_f32_32x32x16_bf16 v[116:131], v[56:59], a[228:231], v[116:131]
    s_waitcnt lgkmcnt(3)
    v_mfma_f32_32x32x16_bf16 v[64:79], v[20:23], a[232:235], v[64:79]
    ds_read_b128 v[44:47], v12 offset:32768
    ds_read_b128 v[48:51], v12 offset:40960
    s_waitcnt lgkmcnt(4)
    v_mfma_f32_32x32x16_bf16 v[84:99], v[24:27], a[232:235], v[84:99]
    ds_read_b128 v[52:55], v32 offset:32768
    ds_read_b128 v[56:59], v32 offset:40960
    s_waitcnt lgkmcnt(5)
    v_mfma_f32_32x32x16_bf16 v[100:115], v[28:31], a[232:235], v[100:115]
    s_waitcnt lgkmcnt(4)
    v_mfma_f32_32x32x16_bf16 v[116:131], v[40:43], a[232:235], v[116:131]
    s_waitcnt lgkmcnt(0)
    s_waitcnt vmcnt(0)
    s_barrier
    v_mfma_f32_32x32x16_bf16 v[64:79], v[44:47], a[236:239], v[64:79]
    ds_read_b128 v[20:23], v33 offset:0
    ds_read_b128 v[24:27], v33 offset:8192
    v_mfma_f32_32x32x16_bf16 v[84:99], v[48:51], a[236:239], v[84:99]
    ds_read_b128 v[28:31], v34 offset:0
    ds_read_b128 v[40:43], v34 offset:8192
    v_mfma_f32_32x32x16_bf16 v[100:115], v[52:55], a[236:239], v[100:115]
    v_mfma_f32_32x32x16_bf16 v[116:131], v[56:59], a[236:239], v[116:131]
    s_waitcnt lgkmcnt(3)
    v_mfma_f32_32x32x16_bf16 v[100:115], v[20:23], a[240:243], v[100:115]
    ds_read_b128 v[44:47], v35 offset:0
    ds_read_b128 v[48:51], v35 offset:8192
    s_waitcnt lgkmcnt(4)
    v_mfma_f32_32x32x16_bf16 v[116:131], v[24:27], a[240:243], v[116:131]
    ds_read_b128 v[52:55], v36 offset:0
    ds_read_b128 v[56:59], v36 offset:8192
    s_waitcnt lgkmcnt(5)
    v_mfma_f32_32x32x16_bf16 v[100:115], v[28:31], a[244:247], v[100:115]
    s_waitcnt lgkmcnt(4)
    v_mfma_f32_32x32x16_bf16 v[116:131], v[40:43], a[244:247], v[116:131]
    s_waitcnt lgkmcnt(3)
    v_mfma_f32_32x32x16_bf16 v[100:115], v[44:47], a[248:251], v[100:115]
    ds_read_b128 v[20:23], v13 offset:0
    ds_read_b128 v[24:27], v13 offset:8192
    s_waitcnt lgkmcnt(4)
    v_mfma_f32_32x32x16_bf16 v[116:131], v[48:51], a[248:251], v[116:131]
    ds_read_b128 v[28:31], v14 offset:0
    ds_read_b128 v[40:43], v14 offset:8192
    s_waitcnt lgkmcnt(5)
    v_mfma_f32_32x32x16_bf16 v[100:115], v[52:55], a[252:255], v[100:115]
    s_waitcnt lgkmcnt(4)
    v_mfma_f32_32x32x16_bf16 v[116:131], v[56:59], a[252:255], v[116:131]
    s_waitcnt lgkmcnt(3)
    v_mfma_f32_32x32x16_bf16 v[64:79], v[20:23], a[240:243], v[64:79]
    ds_read_b128 v[44:47], v15 offset:0
    ds_read_b128 v[48:51], v15 offset:8192
    s_nop 5
    ds_write_b128 v218, v[100:103] offset:0
    s_waitcnt lgkmcnt(5)
    v_mfma_f32_32x32x16_bf16 v[84:99], v[24:27], a[240:243], v[84:99]
    ds_read_b128 v[52:55], v16 offset:0
    ds_read_b128 v[56:59], v16 offset:8192
    ds_write_b128 v218, v[104:107] offset:1024
    s_waitcnt lgkmcnt(7)
    v_mfma_f32_32x32x16_bf16 v[64:79], v[28:31], a[244:247], v[64:79]
    ds_write_b128 v218, v[108:111] offset:2048
    s_waitcnt lgkmcnt(7)
    v_mfma_f32_32x32x16_bf16 v[84:99], v[40:43], a[244:247], v[84:99]
    ds_write_b128 v218, v[112:115] offset:3072
    s_waitcnt lgkmcnt(3)
    v_mfma_f32_32x32x16_bf16 v[64:79], v[44:47], a[248:251], v[64:79]
    ds_write_b128 v218, v[116:119] offset:4096
    v_mfma_f32_32x32x16_bf16 v[84:99], v[48:51], a[248:251], v[84:99]
    ds_write_b128 v218, v[120:123] offset:5120
    v_mfma_f32_32x32x16_bf16 v[64:79], v[52:55], a[252:255], v[64:79]
    ds_write_b128 v218, v[124:127] offset:6144
    v_mfma_f32_32x32x16_bf16 v[84:99], v[56:59], a[252:255], v[84:99]
    ds_write_b128 v218, v[128:131] offset:7168
    s_waitcnt lgkmcnt(0)
    s_barrier
    ds_read_b128 v[20:23], v219 offset:0
    ds_read_b128 v[24:27], v219 offset:1024
    ds_read_b128 v[28:31], v219 offset:2048
    ds_read_b128 v[40:43], v219 offset:3072
    ds_read_b128 v[44:47], v219 offset:4096
    ds_read_b128 v[48:51], v219 offset:5120
    ds_read_b128 v[52:55], v219 offset:6144
    ds_read_b128 v[56:59], v219 offset:7168
    s_waitcnt lgkmcnt(7)
    v_add_f32 v64, v64, v20
    v_add_f32 v65, v65, v21
    v_add_f32 v66, v66, v22
    v_add_f32 v67, v67, v23
    v_fma_f32 v64, v136, v64, v168
    v_fma_f32 v65, v137, v65, v169
    v_fma_f32 v66, v138, v66, v170
    v_fma_f32 v67, v139, v67, v171
    buffer_store_dword v64, v132, s[48:51], s30 offen
    buffer_store_dword v65, v133, s[48:51], s30 offen
    buffer_store_dword v66, v134, s[48:51], s30 offen
    buffer_store_dword v67, v135, s[48:51], s30 offen
    s_waitcnt lgkmcnt(6)
    v_add_f32 v68, v68, v24
    v_add_f32 v69, v69, v25
    v_add_f32 v70, v70, v26
    v_add_f32 v71, v71, v27
    v_fma_f32 v68, v140, v68, v172
    v_fma_f32 v69, v141, v69, v173
    v_fma_f32 v70, v142, v70, v174
    v_fma_f32 v71, v143, v71, v175
    s_add_u32 s30, s30, 32768
    buffer_store_dword v68, v132, s[48:51], s30 offen
    buffer_store_dword v69, v133, s[48:51], s30 offen
    buffer_store_dword v70, v134, s[48:51], s30 offen
    buffer_store_dword v71, v135, s[48:51], s30 offen
    s_waitcnt lgkmcnt(5)
    v_add_f32 v72, v72, v28
    v_add_f32 v73, v73, v29
    v_add_f32 v74, v74, v30
    v_add_f32 v75, v75, v31
    v_fma_f32 v72, v144, v72, v176
    v_fma_f32 v73, v145, v73, v177
    v_fma_f32 v74, v146, v74, v178
    v_fma_f32 v75, v147, v75, v179
    s_add_u32 s30, s30, 32768
    buffer_store_dword v72, v132, s[48:51], s30 offen
    buffer_store_dword v73, v133, s[48:51], s30 offen
    buffer_store_dword v74, v134, s[48:51], s30 offen
    buffer_store_dword v75, v135, s[48:51], s30 offen
    s_waitcnt lgkmcnt(4)
    v_add_f32 v76, v76, v40
    v_add_f32 v77, v77, v41
    v_add_f32 v78, v78, v42
    v_add_f32 v79, v79, v43
    v_fma_f32 v76, v148, v76, v184
    v_fma_f32 v77, v149, v77, v185
    v_fma_f32 v78, v150, v78, v186
    v_fma_f32 v79, v151, v79, v187
    s_add_u32 s30, s30, 32768
    buffer_store_dword v76, v132, s[48:51], s30 offen
    buffer_store_dword v77, v133, s[48:51], s30 offen
    buffer_store_dword v78, v134, s[48:51], s30 offen
    buffer_store_dword v79, v135, s[48:51], s30 offen
    s_waitcnt lgkmcnt(3)
    v_add_f32 v84, v84, v44
    v_add_f32 v85, v85, v45
    v_add_f32 v86, v86, v46
    v_add_f32 v87, v87, v47
    v_fma_f32 v84, v152, v84, v188
    v_fma_f32 v85, v153, v85, v189
    v_fma_f32 v86, v154, v86, v190
    v_fma_f32 v87, v155, v87, v191
    s_add_u32 s30, s30, 32768
    buffer_store_dword v84, v132, s[48:51], s30 offen
    buffer_store_dword v85, v133, s[48:51], s30 offen
    buffer_store_dword v86, v134, s[48:51], s30 offen
    buffer_store_dword v87, v135, s[48:51], s30 offen
    s_waitcnt lgkmcnt(2)
    v_add_f32 v88, v88, v48
    v_add_f32 v89, v89, v49
    v_add_f32 v90, v90, v50
    v_add_f32 v91, v91, v51
    v_fma_f32 v88, v156, v88, v192
    v_fma_f32 v89, v157, v89, v193
    v_fma_f32 v90, v158, v90, v194
    v_fma_f32 v91, v159, v91, v195
    s_add_u32 s30, s30, 32768
    buffer_store_dword v88, v132, s[48:51], s30 offen
    buffer_store_dword v89, v133, s[48:51], s30 offen
    buffer_store_dword v90, v134, s[48:51], s30 offen
    buffer_store_dword v91, v135, s[48:51], s30 offen
    s_waitcnt lgkmcnt(1)
    v_add_f32 v92, v92, v52
    v_add_f32 v93, v93, v53
    v_add_f32 v94, v94, v54
    v_add_f32 v95, v95, v55
    v_fma_f32 v92, v160, v92, v196
    v_fma_f32 v93, v161, v93, v197
    v_fma_f32 v94, v162, v94, v198
    v_fma_f32 v95, v163, v95, v199
    s_add_u32 s30, s30, 32768
    buffer_store_dword v92, v132, s[48:51], s30 offen
    buffer_store_dword v93, v133, s[48:51], s30 offen
    buffer_store_dword v94, v134, s[48:51], s30 offen
    buffer_store_dword v95, v135, s[48:51], s30 offen
    s_waitcnt lgkmcnt(0)
    v_add_f32 v96, v96, v56
    v_add_f32 v97, v97, v57
    v_add_f32 v98, v98, v58
    v_add_f32 v99, v99, v59
    v_fma_f32 v96, v164, v96, v200
    v_fma_f32 v97, v165, v97, v201
    v_fma_f32 v98, v166, v98, v202
    v_fma_f32 v99, v167, v99, v203
    s_add_u32 s30, s30, 32768
    buffer_store_dword v96, v132, s[48:51], s30 offen
    buffer_store_dword v97, v133, s[48:51], s30 offen
    buffer_store_dword v98, v134, s[48:51], s30 offen
    buffer_store_dword v99, v135, s[48:51], s30 offen
Lend_gated_mix__ssm_conv_s5__ssm_conv_h3__prompt_kernel:
    s_endpgm

.section .rodata,"a"
.p2align 6
.amdhsa_kernel gated_mix__ssm_conv_s5__ssm_conv_h3__prompt_kernel
  .amdhsa_next_free_vgpr 496
  .amdhsa_next_free_sgpr 84
  .amdhsa_accum_offset 240
  .amdhsa_group_segment_fixed_size 0
  .amdhsa_kernarg_size 152
  .amdhsa_user_sgpr_count 2
  .amdhsa_user_sgpr_kernarg_segment_ptr 1
  .amdhsa_system_sgpr_workgroup_id_x 1
  .amdhsa_float_denorm_mode_32 3
.end_amdhsa_kernel
```

```asm
; @launch grid=(256,1,1) block=(256,1,1) lds=163840
.amdgcn_target "amdgcn-amd-amdhsa--gfx950"
.text
.globl gated_mix__ssm_conv_s5__ssm_conv_h3__prompt_kernel
.p2align 8
.type gated_mix__ssm_conv_s5__ssm_conv_h3__prompt_kernel,@function
gated_mix__ssm_conv_s5__ssm_conv_h3__prompt_kernel:
    s_cmp_ge_u32 s2, 256
    s_cbranch_scc1 Lend_gated_mix__ssm_conv_s5__ssm_conv_h3__prompt_kernel
    s_load_dwordx16 s[4:19], s[0:1], 0
    s_load_dwordx16 s[20:35], s[0:1], 64
    s_load_dwordx4 s[36:39], s[0:1], 128
    s_load_dwordx2 s[40:41], s[0:1], 144
    s_waitcnt lgkmcnt(0)
    s_memrealtime s[22:23]
    v_lshrrev_b32 v1, 6, v0
    s_nop 0
    v_readfirstlane_b32 s42, v1
    v_and_b32 v1, 63, v0
    s_and_b32 s45, s2, 7
    s_lshr_b32 s43, s45, 1
    s_lshl_b32 s43, s43, 2
    s_and_b32 s44, s45, 1
    s_lshl_b32 s44, s44, 3
    s_lshr_b32 s45, s2, 3
    s_and_b32 s3, s45, 3
    s_add_u32 s43, s43, s3
    s_lshr_b32 s45, s45, 2
    s_add_u32 s44, s44, s45
    v_mov_b32 v4, 0
    v_mov_b32 v5, 0
    v_mov_b32 v6, 0
    v_mov_b32 v7, 0
    v_lshlrev_b32 v2, 4, v0
    v_add_u32 v2, 148480, v2
    ds_write_b128 v2, v[4:7]
    v_lshlrev_b32 v2, 2, v0
    v_add_u32 v2, 152576, v2
    ds_write_b32 v2, v4
    v_lshrrev_b32 v3, 4, v1
    v_and_b32 v16, 7, v1
    v_xor_b32 v16, v16, v3
    v_lshlrev_b32 v16, 4, v16
    v_lshrrev_b32 v3, 3, v1
    v_lshl_add_u32 v12, v3, 11, v16
    v_and_b32 v3, 32, v1
    v_lshl_add_u32 v8, v3, 11, v16
    v_and_b32 v3, 8, v1
    v_lshl_add_u32 v8, v3, 12, v8
    v_and_b32 v3, 16, v1
    v_lshl_add_u32 v8, v3, 7, v8
    v_xor_b32 v3, 64, v8
    v_xor_b32 v16, 64, v12
    v_add_u32 v9, 4096, v3
    v_add_u32 v10, 8192, v8
    v_add_u32 v11, 12288, v3
    v_add_u32 v13, 16384, v16
    v_add_u32 v14, 32768, v12
    v_add_u32 v15, 49152, v16
    s_lshr_b32 s48, s42, 1
    s_lshl_b32 s45, s43, 7
    s_lshl_b32 s3, s48, 6
    s_add_u32 s45, s45, s3
    s_and_b32 s3, s42, 1
    s_lshl_b32 s3, s3, 3
    s_add_u32 s45, s45, s3
    s_lshl_b32 s45, s45, 11
    s_lshl_b32 s46, s44, 6
    s_lshl_b32 s3, s48, 5
    s_add_u32 s46, s46, s3
    s_lshl_b32 s46, s46, 11
    s_lshl_b32 s47, s42, 12
    s_lshl_b32 s3, s43, 2
    s_add_u32 s3, s3, s44
    s_and_b32 s3, s3, 15
    s_lshl_b32 s49, s3, 7
    v_bfe_u32 v16, v1, 3, 2
    v_lshrrev_b32 v17, 5, v1
    v_lshlrev_b32 v17, 2, v17
    v_lshl_add_u32 v16, v16, 3, v17
    v_and_b32 v17, 7, v1
    v_lshlrev_b32 v17, 4, v17
    v_lshl_add_u32 v3, v16, 11, v17
    s_lshl_b32 s48, s43, 7
    s_lshl_b32 s3, s42, 5
    s_add_u32 s48, s48, s3
    s_lshl_b32 s48, s48, 11
    s_lshl_b32 s3, s44, 7
    s_add_u32 s48, s48, s3
    v_add_u32 v3, s48, v3
    v_subrev_u32 v16, 6144, v3
    v_min_u32 v16, 0x7fff0000, v16
    v_subrev_u32 v20, 4096, v3
    v_min_u32 v20, 0x7fff0000, v20
    v_subrev_u32 v24, 2048, v3
    v_min_u32 v24, 0x7fff0000, v24
    s_mov_b32 s48, 4096
    s_lshl_b32 s52, s44, 9
    v_lshlrev_b32 v60, 4, v1
    s_mov_b32 s56, s4
    s_mov_b32 s57, s5
    s_mov_b32 s58, 4194304
    s_mov_b32 s59, 131072
    s_and_b32 s3, s42, 1
    s_cmp_eq_u32 s3, 0
    s_cselect_b32 s60, s10, s12
    s_cselect_b32 s61, s11, s13
    s_mov_b32 s62, 2097152
    s_mov_b32 s63, 131072
    s_waitcnt lgkmcnt(0)
    s_add_u32 s50, s45, s49
    s_add_u32 m0, s47, 0
    s_nop 0
    buffer_load_dwordx4 v8, s[56:59], s50 offen  lds
    s_add_u32 m0, s47, 1024
    s_nop 0
    buffer_load_dwordx4 v9, s[56:59], s50 offen  lds
    s_add_u32 m0, s47, 2048
    s_nop 0
    buffer_load_dwordx4 v10, s[56:59], s50 offen  lds
    s_add_u32 m0, s47, 3072
    s_nop 0
    buffer_load_dwordx4 v11, s[56:59], s50 offen  lds
    s_add_u32 s51, s46, s49
    s_add_u32 m0, s47, 16384
    s_nop 0
    buffer_load_dwordx4 v12, s[60:63], s51 offen  lds
    s_add_u32 m0, s47, 17408
    s_nop 0
    buffer_load_dwordx4 v13, s[60:63], s51 offen  lds
    s_add_u32 m0, s47, 18432
    s_nop 0
    buffer_load_dwordx4 v14, s[60:63], s51 offen  lds
    s_add_u32 m0, s47, 19456
    s_nop 0
    buffer_load_dwordx4 v15, s[60:63], s51 offen  lds
    s_add_u32 s49, s49, 128
    s_and_b32 s49, s49, 0x7ff
    s_add_u32 s50, s45, s49
    s_add_u32 m0, s47, 32768
    s_nop 0
    buffer_load_dwordx4 v8, s[56:59], s50 offen  lds
    s_add_u32 m0, s47, 33792
    s_nop 0
    buffer_load_dwordx4 v9, s[56:59], s50 offen  lds
    s_add_u32 m0, s47, 34816
    s_nop 0
    buffer_load_dwordx4 v10, s[56:59], s50 offen  lds
    s_add_u32 m0, s47, 35840
    s_nop 0
    buffer_load_dwordx4 v11, s[56:59], s50 offen  lds
    s_add_u32 s51, s46, s49
    s_add_u32 m0, s47, 49152
    s_nop 0
    buffer_load_dwordx4 v12, s[60:63], s51 offen  lds
    s_add_u32 m0, s47, 50176
    s_nop 0
    buffer_load_dwordx4 v13, s[60:63], s51 offen  lds
    s_add_u32 m0, s47, 51200
    s_nop 0
    buffer_load_dwordx4 v14, s[60:63], s51 offen  lds
    s_add_u32 m0, s47, 52224
    s_nop 0
    buffer_load_dwordx4 v15, s[60:63], s51 offen  lds
    s_mov_b32 s64, s28
    s_mov_b32 s65, s29
    s_mov_b32 s66, 8192
    s_mov_b32 s67, 131072
    s_mov_b32 s68, s24
    s_mov_b32 s69, s25
    s_mov_b32 s70, 4194304
    s_mov_b32 s71, 131072
    s_mov_b32 s72, s26
    s_mov_b32 s73, s27
    s_mov_b32 s74, 4194304
    s_mov_b32 s75, 131072
    s_lshl_b32 s3, s42, 10
    s_add_u32 s4, s3, 157696
    s_mov_b32 s24, s38
    s_mov_b32 s25, s39
    s_mov_b32 s26, 256
    s_mov_b32 s27, 131072
    s_or_b32 s3, s2, s42
    s_cmp_lg_u32 s3, 0
    s_cbranch_scc1 Lnonce_gate_1
    v_mov_b32 v4, s22
    v_mov_b32 v5, s23
    v_mov_b32 v2, 0
    buffer_store_dwordx2 v[4:5], v2, s[24:27], 0 offen sc0 sc1
    s_nop 1
Lnonce_gate_1:
    s_mov_b32 s5, 0xffff0000
    v_mov_b32 v6, 0
    s_and_b32 s3, s42, 1
    s_lshl_b32 s3, s3, 5
    v_and_b32 v7, 31, v1
    v_add_u32 v7, s3, v7
    s_lshl_b32 s3, s44, 6
    v_add_u32 v61, s3, v7
    v_lshlrev_b32 v61, 1, v61
    s_mov_b32 s76, s6
    s_mov_b32 s77, s7
    s_mov_b32 s78, 2048
    s_mov_b32 s79, 131072
    buffer_load_ushort v62, v61, s[76:79], 0 offen
    s_mov_b32 s76, s8
    s_mov_b32 s77, s9
    s_mov_b32 s78, 2048
    s_mov_b32 s79, 131072
    buffer_load_ushort v63, v61, s[76:79], 0 offen
    s_mov_b32 s8, s18
    s_mov_b32 s9, s19
    s_mov_b32 s10, 2048
    s_mov_b32 s11, 131072
    buffer_load_ushort v64, v61, s[8:11], 0 offen
    v_and_b32 v81, 31, v1
    v_bfe_u32 v82, v81, 1, 3
    v_lshrrev_b32 v83, 5, v1
    v_xor_b32 v82, v82, v83
    v_lshlrev_b32 v82, 4, v82
    v_lshl_add_u32 v82, v81, 7, v82
    s_lshr_b32 s6, s42, 1
    s_lshl_b32 s6, s6, 13
    s_and_b32 s7, s42, 1
    s_lshl_b32 s7, s7, 13
    s_add_u32 s7, s7, 16384
    v_xor_b32 v83, 0, v82
    v_add_u32 v65, s6, v83
    v_add_u32 v73, s7, v83
    v_add_u32 v69, 0x10000, v65
    v_add_u32 v77, 0x10000, v73
    v_xor_b32 v83, 32, v82
    v_add_u32 v66, s6, v83
    v_add_u32 v74, s7, v83
    v_add_u32 v70, 0x10000, v66
    v_add_u32 v78, 0x10000, v74
    v_xor_b32 v83, 64, v82
    v_add_u32 v67, s6, v83
    v_add_u32 v75, s7, v83
    v_add_u32 v71, 0x10000, v67
    v_add_u32 v79, 0x10000, v75
    v_xor_b32 v83, 96, v82
    v_add_u32 v68, s6, v83
    v_add_u32 v76, s7, v83
    v_add_u32 v72, 0x10000, v68
    v_add_u32 v80, 0x10000, v76
    s_mov_b32 s8, s40
    s_mov_b32 s9, s41
    s_mov_b32 s10, 33554432
    s_mov_b32 s11, 131072
    v_and_b32 v81, 7, v1
    s_lshl_b32 s3, s42, 10
    s_add_u32 s3, s3, 157696
    v_lshl_add_u32 v83, v81, 6, s3
    v_bfe_u32 v81, v1, 2, 1
    v_lshlrev_b32 v81, 3, v81
    v_lshrrev_b32 v82, 5, v1
    v_add_u32 v81, v81, v82
    v_lshlrev_b32 v180, 14, v81
    v_bfe_u32 v81, v1, 3, 2
    v_sub_u32 v81, 3, v81
    v_lshl_add_u32 v180, v81, 6, v180
    v_and_b32 v81, 3, v1
    v_lshl_add_u32 v180, v81, 4, v180
    s_lshl_b32 s6, s44, 18
    s_add_u32 s6, s6, 8404736
    s_lshl_b32 s3, s43, 10
    s_sub_u32 s6, s6, s3
    s_lshl_b32 s3, s42, 8
    s_sub_u32 s6, s6, s3
    s_lshl_b32 s13, s44, 4
    s_add_u32 s13, s13, s43
    s_lshl_b32 s13, s13, 2
    s_add_u32 s13, s13, s42
    s_lshl_b32 s13, s13, 3
    s_add_u32 s13, s13, 21495808
    s_lshl_b32 s18, s44, 2
    s_add_u32 s18, s18, s42
    s_lshl_b32 s18, s18, 4
    s_add_u32 s18, s18, s43
    s_lshl_b32 s18, s18, 3
    s_add_u32 s18, s18, 21504000
    s_lshl_b32 s3, s44, 9
    s_add_u32 s3, s3, 21495808
    v_lshrrev_b32 v81, 1, v60
    v_add_u32 v81, s3, v81
    s_lshl_b32 s19, s44, 6
    s_lshr_b32 s3, s43, 3
    s_lshl_b32 s3, s3, 5
    s_add_u32 s19, s19, s3
    s_lshl_b32 s3, s42, 3
    s_add_u32 s19, s19, s3
    s_and_b32 s3, s43, 7
    s_add_u32 s19, s19, s3
    s_lshl_b32 s28, s19, 12
    s_add_u32 s76, s30, s28
    s_addc_u32 s77, s31, 0
    s_mov_b32 s78, 4096
    s_mov_b32 s79, 131072
    s_mov_b32 s80, s32
    s_mov_b32 s81, s33
    s_mov_b32 s82, 2048
    s_mov_b32 s83, 131072
    s_lshl_b32 s3, s19, 1
    v_mov_b32 v82, s3
    buffer_load_ushort v82, v82, s[80:83], 0 offen
    s_mul_i32 s29, s42, 16640
    s_add_u32 s29, s29, 65536
    v_lshrrev_b32 v207, 4, v1
    v_and_b32 v224, 3, v1
    v_xor_b32 v224, v224, v207
    v_lshlrev_b32 v224, 4, v224
    v_lshrrev_b32 v207, 2, v1
    v_lshl_add_u32 v181, v207, 6, v224
    s_lshl_b32 s38, s44, 4
    s_add_u32 s38, s38, s43
    s_lshl_b32 s38, s38, 14
    s_lshl_b32 s39, s42, 12
    s_add_u32 s38, s38, s39
    s_add_u32 s38, s38, 8388608
    s_add_u32 s39, s39, 132096
    s_mov_b32 s80, s14
    s_mov_b32 s81, s15
    s_mov_b32 s82, 2097152
    s_mov_b32 s83, 131072
    s_mov_b32 s84, s16
    s_mov_b32 s85, s17
    s_mov_b32 s86, 2097152
    s_mov_b32 s87, 131072
    v_lshrrev_b32 v224, 2, v1
    v_lshrrev_b32 v225, 4, v1
    v_xor_b32 v225, v225, v1
    v_and_b32 v225, 3, v225
    v_lshlrev_b32 v225, 4, v225
    v_lshl_add_u32 v207, v224, 11, v225
    s_lshl_b32 s14, s44, 17
    s_and_b32 s3, s42, 1
    s_lshl_b32 s3, s3, 16
    s_add_u32 s14, s14, s3
    s_lshl_b32 s3, s43, 7
    s_add_u32 s14, s14, s3
    s_lshr_b32 s3, s42, 1
    s_lshl_b32 s3, s3, 6
    s_add_u32 s14, s14, s3
    s_add_u32 s15, s14, 32768
    s_lshl_b32 s16, s42, 12
    s_add_u32 s16, s16, 132096
    s_mov_b32 s88, s34
    s_mov_b32 s89, s35
    s_mov_b32 s90, 2048
    s_mov_b32 s91, 131072
    s_lshl_b32 s17, s43, 7
    s_lshl_b32 s3, s44, 3
    s_add_u32 s17, s17, s3
    s_lshl_b32 s3, s42, 1
    s_add_u32 s17, s17, s3
    s_lshl_b32 s3, s17, 2
    s_add_u32 s3, s3, 20971520
    v_mov_b32 v224, s3
    s_lshl_b32 s17, s17, 11
    s_mov_b32 s32, 8192
    buffer_load_dwordx4 v[208:211], v60, s[88:91], 0 offen offset:0
    buffer_load_dwordx4 v[212:215], v60, s[88:91], 0 offen offset:1024
    buffer_load_dwordx4 v[44:47], v60, s[56:59], s17 offen offset:0
    buffer_load_dwordx4 v[48:51], v60, s[56:59], s17 offen offset:1024
    buffer_load_dwordx4 v[52:55], v60, s[56:59], s17 offen offset:2048
    buffer_load_dwordx4 v[56:59], v60, s[56:59], s17 offen offset:3072
    s_waitcnt vmcnt(18)
    s_barrier
    ds_read_b128 v[84:87], v65 offset:0
    ds_read_b128 v[92:95], v73 offset:0
    ds_read_b128 v[96:99], v73 offset:4096
    ds_read_b128 v[88:91], v65 offset:4096
    s_add_u32 s49, s49, 128
    s_and_b32 s49, s49, 0x7ff
    s_add_u32 s50, s45, s49
    s_add_u32 m0, s47, 65536
    s_waitcnt lgkmcnt(2)
    v_mfma_f32_32x32x16_bf16 v[116:131], v[84:87], v[92:95], 0
    ds_read_b128 v[100:103], v66 offset:0
    ds_read_b128 v[108:111], v74 offset:0
    buffer_load_dwordx4 v8, s[56:59], s50 offen  lds
    s_add_u32 m0, s47, 66560
    s_waitcnt lgkmcnt(3)
    v_mfma_f32_32x32x16_bf16 v[132:147], v[84:87], v[96:99], 0
    ds_read_b128 v[112:115], v74 offset:4096
    ds_read_b128 v[104:107], v66 offset:4096
    buffer_load_dwordx4 v9, s[56:59], s50 offen  lds
    s_add_u32 m0, s47, 67584
    s_waitcnt lgkmcnt(4)
    v_mfma_f32_32x32x16_bf16 v[148:163], v[88:91], v[92:95], 0
    buffer_load_dwordx4 v10, s[56:59], s50 offen  lds
    s_add_u32 m0, s47, 68608
    v_mfma_f32_32x32x16_bf16 v[164:179], v[88:91], v[96:99], 0
    buffer_load_dwordx4 v11, s[56:59], s50 offen  lds
    s_add_u32 s51, s46, s49
    s_add_u32 m0, s47, 81920
    s_waitcnt lgkmcnt(2)
    v_mfma_f32_32x32x16_bf16 v[116:131], v[100:103], v[108:111], v[116:131]
    ds_read_b128 v[84:87], v67 offset:0
    ds_read_b128 v[92:95], v75 offset:0
    buffer_load_dwordx4 v12, s[60:63], s51 offen  lds
    s_add_u32 m0, s47, 82944
    s_waitcnt lgkmcnt(3)
    v_mfma_f32_32x32x16_bf16 v[132:147], v[100:103], v[112:115], v[132:147]
    ds_read_b128 v[96:99], v75 offset:4096
    ds_read_b128 v[88:91], v67 offset:4096
    buffer_load_dwordx4 v13, s[60:63], s51 offen  lds
    s_add_u32 m0, s47, 83968
    s_waitcnt lgkmcnt(4)
    v_mfma_f32_32x32x16_bf16 v[148:163], v[104:107], v[108:111], v[148:163]
    buffer_load_dwordx4 v14, s[60:63], s51 offen  lds
    s_add_u32 m0, s47, 84992
    v_mfma_f32_32x32x16_bf16 v[164:179], v[104:107], v[112:115], v[164:179]
    buffer_load_dwordx4 v15, s[60:63], s51 offen  lds
    s_add_u32 s49, s49, 128
    s_and_b32 s49, s49, 0x7ff
    s_add_u32 s50, s45, s49
    s_add_u32 m0, s47, 98304
    s_waitcnt lgkmcnt(2)
    v_mfma_f32_32x32x16_bf16 v[116:131], v[84:87], v[92:95], v[116:131]
    ds_read_b128 v[100:103], v68 offset:0
    ds_read_b128 v[108:111], v76 offset:0
    buffer_load_dwordx4 v8, s[56:59], s50 offen  lds
    s_add_u32 m0, s47, 99328
    s_waitcnt lgkmcnt(3)
    v_mfma_f32_32x32x16_bf16 v[132:147], v[84:87], v[96:99], v[132:147]
    ds_read_b128 v[112:115], v76 offset:4096
    ds_read_b128 v[104:107], v68 offset:4096
    buffer_load_dwordx4 v9, s[56:59], s50 offen  lds
    s_add_u32 m0, s47, 100352
    s_waitcnt lgkmcnt(4)
    v_mfma_f32_32x32x16_bf16 v[148:163], v[88:91], v[92:95], v[148:163]
    buffer_load_dwordx4 v10, s[56:59], s50 offen  lds
    s_add_u32 m0, s47, 101376
    v_mfma_f32_32x32x16_bf16 v[164:179], v[88:91], v[96:99], v[164:179]
    buffer_load_dwordx4 v11, s[56:59], s50 offen  lds
    s_waitcnt lgkmcnt(0)
    s_waitcnt vmcnt(22)
    s_barrier
    s_add_u32 s51, s46, s49
    s_add_u32 m0, s47, 114688
    v_mfma_f32_32x32x16_bf16 v[116:131], v[100:103], v[108:111], v[116:131]
    ds_read_b128 v[84:87], v65 offset:32768
    ds_read_b128 v[92:95], v73 offset:32768
    buffer_load_dwordx4 v12, s[60:63], s51 offen  lds
    s_waitcnt vmcnt(22)
    v_lshlrev_b32 v62, 16, v62
    s_waitcnt vmcnt(21)
    v_lshlrev_b32 v63, 16, v63
    s_waitcnt vmcnt(20)
    v_lshlrev_b32 v64, 16, v64
    v_mul_f32 v242, 1069066811, v64
    s_add_u32 m0, s47, 115712
    v_mfma_f32_32x32x16_bf16 v[132:147], v[100:103], v[112:115], v[132:147]
    ds_read_b128 v[96:99], v73 offset:36864
    ds_read_b128 v[88:91], v65 offset:36864
    buffer_load_dwordx4 v13, s[60:63], s51 offen  lds
    v_exp_f32 v242, v242
    s_nop 0
    v_cvt_pk_bf16_f32 v242, v242, v242
    v_lshlrev_b32 v242, 16, v242
    v_mul_f32 v243, v242, v62
    s_add_u32 m0, s47, 116736
    v_mfma_f32_32x32x16_bf16 v[148:163], v[104:107], v[108:111], v[148:163]
    buffer_load_dwordx4 v14, s[60:63], s51 offen  lds
    v_mul_f32 v244, v242, v63
    v_mul_f32 v243, 1069066811, v243
    v_exp_f32 v243, v243
    v_mul_f32 v244, 1042479491, v244
    v_fract_f32 v244, v244
    v_cos_f32 v245, v244
    s_add_u32 m0, s47, 117760
    v_mfma_f32_32x32x16_bf16 v[164:179], v[104:107], v[112:115], v[164:179]
    buffer_load_dwordx4 v15, s[60:63], s51 offen  lds
    v_sin_f32 v246, v244
    v_mul_f32 v230, v243, v245
    v_mul_f32 v231, v243, v246
    v_add_f32 v242, -1.0, v230
    v_mul_f32 v243, v62, v62
    v_fmac_f32 v243, v63, v63
    v_rcp_f32 v243, v243
    s_add_u32 s49, s49, 128
    s_and_b32 s49, s49, 0x7ff
    s_add_u32 s50, s45, s49
    s_add_u32 m0, s47, 0
    s_waitcnt lgkmcnt(2)
    v_mfma_f32_32x32x16_bf16 v[116:131], v[84:87], v[92:95], v[116:131]
    ds_read_b128 v[100:103], v66 offset:32768
    ds_read_b128 v[108:111], v74 offset:32768
    buffer_load_dwordx4 v8, s[56:59], s50 offen  lds
    v_add_f32 v243, v243, v243
    v_mul_f32 v244, v242, v62
    v_fmac_f32 v244, v231, v63
    v_mul_f32 v245, v231, v62
    s_add_u32 m0, s47, 1024
    s_waitcnt lgkmcnt(3)
    v_mfma_f32_32x32x16_bf16 v[132:147], v[84:87], v[96:99], v[132:147]
    ds_read_b128 v[112:115], v74 offset:36864
    ds_read_b128 v[104:107], v66 offset:36864
    buffer_load_dwordx4 v9, s[56:59], s50 offen  lds
    v_fma_f32 v245, -v242, v63, v245
    v_mul_f32 v232, v244, v243
    v_mul_f32 v233, v245, v243
    v_mul_f32 v242, v231, v231
    s_add_u32 m0, s47, 2048
    s_waitcnt lgkmcnt(4)
    v_mfma_f32_32x32x16_bf16 v[148:163], v[88:91], v[92:95], v[148:163]
    buffer_load_dwordx4 v10, s[56:59], s50 offen  lds
    v_fma_f32 v242, v230, v230, -v242
    v_mul_f32 v243, v230, v231
    v_add_f32 v243, v243, v243
    v_mul_f32 v244, v243, v243
    v_fma_f32 v244, v242, v242, -v244
    v_mul_f32 v245, v242, v243
    s_add_u32 m0, s47, 3072
    v_mfma_f32_32x32x16_bf16 v[164:179], v[88:91], v[96:99], v[164:179]
    buffer_load_dwordx4 v11, s[56:59], s50 offen  lds
    v_add_f32 v245, v245, v245
    v_mul_f32 v242, v245, v245
    v_fma_f32 v242, v244, v244, -v242
    v_mul_f32 v243, v244, v245
    v_add_f32 v243, v243, v243
    v_mul_f32 v234, v243, v243
    v_fma_f32 v234, v242, v242, -v234
    s_add_u32 s51, s46, s49
    s_add_u32 m0, s47, 16384
    s_waitcnt lgkmcnt(2)
    v_mfma_f32_32x32x16_bf16 v[116:131], v[100:103], v[108:111], v[116:131]
    ds_read_b128 v[84:87], v67 offset:32768
    ds_read_b128 v[92:95], v75 offset:32768
    buffer_load_dwordx4 v12, s[60:63], s51 offen  lds
    v_mul_f32 v235, v242, v243
    v_add_f32 v235, v235, v235
    v_mul_f32 v242, v235, v235
    v_fma_f32 v242, v234, v234, -v242
    s_add_u32 m0, s47, 17408
    s_waitcnt lgkmcnt(3)
    v_mfma_f32_32x32x16_bf16 v[132:147], v[100:103], v[112:115], v[132:147]
    ds_read_b128 v[96:99], v75 offset:36864
    ds_read_b128 v[88:91], v67 offset:36864
    buffer_load_dwordx4 v13, s[60:63], s51 offen  lds
    v_mul_f32 v243, v234, v235
    v_add_f32 v243, v243, v243
    v_mul_f32 v244, v243, v243
    v_fma_f32 v244, v242, v242, -v244
    s_add_u32 m0, s47, 18432
    s_waitcnt lgkmcnt(4)
    v_mfma_f32_32x32x16_bf16 v[148:163], v[104:107], v[108:111], v[148:163]
    buffer_load_dwordx4 v14, s[60:63], s51 offen  lds
    v_mul_f32 v245, v242, v243
    v_add_f32 v245, v245, v245
    v_mul_f32 v236, v245, v245
    v_fma_f32 v236, v244, v244, -v236
    v_mul_f32 v237, v244, v245
    v_add_f32 v237, v237, v237
    s_add_u32 m0, s47, 19456
    v_mfma_f32_32x32x16_bf16 v[164:179], v[104:107], v[112:115], v[164:179]
    buffer_load_dwordx4 v15, s[60:63], s51 offen  lds
    s_mov_b32 s34, 0
    s_mov_b32 s35, -1
    s_lshr_b32 s3, s42, 1
    s_cmp_eq_u32 s3, 1
    s_cselect_b32 s54, -1, 0
    s_cselect_b32 s55, -1, 0
    v_cndmask_b32 v242, 1.0, v242, s[34:35]
    v_cndmask_b32 v243, 0, v243, s[34:35]
    v_cndmask_b32 v244, 1.0, v244, s[54:55]
    s_waitcnt lgkmcnt(2)
    v_mfma_f32_32x32x16_bf16 v[116:131], v[84:87], v[92:95], v[116:131]
    ds_read_b128 v[100:103], v68 offset:32768
    ds_read_b128 v[108:111], v76 offset:32768
    v_cndmask_b32 v245, 0, v245, s[54:55]
    v_mul_f32 v246, v243, v245
    v_fma_f32 v246, v242, v244, -v246
    v_mul_f32 v247, v242, v245
    v_fmac_f32 v247, v243, v244
    v_mul_f32 v242, v247, v235
    s_waitcnt lgkmcnt(3)
    v_mfma_f32_32x32x16_bf16 v[132:147], v[84:87], v[96:99], v[132:147]
    ds_read_b128 v[112:115], v76 offset:36864
    ds_read_b128 v[104:107], v68 offset:36864
    v_fma_f32 v242, v246, v234, -v242
    v_mul_f32 v243, v246, v235
    v_fmac_f32 v243, v247, v234
    v_mov_b32 v238, v246
    v_mov_b32 v239, v242
    v_mov_b32 v240, v247
    s_waitcnt lgkmcnt(4)
    v_mfma_f32_32x32x16_bf16 v[148:163], v[88:91], v[92:95], v[148:163]
    v_mov_b32 v241, v243
    v_mfma_f32_32x32x16_bf16 v[164:179], v[88:91], v[96:99], v[164:179]
    s_waitcnt lgkmcnt(0)
    s_waitcnt vmcnt(16)
    s_barrier
    s_add_u32 s49, s49, 128
    s_and_b32 s49, s49, 0x7ff
    s_add_u32 s50, s45, s49
    s_add_u32 m0, s47, 32768
    v_mfma_f32_32x32x16_bf16 v[116:131], v[100:103], v[108:111], v[116:131]
    ds_read_b128 v[84:87], v69 offset:0
    ds_read_b128 v[92:95], v77 offset:0
    buffer_load_dwordx4 v8, s[56:59], s50 offen  lds
    v_lshlrev_b32 v203, 16, v208
    v_and_b32 v204, s5, v208
    v_lshlrev_b32 v205, 16, v44
    v_and_b32 v206, s5, v44
    s_add_u32 m0, s47, 33792
    v_mfma_f32_32x32x16_bf16 v[132:147], v[100:103], v[112:115], v[132:147]
    ds_read_b128 v[96:99], v77 offset:4096
    ds_read_b128 v[88:91], v69 offset:4096
    buffer_load_dwordx4 v9, s[56:59], s50 offen  lds
    v_mul_f32 v226, v203, v205
    v_fmac_f32 v226, v204, v206
    v_lshlrev_b32 v205, 16, v52
    v_and_b32 v206, s5, v52
    s_add_u32 m0, s47, 34816
    v_mfma_f32_32x32x16_bf16 v[148:163], v[104:107], v[108:111], v[148:163]
    buffer_load_dwordx4 v10, s[56:59], s50 offen  lds
    v_mul_f32 v227, v203, v205
    v_fmac_f32 v227, v204, v206
    v_lshlrev_b32 v203, 16, v209
    v_and_b32 v204, s5, v209
    v_lshlrev_b32 v205, 16, v45
    v_and_b32 v206, s5, v45
    s_add_u32 m0, s47, 35840
    v_mfma_f32_32x32x16_bf16 v[164:179], v[104:107], v[112:115], v[164:179]
    buffer_load_dwordx4 v11, s[56:59], s50 offen  lds
    v_fmac_f32 v226, v203, v205
    v_fmac_f32 v226, v204, v206
    v_lshlrev_b32 v205, 16, v53
    v_and_b32 v206, s5, v53
    v_fmac_f32 v227, v203, v205
    v_fmac_f32 v227, v204, v206
    v_lshlrev_b32 v203, 16, v210
    s_add_u32 s51, s46, s49
    s_add_u32 m0, s47, 49152
    s_waitcnt lgkmcnt(2)
    v_mfma_f32_32x32x16_bf16 v[116:131], v[84:87], v[92:95], v[116:131]
    ds_read_b128 v[100:103], v70 offset:0
    ds_read_b128 v[108:111], v78 offset:0
    buffer_load_dwordx4 v12, s[60:63], s51 offen  lds
    v_and_b32 v204, s5, v210
    v_lshlrev_b32 v205, 16, v46
    v_and_b32 v206, s5, v46
    v_fmac_f32 v226, v203, v205
    s_add_u32 m0, s47, 50176
    s_waitcnt lgkmcnt(3)
    v_mfma_f32_32x32x16_bf16 v[132:147], v[84:87], v[96:99], v[132:147]
    ds_read_b128 v[112:115], v78 offset:4096
    ds_read_b128 v[104:107], v70 offset:4096
    buffer_load_dwordx4 v13, s[60:63], s51 offen  lds
    v_fmac_f32 v226, v204, v206
    v_lshlrev_b32 v205, 16, v54
    v_and_b32 v206, s5, v54
    v_fmac_f32 v227, v203, v205
    s_add_u32 m0, s47, 51200
    s_waitcnt lgkmcnt(4)
    v_mfma_f32_32x32x16_bf16 v[148:163], v[88:91], v[92:95], v[148:163]
    buffer_load_dwordx4 v14, s[60:63], s51 offen  lds
    v_fmac_f32 v227, v204, v206
    v_lshlrev_b32 v203, 16, v211
    v_and_b32 v204, s5, v211
    v_lshlrev_b32 v205, 16, v47
    v_and_b32 v206, s5, v47
    v_fmac_f32 v226, v203, v205
    s_add_u32 m0, s47, 52224
    v_mfma_f32_32x32x16_bf16 v[164:179], v[88:91], v[96:99], v[164:179]
    buffer_load_dwordx4 v15, s[60:63], s51 offen  lds
    v_fmac_f32 v226, v204, v206
    v_lshlrev_b32 v205, 16, v55
    v_and_b32 v206, s5, v55
    v_fmac_f32 v227, v203, v205
    v_fmac_f32 v227, v204, v206
    v_lshlrev_b32 v203, 16, v212
    v_and_b32 v204, s5, v212
    s_waitcnt lgkmcnt(2)
    v_mfma_f32_32x32x16_bf16 v[116:131], v[100:103], v[108:111], v[116:131]
    ds_read_b128 v[84:87], v71 offset:0
    ds_read_b128 v[92:95], v79 offset:0
    v_lshlrev_b32 v205, 16, v48
    v_and_b32 v206, s5, v48
    v_fmac_f32 v226, v203, v205
    v_fmac_f32 v226, v204, v206
    v_lshlrev_b32 v205, 16, v56
    v_and_b32 v206, s5, v56
    s_waitcnt lgkmcnt(3)
    v_mfma_f32_32x32x16_bf16 v[132:147], v[100:103], v[112:115], v[132:147]
    ds_read_b128 v[96:99], v79 offset:4096
    ds_read_b128 v[88:91], v71 offset:4096
    v_fmac_f32 v227, v203, v205
    v_fmac_f32 v227, v204, v206
    v_lshlrev_b32 v203, 16, v213
    v_and_b32 v204, s5, v213
    v_lshlrev_b32 v205, 16, v49
    v_and_b32 v206, s5, v49
    s_waitcnt lgkmcnt(4)
    v_mfma_f32_32x32x16_bf16 v[148:163], v[104:107], v[108:111], v[148:163]
    v_fmac_f32 v226, v203, v205
    v_fmac_f32 v226, v204, v206
    v_lshlrev_b32 v205, 16, v57
    v_and_b32 v206, s5, v57
    v_fmac_f32 v227, v203, v205
    v_fmac_f32 v227, v204, v206
    v_lshlrev_b32 v203, 16, v214
    v_and_b32 v204, s5, v214
    v_mfma_f32_32x32x16_bf16 v[164:179], v[104:107], v[112:115], v[164:179]
    v_lshlrev_b32 v205, 16, v50
    v_and_b32 v206, s5, v50
    v_fmac_f32 v226, v203, v205
    v_fmac_f32 v226, v204, v206
    v_lshlrev_b32 v205, 16, v58
    v_and_b32 v206, s5, v58
    v_fmac_f32 v227, v203, v205
    v_fmac_f32 v227, v204, v206
    s_waitcnt lgkmcnt(2)
    v_mfma_f32_32x32x16_bf16 v[116:131], v[84:87], v[92:95], v[116:131]
    ds_read_b128 v[100:103], v72 offset:0
    ds_read_b128 v[108:111], v80 offset:0
    v_lshlrev_b32 v203, 16, v215
    v_and_b32 v204, s5, v215
    v_lshlrev_b32 v205, 16, v51
    v_and_b32 v206, s5, v51
    v_fmac_f32 v226, v203, v205
    v_fmac_f32 v226, v204, v206
    s_waitcnt lgkmcnt(3)
    v_mfma_f32_32x32x16_bf16 v[132:147], v[84:87], v[96:99], v[132:147]
    ds_read_b128 v[112:115], v80 offset:4096
    ds_read_b128 v[104:107], v72 offset:4096
    v_lshlrev_b32 v205, 16, v59
    v_and_b32 v206, s5, v59
    v_fmac_f32 v227, v203, v205
    v_fmac_f32 v227, v204, v206
    v_add_f32_dpp v226, v226, v226 row_shr:1 row_mask:0xf bank_mask:0xf bound_ctrl:0
    s_nop 0
    v_add_f32_dpp v227, v227, v227 row_shr:1 row_mask:0xf bank_mask:0xf bound_ctrl:0
    s_waitcnt lgkmcnt(4)
    v_mfma_f32_32x32x16_bf16 v[148:163], v[88:91], v[92:95], v[148:163]
    v_add_f32_dpp v226, v226, v226 row_shr:2 row_mask:0xf bank_mask:0xf bound_ctrl:0
    v_add_f32_dpp v227, v227, v227 row_shr:2 row_mask:0xf bank_mask:0xf bound_ctrl:0
    s_nop 0
    v_add_f32_dpp v226, v226, v226 row_shr:4 row_mask:0xf bank_mask:0xf bound_ctrl:0
    v_add_f32_dpp v227, v227, v227 row_shr:4 row_mask:0xf bank_mask:0xf bound_ctrl:0
    s_nop 0
    v_add_f32_dpp v226, v226, v226 row_shr:8 row_mask:0xf bank_mask:0xf bound_ctrl:0
    v_add_f32_dpp v227, v227, v227 row_shr:8 row_mask:0xf bank_mask:0xf bound_ctrl:0
    s_nop 0
    v_add_f32_dpp v226, v226, v226 row_bcast:15 row_mask:0xa bank_mask:0xf
    v_add_f32_dpp v227, v227, v227 row_bcast:15 row_mask:0xa bank_mask:0xf
    v_mfma_f32_32x32x16_bf16 v[164:179], v[88:91], v[96:99], v[164:179]
    v_add_f32_dpp v226, v226, v226 row_bcast:31 row_mask:0xc bank_mask:0xf
    v_add_f32_dpp v227, v227, v227 row_bcast:31 row_mask:0xc bank_mask:0xf
    v_cvt_pk_bf16_f32 v203, v226, v227
    v_lshlrev_b32 v226, 16, v203
    v_and_b32 v227, s5, v203
    v_mul_f32 v226, 0xbfb8aa3b, v226
    v_mul_f32 v227, 0xbfb8aa3b, v227
    v_exp_f32 v226, v226
    s_waitcnt lgkmcnt(0)
    s_waitcnt vmcnt(16)
    s_barrier
    s_add_u32 s49, s49, 128
    s_and_b32 s49, s49, 0x7ff
    s_add_u32 s50, s45, s49
    s_add_u32 m0, s47, 65536
    v_mfma_f32_32x32x16_bf16 v[116:131], v[100:103], v[108:111], v[116:131]
    ds_read_b128 v[84:87], v69 offset:32768
    ds_read_b128 v[92:95], v77 offset:32768
    buffer_load_dwordx4 v8, s[56:59], s50 offen  lds
    v_exp_f32 v227, v227
    v_add_f32 v226, 1.0, v226
    v_add_f32 v227, 1.0, v227
    v_rcp_f32 v226, v226
    s_add_u32 m0, s47, 66560
    v_mfma_f32_32x32x16_bf16 v[132:147], v[100:103], v[112:115], v[132:147]
    ds_read_b128 v[96:99], v77 offset:36864
    ds_read_b128 v[88:91], v69 offset:36864
    buffer_load_dwordx4 v9, s[56:59], s50 offen  lds
    v_rcp_f32 v227, v227
    s_nop 0
    v_cvt_pk_bf16_f32 v203, v226, v227
    v_lshlrev_b32 v226, 16, v203
    v_and_b32 v227, s5, v203
    s_add_u32 m0, s47, 67584
    v_mfma_f32_32x32x16_bf16 v[148:163], v[104:107], v[108:111], v[148:163]
    buffer_load_dwordx4 v10, s[56:59], s50 offen  lds
    v_sub_f32 v228, 1.0, v226
    v_sub_f32 v229, 1.0, v227
    v_cvt_pk_bf16_f32 v203, v228, v229
    v_lshlrev_b32 v228, 16, v203
    v_and_b32 v229, s5, v203
    s_add_u32 m0, s47, 68608
    v_mfma_f32_32x32x16_bf16 v[164:179], v[104:107], v[112:115], v[164:179]
    buffer_load_dwordx4 v11, s[56:59], s50 offen  lds
    s_add_u32 s51, s46, s49
    s_add_u32 m0, s47, 81920
    s_waitcnt lgkmcnt(2)
    v_mfma_f32_32x32x16_bf16 v[116:131], v[84:87], v[92:95], v[116:131]
    ds_read_b128 v[100:103], v70 offset:32768
    ds_read_b128 v[108:111], v78 offset:32768
    buffer_load_dwordx4 v12, s[60:63], s51 offen  lds
    s_add_u32 m0, s47, 82944
    s_waitcnt lgkmcnt(3)
    v_mfma_f32_32x32x16_bf16 v[132:147], v[84:87], v[96:99], v[132:147]
    ds_read_b128 v[112:115], v78 offset:36864
    ds_read_b128 v[104:107], v70 offset:36864
    buffer_load_dwordx4 v13, s[60:63], s51 offen  lds
    s_add_u32 m0, s47, 83968
    s_waitcnt lgkmcnt(4)
    v_mfma_f32_32x32x16_bf16 v[148:163], v[88:91], v[92:95], v[148:163]
    buffer_load_dwordx4 v14, s[60:63], s51 offen  lds
    s_add_u32 m0, s47, 84992
    v_mfma_f32_32x32x16_bf16 v[164:179], v[88:91], v[96:99], v[164:179]
    buffer_load_dwordx4 v15, s[60:63], s51 offen  lds
    s_mov_b32 m0, s4
    s_waitcnt lgkmcnt(2)
    v_mfma_f32_32x32x16_bf16 v[116:131], v[100:103], v[108:111], v[116:131]
    ds_read_b128 v[84:87], v71 offset:32768
    ds_read_b128 v[92:95], v79 offset:32768
    buffer_load_dwordx4 v60, s[64:67], s52 offen lds
    s_waitcnt lgkmcnt(3)
    v_mfma_f32_32x32x16_bf16 v[132:147], v[100:103], v[112:115], v[132:147]
    ds_read_b128 v[96:99], v79 offset:36864
    ds_read_b128 v[88:91], v71 offset:36864
    buffer_load_dwordx4 v[16:19], v16, s[68:71], 0 offen
    s_waitcnt lgkmcnt(4)
    v_mfma_f32_32x32x16_bf16 v[148:163], v[104:107], v[108:111], v[148:163]
    buffer_load_dwordx4 v[20:23], v20, s[68:71], 0 offen
    v_mfma_f32_32x32x16_bf16 v[164:179], v[104:107], v[112:115], v[164:179]
    buffer_load_dwordx4 v[24:27], v24, s[68:71], 0 offen
    s_waitcnt lgkmcnt(2)
    v_mfma_f32_32x32x16_bf16 v[116:131], v[84:87], v[92:95], v[116:131]
    ds_read_b128 v[100:103], v72 offset:32768
    ds_read_b128 v[108:111], v80 offset:32768
    buffer_load_dwordx4 v[28:31], v3, s[68:71], 0 offen offset:0
    s_waitcnt lgkmcnt(3)
    v_mfma_f32_32x32x16_bf16 v[132:147], v[84:87], v[96:99], v[132:147]
    ds_read_b128 v[112:115], v80 offset:36864
    ds_read_b128 v[104:107], v72 offset:36864
    buffer_load_dwordx4 v[32:35], v3, s[68:71], 0 offen offset:2048
    s_waitcnt lgkmcnt(4)
    v_mfma_f32_32x32x16_bf16 v[148:163], v[88:91], v[92:95], v[148:163]
    buffer_load_dwordx4 v[36:39], v3, s[68:71], s48 offen offset:0
    v_mfma_f32_32x32x16_bf16 v[164:179], v[88:91], v[96:99], v[164:179]
    buffer_load_dwordx4 v[40:43], v3, s[68:71], s48 offen offset:2048
    s_waitcnt lgkmcnt(0)
    s_waitcnt vmcnt(24)
    s_barrier
    v_mfma_f32_32x32x16_bf16 v[116:131], v[100:103], v[108:111], v[116:131]
    ds_read_b128 v[84:87], v65 offset:0
    ds_read_b128 v[92:95], v73 offset:0
    buffer_load_dwordx4 v[44:47], v3, s[72:75], 0 offen offset:0
    v_mfma_f32_32x32x16_bf16 v[132:147], v[100:103], v[112:115], v[132:147]
    ds_read_b128 v[96:99], v73 offset:4096
    ds_read_b128 v[88:91], v65 offset:4096
    buffer_load_dwordx4 v[48:51], v3, s[72:75], 0 offen offset:2048
    v_mfma_f32_32x32x16_bf16 v[148:163], v[104:107], v[108:111], v[148:163]
    buffer_load_dwordx4 v[52:55], v3, s[72:75], s48 offen offset:0
    v_mfma_f32_32x32x16_bf16 v[164:179], v[104:107], v[112:115], v[164:179]
    buffer_load_dwordx4 v[56:59], v3, s[72:75], s48 offen offset:2048
    s_add_u32 m0, s16, 0
    s_waitcnt lgkmcnt(2)
    v_mfma_f32_32x32x16_bf16 v[116:131], v[84:87], v[92:95], v[116:131]
    ds_read_b128 v[100:103], v66 offset:0
    ds_read_b128 v[108:111], v74 offset:0
    buffer_load_dwordx4 v207, s[80:83], s14 offen  lds
    s_add_u32 m0, s16, 1024
    s_waitcnt lgkmcnt(3)
    v_mfma_f32_32x32x16_bf16 v[132:147], v[84:87], v[96:99], v[132:147]
    ds_read_b128 v[112:115], v74 offset:4096
    ds_read_b128 v[104:107], v66 offset:4096
    buffer_load_dwordx4 v207, s[80:83], s15 offen  lds
    s_add_u32 m0, s16, 2048
    s_waitcnt lgkmcnt(4)
    v_mfma_f32_32x32x16_bf16 v[148:163], v[88:91], v[92:95], v[148:163]
    buffer_load_dwordx4 v207, s[84:87], s14 offen  lds
    s_add_u32 m0, s16, 3072
    v_mfma_f32_32x32x16_bf16 v[164:179], v[88:91], v[96:99], v[164:179]
    buffer_load_dwordx4 v207, s[84:87], s15 offen  lds
    s_add_u32 s49, s49, 128
    s_and_b32 s49, s49, 0x7ff
    s_add_u32 s50, s45, s49
    s_add_u32 m0, s47, 98304
    s_waitcnt lgkmcnt(2)
    v_mfma_f32_32x32x16_bf16 v[116:131], v[100:103], v[108:111], v[116:131]
    ds_read_b128 v[84:87], v67 offset:0
    ds_read_b128 v[92:95], v75 offset:0
    buffer_load_dwordx4 v8, s[56:59], s50 offen  lds
    s_add_u32 m0, s47, 99328
    s_waitcnt lgkmcnt(3)
    v_mfma_f32_32x32x16_bf16 v[132:147], v[100:103], v[112:115], v[132:147]
    ds_read_b128 v[96:99], v75 offset:4096
    ds_read_b128 v[88:91], v67 offset:4096
    buffer_load_dwordx4 v9, s[56:59], s50 offen  lds
    s_add_u32 m0, s47, 100352
    s_waitcnt lgkmcnt(4)
    v_mfma_f32_32x32x16_bf16 v[148:163], v[104:107], v[108:111], v[148:163]
    buffer_load_dwordx4 v10, s[56:59], s50 offen  lds
    s_add_u32 m0, s47, 101376
    v_mfma_f32_32x32x16_bf16 v[164:179], v[104:107], v[112:115], v[164:179]
    buffer_load_dwordx4 v11, s[56:59], s50 offen  lds
    s_add_u32 s51, s46, s49
    s_add_u32 m0, s47, 114688
    s_waitcnt lgkmcnt(2)
    v_mfma_f32_32x32x16_bf16 v[116:131], v[84:87], v[92:95], v[116:131]
    ds_read_b128 v[100:103], v68 offset:0
    ds_read_b128 v[108:111], v76 offset:0
    buffer_load_dwordx4 v12, s[60:63], s51 offen  lds
    s_add_u32 m0, s47, 115712
    s_waitcnt lgkmcnt(3)
    v_mfma_f32_32x32x16_bf16 v[132:147], v[84:87], v[96:99], v[132:147]
    ds_read_b128 v[112:115], v76 offset:4096
    ds_read_b128 v[104:107], v68 offset:4096
    buffer_load_dwordx4 v13, s[60:63], s51 offen  lds
    s_add_u32 m0, s47, 116736
    s_waitcnt lgkmcnt(4)
    v_mfma_f32_32x32x16_bf16 v[148:163], v[88:91], v[92:95], v[148:163]
    buffer_load_dwordx4 v14, s[60:63], s51 offen  lds
    s_add_u32 m0, s47, 117760
    v_mfma_f32_32x32x16_bf16 v[164:179], v[88:91], v[96:99], v[164:179]
    buffer_load_dwordx4 v15, s[60:63], s51 offen  lds
    s_waitcnt lgkmcnt(0)
    s_waitcnt vmcnt(32)
    s_barrier
    s_add_u32 s49, s49, 128
    s_and_b32 s49, s49, 0x7ff
    s_add_u32 s50, s45, s49
    s_add_u32 m0, s47, 0
    v_mfma_f32_32x32x16_bf16 v[116:131], v[100:103], v[108:111], v[116:131]
    ds_read_b128 v[84:87], v65 offset:32768
    ds_read_b128 v[92:95], v73 offset:32768
    buffer_load_dwordx4 v8, s[56:59], s50 offen  lds
    s_add_u32 m0, s47, 1024
    v_mfma_f32_32x32x16_bf16 v[132:147], v[100:103], v[112:115], v[132:147]
    ds_read_b128 v[96:99], v73 offset:36864
    ds_read_b128 v[88:91], v65 offset:36864
    buffer_load_dwordx4 v9, s[56:59], s50 offen  lds
    s_add_u32 m0, s47, 2048
    v_mfma_f32_32x32x16_bf16 v[148:163], v[104:107], v[108:111], v[148:163]
    buffer_load_dwordx4 v10, s[56:59], s50 offen  lds
    s_add_u32 m0, s47, 3072
    v_mfma_f32_32x32x16_bf16 v[164:179], v[104:107], v[112:115], v[164:179]
    buffer_load_dwordx4 v11, s[56:59], s50 offen  lds
    s_waitcnt lgkmcnt(2)
    v_mfma_f32_32x32x16_bf16 v[116:131], v[84:87], v[92:95], v[116:131]
    ds_read_b128 v[100:103], v66 offset:32768
    ds_read_b128 v[108:111], v74 offset:32768
    s_mov_b32 s7, 0x05040100
    s_mov_b32 s12, 0x07060302
    s_waitcnt vmcnt(27)
    s_waitcnt lgkmcnt(3)
    v_mfma_f32_32x32x16_bf16 v[132:147], v[84:87], v[96:99], v[132:147]
    ds_read_b128 v[112:115], v74 offset:36864
    ds_read_b128 v[104:107], v66 offset:36864
    ds_read_b128 v[184:187], v83 offset:0
    s_add_u32 s51, s46, s49
    s_add_u32 m0, s47, 16384
    s_waitcnt lgkmcnt(5)
    v_mfma_f32_32x32x16_bf16 v[148:163], v[88:91], v[92:95], v[148:163]
    buffer_load_dwordx4 v12, s[60:63], s51 offen  lds
    ds_read_b128 v[188:191], v83 offset:16
    s_waitcnt vmcnt(26)
    v_perm_b32 v196, v16, v20, s7
    s_waitcnt vmcnt(25)
    v_perm_b32 v197, v20, v24, s7
    s_add_u32 m0, s47, 17408
    v_mfma_f32_32x32x16_bf16 v[164:179], v[88:91], v[96:99], v[164:179]
    buffer_load_dwordx4 v13, s[60:63], s51 offen  lds
    s_waitcnt vmcnt(25)
    v_perm_b32 v198, v24, v28, s7
    s_waitcnt vmcnt(24)
    v_perm_b32 v199, v28, v32, s7
    s_waitcnt vmcnt(23)
    v_perm_b32 v200, v32, v36, s7
    s_waitcnt vmcnt(22)
    v_perm_b32 v201, v36, v40, s7
    s_waitcnt lgkmcnt(4)
    v_mfma_f32_32x32x16_bf16 v[116:131], v[100:103], v[108:111], v[116:131]
    ds_read_b128 v[84:87], v67 offset:32768
    ds_read_b128 v[92:95], v75 offset:32768
    s_waitcnt vmcnt(21)
    v_lshlrev_b32 v192, 16, v44
    s_waitcnt vmcnt(20)
    v_lshlrev_b32 v193, 16, v48
    s_waitcnt vmcnt(19)
    v_lshlrev_b32 v194, 16, v52
    s_waitcnt lgkmcnt(5)
    v_mfma_f32_32x32x16_bf16 v[132:147], v[100:103], v[112:115], v[132:147]
    ds_read_b128 v[96:99], v75 offset:36864
    ds_read_b128 v[88:91], v67 offset:36864
    s_waitcnt vmcnt(18)
    v_lshlrev_b32 v195, 16, v56
    s_waitcnt lgkmcnt(5)
    v_dot2_f32_bf16 v203, v196, v185, 0
    s_add_u32 m0, s47, 18432
    v_mfma_f32_32x32x16_bf16 v[148:163], v[104:107], v[108:111], v[148:163]
    buffer_load_dwordx4 v14, s[60:63], s51 offen  lds
    v_dot2_f32_bf16 v204, v197, v185, 0
    v_dot2_f32_bf16 v205, v198, v185, 0
    v_dot2_f32_bf16 v206, v199, v185, 0
    s_add_u32 m0, s47, 19456
    v_mfma_f32_32x32x16_bf16 v[164:179], v[104:107], v[112:115], v[164:179]
    buffer_load_dwordx4 v15, s[60:63], s51 offen  lds
    v_dot2c_f32_bf16 v203, v198, v184
    v_dot2c_f32_bf16 v204, v199, v184
    v_dot2c_f32_bf16 v205, v200, v184
    v_dot2c_f32_bf16 v206, v201, v184
    s_waitcnt lgkmcnt(2)
    v_mfma_f32_32x32x16_bf16 v[116:131], v[84:87], v[92:95], v[116:131]
    ds_read_b128 v[100:103], v68 offset:32768
    ds_read_b128 v[108:111], v76 offset:32768
    v_mul_f32 v203, v203, v192
    v_mul_f32 v204, v204, v193
    v_mul_f32 v205, v205, v194
    s_waitcnt lgkmcnt(3)
    v_mfma_f32_32x32x16_bf16 v[132:147], v[84:87], v[96:99], v[132:147]
    ds_read_b128 v[112:115], v76 offset:36864
    ds_read_b128 v[104:107], v68 offset:36864
    v_mul_f32 v206, v206, v195
    v_cvt_pk_bf16_f32 v210, v206, v205
    v_cvt_pk_bf16_f32 v211, v204, v203
    s_waitcnt lgkmcnt(4)
    v_mfma_f32_32x32x16_bf16 v[148:163], v[88:91], v[92:95], v[148:163]
    v_perm_b32 v196, v16, v20, s12
    v_perm_b32 v197, v20, v24, s12
    v_perm_b32 v198, v24, v28, s12
    v_perm_b32 v199, v28, v32, s12
    v_perm_b32 v200, v32, v36, s12
    v_mfma_f32_32x32x16_bf16 v[164:179], v[88:91], v[96:99], v[164:179]
    v_perm_b32 v201, v36, v40, s12
    v_and_b32 v192, s5, v44
    v_and_b32 v193, s5, v48
    v_and_b32 v194, s5, v52
    v_and_b32 v195, s5, v56
    s_waitcnt lgkmcnt(0)
    s_barrier
    v_mfma_f32_32x32x16_bf16 v[116:131], v[100:103], v[108:111], v[116:131]
    ds_read_b128 v[84:87], v69 offset:0
    ds_read_b128 v[92:95], v77 offset:0
    v_dot2_f32_bf16 v203, v196, v187, 0
    v_dot2_f32_bf16 v204, v197, v187, 0
    v_dot2_f32_bf16 v205, v198, v187, 0
    v_mfma_f32_32x32x16_bf16 v[132:147], v[100:103], v[112:115], v[132:147]
    ds_read_b128 v[96:99], v77 offset:4096
    ds_read_b128 v[88:91], v69 offset:4096
    s_add_u32 s49, s49, 128
    s_and_b32 s49, s49, 0x7ff
    s_add_u32 s50, s45, s49
    s_add_u32 m0, s47, 32768
    v_mfma_f32_32x32x16_bf16 v[148:163], v[104:107], v[108:111], v[148:163]
    buffer_load_dwordx4 v8, s[56:59], s50 offen  lds
    v_dot2_f32_bf16 v206, v199, v187, 0
    v_dot2c_f32_bf16 v203, v198, v186
    v_dot2c_f32_bf16 v204, v199, v186
    s_add_u32 m0, s47, 33792
    v_mfma_f32_32x32x16_bf16 v[164:179], v[104:107], v[112:115], v[164:179]
    buffer_load_dwordx4 v9, s[56:59], s50 offen  lds
    v_dot2c_f32_bf16 v205, v200, v186
    v_dot2c_f32_bf16 v206, v201, v186
    v_mul_f32 v203, v203, v192
    v_mul_f32 v204, v204, v193
    s_waitcnt lgkmcnt(2)
    v_mfma_f32_32x32x16_bf16 v[116:131], v[84:87], v[92:95], v[116:131]
    ds_read_b128 v[100:103], v70 offset:0
    ds_read_b128 v[108:111], v78 offset:0
    v_mul_f32 v205, v205, v194
    v_mul_f32 v206, v206, v195
    v_cvt_pk_bf16_f32 v208, v206, v205
    s_waitcnt lgkmcnt(3)
    v_mfma_f32_32x32x16_bf16 v[132:147], v[84:87], v[96:99], v[132:147]
    ds_read_b128 v[112:115], v78 offset:4096
    ds_read_b128 v[104:107], v70 offset:4096
    v_cvt_pk_bf16_f32 v209, v204, v203
    ds_read_b128 v[184:187], v83 offset:32
    s_add_u32 m0, s47, 34816
    s_waitcnt lgkmcnt(5)
    v_mfma_f32_32x32x16_bf16 v[148:163], v[88:91], v[92:95], v[148:163]
    buffer_load_dwordx4 v10, s[56:59], s50 offen  lds
    v_perm_b32 v196, v17, v21, s7
    v_perm_b32 v197, v21, v25, s7
    v_permlane32_swap_b32 v210, v208
    s_add_u32 m0, s47, 35840
    v_mfma_f32_32x32x16_bf16 v[164:179], v[88:91], v[96:99], v[164:179]
    buffer_load_dwordx4 v11, s[56:59], s50 offen  lds
    v_permlane32_swap_b32 v211, v209
    v_perm_b32 v198, v25, v29, s7
    v_perm_b32 v199, v29, v33, s7
    v_perm_b32 v200, v33, v37, s7
    s_waitcnt lgkmcnt(3)
    v_mfma_f32_32x32x16_bf16 v[116:131], v[100:103], v[108:111], v[116:131]
    ds_read_b128 v[84:87], v71 offset:0
    ds_read_b128 v[92:95], v79 offset:0
    v_perm_b32 v201, v37, v41, s7
    v_lshlrev_b32 v192, 16, v45
    v_lshlrev_b32 v193, 16, v49
    s_waitcnt lgkmcnt(4)
    v_mfma_f32_32x32x16_bf16 v[132:147], v[100:103], v[112:115], v[132:147]
    ds_read_b128 v[96:99], v79 offset:4096
    ds_read_b128 v[88:91], v71 offset:4096
    v_lshlrev_b32 v194, 16, v53
    s_add_u32 s51, s46, s49
    s_add_u32 m0, s47, 49152
    s_waitcnt lgkmcnt(5)
    v_mfma_f32_32x32x16_bf16 v[148:163], v[104:107], v[108:111], v[148:163]
    buffer_load_dwordx4 v12, s[60:63], s51 offen  lds
    v_lshlrev_b32 v195, 16, v57
    v_dot2_f32_bf16 v203, v196, v189, 0
    v_dot2_f32_bf16 v204, v197, v189, 0
    s_add_u32 m0, s47, 50176
    v_mfma_f32_32x32x16_bf16 v[164:179], v[104:107], v[112:115], v[164:179]
    buffer_load_dwordx4 v13, s[60:63], s51 offen  lds
    v_dot2_f32_bf16 v205, v198, v189, 0
    v_dot2_f32_bf16 v206, v199, v189, 0
    v_dot2c_f32_bf16 v203, v198, v188
    v_dot2c_f32_bf16 v204, v199, v188
    s_waitcnt lgkmcnt(2)
    v_mfma_f32_32x32x16_bf16 v[116:131], v[84:87], v[92:95], v[116:131]
    ds_read_b128 v[100:103], v72 offset:0
    ds_read_b128 v[108:111], v80 offset:0
    v_dot2c_f32_bf16 v205, v200, v188
    v_dot2c_f32_bf16 v206, v201, v188
    v_mul_f32 v203, v203, v192
    s_waitcnt lgkmcnt(3)
    v_mfma_f32_32x32x16_bf16 v[132:147], v[84:87], v[96:99], v[132:147]
    ds_read_b128 v[112:115], v80 offset:4096
    ds_read_b128 v[104:107], v72 offset:4096
    v_mul_f32 v204, v204, v193
    v_mul_f32 v205, v205, v194
    s_add_u32 m0, s47, 51200
    s_waitcnt lgkmcnt(4)
    v_mfma_f32_32x32x16_bf16 v[148:163], v[88:91], v[92:95], v[148:163]
    buffer_load_dwordx4 v14, s[60:63], s51 offen  lds
    v_mul_f32 v206, v206, v195
    v_cvt_pk_bf16_f32 v214, v206, v205
    v_cvt_pk_bf16_f32 v215, v204, v203
    s_add_u32 m0, s47, 52224
    v_mfma_f32_32x32x16_bf16 v[164:179], v[88:91], v[96:99], v[164:179]
    buffer_load_dwordx4 v15, s[60:63], s51 offen  lds
    v_perm_b32 v196, v17, v21, s12
    v_perm_b32 v197, v21, v25, s12
    v_perm_b32 v198, v25, v29, s12
    v_perm_b32 v199, v29, v33, s12
    s_waitcnt lgkmcnt(0)
    s_waitcnt vmcnt(16)
    s_barrier
    v_mfma_f32_32x32x16_bf16 v[116:131], v[100:103], v[108:111], v[116:131]
    ds_read_b128 v[84:87], v69 offset:32768
    ds_read_b128 v[92:95], v77 offset:32768
    v_perm_b32 v200, v33, v37, s12
    v_perm_b32 v201, v37, v41, s12
    v_and_b32 v192, s5, v45
    v_mfma_f32_32x32x16_bf16 v[132:147], v[100:103], v[112:115], v[132:147]
    ds_read_b128 v[96:99], v77 offset:36864
    ds_read_b128 v[88:91], v69 offset:36864
    s_add_u32 s49, s49, 128
    s_and_b32 s49, s49, 0x7ff
    s_add_u32 s50, s45, s49
    s_add_u32 m0, s47, 65536
    v_mfma_f32_32x32x16_bf16 v[148:163], v[104:107], v[108:111], v[148:163]
    buffer_load_dwordx4 v8, s[56:59], s50 offen  lds
    v_and_b32 v193, s5, v49
    v_and_b32 v194, s5, v53
    v_and_b32 v195, s5, v57
    s_add_u32 m0, s47, 66560
    v_mfma_f32_32x32x16_bf16 v[164:179], v[104:107], v[112:115], v[164:179]
    buffer_load_dwordx4 v9, s[56:59], s50 offen  lds
    v_dot2_f32_bf16 v203, v196, v191, 0
    v_dot2_f32_bf16 v204, v197, v191, 0
    v_dot2_f32_bf16 v205, v198, v191, 0
    v_dot2_f32_bf16 v206, v199, v191, 0
    s_waitcnt lgkmcnt(2)
    v_mfma_f32_32x32x16_bf16 v[116:131], v[84:87], v[92:95], v[116:131]
    ds_read_b128 v[100:103], v70 offset:32768
    ds_read_b128 v[108:111], v78 offset:32768
    v_dot2c_f32_bf16 v203, v198, v190
    v_dot2c_f32_bf16 v204, v199, v190
    v_dot2c_f32_bf16 v205, v200, v190
    s_waitcnt lgkmcnt(3)
    v_mfma_f32_32x32x16_bf16 v[132:147], v[84:87], v[96:99], v[132:147]
    ds_read_b128 v[112:115], v78 offset:36864
    ds_read_b128 v[104:107], v70 offset:36864
    v_dot2c_f32_bf16 v206, v201, v190
    v_mul_f32 v203, v203, v192
    s_add_u32 m0, s47, 67584
    s_waitcnt lgkmcnt(4)
    v_mfma_f32_32x32x16_bf16 v[148:163], v[88:91], v[92:95], v[148:163]
    buffer_load_dwordx4 v10, s[56:59], s50 offen  lds
    v_mul_f32 v204, v204, v193
    v_mul_f32 v205, v205, v194
    v_mul_f32 v206, v206, v195
    s_add_u32 m0, s47, 68608
    v_mfma_f32_32x32x16_bf16 v[164:179], v[88:91], v[96:99], v[164:179]
    buffer_load_dwordx4 v11, s[56:59], s50 offen  lds
    v_cvt_pk_bf16_f32 v212, v206, v205
    v_cvt_pk_bf16_f32 v213, v204, v203
    ds_read_b128 v[188:191], v83 offset:48
    v_perm_b32 v196, v18, v22, s7
    s_waitcnt lgkmcnt(3)
    v_mfma_f32_32x32x16_bf16 v[116:131], v[100:103], v[108:111], v[116:131]
    ds_read_b128 v[84:87], v71 offset:32768
    ds_read_b128 v[92:95], v79 offset:32768
    v_perm_b32 v197, v22, v26, s7
    v_permlane32_swap_b32 v214, v212
    v_permlane32_swap_b32 v215, v213
    s_waitcnt lgkmcnt(4)
    v_mfma_f32_32x32x16_bf16 v[132:147], v[100:103], v[112:115], v[132:147]
    ds_read_b128 v[96:99], v79 offset:36864
    ds_read_b128 v[88:91], v71 offset:36864
    v_perm_b32 v198, v26, v30, s7
    s_add_u32 s51, s46, s49
    s_add_u32 m0, s47, 81920
    s_waitcnt lgkmcnt(5)
    v_mfma_f32_32x32x16_bf16 v[148:163], v[104:107], v[108:111], v[148:163]
    buffer_load_dwordx4 v12, s[60:63], s51 offen  lds
    v_perm_b32 v199, v30, v34, s7
    v_perm_b32 v200, v34, v38, s7
    v_perm_b32 v201, v38, v42, s7
    s_add_u32 m0, s47, 82944
    v_mfma_f32_32x32x16_bf16 v[164:179], v[104:107], v[112:115], v[164:179]
    buffer_load_dwordx4 v13, s[60:63], s51 offen  lds
    v_lshlrev_b32 v192, 16, v46
    v_lshlrev_b32 v193, 16, v50
    v_lshlrev_b32 v194, 16, v54
    v_lshlrev_b32 v195, 16, v58
    s_waitcnt lgkmcnt(2)
    v_mfma_f32_32x32x16_bf16 v[116:131], v[84:87], v[92:95], v[116:131]
    ds_read_b128 v[100:103], v72 offset:32768
    ds_read_b128 v[108:111], v80 offset:32768
    v_dot2_f32_bf16 v203, v196, v185, 0
    v_dot2_f32_bf16 v204, v197, v185, 0
    v_dot2_f32_bf16 v205, v198, v185, 0
    s_waitcnt lgkmcnt(3)
    v_mfma_f32_32x32x16_bf16 v[132:147], v[84:87], v[96:99], v[132:147]
    ds_read_b128 v[112:115], v80 offset:36864
    ds_read_b128 v[104:107], v72 offset:36864
    v_dot2_f32_bf16 v206, v199, v185, 0
    v_dot2c_f32_bf16 v203, v198, v184
    s_add_u32 m0, s47, 83968
    s_waitcnt lgkmcnt(4)
    v_mfma_f32_32x32x16_bf16 v[148:163], v[88:91], v[92:95], v[148:163]
    buffer_load_dwordx4 v14, s[60:63], s51 offen  lds
    v_dot2c_f32_bf16 v204, v199, v184
    v_dot2c_f32_bf16 v205, v200, v184
    v_dot2c_f32_bf16 v206, v201, v184
    s_add_u32 m0, s47, 84992
    v_mfma_f32_32x32x16_bf16 v[164:179], v[88:91], v[96:99], v[164:179]
    buffer_load_dwordx4 v15, s[60:63], s51 offen  lds
    v_mul_f32 v203, v203, v192
    v_mul_f32 v204, v204, v193
    v_mul_f32 v205, v205, v194
    v_mul_f32 v206, v206, v195
    s_waitcnt lgkmcnt(0)
    s_waitcnt vmcnt(16)
    s_barrier
    v_mfma_f32_32x32x16_bf16 v[116:131], v[100:103], v[108:111], v[116:131]
    ds_read_b128 v[84:87], v65 offset:0
    ds_read_b128 v[92:95], v73 offset:0
    v_cvt_pk_bf16_f32 v218, v206, v205
    v_cvt_pk_bf16_f32 v219, v204, v203
    v_perm_b32 v196, v18, v22, s12
    v_mfma_f32_32x32x16_bf16 v[132:147], v[100:103], v[112:115], v[132:147]
    ds_read_b128 v[96:99], v73 offset:4096
    ds_read_b128 v[88:91], v65 offset:4096
    s_add_u32 s49, s49, 128
    s_and_b32 s49, s49, 0x7ff
    s_add_u32 s50, s45, s49
    s_add_u32 m0, s47, 98304
    v_mfma_f32_32x32x16_bf16 v[148:163], v[104:107], v[108:111], v[148:163]
    buffer_load_dwordx4 v8, s[56:59], s50 offen  lds
    v_perm_b32 v197, v22, v26, s12
    v_perm_b32 v198, v26, v30, s12
    v_perm_b32 v199, v30, v34, s12
    s_add_u32 m0, s47, 99328
    v_mfma_f32_32x32x16_bf16 v[164:179], v[104:107], v[112:115], v[164:179]
    buffer_load_dwordx4 v9, s[56:59], s50 offen  lds
    v_perm_b32 v200, v34, v38, s12
    v_perm_b32 v201, v38, v42, s12
    v_and_b32 v192, s5, v46
    v_and_b32 v193, s5, v50
    s_waitcnt lgkmcnt(2)
    v_mfma_f32_32x32x16_bf16 v[116:131], v[84:87], v[92:95], v[116:131]
    ds_read_b128 v[100:103], v66 offset:0
    ds_read_b128 v[108:111], v74 offset:0
    v_and_b32 v194, s5, v54
    v_and_b32 v195, s5, v58
    v_dot2_f32_bf16 v203, v196, v187, 0
    s_waitcnt lgkmcnt(3)
    v_mfma_f32_32x32x16_bf16 v[132:147], v[84:87], v[96:99], v[132:147]
    ds_read_b128 v[112:115], v74 offset:4096
    ds_read_b128 v[104:107], v66 offset:4096
    v_dot2_f32_bf16 v204, v197, v187, 0
    v_dot2_f32_bf16 v205, v198, v187, 0
    s_add_u32 m0, s47, 100352
    s_waitcnt lgkmcnt(4)
    v_mfma_f32_32x32x16_bf16 v[148:163], v[88:91], v[92:95], v[148:163]
    buffer_load_dwordx4 v10, s[56:59], s50 offen  lds
    v_dot2_f32_bf16 v206, v199, v187, 0
    v_dot2c_f32_bf16 v203, v198, v186
    v_dot2c_f32_bf16 v204, v199, v186
    s_add_u32 m0, s47, 101376
    v_mfma_f32_32x32x16_bf16 v[164:179], v[88:91], v[96:99], v[164:179]
    buffer_load_dwordx4 v11, s[56:59], s50 offen  lds
    v_dot2c_f32_bf16 v205, v200, v186
    v_dot2c_f32_bf16 v206, v201, v186
    v_mul_f32 v203, v203, v192
    v_mul_f32 v204, v204, v193
    s_waitcnt lgkmcnt(2)
    v_mfma_f32_32x32x16_bf16 v[116:131], v[100:103], v[108:111], v[116:131]
    ds_read_b128 v[84:87], v67 offset:0
    ds_read_b128 v[92:95], v75 offset:0
    v_mul_f32 v205, v205, v194
    v_mul_f32 v206, v206, v195
    v_cvt_pk_bf16_f32 v216, v206, v205
    s_waitcnt lgkmcnt(3)
    v_mfma_f32_32x32x16_bf16 v[132:147], v[100:103], v[112:115], v[132:147]
    ds_read_b128 v[96:99], v75 offset:4096
    ds_read_b128 v[88:91], v67 offset:4096
    v_cvt_pk_bf16_f32 v217, v204, v203
    s_add_u32 s51, s46, s49
    s_add_u32 m0, s47, 114688
    s_waitcnt lgkmcnt(4)
    v_mfma_f32_32x32x16_bf16 v[148:163], v[104:107], v[108:111], v[148:163]
    buffer_load_dwordx4 v12, s[60:63], s51 offen  lds
    v_perm_b32 v196, v19, v23, s7
    v_perm_b32 v197, v23, v27, s7
    v_permlane32_swap_b32 v218, v216
    s_add_u32 m0, s47, 115712
    v_mfma_f32_32x32x16_bf16 v[164:179], v[104:107], v[112:115], v[164:179]
    buffer_load_dwordx4 v13, s[60:63], s51 offen  lds
    v_permlane32_swap_b32 v219, v217
    v_perm_b32 v198, v27, v31, s7
    v_perm_b32 v199, v31, v35, s7
    v_perm_b32 v200, v35, v39, s7
    s_waitcnt lgkmcnt(2)
    v_mfma_f32_32x32x16_bf16 v[116:131], v[84:87], v[92:95], v[116:131]
    ds_read_b128 v[100:103], v68 offset:0
    ds_read_b128 v[108:111], v76 offset:0
    v_perm_b32 v201, v39, v43, s7
    v_lshlrev_b32 v192, 16, v47
    v_lshlrev_b32 v193, 16, v51
    s_waitcnt lgkmcnt(3)
    v_mfma_f32_32x32x16_bf16 v[132:147], v[84:87], v[96:99], v[132:147]
    ds_read_b128 v[112:115], v76 offset:4096
    ds_read_b128 v[104:107], v68 offset:4096
    v_lshlrev_b32 v194, 16, v55
    v_lshlrev_b32 v195, 16, v59
    s_add_u32 m0, s47, 116736
    s_waitcnt lgkmcnt(4)
    v_mfma_f32_32x32x16_bf16 v[148:163], v[88:91], v[92:95], v[148:163]
    buffer_load_dwordx4 v14, s[60:63], s51 offen  lds
    v_dot2_f32_bf16 v203, v196, v189, 0
    v_dot2_f32_bf16 v204, v197, v189, 0
    v_dot2_f32_bf16 v205, v198, v189, 0
    s_add_u32 m0, s47, 117760
    v_mfma_f32_32x32x16_bf16 v[164:179], v[88:91], v[96:99], v[164:179]
    buffer_load_dwordx4 v15, s[60:63], s51 offen  lds
    v_dot2_f32_bf16 v206, v199, v189, 0
    v_dot2c_f32_bf16 v203, v198, v188
    v_dot2c_f32_bf16 v204, v199, v188
    v_dot2c_f32_bf16 v205, v200, v188
    s_waitcnt lgkmcnt(0)
    s_waitcnt vmcnt(16)
    s_barrier
    v_mfma_f32_32x32x16_bf16 v[116:131], v[100:103], v[108:111], v[116:131]
    ds_read_b128 v[84:87], v65 offset:32768
    ds_read_b128 v[92:95], v73 offset:32768
    v_dot2c_f32_bf16 v206, v201, v188
    v_mul_f32 v203, v203, v192
    v_mul_f32 v204, v204, v193
    v_mfma_f32_32x32x16_bf16 v[132:147], v[100:103], v[112:115], v[132:147]
    ds_read_b128 v[96:99], v73 offset:36864
    ds_read_b128 v[88:91], v65 offset:36864
    s_add_u32 s49, s49, 128
    s_and_b32 s49, s49, 0x7ff
    s_add_u32 s50, s45, s49
    s_add_u32 m0, s47, 0
    v_mfma_f32_32x32x16_bf16 v[148:163], v[104:107], v[108:111], v[148:163]
    buffer_load_dwordx4 v8, s[56:59], s50 offen  lds
    v_mul_f32 v205, v205, v194
    v_mul_f32 v206, v206, v195
    v_cvt_pk_bf16_f32 v222, v206, v205
    s_add_u32 m0, s47, 1024
    v_mfma_f32_32x32x16_bf16 v[164:179], v[104:107], v[112:115], v[164:179]
    buffer_load_dwordx4 v9, s[56:59], s50 offen  lds
    v_cvt_pk_bf16_f32 v223, v204, v203
    v_perm_b32 v196, v19, v23, s12
    v_perm_b32 v197, v23, v27, s12
    v_perm_b32 v198, v27, v31, s12
    s_waitcnt lgkmcnt(2)
    v_mfma_f32_32x32x16_bf16 v[116:131], v[84:87], v[92:95], v[116:131]
    ds_read_b128 v[100:103], v66 offset:32768
    ds_read_b128 v[108:111], v74 offset:32768
    v_perm_b32 v199, v31, v35, s12
    v_perm_b32 v200, v35, v39, s12
    v_perm_b32 v201, v39, v43, s12
    s_waitcnt lgkmcnt(3)
    v_mfma_f32_32x32x16_bf16 v[132:147], v[84:87], v[96:99], v[132:147]
    ds_read_b128 v[112:115], v74 offset:36864
    ds_read_b128 v[104:107], v66 offset:36864
    v_and_b32 v192, s5, v47
    v_and_b32 v193, s5, v51
    s_add_u32 m0, s47, 2048
    s_waitcnt lgkmcnt(4)
    v_mfma_f32_32x32x16_bf16 v[148:163], v[88:91], v[92:95], v[148:163]
    buffer_load_dwordx4 v10, s[56:59], s50 offen  lds
    v_and_b32 v194, s5, v55
    v_and_b32 v195, s5, v59
    v_dot2_f32_bf16 v203, v196, v191, 0
    s_add_u32 m0, s47, 3072
    v_mfma_f32_32x32x16_bf16 v[164:179], v[88:91], v[96:99], v[164:179]
    buffer_load_dwordx4 v11, s[56:59], s50 offen  lds
    v_dot2_f32_bf16 v204, v197, v191, 0
    v_dot2_f32_bf16 v205, v198, v191, 0
    v_dot2_f32_bf16 v206, v199, v191, 0
    v_dot2c_f32_bf16 v203, v198, v190
    s_waitcnt lgkmcnt(2)
    v_mfma_f32_32x32x16_bf16 v[116:131], v[100:103], v[108:111], v[116:131]
    ds_read_b128 v[84:87], v67 offset:32768
    ds_read_b128 v[92:95], v75 offset:32768
    v_dot2c_f32_bf16 v204, v199, v190
    v_dot2c_f32_bf16 v205, v200, v190
    v_dot2c_f32_bf16 v206, v201, v190
    s_waitcnt lgkmcnt(3)
    v_mfma_f32_32x32x16_bf16 v[132:147], v[100:103], v[112:115], v[132:147]
    ds_read_b128 v[96:99], v75 offset:36864
    ds_read_b128 v[88:91], v67 offset:36864
    v_mul_f32 v203, v203, v192
    s_add_u32 s51, s46, s49
    s_add_u32 m0, s47, 16384
    s_waitcnt lgkmcnt(4)
    v_mfma_f32_32x32x16_bf16 v[148:163], v[104:107], v[108:111], v[148:163]
    buffer_load_dwordx4 v12, s[60:63], s51 offen  lds
    v_mul_f32 v204, v204, v193
    v_mul_f32 v205, v205, v194
    v_mul_f32 v206, v206, v195
    s_add_u32 m0, s47, 17408
    v_mfma_f32_32x32x16_bf16 v[164:179], v[104:107], v[112:115], v[164:179]
    buffer_load_dwordx4 v13, s[60:63], s51 offen  lds
    v_cvt_pk_bf16_f32 v220, v206, v205
    v_cvt_pk_bf16_f32 v221, v204, v203
    s_nop 0
    v_permlane32_swap_b32 v222, v220
    v_permlane32_swap_b32 v223, v221
    s_waitcnt lgkmcnt(2)
    v_mfma_f32_32x32x16_bf16 v[116:131], v[84:87], v[92:95], v[116:131]
    ds_read_b128 v[100:103], v68 offset:32768
    ds_read_b128 v[108:111], v76 offset:32768
    s_waitcnt lgkmcnt(3)
    v_mfma_f32_32x32x16_bf16 v[132:147], v[84:87], v[96:99], v[132:147]
    ds_read_b128 v[112:115], v76 offset:36864
    ds_read_b128 v[104:107], v68 offset:36864
    s_add_u32 m0, s47, 18432
    s_waitcnt lgkmcnt(4)
    v_mfma_f32_32x32x16_bf16 v[148:163], v[88:91], v[92:95], v[148:163]
    buffer_load_dwordx4 v14, s[60:63], s51 offen  lds
    s_add_u32 m0, s47, 19456
    v_mfma_f32_32x32x16_bf16 v[164:179], v[88:91], v[96:99], v[164:179]
    buffer_load_dwordx4 v15, s[60:63], s51 offen  lds
    s_waitcnt lgkmcnt(0)
    s_waitcnt vmcnt(16)
    s_barrier
    v_mfma_f32_32x32x16_bf16 v[116:131], v[100:103], v[108:111], v[116:131]
    ds_read_b128 v[84:87], v69 offset:0
    ds_read_b128 v[92:95], v77 offset:0
    v_mfma_f32_32x32x16_bf16 v[132:147], v[100:103], v[112:115], v[132:147]
    ds_read_b128 v[96:99], v77 offset:4096
    ds_read_b128 v[88:91], v69 offset:4096
    s_add_u32 s49, s49, 128
    s_and_b32 s49, s49, 0x7ff
    s_add_u32 s50, s45, s49
    s_add_u32 m0, s47, 32768
    v_mfma_f32_32x32x16_bf16 v[148:163], v[104:107], v[108:111], v[148:163]
    buffer_load_dwordx4 v8, s[56:59], s50 offen  lds
    s_add_u32 m0, s47, 33792
    v_mfma_f32_32x32x16_bf16 v[164:179], v[104:107], v[112:115], v[164:179]
    buffer_load_dwordx4 v9, s[56:59], s50 offen  lds
    s_waitcnt lgkmcnt(2)
    v_mfma_f32_32x32x16_bf16 v[116:131], v[84:87], v[92:95], v[116:131]
    ds_read_b128 v[100:103], v70 offset:0
    ds_read_b128 v[108:111], v78 offset:0
    s_waitcnt lgkmcnt(3)
    v_mfma_f32_32x32x16_bf16 v[132:147], v[84:87], v[96:99], v[132:147]
    ds_read_b128 v[112:115], v78 offset:4096
    ds_read_b128 v[104:107], v70 offset:4096
    s_add_u32 m0, s47, 34816
    s_waitcnt lgkmcnt(4)
    v_mfma_f32_32x32x16_bf16 v[148:163], v[88:91], v[92:95], v[148:163]
    buffer_load_dwordx4 v10, s[56:59], s50 offen  lds
    s_add_u32 m0, s47, 35840
    v_mfma_f32_32x32x16_bf16 v[164:179], v[88:91], v[96:99], v[164:179]
    buffer_load_dwordx4 v11, s[56:59], s50 offen  lds
    s_waitcnt lgkmcnt(2)
    v_mfma_f32_32x32x16_bf16 v[116:131], v[100:103], v[108:111], v[116:131]
    ds_read_b128 v[84:87], v71 offset:0
    ds_read_b128 v[92:95], v79 offset:0
    s_waitcnt lgkmcnt(3)
    v_mfma_f32_32x32x16_bf16 v[132:147], v[100:103], v[112:115], v[132:147]
    ds_read_b128 v[96:99], v79 offset:4096
    ds_read_b128 v[88:91], v71 offset:4096
    s_add_u32 s51, s46, s49
    s_add_u32 m0, s47, 49152
    s_waitcnt lgkmcnt(4)
    v_mfma_f32_32x32x16_bf16 v[148:163], v[104:107], v[108:111], v[148:163]
    buffer_load_dwordx4 v12, s[60:63], s51 offen  lds
    s_add_u32 m0, s47, 50176
    v_mfma_f32_32x32x16_bf16 v[164:179], v[104:107], v[112:115], v[164:179]
    buffer_load_dwordx4 v13, s[60:63], s51 offen  lds
    s_waitcnt lgkmcnt(2)
    v_mfma_f32_32x32x16_bf16 v[116:131], v[84:87], v[92:95], v[116:131]
    ds_read_b128 v[100:103], v72 offset:0
    ds_read_b128 v[108:111], v80 offset:0
    s_waitcnt lgkmcnt(3)
    v_mfma_f32_32x32x16_bf16 v[132:147], v[84:87], v[96:99], v[132:147]
    ds_read_b128 v[112:115], v80 offset:4096
    ds_read_b128 v[104:107], v72 offset:4096
    s_add_u32 m0, s47, 51200
    s_waitcnt lgkmcnt(4)
    v_mfma_f32_32x32x16_bf16 v[148:163], v[88:91], v[92:95], v[148:163]
    buffer_load_dwordx4 v14, s[60:63], s51 offen  lds
    s_add_u32 m0, s47, 52224
    v_mfma_f32_32x32x16_bf16 v[164:179], v[88:91], v[96:99], v[164:179]
    buffer_load_dwordx4 v15, s[60:63], s51 offen  lds
    s_waitcnt lgkmcnt(0)
    s_waitcnt vmcnt(16)
    s_barrier
    v_mfma_f32_32x32x16_bf16 v[116:131], v[100:103], v[108:111], v[116:131]
    ds_read_b128 v[84:87], v69 offset:32768
    ds_read_b128 v[92:95], v77 offset:32768
    v_mov_b32 v2, 0
    buffer_load_dwordx2 v[4:5], v2, s[24:27], 0 offen sc0 sc1
    v_mfma_f32_32x32x16_bf16 v[132:147], v[100:103], v[112:115], v[132:147]
    ds_read_b128 v[96:99], v77 offset:36864
    ds_read_b128 v[88:91], v69 offset:36864
    s_add_u32 s49, s49, 128
    s_and_b32 s49, s49, 0x7ff
    s_add_u32 s50, s45, s49
    s_add_u32 m0, s47, 65536
    v_mfma_f32_32x32x16_bf16 v[148:163], v[104:107], v[108:111], v[148:163]
    buffer_load_dwordx4 v8, s[56:59], s50 offen  lds
    buffer_store_dwordx4 v[208:211], v180, s[8:11], s6 offen sc0 sc1
    s_add_u32 m0, s47, 66560
    v_mfma_f32_32x32x16_bf16 v[164:179], v[104:107], v[112:115], v[164:179]
    buffer_load_dwordx4 v9, s[56:59], s50 offen  lds
    s_add_u32 s6, s6, 32768
    buffer_store_dwordx4 v[212:215], v180, s[8:11], s6 offen sc0 sc1
    s_waitcnt lgkmcnt(2)
    v_mfma_f32_32x32x16_bf16 v[116:131], v[84:87], v[92:95], v[116:131]
    ds_read_b128 v[100:103], v70 offset:32768
    ds_read_b128 v[108:111], v78 offset:32768
    s_add_u32 s6, s6, 32768
    buffer_store_dwordx4 v[216:219], v180, s[8:11], s6 offen sc0 sc1
    s_waitcnt lgkmcnt(3)
    v_mfma_f32_32x32x16_bf16 v[132:147], v[84:87], v[96:99], v[132:147]
    ds_read_b128 v[112:115], v78 offset:36864
    ds_read_b128 v[104:107], v70 offset:36864
    s_add_u32 s6, s6, 32768
    s_add_u32 m0, s47, 67584
    s_waitcnt lgkmcnt(4)
    v_mfma_f32_32x32x16_bf16 v[148:163], v[88:91], v[92:95], v[148:163]
    buffer_load_dwordx4 v10, s[56:59], s50 offen  lds
    buffer_store_dwordx4 v[220:223], v180, s[8:11], s6 offen sc0 sc1
    s_add_u32 m0, s47, 68608
    v_mfma_f32_32x32x16_bf16 v[164:179], v[88:91], v[96:99], v[164:179]
    buffer_load_dwordx4 v11, s[56:59], s50 offen  lds
    s_mov_b64 s[30:31], exec
    s_mov_b32 exec_lo, 0
    s_mov_b32 exec_hi, 0x80000000
    buffer_store_dwordx2 v[226:227], v224, s[8:11], 0 offen sc0 sc1
    buffer_store_dwordx2 v[228:229], v224, s[8:11], s32 offen sc0 sc1
    s_mov_b64 exec, s[30:31]
    s_waitcnt lgkmcnt(2)
    v_mfma_f32_32x32x16_bf16 v[116:131], v[100:103], v[108:111], v[116:131]
    ds_read_b128 v[84:87], v71 offset:32768
    ds_read_b128 v[92:95], v79 offset:32768
    s_waitcnt lgkmcnt(3)
    v_mfma_f32_32x32x16_bf16 v[132:147], v[100:103], v[112:115], v[132:147]
    ds_read_b128 v[96:99], v79 offset:36864
    ds_read_b128 v[88:91], v71 offset:36864
    s_add_u32 s51, s46, s49
    s_add_u32 m0, s47, 81920
    s_waitcnt lgkmcnt(4)
    v_mfma_f32_32x32x16_bf16 v[148:163], v[104:107], v[108:111], v[148:163]
    buffer_load_dwordx4 v12, s[60:63], s51 offen  lds
    s_add_u32 m0, s47, 82944
    v_mfma_f32_32x32x16_bf16 v[164:179], v[104:107], v[112:115], v[164:179]
    buffer_load_dwordx4 v13, s[60:63], s51 offen  lds
    s_waitcnt lgkmcnt(2)
    v_mfma_f32_32x32x16_bf16 v[116:131], v[84:87], v[92:95], v[116:131]
    ds_read_b128 v[100:103], v72 offset:32768
    ds_read_b128 v[108:111], v80 offset:32768
    s_waitcnt lgkmcnt(3)
    v_mfma_f32_32x32x16_bf16 v[132:147], v[84:87], v[96:99], v[132:147]
    ds_read_b128 v[112:115], v80 offset:36864
    ds_read_b128 v[104:107], v72 offset:36864
    s_add_u32 m0, s47, 83968
    s_waitcnt lgkmcnt(4)
    v_mfma_f32_32x32x16_bf16 v[148:163], v[88:91], v[92:95], v[148:163]
    buffer_load_dwordx4 v14, s[60:63], s51 offen  lds
    s_add_u32 m0, s47, 84992
    v_mfma_f32_32x32x16_bf16 v[164:179], v[88:91], v[96:99], v[164:179]
    buffer_load_dwordx4 v15, s[60:63], s51 offen  lds
    s_waitcnt lgkmcnt(0)
    s_waitcnt vmcnt(23)
    s_barrier
    v_mfma_f32_32x32x16_bf16 v[116:131], v[100:103], v[108:111], v[116:131]
    ds_read_b128 v[84:87], v65 offset:0
    ds_read_b128 v[92:95], v73 offset:0
    v_mfma_f32_32x32x16_bf16 v[132:147], v[100:103], v[112:115], v[132:147]
    ds_read_b128 v[96:99], v73 offset:4096
    ds_read_b128 v[88:91], v65 offset:4096
    s_add_u32 s49, s49, 128
    s_and_b32 s49, s49, 0x7ff
    s_add_u32 s50, s45, s49
    s_add_u32 m0, s47, 98304
    v_mfma_f32_32x32x16_bf16 v[148:163], v[104:107], v[108:111], v[148:163]
    buffer_load_dwordx4 v8, s[56:59], s50 offen  lds
    s_add_u32 m0, s47, 99328
    v_mfma_f32_32x32x16_bf16 v[164:179], v[104:107], v[112:115], v[164:179]
    buffer_load_dwordx4 v9, s[56:59], s50 offen  lds
    s_waitcnt lgkmcnt(2)
    v_mfma_f32_32x32x16_bf16 v[116:131], v[84:87], v[92:95], v[116:131]
    ds_read_b128 v[100:103], v66 offset:0
    ds_read_b128 v[108:111], v74 offset:0
    s_waitcnt lgkmcnt(3)
    v_mfma_f32_32x32x16_bf16 v[132:147], v[84:87], v[96:99], v[132:147]
    ds_read_b128 v[112:115], v74 offset:4096
    ds_read_b128 v[104:107], v66 offset:4096
    s_add_u32 m0, s47, 100352
    s_waitcnt lgkmcnt(4)
    v_mfma_f32_32x32x16_bf16 v[148:163], v[88:91], v[92:95], v[148:163]
    buffer_load_dwordx4 v10, s[56:59], s50 offen  lds
    s_add_u32 m0, s47, 101376
    v_mfma_f32_32x32x16_bf16 v[164:179], v[88:91], v[96:99], v[164:179]
    buffer_load_dwordx4 v11, s[56:59], s50 offen  lds
    s_waitcnt lgkmcnt(2)
    v_mfma_f32_32x32x16_bf16 v[116:131], v[100:103], v[108:111], v[116:131]
    ds_read_b128 v[84:87], v67 offset:0
    ds_read_b128 v[92:95], v75 offset:0
    s_waitcnt lgkmcnt(3)
    v_mfma_f32_32x32x16_bf16 v[132:147], v[100:103], v[112:115], v[132:147]
    ds_read_b128 v[96:99], v75 offset:4096
    ds_read_b128 v[88:91], v67 offset:4096
    s_add_u32 s51, s46, s49
    s_add_u32 m0, s47, 114688
    s_waitcnt lgkmcnt(4)
    v_mfma_f32_32x32x16_bf16 v[148:163], v[104:107], v[108:111], v[148:163]
    buffer_load_dwordx4 v12, s[60:63], s51 offen  lds
    s_add_u32 m0, s47, 115712
    v_mfma_f32_32x32x16_bf16 v[164:179], v[104:107], v[112:115], v[164:179]
    buffer_load_dwordx4 v13, s[60:63], s51 offen  lds
    s_waitcnt lgkmcnt(2)
    v_mfma_f32_32x32x16_bf16 v[116:131], v[84:87], v[92:95], v[116:131]
    ds_read_b128 v[100:103], v68 offset:0
    ds_read_b128 v[108:111], v76 offset:0
    s_waitcnt lgkmcnt(3)
    v_mfma_f32_32x32x16_bf16 v[132:147], v[84:87], v[96:99], v[132:147]
    ds_read_b128 v[112:115], v76 offset:4096
    ds_read_b128 v[104:107], v68 offset:4096
    s_add_u32 m0, s47, 116736
    s_waitcnt lgkmcnt(4)
    v_mfma_f32_32x32x16_bf16 v[148:163], v[88:91], v[92:95], v[148:163]
    buffer_load_dwordx4 v14, s[60:63], s51 offen  lds
    s_add_u32 m0, s47, 117760
    v_mfma_f32_32x32x16_bf16 v[164:179], v[88:91], v[96:99], v[164:179]
    buffer_load_dwordx4 v15, s[60:63], s51 offen  lds
    s_waitcnt lgkmcnt(0)
    s_waitcnt vmcnt(23)
    s_barrier
    v_mfma_f32_32x32x16_bf16 v[116:131], v[100:103], v[108:111], v[116:131]
    ds_read_b128 v[84:87], v65 offset:32768
    ds_read_b128 v[92:95], v73 offset:32768
    s_lshl_b32 s6, s44, 2
    s_add_u32 s6, s6, s42
    s_lshl_b32 s6, s6, 16
    s_lshl_b32 s3, s43, 12
    v_mfma_f32_32x32x16_bf16 v[132:147], v[100:103], v[112:115], v[132:147]
    ds_read_b128 v[96:99], v73 offset:36864
    ds_read_b128 v[88:91], v65 offset:36864
    s_add_u32 s6, s6, s3
    s_add_u32 s6, s6, 16777216
    s_mov_b32 s7, 0x05040100
    s_mov_b32 s12, 0x07060302
    v_mfma_f32_32x32x16_bf16 v[148:163], v[104:107], v[108:111], v[148:163]
    v_and_b32 v18, 31, v1
    v_lshlrev_b32 v16, 6, v18
    v_bfe_u32 v18, v1, 2, 2
    v_lshrrev_b32 v19, 5, v1
    v_lshlrev_b32 v19, 1, v19
    v_xor_b32 v18, v18, v19
    v_mfma_f32_32x32x16_bf16 v[164:179], v[104:107], v[112:115], v[164:179]
    v_lshl_add_u32 v16, v18, 4, v16
    v_add_u32 v16, s16, v16
    v_xor_b32 v17, 16, v16
    ds_read_b128 v[20:23], v16 offset:0
    ds_read_b128 v[24:27], v17 offset:0
    s_waitcnt lgkmcnt(4)
    v_mfma_f32_32x32x16_bf16 v[116:131], v[84:87], v[92:95], v[116:131]
    ds_read_b128 v[100:103], v66 offset:32768
    ds_read_b128 v[108:111], v74 offset:32768
    ds_read_b128 v[28:31], v16 offset:2048
    ds_read_b128 v[32:35], v17 offset:2048
    s_waitcnt lgkmcnt(1)
    v_perm_b32 v36, v28, v20, s7
    v_perm_b32 v37, v28, v20, s12
    v_mfma_f32_32x32x16_bf16 v[132:147], v[84:87], v[96:99], v[132:147]
    ds_read_b128 v[112:115], v74 offset:36864
    ds_read_b128 v[104:107], v66 offset:36864
    v_perm_b32 v38, v29, v21, s7
    v_perm_b32 v39, v29, v21, s12
    buffer_store_dwordx4 v[36:39], v60, s[8:11], s6 offen offset:0 sc0 sc1
    v_perm_b32 v40, v30, v22, s7
    v_mfma_f32_32x32x16_bf16 v[148:163], v[88:91], v[92:95], v[148:163]
    v_perm_b32 v41, v30, v22, s12
    v_perm_b32 v42, v31, v23, s7
    v_perm_b32 v43, v31, v23, s12
    buffer_store_dwordx4 v[40:43], v60, s[8:11], s6 offen offset:1024 sc0 sc1
    s_waitcnt lgkmcnt(2)
    v_perm_b32 v36, v32, v24, s7
    v_perm_b32 v37, v32, v24, s12
    v_mfma_f32_32x32x16_bf16 v[164:179], v[88:91], v[96:99], v[164:179]
    v_perm_b32 v38, v33, v25, s7
    v_perm_b32 v39, v33, v25, s12
    buffer_store_dwordx4 v[36:39], v60, s[8:11], s6 offen offset:2048 sc0 sc1
    v_perm_b32 v40, v34, v26, s7
    v_perm_b32 v41, v34, v26, s12
    v_perm_b32 v42, v35, v27, s7
    v_mfma_f32_32x32x16_bf16 v[116:131], v[100:103], v[108:111], v[116:131]
    ds_read_b128 v[84:87], v67 offset:32768
    ds_read_b128 v[92:95], v75 offset:32768
    v_perm_b32 v43, v35, v27, s12
    buffer_store_dwordx4 v[40:43], v60, s[8:11], s6 offen offset:3072 sc0 sc1
    v_subrev_u32 v61, 32, v60
    s_waitcnt lgkmcnt(3)
    v_mfma_f32_32x32x16_bf16 v[132:147], v[100:103], v[112:115], v[132:147]
    ds_read_b128 v[96:99], v75 offset:36864
    ds_read_b128 v[88:91], v67 offset:36864
    v_min_u32 v61, 0x7fff0000, v61
    v_subrev_u32 v62, 16, v60
    v_min_u32 v62, 0x7fff0000, v62
    v_add_u32 v63, s29, v60
    s_waitcnt lgkmcnt(4)
    v_mfma_f32_32x32x16_bf16 v[148:163], v[104:107], v[108:111], v[148:163]
    buffer_load_dwordx4 v[36:39], v61, s[76:79], 0 offen
    buffer_load_dwordx2 v[46:47], v62, s[76:79], 0 offen
    v_mfma_f32_32x32x16_bf16 v[164:179], v[104:107], v[112:115], v[164:179]
    buffer_load_dwordx4 v[20:23], v60, s[76:79], 0 offen offset:0
    s_waitcnt lgkmcnt(2)
    v_mfma_f32_32x32x16_bf16 v[116:131], v[84:87], v[92:95], v[116:131]
    ds_read_b128 v[100:103], v68 offset:32768
    ds_read_b128 v[108:111], v76 offset:32768
    buffer_load_dwordx2 v[16:17], v60, s[76:79], 0 offen offset:16
    s_waitcnt lgkmcnt(3)
    v_mfma_f32_32x32x16_bf16 v[132:147], v[84:87], v[96:99], v[132:147]
    ds_read_b128 v[112:115], v76 offset:36864
    ds_read_b128 v[104:107], v68 offset:36864
    buffer_load_dwordx4 v[24:27], v60, s[76:79], 0 offen offset:1024
    s_waitcnt lgkmcnt(4)
    v_mfma_f32_32x32x16_bf16 v[148:163], v[88:91], v[92:95], v[148:163]
    buffer_load_dwordx2 v[40:41], v60, s[76:79], 0 offen offset:1040
    buffer_load_dwordx4 v[28:31], v60, s[76:79], 0 offen offset:2048
    v_mfma_f32_32x32x16_bf16 v[164:179], v[88:91], v[96:99], v[164:179]
    buffer_load_dwordx2 v[42:43], v60, s[76:79], 0 offen offset:2064
    s_waitcnt lgkmcnt(0)
    s_waitcnt vmcnt(20)
    s_barrier
    v_mfma_f32_32x32x16_bf16 v[116:131], v[100:103], v[108:111], v[116:131]
    ds_read_b128 v[84:87], v69 offset:0
    ds_read_b128 v[92:95], v77 offset:0
    buffer_load_dwordx4 v[32:35], v60, s[76:79], 0 offen offset:3072
    v_mfma_f32_32x32x16_bf16 v[132:147], v[100:103], v[112:115], v[132:147]
    ds_read_b128 v[96:99], v77 offset:4096
    ds_read_b128 v[88:91], v69 offset:4096
    buffer_load_dwordx2 v[44:45], v60, s[76:79], 0 offen offset:3088
    v_mfma_f32_32x32x16_bf16 v[148:163], v[104:107], v[108:111], v[148:163]
    s_mov_b32 s88, s20
    s_mov_b32 s89, s21
    s_mov_b32 s90, 2048
    s_mov_b32 s91, 131072
    s_and_b32 s3, s42, 1
    s_lshl_b32 s3, s3, 5
    v_mfma_f32_32x32x16_bf16 v[164:179], v[104:107], v[112:115], v[164:179]
    s_and_b32 s3, s42, 1
    s_lshl_b32 s3, s3, 6
    v_and_b32 v64, 31, v1
    v_lshl_add_u32 v64, v64, 1, s3
    s_lshl_b32 s3, s44, 7
    buffer_load_ushort v64, v64, s[88:91], s3 offen
    v_and_b32 v83, 15, v1
    v_lshrrev_b32 v180, 4, v1
    v_add_u32 v184, 1, v83
    s_waitcnt lgkmcnt(2)
    v_mfma_f32_32x32x16_bf16 v[116:131], v[84:87], v[92:95], v[116:131]
    ds_read_b128 v[100:103], v70 offset:0
    ds_read_b128 v[108:111], v78 offset:0
    v_and_b32 v185, 3, v184
    v_mul_u32_u24 v185, 4160, v185
    v_and_b32 v184, 28, v184
    v_lshl_add_u32 v185, v184, 1, v185
    s_waitcnt lgkmcnt(3)
    v_mfma_f32_32x32x16_bf16 v[132:147], v[84:87], v[96:99], v[132:147]
    ds_read_b128 v[112:115], v78 offset:4096
    ds_read_b128 v[104:107], v70 offset:4096
    v_lshl_add_u32 v185, v180, 4, v185
    v_add_u32 v186, s29, v185
    v_lshlrev_b32 v184, 1, v83
    v_sub_u32 v184, v180, v184
    s_waitcnt lgkmcnt(4)
    v_mfma_f32_32x32x16_bf16 v[148:163], v[88:91], v[92:95], v[148:163]
    v_add_u32 v184, 30, v184
    v_lshrrev_b32 v185, 2, v184
    v_lshlrev_b32 v184, 6, v184
    v_add_u32 v184, 132096, v184
    v_add_u32 v187, 63, v185
    v_and_b32 v187, 3, v187
    v_mfma_f32_32x32x16_bf16 v[164:179], v[88:91], v[96:99], v[164:179]
    v_xor_b32 v187, s42, v187
    v_lshl_add_u32 v187, v187, 4, v184
    v_add_u32 v188, 62, v185
    v_and_b32 v188, 3, v188
    v_xor_b32 v188, s42, v188
    v_lshl_add_u32 v188, v188, 4, v184
    s_waitcnt lgkmcnt(2)
    v_mfma_f32_32x32x16_bf16 v[116:131], v[100:103], v[108:111], v[116:131]
    ds_read_b128 v[84:87], v71 offset:0
    ds_read_b128 v[92:95], v79 offset:0
    v_add_u32 v189, 61, v185
    v_and_b32 v189, 3, v189
    v_xor_b32 v189, s42, v189
    v_lshl_add_u32 v189, v189, 4, v184
    s_waitcnt lgkmcnt(3)
    v_mfma_f32_32x32x16_bf16 v[132:147], v[100:103], v[112:115], v[132:147]
    ds_read_b128 v[96:99], v79 offset:4096
    ds_read_b128 v[88:91], v71 offset:4096
    v_add_u32 v190, 60, v185
    v_and_b32 v190, 3, v190
    v_xor_b32 v190, s42, v190
    v_lshl_add_u32 v190, v190, 4, v184
    s_waitcnt lgkmcnt(4)
    v_mfma_f32_32x32x16_bf16 v[148:163], v[104:107], v[108:111], v[148:163]
    v_lshlrev_b32 v184, 5, v83
    v_lshl_add_u32 v184, v180, 3, v184
    v_sub_u32 v184, 504, v184
    v_and_b32 v191, 8, v184
    v_lshrrev_b32 v184, 4, v184
    v_lshl_add_u32 v191, v184, 6, v191
    v_mfma_f32_32x32x16_bf16 v[164:179], v[104:107], v[112:115], v[164:179]
    v_bfe_u32 v184, v184, 2, 2
    v_xor_b32 v184, s42, v184
    v_lshl_add_u32 v191, v184, 4, v191
    v_add_u32 v191, 132096, v191
    v_and_b32 v184, 1, v180
    v_lshlrev_b32 v184, 9, v184
    s_waitcnt lgkmcnt(2)
    v_mfma_f32_32x32x16_bf16 v[116:131], v[84:87], v[92:95], v[116:131]
    ds_read_b128 v[100:103], v72 offset:0
    ds_read_b128 v[108:111], v80 offset:0
    v_lshl_add_u32 v184, v83, 5, v184
    v_lshrrev_b32 v185, 1, v180
    v_lshl_add_u32 v192, v185, 4, v184
    s_mov_b32 s6, 0
    v_readfirstlane_b32 s22, v4
    v_readfirstlane_b32 s23, v5
    s_nop 3
    s_or_b32 s3, s22, s23
    s_cmp_lg_u32 s3, 0
    s_cbranch_scc1 Lnok_gate_2
Lnretry_gate_3:
    buffer_load_dwordx2 v[4:5], v2, s[24:27], 0 offen sc0 sc1
    s_waitcnt vmcnt(0)
    v_readfirstlane_b32 s22, v4
    v_readfirstlane_b32 s23, v5
    s_add_u32 s6, s6, 1
    s_nop 3
    s_or_b32 s3, s22, s23
    s_cmp_gt_u32 s6, 20000
    s_cbranch_scc1 Lnok_gate_2
    s_cmp_eq_u32 s3, 0
    s_cbranch_scc1 Lnretry_gate_3
Lnok_gate_2:
    s_waitcnt lgkmcnt(3)
    v_mfma_f32_32x32x16_bf16 v[132:147], v[84:87], v[96:99], v[132:147]
    ds_read_b128 v[112:115], v80 offset:4096
    ds_read_b128 v[104:107], v72 offset:4096
    v_mov_b32 v182, s22
    v_mov_b32 v183, s23
    s_mov_b64 s[6:7], exec
    s_mov_b64 exec, 1
    buffer_store_dwordx2 v[182:183], v6, s[8:11], s13 offen sc0 sc1
    s_mov_b64 exec, s[6:7]
    s_waitcnt lgkmcnt(4)
    v_mfma_f32_32x32x16_bf16 v[148:163], v[88:91], v[92:95], v[148:163]
    v_mfma_f32_32x32x16_bf16 v[164:179], v[88:91], v[96:99], v[164:179]
    s_waitcnt lgkmcnt(0)
    s_waitcnt vmcnt(16)
    s_barrier
    v_mfma_f32_32x32x16_bf16 v[116:131], v[100:103], v[108:111], v[116:131]
    ds_read_b128 v[84:87], v69 offset:32768
    ds_read_b128 v[92:95], v77 offset:32768
    v_mfma_f32_32x32x16_bf16 v[132:147], v[100:103], v[112:115], v[132:147]
    ds_read_b128 v[96:99], v77 offset:36864
    ds_read_b128 v[88:91], v69 offset:36864
    v_mfma_f32_32x32x16_bf16 v[148:163], v[104:107], v[108:111], v[148:163]
    v_mfma_f32_32x32x16_bf16 v[164:179], v[104:107], v[112:115], v[164:179]
    s_waitcnt lgkmcnt(2)
    v_mfma_f32_32x32x16_bf16 v[116:131], v[84:87], v[92:95], v[116:131]
    ds_read_b128 v[100:103], v70 offset:32768
    ds_read_b128 v[108:111], v78 offset:32768
    s_waitcnt lgkmcnt(3)
    v_mfma_f32_32x32x16_bf16 v[132:147], v[84:87], v[96:99], v[132:147]
    ds_read_b128 v[112:115], v78 offset:36864
    ds_read_b128 v[104:107], v70 offset:36864
    s_waitcnt lgkmcnt(4)
    v_mfma_f32_32x32x16_bf16 v[148:163], v[88:91], v[92:95], v[148:163]
    v_mfma_f32_32x32x16_bf16 v[164:179], v[88:91], v[96:99], v[164:179]
    s_waitcnt lgkmcnt(2)
    v_mfma_f32_32x32x16_bf16 v[116:131], v[100:103], v[108:111], v[116:131]
    ds_read_b128 v[84:87], v71 offset:32768
    ds_read_b128 v[92:95], v79 offset:32768
    s_waitcnt lgkmcnt(3)
    v_mfma_f32_32x32x16_bf16 v[132:147], v[100:103], v[112:115], v[132:147]
    ds_read_b128 v[96:99], v79 offset:36864
    ds_read_b128 v[88:91], v71 offset:36864
    s_waitcnt lgkmcnt(4)
    v_mfma_f32_32x32x16_bf16 v[148:163], v[104:107], v[108:111], v[148:163]
    v_mfma_f32_32x32x16_bf16 v[164:179], v[104:107], v[112:115], v[164:179]
    s_waitcnt lgkmcnt(2)
    v_mfma_f32_32x32x16_bf16 v[116:131], v[84:87], v[92:95], v[116:131]
    ds_read_b128 v[100:103], v72 offset:32768
    ds_read_b128 v[108:111], v80 offset:32768
    s_waitcnt lgkmcnt(3)
    v_mfma_f32_32x32x16_bf16 v[132:147], v[84:87], v[96:99], v[132:147]
    ds_read_b128 v[112:115], v80 offset:36864
    ds_read_b128 v[104:107], v72 offset:36864
    s_waitcnt lgkmcnt(4)
    v_mfma_f32_32x32x16_bf16 v[148:163], v[88:91], v[92:95], v[148:163]
    v_mfma_f32_32x32x16_bf16 v[164:179], v[88:91], v[96:99], v[164:179]
    s_waitcnt lgkmcnt(0)
    v_mfma_f32_32x32x16_bf16 v[116:131], v[100:103], v[108:111], v[116:131]
    v_mfma_f32_32x32x16_bf16 v[132:147], v[100:103], v[112:115], v[132:147]
    v_mfma_f32_32x32x16_bf16 v[148:163], v[104:107], v[108:111], v[148:163]
    v_mfma_f32_32x32x16_bf16 v[164:179], v[104:107], v[112:115], v[164:179]
    s_waitcnt vmcnt(12)
    v_mov_b32 v182, s22
    v_mov_b32 v183, s23
    s_mov_b64 s[6:7], exec
    s_mov_b64 exec, 1
    buffer_store_dwordx2 v[182:183], v6, s[8:11], s18 offen sc0 sc1
    s_mov_b64 exec, s[6:7]
    s_nop 2
    v_pk_fma_f32 v[8:9], v[132:133], v[230:231], v[118:119] op_sel:[0,1,0] op_sel_hi:[1,1,1] neg_lo:[0,1,0] neg_hi:[0,1,0]
    v_pk_fma_f32 v[10:11], v[116:117], v[230:231], v[134:135] op_sel:[0,1,0] op_sel_hi:[1,1,1]
    v_pk_fma_f32 v[2:3], v[116:117], v[230:231], v[8:9] op_sel:[0,0,0] op_sel_hi:[1,0,1]
    v_pk_fma_f32 v[4:5], v[132:133], v[230:231], v[10:11] op_sel:[0,0,0] op_sel_hi:[1,0,1]
    v_pk_fma_f32 v[8:9], v[4:5], v[230:231], v[120:121] op_sel:[0,1,0] op_sel_hi:[1,1,1] neg_lo:[0,1,0] neg_hi:[0,1,0]
    v_pk_fma_f32 v[10:11], v[2:3], v[230:231], v[136:137] op_sel:[0,1,0] op_sel_hi:[1,1,1]
    v_pk_fma_f32 v[2:3], v[2:3], v[230:231], v[8:9] op_sel:[0,0,0] op_sel_hi:[1,0,1]
    v_pk_fma_f32 v[4:5], v[4:5], v[230:231], v[10:11] op_sel:[0,0,0] op_sel_hi:[1,0,1]
    v_pk_fma_f32 v[8:9], v[4:5], v[230:231], v[122:123] op_sel:[0,1,0] op_sel_hi:[1,1,1] neg_lo:[0,1,0] neg_hi:[0,1,0]
    v_pk_fma_f32 v[10:11], v[2:3], v[230:231], v[138:139] op_sel:[0,1,0] op_sel_hi:[1,1,1]
    v_pk_fma_f32 v[2:3], v[2:3], v[230:231], v[8:9] op_sel:[0,0,0] op_sel_hi:[1,0,1]
    v_pk_fma_f32 v[4:5], v[4:5], v[230:231], v[10:11] op_sel:[0,0,0] op_sel_hi:[1,0,1]
    v_pk_fma_f32 v[8:9], v[4:5], v[230:231], v[124:125] op_sel:[0,1,0] op_sel_hi:[1,1,1] neg_lo:[0,1,0] neg_hi:[0,1,0]
    v_pk_fma_f32 v[10:11], v[2:3], v[230:231], v[140:141] op_sel:[0,1,0] op_sel_hi:[1,1,1]
    v_pk_fma_f32 v[2:3], v[2:3], v[230:231], v[8:9] op_sel:[0,0,0] op_sel_hi:[1,0,1]
    v_pk_fma_f32 v[4:5], v[4:5], v[230:231], v[10:11] op_sel:[0,0,0] op_sel_hi:[1,0,1]
    v_pk_fma_f32 v[8:9], v[4:5], v[230:231], v[126:127] op_sel:[0,1,0] op_sel_hi:[1,1,1] neg_lo:[0,1,0] neg_hi:[0,1,0]
    v_pk_fma_f32 v[10:11], v[2:3], v[230:231], v[142:143] op_sel:[0,1,0] op_sel_hi:[1,1,1]
    v_pk_fma_f32 v[2:3], v[2:3], v[230:231], v[8:9] op_sel:[0,0,0] op_sel_hi:[1,0,1]
    v_pk_fma_f32 v[4:5], v[4:5], v[230:231], v[10:11] op_sel:[0,0,0] op_sel_hi:[1,0,1]
    v_pk_fma_f32 v[8:9], v[4:5], v[230:231], v[128:129] op_sel:[0,1,0] op_sel_hi:[1,1,1] neg_lo:[0,1,0] neg_hi:[0,1,0]
    v_pk_fma_f32 v[10:11], v[2:3], v[230:231], v[144:145] op_sel:[0,1,0] op_sel_hi:[1,1,1]
    v_pk_fma_f32 v[2:3], v[2:3], v[230:231], v[8:9] op_sel:[0,0,0] op_sel_hi:[1,0,1]
    v_pk_fma_f32 v[4:5], v[4:5], v[230:231], v[10:11] op_sel:[0,0,0] op_sel_hi:[1,0,1]
    v_pk_fma_f32 v[8:9], v[4:5], v[230:231], v[130:131] op_sel:[0,1,0] op_sel_hi:[1,1,1] neg_lo:[0,1,0] neg_hi:[0,1,0]
    v_pk_fma_f32 v[10:11], v[2:3], v[230:231], v[146:147] op_sel:[0,1,0] op_sel_hi:[1,1,1]
    v_pk_fma_f32 v[2:3], v[2:3], v[230:231], v[8:9] op_sel:[0,0,0] op_sel_hi:[1,0,1]
    v_pk_fma_f32 v[4:5], v[4:5], v[230:231], v[10:11] op_sel:[0,0,0] op_sel_hi:[1,0,1]
    v_pk_fma_f32 v[8:9], v[4:5], v[230:231], v[148:149] op_sel:[0,1,0] op_sel_hi:[1,1,1] neg_lo:[0,1,0] neg_hi:[0,1,0]
    v_pk_fma_f32 v[10:11], v[2:3], v[230:231], v[164:165] op_sel:[0,1,0] op_sel_hi:[1,1,1]
    v_pk_fma_f32 v[2:3], v[2:3], v[230:231], v[8:9] op_sel:[0,0,0] op_sel_hi:[1,0,1]
    v_pk_fma_f32 v[4:5], v[4:5], v[230:231], v[10:11] op_sel:[0,0,0] op_sel_hi:[1,0,1]
    v_pk_fma_f32 v[8:9], v[4:5], v[230:231], v[150:151] op_sel:[0,1,0] op_sel_hi:[1,1,1] neg_lo:[0,1,0] neg_hi:[0,1,0]
    v_pk_fma_f32 v[10:11], v[2:3], v[230:231], v[166:167] op_sel:[0,1,0] op_sel_hi:[1,1,1]
    v_pk_fma_f32 v[2:3], v[2:3], v[230:231], v[8:9] op_sel:[0,0,0] op_sel_hi:[1,0,1]
    v_pk_fma_f32 v[4:5], v[4:5], v[230:231], v[10:11] op_sel:[0,0,0] op_sel_hi:[1,0,1]
    v_pk_fma_f32 v[8:9], v[4:5], v[230:231], v[152:153] op_sel:[0,1,0] op_sel_hi:[1,1,1] neg_lo:[0,1,0] neg_hi:[0,1,0]
    v_pk_fma_f32 v[10:11], v[2:3], v[230:231], v[168:169] op_sel:[0,1,0] op_sel_hi:[1,1,1]
    v_pk_fma_f32 v[2:3], v[2:3], v[230:231], v[8:9] op_sel:[0,0,0] op_sel_hi:[1,0,1]
    v_pk_fma_f32 v[4:5], v[4:5], v[230:231], v[10:11] op_sel:[0,0,0] op_sel_hi:[1,0,1]
    v_pk_fma_f32 v[8:9], v[4:5], v[230:231], v[154:155] op_sel:[0,1,0] op_sel_hi:[1,1,1] neg_lo:[0,1,0] neg_hi:[0,1,0]
    v_pk_fma_f32 v[10:11], v[2:3], v[230:231], v[170:171] op_sel:[0,1,0] op_sel_hi:[1,1,1]
    v_pk_fma_f32 v[2:3], v[2:3], v[230:231], v[8:9] op_sel:[0,0,0] op_sel_hi:[1,0,1]
    v_pk_fma_f32 v[4:5], v[4:5], v[230:231], v[10:11] op_sel:[0,0,0] op_sel_hi:[1,0,1]
    v_pk_fma_f32 v[8:9], v[4:5], v[230:231], v[156:157] op_sel:[0,1,0] op_sel_hi:[1,1,1] neg_lo:[0,1,0] neg_hi:[0,1,0]
    v_pk_fma_f32 v[10:11], v[2:3], v[230:231], v[172:173] op_sel:[0,1,0] op_sel_hi:[1,1,1]
    v_pk_fma_f32 v[2:3], v[2:3], v[230:231], v[8:9] op_sel:[0,0,0] op_sel_hi:[1,0,1]
    v_pk_fma_f32 v[4:5], v[4:5], v[230:231], v[10:11] op_sel:[0,0,0] op_sel_hi:[1,0,1]
    v_pk_fma_f32 v[8:9], v[4:5], v[230:231], v[158:159] op_sel:[0,1,0] op_sel_hi:[1,1,1] neg_lo:[0,1,0] neg_hi:[0,1,0]
    v_pk_fma_f32 v[10:11], v[2:3], v[230:231], v[174:175] op_sel:[0,1,0] op_sel_hi:[1,1,1]
    v_pk_fma_f32 v[2:3], v[2:3], v[230:231], v[8:9] op_sel:[0,0,0] op_sel_hi:[1,0,1]
    v_pk_fma_f32 v[4:5], v[4:5], v[230:231], v[10:11] op_sel:[0,0,0] op_sel_hi:[1,0,1]
    v_pk_fma_f32 v[8:9], v[4:5], v[230:231], v[160:161] op_sel:[0,1,0] op_sel_hi:[1,1,1] neg_lo:[0,1,0] neg_hi:[0,1,0]
    v_pk_fma_f32 v[10:11], v[2:3], v[230:231], v[176:177] op_sel:[0,1,0] op_sel_hi:[1,1,1]
    v_pk_fma_f32 v[2:3], v[2:3], v[230:231], v[8:9] op_sel:[0,0,0] op_sel_hi:[1,0,1]
    v_pk_fma_f32 v[4:5], v[4:5], v[230:231], v[10:11] op_sel:[0,0,0] op_sel_hi:[1,0,1]
    v_pk_fma_f32 v[8:9], v[4:5], v[230:231], v[162:163] op_sel:[0,1,0] op_sel_hi:[1,1,1] neg_lo:[0,1,0] neg_hi:[0,1,0]
    v_pk_fma_f32 v[10:11], v[2:3], v[230:231], v[178:179] op_sel:[0,1,0] op_sel_hi:[1,1,1]
    v_pk_fma_f32 v[2:3], v[2:3], v[230:231], v[8:9] op_sel:[0,0,0] op_sel_hi:[1,0,1]
    v_pk_fma_f32 v[4:5], v[4:5], v[230:231], v[10:11] op_sel:[0,0,0] op_sel_hi:[1,0,1]
    v_lshrrev_b32 v13, 5, v1
    v_lshlrev_b32 v13, 10, v13
    v_lshl_add_u32 v12, v7, 2, v13
    s_lshr_b32 s3, s42, 1
    s_lshl_b32 s3, s3, 11
    s_add_u32 s3, s3, 150528
    v_add_u32 v12, s3, v12
    ds_write2st64_b32 v12, v2, v4 offset0:12 offset1:13
    ds_write2st64_b32 v12, v3, v5 offset0:14 offset1:15
    s_waitcnt lgkmcnt(0)
    s_barrier
    ds_read2st64_b32 v[66:67], v12 offset0:0 offset1:1
    ds_read2st64_b32 v[68:69], v12 offset0:2 offset1:3
    ds_read2st64_b32 v[70:71], v12 offset0:4 offset1:5
    ds_read2st64_b32 v[72:73], v12 offset0:6 offset1:7
    ds_read2st64_b32 v[74:75], v12 offset0:8 offset1:9
    ds_read2st64_b32 v[76:77], v12 offset0:10 offset1:11
    s_waitcnt lgkmcnt(4)
    v_fma_f32 v18, -v235, v67, v68
    v_fma_f32 v19, v235, v66, v69
    v_fma_f32 v68, v234, v66, v18
    v_fma_f32 v69, v234, v67, v19
    s_waitcnt lgkmcnt(3)
    v_fma_f32 v18, -v235, v69, v70
    v_fma_f32 v19, v235, v68, v71
    v_fma_f32 v70, v234, v68, v18
    v_fma_f32 v71, v234, v69, v19
    s_waitcnt lgkmcnt(2)
    v_fma_f32 v18, -v235, v71, v72
    v_fma_f32 v19, v235, v70, v73
    v_fma_f32 v72, v234, v70, v18
    v_fma_f32 v73, v234, v71, v19
    s_waitcnt lgkmcnt(1)
    v_fma_f32 v18, -v235, v73, v74
    v_fma_f32 v19, v235, v72, v75
    v_fma_f32 v74, v234, v72, v18
    v_fma_f32 v75, v234, v73, v19
    s_waitcnt lgkmcnt(0)
    v_fma_f32 v18, -v235, v75, v76
    v_fma_f32 v19, v235, v74, v77
    v_fma_f32 v76, v234, v74, v18
    v_fma_f32 v77, v234, v75, v19
    v_fma_f32 v18, -v235, v77, v2
    v_fma_f32 v19, v235, v76, v4
    v_fma_f32 v14, v234, v76, v18
    v_fma_f32 v15, v234, v77, v19
    v_fma_f32 v18, -v235, v15, v3
    v_fma_f32 v19, v235, v14, v5
    v_fma_f32 v84, v234, v14, v18
    v_fma_f32 v85, v234, v15, v19
    v_mov_b32 v86, v76
    v_mov_b32 v87, v14
    v_mov_b32 v88, v77
    v_mov_b32 v89, v15
    s_lshl_b32 s3, s44, 14
    s_add_u32 s3, s3, 21037056
    s_add_u32 s48, s40, s3
    s_addc_u32 s49, s41, 0
    s_mov_b32 s50, 16384
    s_mov_b32 s51, 131072
    v_lshlrev_b32 v2, 4, v7
    s_lshl_b32 s4, s43, 10
    s_lshr_b32 s3, s42, 1
    s_cmp_eq_u32 s3, 0
    s_cbranch_scc1 Lnopub_gate_4
    v_mov_b32 v12, v84
    v_mov_b32 v13, v85
    v_mov_b32 v14, s22
    v_mov_b32 v15, s23
    s_mov_b64 s[6:7], exec
    s_mov_b64 exec, s[34:35]
    buffer_store_dwordx4 v[12:15], v2, s[48:51], s4 offen sc0 sc1
    s_mov_b64 exec, s[6:7]
    s_nop 1
Lnopub_gate_4:
    s_lshl_b32 s3, s44, 2
    s_add_u32 s3, s3, s42
    s_lshl_b32 s3, s3, 7
    s_add_u32 s3, s3, 21504000
    v_and_b32 v3, 15, v1
    v_lshlrev_b32 v3, 3, v3
    v_add_u32 v3, s3, v3
    v_lshrrev_b32 v13, 5, v1
    v_lshlrev_b32 v13, 10, v13
    v_sub_u32 v13, v2, v13
    s_sub_u32 s3, s4, 1024
    v_add_u32 v12, s3, v13
    v_mul_f32 v14, v237, v237
    v_fma_f32 v14, v236, v236, -v14
    v_mul_f32 v15, v236, v237
    v_add_f32 v15, v15, v15
    v_lshrrev_b32 v13, 5, v1
    v_sub_u32 v13, s43, v13
    v_add_u32 v13, 1, v13
    v_lshrrev_b32 v18, 1, v13
    s_lshl_b32 s3, s44, 2
    s_add_u32 s3, s3, s42
    s_lshl_b32 s6, s3, 16
    s_add_u32 s6, s6, 16777216
    s_lshl_b32 s7, s44, 12
    s_and_b32 s3, s44, 7
    s_lshl_b32 s3, s3, 2
    s_lshl_b32 s13, -1, s3
    s_and_b32 s13, s13, 0x01111111
    s_add_u32 s13, s13, 0x06543210
    s_bitcmp1_b32 s44, 3
    s_cselect_b32 s17, 0x08888888, 0
    s_add_u32 s13, s13, s17
    s_bitcmp1_b32 s44, 3
    s_cselect_b32 s17, 0, 0x88888888
    s_add_u32 s16, s17, 0x76543210
    s_lshl_b32 s17, s16, 28
    s_or_b32 s14, s13, s17
    s_lshr_b32 s15, s16, 4
    buffer_load_dwordx2 v[182:183], v81, s[8:11], 0 offen sc0 sc1
    v_pk_mul_f32 v[8:9], v[132:133], v[232:233] op_sel:[0,1] op_sel_hi:[1,1] neg_lo:[0,1] neg_hi:[0,1]
    v_pk_mul_f32 v[10:11], v[116:117], v[232:233] op_sel:[0,1] op_sel_hi:[1,1]
    v_pk_fma_f32 v[116:117], v[116:117], v[232:233], v[8:9] op_sel:[0,0,0] op_sel_hi:[1,0,1]
    v_pk_fma_f32 v[132:133], v[132:133], v[232:233], v[10:11] op_sel:[0,0,0] op_sel_hi:[1,0,1]
    v_pk_mul_f32 v[8:9], v[134:135], v[232:233] op_sel:[0,1] op_sel_hi:[1,1] neg_lo:[0,1] neg_hi:[0,1]
    v_pk_mul_f32 v[10:11], v[118:119], v[232:233] op_sel:[0,1] op_sel_hi:[1,1]
    v_pk_fma_f32 v[118:119], v[118:119], v[232:233], v[8:9] op_sel:[0,0,0] op_sel_hi:[1,0,1]
    v_pk_fma_f32 v[134:135], v[134:135], v[232:233], v[10:11] op_sel:[0,0,0] op_sel_hi:[1,0,1]
    v_pk_mul_f32 v[8:9], v[136:137], v[232:233] op_sel:[0,1] op_sel_hi:[1,1] neg_lo:[0,1] neg_hi:[0,1]
    v_pk_mul_f32 v[10:11], v[120:121], v[232:233] op_sel:[0,1] op_sel_hi:[1,1]
    v_pk_fma_f32 v[120:121], v[120:121], v[232:233], v[8:9] op_sel:[0,0,0] op_sel_hi:[1,0,1]
    v_pk_fma_f32 v[136:137], v[136:137], v[232:233], v[10:11] op_sel:[0,0,0] op_sel_hi:[1,0,1]
    v_pk_mul_f32 v[8:9], v[138:139], v[232:233] op_sel:[0,1] op_sel_hi:[1,1] neg_lo:[0,1] neg_hi:[0,1]
    v_pk_mul_f32 v[10:11], v[122:123], v[232:233] op_sel:[0,1] op_sel_hi:[1,1]
    v_pk_fma_f32 v[122:123], v[122:123], v[232:233], v[8:9] op_sel:[0,0,0] op_sel_hi:[1,0,1]
    v_pk_fma_f32 v[138:139], v[138:139], v[232:233], v[10:11] op_sel:[0,0,0] op_sel_hi:[1,0,1]
    v_pk_mul_f32 v[8:9], v[140:141], v[232:233] op_sel:[0,1] op_sel_hi:[1,1] neg_lo:[0,1] neg_hi:[0,1]
    v_pk_mul_f32 v[10:11], v[124:125], v[232:233] op_sel:[0,1] op_sel_hi:[1,1]
    v_pk_fma_f32 v[124:125], v[124:125], v[232:233], v[8:9] op_sel:[0,0,0] op_sel_hi:[1,0,1]
    v_pk_fma_f32 v[140:141], v[140:141], v[232:233], v[10:11] op_sel:[0,0,0] op_sel_hi:[1,0,1]
    v_pk_mul_f32 v[8:9], v[142:143], v[232:233] op_sel:[0,1] op_sel_hi:[1,1] neg_lo:[0,1] neg_hi:[0,1]
    v_pk_mul_f32 v[10:11], v[126:127], v[232:233] op_sel:[0,1] op_sel_hi:[1,1]
    v_pk_fma_f32 v[126:127], v[126:127], v[232:233], v[8:9] op_sel:[0,0,0] op_sel_hi:[1,0,1]
    v_pk_fma_f32 v[142:143], v[142:143], v[232:233], v[10:11] op_sel:[0,0,0] op_sel_hi:[1,0,1]
    v_pk_mul_f32 v[8:9], v[144:145], v[232:233] op_sel:[0,1] op_sel_hi:[1,1] neg_lo:[0,1] neg_hi:[0,1]
    v_pk_mul_f32 v[10:11], v[128:129], v[232:233] op_sel:[0,1] op_sel_hi:[1,1]
    v_pk_fma_f32 v[128:129], v[128:129], v[232:233], v[8:9] op_sel:[0,0,0] op_sel_hi:[1,0,1]
    v_pk_fma_f32 v[144:145], v[144:145], v[232:233], v[10:11] op_sel:[0,0,0] op_sel_hi:[1,0,1]
    v_pk_mul_f32 v[8:9], v[146:147], v[232:233] op_sel:[0,1] op_sel_hi:[1,1] neg_lo:[0,1] neg_hi:[0,1]
    v_pk_mul_f32 v[10:11], v[130:131], v[232:233] op_sel:[0,1] op_sel_hi:[1,1]
    v_pk_fma_f32 v[130:131], v[130:131], v[232:233], v[8:9] op_sel:[0,0,0] op_sel_hi:[1,0,1]
    v_pk_fma_f32 v[146:147], v[146:147], v[232:233], v[10:11] op_sel:[0,0,0] op_sel_hi:[1,0,1]
    v_pk_mul_f32 v[8:9], v[164:165], v[232:233] op_sel:[0,1] op_sel_hi:[1,1] neg_lo:[0,1] neg_hi:[0,1]
    v_pk_mul_f32 v[10:11], v[148:149], v[232:233] op_sel:[0,1] op_sel_hi:[1,1]
    v_pk_fma_f32 v[148:149], v[148:149], v[232:233], v[8:9] op_sel:[0,0,0] op_sel_hi:[1,0,1]
    v_pk_fma_f32 v[164:165], v[164:165], v[232:233], v[10:11] op_sel:[0,0,0] op_sel_hi:[1,0,1]
    v_pk_mul_f32 v[8:9], v[166:167], v[232:233] op_sel:[0,1] op_sel_hi:[1,1] neg_lo:[0,1] neg_hi:[0,1]
    v_pk_mul_f32 v[10:11], v[150:151], v[232:233] op_sel:[0,1] op_sel_hi:[1,1]
    v_pk_fma_f32 v[150:151], v[150:151], v[232:233], v[8:9] op_sel:[0,0,0] op_sel_hi:[1,0,1]
    v_pk_fma_f32 v[166:167], v[166:167], v[232:233], v[10:11] op_sel:[0,0,0] op_sel_hi:[1,0,1]
    v_pk_mul_f32 v[8:9], v[168:169], v[232:233] op_sel:[0,1] op_sel_hi:[1,1] neg_lo:[0,1] neg_hi:[0,1]
    v_pk_mul_f32 v[10:11], v[152:153], v[232:233] op_sel:[0,1] op_sel_hi:[1,1]
    v_pk_fma_f32 v[152:153], v[152:153], v[232:233], v[8:9] op_sel:[0,0,0] op_sel_hi:[1,0,1]
    v_pk_fma_f32 v[168:169], v[168:169], v[232:233], v[10:11] op_sel:[0,0,0] op_sel_hi:[1,0,1]
    v_pk_mul_f32 v[8:9], v[170:171], v[232:233] op_sel:[0,1] op_sel_hi:[1,1] neg_lo:[0,1] neg_hi:[0,1]
    v_pk_mul_f32 v[10:11], v[154:155], v[232:233] op_sel:[0,1] op_sel_hi:[1,1]
    v_pk_fma_f32 v[154:155], v[154:155], v[232:233], v[8:9] op_sel:[0,0,0] op_sel_hi:[1,0,1]
    v_pk_fma_f32 v[170:171], v[170:171], v[232:233], v[10:11] op_sel:[0,0,0] op_sel_hi:[1,0,1]
    v_pk_mul_f32 v[8:9], v[172:173], v[232:233] op_sel:[0,1] op_sel_hi:[1,1] neg_lo:[0,1] neg_hi:[0,1]
    v_pk_mul_f32 v[10:11], v[156:157], v[232:233] op_sel:[0,1] op_sel_hi:[1,1]
    v_pk_fma_f32 v[156:157], v[156:157], v[232:233], v[8:9] op_sel:[0,0,0] op_sel_hi:[1,0,1]
    v_pk_fma_f32 v[172:173], v[172:173], v[232:233], v[10:11] op_sel:[0,0,0] op_sel_hi:[1,0,1]
    v_pk_mul_f32 v[8:9], v[174:175], v[232:233] op_sel:[0,1] op_sel_hi:[1,1] neg_lo:[0,1] neg_hi:[0,1]
    v_pk_mul_f32 v[10:11], v[158:159], v[232:233] op_sel:[0,1] op_sel_hi:[1,1]
    v_pk_fma_f32 v[158:159], v[158:159], v[232:233], v[8:9] op_sel:[0,0,0] op_sel_hi:[1,0,1]
    v_pk_fma_f32 v[174:175], v[174:175], v[232:233], v[10:11] op_sel:[0,0,0] op_sel_hi:[1,0,1]
    v_pk_mul_f32 v[8:9], v[176:177], v[232:233] op_sel:[0,1] op_sel_hi:[1,1] neg_lo:[0,1] neg_hi:[0,1]
    v_pk_mul_f32 v[10:11], v[160:161], v[232:233] op_sel:[0,1] op_sel_hi:[1,1]
    v_pk_fma_f32 v[160:161], v[160:161], v[232:233], v[8:9] op_sel:[0,0,0] op_sel_hi:[1,0,1]
    v_pk_fma_f32 v[176:177], v[176:177], v[232:233], v[10:11] op_sel:[0,0,0] op_sel_hi:[1,0,1]
    v_pk_mul_f32 v[8:9], v[178:179], v[232:233] op_sel:[0,1] op_sel_hi:[1,1] neg_lo:[0,1] neg_hi:[0,1]
    v_pk_mul_f32 v[10:11], v[162:163], v[232:233] op_sel:[0,1] op_sel_hi:[1,1]
    v_pk_fma_f32 v[162:163], v[162:163], v[232:233], v[8:9] op_sel:[0,0,0] op_sel_hi:[1,0,1]
    v_pk_fma_f32 v[178:179], v[178:179], v[232:233], v[10:11] op_sel:[0,0,0] op_sel_hi:[1,0,1]
    s_lshr_b32 s16, s42, 1
    v_lshrrev_b32 v78, 5, v1
    v_lshlrev_b32 v78, 13, v78
    v_lshl_add_u32 v13, v7, 2, v78
    s_lshl_b32 s3, s16, 14
    s_add_u32 s3, s3, 0
    v_add_u32 v13, s3, v13
    v_lshrrev_b32 v78, 4, v1
    v_lshlrev_b32 v78, 4, v78
    v_bfe_u32 v79, v1, 3, 1
    v_add_u32 v78, v78, v79
    v_and_b32 v65, 7, v1
    v_xor_b32 v79, v79, v65
    s_and_b32 s3, s42, 1
    s_lshl_b32 s3, s3, 3
    v_or_b32 v79, s3, v79
    v_lshlrev_b32 v79, 4, v79
    v_lshl_add_u32 v19, v78, 8, v79
    s_lshl_b32 s3, s16, 14
    s_add_u32 s3, s3, 0
    v_add_u32 v19, s3, v19
    v_lshlrev_b32 v65, 4, v65
    v_lshl_add_u32 v65, v78, 12, v65
    s_lshl_b32 s13, s43, 19
    s_lshl_b32 s3, s16, 18
    s_add_u32 s13, s13, s3
    s_lshl_b32 s3, s44, 8
    s_add_u32 s13, s13, s3
    s_and_b32 s3, s42, 1
    s_lshl_b32 s3, s3, 7
    s_add_u32 s13, s13, s3
    s_waitcnt vmcnt(13)
    ds_write_b128 v63, v[36:39] offset:0
    v_alignbit_b32 v48, v37, v36, 16
    v_alignbit_b32 v49, v38, v37, 16
    v_alignbit_b32 v50, v39, v38, 16
    s_waitcnt vmcnt(12)
    v_alignbit_b32 v51, v46, v39, 16
    v_pk_mov_b32 v[52:53], v[36:37], v[38:39] op_sel:[1,0]
    v_pk_mov_b32 v[54:55], v[38:39], v[46:47] op_sel:[1,0]
    ds_write_b128 v63, v[48:51] offset:4160
    v_pk_mov_b32 v[56:57], v[48:49], v[50:51] op_sel:[1,0]
    v_mov_b32 v58, v51
    v_alignbit_b32 v59, v47, v46, 16
    ds_write_b128 v63, v[52:55] offset:8320
    ds_write_b128 v63, v[56:59] offset:12480
    s_waitcnt vmcnt(11)
    ds_write_b128 v63, v[20:23] offset:32
    v_alignbit_b32 v48, v21, v20, 16
    v_alignbit_b32 v49, v22, v21, 16
    v_alignbit_b32 v50, v23, v22, 16
    s_waitcnt vmcnt(10)
    v_alignbit_b32 v51, v16, v23, 16
    v_pk_mov_b32 v[52:53], v[20:21], v[22:23] op_sel:[1,0]
    v_pk_mov_b32 v[54:55], v[22:23], v[16:17] op_sel:[1,0]
    ds_write_b128 v63, v[48:51] offset:4192
    v_pk_mov_b32 v[56:57], v[48:49], v[50:51] op_sel:[1,0]
    v_mov_b32 v58, v51
    v_alignbit_b32 v59, v17, v16, 16
    ds_write_b128 v63, v[52:55] offset:8352
    ds_write_b128 v63, v[56:59] offset:12512
    v_subrev_u32 v66, 0, v12
    v_min_u32 v66, 0x7fff0000, v66
    buffer_load_dwordx4 v[66:69], v66, s[48:51], 0 offen sc0 sc1
    v_subrev_u32 v70, 2048, v12
    v_min_u32 v70, 0x7fff0000, v70
    buffer_load_dwordx4 v[70:73], v70, s[48:51], 0 offen sc0 sc1
    v_subrev_u32 v74, 4096, v12
    v_min_u32 v74, 0x7fff0000, v74
    buffer_load_dwordx4 v[74:77], v74, s[48:51], 0 offen sc0 sc1
    v_subrev_u32 v90, 6144, v12
    v_min_u32 v90, 0x7fff0000, v90
    buffer_load_dwordx4 v[90:93], v90, s[48:51], 0 offen sc0 sc1
    v_subrev_u32 v94, 8192, v12
    v_min_u32 v94, 0x7fff0000, v94
    buffer_load_dwordx4 v[94:97], v94, s[48:51], 0 offen sc0 sc1
    v_subrev_u32 v98, 10240, v12
    v_min_u32 v98, 0x7fff0000, v98
    buffer_load_dwordx4 v[98:101], v98, s[48:51], 0 offen sc0 sc1
    v_subrev_u32 v102, 12288, v12
    v_min_u32 v102, 0x7fff0000, v102
    buffer_load_dwordx4 v[102:105], v102, s[48:51], 0 offen sc0 sc1
    v_subrev_u32 v106, 14336, v12
    v_min_u32 v106, 0x7fff0000, v106
    buffer_load_dwordx4 v[106:109], v106, s[48:51], 0 offen sc0 sc1
    s_waitcnt vmcnt(17)
    ds_write_b128 v63, v[24:27] offset:1056
    v_alignbit_b32 v48, v25, v24, 16
    v_alignbit_b32 v49, v26, v25, 16
    v_alignbit_b32 v50, v27, v26, 16
    s_waitcnt vmcnt(16)
    v_alignbit_b32 v51, v40, v27, 16
    v_pk_mov_b32 v[52:53], v[24:25], v[26:27] op_sel:[1,0]
    v_pk_mov_b32 v[54:55], v[26:27], v[40:41] op_sel:[1,0]
    ds_write_b128 v63, v[48:51] offset:5216
    v_pk_mov_b32 v[56:57], v[48:49], v[50:51] op_sel:[1,0]
    v_mov_b32 v58, v51
    v_alignbit_b32 v59, v41, v40, 16
    ds_write_b128 v63, v[52:55] offset:9376
    ds_write_b128 v63, v[56:59] offset:13536
    s_waitcnt vmcnt(15)
    ds_write_b128 v63, v[28:31] offset:2080
    v_alignbit_b32 v48, v29, v28, 16
    v_alignbit_b32 v49, v30, v29, 16
    v_alignbit_b32 v50, v31, v30, 16
    s_waitcnt vmcnt(14)
    v_alignbit_b32 v51, v42, v31, 16
    v_pk_mov_b32 v[52:53], v[28:29], v[30:31] op_sel:[1,0]
    v_pk_mov_b32 v[54:55], v[30:31], v[42:43] op_sel:[1,0]
    ds_write_b128 v63, v[48:51] offset:6240
    v_pk_mov_b32 v[56:57], v[48:49], v[50:51] op_sel:[1,0]
    v_mov_b32 v58, v51
    v_alignbit_b32 v59, v43, v42, 16
    ds_write_b128 v63, v[52:55] offset:10400
    ds_write_b128 v63, v[56:59] offset:14560
    s_waitcnt vmcnt(13)
    ds_write_b128 v63, v[32:35] offset:3104
    v_alignbit_b32 v48, v33, v32, 16
    v_alignbit_b32 v49, v34, v33, 16
    v_alignbit_b32 v50, v35, v34, 16
    s_waitcnt vmcnt(12)
    v_alignbit_b32 v51, v44, v35, 16
    v_pk_mov_b32 v[52:53], v[32:33], v[34:35] op_sel:[1,0]
    v_pk_mov_b32 v[54:55], v[34:35], v[44:45] op_sel:[1,0]
    ds_write_b128 v63, v[48:51] offset:7264
    v_pk_mov_b32 v[56:57], v[48:49], v[50:51] op_sel:[1,0]
    v_mov_b32 v58, v51
    v_alignbit_b32 v59, v45, v44, 16
    ds_write_b128 v63, v[52:55] offset:11424
    ds_write_b128 v63, v[56:59] offset:15584
    v_lshlrev_b32 v82, 16, v82
    s_mov_b32 s18, 0
    s_waitcnt vmcnt(8)
    v_cmp_ne_u64 vcc, s[22:23], v[182:183]
    s_nop 4
    s_cbranch_vccz Lfdone_gate_5
Lfpoll_gate_6:
    buffer_load_dwordx2 v[182:183], v81, s[8:11], 0 offen sc0 sc1
    s_waitcnt vmcnt(0)
    v_cmp_ne_u64 vcc, s[22:23], v[182:183]
    s_nop 4
    s_add_u32 s18, s18, 1
    s_cmp_gt_u32 s18, 20000
    s_cbranch_scc1 Lfdone_gate_5
    s_cbranch_vccnz Lfpoll_gate_6
Lfdone_gate_5:
    s_mov_b32 m0, s39
    s_nop 0
    buffer_load_dwordx4 v181, s[8:11], s38 offen offset:0 sc0 sc1 lds
    buffer_load_dwordx4 v181, s[8:11], s38 offen offset:1024 sc0 sc1 lds
    buffer_load_dwordx4 v181, s[8:11], s38 offen offset:2048 sc0 sc1 lds
    buffer_load_dwordx4 v181, s[8:11], s38 offen offset:3072 sc0 sc1 lds
    s_mov_b32 s16, 0
    v_mov_b32 v16, 0
    s_waitcnt vmcnt(11)
    v_cmp_eq_u64 s[60:61], s[22:23], v[68:69]
    s_waitcnt vmcnt(10)
    v_cmp_eq_u64 s[62:63], s[22:23], v[72:73]
    s_waitcnt vmcnt(9)
    v_cmp_eq_u64 s[64:65], s[22:23], v[76:77]
    s_waitcnt vmcnt(8)
    v_cmp_eq_u64 s[66:67], s[22:23], v[92:93]
    v_addc_co_u32 v16, vcc, 0, v16, s[60:61]
    v_addc_co_u32 v16, vcc, 0, v16, s[62:63]
    v_addc_co_u32 v16, vcc, 0, v16, s[64:65]
    v_addc_co_u32 v16, vcc, 0, v16, s[66:67]
    s_waitcnt vmcnt(7)
    v_cmp_eq_u64 s[60:61], s[22:23], v[96:97]
    s_waitcnt vmcnt(6)
    v_cmp_eq_u64 s[62:63], s[22:23], v[100:101]
    s_waitcnt vmcnt(5)
    v_cmp_eq_u64 s[64:65], s[22:23], v[104:105]
    s_waitcnt vmcnt(4)
    v_cmp_eq_u64 s[66:67], s[22:23], v[108:109]
    v_addc_co_u32 v16, vcc, 0, v16, s[60:61]
    v_addc_co_u32 v16, vcc, 0, v16, s[62:63]
    v_addc_co_u32 v16, vcc, 0, v16, s[64:65]
    v_addc_co_u32 v16, vcc, 0, v16, s[66:67]
    v_cmp_ne_u32 vcc, v18, v16
    s_nop 4
    s_cbranch_vccz Lpolldone_gate_7
Lpoll_gate_8:
    v_subrev_u32 v66, 0, v12
    v_min_u32 v66, 0x7fff0000, v66
    buffer_load_dwordx4 v[66:69], v66, s[48:51], 0 offen sc0 sc1
    v_subrev_u32 v70, 2048, v12
    v_min_u32 v70, 0x7fff0000, v70
    buffer_load_dwordx4 v[70:73], v70, s[48:51], 0 offen sc0 sc1
    v_subrev_u32 v74, 4096, v12
    v_min_u32 v74, 0x7fff0000, v74
    buffer_load_dwordx4 v[74:77], v74, s[48:51], 0 offen sc0 sc1
    v_subrev_u32 v90, 6144, v12
    v_min_u32 v90, 0x7fff0000, v90
    buffer_load_dwordx4 v[90:93], v90, s[48:51], 0 offen sc0 sc1
    v_subrev_u32 v94, 8192, v12
    v_min_u32 v94, 0x7fff0000, v94
    buffer_load_dwordx4 v[94:97], v94, s[48:51], 0 offen sc0 sc1
    v_subrev_u32 v98, 10240, v12
    v_min_u32 v98, 0x7fff0000, v98
    buffer_load_dwordx4 v[98:101], v98, s[48:51], 0 offen sc0 sc1
    v_subrev_u32 v102, 12288, v12
    v_min_u32 v102, 0x7fff0000, v102
    buffer_load_dwordx4 v[102:105], v102, s[48:51], 0 offen sc0 sc1
    v_subrev_u32 v106, 14336, v12
    v_min_u32 v106, 0x7fff0000, v106
    buffer_load_dwordx4 v[106:109], v106, s[48:51], 0 offen sc0 sc1
    s_waitcnt vmcnt(0) lgkmcnt(0)
    v_mov_b32 v16, 0
    v_cmp_eq_u64 s[60:61], s[22:23], v[68:69]
    v_cmp_eq_u64 s[62:63], s[22:23], v[72:73]
    v_cmp_eq_u64 s[64:65], s[22:23], v[76:77]
    v_cmp_eq_u64 s[66:67], s[22:23], v[92:93]
    v_addc_co_u32 v16, vcc, 0, v16, s[60:61]
    v_addc_co_u32 v16, vcc, 0, v16, s[62:63]
    v_addc_co_u32 v16, vcc, 0, v16, s[64:65]
    v_addc_co_u32 v16, vcc, 0, v16, s[66:67]
    v_cmp_eq_u64 s[60:61], s[22:23], v[96:97]
    v_cmp_eq_u64 s[62:63], s[22:23], v[100:101]
    v_cmp_eq_u64 s[64:65], s[22:23], v[104:105]
    v_cmp_eq_u64 s[66:67], s[22:23], v[108:109]
    v_addc_co_u32 v16, vcc, 0, v16, s[60:61]
    v_addc_co_u32 v16, vcc, 0, v16, s[62:63]
    v_addc_co_u32 v16, vcc, 0, v16, s[64:65]
    v_addc_co_u32 v16, vcc, 0, v16, s[66:67]
    v_cmp_ne_u32 vcc, v18, v16
    s_add_u32 s16, s16, 1
    s_cmp_gt_u32 s16, 20000
    s_cbranch_scc1 Lpolldone_gate_7
    s_nop 1
    s_cbranch_vccnz Lpoll_gate_8
Lpolldone_gate_7:
    s_nop 4
    v_fma_f32 v20, -v15, v107, v102
    v_fma_f32 v21, v15, v106, v103
    v_fma_f32 v102, v14, v106, v20
    v_fma_f32 v103, v14, v107, v21
    v_fma_f32 v20, -v15, v103, v98
    v_fma_f32 v21, v15, v102, v99
    v_fma_f32 v98, v14, v102, v20
    v_fma_f32 v99, v14, v103, v21
    v_fma_f32 v20, -v15, v99, v94
    v_fma_f32 v21, v15, v98, v95
    v_fma_f32 v94, v14, v98, v20
    v_fma_f32 v95, v14, v99, v21
    v_fma_f32 v20, -v15, v95, v90
    v_fma_f32 v21, v15, v94, v91
    v_fma_f32 v90, v14, v94, v20
    v_fma_f32 v91, v14, v95, v21
    v_fma_f32 v20, -v15, v91, v74
    v_fma_f32 v21, v15, v90, v75
    v_fma_f32 v74, v14, v90, v20
    v_fma_f32 v75, v14, v91, v21
    v_fma_f32 v20, -v15, v75, v70
    v_fma_f32 v21, v15, v74, v71
    v_fma_f32 v70, v14, v74, v20
    v_fma_f32 v71, v14, v75, v21
    v_fma_f32 v20, -v15, v71, v66
    v_fma_f32 v21, v15, v70, v67
    v_fma_f32 v66, v14, v70, v20
    v_fma_f32 v67, v14, v71, v21
    v_mov_b32 v70, v66
    v_mov_b32 v71, v67
    s_nop 0
    v_permlane32_swap_b32 v66, v70
    v_permlane32_swap_b32 v67, v71
    v_fma_f32 v20, -v237, v71, v66
    v_fma_f32 v21, v237, v70, v67
    v_fma_f32 v22, v236, v70, v20
    v_fma_f32 v23, v236, v71, v21
    buffer_load_dwordx2 v[4:5], v3, s[8:11], 0 offen sc0 sc1
    v_pk_fma_f32 v[8:9], v[240:241], v[22:23], v[86:87] op_sel:[0,1,0] op_sel_hi:[1,1,1] neg_lo:[0,1,0] neg_hi:[0,1,0]
    v_pk_fma_f32 v[10:11], v[238:239], v[22:23], v[88:89] op_sel:[0,1,0] op_sel_hi:[1,1,1]
    v_pk_fma_f32 v[14:15], v[238:239], v[22:23], v[8:9] op_sel:[0,0,0] op_sel_hi:[1,0,1]
    v_pk_fma_f32 v[16:17], v[240:241], v[22:23], v[10:11] op_sel:[0,0,0] op_sel_hi:[1,0,1]
    v_pk_mul_f32 v[8:9], v[16:17], v[232:233] op_sel:[0,1] op_sel_hi:[1,1] neg_lo:[0,1] neg_hi:[0,1]
    v_pk_mul_f32 v[10:11], v[14:15], v[232:233] op_sel:[0,1] op_sel_hi:[1,1]
    v_pk_fma_f32 v[14:15], v[14:15], v[232:233], v[8:9] op_sel:[0,0,0] op_sel_hi:[1,0,1]
    v_pk_fma_f32 v[16:17], v[16:17], v[232:233], v[10:11] op_sel:[0,0,0] op_sel_hi:[1,0,1]
    v_pk_fma_f32 v[8:9], v[16:17], v[230:231], v[116:117] op_sel:[0,1,0] op_sel_hi:[1,1,1] neg_lo:[0,1,0] neg_hi:[0,1,0]
    v_pk_fma_f32 v[10:11], v[14:15], v[230:231], v[132:133] op_sel:[0,1,0] op_sel_hi:[1,1,1]
    v_pk_fma_f32 v[116:117], v[14:15], v[230:231], v[8:9] op_sel:[0,0,0] op_sel_hi:[1,0,1]
    v_pk_fma_f32 v[132:133], v[16:17], v[230:231], v[10:11] op_sel:[0,0,0] op_sel_hi:[1,0,1]
    v_pk_fma_f32 v[8:9], v[132:133], v[230:231], v[118:119] op_sel:[0,1,0] op_sel_hi:[1,1,1] neg_lo:[0,1,0] neg_hi:[0,1,0]
    v_pk_fma_f32 v[10:11], v[116:117], v[230:231], v[134:135] op_sel:[0,1,0] op_sel_hi:[1,1,1]
    v_pk_fma_f32 v[118:119], v[116:117], v[230:231], v[8:9] op_sel:[0,0,0] op_sel_hi:[1,0,1]
    v_pk_fma_f32 v[134:135], v[132:133], v[230:231], v[10:11] op_sel:[0,0,0] op_sel_hi:[1,0,1]
    v_cvt_pk_bf16_f32 v20, v116, -v132
    v_cvt_pk_bf16_f32 v21, v117, -v133
    ds_write2st64_b32 v13, v20, v21 offset0:0 offset1:16
    v_pk_fma_f32 v[8:9], v[134:135], v[230:231], v[120:121] op_sel:[0,1,0] op_sel_hi:[1,1,1] neg_lo:[0,1,0] neg_hi:[0,1,0]
    v_pk_fma_f32 v[10:11], v[118:119], v[230:231], v[136:137] op_sel:[0,1,0] op_sel_hi:[1,1,1]
    v_pk_fma_f32 v[120:121], v[118:119], v[230:231], v[8:9] op_sel:[0,0,0] op_sel_hi:[1,0,1]
    v_pk_fma_f32 v[136:137], v[134:135], v[230:231], v[10:11] op_sel:[0,0,0] op_sel_hi:[1,0,1]
    v_xor_b32 v12, 16, v13
    v_cvt_pk_bf16_f32 v24, v118, -v134
    v_cvt_pk_bf16_f32 v25, v119, -v135
    ds_write2st64_b32 v12, v24, v25 offset0:1 offset1:17
    ds_read_b128 v[28:31], v19 offset:0
    v_pk_fma_f32 v[8:9], v[136:137], v[230:231], v[122:123] op_sel:[0,1,0] op_sel_hi:[1,1,1] neg_lo:[0,1,0] neg_hi:[0,1,0]
    v_pk_fma_f32 v[10:11], v[120:121], v[230:231], v[138:139] op_sel:[0,1,0] op_sel_hi:[1,1,1]
    v_pk_fma_f32 v[122:123], v[120:121], v[230:231], v[8:9] op_sel:[0,0,0] op_sel_hi:[1,0,1]
    v_pk_fma_f32 v[138:139], v[136:137], v[230:231], v[10:11] op_sel:[0,0,0] op_sel_hi:[1,0,1]
    v_xor_b32 v2, 32, v13
    v_cvt_pk_bf16_f32 v20, v120, -v136
    v_cvt_pk_bf16_f32 v21, v121, -v137
    ds_write2st64_b32 v2, v20, v21 offset0:2 offset1:18
    s_waitcnt lgkmcnt(1)
    buffer_store_dwordx4 v[28:31], v65, s[8:11], s13 offen sc0 sc1
    v_pk_fma_f32 v[8:9], v[138:139], v[230:231], v[124:125] op_sel:[0,1,0] op_sel_hi:[1,1,1] neg_lo:[0,1,0] neg_hi:[0,1,0]
    v_pk_fma_f32 v[10:11], v[122:123], v[230:231], v[140:141] op_sel:[0,1,0] op_sel_hi:[1,1,1]
    v_pk_fma_f32 v[124:125], v[122:123], v[230:231], v[8:9] op_sel:[0,0,0] op_sel_hi:[1,0,1]
    v_pk_fma_f32 v[140:141], v[138:139], v[230:231], v[10:11] op_sel:[0,0,0] op_sel_hi:[1,0,1]
    v_xor_b32 v12, 48, v13
    v_cvt_pk_bf16_f32 v24, v122, -v138
    v_cvt_pk_bf16_f32 v25, v123, -v139
    ds_write2st64_b32 v12, v24, v25 offset0:3 offset1:19
    v_xor_b32 v18, 32, v19
    ds_read_b128 v[32:35], v18 offset:512
    v_pk_fma_f32 v[8:9], v[140:141], v[230:231], v[126:127] op_sel:[0,1,0] op_sel_hi:[1,1,1] neg_lo:[0,1,0] neg_hi:[0,1,0]
    v_pk_fma_f32 v[10:11], v[124:125], v[230:231], v[142:143] op_sel:[0,1,0] op_sel_hi:[1,1,1]
    v_pk_fma_f32 v[126:127], v[124:125], v[230:231], v[8:9] op_sel:[0,0,0] op_sel_hi:[1,0,1]
    v_pk_fma_f32 v[142:143], v[140:141], v[230:231], v[10:11] op_sel:[0,0,0] op_sel_hi:[1,0,1]
    v_xor_b32 v2, 64, v13
    v_cvt_pk_bf16_f32 v20, v124, -v140
    v_cvt_pk_bf16_f32 v21, v125, -v141
    ds_write2st64_b32 v2, v20, v21 offset0:4 offset1:20
    s_add_u32 s13, s13, 8192
    s_waitcnt lgkmcnt(1)
    buffer_store_dwordx4 v[32:35], v65, s[8:11], s13 offen sc0 sc1
    v_pk_fma_f32 v[8:9], v[142:143], v[230:231], v[128:129] op_sel:[0,1,0] op_sel_hi:[1,1,1] neg_lo:[0,1,0] neg_hi:[0,1,0]
    v_pk_fma_f32 v[10:11], v[126:127], v[230:231], v[144:145] op_sel:[0,1,0] op_sel_hi:[1,1,1]
    v_pk_fma_f32 v[128:129], v[126:127], v[230:231], v[8:9] op_sel:[0,0,0] op_sel_hi:[1,0,1]
    v_pk_fma_f32 v[144:145], v[142:143], v[230:231], v[10:11] op_sel:[0,0,0] op_sel_hi:[1,0,1]
    v_xor_b32 v12, 80, v13
    v_cvt_pk_bf16_f32 v24, v126, -v142
    v_cvt_pk_bf16_f32 v25, v127, -v143
    ds_write2st64_b32 v12, v24, v25 offset0:5 offset1:21
    v_xor_b32 v18, 64, v19
    ds_read_b128 v[28:31], v18 offset:1024
    v_pk_fma_f32 v[8:9], v[144:145], v[230:231], v[130:131] op_sel:[0,1,0] op_sel_hi:[1,1,1] neg_lo:[0,1,0] neg_hi:[0,1,0]
    v_pk_fma_f32 v[10:11], v[128:129], v[230:231], v[146:147] op_sel:[0,1,0] op_sel_hi:[1,1,1]
    v_pk_fma_f32 v[130:131], v[128:129], v[230:231], v[8:9] op_sel:[0,0,0] op_sel_hi:[1,0,1]
    v_pk_fma_f32 v[146:147], v[144:145], v[230:231], v[10:11] op_sel:[0,0,0] op_sel_hi:[1,0,1]
    v_xor_b32 v2, 96, v13
    v_cvt_pk_bf16_f32 v20, v128, -v144
    v_cvt_pk_bf16_f32 v21, v129, -v145
    ds_write2st64_b32 v2, v20, v21 offset0:6 offset1:22
    s_add_u32 s13, s13, 8192
    s_waitcnt lgkmcnt(1)
    buffer_store_dwordx4 v[28:31], v65, s[8:11], s13 offen sc0 sc1
    v_pk_fma_f32 v[8:9], v[146:147], v[230:231], v[148:149] op_sel:[0,1,0] op_sel_hi:[1,1,1] neg_lo:[0,1,0] neg_hi:[0,1,0]
    v_pk_fma_f32 v[10:11], v[130:131], v[230:231], v[164:165] op_sel:[0,1,0] op_sel_hi:[1,1,1]
    v_pk_fma_f32 v[148:149], v[130:131], v[230:231], v[8:9] op_sel:[0,0,0] op_sel_hi:[1,0,1]
    v_pk_fma_f32 v[164:165], v[146:147], v[230:231], v[10:11] op_sel:[0,0,0] op_sel_hi:[1,0,1]
    v_xor_b32 v12, 112, v13
    v_cvt_pk_bf16_f32 v24, v130, -v146
    v_cvt_pk_bf16_f32 v25, v131, -v147
    ds_write2st64_b32 v12, v24, v25 offset0:7 offset1:23
    v_xor_b32 v18, 96, v19
    ds_read_b128 v[32:35], v18 offset:1536
    v_pk_fma_f32 v[8:9], v[164:165], v[230:231], v[150:151] op_sel:[0,1,0] op_sel_hi:[1,1,1] neg_lo:[0,1,0] neg_hi:[0,1,0]
    v_pk_fma_f32 v[10:11], v[148:149], v[230:231], v[166:167] op_sel:[0,1,0] op_sel_hi:[1,1,1]
    v_pk_fma_f32 v[150:151], v[148:149], v[230:231], v[8:9] op_sel:[0,0,0] op_sel_hi:[1,0,1]
    v_pk_fma_f32 v[166:167], v[164:165], v[230:231], v[10:11] op_sel:[0,0,0] op_sel_hi:[1,0,1]
    v_xor_b32 v2, 128, v13
    v_cvt_pk_bf16_f32 v20, v148, -v164
    v_cvt_pk_bf16_f32 v21, v149, -v165
    ds_write2st64_b32 v2, v20, v21 offset0:8 offset1:24
    s_add_u32 s13, s13, 8192
    s_waitcnt lgkmcnt(1)
    buffer_store_dwordx4 v[32:35], v65, s[8:11], s13 offen sc0 sc1
    v_pk_fma_f32 v[8:9], v[166:167], v[230:231], v[152:153] op_sel:[0,1,0] op_sel_hi:[1,1,1] neg_lo:[0,1,0] neg_hi:[0,1,0]
    v_pk_fma_f32 v[10:11], v[150:151], v[230:231], v[168:169] op_sel:[0,1,0] op_sel_hi:[1,1,1]
    v_pk_fma_f32 v[152:153], v[150:151], v[230:231], v[8:9] op_sel:[0,0,0] op_sel_hi:[1,0,1]
    v_pk_fma_f32 v[168:169], v[166:167], v[230:231], v[10:11] op_sel:[0,0,0] op_sel_hi:[1,0,1]
    v_xor_b32 v12, 144, v13
    v_cvt_pk_bf16_f32 v24, v150, -v166
    v_cvt_pk_bf16_f32 v25, v151, -v167
    ds_write2st64_b32 v12, v24, v25 offset0:9 offset1:25
    v_xor_b32 v18, 128, v19
    ds_read_b128 v[28:31], v18 offset:2048
    v_pk_fma_f32 v[8:9], v[168:169], v[230:231], v[154:155] op_sel:[0,1,0] op_sel_hi:[1,1,1] neg_lo:[0,1,0] neg_hi:[0,1,0]
    v_pk_fma_f32 v[10:11], v[152:153], v[230:231], v[170:171] op_sel:[0,1,0] op_sel_hi:[1,1,1]
    v_pk_fma_f32 v[154:155], v[152:153], v[230:231], v[8:9] op_sel:[0,0,0] op_sel_hi:[1,0,1]
    v_pk_fma_f32 v[170:171], v[168:169], v[230:231], v[10:11] op_sel:[0,0,0] op_sel_hi:[1,0,1]
    v_xor_b32 v2, 160, v13
    v_cvt_pk_bf16_f32 v20, v152, -v168
    v_cvt_pk_bf16_f32 v21, v153, -v169
    ds_write2st64_b32 v2, v20, v21 offset0:10 offset1:26
    s_add_u32 s13, s13, 8192
    s_waitcnt lgkmcnt(1)
    buffer_store_dwordx4 v[28:31], v65, s[8:11], s13 offen sc0 sc1
    v_pk_fma_f32 v[8:9], v[170:171], v[230:231], v[156:157] op_sel:[0,1,0] op_sel_hi:[1,1,1] neg_lo:[0,1,0] neg_hi:[0,1,0]
    v_pk_fma_f32 v[10:11], v[154:155], v[230:231], v[172:173] op_sel:[0,1,0] op_sel_hi:[1,1,1]
    v_pk_fma_f32 v[156:157], v[154:155], v[230:231], v[8:9] op_sel:[0,0,0] op_sel_hi:[1,0,1]
    v_pk_fma_f32 v[172:173], v[170:171], v[230:231], v[10:11] op_sel:[0,0,0] op_sel_hi:[1,0,1]
    v_xor_b32 v12, 176, v13
    v_cvt_pk_bf16_f32 v24, v154, -v170
    v_cvt_pk_bf16_f32 v25, v155, -v171
    ds_write2st64_b32 v12, v24, v25 offset0:11 offset1:27
    v_xor_b32 v18, 160, v19
    ds_read_b128 v[32:35], v18 offset:2560
    v_pk_fma_f32 v[8:9], v[172:173], v[230:231], v[158:159] op_sel:[0,1,0] op_sel_hi:[1,1,1] neg_lo:[0,1,0] neg_hi:[0,1,0]
    v_pk_fma_f32 v[10:11], v[156:157], v[230:231], v[174:175] op_sel:[0,1,0] op_sel_hi:[1,1,1]
    v_pk_fma_f32 v[158:159], v[156:157], v[230:231], v[8:9] op_sel:[0,0,0] op_sel_hi:[1,0,1]
    v_pk_fma_f32 v[174:175], v[172:173], v[230:231], v[10:11] op_sel:[0,0,0] op_sel_hi:[1,0,1]
    v_xor_b32 v2, 192, v13
    v_cvt_pk_bf16_f32 v20, v156, -v172
    v_cvt_pk_bf16_f32 v21, v157, -v173
    ds_write2st64_b32 v2, v20, v21 offset0:12 offset1:28
    s_add_u32 s13, s13, 8192
    s_waitcnt lgkmcnt(1)
    buffer_store_dwordx4 v[32:35], v65, s[8:11], s13 offen sc0 sc1
    v_pk_fma_f32 v[8:9], v[174:175], v[230:231], v[160:161] op_sel:[0,1,0] op_sel_hi:[1,1,1] neg_lo:[0,1,0] neg_hi:[0,1,0]
    v_pk_fma_f32 v[10:11], v[158:159], v[230:231], v[176:177] op_sel:[0,1,0] op_sel_hi:[1,1,1]
    v_pk_fma_f32 v[160:161], v[158:159], v[230:231], v[8:9] op_sel:[0,0,0] op_sel_hi:[1,0,1]
    v_pk_fma_f32 v[176:177], v[174:175], v[230:231], v[10:11] op_sel:[0,0,0] op_sel_hi:[1,0,1]
    v_xor_b32 v12, 208, v13
    v_cvt_pk_bf16_f32 v24, v158, -v174
    v_cvt_pk_bf16_f32 v25, v159, -v175
    ds_write2st64_b32 v12, v24, v25 offset0:13 offset1:29
    v_xor_b32 v18, 192, v19
    ds_read_b128 v[28:31], v18 offset:3072
    v_pk_fma_f32 v[8:9], v[176:177], v[230:231], v[162:163] op_sel:[0,1,0] op_sel_hi:[1,1,1] neg_lo:[0,1,0] neg_hi:[0,1,0]
    v_pk_fma_f32 v[10:11], v[160:161], v[230:231], v[178:179] op_sel:[0,1,0] op_sel_hi:[1,1,1]
    v_pk_fma_f32 v[162:163], v[160:161], v[230:231], v[8:9] op_sel:[0,0,0] op_sel_hi:[1,0,1]
    v_pk_fma_f32 v[178:179], v[176:177], v[230:231], v[10:11] op_sel:[0,0,0] op_sel_hi:[1,0,1]
    v_xor_b32 v2, 224, v13
    v_cvt_pk_bf16_f32 v20, v160, -v176
    v_cvt_pk_bf16_f32 v21, v161, -v177
    ds_write2st64_b32 v2, v20, v21 offset0:14 offset1:30
    s_add_u32 s13, s13, 8192
    s_waitcnt lgkmcnt(1)
    buffer_store_dwordx4 v[28:31], v65, s[8:11], s13 offen sc0 sc1
    v_xor_b32 v12, 240, v13
    v_cvt_pk_bf16_f32 v24, v162, -v178
    v_cvt_pk_bf16_f32 v25, v163, -v179
    ds_write2st64_b32 v12, v24, v25 offset0:15 offset1:31
    v_xor_b32 v18, 224, v19
    ds_read_b128 v[32:35], v18 offset:3584
    s_add_u32 s13, s13, 8192
    s_waitcnt lgkmcnt(0)
    buffer_store_dwordx4 v[32:35], v65, s[8:11], s13 offen sc0 sc1
    s_mov_b32 s4, 0
    s_waitcnt vmcnt(8)
    v_cmp_ne_u64 vcc, s[22:23], v[4:5]
    s_nop 4
    s_cbranch_vccz Lfdone_gate_9
Lfpoll_gate_10:
    buffer_load_dwordx2 v[4:5], v3, s[8:11], 0 offen sc0 sc1
    s_waitcnt vmcnt(0)
    v_cmp_ne_u64 vcc, s[22:23], v[4:5]
    s_nop 4
    s_add_u32 s4, s4, 1
    s_cmp_gt_u32 s4, 20000
    s_cbranch_scc1 Lfdone_gate_9
    s_cbranch_vccnz Lfpoll_gate_10
Lfdone_gate_9:
    s_barrier
    ds_read_b64 v[92:93], v186 offset:448
    ds_read_b64 v[94:95], v186 offset:456
    ds_read_b128 v[96:99], v187 offset:16128
    ds_read_b64 v[100:101], v186 offset:960
    ds_read_b64 v[102:103], v186 offset:968
    ds_read_b128 v[104:107], v187 offset:14080
    ds_read_b64 v[108:109], v186 offset:1472
    ds_read_b64 v[110:111], v186 offset:1480
    ds_read_b128 v[112:115], v187 offset:12032
    s_waitcnt lgkmcnt(1)
    v_mfma_f32_16x16x32_bf16 v[46:49], v[92:95], v[96:99], 0
    s_lshl_b32 s4, s43, 4
    s_add_u32 s4, s4, s44
    v_mfma_f32_16x16x32_bf16 v[50:53], v[100:103], v[96:99], 0
    ds_read_b64 v[116:117], v186 offset:1984
    ds_read_b64 v[118:119], v186 offset:1992
    v_mfma_f32_16x16x32_bf16 v[50:53], v[92:95], v[104:107], v[50:53]
    ds_read_b128 v[120:123], v187 offset:9984
    s_add_u32 s12, s6, s7
    v_mfma_f32_16x16x32_bf16 v[54:57], v[100:103], v[104:107], 0
    buffer_load_dwordx4 a[0:3], v60, s[8:11], s12 offen offset:0 sc0 sc1
    v_mfma_f32_16x16x32_bf16 v[54:57], v[108:111], v[96:99], v[54:57]
    s_lshl_b32 s4, s4, 2
    s_waitcnt lgkmcnt(3)
    v_mfma_f32_16x16x32_bf16 v[54:57], v[92:95], v[112:115], v[54:57]
    s_add_u32 s4, s4, s42
    s_lshl_b32 s4, s4, 3
    v_mfma_f32_16x16x32_bf16 v[66:69], v[108:111], v[104:107], 0
    buffer_load_dwordx4 a[4:7], v60, s[8:11], s12 offen offset:1024 sc0 sc1
    v_mfma_f32_16x16x32_bf16 v[66:69], v[100:103], v[112:115], v[66:69]
    s_add_u32 s4, s4, 21512192
    s_lshl_b32 s3, s43, 9
    v_mfma_f32_16x16x32_bf16 v[70:73], v[108:111], v[112:115], 0
    ds_read_b64 v[124:125], v186 offset:2496
    s_waitcnt lgkmcnt(1)
    v_mfma_f32_16x16x32_bf16 v[66:69], v[116:119], v[96:99], v[66:69]
    ds_read_b64 v[126:127], v186 offset:2504
    ds_read_b128 v[128:131], v187 offset:7936
    v_mfma_f32_16x16x32_bf16 v[66:69], v[92:95], v[120:123], v[66:69]
    buffer_load_dwordx4 a[8:11], v60, s[8:11], s12 offen offset:2048 sc0 sc1
    v_mfma_f32_16x16x32_bf16 v[70:73], v[116:119], v[104:107], v[70:73]
    s_add_u32 s3, s3, 21512192
    v_lshrrev_b32 v81, 1, v60
    v_mfma_f32_16x16x32_bf16 v[70:73], v[100:103], v[120:123], v[70:73]
    v_add_u32 v81, s3, v81
    v_lshrrev_b32 v7, 4, v1
    v_mfma_f32_16x16x32_bf16 v[74:77], v[116:119], v[112:115], 0
    v_and_b32 v8, 15, v1
    v_xor_b32 v8, v8, v7
    v_mfma_f32_16x16x32_bf16 v[74:77], v[108:111], v[120:123], v[74:77]
    v_lshlrev_b32 v8, 4, v8
    v_lshl_add_u32 v2, v7, 12, v8
    v_mfma_f32_16x16x32_bf16 v[84:87], v[116:119], v[120:123], 0
    buffer_load_dwordx4 a[12:15], v60, s[8:11], s12 offen offset:3072 sc0 sc1
    s_waitcnt lgkmcnt(0)
    v_mfma_f32_16x16x32_bf16 v[70:73], v[124:127], v[96:99], v[70:73]
    ds_read_b64 v[132:133], v186 offset:3008
    ds_read_b64 v[134:135], v186 offset:3016
    v_mfma_f32_16x16x32_bf16 v[70:73], v[92:95], v[128:131], v[70:73]
    ds_read_b128 v[136:139], v187 offset:5888
    v_xor_b32 v7, 64, v2
    v_mfma_f32_16x16x32_bf16 v[74:77], v[124:127], v[104:107], v[74:77]
    v_add_u32 v3, 16384, v7
    v_xor_b32 v7, 128, v2
    v_mfma_f32_16x16x32_bf16 v[74:77], v[100:103], v[128:131], v[74:77]
    s_bfe_u32 s7, s14, 0x40000
    s_lshl_b32 s7, s7, 12
    v_mfma_f32_16x16x32_bf16 v[84:87], v[124:127], v[112:115], v[84:87]
    s_add_u32 s12, s6, s7
    buffer_load_dwordx4 a[16:19], v60, s[8:11], s12 offen offset:0 sc0 sc1
    v_mfma_f32_16x16x32_bf16 v[84:87], v[108:111], v[128:131], v[84:87]
    v_add_u32 v4, 32768, v7
    v_xor_b32 v7, 192, v2
    v_mfma_f32_16x16x32_bf16 v[88:91], v[124:127], v[120:123], 0
    ds_read_b64 v[140:141], v186 offset:3520
    ds_read_b64 v[142:143], v186 offset:3528
    v_mfma_f32_16x16x32_bf16 v[88:91], v[116:119], v[128:131], v[88:91]
    ds_read_b128 v[144:147], v187 offset:3840
    s_waitcnt lgkmcnt(3)
    v_mfma_f32_16x16x32_bf16 v[74:77], v[132:135], v[96:99], v[74:77]
    buffer_load_dwordx4 a[20:23], v60, s[8:11], s12 offen offset:1024 sc0 sc1
    v_mfma_f32_16x16x32_bf16 v[74:77], v[92:95], v[136:139], v[74:77]
    v_add_u32 v5, 49152, v7
    s_lshl_b32 s16, s43, 19
    v_mfma_f32_16x16x32_bf16 v[84:87], v[132:135], v[104:107], v[84:87]
    ds_read_b64 v[124:125], v186 offset:4032
    ds_read_b64 v[126:127], v186 offset:4040
    v_mfma_f32_16x16x32_bf16 v[84:87], v[100:103], v[136:139], v[84:87]
    ds_read_b128 v[120:123], v187 offset:1792
    s_lshl_b32 s3, s42, 17
    v_mfma_f32_16x16x32_bf16 v[88:91], v[132:135], v[112:115], v[88:91]
    ds_read_b64 v[116:117], v186 offset:384
    ds_read_b64 v[118:119], v186 offset:392
    v_mfma_f32_16x16x32_bf16 v[88:91], v[108:111], v[136:139], v[88:91]
    ds_read_b128 v[128:131], v188 offset:15872
    s_waitcnt lgkmcnt(6)
    v_mfma_f32_16x16x32_bf16 v[84:87], v[140:143], v[96:99], v[84:87]
    ds_read_b64 v[132:133], v186 offset:896
    ds_read_b64 v[134:135], v186 offset:904
    v_mfma_f32_16x16x32_bf16 v[84:87], v[92:95], v[144:147], v[84:87]
    ds_read_b128 v[112:115], v188 offset:13824
    buffer_load_dwordx4 a[24:27], v60, s[8:11], s12 offen offset:2048 sc0 sc1
    v_mfma_f32_16x16x32_bf16 v[88:91], v[140:143], v[104:107], v[88:91]
    ds_read_b64 v[108:109], v186 offset:1408
    ds_read_b64 v[110:111], v186 offset:1416
    v_mfma_f32_16x16x32_bf16 v[88:91], v[100:103], v[144:147], v[88:91]
    ds_read_b128 v[136:139], v188 offset:11776
    s_waitcnt lgkmcnt(6)
    v_mfma_f32_16x16x32_bf16 v[88:91], v[124:127], v[96:99], v[88:91]
    buffer_load_dwordx4 a[28:31], v60, s[8:11], s12 offen offset:3072 sc0 sc1
    v_mfma_f32_16x16x32_bf16 v[88:91], v[92:95], v[120:123], v[88:91]
    s_add_u32 s16, s16, s3
    s_lshl_b32 s17, s44, 8
    v_mfma_f32_16x16x32_bf16 v[46:49], v[116:119], v[128:131], v[46:49]
    s_lshl_b32 s18, s42, 13
    s_waitcnt lgkmcnt(1)
    v_mfma_f32_16x16x32_bf16 v[50:53], v[132:135], v[128:131], v[50:53]
    ds_read_b64 v[140:141], v186 offset:1920
    ds_read_b64 v[142:143], v186 offset:1928
    v_mfma_f32_16x16x32_bf16 v[50:53], v[116:119], v[112:115], v[50:53]
    ds_read_b128 v[104:107], v188 offset:9728
    s_bfe_u32 s7, s14, 0x40004
    v_mfma_f32_16x16x32_bf16 v[54:57], v[132:135], v[112:115], v[54:57]
    s_lshl_b32 s7, s7, 12
    s_add_u32 s12, s6, s7
    v_mfma_f32_16x16x32_bf16 v[54:57], v[108:111], v[128:131], v[54:57]
    buffer_load_dwordx4 a[32:35], v60, s[8:11], s12 offen offset:0 sc0 sc1
    s_waitcnt lgkmcnt(3)
    v_mfma_f32_16x16x32_bf16 v[54:57], v[116:119], v[136:139], v[54:57]
    buffer_load_dwordx4 a[36:39], v60, s[8:11], s12 offen offset:1024 sc0 sc1
    v_mfma_f32_16x16x32_bf16 v[66:69], v[108:111], v[112:115], v[66:69]
    s_lshr_b32 s30, s42, 1
    v_and_b32 v25, 31, v1
    v_mfma_f32_16x16x32_bf16 v[66:69], v[132:135], v[136:139], v[66:69]
    v_lshrrev_b32 v26, 5, v1
    v_lshlrev_b32 v26, 2, v26
    v_mfma_f32_16x16x32_bf16 v[70:73], v[108:111], v[136:139], v[70:73]
    ds_read_b64 v[100:101], v186 offset:2432
    s_waitcnt lgkmcnt(1)
    v_mfma_f32_16x16x32_bf16 v[66:69], v[140:143], v[128:131], v[66:69]
    ds_read_b64 v[102:103], v186 offset:2440
    ds_read_b128 v[144:147], v188 offset:7680
    v_mfma_f32_16x16x32_bf16 v[66:69], v[116:119], v[104:107], v[66:69]
    buffer_load_dwordx4 a[40:43], v60, s[8:11], s12 offen offset:2048 sc0 sc1
    v_mfma_f32_16x16x32_bf16 v[70:73], v[140:143], v[112:115], v[70:73]
    s_lshl_b32 s3, s30, 3
    v_add_u32 v26, s3, v26
    v_mfma_f32_16x16x32_bf16 v[70:73], v[132:135], v[104:107], v[70:73]
    v_and_b32 v27, 15, v25
    v_xor_b32 v26, v26, v27
    v_mfma_f32_16x16x32_bf16 v[74:77], v[140:143], v[136:139], v[74:77]
    v_lshlrev_b32 v26, 4, v26
    v_lshl_add_u32 v26, v25, 8, v26
    v_mfma_f32_16x16x32_bf16 v[74:77], v[108:111], v[104:107], v[74:77]
    buffer_load_dwordx4 a[44:47], v60, s[8:11], s12 offen offset:3072 sc0 sc1
    v_mfma_f32_16x16x32_bf16 v[84:87], v[140:143], v[104:107], v[84:87]
    s_lshl_b32 s3, s30, 14
    s_waitcnt lgkmcnt(0)
    v_mfma_f32_16x16x32_bf16 v[70:73], v[100:103], v[128:131], v[70:73]
    ds_read_b64 v[124:125], v186 offset:2944
    ds_read_b64 v[126:127], v186 offset:2952
    v_mfma_f32_16x16x32_bf16 v[70:73], v[116:119], v[144:147], v[70:73]
    ds_read_b128 v[96:99], v188 offset:5632
    v_add_u32 v26, s3, v26
    v_mfma_f32_16x16x32_bf16 v[74:77], v[100:103], v[112:115], v[74:77]
    s_bfe_u32 s7, s14, 0x40008
    s_lshl_b32 s7, s7, 12
    v_mfma_f32_16x16x32_bf16 v[74:77], v[132:135], v[144:147], v[74:77]
    s_add_u32 s12, s6, s7
    buffer_load_dwordx4 a[48:51], v60, s[8:11], s12 offen offset:0 sc0 sc1
    v_mfma_f32_16x16x32_bf16 v[84:87], v[100:103], v[136:139], v[84:87]
    v_xor_b32 v9, 0, v26
    v_xor_b32 v17, 0x4000, v9
    v_mfma_f32_16x16x32_bf16 v[84:87], v[108:111], v[144:147], v[84:87]
    v_add_u32 v13, 65536, v9
    v_add_u32 v21, 65536, v17
    v_mfma_f32_16x16x32_bf16 v[88:91], v[100:103], v[104:107], v[88:91]
    ds_read_b64 v[92:93], v186 offset:3456
    ds_read_b64 v[94:95], v186 offset:3464
    v_mfma_f32_16x16x32_bf16 v[88:91], v[140:143], v[144:147], v[88:91]
    ds_read_b128 v[120:123], v188 offset:3584
    s_waitcnt lgkmcnt(3)
    v_mfma_f32_16x16x32_bf16 v[74:77], v[124:127], v[128:131], v[74:77]
    buffer_load_dwordx4 a[52:55], v60, s[8:11], s12 offen offset:1024 sc0 sc1
    v_mfma_f32_16x16x32_bf16 v[74:77], v[116:119], v[96:99], v[74:77]
    v_xor_b32 v10, 16, v26
    v_xor_b32 v18, 0x4000, v10
    v_mfma_f32_16x16x32_bf16 v[84:87], v[124:127], v[112:115], v[84:87]
    ds_read_b64 v[100:101], v186 offset:3968
    ds_read_b64 v[102:103], v186 offset:3976
    v_mfma_f32_16x16x32_bf16 v[84:87], v[132:135], v[96:99], v[84:87]
    ds_read_b128 v[104:107], v188 offset:1536
    buffer_load_dwordx4 a[56:59], v60, s[8:11], s12 offen offset:2048 sc0 sc1
    v_mfma_f32_16x16x32_bf16 v[88:91], v[124:127], v[136:139], v[88:91]
    ds_read_b64 v[140:141], v186 offset:320
    ds_read_b64 v[142:143], v186 offset:328
    v_mfma_f32_16x16x32_bf16 v[88:91], v[108:111], v[96:99], v[88:91]
    ds_read_b128 v[144:147], v189 offset:15616
    s_waitcnt lgkmcnt(6)
    v_mfma_f32_16x16x32_bf16 v[84:87], v[92:95], v[128:131], v[84:87]
    ds_read_b64 v[124:125], v186 offset:832
    ds_read_b64 v[126:127], v186 offset:840
    v_mfma_f32_16x16x32_bf16 v[84:87], v[116:119], v[120:123], v[84:87]
    ds_read_b128 v[136:139], v189 offset:13568
    v_add_u32 v14, 65536, v10
    v_mfma_f32_16x16x32_bf16 v[88:91], v[92:95], v[112:115], v[88:91]
    ds_read_b64 v[108:109], v186 offset:1344
    ds_read_b64 v[110:111], v186 offset:1352
    v_mfma_f32_16x16x32_bf16 v[88:91], v[132:135], v[120:123], v[88:91]
    ds_read_b128 v[96:99], v189 offset:11520
    s_waitcnt lgkmcnt(6)
    v_mfma_f32_16x16x32_bf16 v[88:91], v[100:103], v[128:131], v[88:91]
    buffer_load_dwordx4 a[60:63], v60, s[8:11], s12 offen offset:3072 sc0 sc1
    v_mfma_f32_16x16x32_bf16 v[88:91], v[116:119], v[104:107], v[88:91]
    s_waitcnt vmcnt(16)
    v_mov_b32 v182, s22
    v_mov_b32 v183, s23
    s_mov_b64 s[48:49], exec
    s_mov_b64 exec, 1
    buffer_store_dwordx2 v[182:183], v6, s[8:11], s4 offen sc0 sc1
    s_mov_b64 exec, s[48:49]
    v_mfma_f32_16x16x32_bf16 v[46:49], v[140:143], v[144:147], v[46:49]
    s_bfe_u32 s7, s14, 0x4000c
    s_waitcnt lgkmcnt(1)
    v_mfma_f32_16x16x32_bf16 v[50:53], v[124:127], v[144:147], v[50:53]
    ds_read_b64 v[92:93], v186 offset:1856
    ds_read_b64 v[94:95], v186 offset:1864
    v_mfma_f32_16x16x32_bf16 v[50:53], v[140:143], v[136:139], v[50:53]
    ds_read_b128 v[112:115], v189 offset:9472
    s_lshl_b32 s7, s7, 12
    v_mfma_f32_16x16x32_bf16 v[54:57], v[124:127], v[136:139], v[54:57]
    s_add_u32 s12, s6, s7
    buffer_load_dwordx4 a[64:67], v60, s[8:11], s12 offen offset:0 sc0 sc1
    v_mfma_f32_16x16x32_bf16 v[54:57], v[108:111], v[144:147], v[54:57]
    buffer_load_dwordx4 a[68:71], v60, s[8:11], s12 offen offset:1024 sc0 sc1
    s_waitcnt lgkmcnt(3)
    v_mfma_f32_16x16x32_bf16 v[54:57], v[140:143], v[96:99], v[54:57]
    v_add_u32 v22, 65536, v18
    v_xor_b32 v11, 32, v26
    v_mfma_f32_16x16x32_bf16 v[66:69], v[108:111], v[136:139], v[66:69]
    v_xor_b32 v19, 0x4000, v11
    v_add_u32 v15, 65536, v11
    v_mfma_f32_16x16x32_bf16 v[66:69], v[124:127], v[96:99], v[66:69]
    v_add_u32 v23, 65536, v19
    v_xor_b32 v12, 48, v26
    v_mfma_f32_16x16x32_bf16 v[70:73], v[108:111], v[96:99], v[70:73]
    ds_read_b64 v[132:133], v186 offset:2368
    s_waitcnt lgkmcnt(1)
    v_mfma_f32_16x16x32_bf16 v[66:69], v[92:95], v[144:147], v[66:69]
    ds_read_b64 v[134:135], v186 offset:2376
    ds_read_b128 v[120:123], v189 offset:7424
    v_mfma_f32_16x16x32_bf16 v[66:69], v[140:143], v[112:115], v[66:69]
    buffer_load_dwordx4 a[72:75], v60, s[8:11], s12 offen offset:2048 sc0 sc1
    v_mfma_f32_16x16x32_bf16 v[70:73], v[92:95], v[136:139], v[70:73]
    v_xor_b32 v20, 0x4000, v12
    v_add_u32 v16, 65536, v12
    v_mfma_f32_16x16x32_bf16 v[70:73], v[124:127], v[112:115], v[70:73]
    v_add_u32 v24, 65536, v20
    s_lshl_b32 s13, s44, 4
    v_mfma_f32_16x16x32_bf16 v[74:77], v[92:95], v[96:99], v[74:77]
    buffer_load_dwordx4 a[76:79], v60, s[8:11], s12 offen offset:3072 sc0 sc1
    v_mfma_f32_16x16x32_bf16 v[74:77], v[108:111], v[112:115], v[74:77]
    s_add_u32 s13, s13, s43
    s_lshl_b32 s13, s13, 2
    v_mfma_f32_16x16x32_bf16 v[84:87], v[92:95], v[112:115], v[84:87]
    s_add_u32 s13, s13, s42
    s_waitcnt lgkmcnt(0)
    v_mfma_f32_16x16x32_bf16 v[70:73], v[132:135], v[144:147], v[70:73]
    ds_read_b64 v[100:101], v186 offset:2880
    ds_read_b64 v[102:103], v186 offset:2888
    v_mfma_f32_16x16x32_bf16 v[70:73], v[140:143], v[120:123], v[70:73]
    ds_read_b128 v[128:131], v189 offset:5376
    s_lshl_b32 s13, s13, 3
    v_mfma_f32_16x16x32_bf16 v[74:77], v[132:135], v[136:139], v[74:77]
    s_bfe_u32 s7, s14, 0x40010
    s_lshl_b32 s7, s7, 12
    v_mfma_f32_16x16x32_bf16 v[74:77], v[124:127], v[120:123], v[74:77]
    s_add_u32 s12, s6, s7
    buffer_load_dwordx4 a[80:83], v60, s[8:11], s12 offen offset:0 sc0 sc1
    v_mfma_f32_16x16x32_bf16 v[84:87], v[132:135], v[96:99], v[84:87]
    s_add_u32 s13, s13, 21520384
    s_mov_b32 s32, s36
    v_mfma_f32_16x16x32_bf16 v[84:87], v[108:111], v[120:123], v[84:87]
    s_mov_b32 s33, s37
    s_mov_b32 s34, 8388608
    v_mfma_f32_16x16x32_bf16 v[88:91], v[132:135], v[112:115], v[88:91]
    ds_read_b64 v[116:117], v186 offset:3392
    ds_read_b64 v[118:119], v186 offset:3400
    v_mfma_f32_16x16x32_bf16 v[88:91], v[92:95], v[120:123], v[88:91]
    ds_read_b128 v[104:107], v189 offset:3328
    s_waitcnt lgkmcnt(3)
    v_mfma_f32_16x16x32_bf16 v[74:77], v[100:103], v[144:147], v[74:77]
    buffer_load_dwordx4 a[84:87], v60, s[8:11], s12 offen offset:1024 sc0 sc1
    v_mfma_f32_16x16x32_bf16 v[74:77], v[140:143], v[128:131], v[74:77]
    s_mov_b32 s35, 131072
    s_lshr_b32 s31, s42, 1
    v_mfma_f32_16x16x32_bf16 v[84:87], v[100:103], v[136:139], v[84:87]
    ds_read_b64 v[132:133], v186 offset:3904
    ds_read_b64 v[134:135], v186 offset:3912
    v_mfma_f32_16x16x32_bf16 v[84:87], v[124:127], v[128:131], v[84:87]
    ds_read_b128 v[112:115], v189 offset:1280
    buffer_load_dwordx4 a[88:91], v60, s[8:11], s12 offen offset:2048 sc0 sc1
    v_mfma_f32_16x16x32_bf16 v[88:91], v[100:103], v[96:99], v[88:91]
    ds_read_b64 v[92:93], v186 offset:256
    ds_read_b64 v[94:95], v186 offset:264
    v_mfma_f32_16x16x32_bf16 v[88:91], v[108:111], v[128:131], v[88:91]
    ds_read_b128 v[120:123], v190 offset:15360
    s_waitcnt lgkmcnt(6)
    v_mfma_f32_16x16x32_bf16 v[84:87], v[116:119], v[144:147], v[84:87]
    ds_read_b64 v[100:101], v186 offset:768
    ds_read_b64 v[102:103], v186 offset:776
    v_mfma_f32_16x16x32_bf16 v[84:87], v[140:143], v[104:107], v[84:87]
    ds_read_b128 v[96:99], v190 offset:13312
    buffer_load_dwordx4 a[92:95], v60, s[8:11], s12 offen offset:3072 sc0 sc1
    v_mfma_f32_16x16x32_bf16 v[88:91], v[116:119], v[136:139], v[88:91]
    ds_read_b64 v[108:109], v186 offset:1280
    ds_read_b64 v[110:111], v186 offset:1288
    v_mfma_f32_16x16x32_bf16 v[88:91], v[124:127], v[104:107], v[88:91]
    ds_read_b128 v[128:131], v190 offset:11264
    s_waitcnt lgkmcnt(6)
    v_mfma_f32_16x16x32_bf16 v[88:91], v[132:135], v[144:147], v[88:91]
    s_and_b32 s38, s42, 1
    v_bfe_u32 v29, v1, 4, 1
    v_mfma_f32_16x16x32_bf16 v[88:91], v[140:143], v[112:115], v[88:91]
    s_bfe_u32 s7, s14, 0x40014
    s_lshl_b32 s7, s7, 12
    v_mfma_f32_16x16x32_bf16 v[46:49], v[92:95], v[120:123], v[46:49]
    s_add_u32 s12, s6, s7
    s_waitcnt lgkmcnt(1)
    v_mfma_f32_16x16x32_bf16 v[50:53], v[100:103], v[120:123], v[50:53]
    ds_read_b64 v[116:117], v186 offset:1792
    ds_read_b64 v[118:119], v186 offset:1800
    v_mfma_f32_16x16x32_bf16 v[50:53], v[92:95], v[96:99], v[50:53]
    ds_read_b128 v[136:139], v190 offset:9216
    buffer_load_dwordx4 a[96:99], v60, s[8:11], s12 offen offset:0 sc0 sc1
    v_mfma_f32_16x16x32_bf16 v[54:57], v[100:103], v[96:99], v[54:57]
    v_lshlrev_b32 v29, 2, v29
    v_and_b32 v32, 7, v1
    v_mfma_f32_16x16x32_bf16 v[54:57], v[108:111], v[120:123], v[54:57]
    buffer_load_dwordx4 a[100:103], v60, s[8:11], s12 offen offset:1024 sc0 sc1
    s_waitcnt lgkmcnt(3)
    v_mfma_f32_16x16x32_bf16 v[54:57], v[92:95], v[128:131], v[54:57]
    v_xor_b32 v32, v32, v29
    v_lshlrev_b32 v32, 4, v32
    v_mfma_f32_16x16x32_bf16 v[66:69], v[108:111], v[96:99], v[66:69]
    v_lshrrev_b32 v29, 3, v1
    v_lshl_add_u32 v34, v29, 11, v32
    v_mfma_f32_16x16x32_bf16 v[66:69], v[100:103], v[128:131], v[66:69]
    s_lshl_b32 s39, s43, 18
    s_lshl_b32 s3, s42, 16
    v_mfma_f32_16x16x32_bf16 v[70:73], v[108:111], v[128:131], v[70:73]
    ds_read_b64 v[124:125], v186 offset:2304
    s_waitcnt lgkmcnt(1)
    v_mfma_f32_16x16x32_bf16 v[66:69], v[116:119], v[120:123], v[66:69]
    ds_read_b64 v[126:127], v186 offset:2312
    ds_read_b128 v[104:107], v190 offset:7168
    v_mfma_f32_16x16x32_bf16 v[66:69], v[92:95], v[136:139], v[66:69]
    buffer_load_dwordx4 a[104:107], v60, s[8:11], s12 offen offset:2048 sc0 sc1
    v_mfma_f32_16x16x32_bf16 v[70:73], v[116:119], v[96:99], v[70:73]
    s_add_u32 s39, s39, s3
    s_lshl_b32 s3, s44, 7
    v_mfma_f32_16x16x32_bf16 v[70:73], v[100:103], v[136:139], v[70:73]
    buffer_load_dwordx4 a[108:111], v60, s[8:11], s12 offen offset:3072 sc0 sc1
    v_mfma_f32_16x16x32_bf16 v[74:77], v[116:119], v[128:131], v[74:77]
    s_add_u32 s39, s39, s3
    s_lshl_b32 s45, s44, 18
    v_mfma_f32_16x16x32_bf16 v[74:77], v[108:111], v[136:139], v[74:77]
    s_lshl_b32 s3, s42, 16
    s_add_u32 s45, s45, s3
    v_mfma_f32_16x16x32_bf16 v[84:87], v[116:119], v[136:139], v[84:87]
    s_lshl_b32 s3, s43, 8
    s_waitcnt lgkmcnt(0)
    v_mfma_f32_16x16x32_bf16 v[70:73], v[124:127], v[120:123], v[70:73]
    ds_read_b64 v[132:133], v186 offset:2816
    ds_read_b64 v[134:135], v186 offset:2824
    v_mfma_f32_16x16x32_bf16 v[70:73], v[92:95], v[104:107], v[70:73]
    ds_read_b128 v[144:147], v190 offset:5120
    s_bfe_u32 s7, s14, 0x40018
    v_mfma_f32_16x16x32_bf16 v[74:77], v[124:127], v[96:99], v[74:77]
    s_lshl_b32 s7, s7, 12
    s_add_u32 s12, s6, s7
    v_mfma_f32_16x16x32_bf16 v[74:77], v[100:103], v[104:107], v[74:77]
    buffer_load_dwordx4 a[112:115], v60, s[8:11], s12 offen offset:0 sc0 sc1
    v_mfma_f32_16x16x32_bf16 v[84:87], v[124:127], v[128:131], v[84:87]
    s_add_u32 s45, s45, s3
    s_add_u32 s45, s45, 12582912
    v_mfma_f32_16x16x32_bf16 v[84:87], v[108:111], v[104:107], v[84:87]
    buffer_load_dwordx4 a[116:119], v60, s[8:11], s12 offen offset:1024 sc0 sc1
    v_mfma_f32_16x16x32_bf16 v[88:91], v[124:127], v[136:139], v[88:91]
    ds_read_b64 v[140:141], v186 offset:3328
    ds_read_b64 v[142:143], v186 offset:3336
    v_mfma_f32_16x16x32_bf16 v[88:91], v[116:119], v[104:107], v[88:91]
    ds_read_b128 v[112:115], v190 offset:3072
    s_waitcnt lgkmcnt(3)
    v_mfma_f32_16x16x32_bf16 v[74:77], v[132:135], v[120:123], v[74:77]
    v_bfe_u32 v33, v1, 2, 2
    v_bfe_u32 v29, v1, 4, 1
    v_mfma_f32_16x16x32_bf16 v[74:77], v[92:95], v[144:147], v[74:77]
    v_lshlrev_b32 v29, 1, v29
    v_bfe_u32 v32, v1, 1, 1
    v_mfma_f32_16x16x32_bf16 v[84:87], v[132:135], v[96:99], v[84:87]
    ds_read_b64 v[124:125], v186 offset:3840
    ds_read_b64 v[126:127], v186 offset:3848
    v_mfma_f32_16x16x32_bf16 v[84:87], v[100:103], v[144:147], v[84:87]
    ds_read_b128 v[136:139], v190 offset:1024
    buffer_load_dwordx4 a[120:123], v60, s[8:11], s12 offen offset:2048 sc0 sc1
    v_mfma_f32_16x16x32_bf16 v[88:91], v[132:135], v[128:131], v[88:91]
    ds_read_b64 v[116:117], v186 offset:192
    ds_read_b64 v[118:119], v186 offset:200
    v_mfma_f32_16x16x32_bf16 v[88:91], v[108:111], v[144:147], v[88:91]
    ds_read_b128 v[104:107], v187 offset:15104
    s_waitcnt lgkmcnt(6)
    v_mfma_f32_16x16x32_bf16 v[84:87], v[140:143], v[120:123], v[84:87]
    ds_read_b64 v[132:133], v186 offset:704
    ds_read_b64 v[134:135], v186 offset:712
    v_mfma_f32_16x16x32_bf16 v[84:87], v[92:95], v[112:115], v[84:87]
    ds_read_b128 v[128:131], v187 offset:13056
    buffer_load_dwordx4 a[124:127], v60, s[8:11], s12 offen offset:3072 sc0 sc1
    v_mfma_f32_16x16x32_bf16 v[88:91], v[140:143], v[96:99], v[88:91]
    ds_read_b64 v[108:109], v186 offset:1216
    ds_read_b64 v[110:111], v186 offset:1224
    v_mfma_f32_16x16x32_bf16 v[88:91], v[100:103], v[112:115], v[88:91]
    ds_read_b128 v[144:147], v187 offset:11008
    s_waitcnt lgkmcnt(6)
    v_mfma_f32_16x16x32_bf16 v[88:91], v[124:127], v[120:123], v[88:91]
    s_bfe_u32 s7, s14, 0x4001c
    s_lshl_b32 s7, s7, 12
    v_mfma_f32_16x16x32_bf16 v[88:91], v[92:95], v[136:139], v[88:91]
    s_add_u32 s12, s6, s7
    buffer_load_dwordx4 a[128:131], v60, s[8:11], s12 offen offset:0 sc0 sc1
    v_mfma_f32_16x16x32_bf16 v[46:49], v[116:119], v[104:107], v[46:49]
    v_add_u32 v29, v29, v32
    s_waitcnt lgkmcnt(1)
    v_mfma_f32_16x16x32_bf16 v[50:53], v[132:135], v[104:107], v[50:53]
    ds_read_b64 v[140:141], v186 offset:1728
    ds_read_b64 v[142:143], v186 offset:1736
    v_mfma_f32_16x16x32_bf16 v[50:53], v[116:119], v[128:131], v[50:53]
    ds_read_b128 v[96:99], v187 offset:8960
    s_lshl_b32 s3, s38, 2
    v_mfma_f32_16x16x32_bf16 v[54:57], v[132:135], v[128:131], v[54:57]
    buffer_load_dwordx4 a[132:135], v60, s[8:11], s12 offen offset:1024 sc0 sc1
    v_mfma_f32_16x16x32_bf16 v[54:57], v[108:111], v[104:107], v[54:57]
    v_add_u32 v29, s3, v29
    s_waitcnt lgkmcnt(3)
    v_mfma_f32_16x16x32_bf16 v[54:57], v[116:119], v[144:147], v[54:57]
    v_bfe_u32 v32, v1, 3, 1
    v_lshlrev_b32 v32, 2, v32
    v_mfma_f32_16x16x32_bf16 v[66:69], v[108:111], v[128:131], v[66:69]
    v_xor_b32 v29, v29, v32
    v_lshlrev_b32 v29, 4, v29
    v_mfma_f32_16x16x32_bf16 v[66:69], v[132:135], v[144:147], v[66:69]
    buffer_load_dwordx4 a[136:139], v60, s[8:11], s12 offen offset:2048 sc0 sc1
    v_mfma_f32_16x16x32_bf16 v[70:73], v[108:111], v[144:147], v[70:73]
    ds_read_b64 v[100:101], v186 offset:2240
    s_waitcnt lgkmcnt(1)
    v_mfma_f32_16x16x32_bf16 v[66:69], v[140:143], v[104:107], v[66:69]
    ds_read_b64 v[102:103], v186 offset:2248
    ds_read_b128 v[112:115], v187 offset:6912
    v_mfma_f32_16x16x32_bf16 v[66:69], v[116:119], v[96:99], v[66:69]
    v_and_b32 v32, 1, v1
    v_lshl_add_u32 v29, v32, 3, v29
    v_mfma_f32_16x16x32_bf16 v[70:73], v[140:143], v[128:131], v[70:73]
    v_lshrrev_b32 v32, 5, v1
    v_lshl_add_u32 v33, v32, 2, v33
    v_mfma_f32_16x16x32_bf16 v[70:73], v[132:135], v[96:99], v[70:73]
    buffer_load_dwordx4 a[140:143], v60, s[8:11], s12 offen offset:3072 sc0 sc1
    v_mfma_f32_16x16x32_bf16 v[74:77], v[140:143], v[144:147], v[74:77]
    v_lshl_add_u32 v29, v33, 7, v29
    s_lshl_b32 s3, s31, 13
    v_mfma_f32_16x16x32_bf16 v[74:77], v[108:111], v[96:99], v[74:77]
    s_add_u32 s3, s3, 131072
    v_add_u32 v35, s3, v29
    v_mfma_f32_16x16x32_bf16 v[84:87], v[140:143], v[96:99], v[84:87]
    v_and_b32 v29, 15, v1
    s_waitcnt lgkmcnt(0)
    v_mfma_f32_16x16x32_bf16 v[70:73], v[100:103], v[104:107], v[70:73]
    ds_read_b64 v[124:125], v186 offset:2752
    ds_read_b64 v[126:127], v186 offset:2760
    v_mfma_f32_16x16x32_bf16 v[70:73], v[116:119], v[112:115], v[70:73]
    ds_read_b128 v[120:123], v187 offset:4864
    s_bfe_u32 s7, s15, 0x40000
    v_mfma_f32_16x16x32_bf16 v[74:77], v[100:103], v[128:131], v[74:77]
    s_lshl_b32 s7, s7, 12
    s_add_u32 s12, s6, s7
    v_mfma_f32_16x16x32_bf16 v[74:77], v[132:135], v[112:115], v[74:77]
    buffer_load_dwordx4 a[144:147], v60, s[8:11], s12 offen offset:0 sc0 sc1
    v_mfma_f32_16x16x32_bf16 v[84:87], v[100:103], v[144:147], v[84:87]
    buffer_load_dwordx4 a[148:151], v60, s[8:11], s12 offen offset:1024 sc0 sc1
    v_mfma_f32_16x16x32_bf16 v[84:87], v[108:111], v[112:115], v[84:87]
    s_lshl_b32 s3, s31, 3
    v_xor_b32 v29, s3, v29
    v_mfma_f32_16x16x32_bf16 v[88:91], v[100:103], v[96:99], v[88:91]
    ds_read_b64 v[92:93], v186 offset:3264
    ds_read_b64 v[94:95], v186 offset:3272
    v_mfma_f32_16x16x32_bf16 v[88:91], v[140:143], v[112:115], v[88:91]
    ds_read_b128 v[136:139], v187 offset:2816
    s_waitcnt lgkmcnt(3)
    v_mfma_f32_16x16x32_bf16 v[74:77], v[124:127], v[104:107], v[74:77]
    v_lshlrev_b32 v29, 4, v29
    v_and_b32 v33, 31, v1
    v_mfma_f32_16x16x32_bf16 v[74:77], v[116:119], v[120:123], v[74:77]
    buffer_load_dwordx4 a[152:155], v60, s[8:11], s12 offen offset:2048 sc0 sc1
    v_mfma_f32_16x16x32_bf16 v[84:87], v[124:127], v[128:131], v[84:87]
    ds_read_b64 v[100:101], v186 offset:3776
    ds_read_b64 v[102:103], v186 offset:3784
    v_mfma_f32_16x16x32_bf16 v[84:87], v[132:135], v[120:123], v[84:87]
    ds_read_b128 v[96:99], v187 offset:768
    v_lshl_add_u32 v29, v33, 8, v29
    v_mfma_f32_16x16x32_bf16 v[88:91], v[124:127], v[144:147], v[88:91]
    ds_read_b64 v[140:141], v186 offset:128
    ds_read_b64 v[142:143], v186 offset:136
    v_mfma_f32_16x16x32_bf16 v[88:91], v[108:111], v[120:123], v[88:91]
    ds_read_b128 v[112:115], v188 offset:14848
    s_waitcnt lgkmcnt(6)
    v_mfma_f32_16x16x32_bf16 v[84:87], v[92:95], v[104:107], v[84:87]
    ds_read_b64 v[124:125], v186 offset:640
    ds_read_b64 v[126:127], v186 offset:648
    v_mfma_f32_16x16x32_bf16 v[84:87], v[116:119], v[136:139], v[84:87]
    ds_read_b128 v[144:147], v188 offset:12800
    buffer_load_dwordx4 a[156:159], v60, s[8:11], s12 offen offset:3072 sc0 sc1
    v_mfma_f32_16x16x32_bf16 v[88:91], v[92:95], v[128:131], v[88:91]
    ds_read_b64 v[108:109], v186 offset:1152
    ds_read_b64 v[110:111], v186 offset:1160
    v_mfma_f32_16x16x32_bf16 v[88:91], v[132:135], v[136:139], v[88:91]
    ds_read_b128 v[120:123], v188 offset:10752
    s_waitcnt lgkmcnt(6)
    v_mfma_f32_16x16x32_bf16 v[88:91], v[100:103], v[104:107], v[88:91]
    s_bfe_u32 s7, s15, 0x40004
    s_lshl_b32 s7, s7, 12
    v_mfma_f32_16x16x32_bf16 v[88:91], v[116:119], v[96:99], v[88:91]
    s_add_u32 s12, s6, s7
    buffer_load_dwordx4 a[160:163], v60, s[8:11], s12 offen offset:0 sc0 sc1
    v_mfma_f32_16x16x32_bf16 v[46:49], v[140:143], v[112:115], v[46:49]
    v_lshl_add_u32 v29, v32, 3, v29
    s_waitcnt lgkmcnt(1)
    v_mfma_f32_16x16x32_bf16 v[50:53], v[124:127], v[112:115], v[50:53]
    ds_read_b64 v[92:93], v186 offset:1664
    ds_read_b64 v[94:95], v186 offset:1672
    v_mfma_f32_16x16x32_bf16 v[50:53], v[140:143], v[144:147], v[50:53]
    ds_read_b128 v[128:131], v188 offset:8704
    buffer_load_dwordx4 a[164:167], v60, s[8:11], s12 offen offset:1024 sc0 sc1
    v_mfma_f32_16x16x32_bf16 v[54:57], v[124:127], v[144:147], v[54:57]
    s_lshl_b32 s3, s38, 13
    s_add_u32 s3, s3, 147456
    v_mfma_f32_16x16x32_bf16 v[54:57], v[108:111], v[112:115], v[54:57]
    v_add_u32 v36, s3, v29
    s_waitcnt lgkmcnt(3)
    v_mfma_f32_16x16x32_bf16 v[54:57], v[140:143], v[120:123], v[54:57]
    v_and_b32 v29, 15, v1
    v_lshlrev_b32 v29, 4, v29
    v_mfma_f32_16x16x32_bf16 v[66:69], v[108:111], v[144:147], v[66:69]
    buffer_load_dwordx4 a[168:171], v60, s[8:11], s12 offen offset:2048 sc0 sc1
    v_mfma_f32_16x16x32_bf16 v[66:69], v[124:127], v[120:123], v[66:69]
    v_and_b32 v33, 16, v1
    v_lshl_add_u32 v29, v33, 9, v29
    v_mfma_f32_16x16x32_bf16 v[70:73], v[108:111], v[120:123], v[70:73]
    ds_read_b64 v[132:133], v186 offset:2176
    s_waitcnt lgkmcnt(1)
    v_mfma_f32_16x16x32_bf16 v[66:69], v[92:95], v[112:115], v[66:69]
    ds_read_b64 v[134:135], v186 offset:2184
    ds_read_b128 v[136:139], v188 offset:6656
    v_mfma_f32_16x16x32_bf16 v[66:69], v[140:143], v[128:131], v[66:69]
    buffer_load_dwordx2 v[182:183], v81, s[8:11], 0 offen sc0 sc1
    v_mfma_f32_16x16x32_bf16 v[70:73], v[92:95], v[144:147], v[70:73]
    buffer_load_dwordx4 a[172:175], v60, s[8:11], s12 offen offset:3072 sc0 sc1
    v_mfma_f32_16x16x32_bf16 v[70:73], v[124:127], v[128:131], v[70:73]
    s_lshl_b32 s3, s43, 9
    s_add_u32 s3, s3, 20971520
    v_mfma_f32_16x16x32_bf16 v[74:77], v[92:95], v[120:123], v[74:77]
    v_add_u32 v29, s3, v29
    s_lshl_b32 s3, s31, 8
    v_mfma_f32_16x16x32_bf16 v[74:77], v[108:111], v[128:131], v[74:77]
    v_add_u32 v37, s3, v29
    s_lshl_b32 s3, s42, 10
    v_mfma_f32_16x16x32_bf16 v[84:87], v[92:95], v[128:131], v[84:87]
    s_bfe_u32 s7, s15, 0x40008
    s_waitcnt lgkmcnt(0)
    v_mfma_f32_16x16x32_bf16 v[70:73], v[132:135], v[112:115], v[70:73]
    ds_read_b64 v[100:101], v186 offset:2688
    ds_read_b64 v[102:103], v186 offset:2696
    v_mfma_f32_16x16x32_bf16 v[70:73], v[140:143], v[136:139], v[70:73]
    ds_read_b128 v[104:107], v188 offset:4608
    s_lshl_b32 s7, s7, 12
    v_mfma_f32_16x16x32_bf16 v[74:77], v[132:135], v[144:147], v[74:77]
    s_add_u32 s12, s6, s7
    buffer_load_dwordx4 a[176:179], v60, s[8:11], s12 offen offset:0 sc0 sc1
    v_mfma_f32_16x16x32_bf16 v[74:77], v[124:127], v[136:139], v[74:77]
    s_add_u32 s3, s3, 147456
    v_lshl_add_u32 v38, v32, 4, s3
    v_mfma_f32_16x16x32_bf16 v[84:87], v[132:135], v[120:123], v[84:87]
    buffer_load_dwordx4 a[180:183], v60, s[8:11], s12 offen offset:1024 sc0 sc1
    v_mfma_f32_16x16x32_bf16 v[84:87], v[108:111], v[136:139], v[84:87]
    v_and_b32 v29, 31, v1
    s_lshl_b32 s3, s38, 5
    v_mfma_f32_16x16x32_bf16 v[88:91], v[132:135], v[128:131], v[88:91]
    ds_read_b64 v[116:117], v186 offset:3200
    ds_read_b64 v[118:119], v186 offset:3208
    v_mfma_f32_16x16x32_bf16 v[88:91], v[92:95], v[136:139], v[88:91]
    ds_read_b128 v[96:99], v188 offset:2560
    s_waitcnt lgkmcnt(3)
    v_mfma_f32_16x16x32_bf16 v[74:77], v[100:103], v[112:115], v[74:77]
    buffer_load_dwordx4 a[184:187], v60, s[8:11], s12 offen offset:2048 sc0 sc1
    v_mfma_f32_16x16x32_bf16 v[74:77], v[140:143], v[104:107], v[74:77]
    v_add_u32 v29, s3, v29
    s_lshl_b32 s3, s44, 6
    v_mfma_f32_16x16x32_bf16 v[84:87], v[100:103], v[144:147], v[84:87]
    ds_read_b64 v[132:133], v186 offset:3712
    ds_read_b64 v[134:135], v186 offset:3720
    v_mfma_f32_16x16x32_bf16 v[84:87], v[124:127], v[104:107], v[84:87]
    ds_read_b128 v[128:131], v188 offset:512
    v_add_u32 v29, s3, v29
    v_mfma_f32_16x16x32_bf16 v[88:91], v[100:103], v[120:123], v[88:91]
    ds_read_b64 v[92:93], v186 offset:64
    ds_read_b64 v[94:95], v186 offset:72
    v_mfma_f32_16x16x32_bf16 v[88:91], v[108:111], v[104:107], v[88:91]
    ds_read_b128 v[136:139], v189 offset:14592
    s_waitcnt lgkmcnt(6)
    v_mfma_f32_16x16x32_bf16 v[84:87], v[116:119], v[112:115], v[84:87]
    ds_read_b64 v[100:101], v186 offset:576
    ds_read_b64 v[102:103], v186 offset:584
    v_mfma_f32_16x16x32_bf16 v[84:87], v[140:143], v[96:99], v[84:87]
    ds_read_b128 v[120:123], v189 offset:12544
    buffer_load_dwordx4 a[188:191], v60, s[8:11], s12 offen offset:3072 sc0 sc1
    v_mfma_f32_16x16x32_bf16 v[88:91], v[116:119], v[144:147], v[88:91]
    ds_read_b64 v[108:109], v186 offset:1088
    ds_read_b64 v[110:111], v186 offset:1096
    v_mfma_f32_16x16x32_bf16 v[88:91], v[124:127], v[96:99], v[88:91]
    ds_read_b128 v[104:107], v189 offset:10496
    s_waitcnt lgkmcnt(6)
    v_mfma_f32_16x16x32_bf16 v[88:91], v[132:135], v[112:115], v[88:91]
    s_bfe_u32 s7, s15, 0x4000c
    s_lshl_b32 s7, s7, 12
    v_mfma_f32_16x16x32_bf16 v[88:91], v[140:143], v[128:131], v[88:91]
    s_add_u32 s12, s6, s7
    buffer_load_dwordx4 a[192:195], v60, s[8:11], s12 offen offset:0 sc0 sc1
    v_mfma_f32_16x16x32_bf16 v[46:49], v[92:95], v[136:139], v[46:49]
    v_lshlrev_b32 v32, 14, v32
    s_waitcnt lgkmcnt(1)
    v_mfma_f32_16x16x32_bf16 v[50:53], v[100:103], v[136:139], v[50:53]
    ds_read_b64 v[116:117], v186 offset:1600
    ds_read_b64 v[118:119], v186 offset:1608
    v_mfma_f32_16x16x32_bf16 v[50:53], v[92:95], v[120:123], v[50:53]
    ds_read_b128 v[144:147], v189 offset:8448
    buffer_load_dwordx4 a[196:199], v60, s[8:11], s12 offen offset:1024 sc0 sc1
    v_mfma_f32_16x16x32_bf16 v[54:57], v[100:103], v[120:123], v[54:57]
    v_lshl_add_u32 v39, v29, 2, v32
    v_add_u32 v40, 4096, v39
    v_mfma_f32_16x16x32_bf16 v[54:57], v[108:111], v[136:139], v[54:57]
    v_add_u32 v41, 8192, v39
    s_waitcnt lgkmcnt(3)
    v_mfma_f32_16x16x32_bf16 v[54:57], v[92:95], v[104:107], v[54:57]
    v_add_u32 v42, 12288, v39
    s_lshl_b32 s46, s43, 19
    v_mfma_f32_16x16x32_bf16 v[66:69], v[108:111], v[120:123], v[66:69]
    buffer_load_dwordx4 a[200:203], v60, s[8:11], s12 offen offset:2048 sc0 sc1
    v_mfma_f32_16x16x32_bf16 v[66:69], v[100:103], v[104:107], v[66:69]
    s_lshl_b32 s3, s31, 18
    s_add_u32 s46, s46, s3
    v_mfma_f32_16x16x32_bf16 v[70:73], v[108:111], v[104:107], v[70:73]
    ds_read_b64 v[124:125], v186 offset:2112
    s_waitcnt lgkmcnt(1)
    v_mfma_f32_16x16x32_bf16 v[66:69], v[116:119], v[136:139], v[66:69]
    ds_read_b64 v[126:127], v186 offset:2120
    ds_read_b128 v[96:99], v189 offset:6400
    v_mfma_f32_16x16x32_bf16 v[66:69], v[92:95], v[144:147], v[66:69]
    buffer_load_dwordx4 a[204:207], v60, s[8:11], s12 offen offset:3072 sc0 sc1
    v_mfma_f32_16x16x32_bf16 v[70:73], v[116:119], v[120:123], v[70:73]
    s_lshl_b32 s47, s42, 12
    s_lshl_b32 s3, s42, 13
    v_mfma_f32_16x16x32_bf16 v[70:73], v[100:103], v[144:147], v[70:73]
    s_add_u32 s3, s3, 0
    v_add_u32 v43, s3, v60
    v_mfma_f32_16x16x32_bf16 v[74:77], v[116:119], v[104:107], v[74:77]
    v_xor_b32 v44, 0x4000, v43
    s_lshl_b32 s3, s44, 9
    v_mfma_f32_16x16x32_bf16 v[74:77], v[108:111], v[144:147], v[74:77]
    s_bfe_u32 s7, s15, 0x40010
    s_lshl_b32 s7, s7, 12
    v_mfma_f32_16x16x32_bf16 v[84:87], v[116:119], v[144:147], v[84:87]
    s_add_u32 s12, s6, s7
    s_waitcnt lgkmcnt(0)
    v_mfma_f32_16x16x32_bf16 v[70:73], v[124:127], v[136:139], v[70:73]
    ds_read_b64 v[132:133], v186 offset:2624
    ds_read_b64 v[134:135], v186 offset:2632
    v_mfma_f32_16x16x32_bf16 v[70:73], v[92:95], v[96:99], v[70:73]
    ds_read_b128 v[112:115], v189 offset:4352
    buffer_load_dwordx4 a[208:211], v60, s[8:11], s12 offen offset:0 sc0 sc1
    v_mfma_f32_16x16x32_bf16 v[74:77], v[124:127], v[120:123], v[74:77]
    s_mov_b32 s50, 0
    s_waitcnt vmcnt(10)
    v_cmp_ne_u64 vcc, s[22:23], v[182:183]
    s_nop 4
    s_cbranch_vccz Lfdone_gate_11
Lfpoll_gate_12:
    buffer_load_dwordx2 v[182:183], v81, s[8:11], 0 offen sc0 sc1
    s_waitcnt vmcnt(0)
    v_cmp_ne_u64 vcc, s[22:23], v[182:183]
    s_nop 4
    s_add_u32 s50, s50, 1
    s_cmp_gt_u32 s50, 20000
    s_cbranch_scc1 Lfdone_gate_11
    s_cbranch_vccnz Lfpoll_gate_12
Lfdone_gate_11:
    v_mfma_f32_16x16x32_bf16 v[74:77], v[100:103], v[96:99], v[74:77]
    s_bfe_u32 s17, s14, 0x40000
    s_lshl_b32 s17, s17, 8
    v_mfma_f32_16x16x32_bf16 v[84:87], v[124:127], v[104:107], v[84:87]
    s_add_u32 s20, s16, s17
    s_add_u32 m0, s18, 32768
    v_mfma_f32_16x16x32_bf16 v[84:87], v[108:111], v[96:99], v[84:87]
    buffer_load_dwordx4 v2, s[8:11], s20 offen sc0 sc1 lds
    v_mfma_f32_16x16x32_bf16 v[88:91], v[124:127], v[144:147], v[88:91]
    ds_read_b64 v[140:141], v186 offset:3136
    ds_read_b64 v[142:143], v186 offset:3144
    v_mfma_f32_16x16x32_bf16 v[88:91], v[116:119], v[96:99], v[88:91]
    ds_read_b128 v[128:131], v189 offset:2304
    s_waitcnt lgkmcnt(3)
    v_mfma_f32_16x16x32_bf16 v[74:77], v[132:135], v[136:139], v[74:77]
    buffer_load_dwordx4 a[212:215], v60, s[8:11], s12 offen offset:1024 sc0 sc1
    v_mfma_f32_16x16x32_bf16 v[74:77], v[92:95], v[112:115], v[74:77]
    s_add_u32 m0, s18, 33792
    s_nop 0
    buffer_load_dwordx4 v3, s[8:11], s20 offen sc0 sc1 lds
    v_mfma_f32_16x16x32_bf16 v[84:87], v[132:135], v[120:123], v[84:87]
    ds_read_b64 v[124:125], v186 offset:3648
    ds_read_b64 v[126:127], v186 offset:3656
    v_mfma_f32_16x16x32_bf16 v[84:87], v[100:103], v[112:115], v[84:87]
    ds_read_b128 v[144:147], v189 offset:256
    buffer_load_dwordx4 a[216:219], v60, s[8:11], s12 offen offset:2048 sc0 sc1
    v_mfma_f32_16x16x32_bf16 v[88:91], v[132:135], v[104:107], v[88:91]
    ds_read_b64 v[116:117], v186 offset:0
    ds_read_b64 v[118:119], v186 offset:8
    v_mfma_f32_16x16x32_bf16 v[88:91], v[108:111], v[112:115], v[88:91]
    ds_read_b128 v[96:99], v190 offset:14336
    s_waitcnt lgkmcnt(6)
    v_mfma_f32_16x16x32_bf16 v[84:87], v[140:143], v[136:139], v[84:87]
    ds_read_b64 v[132:133], v186 offset:512
    ds_read_b64 v[134:135], v186 offset:520
    v_mfma_f32_16x16x32_bf16 v[84:87], v[92:95], v[128:131], v[84:87]
    ds_read_b128 v[104:107], v190 offset:12288
    s_add_u32 m0, s18, 34816
    v_mfma_f32_16x16x32_bf16 v[88:91], v[140:143], v[120:123], v[88:91]
    ds_read_b64 v[108:109], v186 offset:1024
    ds_read_b64 v[110:111], v186 offset:1032
    v_mfma_f32_16x16x32_bf16 v[88:91], v[100:103], v[128:131], v[88:91]
    ds_read_b128 v[112:115], v190 offset:10240
    s_waitcnt lgkmcnt(6)
    v_mfma_f32_16x16x32_bf16 v[88:91], v[124:127], v[136:139], v[88:91]
    buffer_load_dwordx4 v4, s[8:11], s20 offen sc0 sc1 lds
    v_mfma_f32_16x16x32_bf16 v[88:91], v[92:95], v[144:147], v[88:91]
    buffer_load_dwordx4 a[220:223], v60, s[8:11], s12 offen offset:3072 sc0 sc1
    v_mfma_f32_16x16x32_bf16 v[46:49], v[116:119], v[96:99], v[46:49]
    s_add_u32 m0, s18, 35840
    s_waitcnt lgkmcnt(1)
    v_mfma_f32_16x16x32_bf16 v[50:53], v[132:135], v[96:99], v[50:53]
    ds_read_b64 v[140:141], v186 offset:1536
    ds_read_b64 v[142:143], v186 offset:1544
    v_mfma_f32_16x16x32_bf16 v[50:53], v[116:119], v[104:107], v[50:53]
    ds_read_b128 v[120:123], v190 offset:8192
    buffer_load_dwordx4 v5, s[8:11], s20 offen sc0 sc1 lds
    v_mfma_f32_16x16x32_bf16 v[54:57], v[132:135], v[104:107], v[54:57]
    s_bfe_u32 s7, s15, 0x40014
    s_lshl_b32 s7, s7, 12
    v_mfma_f32_16x16x32_bf16 v[54:57], v[108:111], v[96:99], v[54:57]
    s_add_u32 s12, s6, s7
    s_waitcnt lgkmcnt(3)
    v_mfma_f32_16x16x32_bf16 v[54:57], v[116:119], v[112:115], v[54:57]
    buffer_load_dwordx4 a[224:227], v60, s[8:11], s12 offen offset:0 sc0 sc1
    v_mfma_f32_16x16x32_bf16 v[66:69], v[108:111], v[104:107], v[66:69]
    s_add_u32 s21, s20, 65536
    s_add_u32 m0, s18, 36864
    v_mfma_f32_16x16x32_bf16 v[66:69], v[132:135], v[112:115], v[66:69]
    buffer_load_dwordx4 v2, s[8:11], s21 offen sc0 sc1 lds
    v_mfma_f32_16x16x32_bf16 v[70:73], v[108:111], v[112:115], v[70:73]
    ds_read_b64 v[100:101], v186 offset:2048
    s_waitcnt lgkmcnt(1)
    v_mfma_f32_16x16x32_bf16 v[66:69], v[140:143], v[96:99], v[66:69]
    ds_read_b64 v[102:103], v186 offset:2056
    ds_read_b128 v[128:131], v190 offset:6144
    v_mfma_f32_16x16x32_bf16 v[66:69], v[116:119], v[120:123], v[66:69]
    buffer_load_dwordx4 a[228:231], v60, s[8:11], s12 offen offset:1024 sc0 sc1
    v_mfma_f32_16x16x32_bf16 v[70:73], v[140:143], v[104:107], v[70:73]
    s_add_u32 m0, s18, 37888
    s_nop 0
    buffer_load_dwordx4 v3, s[8:11], s21 offen sc0 sc1 lds
    v_mfma_f32_16x16x32_bf16 v[70:73], v[132:135], v[120:123], v[70:73]
    buffer_load_dwordx4 a[232:235], v60, s[8:11], s12 offen offset:2048 sc0 sc1
    v_mfma_f32_16x16x32_bf16 v[74:77], v[140:143], v[112:115], v[74:77]
    buffer_load_dwordx4 a[236:239], v60, s[8:11], s12 offen offset:3072 sc0 sc1
    v_mfma_f32_16x16x32_bf16 v[74:77], v[108:111], v[120:123], v[74:77]
    s_add_u32 m0, s18, 38912
    s_nop 0
    buffer_load_dwordx4 v4, s[8:11], s21 offen sc0 sc1 lds
    v_mfma_f32_16x16x32_bf16 v[84:87], v[140:143], v[120:123], v[84:87]
    s_bfe_u32 s7, s15, 0x40018
    s_waitcnt lgkmcnt(0)
    v_mfma_f32_16x16x32_bf16 v[70:73], v[100:103], v[96:99], v[70:73]
    ds_read_b64 v[124:125], v186 offset:2560
    ds_read_b64 v[126:127], v186 offset:2568
    v_mfma_f32_16x16x32_bf16 v[70:73], v[116:119], v[128:131], v[70:73]
    ds_read_b128 v[136:139], v190 offset:4096
    s_lshl_b32 s7, s7, 12
    v_mfma_f32_16x16x32_bf16 v[74:77], v[100:103], v[104:107], v[74:77]
    s_add_u32 s12, s6, s7
    buffer_load_dwordx4 a[240:243], v60, s[8:11], s12 offen offset:0 sc0 sc1
    v_mfma_f32_16x16x32_bf16 v[74:77], v[132:135], v[128:131], v[74:77]
    s_add_u32 m0, s18, 39936
    s_nop 0
    buffer_load_dwordx4 v5, s[8:11], s21 offen sc0 sc1 lds
    v_mfma_f32_16x16x32_bf16 v[84:87], v[100:103], v[112:115], v[84:87]
    buffer_load_dwordx4 a[244:247], v60, s[8:11], s12 offen offset:1024 sc0 sc1
    v_mfma_f32_16x16x32_bf16 v[84:87], v[108:111], v[128:131], v[84:87]
    s_add_u32 s3, s3, 21520384
    v_lshrrev_b32 v28, 1, v60
    v_mfma_f32_16x16x32_bf16 v[88:91], v[100:103], v[120:123], v[88:91]
    ds_read_b64 v[92:93], v186 offset:3072
    ds_read_b64 v[94:95], v186 offset:3080
    v_mfma_f32_16x16x32_bf16 v[88:91], v[140:143], v[128:131], v[88:91]
    ds_read_b128 v[144:147], v190 offset:2048
    s_waitcnt lgkmcnt(3)
    v_mfma_f32_16x16x32_bf16 v[74:77], v[124:127], v[96:99], v[74:77]
    buffer_load_dwordx4 a[248:251], v60, s[8:11], s12 offen offset:2048 sc0 sc1
    v_mfma_f32_16x16x32_bf16 v[74:77], v[116:119], v[136:139], v[74:77]
    v_add_u32 v28, s3, v28
    v_mfma_f32_16x16x32_bf16 v[84:87], v[124:127], v[104:107], v[84:87]
    ds_read_b64 v[100:101], v186 offset:3584
    ds_read_b64 v[102:103], v186 offset:3592
    v_mfma_f32_16x16x32_bf16 v[84:87], v[132:135], v[136:139], v[84:87]
    ds_read_b128 v[120:123], v190 offset:0
    buffer_load_dwordx4 a[252:255], v60, s[8:11], s12 offen offset:3072 sc0 sc1
    v_mfma_f32_16x16x32_bf16 v[88:91], v[124:127], v[112:115], v[88:91]
    v_mfma_f32_16x16x32_bf16 v[88:91], v[108:111], v[136:139], v[88:91]
    s_waitcnt lgkmcnt(3)
    v_mfma_f32_16x16x32_bf16 v[84:87], v[92:95], v[96:99], v[84:87]
    v_mfma_f32_16x16x32_bf16 v[84:87], v[116:119], v[144:147], v[84:87]
    v_mfma_f32_16x16x32_bf16 v[88:91], v[92:95], v[104:107], v[88:91]
    v_mfma_f32_16x16x32_bf16 v[88:91], v[132:135], v[144:147], v[88:91]
    s_waitcnt lgkmcnt(0)
    v_mfma_f32_16x16x32_bf16 v[88:91], v[100:103], v[96:99], v[88:91]
    v_mfma_f32_16x16x32_bf16 v[88:91], v[116:119], v[120:123], v[88:91]
    s_barrier
    ds_read_b128 v[92:95], v9 offset:0
    ds_read_b128 v[96:99], v9 offset:8192
    ds_read_b128 v[100:103], v17 offset:0
    ds_read_b128 v[104:107], v17 offset:8192
    s_bfe_u32 s17, s14, 0x40004
    s_lshl_b32 s17, s17, 8
    s_add_u32 s20, s16, s17
    s_add_u32 m0, s18, 65536
    s_waitcnt lgkmcnt(3)
    v_mfma_f32_32x32x16_bf16 v[124:139], v[92:95], a[0:3], 0
    ds_read_b128 v[108:111], v10 offset:0
    ds_read_b128 v[112:115], v10 offset:8192
    buffer_load_dwordx4 v2, s[8:11], s20 offen sc0 sc1 lds
    ds_read_b64 v[26:27], v191 offset:14336
    ds_read_b64 v[32:33], v191 offset:12288
    ds_read_b64 v[58:59], v191 offset:10240
    ds_read_b64 v[62:63], v191 offset:8192
    ds_read_b64 v[78:79], v191 offset:6144
    ds_read_b64 v[172:173], v191 offset:4096
    s_add_u32 m0, s18, 66560
    s_waitcnt lgkmcnt(10)
    v_mfma_f32_32x32x16_bf16 v[140:155], v[96:99], a[0:3], 0
    ds_read_b128 v[116:119], v18 offset:0
    ds_read_b128 v[120:123], v18 offset:8192
    buffer_load_dwordx4 v3, s[8:11], s20 offen sc0 sc1 lds
    ds_read_b64 v[174:175], v191 offset:2048
    ds_read_b64 v[176:177], v191 offset:0
    s_add_u32 s4, s28, 12582912
    s_waitcnt lgkmcnt(9)
    v_and_b32 v178, s5, v27
    v_lshlrev_b32 v179, 16, v27
    v_and_b32 v180, s5, v26
    s_add_u32 m0, s18, 67584
    v_mfma_f32_32x32x16_bf16 v[156:171], v[100:103], a[0:3], 0
    buffer_load_dwordx4 v4, s[8:11], s20 offen sc0 sc1 lds
    v_lshlrev_b32 v181, 16, v26
    v_fmac_f32 v46, v82, v178
    v_fmac_f32 v47, v82, v179
    v_fmac_f32 v48, v82, v180
    v_fmac_f32 v49, v82, v181
    v_cvt_pk_bf16_f32 v212, v46, v47
    v_cvt_pk_bf16_f32 v213, v48, v49
    s_waitcnt lgkmcnt(8)
    v_and_b32 v178, s5, v33
    s_add_u32 m0, s18, 68608
    v_mfma_f32_32x32x16_bf16 v[196:211], v[104:107], a[0:3], 0
    buffer_load_dwordx4 v5, s[8:11], s20 offen sc0 sc1 lds
    v_lshlrev_b32 v179, 16, v33
    v_and_b32 v180, s5, v32
    v_lshlrev_b32 v181, 16, v32
    v_fmac_f32 v50, v82, v178
    v_fmac_f32 v51, v82, v179
    v_fmac_f32 v52, v82, v180
    v_fmac_f32 v53, v82, v181
    v_cvt_pk_bf16_f32 v214, v50, v51
    v_cvt_pk_bf16_f32 v215, v52, v53
    s_add_u32 s21, s20, 65536
    s_add_u32 m0, s18, 69632
    v_mfma_f32_32x32x16_bf16 v[124:139], v[108:111], a[4:7], v[124:139]
    ds_read_b128 v[92:95], v11 offset:0
    ds_read_b128 v[96:99], v11 offset:8192
    buffer_load_dwordx4 v2, s[8:11], s21 offen sc0 sc1 lds
    v_permlane16_swap_b32 v212, v214
    v_permlane16_swap_b32 v213, v215
    s_waitcnt lgkmcnt(9)
    v_and_b32 v178, s5, v59
    v_lshlrev_b32 v179, 16, v59
    v_and_b32 v180, s5, v58
    v_lshlrev_b32 v181, 16, v58
    s_add_u32 m0, s18, 70656
    v_mfma_f32_32x32x16_bf16 v[140:155], v[112:115], a[4:7], v[140:155]
    ds_read_b128 v[100:103], v19 offset:0
    ds_read_b128 v[104:107], v19 offset:8192
    buffer_load_dwordx4 v3, s[8:11], s21 offen sc0 sc1 lds
    v_fmac_f32 v54, v82, v178
    v_fmac_f32 v55, v82, v179
    v_fmac_f32 v56, v82, v180
    v_fmac_f32 v57, v82, v181
    v_cvt_pk_bf16_f32 v216, v54, v55
    v_cvt_pk_bf16_f32 v217, v56, v57
    s_add_u32 m0, s18, 71680
    s_waitcnt lgkmcnt(7)
    v_mfma_f32_32x32x16_bf16 v[156:171], v[116:119], a[4:7], v[156:171]
    buffer_load_dwordx4 v4, s[8:11], s21 offen sc0 sc1 lds
    v_and_b32 v178, s5, v63
    v_lshlrev_b32 v179, 16, v63
    v_and_b32 v180, s5, v62
    v_lshlrev_b32 v181, 16, v62
    v_fmac_f32 v66, v82, v178
    v_fmac_f32 v67, v82, v179
    v_fmac_f32 v68, v82, v180
    v_fmac_f32 v69, v82, v181
    s_add_u32 m0, s18, 72704
    s_waitcnt lgkmcnt(6)
    v_mfma_f32_32x32x16_bf16 v[196:211], v[120:123], a[4:7], v[196:211]
    buffer_load_dwordx4 v5, s[8:11], s21 offen sc0 sc1 lds
    v_cvt_pk_bf16_f32 v218, v66, v67
    v_cvt_pk_bf16_f32 v219, v68, v69
    s_nop 0
    v_permlane16_swap_b32 v216, v218
    v_permlane16_swap_b32 v217, v219
    v_and_b32 v178, s5, v79
    v_lshlrev_b32 v179, 16, v79
    v_and_b32 v180, s5, v78
    v_lshlrev_b32 v181, 16, v78
    v_fmac_f32 v70, v82, v178
    s_bfe_u32 s17, s14, 0x40008
    s_lshl_b32 s17, s17, 8
    s_add_u32 s20, s16, s17
    s_add_u32 m0, s18, 98304
    s_waitcnt lgkmcnt(3)
    v_mfma_f32_32x32x16_bf16 v[124:139], v[92:95], a[8:11], v[124:139]
    ds_read_b128 v[108:111], v12 offset:0
    ds_read_b128 v[112:115], v12 offset:8192
    buffer_load_dwordx4 v2, s[8:11], s20 offen sc0 sc1 lds
    v_fmac_f32 v71, v82, v179
    v_fmac_f32 v72, v82, v180
    v_fmac_f32 v73, v82, v181
    v_cvt_pk_bf16_f32 v220, v70, v71
    v_cvt_pk_bf16_f32 v221, v72, v73
    v_and_b32 v178, s5, v173
    s_add_u32 m0, s18, 99328
    s_waitcnt lgkmcnt(4)
    v_mfma_f32_32x32x16_bf16 v[140:155], v[96:99], a[8:11], v[140:155]
    ds_read_b128 v[116:119], v20 offset:0
    ds_read_b128 v[120:123], v20 offset:8192
    buffer_load_dwordx4 v3, s[8:11], s20 offen sc0 sc1 lds
    v_lshlrev_b32 v179, 16, v173
    v_and_b32 v180, s5, v172
    v_lshlrev_b32 v181, 16, v172
    v_fmac_f32 v74, v82, v178
    v_fmac_f32 v75, v82, v179
    v_fmac_f32 v76, v82, v180
    s_add_u32 m0, s18, 100352
    s_waitcnt lgkmcnt(5)
    v_mfma_f32_32x32x16_bf16 v[156:171], v[100:103], a[8:11], v[156:171]
    buffer_load_dwordx4 v4, s[8:11], s20 offen sc0 sc1 lds
    v_fmac_f32 v77, v82, v181
    v_cvt_pk_bf16_f32 v222, v74, v75
    v_cvt_pk_bf16_f32 v223, v76, v77
    s_nop 0
    v_permlane16_swap_b32 v220, v222
    v_permlane16_swap_b32 v221, v223
    v_and_b32 v178, s5, v175
    v_lshlrev_b32 v179, 16, v175
    v_and_b32 v180, s5, v174
    s_add_u32 m0, s18, 101376
    s_waitcnt lgkmcnt(4)
    v_mfma_f32_32x32x16_bf16 v[196:211], v[104:107], a[8:11], v[196:211]
    buffer_load_dwordx4 v5, s[8:11], s20 offen sc0 sc1 lds
    v_lshlrev_b32 v181, 16, v174
    v_fmac_f32 v84, v82, v178
    v_fmac_f32 v85, v82, v179
    v_fmac_f32 v86, v82, v180
    v_fmac_f32 v87, v82, v181
    v_cvt_pk_bf16_f32 v224, v84, v85
    v_cvt_pk_bf16_f32 v225, v86, v87
    v_and_b32 v178, s5, v177
    v_lshlrev_b32 v179, 16, v177
    s_waitcnt lgkmcnt(0)
    s_waitcnt vmcnt(15)
    s_barrier
    s_add_u32 s21, s20, 65536
    s_add_u32 m0, s18, 102400
    v_mfma_f32_32x32x16_bf16 v[124:139], v[108:111], a[12:15], v[124:139]
    ds_read_b128 v[92:95], v9 offset:32768
    ds_read_b128 v[96:99], v9 offset:40960
    buffer_load_dwordx4 v2, s[8:11], s21 offen sc0 sc1 lds
    v_and_b32 v180, s5, v176
    v_lshlrev_b32 v181, 16, v176
    v_fmac_f32 v88, v82, v178
    v_fmac_f32 v89, v82, v179
    v_fmac_f32 v90, v82, v180
    v_fmac_f32 v91, v82, v181
    s_add_u32 m0, s18, 103424
    v_mfma_f32_32x32x16_bf16 v[140:155], v[112:115], a[12:15], v[140:155]
    ds_read_b128 v[100:103], v17 offset:32768
    ds_read_b128 v[104:107], v17 offset:40960
    buffer_load_dwordx4 v3, s[8:11], s21 offen sc0 sc1 lds
    v_cvt_pk_bf16_f32 v226, v88, v89
    v_cvt_pk_bf16_f32 v227, v90, v91
    s_nop 0
    v_permlane16_swap_b32 v224, v226
    v_permlane16_swap_b32 v225, v227
    s_add_u32 m0, s18, 104448
    v_mfma_f32_32x32x16_bf16 v[156:171], v[116:119], a[12:15], v[156:171]
    buffer_load_dwordx4 v4, s[8:11], s21 offen sc0 sc1 lds
    s_add_u32 m0, s18, 105472
    v_mfma_f32_32x32x16_bf16 v[196:211], v[120:123], a[12:15], v[196:211]
    buffer_load_dwordx4 v5, s[8:11], s21 offen sc0 sc1 lds
    s_waitcnt lgkmcnt(3)
    v_mfma_f32_32x32x16_bf16 v[124:139], v[92:95], a[16:19], v[124:139]
    ds_read_b128 v[108:111], v10 offset:32768
    ds_read_b128 v[112:115], v10 offset:40960
    buffer_store_dwordx4 v[212:215], v192, s[8:11], s4 offen offset:0 sc0 sc1
    buffer_store_dwordx4 v[216:219], v192, s[8:11], s4 offen offset:1024 sc0 sc1
    buffer_store_dwordx4 v[220:223], v192, s[8:11], s4 offen offset:2048 sc0 sc1
    s_waitcnt lgkmcnt(4)
    v_mfma_f32_32x32x16_bf16 v[140:155], v[96:99], a[16:19], v[140:155]
    ds_read_b128 v[116:119], v18 offset:32768
    ds_read_b128 v[120:123], v18 offset:40960
    s_bfe_u32 s17, s14, 0x4000c
    s_lshl_b32 s17, s17, 8
    s_add_u32 s20, s16, s17
    s_add_u32 m0, s18, 0
    s_waitcnt lgkmcnt(5)
    v_mfma_f32_32x32x16_bf16 v[156:171], v[100:103], a[16:19], v[156:171]
    buffer_load_dwordx4 v2, s[8:11], s20 offen sc0 sc1 lds
    buffer_store_dwordx4 v[224:227], v192, s[8:11], s4 offen offset:3072 sc0 sc1
    s_add_u32 m0, s18, 1024
    s_waitcnt lgkmcnt(4)
    v_mfma_f32_32x32x16_bf16 v[196:211], v[104:107], a[16:19], v[196:211]
    buffer_load_dwordx4 v3, s[8:11], s20 offen sc0 sc1 lds
    s_waitcnt lgkmcnt(3)
    v_mfma_f32_32x32x16_bf16 v[124:139], v[108:111], a[20:23], v[124:139]
    ds_read_b128 v[92:95], v11 offset:32768
    ds_read_b128 v[96:99], v11 offset:40960
    s_waitcnt lgkmcnt(4)
    v_mfma_f32_32x32x16_bf16 v[140:155], v[112:115], a[20:23], v[140:155]
    ds_read_b128 v[100:103], v19 offset:32768
    ds_read_b128 v[104:107], v19 offset:40960
    s_add_u32 m0, s18, 2048
    s_waitcnt lgkmcnt(5)
    v_mfma_f32_32x32x16_bf16 v[156:171], v[116:119], a[20:23], v[156:171]
    buffer_load_dwordx4 v4, s[8:11], s20 offen sc0 sc1 lds
    s_add_u32 m0, s18, 3072
    s_waitcnt lgkmcnt(4)
    v_mfma_f32_32x32x16_bf16 v[196:211], v[120:123], a[20:23], v[196:211]
    buffer_load_dwordx4 v5, s[8:11], s20 offen sc0 sc1 lds
    s_waitcnt lgkmcnt(3)
    v_mfma_f32_32x32x16_bf16 v[124:139], v[92:95], a[24:27], v[124:139]
    ds_read_b128 v[108:111], v12 offset:32768
    ds_read_b128 v[112:115], v12 offset:40960
    s_waitcnt lgkmcnt(4)
    v_mfma_f32_32x32x16_bf16 v[140:155], v[96:99], a[24:27], v[140:155]
    ds_read_b128 v[116:119], v20 offset:32768
    ds_read_b128 v[120:123], v20 offset:40960
    s_add_u32 s21, s20, 65536
    s_add_u32 m0, s18, 4096
    s_waitcnt lgkmcnt(5)
    v_mfma_f32_32x32x16_bf16 v[156:171], v[100:103], a[24:27], v[156:171]
    buffer_load_dwordx4 v2, s[8:11], s21 offen sc0 sc1 lds
    s_add_u32 m0, s18, 5120
    s_waitcnt lgkmcnt(4)
    v_mfma_f32_32x32x16_bf16 v[196:211], v[104:107], a[24:27], v[196:211]
    buffer_load_dwordx4 v3, s[8:11], s21 offen sc0 sc1 lds
    s_waitcnt lgkmcnt(0)
    s_waitcnt vmcnt(18)
    s_barrier
    v_mfma_f32_32x32x16_bf16 v[124:139], v[108:111], a[28:31], v[124:139]
    ds_read_b128 v[92:95], v13 offset:0
    ds_read_b128 v[96:99], v13 offset:8192
    v_mfma_f32_32x32x16_bf16 v[140:155], v[112:115], a[28:31], v[140:155]
    ds_read_b128 v[100:103], v21 offset:0
    ds_read_b128 v[104:107], v21 offset:8192
    s_add_u32 m0, s18, 6144
    v_mfma_f32_32x32x16_bf16 v[156:171], v[116:119], a[28:31], v[156:171]
    buffer_load_dwordx4 v4, s[8:11], s21 offen sc0 sc1 lds
    s_add_u32 m0, s18, 7168
    v_mfma_f32_32x32x16_bf16 v[196:211], v[120:123], a[28:31], v[196:211]
    buffer_load_dwordx4 v5, s[8:11], s21 offen sc0 sc1 lds
    s_waitcnt lgkmcnt(3)
    v_mfma_f32_32x32x16_bf16 v[124:139], v[92:95], a[32:35], v[124:139]
    ds_read_b128 v[108:111], v14 offset:0
    ds_read_b128 v[112:115], v14 offset:8192
    s_waitcnt lgkmcnt(4)
    v_mfma_f32_32x32x16_bf16 v[140:155], v[96:99], a[32:35], v[140:155]
    ds_read_b128 v[116:119], v22 offset:0
    ds_read_b128 v[120:123], v22 offset:8192
    s_bfe_u32 s17, s14, 0x40010
    s_lshl_b32 s17, s17, 8
    s_add_u32 s20, s16, s17
    s_add_u32 m0, s18, 32768
    s_waitcnt lgkmcnt(5)
    v_mfma_f32_32x32x16_bf16 v[156:171], v[100:103], a[32:35], v[156:171]
    buffer_load_dwordx4 v2, s[8:11], s20 offen sc0 sc1 lds
    s_add_u32 m0, s18, 33792
    s_waitcnt lgkmcnt(4)
    v_mfma_f32_32x32x16_bf16 v[196:211], v[104:107], a[32:35], v[196:211]
    buffer_load_dwordx4 v3, s[8:11], s20 offen sc0 sc1 lds
    s_waitcnt lgkmcnt(3)
    v_mfma_f32_32x32x16_bf16 v[124:139], v[108:111], a[36:39], v[124:139]
    ds_read_b128 v[92:95], v15 offset:0
    ds_read_b128 v[96:99], v15 offset:8192
    s_waitcnt lgkmcnt(4)
    v_mfma_f32_32x32x16_bf16 v[140:155], v[112:115], a[36:39], v[140:155]
    ds_read_b128 v[100:103], v23 offset:0
    ds_read_b128 v[104:107], v23 offset:8192
    s_add_u32 m0, s18, 34816
    s_waitcnt lgkmcnt(5)
    v_mfma_f32_32x32x16_bf16 v[156:171], v[116:119], a[36:39], v[156:171]
    buffer_load_dwordx4 v4, s[8:11], s20 offen sc0 sc1 lds
    s_add_u32 m0, s18, 35840
    s_waitcnt lgkmcnt(4)
    v_mfma_f32_32x32x16_bf16 v[196:211], v[120:123], a[36:39], v[196:211]
    buffer_load_dwordx4 v5, s[8:11], s20 offen sc0 sc1 lds
    s_waitcnt lgkmcnt(3)
    v_mfma_f32_32x32x16_bf16 v[124:139], v[92:95], a[40:43], v[124:139]
    ds_read_b128 v[108:111], v16 offset:0
    ds_read_b128 v[112:115], v16 offset:8192
    s_waitcnt lgkmcnt(4)
    v_mfma_f32_32x32x16_bf16 v[140:155], v[96:99], a[40:43], v[140:155]
    ds_read_b128 v[116:119], v24 offset:0
    ds_read_b128 v[120:123], v24 offset:8192
    s_add_u32 s21, s20, 65536
    s_add_u32 m0, s18, 36864
    s_waitcnt lgkmcnt(5)
    v_mfma_f32_32x32x16_bf16 v[156:171], v[100:103], a[40:43], v[156:171]
    buffer_load_dwordx4 v2, s[8:11], s21 offen sc0 sc1 lds
    s_add_u32 m0, s18, 37888
    s_waitcnt lgkmcnt(4)
    v_mfma_f32_32x32x16_bf16 v[196:211], v[104:107], a[40:43], v[196:211]
    buffer_load_dwordx4 v3, s[8:11], s21 offen sc0 sc1 lds
    s_waitcnt lgkmcnt(0)
    s_waitcnt vmcnt(18)
    s_barrier
    v_mfma_f32_32x32x16_bf16 v[124:139], v[108:111], a[44:47], v[124:139]
    ds_read_b128 v[92:95], v13 offset:32768
    ds_read_b128 v[96:99], v13 offset:40960
    v_mfma_f32_32x32x16_bf16 v[140:155], v[112:115], a[44:47], v[140:155]
    ds_read_b128 v[100:103], v21 offset:32768
    ds_read_b128 v[104:107], v21 offset:40960
    s_add_u32 m0, s18, 38912
    v_mfma_f32_32x32x16_bf16 v[156:171], v[116:119], a[44:47], v[156:171]
    buffer_load_dwordx4 v4, s[8:11], s21 offen sc0 sc1 lds
    s_add_u32 m0, s18, 39936
    v_mfma_f32_32x32x16_bf16 v[196:211], v[120:123], a[44:47], v[196:211]
    buffer_load_dwordx4 v5, s[8:11], s21 offen sc0 sc1 lds
    s_waitcnt lgkmcnt(3)
    v_mfma_f32_32x32x16_bf16 v[124:139], v[92:95], a[48:51], v[124:139]
    ds_read_b128 v[108:111], v14 offset:32768
    ds_read_b128 v[112:115], v14 offset:40960
    s_waitcnt lgkmcnt(4)
    v_mfma_f32_32x32x16_bf16 v[140:155], v[96:99], a[48:51], v[140:155]
    ds_read_b128 v[116:119], v22 offset:32768
    ds_read_b128 v[120:123], v22 offset:40960
    s_bfe_u32 s17, s14, 0x40014
    s_lshl_b32 s17, s17, 8
    s_add_u32 s20, s16, s17
    s_add_u32 m0, s18, 65536
    s_waitcnt lgkmcnt(5)
    v_mfma_f32_32x32x16_bf16 v[156:171], v[100:103], a[48:51], v[156:171]
    buffer_load_dwordx4 v2, s[8:11], s20 offen sc0 sc1 lds
    s_add_u32 m0, s18, 66560
    s_waitcnt lgkmcnt(4)
    v_mfma_f32_32x32x16_bf16 v[196:211], v[104:107], a[48:51], v[196:211]
    buffer_load_dwordx4 v3, s[8:11], s20 offen sc0 sc1 lds
    s_waitcnt lgkmcnt(3)
    v_mfma_f32_32x32x16_bf16 v[124:139], v[108:111], a[52:55], v[124:139]
    ds_read_b128 v[92:95], v15 offset:32768
    ds_read_b128 v[96:99], v15 offset:40960
    s_waitcnt lgkmcnt(4)
    v_mfma_f32_32x32x16_bf16 v[140:155], v[112:115], a[52:55], v[140:155]
    ds_read_b128 v[100:103], v23 offset:32768
    ds_read_b128 v[104:107], v23 offset:40960
    s_add_u32 m0, s18, 67584
    s_waitcnt lgkmcnt(5)
    v_mfma_f32_32x32x16_bf16 v[156:171], v[116:119], a[52:55], v[156:171]
    buffer_load_dwordx4 v4, s[8:11], s20 offen sc0 sc1 lds
    s_add_u32 m0, s18, 68608
    s_waitcnt lgkmcnt(4)
    v_mfma_f32_32x32x16_bf16 v[196:211], v[120:123], a[52:55], v[196:211]
    buffer_load_dwordx4 v5, s[8:11], s20 offen sc0 sc1 lds
    s_waitcnt lgkmcnt(3)
    v_mfma_f32_32x32x16_bf16 v[124:139], v[92:95], a[56:59], v[124:139]
    ds_read_b128 v[108:111], v16 offset:32768
    ds_read_b128 v[112:115], v16 offset:40960
    s_waitcnt lgkmcnt(4)
    v_mfma_f32_32x32x16_bf16 v[140:155], v[96:99], a[56:59], v[140:155]
    ds_read_b128 v[116:119], v24 offset:32768
    ds_read_b128 v[120:123], v24 offset:40960
    s_add_u32 s21, s20, 65536
    s_add_u32 m0, s18, 69632
    s_waitcnt lgkmcnt(5)
    v_mfma_f32_32x32x16_bf16 v[156:171], v[100:103], a[56:59], v[156:171]
    buffer_load_dwordx4 v2, s[8:11], s21 offen sc0 sc1 lds
    s_add_u32 m0, s18, 70656
    s_waitcnt lgkmcnt(4)
    v_mfma_f32_32x32x16_bf16 v[196:211], v[104:107], a[56:59], v[196:211]
    buffer_load_dwordx4 v3, s[8:11], s21 offen sc0 sc1 lds
    s_waitcnt lgkmcnt(0)
    s_waitcnt vmcnt(14)
    s_barrier
    v_mfma_f32_32x32x16_bf16 v[124:139], v[108:111], a[60:63], v[124:139]
    ds_read_b128 v[92:95], v9 offset:0
    ds_read_b128 v[96:99], v9 offset:8192
    v_mfma_f32_32x32x16_bf16 v[140:155], v[112:115], a[60:63], v[140:155]
    ds_read_b128 v[100:103], v17 offset:0
    ds_read_b128 v[104:107], v17 offset:8192
    s_add_u32 m0, s18, 71680
    v_mfma_f32_32x32x16_bf16 v[156:171], v[116:119], a[60:63], v[156:171]
    buffer_load_dwordx4 v4, s[8:11], s21 offen sc0 sc1 lds
    s_add_u32 m0, s18, 72704
    v_mfma_f32_32x32x16_bf16 v[196:211], v[120:123], a[60:63], v[196:211]
    buffer_load_dwordx4 v5, s[8:11], s21 offen sc0 sc1 lds
    s_waitcnt lgkmcnt(3)
    v_mfma_f32_32x32x16_bf16 v[124:139], v[92:95], a[64:67], v[124:139]
    ds_read_b128 v[108:111], v10 offset:0
    ds_read_b128 v[112:115], v10 offset:8192
    v_mov_b32 v182, s22
    v_mov_b32 v183, s23
    s_mov_b64 s[28:29], exec
    s_mov_b64 exec, 1
    buffer_store_dwordx2 v[182:183], v6, s[8:11], s13 offen sc0 sc1
    s_mov_b64 exec, s[28:29]
    s_waitcnt lgkmcnt(4)
    v_mfma_f32_32x32x16_bf16 v[140:155], v[96:99], a[64:67], v[140:155]
    ds_read_b128 v[116:119], v18 offset:0
    ds_read_b128 v[120:123], v18 offset:8192
    s_bfe_u32 s17, s14, 0x40018
    s_lshl_b32 s17, s17, 8
    s_add_u32 s20, s16, s17
    s_add_u32 m0, s18, 98304
    s_waitcnt lgkmcnt(5)
    v_mfma_f32_32x32x16_bf16 v[156:171], v[100:103], a[64:67], v[156:171]
    buffer_load_dwordx4 v2, s[8:11], s20 offen sc0 sc1 lds
    s_add_u32 m0, s18, 99328
    s_waitcnt lgkmcnt(4)
    v_mfma_f32_32x32x16_bf16 v[196:211], v[104:107], a[64:67], v[196:211]
    buffer_load_dwordx4 v3, s[8:11], s20 offen sc0 sc1 lds
    s_waitcnt lgkmcnt(3)
    v_mfma_f32_32x32x16_bf16 v[124:139], v[108:111], a[68:71], v[124:139]
    ds_read_b128 v[92:95], v11 offset:0
    ds_read_b128 v[96:99], v11 offset:8192
    s_waitcnt lgkmcnt(4)
    v_mfma_f32_32x32x16_bf16 v[140:155], v[112:115], a[68:71], v[140:155]
    ds_read_b128 v[100:103], v19 offset:0
    ds_read_b128 v[104:107], v19 offset:8192
    s_add_u32 m0, s18, 100352
    s_waitcnt lgkmcnt(5)
    v_mfma_f32_32x32x16_bf16 v[156:171], v[116:119], a[68:71], v[156:171]
    buffer_load_dwordx4 v4, s[8:11], s20 offen sc0 sc1 lds
    s_add_u32 m0, s18, 101376
    s_waitcnt lgkmcnt(4)
    v_mfma_f32_32x32x16_bf16 v[196:211], v[120:123], a[68:71], v[196:211]
    buffer_load_dwordx4 v5, s[8:11], s20 offen sc0 sc1 lds
    s_waitcnt lgkmcnt(3)
    v_mfma_f32_32x32x16_bf16 v[124:139], v[92:95], a[72:75], v[124:139]
    ds_read_b128 v[108:111], v12 offset:0
    ds_read_b128 v[112:115], v12 offset:8192
    s_waitcnt lgkmcnt(4)
    v_mfma_f32_32x32x16_bf16 v[140:155], v[96:99], a[72:75], v[140:155]
    ds_read_b128 v[116:119], v20 offset:0
    ds_read_b128 v[120:123], v20 offset:8192
    s_add_u32 s21, s20, 65536
    s_add_u32 m0, s18, 102400
    s_waitcnt lgkmcnt(5)
    v_mfma_f32_32x32x16_bf16 v[156:171], v[100:103], a[72:75], v[156:171]
    buffer_load_dwordx4 v2, s[8:11], s21 offen sc0 sc1 lds
    s_add_u32 m0, s18, 103424
    s_waitcnt lgkmcnt(4)
    v_mfma_f32_32x32x16_bf16 v[196:211], v[104:107], a[72:75], v[196:211]
    buffer_load_dwordx4 v3, s[8:11], s21 offen sc0 sc1 lds
    s_waitcnt lgkmcnt(0)
    s_waitcnt vmcnt(15)
    s_barrier
    v_mfma_f32_32x32x16_bf16 v[124:139], v[108:111], a[76:79], v[124:139]
    ds_read_b128 v[92:95], v9 offset:32768
    ds_read_b128 v[96:99], v9 offset:40960
    v_mfma_f32_32x32x16_bf16 v[140:155], v[112:115], a[76:79], v[140:155]
    ds_read_b128 v[100:103], v17 offset:32768
    ds_read_b128 v[104:107], v17 offset:40960
    s_add_u32 m0, s18, 104448
    v_mfma_f32_32x32x16_bf16 v[156:171], v[116:119], a[76:79], v[156:171]
    buffer_load_dwordx4 v4, s[8:11], s21 offen sc0 sc1 lds
    s_add_u32 m0, s18, 105472
    v_mfma_f32_32x32x16_bf16 v[196:211], v[120:123], a[76:79], v[196:211]
    buffer_load_dwordx4 v5, s[8:11], s21 offen sc0 sc1 lds
    s_waitcnt lgkmcnt(3)
    v_mfma_f32_32x32x16_bf16 v[124:139], v[92:95], a[80:83], v[124:139]
    ds_read_b128 v[108:111], v10 offset:32768
    ds_read_b128 v[112:115], v10 offset:40960
    s_add_u32 m0, s47, 131072
    s_nop 0
    buffer_load_dwordx4 v34, s[56:59], s39 offen lds
    s_add_u32 s39, s39, 16384
    s_add_u32 m0, s47, 132096
    s_nop 0
    buffer_load_dwordx4 v34, s[56:59], s39 offen lds
    s_waitcnt lgkmcnt(4)
    v_mfma_f32_32x32x16_bf16 v[140:155], v[96:99], a[80:83], v[140:155]
    ds_read_b128 v[116:119], v18 offset:32768
    ds_read_b128 v[120:123], v18 offset:40960
    s_bfe_u32 s17, s14, 0x4001c
    s_lshl_b32 s17, s17, 8
    s_add_u32 s20, s16, s17
    s_add_u32 m0, s18, 0
    s_waitcnt lgkmcnt(5)
    v_mfma_f32_32x32x16_bf16 v[156:171], v[100:103], a[80:83], v[156:171]
    buffer_load_dwordx4 v2, s[8:11], s20 offen sc0 sc1 lds
    s_add_u32 s39, s39, 16384
    s_add_u32 m0, s47, 133120
    s_nop 0
    buffer_load_dwordx4 v34, s[56:59], s39 offen lds
    s_add_u32 s39, s39, 16384
    s_add_u32 m0, s18, 1024
    s_waitcnt lgkmcnt(4)
    v_mfma_f32_32x32x16_bf16 v[196:211], v[104:107], a[80:83], v[196:211]
    buffer_load_dwordx4 v3, s[8:11], s20 offen sc0 sc1 lds
    s_add_u32 m0, s47, 134144
    s_nop 0
    buffer_load_dwordx4 v34, s[56:59], s39 offen lds
    s_lshr_b32 s3, s47, 2
    s_add_u32 m0, s3, 147456
    s_nop 0
    buffer_load_dwordx4 v37, s[8:11], 0 offen sc0 sc1 lds
    s_waitcnt lgkmcnt(3)
    v_mfma_f32_32x32x16_bf16 v[124:139], v[108:111], a[84:87], v[124:139]
    ds_read_b128 v[92:95], v11 offset:32768
    ds_read_b128 v[96:99], v11 offset:40960
    s_waitcnt lgkmcnt(4)
    v_mfma_f32_32x32x16_bf16 v[140:155], v[112:115], a[84:87], v[140:155]
    ds_read_b128 v[100:103], v19 offset:32768
    ds_read_b128 v[104:107], v19 offset:40960
    s_add_u32 m0, s18, 2048
    s_waitcnt lgkmcnt(5)
    v_mfma_f32_32x32x16_bf16 v[156:171], v[116:119], a[84:87], v[156:171]
    buffer_load_dwordx4 v4, s[8:11], s20 offen sc0 sc1 lds
    s_add_u32 m0, s18, 3072
    s_waitcnt lgkmcnt(4)
    v_mfma_f32_32x32x16_bf16 v[196:211], v[120:123], a[84:87], v[196:211]
    buffer_load_dwordx4 v5, s[8:11], s20 offen sc0 sc1 lds
    s_waitcnt lgkmcnt(3)
    v_mfma_f32_32x32x16_bf16 v[124:139], v[92:95], a[88:91], v[124:139]
    ds_read_b128 v[108:111], v12 offset:32768
    ds_read_b128 v[112:115], v12 offset:40960
    s_waitcnt lgkmcnt(4)
    v_mfma_f32_32x32x16_bf16 v[140:155], v[96:99], a[88:91], v[140:155]
    ds_read_b128 v[116:119], v20 offset:32768
    ds_read_b128 v[120:123], v20 offset:40960
    s_add_u32 s21, s20, 65536
    s_add_u32 m0, s18, 4096
    s_waitcnt lgkmcnt(5)
    v_mfma_f32_32x32x16_bf16 v[156:171], v[100:103], a[88:91], v[156:171]
    buffer_load_dwordx4 v2, s[8:11], s21 offen sc0 sc1 lds
    s_add_u32 m0, s18, 5120
    s_waitcnt lgkmcnt(4)
    v_mfma_f32_32x32x16_bf16 v[196:211], v[104:107], a[88:91], v[196:211]
    buffer_load_dwordx4 v3, s[8:11], s21 offen sc0 sc1 lds
    s_waitcnt lgkmcnt(0)
    s_waitcnt vmcnt(20)
    s_barrier
    v_mfma_f32_32x32x16_bf16 v[124:139], v[108:111], a[92:95], v[124:139]
    ds_read_b128 v[92:95], v13 offset:0
    ds_read_b128 v[96:99], v13 offset:8192
    v_mfma_f32_32x32x16_bf16 v[140:155], v[112:115], a[92:95], v[140:155]
    ds_read_b128 v[100:103], v21 offset:0
    ds_read_b128 v[104:107], v21 offset:8192
    s_add_u32 m0, s18, 6144
    v_mfma_f32_32x32x16_bf16 v[156:171], v[116:119], a[92:95], v[156:171]
    buffer_load_dwordx4 v4, s[8:11], s21 offen sc0 sc1 lds
    s_add_u32 m0, s18, 7168
    v_mfma_f32_32x32x16_bf16 v[196:211], v[120:123], a[92:95], v[196:211]
    buffer_load_dwordx4 v5, s[8:11], s21 offen sc0 sc1 lds
    s_waitcnt lgkmcnt(3)
    v_mfma_f32_32x32x16_bf16 v[124:139], v[92:95], a[96:99], v[124:139]
    ds_read_b128 v[108:111], v14 offset:0
    ds_read_b128 v[112:115], v14 offset:8192
    s_waitcnt lgkmcnt(4)
    v_mfma_f32_32x32x16_bf16 v[140:155], v[96:99], a[96:99], v[140:155]
    ds_read_b128 v[116:119], v22 offset:0
    ds_read_b128 v[120:123], v22 offset:8192
    s_bfe_u32 s17, s15, 0x40000
    s_lshl_b32 s17, s17, 8
    s_add_u32 s20, s16, s17
    s_add_u32 m0, s18, 32768
    s_waitcnt lgkmcnt(5)
    v_mfma_f32_32x32x16_bf16 v[156:171], v[100:103], a[96:99], v[156:171]
    buffer_load_dwordx4 v2, s[8:11], s20 offen sc0 sc1 lds
    s_add_u32 m0, s18, 33792
    s_waitcnt lgkmcnt(4)
    v_mfma_f32_32x32x16_bf16 v[196:211], v[104:107], a[96:99], v[196:211]
    buffer_load_dwordx4 v3, s[8:11], s20 offen sc0 sc1 lds
    s_waitcnt lgkmcnt(3)
    v_mfma_f32_32x32x16_bf16 v[124:139], v[108:111], a[100:103], v[124:139]
    ds_read_b128 v[92:95], v15 offset:0
    ds_read_b128 v[96:99], v15 offset:8192
    s_waitcnt lgkmcnt(4)
    v_mfma_f32_32x32x16_bf16 v[140:155], v[112:115], a[100:103], v[140:155]
    ds_read_b128 v[100:103], v23 offset:0
    ds_read_b128 v[104:107], v23 offset:8192
    s_add_u32 m0, s18, 34816
    s_waitcnt lgkmcnt(5)
    v_mfma_f32_32x32x16_bf16 v[156:171], v[116:119], a[100:103], v[156:171]
    buffer_load_dwordx4 v4, s[8:11], s20 offen sc0 sc1 lds
    s_add_u32 m0, s18, 35840
    s_waitcnt lgkmcnt(4)
    v_mfma_f32_32x32x16_bf16 v[196:211], v[120:123], a[100:103], v[196:211]
    buffer_load_dwordx4 v5, s[8:11], s20 offen sc0 sc1 lds
    s_waitcnt lgkmcnt(3)
    v_mfma_f32_32x32x16_bf16 v[124:139], v[92:95], a[104:107], v[124:139]
    ds_read_b128 v[108:111], v16 offset:0
    ds_read_b128 v[112:115], v16 offset:8192
    s_waitcnt lgkmcnt(4)
    v_mfma_f32_32x32x16_bf16 v[140:155], v[96:99], a[104:107], v[140:155]
    ds_read_b128 v[116:119], v24 offset:0
    ds_read_b128 v[120:123], v24 offset:8192
    s_add_u32 s21, s20, 65536
    s_add_u32 m0, s18, 36864
    s_waitcnt lgkmcnt(5)
    v_mfma_f32_32x32x16_bf16 v[156:171], v[100:103], a[104:107], v[156:171]
    buffer_load_dwordx4 v2, s[8:11], s21 offen sc0 sc1 lds
    s_add_u32 m0, s18, 37888
    s_waitcnt lgkmcnt(4)
    v_mfma_f32_32x32x16_bf16 v[196:211], v[104:107], a[104:107], v[196:211]
    buffer_load_dwordx4 v3, s[8:11], s21 offen sc0 sc1 lds
    s_waitcnt lgkmcnt(0)
    s_waitcnt vmcnt(19)
    s_barrier
    v_mfma_f32_32x32x16_bf16 v[124:139], v[108:111], a[108:111], v[124:139]
    ds_read_b128 v[92:95], v13 offset:32768
    ds_read_b128 v[96:99], v13 offset:40960
    v_mfma_f32_32x32x16_bf16 v[140:155], v[112:115], a[108:111], v[140:155]
    ds_read_b128 v[100:103], v21 offset:32768
    ds_read_b128 v[104:107], v21 offset:40960
    s_add_u32 m0, s18, 38912
    v_mfma_f32_32x32x16_bf16 v[156:171], v[116:119], a[108:111], v[156:171]
    buffer_load_dwordx4 v4, s[8:11], s21 offen sc0 sc1 lds
    s_add_u32 m0, s18, 39936
    v_mfma_f32_32x32x16_bf16 v[196:211], v[120:123], a[108:111], v[196:211]
    buffer_load_dwordx4 v5, s[8:11], s21 offen sc0 sc1 lds
    s_waitcnt lgkmcnt(3)
    v_mfma_f32_32x32x16_bf16 v[124:139], v[92:95], a[112:115], v[124:139]
    ds_read_b128 v[108:111], v14 offset:32768
    ds_read_b128 v[112:115], v14 offset:40960
    s_waitcnt vmcnt(14)
    ds_read_b128 v[46:49], v38 offset:0
    ds_read_b128 v[172:175], v38 offset:256
    s_waitcnt lgkmcnt(6)
    v_mfma_f32_32x32x16_bf16 v[140:155], v[96:99], a[112:115], v[140:155]
    ds_read_b128 v[116:119], v22 offset:32768
    ds_read_b128 v[120:123], v22 offset:40960
    s_bfe_u32 s17, s15, 0x40004
    s_lshl_b32 s17, s17, 8
    s_add_u32 s20, s16, s17
    s_add_u32 m0, s18, 65536
    s_waitcnt lgkmcnt(7)
    v_mfma_f32_32x32x16_bf16 v[156:171], v[100:103], a[112:115], v[156:171]
    buffer_load_dwordx4 v2, s[8:11], s20 offen sc0 sc1 lds
    ds_read_b128 v[50:53], v38 offset:32
    ds_read_b128 v[176:179], v38 offset:288
    ds_read_b128 v[54:57], v38 offset:64
    s_add_u32 m0, s18, 66560
    s_waitcnt lgkmcnt(9)
    v_mfma_f32_32x32x16_bf16 v[196:211], v[104:107], a[112:115], v[196:211]
    buffer_load_dwordx4 v3, s[8:11], s20 offen sc0 sc1 lds
    ds_read_b128 v[184:187], v38 offset:320
    ds_read_b128 v[66:69], v38 offset:96
    ds_read_b128 v[188:191], v38 offset:352
    ds_read_b128 v[70:73], v38 offset:128
    s_waitcnt lgkmcnt(12)
    v_mfma_f32_32x32x16_bf16 v[124:139], v[108:111], a[116:119], v[124:139]
    ds_read_b128 v[92:95], v15 offset:32768
    ds_read_b128 v[96:99], v15 offset:40960
    ds_read_b128 v[192:195], v38 offset:384
    ds_read_b128 v[74:77], v38 offset:160
    ds_read_b128 v[212:215], v38 offset:416
    s_waitcnt lgkmcnt(15)
    v_mfma_f32_32x32x16_bf16 v[140:155], v[112:115], a[116:119], v[140:155]
    ds_read_b128 v[100:103], v23 offset:32768
    ds_read_b128 v[104:107], v23 offset:40960
    ds_read_b128 v[82:85], v38 offset:192
    ds_read_b128 v[216:219], v38 offset:448
    s_add_u32 m0, s18, 67584
    s_waitcnt lgkmcnt(15)
    v_mfma_f32_32x32x16_bf16 v[156:171], v[116:119], a[116:119], v[156:171]
    buffer_load_dwordx4 v4, s[8:11], s20 offen sc0 sc1 lds
    ds_read_b128 v[86:89], v38 offset:224
    ds_read_b128 v[220:223], v38 offset:480
    buffer_load_dwordx2 v[30:31], v28, s[8:11], 0 offen sc0 sc1
    s_add_u32 m0, s18, 68608
    v_mfma_f32_32x32x16_bf16 v[196:211], v[120:123], a[116:119], v[196:211]
    buffer_load_dwordx4 v5, s[8:11], s20 offen sc0 sc1 lds
    s_waitcnt lgkmcnt(10)
    v_mfma_f32_32x32x16_bf16 v[124:139], v[92:95], a[120:123], v[124:139]
    ds_read_b128 v[108:111], v16 offset:32768
    ds_read_b128 v[112:115], v16 offset:40960
    s_waitcnt lgkmcnt(11)
    v_mfma_f32_32x32x16_bf16 v[140:155], v[96:99], a[120:123], v[140:155]
    ds_read_b128 v[116:119], v24 offset:32768
    ds_read_b128 v[120:123], v24 offset:40960
    s_add_u32 s21, s20, 65536
    s_add_u32 m0, s18, 69632
    s_waitcnt lgkmcnt(9)
    v_mfma_f32_32x32x16_bf16 v[156:171], v[100:103], a[120:123], v[156:171]
    buffer_load_dwordx4 v2, s[8:11], s21 offen sc0 sc1 lds
    s_add_u32 m0, s18, 70656
    s_waitcnt lgkmcnt(8)
    v_mfma_f32_32x32x16_bf16 v[196:211], v[104:107], a[120:123], v[196:211]
    buffer_load_dwordx4 v3, s[8:11], s21 offen sc0 sc1 lds
    s_waitcnt lgkmcnt(0)
    s_waitcnt vmcnt(15)
    s_barrier
    v_mfma_f32_32x32x16_bf16 v[124:139], v[108:111], a[124:127], v[124:139]
    ds_read_b128 v[92:95], v9 offset:0
    ds_read_b128 v[96:99], v9 offset:8192
    v_mfma_f32_32x32x16_bf16 v[140:155], v[112:115], a[124:127], v[140:155]
    ds_read_b128 v[100:103], v17 offset:0
    ds_read_b128 v[104:107], v17 offset:8192
    s_add_u32 m0, s18, 71680
    v_mfma_f32_32x32x16_bf16 v[156:171], v[116:119], a[124:127], v[156:171]
    buffer_load_dwordx4 v4, s[8:11], s21 offen sc0 sc1 lds
    s_add_u32 m0, s18, 72704
    v_mfma_f32_32x32x16_bf16 v[196:211], v[120:123], a[124:127], v[196:211]
    buffer_load_dwordx4 v5, s[8:11], s21 offen sc0 sc1 lds
    s_waitcnt lgkmcnt(3)
    v_mfma_f32_32x32x16_bf16 v[124:139], v[92:95], a[128:131], v[124:139]
    ds_read_b128 v[108:111], v10 offset:0
    ds_read_b128 v[112:115], v10 offset:8192
    s_waitcnt lgkmcnt(4)
    v_mfma_f32_32x32x16_bf16 v[140:155], v[96:99], a[128:131], v[140:155]
    ds_read_b128 v[116:119], v18 offset:0
    ds_read_b128 v[120:123], v18 offset:8192
    s_bfe_u32 s17, s15, 0x40008
    s_lshl_b32 s17, s17, 8
    s_add_u32 s20, s16, s17
    s_add_u32 m0, s18, 98304
    s_waitcnt lgkmcnt(5)
    v_mfma_f32_32x32x16_bf16 v[156:171], v[100:103], a[128:131], v[156:171]
    buffer_load_dwordx4 v2, s[8:11], s20 offen sc0 sc1 lds
    s_add_u32 m0, s18, 99328
    s_waitcnt lgkmcnt(4)
    v_mfma_f32_32x32x16_bf16 v[196:211], v[104:107], a[128:131], v[196:211]
    buffer_load_dwordx4 v3, s[8:11], s20 offen sc0 sc1 lds
    s_waitcnt lgkmcnt(3)
    v_mfma_f32_32x32x16_bf16 v[124:139], v[108:111], a[132:135], v[124:139]
    ds_read_b128 v[92:95], v11 offset:0
    ds_read_b128 v[96:99], v11 offset:8192
    s_waitcnt lgkmcnt(4)
    v_mfma_f32_32x32x16_bf16 v[140:155], v[112:115], a[132:135], v[140:155]
    ds_read_b128 v[100:103], v19 offset:0
    ds_read_b128 v[104:107], v19 offset:8192
    s_add_u32 m0, s18, 100352
    s_waitcnt lgkmcnt(5)
    v_mfma_f32_32x32x16_bf16 v[156:171], v[116:119], a[132:135], v[156:171]
    buffer_load_dwordx4 v4, s[8:11], s20 offen sc0 sc1 lds
    s_add_u32 m0, s18, 101376
    s_waitcnt lgkmcnt(4)
    v_mfma_f32_32x32x16_bf16 v[196:211], v[120:123], a[132:135], v[196:211]
    buffer_load_dwordx4 v5, s[8:11], s20 offen sc0 sc1 lds
    s_waitcnt lgkmcnt(3)
    v_mfma_f32_32x32x16_bf16 v[124:139], v[92:95], a[136:139], v[124:139]
    ds_read_b128 v[108:111], v12 offset:0
    ds_read_b128 v[112:115], v12 offset:8192
    s_waitcnt lgkmcnt(4)
    v_mfma_f32_32x32x16_bf16 v[140:155], v[96:99], a[136:139], v[140:155]
    ds_read_b128 v[116:119], v20 offset:0
    ds_read_b128 v[120:123], v20 offset:8192
    s_add_u32 s21, s20, 65536
    s_add_u32 m0, s18, 102400
    s_waitcnt lgkmcnt(5)
    v_mfma_f32_32x32x16_bf16 v[156:171], v[100:103], a[136:139], v[156:171]
    buffer_load_dwordx4 v2, s[8:11], s21 offen sc0 sc1 lds
    s_add_u32 m0, s18, 103424
    s_waitcnt lgkmcnt(4)
    v_mfma_f32_32x32x16_bf16 v[196:211], v[104:107], a[136:139], v[196:211]
    buffer_load_dwordx4 v3, s[8:11], s21 offen sc0 sc1 lds
    s_waitcnt lgkmcnt(0)
    s_waitcnt vmcnt(15)
    s_barrier
    v_mfma_f32_32x32x16_bf16 v[124:139], v[108:111], a[140:143], v[124:139]
    ds_read_b128 v[92:95], v9 offset:32768
    ds_read_b128 v[96:99], v9 offset:40960
    v_mfma_f32_32x32x16_bf16 v[140:155], v[112:115], a[140:143], v[140:155]
    ds_read_b128 v[100:103], v17 offset:32768
    ds_read_b128 v[104:107], v17 offset:40960
    s_add_u32 m0, s18, 104448
    v_mfma_f32_32x32x16_bf16 v[156:171], v[116:119], a[140:143], v[156:171]
    buffer_load_dwordx4 v4, s[8:11], s21 offen sc0 sc1 lds
    s_add_u32 m0, s18, 105472
    v_mfma_f32_32x32x16_bf16 v[196:211], v[120:123], a[140:143], v[196:211]
    buffer_load_dwordx4 v5, s[8:11], s21 offen sc0 sc1 lds
    s_waitcnt lgkmcnt(3)
    v_mfma_f32_32x32x16_bf16 v[124:139], v[92:95], a[144:147], v[124:139]
    ds_read_b128 v[108:111], v10 offset:32768
    ds_read_b128 v[112:115], v10 offset:40960
    s_mov_b32 s4, 0
    s_waitcnt vmcnt(13)
    v_cmp_ne_u64 vcc, s[22:23], v[30:31]
    s_nop 4
    s_cbranch_vccz Lfdone_gate_13
Lfpoll_gate_14:
    buffer_load_dwordx2 v[30:31], v28, s[8:11], 0 offen sc0 sc1
    s_waitcnt vmcnt(0)
    v_cmp_ne_u64 vcc, s[22:23], v[30:31]
    s_nop 4
    s_add_u32 s4, s4, 1
    s_cmp_gt_u32 s4, 20000
    s_cbranch_scc1 Lfdone_gate_13
    s_cbranch_vccnz Lfpoll_gate_14
Lfdone_gate_13:
    s_add_u32 m0, s47, 147456
    s_nop 0
    buffer_load_dwordx4 v2, s[8:11], s45 offen sc0 sc1 lds
    s_add_u32 m0, s47, 148480
    s_nop 0
    buffer_load_dwordx4 v3, s[8:11], s45 offen sc0 sc1 lds
    s_waitcnt lgkmcnt(4)
    v_mfma_f32_32x32x16_bf16 v[140:155], v[96:99], a[144:147], v[140:155]
    ds_read_b128 v[116:119], v18 offset:32768
    ds_read_b128 v[120:123], v18 offset:40960
    s_bfe_u32 s17, s15, 0x4000c
    s_lshl_b32 s17, s17, 8
    s_add_u32 s20, s16, s17
    s_add_u32 m0, s18, 0
    s_waitcnt lgkmcnt(5)
    v_mfma_f32_32x32x16_bf16 v[156:171], v[100:103], a[144:147], v[156:171]
    buffer_load_dwordx4 v2, s[8:11], s20 offen sc0 sc1 lds
    s_add_u32 m0, s47, 149504
    s_nop 0
    buffer_load_dwordx4 v4, s[8:11], s45 offen sc0 sc1 lds
    s_add_u32 m0, s47, 150528
    s_nop 0
    buffer_load_dwordx4 v5, s[8:11], s45 offen sc0 sc1 lds
    s_add_u32 m0, s18, 1024
    s_waitcnt lgkmcnt(4)
    v_mfma_f32_32x32x16_bf16 v[196:211], v[104:107], a[144:147], v[196:211]
    buffer_load_dwordx4 v3, s[8:11], s20 offen sc0 sc1 lds
    s_waitcnt lgkmcnt(3)
    v_mfma_f32_32x32x16_bf16 v[124:139], v[108:111], a[148:151], v[124:139]
    ds_read_b128 v[92:95], v11 offset:32768
    ds_read_b128 v[96:99], v11 offset:40960
    s_waitcnt lgkmcnt(4)
    v_mfma_f32_32x32x16_bf16 v[140:155], v[112:115], a[148:151], v[140:155]
    ds_read_b128 v[100:103], v19 offset:32768
    ds_read_b128 v[104:107], v19 offset:40960
    s_add_u32 m0, s18, 2048
    s_waitcnt lgkmcnt(5)
    v_mfma_f32_32x32x16_bf16 v[156:171], v[116:119], a[148:151], v[156:171]
    buffer_load_dwordx4 v4, s[8:11], s20 offen sc0 sc1 lds
    s_add_u32 m0, s18, 3072
    s_waitcnt lgkmcnt(4)
    v_mfma_f32_32x32x16_bf16 v[196:211], v[120:123], a[148:151], v[196:211]
    buffer_load_dwordx4 v5, s[8:11], s20 offen sc0 sc1 lds
    s_waitcnt lgkmcnt(3)
    v_mfma_f32_32x32x16_bf16 v[124:139], v[92:95], a[152:155], v[124:139]
    ds_read_b128 v[108:111], v12 offset:32768
    ds_read_b128 v[112:115], v12 offset:40960
    s_waitcnt lgkmcnt(4)
    v_mfma_f32_32x32x16_bf16 v[140:155], v[96:99], a[152:155], v[140:155]
    ds_read_b128 v[116:119], v20 offset:32768
    ds_read_b128 v[120:123], v20 offset:40960
    s_add_u32 s21, s20, 65536
    s_add_u32 m0, s18, 4096
    s_waitcnt lgkmcnt(5)
    v_mfma_f32_32x32x16_bf16 v[156:171], v[100:103], a[152:155], v[156:171]
    buffer_load_dwordx4 v2, s[8:11], s21 offen sc0 sc1 lds
    s_add_u32 m0, s18, 5120
    s_waitcnt lgkmcnt(4)
    v_mfma_f32_32x32x16_bf16 v[196:211], v[104:107], a[152:155], v[196:211]
    buffer_load_dwordx4 v3, s[8:11], s21 offen sc0 sc1 lds
    s_waitcnt lgkmcnt(0)
    s_waitcnt vmcnt(18)
    s_barrier
    v_mfma_f32_32x32x16_bf16 v[124:139], v[108:111], a[156:159], v[124:139]
    ds_read_b128 v[92:95], v13 offset:0
    ds_read_b128 v[96:99], v13 offset:8192
    v_mfma_f32_32x32x16_bf16 v[140:155], v[112:115], a[156:159], v[140:155]
    ds_read_b128 v[100:103], v21 offset:0
    ds_read_b128 v[104:107], v21 offset:8192
    s_add_u32 m0, s18, 6144
    v_mfma_f32_32x32x16_bf16 v[156:171], v[116:119], a[156:159], v[156:171]
    buffer_load_dwordx4 v4, s[8:11], s21 offen sc0 sc1 lds
    s_add_u32 m0, s18, 7168
    v_mfma_f32_32x32x16_bf16 v[196:211], v[120:123], a[156:159], v[196:211]
    buffer_load_dwordx4 v5, s[8:11], s21 offen sc0 sc1 lds
    s_waitcnt lgkmcnt(3)
    v_mfma_f32_32x32x16_bf16 v[124:139], v[92:95], a[160:163], v[124:139]
    ds_read_b128 v[108:111], v14 offset:0
    ds_read_b128 v[112:115], v14 offset:8192
    s_waitcnt lgkmcnt(4)
    v_mfma_f32_32x32x16_bf16 v[140:155], v[96:99], a[160:163], v[140:155]
    ds_read_b128 v[116:119], v22 offset:0
    ds_read_b128 v[120:123], v22 offset:8192
    s_bfe_u32 s17, s15, 0x40010
    s_lshl_b32 s17, s17, 8
    s_add_u32 s20, s16, s17
    s_add_u32 m0, s18, 32768
    s_waitcnt lgkmcnt(5)
    v_mfma_f32_32x32x16_bf16 v[156:171], v[100:103], a[160:163], v[156:171]
    buffer_load_dwordx4 v2, s[8:11], s20 offen sc0 sc1 lds
    s_add_u32 m0, s18, 33792
    s_waitcnt lgkmcnt(4)
    v_mfma_f32_32x32x16_bf16 v[196:211], v[104:107], a[160:163], v[196:211]
    buffer_load_dwordx4 v3, s[8:11], s20 offen sc0 sc1 lds
    s_waitcnt lgkmcnt(3)
    v_mfma_f32_32x32x16_bf16 v[124:139], v[108:111], a[164:167], v[124:139]
    ds_read_b128 v[92:95], v15 offset:0
    ds_read_b128 v[96:99], v15 offset:8192
    s_waitcnt lgkmcnt(4)
    v_mfma_f32_32x32x16_bf16 v[140:155], v[112:115], a[164:167], v[140:155]
    ds_read_b128 v[100:103], v23 offset:0
    ds_read_b128 v[104:107], v23 offset:8192
    s_add_u32 m0, s18, 34816
    s_waitcnt lgkmcnt(5)
    v_mfma_f32_32x32x16_bf16 v[156:171], v[116:119], a[164:167], v[156:171]
    buffer_load_dwordx4 v4, s[8:11], s20 offen sc0 sc1 lds
    s_add_u32 m0, s18, 35840
    s_waitcnt lgkmcnt(4)
    v_mfma_f32_32x32x16_bf16 v[196:211], v[120:123], a[164:167], v[196:211]
    buffer_load_dwordx4 v5, s[8:11], s20 offen sc0 sc1 lds
    s_waitcnt lgkmcnt(3)
    v_mfma_f32_32x32x16_bf16 v[124:139], v[92:95], a[168:171], v[124:139]
    ds_read_b128 v[108:111], v16 offset:0
    ds_read_b128 v[112:115], v16 offset:8192
    s_waitcnt lgkmcnt(4)
    v_mfma_f32_32x32x16_bf16 v[140:155], v[96:99], a[168:171], v[140:155]
    ds_read_b128 v[116:119], v24 offset:0
    ds_read_b128 v[120:123], v24 offset:8192
    s_add_u32 s21, s20, 65536
    s_add_u32 m0, s18, 36864
    s_waitcnt lgkmcnt(5)
    v_mfma_f32_32x32x16_bf16 v[156:171], v[100:103], a[168:171], v[156:171]
    buffer_load_dwordx4 v2, s[8:11], s21 offen sc0 sc1 lds
    s_add_u32 m0, s18, 37888
    s_waitcnt lgkmcnt(4)
    v_mfma_f32_32x32x16_bf16 v[196:211], v[104:107], a[168:171], v[196:211]
    buffer_load_dwordx4 v3, s[8:11], s21 offen sc0 sc1 lds
    s_waitcnt lgkmcnt(0)
    s_waitcnt vmcnt(18)
    s_barrier
    v_mfma_f32_32x32x16_bf16 v[124:139], v[108:111], a[172:175], v[124:139]
    ds_read_b128 v[92:95], v13 offset:32768
    ds_read_b128 v[96:99], v13 offset:40960
    v_mfma_f32_32x32x16_bf16 v[140:155], v[112:115], a[172:175], v[140:155]
    ds_read_b128 v[100:103], v21 offset:32768
    ds_read_b128 v[104:107], v21 offset:40960
    s_add_u32 m0, s18, 38912
    v_mfma_f32_32x32x16_bf16 v[156:171], v[116:119], a[172:175], v[156:171]
    buffer_load_dwordx4 v4, s[8:11], s21 offen sc0 sc1 lds
    s_add_u32 m0, s18, 39936
    v_mfma_f32_32x32x16_bf16 v[196:211], v[120:123], a[172:175], v[196:211]
    buffer_load_dwordx4 v5, s[8:11], s21 offen sc0 sc1 lds
    s_waitcnt lgkmcnt(3)
    v_mfma_f32_32x32x16_bf16 v[124:139], v[92:95], a[176:179], v[124:139]
    ds_read_b128 v[108:111], v14 offset:32768
    ds_read_b128 v[112:115], v14 offset:40960
    s_waitcnt lgkmcnt(4)
    v_mfma_f32_32x32x16_bf16 v[140:155], v[96:99], a[176:179], v[140:155]
    ds_read_b128 v[116:119], v22 offset:32768
    ds_read_b128 v[120:123], v22 offset:40960
    s_bfe_u32 s17, s15, 0x40014
    s_lshl_b32 s17, s17, 8
    s_add_u32 s20, s16, s17
    s_add_u32 m0, s18, 65536
    s_waitcnt lgkmcnt(5)
    v_mfma_f32_32x32x16_bf16 v[156:171], v[100:103], a[176:179], v[156:171]
    buffer_load_dwordx4 v2, s[8:11], s20 offen sc0 sc1 lds
    s_add_u32 m0, s18, 66560
    s_waitcnt lgkmcnt(4)
    v_mfma_f32_32x32x16_bf16 v[196:211], v[104:107], a[176:179], v[196:211]
    buffer_load_dwordx4 v3, s[8:11], s20 offen sc0 sc1 lds
    s_waitcnt lgkmcnt(3)
    v_mfma_f32_32x32x16_bf16 v[124:139], v[108:111], a[180:183], v[124:139]
    ds_read_b128 v[92:95], v15 offset:32768
    ds_read_b128 v[96:99], v15 offset:40960
    s_waitcnt lgkmcnt(4)
    v_mfma_f32_32x32x16_bf16 v[140:155], v[112:115], a[180:183], v[140:155]
    ds_read_b128 v[100:103], v23 offset:32768
    ds_read_b128 v[104:107], v23 offset:40960
    s_add_u32 m0, s18, 67584
    s_waitcnt lgkmcnt(5)
    v_mfma_f32_32x32x16_bf16 v[156:171], v[116:119], a[180:183], v[156:171]
    buffer_load_dwordx4 v4, s[8:11], s20 offen sc0 sc1 lds
    s_add_u32 m0, s18, 68608
    s_waitcnt lgkmcnt(4)
    v_mfma_f32_32x32x16_bf16 v[196:211], v[120:123], a[180:183], v[196:211]
    buffer_load_dwordx4 v5, s[8:11], s20 offen sc0 sc1 lds
    s_waitcnt lgkmcnt(3)
    v_mfma_f32_32x32x16_bf16 v[124:139], v[92:95], a[184:187], v[124:139]
    ds_read_b128 v[108:111], v16 offset:32768
    ds_read_b128 v[112:115], v16 offset:40960
    s_waitcnt lgkmcnt(4)
    v_mfma_f32_32x32x16_bf16 v[140:155], v[96:99], a[184:187], v[140:155]
    ds_read_b128 v[116:119], v24 offset:32768
    ds_read_b128 v[120:123], v24 offset:40960
    s_add_u32 s21, s20, 65536
    s_add_u32 m0, s18, 69632
    s_waitcnt lgkmcnt(5)
    v_mfma_f32_32x32x16_bf16 v[156:171], v[100:103], a[184:187], v[156:171]
    buffer_load_dwordx4 v2, s[8:11], s21 offen sc0 sc1 lds
    s_add_u32 m0, s18, 70656
    s_waitcnt lgkmcnt(4)
    v_mfma_f32_32x32x16_bf16 v[196:211], v[104:107], a[184:187], v[196:211]
    buffer_load_dwordx4 v3, s[8:11], s21 offen sc0 sc1 lds
    s_waitcnt lgkmcnt(0)
    s_waitcnt vmcnt(14)
    s_barrier
    v_mfma_f32_32x32x16_bf16 v[124:139], v[108:111], a[188:191], v[124:139]
    ds_read_b128 v[92:95], v9 offset:0
    ds_read_b128 v[96:99], v9 offset:8192
    v_mfma_f32_32x32x16_bf16 v[140:155], v[112:115], a[188:191], v[140:155]
    ds_read_b128 v[100:103], v17 offset:0
    ds_read_b128 v[104:107], v17 offset:8192
    s_add_u32 m0, s18, 71680
    v_mfma_f32_32x32x16_bf16 v[156:171], v[116:119], a[188:191], v[156:171]
    buffer_load_dwordx4 v4, s[8:11], s21 offen sc0 sc1 lds
    s_add_u32 m0, s18, 72704
    v_mfma_f32_32x32x16_bf16 v[196:211], v[120:123], a[188:191], v[196:211]
    buffer_load_dwordx4 v5, s[8:11], s21 offen sc0 sc1 lds
    s_waitcnt lgkmcnt(3)
    v_mfma_f32_32x32x16_bf16 v[124:139], v[92:95], a[192:195], v[124:139]
    ds_read_b128 v[108:111], v10 offset:0
    ds_read_b128 v[112:115], v10 offset:8192
    v_lshlrev_b32 v64, 16, v64
    ds_read_b64_tr_b16 v[26:27], v35 offset:0
    v_xor_b32 v7, 0, v36
    s_waitcnt lgkmcnt(5)
    v_mfma_f32_32x32x16_bf16 v[140:155], v[96:99], a[192:195], v[140:155]
    ds_read_b128 v[116:119], v18 offset:0
    ds_read_b128 v[120:123], v18 offset:8192
    s_bfe_u32 s17, s15, 0x40018
    s_lshl_b32 s17, s17, 8
    s_add_u32 s20, s16, s17
    s_add_u32 m0, s18, 98304
    s_waitcnt lgkmcnt(6)
    v_mfma_f32_32x32x16_bf16 v[156:171], v[100:103], a[192:195], v[156:171]
    buffer_load_dwordx4 v2, s[8:11], s20 offen sc0 sc1 lds
    ds_read_b64 v[58:59], v7
    s_waitcnt lgkmcnt(0)
    v_lshlrev_b32 v224, 16, v58
    v_lshlrev_b32 v228, 16, v26
    s_add_u32 m0, s18, 99328
    v_mfma_f32_32x32x16_bf16 v[196:211], v[104:107], a[192:195], v[196:211]
    buffer_load_dwordx4 v3, s[8:11], s20 offen sc0 sc1 lds
    v_and_b32 v225, s5, v58
    v_and_b32 v229, s5, v26
    v_lshlrev_b32 v226, 16, v59
    v_lshlrev_b32 v230, 16, v27
    v_mfma_f32_32x32x16_bf16 v[124:139], v[108:111], a[196:199], v[124:139]
    ds_read_b128 v[92:95], v11 offset:0
    ds_read_b128 v[96:99], v11 offset:8192
    v_and_b32 v227, s5, v59
    v_and_b32 v231, s5, v27
    ds_read_b64_tr_b16 v[32:33], v35 offset:1024
    v_mfma_f32_32x32x16_bf16 v[140:155], v[112:115], a[196:199], v[140:155]
    ds_read_b128 v[100:103], v19 offset:0
    ds_read_b128 v[104:107], v19 offset:8192
    v_xor_b32 v7, 16, v36
    ds_read_b64 v[62:63], v7
    s_add_u32 m0, s18, 100352
    v_mfma_f32_32x32x16_bf16 v[156:171], v[116:119], a[196:199], v[156:171]
    buffer_load_dwordx4 v4, s[8:11], s20 offen sc0 sc1 lds
    v_mul_f32 v172, v172, v224
    v_mul_f32 v173, v173, v225
    v_mul_f32 v174, v174, v226
    s_add_u32 m0, s18, 101376
    v_mfma_f32_32x32x16_bf16 v[196:211], v[120:123], a[196:199], v[196:211]
    buffer_load_dwordx4 v5, s[8:11], s20 offen sc0 sc1 lds
    v_mul_f32 v175, v175, v227
    v_fmac_f32 v172, v46, v64
    v_fmac_f32 v173, v47, v64
    v_fmac_f32 v174, v48, v64
    s_waitcnt lgkmcnt(5)
    v_mfma_f32_32x32x16_bf16 v[124:139], v[92:95], a[200:203], v[124:139]
    ds_read_b128 v[108:111], v12 offset:0
    ds_read_b128 v[112:115], v12 offset:8192
    v_fmac_f32 v175, v49, v64
    v_mul_f32 v172, v172, v228
    v_mul_f32 v173, v173, v229
    s_waitcnt lgkmcnt(6)
    v_mfma_f32_32x32x16_bf16 v[140:155], v[96:99], a[200:203], v[140:155]
    ds_read_b128 v[116:119], v20 offset:0
    ds_read_b128 v[120:123], v20 offset:8192
    v_mul_f32 v174, v174, v230
    s_add_u32 s21, s20, 65536
    s_add_u32 m0, s18, 102400
    s_waitcnt lgkmcnt(6)
    v_mfma_f32_32x32x16_bf16 v[156:171], v[100:103], a[200:203], v[156:171]
    buffer_load_dwordx4 v2, s[8:11], s21 offen sc0 sc1 lds
    v_mul_f32 v175, v175, v231
    s_waitcnt lgkmcnt(4)
    v_lshlrev_b32 v224, 16, v62
    v_lshlrev_b32 v228, 16, v32
    s_add_u32 m0, s18, 103424
    v_mfma_f32_32x32x16_bf16 v[196:211], v[104:107], a[200:203], v[196:211]
    buffer_load_dwordx4 v3, s[8:11], s21 offen sc0 sc1 lds
    v_and_b32 v225, s5, v62
    v_and_b32 v229, s5, v32
    v_lshlrev_b32 v226, 16, v63
    v_lshlrev_b32 v230, 16, v33
    s_waitcnt lgkmcnt(0)
    s_waitcnt vmcnt(14)
    s_barrier
    v_mfma_f32_32x32x16_bf16 v[124:139], v[108:111], a[204:207], v[124:139]
    ds_read_b128 v[92:95], v9 offset:32768
    ds_read_b128 v[96:99], v9 offset:40960
    v_and_b32 v227, s5, v63
    v_and_b32 v231, s5, v33
    ds_read_b64_tr_b16 v[26:27], v35 offset:2048
    v_mfma_f32_32x32x16_bf16 v[140:155], v[112:115], a[204:207], v[140:155]
    ds_read_b128 v[100:103], v17 offset:32768
    ds_read_b128 v[104:107], v17 offset:40960
    v_xor_b32 v7, 32, v36
    ds_read_b64 v[58:59], v7
    s_add_u32 m0, s18, 104448
    v_mfma_f32_32x32x16_bf16 v[156:171], v[116:119], a[204:207], v[156:171]
    buffer_load_dwordx4 v4, s[8:11], s21 offen sc0 sc1 lds
    v_mul_f32 v176, v176, v224
    v_mul_f32 v177, v177, v225
    v_mul_f32 v178, v178, v226
    s_add_u32 m0, s18, 105472
    v_mfma_f32_32x32x16_bf16 v[196:211], v[120:123], a[204:207], v[196:211]
    buffer_load_dwordx4 v5, s[8:11], s21 offen sc0 sc1 lds
    v_mul_f32 v179, v179, v227
    v_fmac_f32 v176, v50, v64
    v_fmac_f32 v177, v51, v64
    v_fmac_f32 v178, v52, v64
    s_waitcnt lgkmcnt(5)
    v_mfma_f32_32x32x16_bf16 v[124:139], v[92:95], a[208:211], v[124:139]
    ds_read_b128 v[108:111], v10 offset:32768
    ds_read_b128 v[112:115], v10 offset:40960
    v_fmac_f32 v179, v53, v64
    v_mul_f32 v176, v176, v228
    v_mul_f32 v177, v177, v229
    s_waitcnt lgkmcnt(6)
    v_mfma_f32_32x32x16_bf16 v[140:155], v[96:99], a[208:211], v[140:155]
    ds_read_b128 v[116:119], v18 offset:32768
    ds_read_b128 v[120:123], v18 offset:40960
    v_mul_f32 v178, v178, v230
    v_mul_f32 v179, v179, v231
    s_waitcnt lgkmcnt(4)
    v_lshlrev_b32 v224, 16, v58
    v_mfma_f32_32x32x16_bf16 v[156:171], v[100:103], a[208:211], v[156:171]
    v_lshlrev_b32 v228, 16, v26
    v_and_b32 v225, s5, v58
    v_and_b32 v229, s5, v26
    v_lshlrev_b32 v226, 16, v59
    v_lshlrev_b32 v230, 16, v27
    v_mfma_f32_32x32x16_bf16 v[196:211], v[104:107], a[208:211], v[196:211]
    v_and_b32 v227, s5, v59
    v_and_b32 v231, s5, v27
    ds_read_b64_tr_b16 v[32:33], v35 offset:3072
    v_xor_b32 v7, 48, v36
    ds_read_b64 v[62:63], v7
    s_waitcnt lgkmcnt(5)
    v_mfma_f32_32x32x16_bf16 v[124:139], v[108:111], a[212:215], v[124:139]
    ds_read_b128 v[92:95], v11 offset:32768
    ds_read_b128 v[96:99], v11 offset:40960
    v_mul_f32 v184, v184, v224
    v_mul_f32 v185, v185, v225
    v_mul_f32 v186, v186, v226
    s_waitcnt lgkmcnt(6)
    v_mfma_f32_32x32x16_bf16 v[140:155], v[112:115], a[212:215], v[140:155]
    ds_read_b128 v[100:103], v19 offset:32768
    ds_read_b128 v[104:107], v19 offset:40960
    v_mul_f32 v187, v187, v227
    v_fmac_f32 v184, v54, v64
    v_fmac_f32 v185, v55, v64
    s_waitcnt lgkmcnt(7)
    v_mfma_f32_32x32x16_bf16 v[156:171], v[116:119], a[212:215], v[156:171]
    v_fmac_f32 v186, v56, v64
    v_fmac_f32 v187, v57, v64
    v_mul_f32 v184, v184, v228
    v_mul_f32 v185, v185, v229
    v_mul_f32 v186, v186, v230
    s_waitcnt lgkmcnt(6)
    v_mfma_f32_32x32x16_bf16 v[196:211], v[120:123], a[212:215], v[196:211]
    v_mul_f32 v187, v187, v231
    s_waitcnt lgkmcnt(4)
    v_lshlrev_b32 v224, 16, v62
    v_lshlrev_b32 v228, 16, v32
    v_and_b32 v225, s5, v62
    v_and_b32 v229, s5, v32
    s_waitcnt lgkmcnt(3)
    v_mfma_f32_32x32x16_bf16 v[124:139], v[92:95], a[216:219], v[124:139]
    ds_read_b128 v[108:111], v12 offset:32768
    ds_read_b128 v[112:115], v12 offset:40960
    v_lshlrev_b32 v226, 16, v63
    v_lshlrev_b32 v230, 16, v33
    v_and_b32 v227, s5, v63
    s_waitcnt lgkmcnt(4)
    v_mfma_f32_32x32x16_bf16 v[140:155], v[96:99], a[216:219], v[140:155]
    ds_read_b128 v[116:119], v20 offset:32768
    ds_read_b128 v[120:123], v20 offset:40960
    v_and_b32 v231, s5, v33
    ds_read_b64_tr_b16 v[26:27], v35 offset:4096
    v_xor_b32 v7, 64, v36
    s_waitcnt lgkmcnt(6)
    v_mfma_f32_32x32x16_bf16 v[156:171], v[100:103], a[216:219], v[156:171]
    ds_read_b64 v[58:59], v7
    v_mul_f32 v188, v188, v224
    v_mul_f32 v189, v189, v225
    v_mul_f32 v190, v190, v226
    v_mul_f32 v191, v191, v227
    s_waitcnt lgkmcnt(6)
    v_mfma_f32_32x32x16_bf16 v[196:211], v[104:107], a[216:219], v[196:211]
    v_fmac_f32 v188, v66, v64
    v_fmac_f32 v189, v67, v64
    v_fmac_f32 v190, v68, v64
    v_fmac_f32 v191, v69, v64
    v_mul_f32 v188, v188, v228
    s_waitcnt lgkmcnt(2)
    s_waitcnt vmcnt(8)
    s_barrier
    v_mfma_f32_32x32x16_bf16 v[124:139], v[108:111], a[220:223], v[124:139]
    ds_read_b128 v[92:95], v13 offset:0
    ds_read_b128 v[96:99], v13 offset:8192
    v_mul_f32 v189, v189, v229
    v_mul_f32 v190, v190, v230
    v_mul_f32 v191, v191, v231
    v_mfma_f32_32x32x16_bf16 v[140:155], v[112:115], a[220:223], v[140:155]
    ds_read_b128 v[100:103], v21 offset:0
    ds_read_b128 v[104:107], v21 offset:8192
    s_waitcnt lgkmcnt(4)
    v_lshlrev_b32 v224, 16, v58
    v_lshlrev_b32 v228, 16, v26
    v_and_b32 v225, s5, v58
    v_mfma_f32_32x32x16_bf16 v[156:171], v[116:119], a[220:223], v[156:171]
    v_and_b32 v229, s5, v26
    v_lshlrev_b32 v226, 16, v59
    v_lshlrev_b32 v230, 16, v27
    v_and_b32 v227, s5, v59
    v_and_b32 v231, s5, v27
    v_mfma_f32_32x32x16_bf16 v[196:211], v[120:123], a[220:223], v[196:211]
    ds_read_b64_tr_b16 v[32:33], v35 offset:5120
    v_xor_b32 v7, 80, v36
    ds_read_b64 v[62:63], v7
    v_mul_f32 v192, v192, v224
    v_mul_f32 v193, v193, v225
    s_waitcnt lgkmcnt(5)
    v_mfma_f32_32x32x16_bf16 v[124:139], v[92:95], a[224:227], v[124:139]
    ds_read_b128 v[108:111], v14 offset:0
    ds_read_b128 v[112:115], v14 offset:8192
    v_mul_f32 v194, v194, v226
    v_mul_f32 v195, v195, v227
    v_fmac_f32 v192, v70, v64
    s_waitcnt lgkmcnt(6)
    v_mfma_f32_32x32x16_bf16 v[140:155], v[96:99], a[224:227], v[140:155]
    ds_read_b128 v[116:119], v22 offset:0
    ds_read_b128 v[120:123], v22 offset:8192
    v_fmac_f32 v193, v71, v64
    v_fmac_f32 v194, v72, v64
    v_fmac_f32 v195, v73, v64
    s_waitcnt lgkmcnt(7)
    v_mfma_f32_32x32x16_bf16 v[156:171], v[100:103], a[224:227], v[156:171]
    v_mul_f32 v192, v192, v228
    v_mul_f32 v193, v193, v229
    v_mul_f32 v194, v194, v230
    v_mul_f32 v195, v195, v231
    s_waitcnt lgkmcnt(4)
    v_lshlrev_b32 v224, 16, v62
    v_mfma_f32_32x32x16_bf16 v[196:211], v[104:107], a[224:227], v[196:211]
    v_lshlrev_b32 v228, 16, v32
    v_and_b32 v225, s5, v62
    v_and_b32 v229, s5, v32
    v_lshlrev_b32 v226, 16, v63
    v_lshlrev_b32 v230, 16, v33
    s_waitcnt lgkmcnt(3)
    v_mfma_f32_32x32x16_bf16 v[124:139], v[108:111], a[228:231], v[124:139]
    ds_read_b128 v[92:95], v15 offset:0
    ds_read_b128 v[96:99], v15 offset:8192
    v_and_b32 v227, s5, v63
    v_and_b32 v231, s5, v33
    ds_read_b64_tr_b16 v[26:27], v35 offset:6144
    s_waitcnt lgkmcnt(5)
    v_mfma_f32_32x32x16_bf16 v[140:155], v[112:115], a[228:231], v[140:155]
    ds_read_b128 v[100:103], v23 offset:0
    ds_read_b128 v[104:107], v23 offset:8192
    v_xor_b32 v7, 96, v36
    ds_read_b64 v[58:59], v7
    v_mul_f32 v212, v212, v224
    s_waitcnt lgkmcnt(7)
    v_mfma_f32_32x32x16_bf16 v[156:171], v[116:119], a[228:231], v[156:171]
    v_mul_f32 v213, v213, v225
    v_mul_f32 v214, v214, v226
    v_mul_f32 v215, v215, v227
    v_fmac_f32 v212, v74, v64
    v_fmac_f32 v213, v75, v64
    s_waitcnt lgkmcnt(6)
    v_mfma_f32_32x32x16_bf16 v[196:211], v[120:123], a[228:231], v[196:211]
    v_fmac_f32 v214, v76, v64
    v_fmac_f32 v215, v77, v64
    v_mul_f32 v212, v212, v228
    v_mul_f32 v213, v213, v229
    v_mul_f32 v214, v214, v230
    s_waitcnt lgkmcnt(5)
    v_mfma_f32_32x32x16_bf16 v[124:139], v[92:95], a[232:235], v[124:139]
    ds_read_b128 v[108:111], v16 offset:0
    ds_read_b128 v[112:115], v16 offset:8192
    v_mul_f32 v215, v215, v231
    s_waitcnt lgkmcnt(2)
    v_lshlrev_b32 v224, 16, v58
    v_lshlrev_b32 v228, 16, v26
    v_mfma_f32_32x32x16_bf16 v[140:155], v[96:99], a[232:235], v[140:155]
    ds_read_b128 v[116:119], v24 offset:0
    ds_read_b128 v[120:123], v24 offset:8192
    v_and_b32 v225, s5, v58
    v_and_b32 v229, s5, v26
    v_lshlrev_b32 v226, 16, v59
    v_mfma_f32_32x32x16_bf16 v[156:171], v[100:103], a[232:235], v[156:171]
    v_lshlrev_b32 v230, 16, v27
    v_and_b32 v227, s5, v59
    v_and_b32 v231, s5, v27
    ds_read_b64_tr_b16 v[32:33], v35 offset:7168
    v_xor_b32 v7, 112, v36
    v_mfma_f32_32x32x16_bf16 v[196:211], v[104:107], a[232:235], v[196:211]
    ds_read_b64 v[62:63], v7
    v_mul_f32 v216, v216, v224
    v_mul_f32 v217, v217, v225
    v_mul_f32 v218, v218, v226
    v_mul_f32 v219, v219, v227
    s_waitcnt lgkmcnt(2)
    s_waitcnt vmcnt(0)
    s_barrier
    v_mfma_f32_32x32x16_bf16 v[124:139], v[108:111], a[236:239], v[124:139]
    ds_read_b128 v[92:95], v21 offset:32768
    ds_read_b128 v[96:99], v21 offset:40960
    v_fmac_f32 v216, v82, v64
    v_fmac_f32 v217, v83, v64
    v_fmac_f32 v218, v84, v64
    v_mfma_f32_32x32x16_bf16 v[140:155], v[112:115], a[236:239], v[140:155]
    ds_read_b128 v[100:103], v22 offset:32768
    ds_read_b128 v[104:107], v22 offset:40960
    v_fmac_f32 v219, v85, v64
    v_mul_f32 v216, v216, v228
    v_mul_f32 v217, v217, v229
    v_mfma_f32_32x32x16_bf16 v[156:171], v[116:119], a[236:239], v[156:171]
    v_mul_f32 v218, v218, v230
    v_mul_f32 v219, v219, v231
    s_waitcnt lgkmcnt(4)
    v_lshlrev_b32 v224, 16, v62
    v_lshlrev_b32 v228, 16, v32
    v_and_b32 v225, s5, v62
    v_mfma_f32_32x32x16_bf16 v[196:211], v[120:123], a[236:239], v[196:211]
    v_and_b32 v229, s5, v32
    v_lshlrev_b32 v226, 16, v63
    v_lshlrev_b32 v230, 16, v33
    v_and_b32 v227, s5, v63
    v_and_b32 v231, s5, v33
    s_waitcnt lgkmcnt(3)
    v_mfma_f32_32x32x16_bf16 v[156:171], v[92:95], a[240:243], v[156:171]
    ds_read_b128 v[108:111], v23 offset:32768
    ds_read_b128 v[112:115], v23 offset:40960
    v_mul_f32 v220, v220, v224
    v_mul_f32 v221, v221, v225
    v_mul_f32 v222, v222, v226
    s_waitcnt lgkmcnt(4)
    v_mfma_f32_32x32x16_bf16 v[196:211], v[96:99], a[240:243], v[196:211]
    ds_read_b128 v[116:119], v24 offset:32768
    ds_read_b128 v[120:123], v24 offset:40960
    v_mul_f32 v223, v223, v227
    v_fmac_f32 v220, v86, v64
    v_fmac_f32 v221, v87, v64
    s_waitcnt lgkmcnt(5)
    v_mfma_f32_32x32x16_bf16 v[156:171], v[100:103], a[244:247], v[156:171]
    v_fmac_f32 v222, v88, v64
    v_fmac_f32 v223, v89, v64
    v_mul_f32 v220, v220, v228
    v_mul_f32 v221, v221, v229
    v_mul_f32 v222, v222, v230
    s_waitcnt lgkmcnt(4)
    v_mfma_f32_32x32x16_bf16 v[196:211], v[104:107], a[244:247], v[196:211]
    v_mul_f32 v223, v223, v231
    s_waitcnt lgkmcnt(3)
    v_mfma_f32_32x32x16_bf16 v[156:171], v[108:111], a[248:251], v[156:171]
    ds_read_b128 v[92:95], v13 offset:32768
    ds_read_b128 v[96:99], v13 offset:40960
    s_waitcnt lgkmcnt(4)
    v_mfma_f32_32x32x16_bf16 v[196:211], v[112:115], a[248:251], v[196:211]
    ds_read_b128 v[100:103], v14 offset:32768
    ds_read_b128 v[104:107], v14 offset:40960
    s_waitcnt lgkmcnt(5)
    v_mfma_f32_32x32x16_bf16 v[156:171], v[116:119], a[252:255], v[156:171]
    s_waitcnt lgkmcnt(4)
    v_mfma_f32_32x32x16_bf16 v[196:211], v[120:123], a[252:255], v[196:211]
    s_waitcnt lgkmcnt(3)
    v_mfma_f32_32x32x16_bf16 v[124:139], v[92:95], a[240:243], v[124:139]
    ds_read_b128 v[108:111], v15 offset:32768
    ds_read_b128 v[112:115], v15 offset:40960
    s_nop 5
    ds_write_b128 v43, v[156:159] offset:0
    s_waitcnt lgkmcnt(5)
    v_mfma_f32_32x32x16_bf16 v[140:155], v[96:99], a[240:243], v[140:155]
    ds_read_b128 v[116:119], v16 offset:32768
    ds_read_b128 v[120:123], v16 offset:40960
    ds_write_b128 v43, v[160:163] offset:1024
    s_waitcnt lgkmcnt(7)
    v_mfma_f32_32x32x16_bf16 v[124:139], v[100:103], a[244:247], v[124:139]
    ds_write_b128 v43, v[164:167] offset:2048
    s_waitcnt lgkmcnt(7)
    v_mfma_f32_32x32x16_bf16 v[140:155], v[104:107], a[244:247], v[140:155]
    ds_write_b128 v43, v[168:171] offset:3072
    s_waitcnt lgkmcnt(3)
    v_mfma_f32_32x32x16_bf16 v[124:139], v[108:111], a[248:251], v[124:139]
    ds_write_b128 v43, v[196:199] offset:4096
    v_mfma_f32_32x32x16_bf16 v[140:155], v[112:115], a[248:251], v[140:155]
    ds_write_b128 v43, v[200:203] offset:5120
    v_mfma_f32_32x32x16_bf16 v[124:139], v[116:119], a[252:255], v[124:139]
    ds_write_b128 v43, v[204:207] offset:6144
    v_mfma_f32_32x32x16_bf16 v[140:155], v[120:123], a[252:255], v[140:155]
    ds_write_b128 v43, v[208:211] offset:7168
    s_waitcnt lgkmcnt(0)
    s_barrier
    ds_read_b128 v[92:95], v44 offset:0
    ds_read_b128 v[96:99], v44 offset:1024
    ds_read_b128 v[100:103], v44 offset:2048
    ds_read_b128 v[104:107], v44 offset:3072
    ds_read_b128 v[108:111], v44 offset:4096
    ds_read_b128 v[112:115], v44 offset:5120
    ds_read_b128 v[116:119], v44 offset:6144
    ds_read_b128 v[120:123], v44 offset:7168
    s_waitcnt lgkmcnt(7)
    v_add_f32 v124, v124, v92
    v_add_f32 v125, v125, v93
    v_add_f32 v126, v126, v94
    v_add_f32 v127, v127, v95
    v_fma_f32 v124, v46, v124, v172
    v_fma_f32 v125, v47, v125, v173
    v_fma_f32 v126, v48, v126, v174
    v_fma_f32 v127, v49, v127, v175
    buffer_store_dword v124, v39, s[32:35], s46 offen
    buffer_store_dword v125, v40, s[32:35], s46 offen
    buffer_store_dword v126, v41, s[32:35], s46 offen
    buffer_store_dword v127, v42, s[32:35], s46 offen
    s_waitcnt lgkmcnt(6)
    v_add_f32 v128, v128, v96
    v_add_f32 v129, v129, v97
    v_add_f32 v130, v130, v98
    v_add_f32 v131, v131, v99
    v_fma_f32 v128, v50, v128, v176
    v_fma_f32 v129, v51, v129, v177
    v_fma_f32 v130, v52, v130, v178
    v_fma_f32 v131, v53, v131, v179
    s_add_u32 s46, s46, 32768
    buffer_store_dword v128, v39, s[32:35], s46 offen
    buffer_store_dword v129, v40, s[32:35], s46 offen
    buffer_store_dword v130, v41, s[32:35], s46 offen
    buffer_store_dword v131, v42, s[32:35], s46 offen
    s_waitcnt lgkmcnt(5)
    v_add_f32 v132, v132, v100
    v_add_f32 v133, v133, v101
    v_add_f32 v134, v134, v102
    v_add_f32 v135, v135, v103
    v_fma_f32 v132, v54, v132, v184
    v_fma_f32 v133, v55, v133, v185
    v_fma_f32 v134, v56, v134, v186
    v_fma_f32 v135, v57, v135, v187
    s_add_u32 s46, s46, 32768
    buffer_store_dword v132, v39, s[32:35], s46 offen
    buffer_store_dword v133, v40, s[32:35], s46 offen
    buffer_store_dword v134, v41, s[32:35], s46 offen
    buffer_store_dword v135, v42, s[32:35], s46 offen
    s_waitcnt lgkmcnt(4)
    v_add_f32 v136, v136, v104
    v_add_f32 v137, v137, v105
    v_add_f32 v138, v138, v106
    v_add_f32 v139, v139, v107
    v_fma_f32 v136, v66, v136, v188
    v_fma_f32 v137, v67, v137, v189
    v_fma_f32 v138, v68, v138, v190
    v_fma_f32 v139, v69, v139, v191
    s_add_u32 s46, s46, 32768
    buffer_store_dword v136, v39, s[32:35], s46 offen
    buffer_store_dword v137, v40, s[32:35], s46 offen
    buffer_store_dword v138, v41, s[32:35], s46 offen
    buffer_store_dword v139, v42, s[32:35], s46 offen
    s_waitcnt lgkmcnt(3)
    v_add_f32 v140, v140, v108
    v_add_f32 v141, v141, v109
    v_add_f32 v142, v142, v110
    v_add_f32 v143, v143, v111
    v_fma_f32 v140, v70, v140, v192
    v_fma_f32 v141, v71, v141, v193
    v_fma_f32 v142, v72, v142, v194
    v_fma_f32 v143, v73, v143, v195
    s_add_u32 s46, s46, 32768
    buffer_store_dword v140, v39, s[32:35], s46 offen
    buffer_store_dword v141, v40, s[32:35], s46 offen
    buffer_store_dword v142, v41, s[32:35], s46 offen
    buffer_store_dword v143, v42, s[32:35], s46 offen
    s_waitcnt lgkmcnt(2)
    v_add_f32 v144, v144, v112
    v_add_f32 v145, v145, v113
    v_add_f32 v146, v146, v114
    v_add_f32 v147, v147, v115
    v_fma_f32 v144, v74, v144, v212
    v_fma_f32 v145, v75, v145, v213
    v_fma_f32 v146, v76, v146, v214
    v_fma_f32 v147, v77, v147, v215
    s_add_u32 s46, s46, 32768
    buffer_store_dword v144, v39, s[32:35], s46 offen
    buffer_store_dword v145, v40, s[32:35], s46 offen
    buffer_store_dword v146, v41, s[32:35], s46 offen
    buffer_store_dword v147, v42, s[32:35], s46 offen
    s_waitcnt lgkmcnt(1)
    v_add_f32 v148, v148, v116
    v_add_f32 v149, v149, v117
    v_add_f32 v150, v150, v118
    v_add_f32 v151, v151, v119
    v_fma_f32 v148, v82, v148, v216
    v_fma_f32 v149, v83, v149, v217
    v_fma_f32 v150, v84, v150, v218
    v_fma_f32 v151, v85, v151, v219
    s_add_u32 s46, s46, 32768
    buffer_store_dword v148, v39, s[32:35], s46 offen
    buffer_store_dword v149, v40, s[32:35], s46 offen
    buffer_store_dword v150, v41, s[32:35], s46 offen
    buffer_store_dword v151, v42, s[32:35], s46 offen
    s_waitcnt lgkmcnt(0)
    v_add_f32 v152, v152, v120
    v_add_f32 v153, v153, v121
    v_add_f32 v154, v154, v122
    v_add_f32 v155, v155, v123
    v_fma_f32 v152, v86, v152, v220
    v_fma_f32 v153, v87, v153, v221
    v_fma_f32 v154, v88, v154, v222
    v_fma_f32 v155, v89, v155, v223
    s_add_u32 s46, s46, 32768
    buffer_store_dword v152, v39, s[32:35], s46 offen
    buffer_store_dword v153, v40, s[32:35], s46 offen
    buffer_store_dword v154, v41, s[32:35], s46 offen
    buffer_store_dword v155, v42, s[32:35], s46 offen
Lend_gated_mix__ssm_conv_s5__ssm_conv_h3__prompt_kernel:
    s_endpgm

.section .rodata,"a"
.p2align 6
.amdhsa_kernel gated_mix__ssm_conv_s5__ssm_conv_h3__prompt_kernel
  .amdhsa_next_free_vgpr 504
  .amdhsa_next_free_sgpr 92
  .amdhsa_accum_offset 248
  .amdhsa_group_segment_fixed_size 0
  .amdhsa_kernarg_size 152
  .amdhsa_user_sgpr_count 2
  .amdhsa_user_sgpr_kernarg_segment_ptr 1
  .amdhsa_system_sgpr_workgroup_id_x 1
  .amdhsa_float_denorm_mode_32 3
.end_amdhsa_kernel
```

```asm
; @launch grid=(256,1,1) block=(256,1,1) lds=163840
.amdgcn_target "amdgcn-amd-amdhsa--gfx950"
.text
.globl gated_mix__ssm_conv_s5__ssm_conv_h3__prompt_kernel
.p2align 8
.type gated_mix__ssm_conv_s5__ssm_conv_h3__prompt_kernel,@function
gated_mix__ssm_conv_s5__ssm_conv_h3__prompt_kernel:
    s_cmp_ge_u32 s2, 256
    s_cbranch_scc1 Lend_gated_mix__ssm_conv_s5__ssm_conv_h3__prompt_kernel
    s_load_dwordx16 s[4:19], s[0:1], 0
    s_load_dwordx16 s[20:35], s[0:1], 64
    s_load_dwordx4 s[36:39], s[0:1], 128
    s_load_dwordx2 s[40:41], s[0:1], 144
    s_getpc_b64 s[42:43]
Lcpf_pc:
    s_bfe_u32 s3, s2, 0x10003
    s_lshl_b32 s3, s3, 15
    v_lshlrev_b32 v1, 7, v0
    v_add_u32 v1, s3, v1
    v_min_u32 v1, Lcode_last-Lcpf_pc, v1
    v_mov_b32 v3, s43
    v_add_co_u32 v2, vcc, s42, v1
    s_nop 1
    v_addc_co_u32 v3, vcc, 0, v3, vcc
    global_load_dword v1, v[2:3], off
    s_memrealtime s[42:43]
    v_lshrrev_b32 v2, 6, v0
    s_nop 0
    v_readfirstlane_b32 s44, v2
    v_and_b32 v2, 63, v0
    s_and_b32 s47, s2, 7
    s_lshr_b32 s45, s47, 1
    s_lshl_b32 s45, s45, 2
    s_and_b32 s46, s47, 1
    s_lshl_b32 s46, s46, 3
    s_lshr_b32 s47, s2, 3
    s_and_b32 s3, s47, 3
    s_add_u32 s45, s45, s3
    s_lshr_b32 s47, s47, 2
    s_add_u32 s46, s46, s47
    v_mov_b32 v4, 0
    v_mov_b32 v5, 0
    v_mov_b32 v6, 0
    v_mov_b32 v7, 0
    v_lshlrev_b32 v3, 4, v0
    v_add_u32 v3, 148480, v3
    ds_write_b128 v3, v[4:7]
    v_lshlrev_b32 v3, 2, v0
    v_add_u32 v3, 152576, v3
    ds_write_b32 v3, v4
    v_lshrrev_b32 v16, 4, v2
    v_and_b32 v17, 7, v2
    v_xor_b32 v17, v17, v16
    v_lshlrev_b32 v17, 4, v17
    v_lshrrev_b32 v16, 3, v2
    v_lshl_add_u32 v12, v16, 11, v17
    v_and_b32 v16, 32, v2
    v_lshl_add_u32 v8, v16, 11, v17
    v_and_b32 v16, 8, v2
    v_lshl_add_u32 v8, v16, 12, v8
    v_and_b32 v16, 16, v2
    v_lshl_add_u32 v8, v16, 7, v8
    v_xor_b32 v16, 64, v8
    v_xor_b32 v17, 64, v12
    v_add_u32 v9, 4096, v16
    v_add_u32 v10, 8192, v8
    v_add_u32 v11, 12288, v16
    v_add_u32 v13, 16384, v17
    v_add_u32 v14, 32768, v12
    v_add_u32 v15, 49152, v17
    s_lshr_b32 s50, s44, 1
    s_lshl_b32 s47, s45, 7
    s_lshl_b32 s3, s50, 6
    s_add_u32 s47, s47, s3
    s_and_b32 s3, s44, 1
    s_lshl_b32 s3, s3, 3
    s_add_u32 s47, s47, s3
    s_lshl_b32 s47, s47, 11
    s_lshl_b32 s48, s46, 6
    s_lshl_b32 s3, s50, 5
    s_add_u32 s48, s48, s3
    s_lshl_b32 s48, s48, 11
    s_lshl_b32 s49, s44, 12
    s_lshl_b32 s3, s45, 2
    s_add_u32 s3, s3, s46
    s_and_b32 s3, s3, 15
    s_lshl_b32 s51, s3, 7
    v_bfe_u32 v17, v2, 3, 2
    v_lshrrev_b32 v18, 5, v2
    v_lshlrev_b32 v18, 2, v18
    v_lshl_add_u32 v17, v17, 3, v18
    v_and_b32 v18, 7, v2
    v_lshlrev_b32 v18, 4, v18
    v_lshl_add_u32 v16, v17, 11, v18
    s_lshl_b32 s50, s45, 7
    s_lshl_b32 s3, s44, 5
    s_add_u32 s50, s50, s3
    s_lshl_b32 s50, s50, 11
    s_lshl_b32 s3, s46, 7
    s_add_u32 s50, s50, s3
    v_add_u32 v16, s50, v16
    v_subrev_u32 v18, 6144, v16
    v_min_u32 v18, 0x7fff0000, v18
    v_subrev_u32 v22, 4096, v16
    v_min_u32 v22, 0x7fff0000, v22
    v_subrev_u32 v26, 2048, v16
    v_min_u32 v26, 0x7fff0000, v26
    s_mov_b32 s50, 4096
    s_lshl_b32 s54, s46, 9
    v_lshlrev_b32 v17, 4, v2
    s_waitcnt lgkmcnt(0)
    s_mov_b32 s56, s4
    s_mov_b32 s57, s5
    s_mov_b32 s58, 4194304
    s_mov_b32 s59, 131072
    s_and_b32 s3, s44, 1
    s_cmp_eq_u32 s3, 0
    s_cselect_b32 s60, s10, s12
    s_cselect_b32 s61, s11, s13
    s_mov_b32 s62, 2097152
    s_mov_b32 s63, 131072
    s_add_u32 s52, s47, s51
    s_add_u32 m0, s49, 0
    s_nop 0
    buffer_load_dwordx4 v8, s[56:59], s52 offen  lds
    s_add_u32 m0, s49, 1024
    s_nop 0
    buffer_load_dwordx4 v9, s[56:59], s52 offen  lds
    s_add_u32 m0, s49, 2048
    s_nop 0
    buffer_load_dwordx4 v10, s[56:59], s52 offen  lds
    s_add_u32 m0, s49, 3072
    s_nop 0
    buffer_load_dwordx4 v11, s[56:59], s52 offen  lds
    s_add_u32 s53, s48, s51
    s_add_u32 m0, s49, 16384
    s_nop 0
    buffer_load_dwordx4 v12, s[60:63], s53 offen  lds
    s_add_u32 m0, s49, 17408
    s_nop 0
    buffer_load_dwordx4 v13, s[60:63], s53 offen  lds
    s_add_u32 m0, s49, 18432
    s_nop 0
    buffer_load_dwordx4 v14, s[60:63], s53 offen  lds
    s_add_u32 m0, s49, 19456
    s_nop 0
    buffer_load_dwordx4 v15, s[60:63], s53 offen  lds
    s_add_u32 s51, s51, 128
    s_and_b32 s51, s51, 0x7ff
    s_add_u32 s52, s47, s51
    s_add_u32 m0, s49, 32768
    s_nop 0
    buffer_load_dwordx4 v8, s[56:59], s52 offen  lds
    s_add_u32 m0, s49, 33792
    s_nop 0
    buffer_load_dwordx4 v9, s[56:59], s52 offen  lds
    s_add_u32 m0, s49, 34816
    s_nop 0
    buffer_load_dwordx4 v10, s[56:59], s52 offen  lds
    s_add_u32 m0, s49, 35840
    s_nop 0
    buffer_load_dwordx4 v11, s[56:59], s52 offen  lds
    s_add_u32 s53, s48, s51
    s_add_u32 m0, s49, 49152
    s_nop 0
    buffer_load_dwordx4 v12, s[60:63], s53 offen  lds
    s_add_u32 m0, s49, 50176
    s_nop 0
    buffer_load_dwordx4 v13, s[60:63], s53 offen  lds
    s_add_u32 m0, s49, 51200
    s_nop 0
    buffer_load_dwordx4 v14, s[60:63], s53 offen  lds
    s_add_u32 m0, s49, 52224
    s_nop 0
    buffer_load_dwordx4 v15, s[60:63], s53 offen  lds
    s_mov_b32 s64, s28
    s_mov_b32 s65, s29
    s_mov_b32 s66, 8192
    s_mov_b32 s67, 131072
    s_mov_b32 s68, s24
    s_mov_b32 s69, s25
    s_mov_b32 s70, 4194304
    s_mov_b32 s71, 131072
    s_mov_b32 s72, s26
    s_mov_b32 s73, s27
    s_mov_b32 s74, 4194304
    s_mov_b32 s75, 131072
    s_lshl_b32 s3, s44, 10
    s_add_u32 s4, s3, 157696
    s_mov_b32 s24, s38
    s_mov_b32 s25, s39
    s_mov_b32 s26, 256
    s_mov_b32 s27, 131072
    s_or_b32 s3, s2, s44
    s_cmp_lg_u32 s3, 0
    s_cbranch_scc1 Lnonce_gate_1
    v_mov_b32 v4, s42
    v_mov_b32 v5, s43
    v_mov_b32 v3, 0
    buffer_store_dwordx2 v[4:5], v3, s[24:27], 0 offen sc0 sc1
    s_nop 1
Lnonce_gate_1:
    s_mov_b32 s5, 0xffff0000
    v_mov_b32 v6, 0
    s_and_b32 s3, s44, 1
    s_lshl_b32 s3, s3, 5
    v_and_b32 v7, 31, v2
    v_add_u32 v7, s3, v7
    s_lshl_b32 s3, s46, 6
    v_add_u32 v62, s3, v7
    v_lshlrev_b32 v62, 1, v62
    s_mov_b32 s76, s6
    s_mov_b32 s77, s7
    s_mov_b32 s78, 2048
    s_mov_b32 s79, 131072
    buffer_load_ushort v63, v62, s[76:79], 0 offen
    s_mov_b32 s76, s8
    s_mov_b32 s77, s9
    s_mov_b32 s78, 2048
    s_mov_b32 s79, 131072
    buffer_load_ushort v64, v62, s[76:79], 0 offen
    s_mov_b32 s8, s18
    s_mov_b32 s9, s19
    s_mov_b32 s10, 2048
    s_mov_b32 s11, 131072
    buffer_load_ushort v65, v62, s[8:11], 0 offen
    v_and_b32 v82, 31, v2
    v_bfe_u32 v83, v82, 1, 3
    v_lshrrev_b32 v84, 5, v2
    v_xor_b32 v83, v83, v84
    v_lshlrev_b32 v83, 4, v83
    v_lshl_add_u32 v83, v82, 7, v83
    s_lshr_b32 s6, s44, 1
    s_lshl_b32 s6, s6, 13
    s_and_b32 s7, s44, 1
    s_lshl_b32 s7, s7, 13
    s_add_u32 s7, s7, 16384
    v_xor_b32 v84, 0, v83
    v_add_u32 v66, s6, v84
    v_add_u32 v74, s7, v84
    v_add_u32 v70, 0x10000, v66
    v_add_u32 v78, 0x10000, v74
    v_xor_b32 v84, 32, v83
    v_add_u32 v67, s6, v84
    v_add_u32 v75, s7, v84
    v_add_u32 v71, 0x10000, v67
    v_add_u32 v79, 0x10000, v75
    v_xor_b32 v84, 64, v83
    v_add_u32 v68, s6, v84
    v_add_u32 v76, s7, v84
    v_add_u32 v72, 0x10000, v68
    v_add_u32 v80, 0x10000, v76
    v_xor_b32 v84, 96, v83
    v_add_u32 v69, s6, v84
    v_add_u32 v77, s7, v84
    v_add_u32 v73, 0x10000, v69
    v_add_u32 v81, 0x10000, v77
    s_mov_b32 s8, s40
    s_mov_b32 s9, s41
    s_mov_b32 s10, 33554432
    s_mov_b32 s11, 131072
    v_and_b32 v82, 7, v2
    s_lshl_b32 s3, s44, 10
    s_add_u32 s3, s3, 157696
    v_lshl_add_u32 v180, v82, 6, s3
    v_bfe_u32 v82, v2, 2, 1
    v_lshlrev_b32 v82, 3, v82
    v_lshrrev_b32 v83, 5, v2
    v_add_u32 v82, v82, v83
    v_lshlrev_b32 v181, 14, v82
    v_bfe_u32 v82, v2, 3, 2
    v_sub_u32 v82, 3, v82
    v_lshl_add_u32 v181, v82, 6, v181
    v_and_b32 v82, 3, v2
    v_lshl_add_u32 v181, v82, 4, v181
    s_lshl_b32 s6, s46, 18
    s_add_u32 s6, s6, 8404736
    s_lshl_b32 s3, s45, 10
    s_sub_u32 s6, s6, s3
    s_lshl_b32 s3, s44, 8
    s_sub_u32 s6, s6, s3
    s_lshl_b32 s13, s46, 4
    s_add_u32 s13, s13, s45
    s_lshl_b32 s13, s13, 2
    s_add_u32 s13, s13, s44
    s_lshl_b32 s13, s13, 3
    s_add_u32 s13, s13, 21495808
    s_lshl_b32 s18, s46, 2
    s_add_u32 s18, s18, s44
    s_lshl_b32 s18, s18, 4
    s_add_u32 s18, s18, s45
    s_lshl_b32 s18, s18, 3
    s_add_u32 s18, s18, 21504000
    s_lshl_b32 s3, s46, 9
    s_add_u32 s3, s3, 21495808
    v_lshrrev_b32 v182, 1, v17
    v_add_u32 v182, s3, v182
    s_lshl_b32 s19, s46, 6
    s_lshr_b32 s3, s45, 3
    s_lshl_b32 s3, s3, 5
    s_add_u32 s19, s19, s3
    s_lshl_b32 s3, s44, 3
    s_add_u32 s19, s19, s3
    s_and_b32 s3, s45, 7
    s_add_u32 s19, s19, s3
    s_lshl_b32 s22, s19, 12
    s_add_u32 s76, s30, s22
    s_addc_u32 s77, s31, 0
    s_mov_b32 s78, 4096
    s_mov_b32 s79, 131072
    s_mov_b32 s80, s32
    s_mov_b32 s81, s33
    s_mov_b32 s82, 2048
    s_mov_b32 s83, 131072
    s_lshl_b32 s3, s19, 1
    v_mov_b32 v183, s3
    buffer_load_ushort v183, v183, s[80:83], 0 offen
    s_mul_i32 s23, s44, 16640
    s_add_u32 s23, s23, 65536
    v_lshrrev_b32 v224, 4, v2
    v_and_b32 v225, 3, v2
    v_xor_b32 v225, v225, v224
    v_lshlrev_b32 v225, 4, v225
    v_lshrrev_b32 v224, 2, v2
    v_lshl_add_u32 v207, v224, 6, v225
    s_lshl_b32 s28, s46, 4
    s_add_u32 s28, s28, s45
    s_lshl_b32 s28, s28, 14
    s_lshl_b32 s29, s44, 12
    s_add_u32 s28, s28, s29
    s_add_u32 s28, s28, 8388608
    s_add_u32 s29, s29, 132096
    s_mov_b32 s80, s14
    s_mov_b32 s81, s15
    s_mov_b32 s82, 2097152
    s_mov_b32 s83, 131072
    s_mov_b32 s84, s16
    s_mov_b32 s85, s17
    s_mov_b32 s86, 2097152
    s_mov_b32 s87, 131072
    v_lshrrev_b32 v225, 2, v2
    v_lshrrev_b32 v226, 4, v2
    v_xor_b32 v226, v226, v2
    v_and_b32 v226, 3, v226
    v_lshlrev_b32 v226, 4, v226
    v_lshl_add_u32 v224, v225, 11, v226
    s_lshl_b32 s14, s46, 17
    s_and_b32 s3, s44, 1
    s_lshl_b32 s3, s3, 16
    s_add_u32 s14, s14, s3
    s_lshl_b32 s3, s45, 7
    s_add_u32 s14, s14, s3
    s_lshr_b32 s3, s44, 1
    s_lshl_b32 s3, s3, 6
    s_add_u32 s14, s14, s3
    s_add_u32 s15, s14, 32768
    s_lshl_b32 s16, s44, 12
    s_add_u32 s16, s16, 132096
    s_mov_b32 s88, s34
    s_mov_b32 s89, s35
    s_mov_b32 s90, 2048
    s_mov_b32 s91, 131072
    s_lshl_b32 s17, s45, 7
    s_lshl_b32 s3, s46, 3
    s_add_u32 s17, s17, s3
    s_lshl_b32 s3, s44, 1
    s_add_u32 s17, s17, s3
    s_lshl_b32 s3, s17, 2
    s_add_u32 s3, s3, 20971520
    v_mov_b32 v225, s3
    s_lshl_b32 s17, s17, 11
    s_mov_b32 s32, 8192
    buffer_load_dwordx4 v[208:211], v17, s[88:91], 0 offen offset:0
    buffer_load_dwordx4 v[212:215], v17, s[88:91], 0 offen offset:1024
    buffer_load_dwordx4 v[46:49], v17, s[56:59], s17 offen offset:0
    buffer_load_dwordx4 v[50:53], v17, s[56:59], s17 offen offset:1024
    buffer_load_dwordx4 v[54:57], v17, s[56:59], s17 offen offset:2048
    buffer_load_dwordx4 v[58:61], v17, s[56:59], s17 offen offset:3072
    s_waitcnt vmcnt(18)
    s_barrier
    ds_read_b128 v[84:87], v66 offset:0
    ds_read_b128 v[92:95], v74 offset:0
    ds_read_b128 v[96:99], v74 offset:4096
    ds_read_b128 v[88:91], v66 offset:4096
    s_add_u32 s51, s51, 128
    s_and_b32 s51, s51, 0x7ff
    s_add_u32 s52, s47, s51
    s_add_u32 m0, s49, 65536
    s_waitcnt lgkmcnt(2)
    v_mfma_f32_32x32x16_bf16 v[116:131], v[84:87], v[92:95], 0
    ds_read_b128 v[100:103], v67 offset:0
    ds_read_b128 v[108:111], v75 offset:0
    buffer_load_dwordx4 v8, s[56:59], s52 offen  lds
    s_add_u32 m0, s49, 66560
    s_waitcnt lgkmcnt(3)
    v_mfma_f32_32x32x16_bf16 v[132:147], v[84:87], v[96:99], 0
    ds_read_b128 v[112:115], v75 offset:4096
    ds_read_b128 v[104:107], v67 offset:4096
    buffer_load_dwordx4 v9, s[56:59], s52 offen  lds
    s_add_u32 m0, s49, 67584
    s_waitcnt lgkmcnt(4)
    v_mfma_f32_32x32x16_bf16 v[148:163], v[88:91], v[92:95], 0
    buffer_load_dwordx4 v10, s[56:59], s52 offen  lds
    s_add_u32 m0, s49, 68608
    v_mfma_f32_32x32x16_bf16 v[164:179], v[88:91], v[96:99], 0
    buffer_load_dwordx4 v11, s[56:59], s52 offen  lds
    s_add_u32 s53, s48, s51
    s_add_u32 m0, s49, 81920
    s_waitcnt lgkmcnt(2)
    v_mfma_f32_32x32x16_bf16 v[116:131], v[100:103], v[108:111], v[116:131]
    ds_read_b128 v[84:87], v68 offset:0
    ds_read_b128 v[92:95], v76 offset:0
    buffer_load_dwordx4 v12, s[60:63], s53 offen  lds
    s_add_u32 m0, s49, 82944
    s_waitcnt lgkmcnt(3)
    v_mfma_f32_32x32x16_bf16 v[132:147], v[100:103], v[112:115], v[132:147]
    ds_read_b128 v[96:99], v76 offset:4096
    ds_read_b128 v[88:91], v68 offset:4096
    buffer_load_dwordx4 v13, s[60:63], s53 offen  lds
    s_add_u32 m0, s49, 83968
    s_waitcnt lgkmcnt(4)
    v_mfma_f32_32x32x16_bf16 v[148:163], v[104:107], v[108:111], v[148:163]
    buffer_load_dwordx4 v14, s[60:63], s53 offen  lds
    s_add_u32 m0, s49, 84992
    v_mfma_f32_32x32x16_bf16 v[164:179], v[104:107], v[112:115], v[164:179]
    buffer_load_dwordx4 v15, s[60:63], s53 offen  lds
    s_add_u32 s51, s51, 128
    s_and_b32 s51, s51, 0x7ff
    s_add_u32 s52, s47, s51
    s_add_u32 m0, s49, 98304
    s_waitcnt lgkmcnt(2)
    v_mfma_f32_32x32x16_bf16 v[116:131], v[84:87], v[92:95], v[116:131]
    ds_read_b128 v[100:103], v69 offset:0
    ds_read_b128 v[108:111], v77 offset:0
    buffer_load_dwordx4 v8, s[56:59], s52 offen  lds
    s_add_u32 m0, s49, 99328
    s_waitcnt lgkmcnt(3)
    v_mfma_f32_32x32x16_bf16 v[132:147], v[84:87], v[96:99], v[132:147]
    ds_read_b128 v[112:115], v77 offset:4096
    ds_read_b128 v[104:107], v69 offset:4096
    buffer_load_dwordx4 v9, s[56:59], s52 offen  lds
    s_add_u32 m0, s49, 100352
    s_waitcnt lgkmcnt(4)
    v_mfma_f32_32x32x16_bf16 v[148:163], v[88:91], v[92:95], v[148:163]
    buffer_load_dwordx4 v10, s[56:59], s52 offen  lds
    s_add_u32 m0, s49, 101376
    v_mfma_f32_32x32x16_bf16 v[164:179], v[88:91], v[96:99], v[164:179]
    buffer_load_dwordx4 v11, s[56:59], s52 offen  lds
    s_waitcnt lgkmcnt(0)
    s_waitcnt vmcnt(22)
    s_barrier
    s_add_u32 s53, s48, s51
    s_add_u32 m0, s49, 114688
    v_mfma_f32_32x32x16_bf16 v[116:131], v[100:103], v[108:111], v[116:131]
    ds_read_b128 v[84:87], v66 offset:32768
    ds_read_b128 v[92:95], v74 offset:32768
    buffer_load_dwordx4 v12, s[60:63], s53 offen  lds
    s_waitcnt vmcnt(22)
    v_lshlrev_b32 v63, 16, v63
    s_waitcnt vmcnt(21)
    v_lshlrev_b32 v64, 16, v64
    s_waitcnt vmcnt(20)
    v_lshlrev_b32 v65, 16, v65
    v_mul_f32 v242, 1069066811, v65
    s_add_u32 m0, s49, 115712
    v_mfma_f32_32x32x16_bf16 v[132:147], v[100:103], v[112:115], v[132:147]
    ds_read_b128 v[96:99], v74 offset:36864
    ds_read_b128 v[88:91], v66 offset:36864
    buffer_load_dwordx4 v13, s[60:63], s53 offen  lds
    v_exp_f32 v242, v242
    s_nop 0
    v_cvt_pk_bf16_f32 v242, v242, v242
    v_lshlrev_b32 v242, 16, v242
    v_mul_f32 v243, v242, v63
    s_add_u32 m0, s49, 116736
    v_mfma_f32_32x32x16_bf16 v[148:163], v[104:107], v[108:111], v[148:163]
    buffer_load_dwordx4 v14, s[60:63], s53 offen  lds
    v_mul_f32 v244, v242, v64
    v_mul_f32 v243, 1069066811, v243
    v_exp_f32 v243, v243
    v_mul_f32 v244, 1042479491, v244
    v_fract_f32 v244, v244
    v_cos_f32 v245, v244
    s_add_u32 m0, s49, 117760
    v_mfma_f32_32x32x16_bf16 v[164:179], v[104:107], v[112:115], v[164:179]
    buffer_load_dwordx4 v15, s[60:63], s53 offen  lds
    v_sin_f32 v246, v244
    v_mul_f32 v230, v243, v245
    v_mul_f32 v231, v243, v246
    v_add_f32 v242, -1.0, v230
    v_mul_f32 v243, v63, v63
    v_fmac_f32 v243, v64, v64
    v_rcp_f32 v243, v243
    s_add_u32 s51, s51, 128
    s_and_b32 s51, s51, 0x7ff
    s_add_u32 s52, s47, s51
    s_add_u32 m0, s49, 0
    s_waitcnt lgkmcnt(2)
    v_mfma_f32_32x32x16_bf16 v[116:131], v[84:87], v[92:95], v[116:131]
    ds_read_b128 v[100:103], v67 offset:32768
    ds_read_b128 v[108:111], v75 offset:32768
    buffer_load_dwordx4 v8, s[56:59], s52 offen  lds
    v_add_f32 v243, v243, v243
    v_mul_f32 v244, v242, v63
    v_fmac_f32 v244, v231, v64
    v_mul_f32 v245, v231, v63
    s_add_u32 m0, s49, 1024
    s_waitcnt lgkmcnt(3)
    v_mfma_f32_32x32x16_bf16 v[132:147], v[84:87], v[96:99], v[132:147]
    ds_read_b128 v[112:115], v75 offset:36864
    ds_read_b128 v[104:107], v67 offset:36864
    buffer_load_dwordx4 v9, s[56:59], s52 offen  lds
    v_fma_f32 v245, -v242, v64, v245
    v_mul_f32 v232, v244, v243
    v_mul_f32 v233, v245, v243
    v_mul_f32 v242, v231, v231
    s_add_u32 m0, s49, 2048
    s_waitcnt lgkmcnt(4)
    v_mfma_f32_32x32x16_bf16 v[148:163], v[88:91], v[92:95], v[148:163]
    buffer_load_dwordx4 v10, s[56:59], s52 offen  lds
    v_fma_f32 v242, v230, v230, -v242
    v_mul_f32 v243, v230, v231
    v_add_f32 v243, v243, v243
    v_mul_f32 v244, v243, v243
    v_fma_f32 v244, v242, v242, -v244
    v_mul_f32 v245, v242, v243
    s_add_u32 m0, s49, 3072
    v_mfma_f32_32x32x16_bf16 v[164:179], v[88:91], v[96:99], v[164:179]
    buffer_load_dwordx4 v11, s[56:59], s52 offen  lds
    v_add_f32 v245, v245, v245
    v_mul_f32 v242, v245, v245
    v_fma_f32 v242, v244, v244, -v242
    v_mul_f32 v243, v244, v245
    v_add_f32 v243, v243, v243
    v_mul_f32 v234, v243, v243
    v_fma_f32 v234, v242, v242, -v234
    s_add_u32 s53, s48, s51
    s_add_u32 m0, s49, 16384
    s_waitcnt lgkmcnt(2)
    v_mfma_f32_32x32x16_bf16 v[116:131], v[100:103], v[108:111], v[116:131]
    ds_read_b128 v[84:87], v68 offset:32768
    ds_read_b128 v[92:95], v76 offset:32768
    buffer_load_dwordx4 v12, s[60:63], s53 offen  lds
    v_mul_f32 v235, v242, v243
    v_add_f32 v235, v235, v235
    v_mul_f32 v242, v235, v235
    v_fma_f32 v242, v234, v234, -v242
    s_add_u32 m0, s49, 17408
    s_waitcnt lgkmcnt(3)
    v_mfma_f32_32x32x16_bf16 v[132:147], v[100:103], v[112:115], v[132:147]
    ds_read_b128 v[96:99], v76 offset:36864
    ds_read_b128 v[88:91], v68 offset:36864
    buffer_load_dwordx4 v13, s[60:63], s53 offen  lds
    v_mul_f32 v243, v234, v235
    v_add_f32 v243, v243, v243
    v_mul_f32 v244, v243, v243
    v_fma_f32 v244, v242, v242, -v244
    s_add_u32 m0, s49, 18432
    s_waitcnt lgkmcnt(4)
    v_mfma_f32_32x32x16_bf16 v[148:163], v[104:107], v[108:111], v[148:163]
    buffer_load_dwordx4 v14, s[60:63], s53 offen  lds
    v_mul_f32 v245, v242, v243
    v_add_f32 v245, v245, v245
    v_mul_f32 v236, v245, v245
    v_fma_f32 v236, v244, v244, -v236
    v_mul_f32 v237, v244, v245
    v_add_f32 v237, v237, v237
    s_add_u32 m0, s49, 19456
    v_mfma_f32_32x32x16_bf16 v[164:179], v[104:107], v[112:115], v[164:179]
    buffer_load_dwordx4 v15, s[60:63], s53 offen  lds
    s_mov_b32 s34, 0
    s_mov_b32 s35, -1
    s_lshr_b32 s3, s44, 1
    s_cmp_eq_u32 s3, 1
    s_cselect_b32 s38, -1, 0
    s_cselect_b32 s39, -1, 0
    v_cndmask_b32 v242, 1.0, v242, s[34:35]
    v_cndmask_b32 v243, 0, v243, s[34:35]
    v_cndmask_b32 v244, 1.0, v244, s[38:39]
    s_waitcnt lgkmcnt(2)
    v_mfma_f32_32x32x16_bf16 v[116:131], v[84:87], v[92:95], v[116:131]
    ds_read_b128 v[100:103], v69 offset:32768
    ds_read_b128 v[108:111], v77 offset:32768
    v_cndmask_b32 v245, 0, v245, s[38:39]
    v_mul_f32 v246, v243, v245
    v_fma_f32 v246, v242, v244, -v246
    v_mul_f32 v247, v242, v245
    v_fmac_f32 v247, v243, v244
    v_mul_f32 v242, v247, v235
    s_waitcnt lgkmcnt(3)
    v_mfma_f32_32x32x16_bf16 v[132:147], v[84:87], v[96:99], v[132:147]
    ds_read_b128 v[112:115], v77 offset:36864
    ds_read_b128 v[104:107], v69 offset:36864
    v_fma_f32 v242, v246, v234, -v242
    v_mul_f32 v243, v246, v235
    v_fmac_f32 v243, v247, v234
    v_mov_b32 v238, v246
    v_mov_b32 v239, v242
    v_mov_b32 v240, v247
    s_waitcnt lgkmcnt(4)
    v_mfma_f32_32x32x16_bf16 v[148:163], v[88:91], v[92:95], v[148:163]
    v_mov_b32 v241, v243
    v_mfma_f32_32x32x16_bf16 v[164:179], v[88:91], v[96:99], v[164:179]
    s_waitcnt lgkmcnt(0)
    s_waitcnt vmcnt(16)
    s_barrier
    s_add_u32 s51, s51, 128
    s_and_b32 s51, s51, 0x7ff
    s_add_u32 s52, s47, s51
    s_add_u32 m0, s49, 32768
    v_mfma_f32_32x32x16_bf16 v[116:131], v[100:103], v[108:111], v[116:131]
    ds_read_b128 v[84:87], v70 offset:0
    ds_read_b128 v[92:95], v78 offset:0
    buffer_load_dwordx4 v8, s[56:59], s52 offen  lds
    v_lshlrev_b32 v203, 16, v208
    v_and_b32 v204, s5, v208
    v_lshlrev_b32 v205, 16, v46
    v_and_b32 v206, s5, v46
    s_add_u32 m0, s49, 33792
    v_mfma_f32_32x32x16_bf16 v[132:147], v[100:103], v[112:115], v[132:147]
    ds_read_b128 v[96:99], v78 offset:4096
    ds_read_b128 v[88:91], v70 offset:4096
    buffer_load_dwordx4 v9, s[56:59], s52 offen  lds
    v_mul_f32 v226, v203, v205
    v_fmac_f32 v226, v204, v206
    v_lshlrev_b32 v205, 16, v54
    v_and_b32 v206, s5, v54
    s_add_u32 m0, s49, 34816
    v_mfma_f32_32x32x16_bf16 v[148:163], v[104:107], v[108:111], v[148:163]
    buffer_load_dwordx4 v10, s[56:59], s52 offen  lds
    v_mul_f32 v227, v203, v205
    v_fmac_f32 v227, v204, v206
    v_lshlrev_b32 v203, 16, v209
    v_and_b32 v204, s5, v209
    v_lshlrev_b32 v205, 16, v47
    v_and_b32 v206, s5, v47
    s_add_u32 m0, s49, 35840
    v_mfma_f32_32x32x16_bf16 v[164:179], v[104:107], v[112:115], v[164:179]
    buffer_load_dwordx4 v11, s[56:59], s52 offen  lds
    v_fmac_f32 v226, v203, v205
    v_fmac_f32 v226, v204, v206
    v_lshlrev_b32 v205, 16, v55
    v_and_b32 v206, s5, v55
    v_fmac_f32 v227, v203, v205
    v_fmac_f32 v227, v204, v206
    v_lshlrev_b32 v203, 16, v210
    s_add_u32 s53, s48, s51
    s_add_u32 m0, s49, 49152
    s_waitcnt lgkmcnt(2)
    v_mfma_f32_32x32x16_bf16 v[116:131], v[84:87], v[92:95], v[116:131]
    ds_read_b128 v[100:103], v71 offset:0
    ds_read_b128 v[108:111], v79 offset:0
    buffer_load_dwordx4 v12, s[60:63], s53 offen  lds
    v_and_b32 v204, s5, v210
    v_lshlrev_b32 v205, 16, v48
    v_and_b32 v206, s5, v48
    v_fmac_f32 v226, v203, v205
    s_add_u32 m0, s49, 50176
    s_waitcnt lgkmcnt(3)
    v_mfma_f32_32x32x16_bf16 v[132:147], v[84:87], v[96:99], v[132:147]
    ds_read_b128 v[112:115], v79 offset:4096
    ds_read_b128 v[104:107], v71 offset:4096
    buffer_load_dwordx4 v13, s[60:63], s53 offen  lds
    v_fmac_f32 v226, v204, v206
    v_lshlrev_b32 v205, 16, v56
    v_and_b32 v206, s5, v56
    v_fmac_f32 v227, v203, v205
    s_add_u32 m0, s49, 51200
    s_waitcnt lgkmcnt(4)
    v_mfma_f32_32x32x16_bf16 v[148:163], v[88:91], v[92:95], v[148:163]
    buffer_load_dwordx4 v14, s[60:63], s53 offen  lds
    v_fmac_f32 v227, v204, v206
    v_lshlrev_b32 v203, 16, v211
    v_and_b32 v204, s5, v211
    v_lshlrev_b32 v205, 16, v49
    v_and_b32 v206, s5, v49
    v_fmac_f32 v226, v203, v205
    s_add_u32 m0, s49, 52224
    v_mfma_f32_32x32x16_bf16 v[164:179], v[88:91], v[96:99], v[164:179]
    buffer_load_dwordx4 v15, s[60:63], s53 offen  lds
    v_fmac_f32 v226, v204, v206
    v_lshlrev_b32 v205, 16, v57
    v_and_b32 v206, s5, v57
    v_fmac_f32 v227, v203, v205
    v_fmac_f32 v227, v204, v206
    v_lshlrev_b32 v203, 16, v212
    v_and_b32 v204, s5, v212
    s_waitcnt lgkmcnt(2)
    v_mfma_f32_32x32x16_bf16 v[116:131], v[100:103], v[108:111], v[116:131]
    ds_read_b128 v[84:87], v72 offset:0
    ds_read_b128 v[92:95], v80 offset:0
    v_lshlrev_b32 v205, 16, v50
    v_and_b32 v206, s5, v50
    v_fmac_f32 v226, v203, v205
    v_fmac_f32 v226, v204, v206
    v_lshlrev_b32 v205, 16, v58
    v_and_b32 v206, s5, v58
    s_waitcnt lgkmcnt(3)
    v_mfma_f32_32x32x16_bf16 v[132:147], v[100:103], v[112:115], v[132:147]
    ds_read_b128 v[96:99], v80 offset:4096
    ds_read_b128 v[88:91], v72 offset:4096
    v_fmac_f32 v227, v203, v205
    v_fmac_f32 v227, v204, v206
    v_lshlrev_b32 v203, 16, v213
    v_and_b32 v204, s5, v213
    v_lshlrev_b32 v205, 16, v51
    v_and_b32 v206, s5, v51
    s_waitcnt lgkmcnt(4)
    v_mfma_f32_32x32x16_bf16 v[148:163], v[104:107], v[108:111], v[148:163]
    v_fmac_f32 v226, v203, v205
    v_fmac_f32 v226, v204, v206
    v_lshlrev_b32 v205, 16, v59
    v_and_b32 v206, s5, v59
    v_fmac_f32 v227, v203, v205
    v_fmac_f32 v227, v204, v206
    v_lshlrev_b32 v203, 16, v214
    v_and_b32 v204, s5, v214
    v_mfma_f32_32x32x16_bf16 v[164:179], v[104:107], v[112:115], v[164:179]
    v_lshlrev_b32 v205, 16, v52
    v_and_b32 v206, s5, v52
    v_fmac_f32 v226, v203, v205
    v_fmac_f32 v226, v204, v206
    v_lshlrev_b32 v205, 16, v60
    v_and_b32 v206, s5, v60
    v_fmac_f32 v227, v203, v205
    v_fmac_f32 v227, v204, v206
    s_waitcnt lgkmcnt(2)
    v_mfma_f32_32x32x16_bf16 v[116:131], v[84:87], v[92:95], v[116:131]
    ds_read_b128 v[100:103], v73 offset:0
    ds_read_b128 v[108:111], v81 offset:0
    v_lshlrev_b32 v203, 16, v215
    v_and_b32 v204, s5, v215
    v_lshlrev_b32 v205, 16, v53
    v_and_b32 v206, s5, v53
    v_fmac_f32 v226, v203, v205
    v_fmac_f32 v226, v204, v206
    s_waitcnt lgkmcnt(3)
    v_mfma_f32_32x32x16_bf16 v[132:147], v[84:87], v[96:99], v[132:147]
    ds_read_b128 v[112:115], v81 offset:4096
    ds_read_b128 v[104:107], v73 offset:4096
    v_lshlrev_b32 v205, 16, v61
    v_and_b32 v206, s5, v61
    v_fmac_f32 v227, v203, v205
    v_fmac_f32 v227, v204, v206
    v_add_f32_dpp v226, v226, v226 row_shr:1 row_mask:0xf bank_mask:0xf bound_ctrl:0
    s_nop 0
    v_add_f32_dpp v227, v227, v227 row_shr:1 row_mask:0xf bank_mask:0xf bound_ctrl:0
    s_waitcnt lgkmcnt(4)
    v_mfma_f32_32x32x16_bf16 v[148:163], v[88:91], v[92:95], v[148:163]
    v_add_f32_dpp v226, v226, v226 row_shr:2 row_mask:0xf bank_mask:0xf bound_ctrl:0
    v_add_f32_dpp v227, v227, v227 row_shr:2 row_mask:0xf bank_mask:0xf bound_ctrl:0
    s_nop 0
    v_add_f32_dpp v226, v226, v226 row_shr:4 row_mask:0xf bank_mask:0xf bound_ctrl:0
    v_add_f32_dpp v227, v227, v227 row_shr:4 row_mask:0xf bank_mask:0xf bound_ctrl:0
    s_nop 0
    v_add_f32_dpp v226, v226, v226 row_shr:8 row_mask:0xf bank_mask:0xf bound_ctrl:0
    v_add_f32_dpp v227, v227, v227 row_shr:8 row_mask:0xf bank_mask:0xf bound_ctrl:0
    s_nop 0
    v_add_f32_dpp v226, v226, v226 row_bcast:15 row_mask:0xa bank_mask:0xf
    v_add_f32_dpp v227, v227, v227 row_bcast:15 row_mask:0xa bank_mask:0xf
    v_mfma_f32_32x32x16_bf16 v[164:179], v[88:91], v[96:99], v[164:179]
    v_add_f32_dpp v226, v226, v226 row_bcast:31 row_mask:0xc bank_mask:0xf
    v_add_f32_dpp v227, v227, v227 row_bcast:31 row_mask:0xc bank_mask:0xf
    v_cvt_pk_bf16_f32 v203, v226, v227
    v_lshlrev_b32 v226, 16, v203
    v_and_b32 v227, s5, v203
    v_mul_f32 v226, 0xbfb8aa3b, v226
    v_mul_f32 v227, 0xbfb8aa3b, v227
    v_exp_f32 v226, v226
    s_waitcnt lgkmcnt(0)
    s_waitcnt vmcnt(16)
    s_barrier
    s_add_u32 s51, s51, 128
    s_and_b32 s51, s51, 0x7ff
    s_add_u32 s52, s47, s51
    s_add_u32 m0, s49, 65536
    v_mfma_f32_32x32x16_bf16 v[116:131], v[100:103], v[108:111], v[116:131]
    ds_read_b128 v[84:87], v70 offset:32768
    ds_read_b128 v[92:95], v78 offset:32768
    buffer_load_dwordx4 v8, s[56:59], s52 offen  lds
    v_exp_f32 v227, v227
    v_add_f32 v226, 1.0, v226
    v_add_f32 v227, 1.0, v227
    v_rcp_f32 v226, v226
    s_add_u32 m0, s49, 66560
    v_mfma_f32_32x32x16_bf16 v[132:147], v[100:103], v[112:115], v[132:147]
    ds_read_b128 v[96:99], v78 offset:36864
    ds_read_b128 v[88:91], v70 offset:36864
    buffer_load_dwordx4 v9, s[56:59], s52 offen  lds
    v_rcp_f32 v227, v227
    s_nop 0
    v_cvt_pk_bf16_f32 v203, v226, v227
    v_lshlrev_b32 v226, 16, v203
    v_and_b32 v227, s5, v203
    s_add_u32 m0, s49, 67584
    v_mfma_f32_32x32x16_bf16 v[148:163], v[104:107], v[108:111], v[148:163]
    buffer_load_dwordx4 v10, s[56:59], s52 offen  lds
    v_sub_f32 v228, 1.0, v226
    v_sub_f32 v229, 1.0, v227
    v_cvt_pk_bf16_f32 v203, v228, v229
    v_lshlrev_b32 v228, 16, v203
    v_and_b32 v229, s5, v203
    s_add_u32 m0, s49, 68608
    v_mfma_f32_32x32x16_bf16 v[164:179], v[104:107], v[112:115], v[164:179]
    buffer_load_dwordx4 v11, s[56:59], s52 offen  lds
    s_add_u32 s53, s48, s51
    s_add_u32 m0, s49, 81920
    s_waitcnt lgkmcnt(2)
    v_mfma_f32_32x32x16_bf16 v[116:131], v[84:87], v[92:95], v[116:131]
    ds_read_b128 v[100:103], v71 offset:32768
    ds_read_b128 v[108:111], v79 offset:32768
    buffer_load_dwordx4 v12, s[60:63], s53 offen  lds
    s_add_u32 m0, s49, 82944
    s_waitcnt lgkmcnt(3)
    v_mfma_f32_32x32x16_bf16 v[132:147], v[84:87], v[96:99], v[132:147]
    ds_read_b128 v[112:115], v79 offset:36864
    ds_read_b128 v[104:107], v71 offset:36864
    buffer_load_dwordx4 v13, s[60:63], s53 offen  lds
    s_add_u32 m0, s49, 83968
    s_waitcnt lgkmcnt(4)
    v_mfma_f32_32x32x16_bf16 v[148:163], v[88:91], v[92:95], v[148:163]
    buffer_load_dwordx4 v14, s[60:63], s53 offen  lds
    s_add_u32 m0, s49, 84992
    v_mfma_f32_32x32x16_bf16 v[164:179], v[88:91], v[96:99], v[164:179]
    buffer_load_dwordx4 v15, s[60:63], s53 offen  lds
    s_mov_b32 m0, s4
    s_waitcnt lgkmcnt(2)
    v_mfma_f32_32x32x16_bf16 v[116:131], v[100:103], v[108:111], v[116:131]
    ds_read_b128 v[84:87], v72 offset:32768
    ds_read_b128 v[92:95], v80 offset:32768
    buffer_load_dwordx4 v17, s[64:67], s54 offen lds
    s_waitcnt lgkmcnt(3)
    v_mfma_f32_32x32x16_bf16 v[132:147], v[100:103], v[112:115], v[132:147]
    ds_read_b128 v[96:99], v80 offset:36864
    ds_read_b128 v[88:91], v72 offset:36864
    buffer_load_dwordx4 v[18:21], v18, s[68:71], 0 offen
    s_waitcnt lgkmcnt(4)
    v_mfma_f32_32x32x16_bf16 v[148:163], v[104:107], v[108:111], v[148:163]
    buffer_load_dwordx4 v[22:25], v22, s[68:71], 0 offen
    v_mfma_f32_32x32x16_bf16 v[164:179], v[104:107], v[112:115], v[164:179]
    buffer_load_dwordx4 v[26:29], v26, s[68:71], 0 offen
    s_waitcnt lgkmcnt(2)
    v_mfma_f32_32x32x16_bf16 v[116:131], v[84:87], v[92:95], v[116:131]
    ds_read_b128 v[100:103], v73 offset:32768
    ds_read_b128 v[108:111], v81 offset:32768
    buffer_load_dwordx4 v[30:33], v16, s[68:71], 0 offen offset:0
    s_waitcnt lgkmcnt(3)
    v_mfma_f32_32x32x16_bf16 v[132:147], v[84:87], v[96:99], v[132:147]
    ds_read_b128 v[112:115], v81 offset:36864
    ds_read_b128 v[104:107], v73 offset:36864
    buffer_load_dwordx4 v[34:37], v16, s[68:71], 0 offen offset:2048
    s_waitcnt lgkmcnt(4)
    v_mfma_f32_32x32x16_bf16 v[148:163], v[88:91], v[92:95], v[148:163]
    buffer_load_dwordx4 v[38:41], v16, s[68:71], s50 offen offset:0
    v_mfma_f32_32x32x16_bf16 v[164:179], v[88:91], v[96:99], v[164:179]
    buffer_load_dwordx4 v[42:45], v16, s[68:71], s50 offen offset:2048
    s_waitcnt lgkmcnt(0)
    s_waitcnt vmcnt(24)
    s_barrier
    v_mfma_f32_32x32x16_bf16 v[116:131], v[100:103], v[108:111], v[116:131]
    ds_read_b128 v[84:87], v66 offset:0
    ds_read_b128 v[92:95], v74 offset:0
    buffer_load_dwordx4 v[46:49], v16, s[72:75], 0 offen offset:0
    v_mfma_f32_32x32x16_bf16 v[132:147], v[100:103], v[112:115], v[132:147]
    ds_read_b128 v[96:99], v74 offset:4096
    ds_read_b128 v[88:91], v66 offset:4096
    buffer_load_dwordx4 v[50:53], v16, s[72:75], 0 offen offset:2048
    v_mfma_f32_32x32x16_bf16 v[148:163], v[104:107], v[108:111], v[148:163]
    buffer_load_dwordx4 v[54:57], v16, s[72:75], s50 offen offset:0
    v_mfma_f32_32x32x16_bf16 v[164:179], v[104:107], v[112:115], v[164:179]
    buffer_load_dwordx4 v[58:61], v16, s[72:75], s50 offen offset:2048
    s_add_u32 s51, s51, 128
    s_and_b32 s51, s51, 0x7ff
    s_add_u32 s52, s47, s51
    s_add_u32 m0, s49, 98304
    s_waitcnt lgkmcnt(2)
    v_mfma_f32_32x32x16_bf16 v[116:131], v[84:87], v[92:95], v[116:131]
    ds_read_b128 v[100:103], v67 offset:0
    ds_read_b128 v[108:111], v75 offset:0
    buffer_load_dwordx4 v8, s[56:59], s52 offen  lds
    s_add_u32 m0, s49, 99328
    s_waitcnt lgkmcnt(3)
    v_mfma_f32_32x32x16_bf16 v[132:147], v[84:87], v[96:99], v[132:147]
    ds_read_b128 v[112:115], v75 offset:4096
    ds_read_b128 v[104:107], v67 offset:4096
    buffer_load_dwordx4 v9, s[56:59], s52 offen  lds
    s_add_u32 m0, s49, 100352
    s_waitcnt lgkmcnt(4)
    v_mfma_f32_32x32x16_bf16 v[148:163], v[88:91], v[92:95], v[148:163]
    buffer_load_dwordx4 v10, s[56:59], s52 offen  lds
    s_add_u32 m0, s49, 101376
    v_mfma_f32_32x32x16_bf16 v[164:179], v[88:91], v[96:99], v[164:179]
    buffer_load_dwordx4 v11, s[56:59], s52 offen  lds
    s_add_u32 s53, s48, s51
    s_add_u32 m0, s49, 114688
    s_waitcnt lgkmcnt(2)
    v_mfma_f32_32x32x16_bf16 v[116:131], v[100:103], v[108:111], v[116:131]
    ds_read_b128 v[84:87], v68 offset:0
    ds_read_b128 v[92:95], v76 offset:0
    buffer_load_dwordx4 v12, s[60:63], s53 offen  lds
    s_add_u32 m0, s49, 115712
    s_waitcnt lgkmcnt(3)
    v_mfma_f32_32x32x16_bf16 v[132:147], v[100:103], v[112:115], v[132:147]
    ds_read_b128 v[96:99], v76 offset:4096
    ds_read_b128 v[88:91], v68 offset:4096
    buffer_load_dwordx4 v13, s[60:63], s53 offen  lds
    s_add_u32 m0, s49, 116736
    s_waitcnt lgkmcnt(4)
    v_mfma_f32_32x32x16_bf16 v[148:163], v[104:107], v[108:111], v[148:163]
    buffer_load_dwordx4 v14, s[60:63], s53 offen  lds
    s_add_u32 m0, s49, 117760
    v_mfma_f32_32x32x16_bf16 v[164:179], v[104:107], v[112:115], v[164:179]
    buffer_load_dwordx4 v15, s[60:63], s53 offen  lds
    s_waitcnt lgkmcnt(2)
    v_mfma_f32_32x32x16_bf16 v[116:131], v[84:87], v[92:95], v[116:131]
    ds_read_b128 v[100:103], v69 offset:0
    ds_read_b128 v[108:111], v77 offset:0
    s_waitcnt lgkmcnt(3)
    v_mfma_f32_32x32x16_bf16 v[132:147], v[84:87], v[96:99], v[132:147]
    ds_read_b128 v[112:115], v77 offset:4096
    ds_read_b128 v[104:107], v69 offset:4096
    s_waitcnt lgkmcnt(4)
    v_mfma_f32_32x32x16_bf16 v[148:163], v[88:91], v[92:95], v[148:163]
    v_mfma_f32_32x32x16_bf16 v[164:179], v[88:91], v[96:99], v[164:179]
    s_waitcnt lgkmcnt(0)
    s_waitcnt vmcnt(28)
    s_barrier
    s_add_u32 s51, s51, 128
    s_and_b32 s51, s51, 0x7ff
    s_add_u32 s52, s47, s51
    s_add_u32 m0, s49, 0
    v_mfma_f32_32x32x16_bf16 v[116:131], v[100:103], v[108:111], v[116:131]
    ds_read_b128 v[84:87], v66 offset:32768
    ds_read_b128 v[92:95], v74 offset:32768
    buffer_load_dwordx4 v8, s[56:59], s52 offen  lds
    s_add_u32 m0, s49, 1024
    v_mfma_f32_32x32x16_bf16 v[132:147], v[100:103], v[112:115], v[132:147]
    ds_read_b128 v[96:99], v74 offset:36864
    ds_read_b128 v[88:91], v66 offset:36864
    buffer_load_dwordx4 v9, s[56:59], s52 offen  lds
    s_add_u32 m0, s49, 2048
    v_mfma_f32_32x32x16_bf16 v[148:163], v[104:107], v[108:111], v[148:163]
    buffer_load_dwordx4 v10, s[56:59], s52 offen  lds
    s_add_u32 m0, s49, 3072
    v_mfma_f32_32x32x16_bf16 v[164:179], v[104:107], v[112:115], v[164:179]
    buffer_load_dwordx4 v11, s[56:59], s52 offen  lds
    s_waitcnt lgkmcnt(2)
    v_mfma_f32_32x32x16_bf16 v[116:131], v[84:87], v[92:95], v[116:131]
    ds_read_b128 v[100:103], v67 offset:32768
    ds_read_b128 v[108:111], v75 offset:32768
    s_mov_b32 s7, 0x05040100
    s_mov_b32 s12, 0x07060302
    s_waitcnt vmcnt(23)
    s_waitcnt lgkmcnt(3)
    v_mfma_f32_32x32x16_bf16 v[132:147], v[84:87], v[96:99], v[132:147]
    ds_read_b128 v[112:115], v75 offset:36864
    ds_read_b128 v[104:107], v67 offset:36864
    ds_read_b128 v[184:187], v180 offset:0
    s_add_u32 s53, s48, s51
    s_add_u32 m0, s49, 16384
    s_waitcnt lgkmcnt(5)
    v_mfma_f32_32x32x16_bf16 v[148:163], v[88:91], v[92:95], v[148:163]
    buffer_load_dwordx4 v12, s[60:63], s53 offen  lds
    ds_read_b128 v[188:191], v180 offset:16
    s_waitcnt vmcnt(22)
    v_perm_b32 v196, v18, v22, s7
    s_waitcnt vmcnt(21)
    v_perm_b32 v197, v22, v26, s7
    s_add_u32 m0, s49, 17408
    v_mfma_f32_32x32x16_bf16 v[164:179], v[88:91], v[96:99], v[164:179]
    buffer_load_dwordx4 v13, s[60:63], s53 offen  lds
    s_waitcnt vmcnt(21)
    v_perm_b32 v198, v26, v30, s7
    s_waitcnt vmcnt(20)
    v_perm_b32 v199, v30, v34, s7
    s_waitcnt vmcnt(19)
    v_perm_b32 v200, v34, v38, s7
    s_waitcnt vmcnt(18)
    v_perm_b32 v201, v38, v42, s7
    s_waitcnt lgkmcnt(4)
    v_mfma_f32_32x32x16_bf16 v[116:131], v[100:103], v[108:111], v[116:131]
    ds_read_b128 v[84:87], v68 offset:32768
    ds_read_b128 v[92:95], v76 offset:32768
    s_waitcnt vmcnt(17)
    v_lshlrev_b32 v192, 16, v46
    s_waitcnt vmcnt(16)
    v_lshlrev_b32 v193, 16, v50
    s_waitcnt vmcnt(15)
    v_lshlrev_b32 v194, 16, v54
    s_waitcnt lgkmcnt(5)
    v_mfma_f32_32x32x16_bf16 v[132:147], v[100:103], v[112:115], v[132:147]
    ds_read_b128 v[96:99], v76 offset:36864
    ds_read_b128 v[88:91], v68 offset:36864
    s_waitcnt vmcnt(14)
    v_lshlrev_b32 v195, 16, v58
    s_waitcnt lgkmcnt(5)
    v_dot2_f32_bf16 v203, v196, v185, 0
    s_add_u32 m0, s49, 18432
    v_mfma_f32_32x32x16_bf16 v[148:163], v[104:107], v[108:111], v[148:163]
    buffer_load_dwordx4 v14, s[60:63], s53 offen  lds
    v_dot2_f32_bf16 v204, v197, v185, 0
    v_dot2_f32_bf16 v205, v198, v185, 0
    v_dot2_f32_bf16 v206, v199, v185, 0
    s_add_u32 m0, s49, 19456
    v_mfma_f32_32x32x16_bf16 v[164:179], v[104:107], v[112:115], v[164:179]
    buffer_load_dwordx4 v15, s[60:63], s53 offen  lds
    v_dot2c_f32_bf16 v203, v198, v184
    v_dot2c_f32_bf16 v204, v199, v184
    v_dot2c_f32_bf16 v205, v200, v184
    v_dot2c_f32_bf16 v206, v201, v184
    s_waitcnt lgkmcnt(2)
    v_mfma_f32_32x32x16_bf16 v[116:131], v[84:87], v[92:95], v[116:131]
    ds_read_b128 v[100:103], v69 offset:32768
    ds_read_b128 v[108:111], v77 offset:32768
    v_mul_f32 v203, v203, v192
    v_mul_f32 v204, v204, v193
    v_mul_f32 v205, v205, v194
    s_waitcnt lgkmcnt(3)
    v_mfma_f32_32x32x16_bf16 v[132:147], v[84:87], v[96:99], v[132:147]
    ds_read_b128 v[112:115], v77 offset:36864
    ds_read_b128 v[104:107], v69 offset:36864
    v_mul_f32 v206, v206, v195
    v_cvt_pk_bf16_f32 v210, v206, v205
    v_cvt_pk_bf16_f32 v211, v204, v203
    s_waitcnt lgkmcnt(4)
    v_mfma_f32_32x32x16_bf16 v[148:163], v[88:91], v[92:95], v[148:163]
    v_perm_b32 v196, v18, v22, s12
    v_perm_b32 v197, v22, v26, s12
    v_perm_b32 v198, v26, v30, s12
    v_perm_b32 v199, v30, v34, s12
    v_perm_b32 v200, v34, v38, s12
    v_mfma_f32_32x32x16_bf16 v[164:179], v[88:91], v[96:99], v[164:179]
    v_perm_b32 v201, v38, v42, s12
    v_and_b32 v192, s5, v46
    v_and_b32 v193, s5, v50
    v_and_b32 v194, s5, v54
    v_and_b32 v195, s5, v58
    s_waitcnt lgkmcnt(0)
    s_barrier
    v_mfma_f32_32x32x16_bf16 v[116:131], v[100:103], v[108:111], v[116:131]
    ds_read_b128 v[84:87], v70 offset:0
    ds_read_b128 v[92:95], v78 offset:0
    v_dot2_f32_bf16 v203, v196, v187, 0
    v_dot2_f32_bf16 v204, v197, v187, 0
    v_dot2_f32_bf16 v205, v198, v187, 0
    v_mfma_f32_32x32x16_bf16 v[132:147], v[100:103], v[112:115], v[132:147]
    ds_read_b128 v[96:99], v78 offset:4096
    ds_read_b128 v[88:91], v70 offset:4096
    s_add_u32 s51, s51, 128
    s_and_b32 s51, s51, 0x7ff
    s_add_u32 s52, s47, s51
    s_add_u32 m0, s49, 32768
    v_mfma_f32_32x32x16_bf16 v[148:163], v[104:107], v[108:111], v[148:163]
    buffer_load_dwordx4 v8, s[56:59], s52 offen  lds
    v_dot2_f32_bf16 v206, v199, v187, 0
    v_dot2c_f32_bf16 v203, v198, v186
    v_dot2c_f32_bf16 v204, v199, v186
    s_add_u32 m0, s49, 33792
    v_mfma_f32_32x32x16_bf16 v[164:179], v[104:107], v[112:115], v[164:179]
    buffer_load_dwordx4 v9, s[56:59], s52 offen  lds
    v_dot2c_f32_bf16 v205, v200, v186
    v_dot2c_f32_bf16 v206, v201, v186
    v_mul_f32 v203, v203, v192
    v_mul_f32 v204, v204, v193
    s_waitcnt lgkmcnt(2)
    v_mfma_f32_32x32x16_bf16 v[116:131], v[84:87], v[92:95], v[116:131]
    ds_read_b128 v[100:103], v71 offset:0
    ds_read_b128 v[108:111], v79 offset:0
    v_mul_f32 v205, v205, v194
    v_mul_f32 v206, v206, v195
    v_cvt_pk_bf16_f32 v208, v206, v205
    s_waitcnt lgkmcnt(3)
    v_mfma_f32_32x32x16_bf16 v[132:147], v[84:87], v[96:99], v[132:147]
    ds_read_b128 v[112:115], v79 offset:4096
    ds_read_b128 v[104:107], v71 offset:4096
    v_cvt_pk_bf16_f32 v209, v204, v203
    ds_read_b128 v[184:187], v180 offset:32
    s_add_u32 m0, s49, 34816
    s_waitcnt lgkmcnt(5)
    v_mfma_f32_32x32x16_bf16 v[148:163], v[88:91], v[92:95], v[148:163]
    buffer_load_dwordx4 v10, s[56:59], s52 offen  lds
    v_perm_b32 v196, v19, v23, s7
    v_perm_b32 v197, v23, v27, s7
    v_permlane32_swap_b32 v210, v208
    s_add_u32 m0, s49, 35840
    v_mfma_f32_32x32x16_bf16 v[164:179], v[88:91], v[96:99], v[164:179]
    buffer_load_dwordx4 v11, s[56:59], s52 offen  lds
    v_permlane32_swap_b32 v211, v209
    v_perm_b32 v198, v27, v31, s7
    v_perm_b32 v199, v31, v35, s7
    v_perm_b32 v200, v35, v39, s7
    s_waitcnt lgkmcnt(3)
    v_mfma_f32_32x32x16_bf16 v[116:131], v[100:103], v[108:111], v[116:131]
    ds_read_b128 v[84:87], v72 offset:0
    ds_read_b128 v[92:95], v80 offset:0
    v_perm_b32 v201, v39, v43, s7
    v_lshlrev_b32 v192, 16, v47
    v_lshlrev_b32 v193, 16, v51
    s_waitcnt lgkmcnt(4)
    v_mfma_f32_32x32x16_bf16 v[132:147], v[100:103], v[112:115], v[132:147]
    ds_read_b128 v[96:99], v80 offset:4096
    ds_read_b128 v[88:91], v72 offset:4096
    v_lshlrev_b32 v194, 16, v55
    s_add_u32 s53, s48, s51
    s_add_u32 m0, s49, 49152
    s_waitcnt lgkmcnt(5)
    v_mfma_f32_32x32x16_bf16 v[148:163], v[104:107], v[108:111], v[148:163]
    buffer_load_dwordx4 v12, s[60:63], s53 offen  lds
    v_lshlrev_b32 v195, 16, v59
    v_dot2_f32_bf16 v203, v196, v189, 0
    v_dot2_f32_bf16 v204, v197, v189, 0
    s_add_u32 m0, s49, 50176
    v_mfma_f32_32x32x16_bf16 v[164:179], v[104:107], v[112:115], v[164:179]
    buffer_load_dwordx4 v13, s[60:63], s53 offen  lds
    v_dot2_f32_bf16 v205, v198, v189, 0
    v_dot2_f32_bf16 v206, v199, v189, 0
    v_dot2c_f32_bf16 v203, v198, v188
    v_dot2c_f32_bf16 v204, v199, v188
    s_waitcnt lgkmcnt(2)
    v_mfma_f32_32x32x16_bf16 v[116:131], v[84:87], v[92:95], v[116:131]
    ds_read_b128 v[100:103], v73 offset:0
    ds_read_b128 v[108:111], v81 offset:0
    v_dot2c_f32_bf16 v205, v200, v188
    v_dot2c_f32_bf16 v206, v201, v188
    v_mul_f32 v203, v203, v192
    s_waitcnt lgkmcnt(3)
    v_mfma_f32_32x32x16_bf16 v[132:147], v[84:87], v[96:99], v[132:147]
    ds_read_b128 v[112:115], v81 offset:4096
    ds_read_b128 v[104:107], v73 offset:4096
    v_mul_f32 v204, v204, v193
    v_mul_f32 v205, v205, v194
    s_add_u32 m0, s49, 51200
    s_waitcnt lgkmcnt(4)
    v_mfma_f32_32x32x16_bf16 v[148:163], v[88:91], v[92:95], v[148:163]
    buffer_load_dwordx4 v14, s[60:63], s53 offen  lds
    v_mul_f32 v206, v206, v195
    v_cvt_pk_bf16_f32 v214, v206, v205
    v_cvt_pk_bf16_f32 v215, v204, v203
    s_add_u32 m0, s49, 52224
    v_mfma_f32_32x32x16_bf16 v[164:179], v[88:91], v[96:99], v[164:179]
    buffer_load_dwordx4 v15, s[60:63], s53 offen  lds
    v_perm_b32 v196, v19, v23, s12
    v_perm_b32 v197, v23, v27, s12
    v_perm_b32 v198, v27, v31, s12
    v_perm_b32 v199, v31, v35, s12
    s_waitcnt lgkmcnt(0)
    s_waitcnt vmcnt(16)
    s_barrier
    v_mfma_f32_32x32x16_bf16 v[116:131], v[100:103], v[108:111], v[116:131]
    ds_read_b128 v[84:87], v70 offset:32768
    ds_read_b128 v[92:95], v78 offset:32768
    v_perm_b32 v200, v35, v39, s12
    v_perm_b32 v201, v39, v43, s12
    v_and_b32 v192, s5, v47
    v_mfma_f32_32x32x16_bf16 v[132:147], v[100:103], v[112:115], v[132:147]
    ds_read_b128 v[96:99], v78 offset:36864
    ds_read_b128 v[88:91], v70 offset:36864
    s_add_u32 s51, s51, 128
    s_and_b32 s51, s51, 0x7ff
    s_add_u32 s52, s47, s51
    s_add_u32 m0, s49, 65536
    v_mfma_f32_32x32x16_bf16 v[148:163], v[104:107], v[108:111], v[148:163]
    buffer_load_dwordx4 v8, s[56:59], s52 offen  lds
    v_and_b32 v193, s5, v51
    v_and_b32 v194, s5, v55
    v_and_b32 v195, s5, v59
    s_add_u32 m0, s49, 66560
    v_mfma_f32_32x32x16_bf16 v[164:179], v[104:107], v[112:115], v[164:179]
    buffer_load_dwordx4 v9, s[56:59], s52 offen  lds
    v_dot2_f32_bf16 v203, v196, v191, 0
    v_dot2_f32_bf16 v204, v197, v191, 0
    v_dot2_f32_bf16 v205, v198, v191, 0
    v_dot2_f32_bf16 v206, v199, v191, 0
    s_waitcnt lgkmcnt(2)
    v_mfma_f32_32x32x16_bf16 v[116:131], v[84:87], v[92:95], v[116:131]
    ds_read_b128 v[100:103], v71 offset:32768
    ds_read_b128 v[108:111], v79 offset:32768
    v_dot2c_f32_bf16 v203, v198, v190
    v_dot2c_f32_bf16 v204, v199, v190
    s_add_u32 m0, s49, 67584
    s_waitcnt lgkmcnt(3)
    v_mfma_f32_32x32x16_bf16 v[132:147], v[84:87], v[96:99], v[132:147]
    ds_read_b128 v[112:115], v79 offset:36864
    ds_read_b128 v[104:107], v71 offset:36864
    buffer_load_dwordx4 v10, s[56:59], s52 offen  lds
    v_dot2c_f32_bf16 v205, v200, v190
    s_add_u32 m0, s49, 68608
    s_waitcnt lgkmcnt(4)
    v_mfma_f32_32x32x16_bf16 v[148:163], v[88:91], v[92:95], v[148:163]
    buffer_load_dwordx4 v11, s[56:59], s52 offen  lds
    v_dot2c_f32_bf16 v206, v201, v190
    v_mul_f32 v203, v203, v192
    s_add_u32 s53, s48, s51
    s_add_u32 m0, s49, 81920
    v_mfma_f32_32x32x16_bf16 v[164:179], v[88:91], v[96:99], v[164:179]
    buffer_load_dwordx4 v12, s[60:63], s53 offen  lds
    v_mul_f32 v204, v204, v193
    v_mul_f32 v205, v205, v194
    v_mul_f32 v206, v206, v195
    v_cvt_pk_bf16_f32 v212, v206, v205
    s_waitcnt lgkmcnt(2)
    v_mfma_f32_32x32x16_bf16 v[116:131], v[100:103], v[108:111], v[116:131]
    ds_read_b128 v[84:87], v72 offset:32768
    ds_read_b128 v[92:95], v80 offset:32768
    v_cvt_pk_bf16_f32 v213, v204, v203
    ds_read_b128 v[188:191], v180 offset:48
    s_add_u32 m0, s49, 82944
    s_waitcnt lgkmcnt(4)
    v_mfma_f32_32x32x16_bf16 v[132:147], v[100:103], v[112:115], v[132:147]
    ds_read_b128 v[96:99], v80 offset:36864
    ds_read_b128 v[88:91], v72 offset:36864
    buffer_load_dwordx4 v13, s[60:63], s53 offen  lds
    v_perm_b32 v196, v20, v24, s7
    s_add_u32 m0, s49, 83968
    s_waitcnt lgkmcnt(5)
    v_mfma_f32_32x32x16_bf16 v[148:163], v[104:107], v[108:111], v[148:163]
    buffer_load_dwordx4 v14, s[60:63], s53 offen  lds
    v_perm_b32 v197, v24, v28, s7
    v_permlane32_swap_b32 v214, v212
    v_permlane32_swap_b32 v215, v213
    s_add_u32 m0, s49, 84992
    v_mfma_f32_32x32x16_bf16 v[164:179], v[104:107], v[112:115], v[164:179]
    buffer_load_dwordx4 v15, s[60:63], s53 offen  lds
    v_perm_b32 v198, v28, v32, s7
    v_perm_b32 v199, v32, v36, s7
    v_perm_b32 v200, v36, v40, s7
    v_perm_b32 v201, v40, v44, s7
    s_waitcnt lgkmcnt(3)
    v_mfma_f32_32x32x16_bf16 v[116:131], v[84:87], v[92:95], v[116:131]
    ds_read_b128 v[100:103], v73 offset:32768
    ds_read_b128 v[108:111], v81 offset:32768
    v_lshlrev_b32 v192, 16, v48
    v_lshlrev_b32 v193, 16, v52
    s_add_u32 m0, s16, 0
    s_waitcnt lgkmcnt(3)
    v_mfma_f32_32x32x16_bf16 v[132:147], v[84:87], v[96:99], v[132:147]
    ds_read_b128 v[112:115], v81 offset:36864
    ds_read_b128 v[104:107], v73 offset:36864
    buffer_load_dwordx4 v224, s[80:83], s14 offen  lds
    v_lshlrev_b32 v194, 16, v56
    s_add_u32 m0, s16, 1024
    s_waitcnt lgkmcnt(4)
    v_mfma_f32_32x32x16_bf16 v[148:163], v[88:91], v[92:95], v[148:163]
    buffer_load_dwordx4 v224, s[80:83], s15 offen  lds
    v_lshlrev_b32 v195, 16, v60
    v_dot2_f32_bf16 v203, v196, v185, 0
    v_dot2_f32_bf16 v204, v197, v185, 0
    s_add_u32 m0, s16, 2048
    v_mfma_f32_32x32x16_bf16 v[164:179], v[88:91], v[96:99], v[164:179]
    buffer_load_dwordx4 v224, s[84:87], s14 offen  lds
    v_dot2_f32_bf16 v205, v198, v185, 0
    v_dot2_f32_bf16 v206, v199, v185, 0
    v_dot2c_f32_bf16 v203, v198, v184
    v_dot2c_f32_bf16 v204, v199, v184
    s_waitcnt lgkmcnt(0)
    s_waitcnt vmcnt(19)
    s_barrier
    v_mfma_f32_32x32x16_bf16 v[116:131], v[100:103], v[108:111], v[116:131]
    ds_read_b128 v[84:87], v66 offset:0
    ds_read_b128 v[92:95], v74 offset:0
    v_dot2c_f32_bf16 v205, v200, v184
    v_dot2c_f32_bf16 v206, v201, v184
    s_add_u32 m0, s16, 3072
    v_mfma_f32_32x32x16_bf16 v[132:147], v[100:103], v[112:115], v[132:147]
    ds_read_b128 v[96:99], v74 offset:4096
    ds_read_b128 v[88:91], v66 offset:4096
    buffer_load_dwordx4 v224, s[84:87], s15 offen  lds
    s_add_u32 s51, s51, 128
    s_and_b32 s51, s51, 0x7ff
    s_add_u32 s52, s47, s51
    s_add_u32 m0, s49, 98304
    v_mfma_f32_32x32x16_bf16 v[148:163], v[104:107], v[108:111], v[148:163]
    buffer_load_dwordx4 v8, s[56:59], s52 offen  lds
    v_mul_f32 v203, v203, v192
    v_mul_f32 v204, v204, v193
    v_mul_f32 v205, v205, v194
    s_add_u32 m0, s49, 99328
    v_mfma_f32_32x32x16_bf16 v[164:179], v[104:107], v[112:115], v[164:179]
    buffer_load_dwordx4 v9, s[56:59], s52 offen  lds
    v_mul_f32 v206, v206, v195
    v_cvt_pk_bf16_f32 v218, v206, v205
    v_cvt_pk_bf16_f32 v219, v204, v203
    v_perm_b32 v196, v20, v24, s12
    s_waitcnt lgkmcnt(2)
    v_mfma_f32_32x32x16_bf16 v[116:131], v[84:87], v[92:95], v[116:131]
    ds_read_b128 v[100:103], v67 offset:0
    ds_read_b128 v[108:111], v75 offset:0
    v_perm_b32 v197, v24, v28, s12
    v_perm_b32 v198, v28, v32, s12
    v_perm_b32 v199, v32, v36, s12
    s_waitcnt lgkmcnt(3)
    v_mfma_f32_32x32x16_bf16 v[132:147], v[84:87], v[96:99], v[132:147]
    ds_read_b128 v[112:115], v75 offset:4096
    ds_read_b128 v[104:107], v67 offset:4096
    v_perm_b32 v200, v36, v40, s12
    v_perm_b32 v201, v40, v44, s12
    s_add_u32 m0, s49, 100352
    s_waitcnt lgkmcnt(4)
    v_mfma_f32_32x32x16_bf16 v[148:163], v[88:91], v[92:95], v[148:163]
    buffer_load_dwordx4 v10, s[56:59], s52 offen  lds
    v_and_b32 v192, s5, v48
    v_and_b32 v193, s5, v52
    v_and_b32 v194, s5, v56
    s_add_u32 m0, s49, 101376
    v_mfma_f32_32x32x16_bf16 v[164:179], v[88:91], v[96:99], v[164:179]
    buffer_load_dwordx4 v11, s[56:59], s52 offen  lds
    v_and_b32 v195, s5, v60
    v_dot2_f32_bf16 v203, v196, v187, 0
    v_dot2_f32_bf16 v204, v197, v187, 0
    v_dot2_f32_bf16 v205, v198, v187, 0
    s_waitcnt lgkmcnt(2)
    v_mfma_f32_32x32x16_bf16 v[116:131], v[100:103], v[108:111], v[116:131]
    ds_read_b128 v[84:87], v68 offset:0
    ds_read_b128 v[92:95], v76 offset:0
    v_dot2_f32_bf16 v206, v199, v187, 0
    v_dot2c_f32_bf16 v203, v198, v186
    v_dot2c_f32_bf16 v204, v199, v186
    s_waitcnt lgkmcnt(3)
    v_mfma_f32_32x32x16_bf16 v[132:147], v[100:103], v[112:115], v[132:147]
    ds_read_b128 v[96:99], v76 offset:4096
    ds_read_b128 v[88:91], v68 offset:4096
    v_dot2c_f32_bf16 v205, v200, v186
    s_add_u32 s53, s48, s51
    s_add_u32 m0, s49, 114688
    s_waitcnt lgkmcnt(4)
    v_mfma_f32_32x32x16_bf16 v[148:163], v[104:107], v[108:111], v[148:163]
    buffer_load_dwordx4 v12, s[60:63], s53 offen  lds
    v_dot2c_f32_bf16 v206, v201, v186
    v_mul_f32 v203, v203, v192
    v_mul_f32 v204, v204, v193
    s_add_u32 m0, s49, 115712
    v_mfma_f32_32x32x16_bf16 v[164:179], v[104:107], v[112:115], v[164:179]
    buffer_load_dwordx4 v13, s[60:63], s53 offen  lds
    v_mul_f32 v205, v205, v194
    v_mul_f32 v206, v206, v195
    v_cvt_pk_bf16_f32 v216, v206, v205
    v_cvt_pk_bf16_f32 v217, v204, v203
    s_waitcnt lgkmcnt(2)
    v_mfma_f32_32x32x16_bf16 v[116:131], v[84:87], v[92:95], v[116:131]
    ds_read_b128 v[100:103], v69 offset:0
    ds_read_b128 v[108:111], v77 offset:0
    v_perm_b32 v196, v21, v25, s7
    v_perm_b32 v197, v25, v29, s7
    v_permlane32_swap_b32 v218, v216
    s_waitcnt lgkmcnt(3)
    v_mfma_f32_32x32x16_bf16 v[132:147], v[84:87], v[96:99], v[132:147]
    ds_read_b128 v[112:115], v77 offset:4096
    ds_read_b128 v[104:107], v69 offset:4096
    v_permlane32_swap_b32 v219, v217
    v_perm_b32 v198, v29, v33, s7
    s_add_u32 m0, s49, 116736
    s_waitcnt lgkmcnt(4)
    v_mfma_f32_32x32x16_bf16 v[148:163], v[88:91], v[92:95], v[148:163]
    buffer_load_dwordx4 v14, s[60:63], s53 offen  lds
    v_perm_b32 v199, v33, v37, s7
    v_perm_b32 v200, v37, v41, s7
    v_perm_b32 v201, v41, v45, s7
    s_add_u32 m0, s49, 117760
    v_mfma_f32_32x32x16_bf16 v[164:179], v[88:91], v[96:99], v[164:179]
    buffer_load_dwordx4 v15, s[60:63], s53 offen  lds
    v_lshlrev_b32 v192, 16, v49
    v_lshlrev_b32 v193, 16, v53
    v_lshlrev_b32 v194, 16, v57
    v_lshlrev_b32 v195, 16, v61
    s_waitcnt lgkmcnt(0)
    s_waitcnt vmcnt(20)
    s_barrier
    v_mfma_f32_32x32x16_bf16 v[116:131], v[100:103], v[108:111], v[116:131]
    ds_read_b128 v[84:87], v66 offset:32768
    ds_read_b128 v[92:95], v74 offset:32768
    v_dot2_f32_bf16 v203, v196, v189, 0
    v_dot2_f32_bf16 v204, v197, v189, 0
    v_dot2_f32_bf16 v205, v198, v189, 0
    v_mfma_f32_32x32x16_bf16 v[132:147], v[100:103], v[112:115], v[132:147]
    ds_read_b128 v[96:99], v74 offset:36864
    ds_read_b128 v[88:91], v66 offset:36864
    s_add_u32 s51, s51, 128
    s_and_b32 s51, s51, 0x7ff
    s_add_u32 s52, s47, s51
    s_add_u32 m0, s49, 0
    v_mfma_f32_32x32x16_bf16 v[148:163], v[104:107], v[108:111], v[148:163]
    buffer_load_dwordx4 v8, s[56:59], s52 offen  lds
    v_dot2_f32_bf16 v206, v199, v189, 0
    v_dot2c_f32_bf16 v203, v198, v188
    v_dot2c_f32_bf16 v204, v199, v188
    s_add_u32 m0, s49, 1024
    v_mfma_f32_32x32x16_bf16 v[164:179], v[104:107], v[112:115], v[164:179]
    buffer_load_dwordx4 v9, s[56:59], s52 offen  lds
    v_dot2c_f32_bf16 v205, v200, v188
    v_dot2c_f32_bf16 v206, v201, v188
    v_mul_f32 v203, v203, v192
    v_mul_f32 v204, v204, v193
    s_waitcnt lgkmcnt(2)
    v_mfma_f32_32x32x16_bf16 v[116:131], v[84:87], v[92:95], v[116:131]
    ds_read_b128 v[100:103], v67 offset:32768
    ds_read_b128 v[108:111], v75 offset:32768
    v_mul_f32 v205, v205, v194
    v_mul_f32 v206, v206, v195
    v_cvt_pk_bf16_f32 v222, v206, v205
    s_waitcnt lgkmcnt(3)
    v_mfma_f32_32x32x16_bf16 v[132:147], v[84:87], v[96:99], v[132:147]
    ds_read_b128 v[112:115], v75 offset:36864
    ds_read_b128 v[104:107], v67 offset:36864
    v_cvt_pk_bf16_f32 v223, v204, v203
    v_perm_b32 v196, v21, v25, s12
    s_add_u32 m0, s49, 2048
    s_waitcnt lgkmcnt(4)
    v_mfma_f32_32x32x16_bf16 v[148:163], v[88:91], v[92:95], v[148:163]
    buffer_load_dwordx4 v10, s[56:59], s52 offen  lds
    v_perm_b32 v197, v25, v29, s12
    v_perm_b32 v198, v29, v33, s12
    v_perm_b32 v199, v33, v37, s12
    s_add_u32 m0, s49, 3072
    v_mfma_f32_32x32x16_bf16 v[164:179], v[88:91], v[96:99], v[164:179]
    buffer_load_dwordx4 v11, s[56:59], s52 offen  lds
    v_perm_b32 v200, v37, v41, s12
    v_perm_b32 v201, v41, v45, s12
    v_and_b32 v192, s5, v49
    v_and_b32 v193, s5, v53
    s_waitcnt lgkmcnt(2)
    v_mfma_f32_32x32x16_bf16 v[116:131], v[100:103], v[108:111], v[116:131]
    ds_read_b128 v[84:87], v68 offset:32768
    ds_read_b128 v[92:95], v76 offset:32768
    v_and_b32 v194, s5, v57
    v_and_b32 v195, s5, v61
    v_dot2_f32_bf16 v203, v196, v191, 0
    s_waitcnt lgkmcnt(3)
    v_mfma_f32_32x32x16_bf16 v[132:147], v[100:103], v[112:115], v[132:147]
    ds_read_b128 v[96:99], v76 offset:36864
    ds_read_b128 v[88:91], v68 offset:36864
    v_dot2_f32_bf16 v204, v197, v191, 0
    s_add_u32 s53, s48, s51
    s_add_u32 m0, s49, 16384
    s_waitcnt lgkmcnt(4)
    v_mfma_f32_32x32x16_bf16 v[148:163], v[104:107], v[108:111], v[148:163]
    buffer_load_dwordx4 v12, s[60:63], s53 offen  lds
    v_dot2_f32_bf16 v205, v198, v191, 0
    v_dot2_f32_bf16 v206, v199, v191, 0
    v_dot2c_f32_bf16 v203, v198, v190
    s_add_u32 m0, s49, 17408
    v_mfma_f32_32x32x16_bf16 v[164:179], v[104:107], v[112:115], v[164:179]
    buffer_load_dwordx4 v13, s[60:63], s53 offen  lds
    v_dot2c_f32_bf16 v204, v199, v190
    v_dot2c_f32_bf16 v205, v200, v190
    v_dot2c_f32_bf16 v206, v201, v190
    v_mul_f32 v203, v203, v192
    s_waitcnt lgkmcnt(2)
    v_mfma_f32_32x32x16_bf16 v[116:131], v[84:87], v[92:95], v[116:131]
    ds_read_b128 v[100:103], v69 offset:32768
    ds_read_b128 v[108:111], v77 offset:32768
    v_mul_f32 v204, v204, v193
    v_mul_f32 v205, v205, v194
    v_mul_f32 v206, v206, v195
    s_waitcnt lgkmcnt(3)
    v_mfma_f32_32x32x16_bf16 v[132:147], v[84:87], v[96:99], v[132:147]
    ds_read_b128 v[112:115], v77 offset:36864
    ds_read_b128 v[104:107], v69 offset:36864
    v_cvt_pk_bf16_f32 v220, v206, v205
    v_cvt_pk_bf16_f32 v221, v204, v203
    s_add_u32 m0, s49, 18432
    s_waitcnt lgkmcnt(4)
    v_mfma_f32_32x32x16_bf16 v[148:163], v[88:91], v[92:95], v[148:163]
    buffer_load_dwordx4 v14, s[60:63], s53 offen  lds
    v_permlane32_swap_b32 v222, v220
    v_permlane32_swap_b32 v223, v221
    s_add_u32 m0, s49, 19456
    v_mfma_f32_32x32x16_bf16 v[164:179], v[88:91], v[96:99], v[164:179]
    buffer_load_dwordx4 v15, s[60:63], s53 offen  lds
    s_waitcnt lgkmcnt(0)
    s_waitcnt vmcnt(20)
    s_barrier
    v_mfma_f32_32x32x16_bf16 v[116:131], v[100:103], v[108:111], v[116:131]
    ds_read_b128 v[84:87], v70 offset:0
    ds_read_b128 v[92:95], v78 offset:0
    v_mfma_f32_32x32x16_bf16 v[132:147], v[100:103], v[112:115], v[132:147]
    ds_read_b128 v[96:99], v78 offset:4096
    ds_read_b128 v[88:91], v70 offset:4096
    s_add_u32 s51, s51, 128
    s_and_b32 s51, s51, 0x7ff
    s_add_u32 s52, s47, s51
    s_add_u32 m0, s49, 32768
    v_mfma_f32_32x32x16_bf16 v[148:163], v[104:107], v[108:111], v[148:163]
    buffer_load_dwordx4 v8, s[56:59], s52 offen  lds
    s_add_u32 m0, s49, 33792
    v_mfma_f32_32x32x16_bf16 v[164:179], v[104:107], v[112:115], v[164:179]
    buffer_load_dwordx4 v9, s[56:59], s52 offen  lds
    s_waitcnt lgkmcnt(2)
    v_mfma_f32_32x32x16_bf16 v[116:131], v[84:87], v[92:95], v[116:131]
    ds_read_b128 v[100:103], v71 offset:0
    ds_read_b128 v[108:111], v79 offset:0
    s_waitcnt lgkmcnt(3)
    v_mfma_f32_32x32x16_bf16 v[132:147], v[84:87], v[96:99], v[132:147]
    ds_read_b128 v[112:115], v79 offset:4096
    ds_read_b128 v[104:107], v71 offset:4096
    s_add_u32 m0, s49, 34816
    s_waitcnt lgkmcnt(4)
    v_mfma_f32_32x32x16_bf16 v[148:163], v[88:91], v[92:95], v[148:163]
    buffer_load_dwordx4 v10, s[56:59], s52 offen  lds
    s_add_u32 m0, s49, 35840
    v_mfma_f32_32x32x16_bf16 v[164:179], v[88:91], v[96:99], v[164:179]
    buffer_load_dwordx4 v11, s[56:59], s52 offen  lds
    s_waitcnt lgkmcnt(2)
    v_mfma_f32_32x32x16_bf16 v[116:131], v[100:103], v[108:111], v[116:131]
    ds_read_b128 v[84:87], v72 offset:0
    ds_read_b128 v[92:95], v80 offset:0
    s_waitcnt lgkmcnt(3)
    v_mfma_f32_32x32x16_bf16 v[132:147], v[100:103], v[112:115], v[132:147]
    ds_read_b128 v[96:99], v80 offset:4096
    ds_read_b128 v[88:91], v72 offset:4096
    s_add_u32 s53, s48, s51
    s_add_u32 m0, s49, 49152
    s_waitcnt lgkmcnt(4)
    v_mfma_f32_32x32x16_bf16 v[148:163], v[104:107], v[108:111], v[148:163]
    buffer_load_dwordx4 v12, s[60:63], s53 offen  lds
    s_add_u32 m0, s49, 50176
    v_mfma_f32_32x32x16_bf16 v[164:179], v[104:107], v[112:115], v[164:179]
    buffer_load_dwordx4 v13, s[60:63], s53 offen  lds
    s_waitcnt lgkmcnt(2)
    v_mfma_f32_32x32x16_bf16 v[116:131], v[84:87], v[92:95], v[116:131]
    ds_read_b128 v[100:103], v73 offset:0
    ds_read_b128 v[108:111], v81 offset:0
    s_waitcnt lgkmcnt(3)
    v_mfma_f32_32x32x16_bf16 v[132:147], v[84:87], v[96:99], v[132:147]
    ds_read_b128 v[112:115], v81 offset:4096
    ds_read_b128 v[104:107], v73 offset:4096
    s_add_u32 m0, s49, 51200
    s_waitcnt lgkmcnt(4)
    v_mfma_f32_32x32x16_bf16 v[148:163], v[88:91], v[92:95], v[148:163]
    buffer_load_dwordx4 v14, s[60:63], s53 offen  lds
    s_add_u32 m0, s49, 52224
    v_mfma_f32_32x32x16_bf16 v[164:179], v[88:91], v[96:99], v[164:179]
    buffer_load_dwordx4 v15, s[60:63], s53 offen  lds
    s_waitcnt lgkmcnt(0)
    s_waitcnt vmcnt(16)
    s_barrier
    v_mfma_f32_32x32x16_bf16 v[116:131], v[100:103], v[108:111], v[116:131]
    ds_read_b128 v[84:87], v70 offset:32768
    ds_read_b128 v[92:95], v78 offset:32768
    v_mov_b32 v3, 0
    buffer_load_dwordx2 v[4:5], v3, s[24:27], 0 offen sc0 sc1
    v_mfma_f32_32x32x16_bf16 v[132:147], v[100:103], v[112:115], v[132:147]
    ds_read_b128 v[96:99], v78 offset:36864
    ds_read_b128 v[88:91], v70 offset:36864
    s_add_u32 s51, s51, 128
    s_and_b32 s51, s51, 0x7ff
    s_add_u32 s52, s47, s51
    s_add_u32 m0, s49, 65536
    v_mfma_f32_32x32x16_bf16 v[148:163], v[104:107], v[108:111], v[148:163]
    buffer_load_dwordx4 v8, s[56:59], s52 offen  lds
    buffer_store_dwordx4 v[208:211], v181, s[8:11], s6 offen sc0 sc1
    s_add_u32 m0, s49, 66560
    v_mfma_f32_32x32x16_bf16 v[164:179], v[104:107], v[112:115], v[164:179]
    buffer_load_dwordx4 v9, s[56:59], s52 offen  lds
    s_add_u32 s6, s6, 32768
    buffer_store_dwordx4 v[212:215], v181, s[8:11], s6 offen sc0 sc1
    s_waitcnt lgkmcnt(2)
    v_mfma_f32_32x32x16_bf16 v[116:131], v[84:87], v[92:95], v[116:131]
    ds_read_b128 v[100:103], v71 offset:32768
    ds_read_b128 v[108:111], v79 offset:32768
    s_add_u32 s6, s6, 32768
    buffer_store_dwordx4 v[216:219], v181, s[8:11], s6 offen sc0 sc1
    s_waitcnt lgkmcnt(3)
    v_mfma_f32_32x32x16_bf16 v[132:147], v[84:87], v[96:99], v[132:147]
    ds_read_b128 v[112:115], v79 offset:36864
    ds_read_b128 v[104:107], v71 offset:36864
    s_add_u32 s6, s6, 32768
    s_add_u32 m0, s49, 67584
    s_waitcnt lgkmcnt(4)
    v_mfma_f32_32x32x16_bf16 v[148:163], v[88:91], v[92:95], v[148:163]
    buffer_load_dwordx4 v10, s[56:59], s52 offen  lds
    buffer_store_dwordx4 v[220:223], v181, s[8:11], s6 offen sc0 sc1
    s_add_u32 m0, s49, 68608
    v_mfma_f32_32x32x16_bf16 v[164:179], v[88:91], v[96:99], v[164:179]
    buffer_load_dwordx4 v11, s[56:59], s52 offen  lds
    s_mov_b64 s[30:31], exec
    s_mov_b32 exec_lo, 0
    s_mov_b32 exec_hi, 0x80000000
    buffer_store_dwordx2 v[226:227], v225, s[8:11], 0 offen sc0 sc1
    buffer_store_dwordx2 v[228:229], v225, s[8:11], s32 offen sc0 sc1
    s_mov_b64 exec, s[30:31]
    s_waitcnt lgkmcnt(2)
    v_mfma_f32_32x32x16_bf16 v[116:131], v[100:103], v[108:111], v[116:131]
    ds_read_b128 v[84:87], v72 offset:32768
    ds_read_b128 v[92:95], v80 offset:32768
    s_waitcnt lgkmcnt(3)
    v_mfma_f32_32x32x16_bf16 v[132:147], v[100:103], v[112:115], v[132:147]
    ds_read_b128 v[96:99], v80 offset:36864
    ds_read_b128 v[88:91], v72 offset:36864
    s_add_u32 s53, s48, s51
    s_add_u32 m0, s49, 81920
    s_waitcnt lgkmcnt(4)
    v_mfma_f32_32x32x16_bf16 v[148:163], v[104:107], v[108:111], v[148:163]
    buffer_load_dwordx4 v12, s[60:63], s53 offen  lds
    s_add_u32 m0, s49, 82944
    v_mfma_f32_32x32x16_bf16 v[164:179], v[104:107], v[112:115], v[164:179]
    buffer_load_dwordx4 v13, s[60:63], s53 offen  lds
    s_waitcnt lgkmcnt(2)
    v_mfma_f32_32x32x16_bf16 v[116:131], v[84:87], v[92:95], v[116:131]
    ds_read_b128 v[100:103], v73 offset:32768
    ds_read_b128 v[108:111], v81 offset:32768
    s_waitcnt lgkmcnt(3)
    v_mfma_f32_32x32x16_bf16 v[132:147], v[84:87], v[96:99], v[132:147]
    ds_read_b128 v[112:115], v81 offset:36864
    ds_read_b128 v[104:107], v73 offset:36864
    s_add_u32 m0, s49, 83968
    s_waitcnt lgkmcnt(4)
    v_mfma_f32_32x32x16_bf16 v[148:163], v[88:91], v[92:95], v[148:163]
    buffer_load_dwordx4 v14, s[60:63], s53 offen  lds
    s_add_u32 m0, s49, 84992
    v_mfma_f32_32x32x16_bf16 v[164:179], v[88:91], v[96:99], v[164:179]
    buffer_load_dwordx4 v15, s[60:63], s53 offen  lds
    s_waitcnt lgkmcnt(0)
    s_waitcnt vmcnt(23)
    s_barrier
    v_mfma_f32_32x32x16_bf16 v[116:131], v[100:103], v[108:111], v[116:131]
    ds_read_b128 v[84:87], v66 offset:0
    ds_read_b128 v[92:95], v74 offset:0
    v_mfma_f32_32x32x16_bf16 v[132:147], v[100:103], v[112:115], v[132:147]
    ds_read_b128 v[96:99], v74 offset:4096
    ds_read_b128 v[88:91], v66 offset:4096
    s_add_u32 s51, s51, 128
    s_and_b32 s51, s51, 0x7ff
    s_add_u32 s52, s47, s51
    s_add_u32 m0, s49, 98304
    v_mfma_f32_32x32x16_bf16 v[148:163], v[104:107], v[108:111], v[148:163]
    buffer_load_dwordx4 v8, s[56:59], s52 offen  lds
    s_add_u32 m0, s49, 99328
    v_mfma_f32_32x32x16_bf16 v[164:179], v[104:107], v[112:115], v[164:179]
    buffer_load_dwordx4 v9, s[56:59], s52 offen  lds
    s_waitcnt lgkmcnt(2)
    v_mfma_f32_32x32x16_bf16 v[116:131], v[84:87], v[92:95], v[116:131]
    ds_read_b128 v[100:103], v67 offset:0
    ds_read_b128 v[108:111], v75 offset:0
    s_waitcnt lgkmcnt(3)
    v_mfma_f32_32x32x16_bf16 v[132:147], v[84:87], v[96:99], v[132:147]
    ds_read_b128 v[112:115], v75 offset:4096
    ds_read_b128 v[104:107], v67 offset:4096
    s_add_u32 m0, s49, 100352
    s_waitcnt lgkmcnt(4)
    v_mfma_f32_32x32x16_bf16 v[148:163], v[88:91], v[92:95], v[148:163]
    buffer_load_dwordx4 v10, s[56:59], s52 offen  lds
    s_add_u32 m0, s49, 101376
    v_mfma_f32_32x32x16_bf16 v[164:179], v[88:91], v[96:99], v[164:179]
    buffer_load_dwordx4 v11, s[56:59], s52 offen  lds
    s_waitcnt lgkmcnt(2)
    v_mfma_f32_32x32x16_bf16 v[116:131], v[100:103], v[108:111], v[116:131]
    ds_read_b128 v[84:87], v68 offset:0
    ds_read_b128 v[92:95], v76 offset:0
    s_waitcnt lgkmcnt(3)
    v_mfma_f32_32x32x16_bf16 v[132:147], v[100:103], v[112:115], v[132:147]
    ds_read_b128 v[96:99], v76 offset:4096
    ds_read_b128 v[88:91], v68 offset:4096
    s_add_u32 s53, s48, s51
    s_add_u32 m0, s49, 114688
    s_waitcnt lgkmcnt(4)
    v_mfma_f32_32x32x16_bf16 v[148:163], v[104:107], v[108:111], v[148:163]
    buffer_load_dwordx4 v12, s[60:63], s53 offen  lds
    s_add_u32 m0, s49, 115712
    v_mfma_f32_32x32x16_bf16 v[164:179], v[104:107], v[112:115], v[164:179]
    buffer_load_dwordx4 v13, s[60:63], s53 offen  lds
    s_waitcnt lgkmcnt(2)
    v_mfma_f32_32x32x16_bf16 v[116:131], v[84:87], v[92:95], v[116:131]
    ds_read_b128 v[100:103], v69 offset:0
    ds_read_b128 v[108:111], v77 offset:0
    s_waitcnt lgkmcnt(3)
    v_mfma_f32_32x32x16_bf16 v[132:147], v[84:87], v[96:99], v[132:147]
    ds_read_b128 v[112:115], v77 offset:4096
    ds_read_b128 v[104:107], v69 offset:4096
    s_add_u32 m0, s49, 116736
    s_waitcnt lgkmcnt(4)
    v_mfma_f32_32x32x16_bf16 v[148:163], v[88:91], v[92:95], v[148:163]
    buffer_load_dwordx4 v14, s[60:63], s53 offen  lds
    s_add_u32 m0, s49, 117760
    v_mfma_f32_32x32x16_bf16 v[164:179], v[88:91], v[96:99], v[164:179]
    buffer_load_dwordx4 v15, s[60:63], s53 offen  lds
    s_waitcnt lgkmcnt(0)
    s_waitcnt vmcnt(23)
    s_barrier
    v_mfma_f32_32x32x16_bf16 v[116:131], v[100:103], v[108:111], v[116:131]
    ds_read_b128 v[84:87], v66 offset:32768
    ds_read_b128 v[92:95], v74 offset:32768
    s_lshl_b32 s6, s46, 2
    s_add_u32 s6, s6, s44
    s_lshl_b32 s6, s6, 16
    s_lshl_b32 s3, s45, 12
    v_mfma_f32_32x32x16_bf16 v[132:147], v[100:103], v[112:115], v[132:147]
    ds_read_b128 v[96:99], v74 offset:36864
    ds_read_b128 v[88:91], v66 offset:36864
    s_add_u32 s6, s6, s3
    s_add_u32 s6, s6, 16777216
    s_mov_b32 s7, 0x05040100
    s_mov_b32 s12, 0x07060302
    v_mfma_f32_32x32x16_bf16 v[148:163], v[104:107], v[108:111], v[148:163]
    v_and_b32 v20, 31, v2
    v_lshlrev_b32 v18, 6, v20
    v_bfe_u32 v20, v2, 2, 2
    v_lshrrev_b32 v21, 5, v2
    v_lshlrev_b32 v21, 1, v21
    v_xor_b32 v20, v20, v21
    v_mfma_f32_32x32x16_bf16 v[164:179], v[104:107], v[112:115], v[164:179]
    v_lshl_add_u32 v18, v20, 4, v18
    v_add_u32 v18, s16, v18
    v_xor_b32 v19, 16, v18
    ds_read_b128 v[22:25], v18 offset:0
    ds_read_b128 v[26:29], v19 offset:0
    s_waitcnt lgkmcnt(4)
    v_mfma_f32_32x32x16_bf16 v[116:131], v[84:87], v[92:95], v[116:131]
    ds_read_b128 v[100:103], v67 offset:32768
    ds_read_b128 v[108:111], v75 offset:32768
    ds_read_b128 v[30:33], v18 offset:2048
    ds_read_b128 v[34:37], v19 offset:2048
    s_waitcnt lgkmcnt(1)
    v_perm_b32 v38, v30, v22, s7
    v_perm_b32 v39, v30, v22, s12
    v_mfma_f32_32x32x16_bf16 v[132:147], v[84:87], v[96:99], v[132:147]
    ds_read_b128 v[112:115], v75 offset:36864
    ds_read_b128 v[104:107], v67 offset:36864
    v_perm_b32 v40, v31, v23, s7
    v_perm_b32 v41, v31, v23, s12
    buffer_store_dwordx4 v[38:41], v17, s[8:11], s6 offen offset:0 sc0 sc1
    v_perm_b32 v42, v32, v24, s7
    v_mfma_f32_32x32x16_bf16 v[148:163], v[88:91], v[92:95], v[148:163]
    v_perm_b32 v43, v32, v24, s12
    v_perm_b32 v44, v33, v25, s7
    v_perm_b32 v45, v33, v25, s12
    buffer_store_dwordx4 v[42:45], v17, s[8:11], s6 offen offset:1024 sc0 sc1
    s_waitcnt lgkmcnt(2)
    v_perm_b32 v38, v34, v26, s7
    v_perm_b32 v39, v34, v26, s12
    v_mfma_f32_32x32x16_bf16 v[164:179], v[88:91], v[96:99], v[164:179]
    v_perm_b32 v40, v35, v27, s7
    v_perm_b32 v41, v35, v27, s12
    buffer_store_dwordx4 v[38:41], v17, s[8:11], s6 offen offset:2048 sc0 sc1
    v_perm_b32 v42, v36, v28, s7
    v_perm_b32 v43, v36, v28, s12
    v_perm_b32 v44, v37, v29, s7
    v_mfma_f32_32x32x16_bf16 v[116:131], v[100:103], v[108:111], v[116:131]
    ds_read_b128 v[84:87], v68 offset:32768
    ds_read_b128 v[92:95], v76 offset:32768
    v_perm_b32 v45, v37, v29, s12
    buffer_store_dwordx4 v[42:45], v17, s[8:11], s6 offen offset:3072 sc0 sc1
    v_subrev_u32 v62, 32, v17
    s_waitcnt lgkmcnt(3)
    v_mfma_f32_32x32x16_bf16 v[132:147], v[100:103], v[112:115], v[132:147]
    ds_read_b128 v[96:99], v76 offset:36864
    ds_read_b128 v[88:91], v68 offset:36864
    v_min_u32 v62, 0x7fff0000, v62
    v_subrev_u32 v63, 16, v17
    v_min_u32 v63, 0x7fff0000, v63
    v_add_u32 v64, s23, v17
    s_waitcnt lgkmcnt(4)
    v_mfma_f32_32x32x16_bf16 v[148:163], v[104:107], v[108:111], v[148:163]
    buffer_load_dwordx4 v[38:41], v62, s[76:79], 0 offen
    buffer_load_dwordx2 v[48:49], v63, s[76:79], 0 offen
    v_mfma_f32_32x32x16_bf16 v[164:179], v[104:107], v[112:115], v[164:179]
    buffer_load_dwordx4 v[22:25], v17, s[76:79], 0 offen offset:0
    s_waitcnt lgkmcnt(2)
    v_mfma_f32_32x32x16_bf16 v[116:131], v[84:87], v[92:95], v[116:131]
    ds_read_b128 v[100:103], v69 offset:32768
    ds_read_b128 v[108:111], v77 offset:32768
    buffer_load_dwordx2 v[18:19], v17, s[76:79], 0 offen offset:16
    s_waitcnt lgkmcnt(3)
    v_mfma_f32_32x32x16_bf16 v[132:147], v[84:87], v[96:99], v[132:147]
    ds_read_b128 v[112:115], v77 offset:36864
    ds_read_b128 v[104:107], v69 offset:36864
    buffer_load_dwordx4 v[26:29], v17, s[76:79], 0 offen offset:1024
    s_waitcnt lgkmcnt(4)
    v_mfma_f32_32x32x16_bf16 v[148:163], v[88:91], v[92:95], v[148:163]
    buffer_load_dwordx2 v[42:43], v17, s[76:79], 0 offen offset:1040
    buffer_load_dwordx4 v[30:33], v17, s[76:79], 0 offen offset:2048
    v_mfma_f32_32x32x16_bf16 v[164:179], v[88:91], v[96:99], v[164:179]
    buffer_load_dwordx2 v[44:45], v17, s[76:79], 0 offen offset:2064
    s_waitcnt lgkmcnt(0)
    s_waitcnt vmcnt(20)
    s_barrier
    v_mfma_f32_32x32x16_bf16 v[116:131], v[100:103], v[108:111], v[116:131]
    ds_read_b128 v[84:87], v70 offset:0
    ds_read_b128 v[92:95], v78 offset:0
    buffer_load_dwordx4 v[34:37], v17, s[76:79], 0 offen offset:3072
    v_mfma_f32_32x32x16_bf16 v[132:147], v[100:103], v[112:115], v[132:147]
    ds_read_b128 v[96:99], v78 offset:4096
    ds_read_b128 v[88:91], v70 offset:4096
    buffer_load_dwordx2 v[46:47], v17, s[76:79], 0 offen offset:3088
    v_mfma_f32_32x32x16_bf16 v[148:163], v[104:107], v[108:111], v[148:163]
    s_mov_b32 s88, s20
    s_mov_b32 s89, s21
    s_mov_b32 s90, 2048
    s_mov_b32 s91, 131072
    s_and_b32 s3, s44, 1
    s_lshl_b32 s3, s3, 5
    v_mfma_f32_32x32x16_bf16 v[164:179], v[104:107], v[112:115], v[164:179]
    s_and_b32 s3, s44, 1
    s_lshl_b32 s3, s3, 6
    v_and_b32 v65, 31, v2
    v_lshl_add_u32 v65, v65, 1, s3
    s_lshl_b32 s3, s46, 7
    buffer_load_ushort v65, v65, s[88:91], s3 offen
    v_and_b32 v180, 15, v2
    v_lshrrev_b32 v181, 4, v2
    v_add_u32 v184, 1, v180
    s_waitcnt lgkmcnt(2)
    v_mfma_f32_32x32x16_bf16 v[116:131], v[84:87], v[92:95], v[116:131]
    ds_read_b128 v[100:103], v71 offset:0
    ds_read_b128 v[108:111], v79 offset:0
    v_and_b32 v185, 3, v184
    v_mul_u32_u24 v185, 4160, v185
    v_and_b32 v184, 28, v184
    v_lshl_add_u32 v185, v184, 1, v185
    s_waitcnt lgkmcnt(3)
    v_mfma_f32_32x32x16_bf16 v[132:147], v[84:87], v[96:99], v[132:147]
    ds_read_b128 v[112:115], v79 offset:4096
    ds_read_b128 v[104:107], v71 offset:4096
    v_lshl_add_u32 v185, v181, 4, v185
    v_add_u32 v186, s23, v185
    v_lshlrev_b32 v184, 1, v180
    v_sub_u32 v184, v181, v184
    s_waitcnt lgkmcnt(4)
    v_mfma_f32_32x32x16_bf16 v[148:163], v[88:91], v[92:95], v[148:163]
    v_add_u32 v184, 30, v184
    v_lshrrev_b32 v185, 2, v184
    v_lshlrev_b32 v184, 6, v184
    v_add_u32 v184, 132096, v184
    v_add_u32 v187, 63, v185
    v_and_b32 v187, 3, v187
    v_mfma_f32_32x32x16_bf16 v[164:179], v[88:91], v[96:99], v[164:179]
    v_xor_b32 v187, s44, v187
    v_lshl_add_u32 v187, v187, 4, v184
    v_add_u32 v188, 62, v185
    v_and_b32 v188, 3, v188
    v_xor_b32 v188, s44, v188
    v_lshl_add_u32 v188, v188, 4, v184
    s_waitcnt lgkmcnt(2)
    v_mfma_f32_32x32x16_bf16 v[116:131], v[100:103], v[108:111], v[116:131]
    ds_read_b128 v[84:87], v72 offset:0
    ds_read_b128 v[92:95], v80 offset:0
    v_add_u32 v189, 61, v185
    v_and_b32 v189, 3, v189
    v_xor_b32 v189, s44, v189
    v_lshl_add_u32 v189, v189, 4, v184
    s_waitcnt lgkmcnt(3)
    v_mfma_f32_32x32x16_bf16 v[132:147], v[100:103], v[112:115], v[132:147]
    ds_read_b128 v[96:99], v80 offset:4096
    ds_read_b128 v[88:91], v72 offset:4096
    v_add_u32 v190, 60, v185
    v_and_b32 v190, 3, v190
    v_xor_b32 v190, s44, v190
    v_lshl_add_u32 v190, v190, 4, v184
    s_waitcnt lgkmcnt(4)
    v_mfma_f32_32x32x16_bf16 v[148:163], v[104:107], v[108:111], v[148:163]
    v_lshlrev_b32 v184, 5, v180
    v_lshl_add_u32 v184, v181, 3, v184
    v_sub_u32 v184, 504, v184
    v_and_b32 v191, 8, v184
    v_lshrrev_b32 v184, 4, v184
    v_lshl_add_u32 v191, v184, 6, v191
    v_mfma_f32_32x32x16_bf16 v[164:179], v[104:107], v[112:115], v[164:179]
    v_bfe_u32 v184, v184, 2, 2
    v_xor_b32 v184, s44, v184
    v_lshl_add_u32 v191, v184, 4, v191
    v_add_u32 v191, 132096, v191
    v_and_b32 v184, 1, v181
    v_lshlrev_b32 v184, 9, v184
    s_waitcnt lgkmcnt(2)
    v_mfma_f32_32x32x16_bf16 v[116:131], v[84:87], v[92:95], v[116:131]
    ds_read_b128 v[100:103], v73 offset:0
    ds_read_b128 v[108:111], v81 offset:0
    v_lshl_add_u32 v184, v180, 5, v184
    v_lshrrev_b32 v185, 1, v181
    v_lshl_add_u32 v192, v185, 4, v184
    s_mov_b32 s6, 0
    v_readfirstlane_b32 s42, v4
    v_readfirstlane_b32 s43, v5
    s_nop 3
    s_or_b32 s3, s42, s43
    s_cmp_lg_u32 s3, 0
    s_cbranch_scc1 Lnok_gate_2
Lnretry_gate_3:
    buffer_load_dwordx2 v[4:5], v3, s[24:27], 0 offen sc0 sc1
    s_waitcnt vmcnt(0)
    v_readfirstlane_b32 s42, v4
    v_readfirstlane_b32 s43, v5
    s_add_u32 s6, s6, 1
    s_nop 3
    s_or_b32 s3, s42, s43
    s_cmp_gt_u32 s6, 20000
    s_cbranch_scc1 Lnok_gate_2
    s_cmp_eq_u32 s3, 0
    s_cbranch_scc1 Lnretry_gate_3
Lnok_gate_2:
    s_waitcnt lgkmcnt(3)
    v_mfma_f32_32x32x16_bf16 v[132:147], v[84:87], v[96:99], v[132:147]
    ds_read_b128 v[112:115], v81 offset:4096
    ds_read_b128 v[104:107], v73 offset:4096
    v_mov_b32 v82, s42
    v_mov_b32 v83, s43
    s_mov_b64 s[6:7], exec
    s_mov_b64 exec, 1
    buffer_store_dwordx2 v[82:83], v6, s[8:11], s13 offen sc0 sc1
    s_mov_b64 exec, s[6:7]
    s_waitcnt lgkmcnt(4)
    v_mfma_f32_32x32x16_bf16 v[148:163], v[88:91], v[92:95], v[148:163]
    v_mfma_f32_32x32x16_bf16 v[164:179], v[88:91], v[96:99], v[164:179]
    s_waitcnt lgkmcnt(0)
    s_waitcnt vmcnt(16)
    s_barrier
    v_mfma_f32_32x32x16_bf16 v[116:131], v[100:103], v[108:111], v[116:131]
    ds_read_b128 v[84:87], v70 offset:32768
    ds_read_b128 v[92:95], v78 offset:32768
    v_mfma_f32_32x32x16_bf16 v[132:147], v[100:103], v[112:115], v[132:147]
    ds_read_b128 v[96:99], v78 offset:36864
    ds_read_b128 v[88:91], v70 offset:36864
    v_mfma_f32_32x32x16_bf16 v[148:163], v[104:107], v[108:111], v[148:163]
    v_mfma_f32_32x32x16_bf16 v[164:179], v[104:107], v[112:115], v[164:179]
    s_waitcnt lgkmcnt(2)
    v_mfma_f32_32x32x16_bf16 v[116:131], v[84:87], v[92:95], v[116:131]
    ds_read_b128 v[100:103], v71 offset:32768
    ds_read_b128 v[108:111], v79 offset:32768
    s_waitcnt lgkmcnt(3)
    v_mfma_f32_32x32x16_bf16 v[132:147], v[84:87], v[96:99], v[132:147]
    ds_read_b128 v[112:115], v79 offset:36864
    ds_read_b128 v[104:107], v71 offset:36864
    s_waitcnt lgkmcnt(4)
    v_mfma_f32_32x32x16_bf16 v[148:163], v[88:91], v[92:95], v[148:163]
    v_mfma_f32_32x32x16_bf16 v[164:179], v[88:91], v[96:99], v[164:179]
    s_waitcnt lgkmcnt(2)
    v_mfma_f32_32x32x16_bf16 v[116:131], v[100:103], v[108:111], v[116:131]
    ds_read_b128 v[84:87], v72 offset:32768
    ds_read_b128 v[92:95], v80 offset:32768
    s_waitcnt lgkmcnt(3)
    v_mfma_f32_32x32x16_bf16 v[132:147], v[100:103], v[112:115], v[132:147]
    ds_read_b128 v[96:99], v80 offset:36864
    ds_read_b128 v[88:91], v72 offset:36864
    s_waitcnt lgkmcnt(4)
    v_mfma_f32_32x32x16_bf16 v[148:163], v[104:107], v[108:111], v[148:163]
    v_mfma_f32_32x32x16_bf16 v[164:179], v[104:107], v[112:115], v[164:179]
    s_waitcnt lgkmcnt(2)
    v_mfma_f32_32x32x16_bf16 v[116:131], v[84:87], v[92:95], v[116:131]
    ds_read_b128 v[100:103], v73 offset:32768
    ds_read_b128 v[108:111], v81 offset:32768
    s_waitcnt lgkmcnt(3)
    v_mfma_f32_32x32x16_bf16 v[132:147], v[84:87], v[96:99], v[132:147]
    ds_read_b128 v[112:115], v81 offset:36864
    ds_read_b128 v[104:107], v73 offset:36864
    s_waitcnt lgkmcnt(4)
    v_mfma_f32_32x32x16_bf16 v[148:163], v[88:91], v[92:95], v[148:163]
    v_mfma_f32_32x32x16_bf16 v[164:179], v[88:91], v[96:99], v[164:179]
    s_waitcnt lgkmcnt(0)
    v_mfma_f32_32x32x16_bf16 v[116:131], v[100:103], v[108:111], v[116:131]
    v_mfma_f32_32x32x16_bf16 v[132:147], v[100:103], v[112:115], v[132:147]
    v_mfma_f32_32x32x16_bf16 v[148:163], v[104:107], v[108:111], v[148:163]
    v_mfma_f32_32x32x16_bf16 v[164:179], v[104:107], v[112:115], v[164:179]
    s_waitcnt vmcnt(12)
    v_mov_b32 v82, s42
    v_mov_b32 v83, s43
    s_mov_b64 s[6:7], exec
    s_mov_b64 exec, 1
    buffer_store_dwordx2 v[82:83], v6, s[8:11], s18 offen sc0 sc1
    s_mov_b64 exec, s[6:7]
    s_nop 2
    v_pk_fma_f32 v[10:11], v[132:133], v[230:231], v[118:119] op_sel:[0,1,0] op_sel_hi:[1,1,1] neg_lo:[0,1,0] neg_hi:[0,1,0]
    v_pk_fma_f32 v[12:13], v[116:117], v[230:231], v[134:135] op_sel:[0,1,0] op_sel_hi:[1,1,1]
    v_pk_fma_f32 v[4:5], v[116:117], v[230:231], v[10:11] op_sel:[0,0,0] op_sel_hi:[1,0,1]
    v_pk_fma_f32 v[8:9], v[132:133], v[230:231], v[12:13] op_sel:[0,0,0] op_sel_hi:[1,0,1]
    v_pk_fma_f32 v[10:11], v[8:9], v[230:231], v[120:121] op_sel:[0,1,0] op_sel_hi:[1,1,1] neg_lo:[0,1,0] neg_hi:[0,1,0]
    v_pk_fma_f32 v[12:13], v[4:5], v[230:231], v[136:137] op_sel:[0,1,0] op_sel_hi:[1,1,1]
    v_pk_fma_f32 v[4:5], v[4:5], v[230:231], v[10:11] op_sel:[0,0,0] op_sel_hi:[1,0,1]
    v_pk_fma_f32 v[8:9], v[8:9], v[230:231], v[12:13] op_sel:[0,0,0] op_sel_hi:[1,0,1]
    v_pk_fma_f32 v[10:11], v[8:9], v[230:231], v[122:123] op_sel:[0,1,0] op_sel_hi:[1,1,1] neg_lo:[0,1,0] neg_hi:[0,1,0]
    v_pk_fma_f32 v[12:13], v[4:5], v[230:231], v[138:139] op_sel:[0,1,0] op_sel_hi:[1,1,1]
    v_pk_fma_f32 v[4:5], v[4:5], v[230:231], v[10:11] op_sel:[0,0,0] op_sel_hi:[1,0,1]
    v_pk_fma_f32 v[8:9], v[8:9], v[230:231], v[12:13] op_sel:[0,0,0] op_sel_hi:[1,0,1]
    v_pk_fma_f32 v[10:11], v[8:9], v[230:231], v[124:125] op_sel:[0,1,0] op_sel_hi:[1,1,1] neg_lo:[0,1,0] neg_hi:[0,1,0]
    v_pk_fma_f32 v[12:13], v[4:5], v[230:231], v[140:141] op_sel:[0,1,0] op_sel_hi:[1,1,1]
    v_pk_fma_f32 v[4:5], v[4:5], v[230:231], v[10:11] op_sel:[0,0,0] op_sel_hi:[1,0,1]
    v_pk_fma_f32 v[8:9], v[8:9], v[230:231], v[12:13] op_sel:[0,0,0] op_sel_hi:[1,0,1]
    v_pk_fma_f32 v[10:11], v[8:9], v[230:231], v[126:127] op_sel:[0,1,0] op_sel_hi:[1,1,1] neg_lo:[0,1,0] neg_hi:[0,1,0]
    v_pk_fma_f32 v[12:13], v[4:5], v[230:231], v[142:143] op_sel:[0,1,0] op_sel_hi:[1,1,1]
    v_pk_fma_f32 v[4:5], v[4:5], v[230:231], v[10:11] op_sel:[0,0,0] op_sel_hi:[1,0,1]
    v_pk_fma_f32 v[8:9], v[8:9], v[230:231], v[12:13] op_sel:[0,0,0] op_sel_hi:[1,0,1]
    v_pk_fma_f32 v[10:11], v[8:9], v[230:231], v[128:129] op_sel:[0,1,0] op_sel_hi:[1,1,1] neg_lo:[0,1,0] neg_hi:[0,1,0]
    v_pk_fma_f32 v[12:13], v[4:5], v[230:231], v[144:145] op_sel:[0,1,0] op_sel_hi:[1,1,1]
    v_pk_fma_f32 v[4:5], v[4:5], v[230:231], v[10:11] op_sel:[0,0,0] op_sel_hi:[1,0,1]
    v_pk_fma_f32 v[8:9], v[8:9], v[230:231], v[12:13] op_sel:[0,0,0] op_sel_hi:[1,0,1]
    v_pk_fma_f32 v[10:11], v[8:9], v[230:231], v[130:131] op_sel:[0,1,0] op_sel_hi:[1,1,1] neg_lo:[0,1,0] neg_hi:[0,1,0]
    v_pk_fma_f32 v[12:13], v[4:5], v[230:231], v[146:147] op_sel:[0,1,0] op_sel_hi:[1,1,1]
    v_pk_fma_f32 v[4:5], v[4:5], v[230:231], v[10:11] op_sel:[0,0,0] op_sel_hi:[1,0,1]
    v_pk_fma_f32 v[8:9], v[8:9], v[230:231], v[12:13] op_sel:[0,0,0] op_sel_hi:[1,0,1]
    v_pk_fma_f32 v[10:11], v[8:9], v[230:231], v[148:149] op_sel:[0,1,0] op_sel_hi:[1,1,1] neg_lo:[0,1,0] neg_hi:[0,1,0]
    v_pk_fma_f32 v[12:13], v[4:5], v[230:231], v[164:165] op_sel:[0,1,0] op_sel_hi:[1,1,1]
    v_pk_fma_f32 v[4:5], v[4:5], v[230:231], v[10:11] op_sel:[0,0,0] op_sel_hi:[1,0,1]
    v_pk_fma_f32 v[8:9], v[8:9], v[230:231], v[12:13] op_sel:[0,0,0] op_sel_hi:[1,0,1]
    v_pk_fma_f32 v[10:11], v[8:9], v[230:231], v[150:151] op_sel:[0,1,0] op_sel_hi:[1,1,1] neg_lo:[0,1,0] neg_hi:[0,1,0]
    v_pk_fma_f32 v[12:13], v[4:5], v[230:231], v[166:167] op_sel:[0,1,0] op_sel_hi:[1,1,1]
    v_pk_fma_f32 v[4:5], v[4:5], v[230:231], v[10:11] op_sel:[0,0,0] op_sel_hi:[1,0,1]
    v_pk_fma_f32 v[8:9], v[8:9], v[230:231], v[12:13] op_sel:[0,0,0] op_sel_hi:[1,0,1]
    v_pk_fma_f32 v[10:11], v[8:9], v[230:231], v[152:153] op_sel:[0,1,0] op_sel_hi:[1,1,1] neg_lo:[0,1,0] neg_hi:[0,1,0]
    v_pk_fma_f32 v[12:13], v[4:5], v[230:231], v[168:169] op_sel:[0,1,0] op_sel_hi:[1,1,1]
    v_pk_fma_f32 v[4:5], v[4:5], v[230:231], v[10:11] op_sel:[0,0,0] op_sel_hi:[1,0,1]
    v_pk_fma_f32 v[8:9], v[8:9], v[230:231], v[12:13] op_sel:[0,0,0] op_sel_hi:[1,0,1]
    v_pk_fma_f32 v[10:11], v[8:9], v[230:231], v[154:155] op_sel:[0,1,0] op_sel_hi:[1,1,1] neg_lo:[0,1,0] neg_hi:[0,1,0]
    v_pk_fma_f32 v[12:13], v[4:5], v[230:231], v[170:171] op_sel:[0,1,0] op_sel_hi:[1,1,1]
    v_pk_fma_f32 v[4:5], v[4:5], v[230:231], v[10:11] op_sel:[0,0,0] op_sel_hi:[1,0,1]
    v_pk_fma_f32 v[8:9], v[8:9], v[230:231], v[12:13] op_sel:[0,0,0] op_sel_hi:[1,0,1]
    v_pk_fma_f32 v[10:11], v[8:9], v[230:231], v[156:157] op_sel:[0,1,0] op_sel_hi:[1,1,1] neg_lo:[0,1,0] neg_hi:[0,1,0]
    v_pk_fma_f32 v[12:13], v[4:5], v[230:231], v[172:173] op_sel:[0,1,0] op_sel_hi:[1,1,1]
    v_pk_fma_f32 v[4:5], v[4:5], v[230:231], v[10:11] op_sel:[0,0,0] op_sel_hi:[1,0,1]
    v_pk_fma_f32 v[8:9], v[8:9], v[230:231], v[12:13] op_sel:[0,0,0] op_sel_hi:[1,0,1]
    v_pk_fma_f32 v[10:11], v[8:9], v[230:231], v[158:159] op_sel:[0,1,0] op_sel_hi:[1,1,1] neg_lo:[0,1,0] neg_hi:[0,1,0]
    v_pk_fma_f32 v[12:13], v[4:5], v[230:231], v[174:175] op_sel:[0,1,0] op_sel_hi:[1,1,1]
    v_pk_fma_f32 v[4:5], v[4:5], v[230:231], v[10:11] op_sel:[0,0,0] op_sel_hi:[1,0,1]
    v_pk_fma_f32 v[8:9], v[8:9], v[230:231], v[12:13] op_sel:[0,0,0] op_sel_hi:[1,0,1]
    v_pk_fma_f32 v[10:11], v[8:9], v[230:231], v[160:161] op_sel:[0,1,0] op_sel_hi:[1,1,1] neg_lo:[0,1,0] neg_hi:[0,1,0]
    v_pk_fma_f32 v[12:13], v[4:5], v[230:231], v[176:177] op_sel:[0,1,0] op_sel_hi:[1,1,1]
    v_pk_fma_f32 v[4:5], v[4:5], v[230:231], v[10:11] op_sel:[0,0,0] op_sel_hi:[1,0,1]
    v_pk_fma_f32 v[8:9], v[8:9], v[230:231], v[12:13] op_sel:[0,0,0] op_sel_hi:[1,0,1]
    v_pk_fma_f32 v[10:11], v[8:9], v[230:231], v[162:163] op_sel:[0,1,0] op_sel_hi:[1,1,1] neg_lo:[0,1,0] neg_hi:[0,1,0]
    v_pk_fma_f32 v[12:13], v[4:5], v[230:231], v[178:179] op_sel:[0,1,0] op_sel_hi:[1,1,1]
    v_pk_fma_f32 v[4:5], v[4:5], v[230:231], v[10:11] op_sel:[0,0,0] op_sel_hi:[1,0,1]
    v_pk_fma_f32 v[8:9], v[8:9], v[230:231], v[12:13] op_sel:[0,0,0] op_sel_hi:[1,0,1]
    v_lshrrev_b32 v3, 5, v2
    v_lshlrev_b32 v3, 10, v3
    v_lshl_add_u32 v1, v7, 2, v3
    s_lshr_b32 s3, s44, 1
    s_lshl_b32 s3, s3, 11
    s_add_u32 s3, s3, 150528
    v_add_u32 v1, s3, v1
    ds_write2st64_b32 v1, v4, v8 offset0:12 offset1:13
    ds_write2st64_b32 v1, v5, v9 offset0:14 offset1:15
    s_waitcnt lgkmcnt(0)
    s_barrier
    ds_read2st64_b32 v[66:67], v1 offset0:0 offset1:1
    ds_read2st64_b32 v[68:69], v1 offset0:2 offset1:3
    ds_read2st64_b32 v[70:71], v1 offset0:4 offset1:5
    ds_read2st64_b32 v[72:73], v1 offset0:6 offset1:7
    ds_read2st64_b32 v[74:75], v1 offset0:8 offset1:9
    ds_read2st64_b32 v[76:77], v1 offset0:10 offset1:11
    s_waitcnt lgkmcnt(4)
    v_fma_f32 v20, -v235, v67, v68
    v_fma_f32 v21, v235, v66, v69
    v_fma_f32 v68, v234, v66, v20
    v_fma_f32 v69, v234, v67, v21
    s_waitcnt lgkmcnt(3)
    v_fma_f32 v20, -v235, v69, v70
    v_fma_f32 v21, v235, v68, v71
    v_fma_f32 v70, v234, v68, v20
    v_fma_f32 v71, v234, v69, v21
    s_waitcnt lgkmcnt(2)
    v_fma_f32 v20, -v235, v71, v72
    v_fma_f32 v21, v235, v70, v73
    v_fma_f32 v72, v234, v70, v20
    v_fma_f32 v73, v234, v71, v21
    s_waitcnt lgkmcnt(1)
    v_fma_f32 v20, -v235, v73, v74
    v_fma_f32 v21, v235, v72, v75
    v_fma_f32 v74, v234, v72, v20
    v_fma_f32 v75, v234, v73, v21
    s_waitcnt lgkmcnt(0)
    v_fma_f32 v20, -v235, v75, v76
    v_fma_f32 v21, v235, v74, v77
    v_fma_f32 v76, v234, v74, v20
    v_fma_f32 v77, v234, v75, v21
    v_fma_f32 v20, -v235, v77, v4
    v_fma_f32 v21, v235, v76, v8
    v_fma_f32 v14, v234, v76, v20
    v_fma_f32 v15, v234, v77, v21
    v_fma_f32 v20, -v235, v15, v5
    v_fma_f32 v21, v235, v14, v9
    v_fma_f32 v80, v234, v14, v20
    v_fma_f32 v81, v234, v15, v21
    v_mov_b32 v84, v76
    v_mov_b32 v85, v14
    v_mov_b32 v86, v77
    v_mov_b32 v87, v15
    s_lshl_b32 s3, s46, 14
    s_add_u32 s3, s3, 21037056
    s_add_u32 s48, s40, s3
    s_addc_u32 s49, s41, 0
    s_mov_b32 s50, 16384
    s_mov_b32 s51, 131072
    v_lshlrev_b32 v1, 4, v7
    s_lshl_b32 s4, s45, 10
    s_lshr_b32 s3, s44, 1
    s_cmp_eq_u32 s3, 0
    s_cbranch_scc1 Lnopub_gate_4
    v_mov_b32 v66, v80
    v_mov_b32 v67, v81
    v_mov_b32 v68, s42
    v_mov_b32 v69, s43
    s_mov_b64 s[6:7], exec
    s_mov_b64 exec, s[34:35]
    buffer_store_dwordx4 v[66:69], v1, s[48:51], s4 offen sc0 sc1
    s_mov_b64 exec, s[6:7]
    s_nop 1
Lnopub_gate_4:
    s_lshl_b32 s3, s46, 2
    s_add_u32 s3, s3, s44
    s_lshl_b32 s3, s3, 7
    s_add_u32 s3, s3, 21504000
    v_and_b32 v3, 15, v2
    v_lshlrev_b32 v3, 3, v3
    v_add_u32 v3, s3, v3
    v_lshrrev_b32 v9, 5, v2
    v_lshlrev_b32 v9, 10, v9
    v_sub_u32 v9, v1, v9
    s_sub_u32 s3, s4, 1024
    v_add_u32 v8, s3, v9
    v_mul_f32 v14, v237, v237
    v_fma_f32 v14, v236, v236, -v14
    v_mul_f32 v15, v236, v237
    v_add_f32 v15, v15, v15
    v_lshrrev_b32 v9, 5, v2
    v_sub_u32 v9, s45, v9
    v_add_u32 v9, 1, v9
    v_lshrrev_b32 v16, 1, v9
    s_lshl_b32 s3, s46, 2
    s_add_u32 s3, s3, s44
    s_lshl_b32 s6, s3, 16
    s_add_u32 s6, s6, 16777216
    s_lshl_b32 s7, s46, 12
    s_and_b32 s3, s46, 7
    s_lshl_b32 s3, s3, 2
    s_lshl_b32 s13, -1, s3
    s_and_b32 s13, s13, 0x01111111
    s_add_u32 s13, s13, 0x06543210
    s_bitcmp1_b32 s46, 3
    s_cselect_b32 s17, 0x08888888, 0
    s_add_u32 s13, s13, s17
    s_bitcmp1_b32 s46, 3
    s_cselect_b32 s17, 0, 0x88888888
    s_add_u32 s16, s17, 0x76543210
    s_lshl_b32 s17, s16, 28
    s_or_b32 s14, s13, s17
    s_lshr_b32 s15, s16, 4
    buffer_load_dwordx2 v[82:83], v182, s[8:11], 0 offen sc0 sc1
    v_pk_mul_f32 v[10:11], v[132:133], v[232:233] op_sel:[0,1] op_sel_hi:[1,1] neg_lo:[0,1] neg_hi:[0,1]
    v_pk_mul_f32 v[12:13], v[116:117], v[232:233] op_sel:[0,1] op_sel_hi:[1,1]
    v_pk_fma_f32 v[116:117], v[116:117], v[232:233], v[10:11] op_sel:[0,0,0] op_sel_hi:[1,0,1]
    v_pk_fma_f32 v[132:133], v[132:133], v[232:233], v[12:13] op_sel:[0,0,0] op_sel_hi:[1,0,1]
    v_pk_mul_f32 v[10:11], v[134:135], v[232:233] op_sel:[0,1] op_sel_hi:[1,1] neg_lo:[0,1] neg_hi:[0,1]
    v_pk_mul_f32 v[12:13], v[118:119], v[232:233] op_sel:[0,1] op_sel_hi:[1,1]
    v_pk_fma_f32 v[118:119], v[118:119], v[232:233], v[10:11] op_sel:[0,0,0] op_sel_hi:[1,0,1]
    v_pk_fma_f32 v[134:135], v[134:135], v[232:233], v[12:13] op_sel:[0,0,0] op_sel_hi:[1,0,1]
    v_pk_mul_f32 v[10:11], v[136:137], v[232:233] op_sel:[0,1] op_sel_hi:[1,1] neg_lo:[0,1] neg_hi:[0,1]
    v_pk_mul_f32 v[12:13], v[120:121], v[232:233] op_sel:[0,1] op_sel_hi:[1,1]
    v_pk_fma_f32 v[120:121], v[120:121], v[232:233], v[10:11] op_sel:[0,0,0] op_sel_hi:[1,0,1]
    v_pk_fma_f32 v[136:137], v[136:137], v[232:233], v[12:13] op_sel:[0,0,0] op_sel_hi:[1,0,1]
    v_pk_mul_f32 v[10:11], v[138:139], v[232:233] op_sel:[0,1] op_sel_hi:[1,1] neg_lo:[0,1] neg_hi:[0,1]
    v_pk_mul_f32 v[12:13], v[122:123], v[232:233] op_sel:[0,1] op_sel_hi:[1,1]
    v_pk_fma_f32 v[122:123], v[122:123], v[232:233], v[10:11] op_sel:[0,0,0] op_sel_hi:[1,0,1]
    v_pk_fma_f32 v[138:139], v[138:139], v[232:233], v[12:13] op_sel:[0,0,0] op_sel_hi:[1,0,1]
    v_pk_mul_f32 v[10:11], v[140:141], v[232:233] op_sel:[0,1] op_sel_hi:[1,1] neg_lo:[0,1] neg_hi:[0,1]
    v_pk_mul_f32 v[12:13], v[124:125], v[232:233] op_sel:[0,1] op_sel_hi:[1,1]
    v_pk_fma_f32 v[124:125], v[124:125], v[232:233], v[10:11] op_sel:[0,0,0] op_sel_hi:[1,0,1]
    v_pk_fma_f32 v[140:141], v[140:141], v[232:233], v[12:13] op_sel:[0,0,0] op_sel_hi:[1,0,1]
    v_pk_mul_f32 v[10:11], v[142:143], v[232:233] op_sel:[0,1] op_sel_hi:[1,1] neg_lo:[0,1] neg_hi:[0,1]
    v_pk_mul_f32 v[12:13], v[126:127], v[232:233] op_sel:[0,1] op_sel_hi:[1,1]
    v_pk_fma_f32 v[126:127], v[126:127], v[232:233], v[10:11] op_sel:[0,0,0] op_sel_hi:[1,0,1]
    v_pk_fma_f32 v[142:143], v[142:143], v[232:233], v[12:13] op_sel:[0,0,0] op_sel_hi:[1,0,1]
    v_pk_mul_f32 v[10:11], v[144:145], v[232:233] op_sel:[0,1] op_sel_hi:[1,1] neg_lo:[0,1] neg_hi:[0,1]
    v_pk_mul_f32 v[12:13], v[128:129], v[232:233] op_sel:[0,1] op_sel_hi:[1,1]
    v_pk_fma_f32 v[128:129], v[128:129], v[232:233], v[10:11] op_sel:[0,0,0] op_sel_hi:[1,0,1]
    v_pk_fma_f32 v[144:145], v[144:145], v[232:233], v[12:13] op_sel:[0,0,0] op_sel_hi:[1,0,1]
    v_pk_mul_f32 v[10:11], v[146:147], v[232:233] op_sel:[0,1] op_sel_hi:[1,1] neg_lo:[0,1] neg_hi:[0,1]
    v_pk_mul_f32 v[12:13], v[130:131], v[232:233] op_sel:[0,1] op_sel_hi:[1,1]
    v_pk_fma_f32 v[130:131], v[130:131], v[232:233], v[10:11] op_sel:[0,0,0] op_sel_hi:[1,0,1]
    v_pk_fma_f32 v[146:147], v[146:147], v[232:233], v[12:13] op_sel:[0,0,0] op_sel_hi:[1,0,1]
    v_pk_mul_f32 v[10:11], v[164:165], v[232:233] op_sel:[0,1] op_sel_hi:[1,1] neg_lo:[0,1] neg_hi:[0,1]
    v_pk_mul_f32 v[12:13], v[148:149], v[232:233] op_sel:[0,1] op_sel_hi:[1,1]
    v_pk_fma_f32 v[148:149], v[148:149], v[232:233], v[10:11] op_sel:[0,0,0] op_sel_hi:[1,0,1]
    v_pk_fma_f32 v[164:165], v[164:165], v[232:233], v[12:13] op_sel:[0,0,0] op_sel_hi:[1,0,1]
    v_pk_mul_f32 v[10:11], v[166:167], v[232:233] op_sel:[0,1] op_sel_hi:[1,1] neg_lo:[0,1] neg_hi:[0,1]
    v_pk_mul_f32 v[12:13], v[150:151], v[232:233] op_sel:[0,1] op_sel_hi:[1,1]
    v_pk_fma_f32 v[150:151], v[150:151], v[232:233], v[10:11] op_sel:[0,0,0] op_sel_hi:[1,0,1]
    v_pk_fma_f32 v[166:167], v[166:167], v[232:233], v[12:13] op_sel:[0,0,0] op_sel_hi:[1,0,1]
    v_pk_mul_f32 v[10:11], v[168:169], v[232:233] op_sel:[0,1] op_sel_hi:[1,1] neg_lo:[0,1] neg_hi:[0,1]
    v_pk_mul_f32 v[12:13], v[152:153], v[232:233] op_sel:[0,1] op_sel_hi:[1,1]
    v_pk_fma_f32 v[152:153], v[152:153], v[232:233], v[10:11] op_sel:[0,0,0] op_sel_hi:[1,0,1]
    v_pk_fma_f32 v[168:169], v[168:169], v[232:233], v[12:13] op_sel:[0,0,0] op_sel_hi:[1,0,1]
    v_pk_mul_f32 v[10:11], v[170:171], v[232:233] op_sel:[0,1] op_sel_hi:[1,1] neg_lo:[0,1] neg_hi:[0,1]
    v_pk_mul_f32 v[12:13], v[154:155], v[232:233] op_sel:[0,1] op_sel_hi:[1,1]
    v_pk_fma_f32 v[154:155], v[154:155], v[232:233], v[10:11] op_sel:[0,0,0] op_sel_hi:[1,0,1]
    v_pk_fma_f32 v[170:171], v[170:171], v[232:233], v[12:13] op_sel:[0,0,0] op_sel_hi:[1,0,1]
    v_pk_mul_f32 v[10:11], v[172:173], v[232:233] op_sel:[0,1] op_sel_hi:[1,1] neg_lo:[0,1] neg_hi:[0,1]
    v_pk_mul_f32 v[12:13], v[156:157], v[232:233] op_sel:[0,1] op_sel_hi:[1,1]
    v_pk_fma_f32 v[156:157], v[156:157], v[232:233], v[10:11] op_sel:[0,0,0] op_sel_hi:[1,0,1]
    v_pk_fma_f32 v[172:173], v[172:173], v[232:233], v[12:13] op_sel:[0,0,0] op_sel_hi:[1,0,1]
    v_pk_mul_f32 v[10:11], v[174:175], v[232:233] op_sel:[0,1] op_sel_hi:[1,1] neg_lo:[0,1] neg_hi:[0,1]
    v_pk_mul_f32 v[12:13], v[158:159], v[232:233] op_sel:[0,1] op_sel_hi:[1,1]
    v_pk_fma_f32 v[158:159], v[158:159], v[232:233], v[10:11] op_sel:[0,0,0] op_sel_hi:[1,0,1]
    v_pk_fma_f32 v[174:175], v[174:175], v[232:233], v[12:13] op_sel:[0,0,0] op_sel_hi:[1,0,1]
    v_pk_mul_f32 v[10:11], v[176:177], v[232:233] op_sel:[0,1] op_sel_hi:[1,1] neg_lo:[0,1] neg_hi:[0,1]
    v_pk_mul_f32 v[12:13], v[160:161], v[232:233] op_sel:[0,1] op_sel_hi:[1,1]
    v_pk_fma_f32 v[160:161], v[160:161], v[232:233], v[10:11] op_sel:[0,0,0] op_sel_hi:[1,0,1]
    v_pk_fma_f32 v[176:177], v[176:177], v[232:233], v[12:13] op_sel:[0,0,0] op_sel_hi:[1,0,1]
    v_pk_mul_f32 v[10:11], v[178:179], v[232:233] op_sel:[0,1] op_sel_hi:[1,1] neg_lo:[0,1] neg_hi:[0,1]
    v_pk_mul_f32 v[12:13], v[162:163], v[232:233] op_sel:[0,1] op_sel_hi:[1,1]
    v_pk_fma_f32 v[162:163], v[162:163], v[232:233], v[10:11] op_sel:[0,0,0] op_sel_hi:[1,0,1]
    v_pk_fma_f32 v[178:179], v[178:179], v[232:233], v[12:13] op_sel:[0,0,0] op_sel_hi:[1,0,1]
    s_lshr_b32 s16, s44, 1
    v_lshrrev_b32 v104, 5, v2
    v_lshlrev_b32 v104, 13, v104
    v_lshl_add_u32 v9, v7, 2, v104
    s_lshl_b32 s3, s16, 14
    s_add_u32 s3, s3, 0
    v_add_u32 v9, s3, v9
    v_lshrrev_b32 v104, 4, v2
    v_lshlrev_b32 v104, 4, v104
    v_bfe_u32 v105, v2, 3, 1
    v_add_u32 v104, v104, v105
    v_and_b32 v21, 7, v2
    v_xor_b32 v105, v105, v21
    s_and_b32 s3, s44, 1
    s_lshl_b32 s3, s3, 3
    v_or_b32 v105, s3, v105
    v_lshlrev_b32 v105, 4, v105
    v_lshl_add_u32 v20, v104, 8, v105
    s_lshl_b32 s3, s16, 14
    s_add_u32 s3, s3, 0
    v_add_u32 v20, s3, v20
    v_lshlrev_b32 v21, 4, v21
    v_lshl_add_u32 v21, v104, 12, v21
    s_lshl_b32 s13, s45, 19
    s_lshl_b32 s3, s16, 18
    s_add_u32 s13, s13, s3
    s_lshl_b32 s3, s46, 8
    s_add_u32 s13, s13, s3
    s_and_b32 s3, s44, 1
    s_lshl_b32 s3, s3, 7
    s_add_u32 s13, s13, s3
    s_waitcnt vmcnt(13)
    ds_write_b128 v64, v[38:41] offset:0
    v_alignbit_b32 v50, v39, v38, 16
    v_alignbit_b32 v51, v40, v39, 16
    v_alignbit_b32 v52, v41, v40, 16
    s_waitcnt vmcnt(12)
    v_alignbit_b32 v53, v48, v41, 16
    v_pk_mov_b32 v[54:55], v[38:39], v[40:41] op_sel:[1,0]
    v_pk_mov_b32 v[56:57], v[40:41], v[48:49] op_sel:[1,0]
    ds_write_b128 v64, v[50:53] offset:4160
    v_pk_mov_b32 v[58:59], v[50:51], v[52:53] op_sel:[1,0]
    v_mov_b32 v60, v53
    v_alignbit_b32 v61, v49, v48, 16
    ds_write_b128 v64, v[54:57] offset:8320
    ds_write_b128 v64, v[58:61] offset:12480
    s_waitcnt vmcnt(11)
    ds_write_b128 v64, v[22:25] offset:32
    v_alignbit_b32 v50, v23, v22, 16
    v_alignbit_b32 v51, v24, v23, 16
    v_alignbit_b32 v52, v25, v24, 16
    s_waitcnt vmcnt(10)
    v_alignbit_b32 v53, v18, v25, 16
    v_pk_mov_b32 v[54:55], v[22:23], v[24:25] op_sel:[1,0]
    v_pk_mov_b32 v[56:57], v[24:25], v[18:19] op_sel:[1,0]
    ds_write_b128 v64, v[50:53] offset:4192
    v_pk_mov_b32 v[58:59], v[50:51], v[52:53] op_sel:[1,0]
    v_mov_b32 v60, v53
    v_alignbit_b32 v61, v19, v18, 16
    ds_write_b128 v64, v[54:57] offset:8352
    ds_write_b128 v64, v[58:61] offset:12512
    v_subrev_u32 v66, 0, v8
    v_min_u32 v66, 0x7fff0000, v66
    buffer_load_dwordx4 v[66:69], v66, s[48:51], 0 offen sc0 sc1
    v_subrev_u32 v70, 2048, v8
    v_min_u32 v70, 0x7fff0000, v70
    buffer_load_dwordx4 v[70:73], v70, s[48:51], 0 offen sc0 sc1
    v_subrev_u32 v74, 4096, v8
    v_min_u32 v74, 0x7fff0000, v74
    buffer_load_dwordx4 v[74:77], v74, s[48:51], 0 offen sc0 sc1
    v_subrev_u32 v78, 6144, v8
    v_min_u32 v78, 0x7fff0000, v78
    buffer_load_dwordx4 v[78:81], v78, s[48:51], 0 offen sc0 sc1
    v_subrev_u32 v88, 8192, v8
    v_min_u32 v88, 0x7fff0000, v88
    buffer_load_dwordx4 v[88:91], v88, s[48:51], 0 offen sc0 sc1
    v_subrev_u32 v92, 10240, v8
    v_min_u32 v92, 0x7fff0000, v92
    buffer_load_dwordx4 v[92:95], v92, s[48:51], 0 offen sc0 sc1
    v_subrev_u32 v96, 12288, v8
    v_min_u32 v96, 0x7fff0000, v96
    buffer_load_dwordx4 v[96:99], v96, s[48:51], 0 offen sc0 sc1
    v_subrev_u32 v100, 14336, v8
    v_min_u32 v100, 0x7fff0000, v100
    buffer_load_dwordx4 v[100:103], v100, s[48:51], 0 offen sc0 sc1
    s_waitcnt vmcnt(17)
    ds_write_b128 v64, v[26:29] offset:1056
    v_alignbit_b32 v50, v27, v26, 16
    v_alignbit_b32 v51, v28, v27, 16
    v_alignbit_b32 v52, v29, v28, 16
    s_waitcnt vmcnt(16)
    v_alignbit_b32 v53, v42, v29, 16
    v_pk_mov_b32 v[54:55], v[26:27], v[28:29] op_sel:[1,0]
    v_pk_mov_b32 v[56:57], v[28:29], v[42:43] op_sel:[1,0]
    ds_write_b128 v64, v[50:53] offset:5216
    v_pk_mov_b32 v[58:59], v[50:51], v[52:53] op_sel:[1,0]
    v_mov_b32 v60, v53
    v_alignbit_b32 v61, v43, v42, 16
    ds_write_b128 v64, v[54:57] offset:9376
    ds_write_b128 v64, v[58:61] offset:13536
    s_waitcnt vmcnt(15)
    ds_write_b128 v64, v[30:33] offset:2080
    v_alignbit_b32 v50, v31, v30, 16
    v_alignbit_b32 v51, v32, v31, 16
    v_alignbit_b32 v52, v33, v32, 16
    s_waitcnt vmcnt(14)
    v_alignbit_b32 v53, v44, v33, 16
    v_pk_mov_b32 v[54:55], v[30:31], v[32:33] op_sel:[1,0]
    v_pk_mov_b32 v[56:57], v[32:33], v[44:45] op_sel:[1,0]
    ds_write_b128 v64, v[50:53] offset:6240
    v_pk_mov_b32 v[58:59], v[50:51], v[52:53] op_sel:[1,0]
    v_mov_b32 v60, v53
    v_alignbit_b32 v61, v45, v44, 16
    ds_write_b128 v64, v[54:57] offset:10400
    ds_write_b128 v64, v[58:61] offset:14560
    s_waitcnt vmcnt(13)
    ds_write_b128 v64, v[34:37] offset:3104
    v_alignbit_b32 v50, v35, v34, 16
    v_alignbit_b32 v51, v36, v35, 16
    v_alignbit_b32 v52, v37, v36, 16
    s_waitcnt vmcnt(12)
    v_alignbit_b32 v53, v46, v37, 16
    v_pk_mov_b32 v[54:55], v[34:35], v[36:37] op_sel:[1,0]
    v_pk_mov_b32 v[56:57], v[36:37], v[46:47] op_sel:[1,0]
    ds_write_b128 v64, v[50:53] offset:7264
    v_pk_mov_b32 v[58:59], v[50:51], v[52:53] op_sel:[1,0]
    v_mov_b32 v60, v53
    v_alignbit_b32 v61, v47, v46, 16
    ds_write_b128 v64, v[54:57] offset:11424
    ds_write_b128 v64, v[58:61] offset:15584
    v_lshlrev_b32 v183, 16, v183
    s_mov_b32 s18, 0
    s_waitcnt vmcnt(8)
    v_cmp_ne_u64 vcc, s[42:43], v[82:83]
    s_nop 4
    s_cbranch_vccz Lfdone_gate_5
Lfpoll_gate_6:
    buffer_load_dwordx2 v[82:83], v182, s[8:11], 0 offen sc0 sc1
    s_waitcnt vmcnt(0)
    v_cmp_ne_u64 vcc, s[42:43], v[82:83]
    s_nop 4
    s_add_u32 s18, s18, 1
    s_cmp_gt_u32 s18, 20000
    s_cbranch_scc1 Lfdone_gate_5
    s_cbranch_vccnz Lfpoll_gate_6
Lfdone_gate_5:
    s_mov_b32 m0, s29
    s_nop 0
    buffer_load_dwordx4 v207, s[8:11], s28 offen offset:0 sc0 sc1 lds
    buffer_load_dwordx4 v207, s[8:11], s28 offen offset:1024 sc0 sc1 lds
    buffer_load_dwordx4 v207, s[8:11], s28 offen offset:2048 sc0 sc1 lds
    buffer_load_dwordx4 v207, s[8:11], s28 offen offset:3072 sc0 sc1 lds
    s_mov_b32 s16, 0
    v_mov_b32 v18, 0
    s_waitcnt vmcnt(11)
    v_cmp_eq_u64 s[60:61], s[42:43], v[68:69]
    s_waitcnt vmcnt(10)
    v_cmp_eq_u64 s[62:63], s[42:43], v[72:73]
    s_waitcnt vmcnt(9)
    v_cmp_eq_u64 s[64:65], s[42:43], v[76:77]
    s_waitcnt vmcnt(8)
    v_cmp_eq_u64 s[66:67], s[42:43], v[80:81]
    v_addc_co_u32 v18, vcc, 0, v18, s[60:61]
    v_addc_co_u32 v18, vcc, 0, v18, s[62:63]
    v_addc_co_u32 v18, vcc, 0, v18, s[64:65]
    v_addc_co_u32 v18, vcc, 0, v18, s[66:67]
    s_waitcnt vmcnt(7)
    v_cmp_eq_u64 s[60:61], s[42:43], v[90:91]
    s_waitcnt vmcnt(6)
    v_cmp_eq_u64 s[62:63], s[42:43], v[94:95]
    s_waitcnt vmcnt(5)
    v_cmp_eq_u64 s[64:65], s[42:43], v[98:99]
    s_waitcnt vmcnt(4)
    v_cmp_eq_u64 s[66:67], s[42:43], v[102:103]
    v_addc_co_u32 v18, vcc, 0, v18, s[60:61]
    v_addc_co_u32 v18, vcc, 0, v18, s[62:63]
    v_addc_co_u32 v18, vcc, 0, v18, s[64:65]
    v_addc_co_u32 v18, vcc, 0, v18, s[66:67]
    v_cmp_ne_u32 vcc, v16, v18
    s_nop 4
    s_cbranch_vccz Lpolldone_gate_7
Lpoll_gate_8:
    v_subrev_u32 v66, 0, v8
    v_min_u32 v66, 0x7fff0000, v66
    buffer_load_dwordx4 v[66:69], v66, s[48:51], 0 offen sc0 sc1
    v_subrev_u32 v70, 2048, v8
    v_min_u32 v70, 0x7fff0000, v70
    buffer_load_dwordx4 v[70:73], v70, s[48:51], 0 offen sc0 sc1
    v_subrev_u32 v74, 4096, v8
    v_min_u32 v74, 0x7fff0000, v74
    buffer_load_dwordx4 v[74:77], v74, s[48:51], 0 offen sc0 sc1
    v_subrev_u32 v78, 6144, v8
    v_min_u32 v78, 0x7fff0000, v78
    buffer_load_dwordx4 v[78:81], v78, s[48:51], 0 offen sc0 sc1
    v_subrev_u32 v88, 8192, v8
    v_min_u32 v88, 0x7fff0000, v88
    buffer_load_dwordx4 v[88:91], v88, s[48:51], 0 offen sc0 sc1
    v_subrev_u32 v92, 10240, v8
    v_min_u32 v92, 0x7fff0000, v92
    buffer_load_dwordx4 v[92:95], v92, s[48:51], 0 offen sc0 sc1
    v_subrev_u32 v96, 12288, v8
    v_min_u32 v96, 0x7fff0000, v96
    buffer_load_dwordx4 v[96:99], v96, s[48:51], 0 offen sc0 sc1
    v_subrev_u32 v100, 14336, v8
    v_min_u32 v100, 0x7fff0000, v100
    buffer_load_dwordx4 v[100:103], v100, s[48:51], 0 offen sc0 sc1
    s_waitcnt vmcnt(0) lgkmcnt(0)
    v_mov_b32 v18, 0
    v_cmp_eq_u64 s[60:61], s[42:43], v[68:69]
    v_cmp_eq_u64 s[62:63], s[42:43], v[72:73]
    v_cmp_eq_u64 s[64:65], s[42:43], v[76:77]
    v_cmp_eq_u64 s[66:67], s[42:43], v[80:81]
    v_addc_co_u32 v18, vcc, 0, v18, s[60:61]
    v_addc_co_u32 v18, vcc, 0, v18, s[62:63]
    v_addc_co_u32 v18, vcc, 0, v18, s[64:65]
    v_addc_co_u32 v18, vcc, 0, v18, s[66:67]
    v_cmp_eq_u64 s[60:61], s[42:43], v[90:91]
    v_cmp_eq_u64 s[62:63], s[42:43], v[94:95]
    v_cmp_eq_u64 s[64:65], s[42:43], v[98:99]
    v_cmp_eq_u64 s[66:67], s[42:43], v[102:103]
    v_addc_co_u32 v18, vcc, 0, v18, s[60:61]
    v_addc_co_u32 v18, vcc, 0, v18, s[62:63]
    v_addc_co_u32 v18, vcc, 0, v18, s[64:65]
    v_addc_co_u32 v18, vcc, 0, v18, s[66:67]
    v_cmp_ne_u32 vcc, v16, v18
    s_add_u32 s16, s16, 1
    s_cmp_gt_u32 s16, 20000
    s_cbranch_scc1 Lpolldone_gate_7
    s_nop 1
    s_cbranch_vccnz Lpoll_gate_8
Lpolldone_gate_7:
    s_nop 4
    v_fma_f32 v22, -v15, v101, v96
    v_fma_f32 v23, v15, v100, v97
    v_fma_f32 v96, v14, v100, v22
    v_fma_f32 v97, v14, v101, v23
    v_fma_f32 v22, -v15, v97, v92
    v_fma_f32 v23, v15, v96, v93
    v_fma_f32 v92, v14, v96, v22
    v_fma_f32 v93, v14, v97, v23
    v_fma_f32 v22, -v15, v93, v88
    v_fma_f32 v23, v15, v92, v89
    v_fma_f32 v88, v14, v92, v22
    v_fma_f32 v89, v14, v93, v23
    v_fma_f32 v22, -v15, v89, v78
    v_fma_f32 v23, v15, v88, v79
    v_fma_f32 v78, v14, v88, v22
    v_fma_f32 v79, v14, v89, v23
    v_fma_f32 v22, -v15, v79, v74
    v_fma_f32 v23, v15, v78, v75
    v_fma_f32 v74, v14, v78, v22
    v_fma_f32 v75, v14, v79, v23
    v_fma_f32 v22, -v15, v75, v70
    v_fma_f32 v23, v15, v74, v71
    v_fma_f32 v70, v14, v74, v22
    v_fma_f32 v71, v14, v75, v23
    v_fma_f32 v22, -v15, v71, v66
    v_fma_f32 v23, v15, v70, v67
    v_fma_f32 v66, v14, v70, v22
    v_fma_f32 v67, v14, v71, v23
    v_mov_b32 v70, v66
    v_mov_b32 v71, v67
    s_nop 0
    v_permlane32_swap_b32 v66, v70
    v_permlane32_swap_b32 v67, v71
    v_fma_f32 v22, -v237, v71, v66
    v_fma_f32 v23, v237, v70, v67
    v_fma_f32 v24, v236, v70, v22
    v_fma_f32 v25, v236, v71, v23
    buffer_load_dwordx2 v[4:5], v3, s[8:11], 0 offen sc0 sc1
    v_pk_fma_f32 v[10:11], v[240:241], v[24:25], v[84:85] op_sel:[0,1,0] op_sel_hi:[1,1,1] neg_lo:[0,1,0] neg_hi:[0,1,0]
    v_pk_fma_f32 v[12:13], v[238:239], v[24:25], v[86:87] op_sel:[0,1,0] op_sel_hi:[1,1,1]
    v_pk_fma_f32 v[14:15], v[238:239], v[24:25], v[10:11] op_sel:[0,0,0] op_sel_hi:[1,0,1]
    v_pk_fma_f32 v[18:19], v[240:241], v[24:25], v[12:13] op_sel:[0,0,0] op_sel_hi:[1,0,1]
    v_pk_mul_f32 v[10:11], v[18:19], v[232:233] op_sel:[0,1] op_sel_hi:[1,1] neg_lo:[0,1] neg_hi:[0,1]
    v_pk_mul_f32 v[12:13], v[14:15], v[232:233] op_sel:[0,1] op_sel_hi:[1,1]
    v_pk_fma_f32 v[14:15], v[14:15], v[232:233], v[10:11] op_sel:[0,0,0] op_sel_hi:[1,0,1]
    v_pk_fma_f32 v[18:19], v[18:19], v[232:233], v[12:13] op_sel:[0,0,0] op_sel_hi:[1,0,1]
    v_pk_fma_f32 v[10:11], v[18:19], v[230:231], v[116:117] op_sel:[0,1,0] op_sel_hi:[1,1,1] neg_lo:[0,1,0] neg_hi:[0,1,0]
    v_pk_fma_f32 v[12:13], v[14:15], v[230:231], v[132:133] op_sel:[0,1,0] op_sel_hi:[1,1,1]
    v_pk_fma_f32 v[116:117], v[14:15], v[230:231], v[10:11] op_sel:[0,0,0] op_sel_hi:[1,0,1]
    v_pk_fma_f32 v[132:133], v[18:19], v[230:231], v[12:13] op_sel:[0,0,0] op_sel_hi:[1,0,1]
    v_pk_fma_f32 v[10:11], v[132:133], v[230:231], v[118:119] op_sel:[0,1,0] op_sel_hi:[1,1,1] neg_lo:[0,1,0] neg_hi:[0,1,0]
    v_pk_fma_f32 v[12:13], v[116:117], v[230:231], v[134:135] op_sel:[0,1,0] op_sel_hi:[1,1,1]
    v_pk_fma_f32 v[118:119], v[116:117], v[230:231], v[10:11] op_sel:[0,0,0] op_sel_hi:[1,0,1]
    v_pk_fma_f32 v[134:135], v[132:133], v[230:231], v[12:13] op_sel:[0,0,0] op_sel_hi:[1,0,1]
    v_cvt_pk_bf16_f32 v22, v116, -v132
    v_cvt_pk_bf16_f32 v23, v117, -v133
    ds_write2st64_b32 v9, v22, v23 offset0:0 offset1:16
    v_pk_fma_f32 v[10:11], v[134:135], v[230:231], v[120:121] op_sel:[0,1,0] op_sel_hi:[1,1,1] neg_lo:[0,1,0] neg_hi:[0,1,0]
    v_pk_fma_f32 v[12:13], v[118:119], v[230:231], v[136:137] op_sel:[0,1,0] op_sel_hi:[1,1,1]
    v_pk_fma_f32 v[120:121], v[118:119], v[230:231], v[10:11] op_sel:[0,0,0] op_sel_hi:[1,0,1]
    v_pk_fma_f32 v[136:137], v[134:135], v[230:231], v[12:13] op_sel:[0,0,0] op_sel_hi:[1,0,1]
    v_xor_b32 v8, 16, v9
    v_cvt_pk_bf16_f32 v26, v118, -v134
    v_cvt_pk_bf16_f32 v27, v119, -v135
    ds_write2st64_b32 v8, v26, v27 offset0:1 offset1:17
    ds_read_b128 v[28:31], v20 offset:0
    v_pk_fma_f32 v[10:11], v[136:137], v[230:231], v[122:123] op_sel:[0,1,0] op_sel_hi:[1,1,1] neg_lo:[0,1,0] neg_hi:[0,1,0]
    v_pk_fma_f32 v[12:13], v[120:121], v[230:231], v[138:139] op_sel:[0,1,0] op_sel_hi:[1,1,1]
    v_pk_fma_f32 v[122:123], v[120:121], v[230:231], v[10:11] op_sel:[0,0,0] op_sel_hi:[1,0,1]
    v_pk_fma_f32 v[138:139], v[136:137], v[230:231], v[12:13] op_sel:[0,0,0] op_sel_hi:[1,0,1]
    v_xor_b32 v1, 32, v9
    v_cvt_pk_bf16_f32 v22, v120, -v136
    v_cvt_pk_bf16_f32 v23, v121, -v137
    ds_write2st64_b32 v1, v22, v23 offset0:2 offset1:18
    s_waitcnt lgkmcnt(1)
    buffer_store_dwordx4 v[28:31], v21, s[8:11], s13 offen sc0 sc1
    v_pk_fma_f32 v[10:11], v[138:139], v[230:231], v[124:125] op_sel:[0,1,0] op_sel_hi:[1,1,1] neg_lo:[0,1,0] neg_hi:[0,1,0]
    v_pk_fma_f32 v[12:13], v[122:123], v[230:231], v[140:141] op_sel:[0,1,0] op_sel_hi:[1,1,1]
    v_pk_fma_f32 v[124:125], v[122:123], v[230:231], v[10:11] op_sel:[0,0,0] op_sel_hi:[1,0,1]
    v_pk_fma_f32 v[140:141], v[138:139], v[230:231], v[12:13] op_sel:[0,0,0] op_sel_hi:[1,0,1]
    v_xor_b32 v8, 48, v9
    v_cvt_pk_bf16_f32 v26, v122, -v138
    v_cvt_pk_bf16_f32 v27, v123, -v139
    ds_write2st64_b32 v8, v26, v27 offset0:3 offset1:19
    v_xor_b32 v16, 32, v20
    ds_read_b128 v[32:35], v16 offset:512
    v_pk_fma_f32 v[10:11], v[140:141], v[230:231], v[126:127] op_sel:[0,1,0] op_sel_hi:[1,1,1] neg_lo:[0,1,0] neg_hi:[0,1,0]
    v_pk_fma_f32 v[12:13], v[124:125], v[230:231], v[142:143] op_sel:[0,1,0] op_sel_hi:[1,1,1]
    v_pk_fma_f32 v[126:127], v[124:125], v[230:231], v[10:11] op_sel:[0,0,0] op_sel_hi:[1,0,1]
    v_pk_fma_f32 v[142:143], v[140:141], v[230:231], v[12:13] op_sel:[0,0,0] op_sel_hi:[1,0,1]
    v_xor_b32 v1, 64, v9
    v_cvt_pk_bf16_f32 v22, v124, -v140
    v_cvt_pk_bf16_f32 v23, v125, -v141
    ds_write2st64_b32 v1, v22, v23 offset0:4 offset1:20
    s_add_u32 s13, s13, 8192
    s_waitcnt lgkmcnt(1)
    buffer_store_dwordx4 v[32:35], v21, s[8:11], s13 offen sc0 sc1
    v_pk_fma_f32 v[10:11], v[142:143], v[230:231], v[128:129] op_sel:[0,1,0] op_sel_hi:[1,1,1] neg_lo:[0,1,0] neg_hi:[0,1,0]
    v_pk_fma_f32 v[12:13], v[126:127], v[230:231], v[144:145] op_sel:[0,1,0] op_sel_hi:[1,1,1]
    v_pk_fma_f32 v[128:129], v[126:127], v[230:231], v[10:11] op_sel:[0,0,0] op_sel_hi:[1,0,1]
    v_pk_fma_f32 v[144:145], v[142:143], v[230:231], v[12:13] op_sel:[0,0,0] op_sel_hi:[1,0,1]
    v_xor_b32 v8, 80, v9
    v_cvt_pk_bf16_f32 v26, v126, -v142
    v_cvt_pk_bf16_f32 v27, v127, -v143
    ds_write2st64_b32 v8, v26, v27 offset0:5 offset1:21
    v_xor_b32 v16, 64, v20
    ds_read_b128 v[28:31], v16 offset:1024
    v_pk_fma_f32 v[10:11], v[144:145], v[230:231], v[130:131] op_sel:[0,1,0] op_sel_hi:[1,1,1] neg_lo:[0,1,0] neg_hi:[0,1,0]
    v_pk_fma_f32 v[12:13], v[128:129], v[230:231], v[146:147] op_sel:[0,1,0] op_sel_hi:[1,1,1]
    v_pk_fma_f32 v[130:131], v[128:129], v[230:231], v[10:11] op_sel:[0,0,0] op_sel_hi:[1,0,1]
    v_pk_fma_f32 v[146:147], v[144:145], v[230:231], v[12:13] op_sel:[0,0,0] op_sel_hi:[1,0,1]
    v_xor_b32 v1, 96, v9
    v_cvt_pk_bf16_f32 v22, v128, -v144
    v_cvt_pk_bf16_f32 v23, v129, -v145
    ds_write2st64_b32 v1, v22, v23 offset0:6 offset1:22
    s_add_u32 s13, s13, 8192
    s_waitcnt lgkmcnt(1)
    buffer_store_dwordx4 v[28:31], v21, s[8:11], s13 offen sc0 sc1
    v_pk_fma_f32 v[10:11], v[146:147], v[230:231], v[148:149] op_sel:[0,1,0] op_sel_hi:[1,1,1] neg_lo:[0,1,0] neg_hi:[0,1,0]
    v_pk_fma_f32 v[12:13], v[130:131], v[230:231], v[164:165] op_sel:[0,1,0] op_sel_hi:[1,1,1]
    v_pk_fma_f32 v[148:149], v[130:131], v[230:231], v[10:11] op_sel:[0,0,0] op_sel_hi:[1,0,1]
    v_pk_fma_f32 v[164:165], v[146:147], v[230:231], v[12:13] op_sel:[0,0,0] op_sel_hi:[1,0,1]
    v_xor_b32 v8, 112, v9
    v_cvt_pk_bf16_f32 v26, v130, -v146
    v_cvt_pk_bf16_f32 v27, v131, -v147
    ds_write2st64_b32 v8, v26, v27 offset0:7 offset1:23
    v_xor_b32 v16, 96, v20
    ds_read_b128 v[32:35], v16 offset:1536
    v_pk_fma_f32 v[10:11], v[164:165], v[230:231], v[150:151] op_sel:[0,1,0] op_sel_hi:[1,1,1] neg_lo:[0,1,0] neg_hi:[0,1,0]
    v_pk_fma_f32 v[12:13], v[148:149], v[230:231], v[166:167] op_sel:[0,1,0] op_sel_hi:[1,1,1]
    v_pk_fma_f32 v[150:151], v[148:149], v[230:231], v[10:11] op_sel:[0,0,0] op_sel_hi:[1,0,1]
    v_pk_fma_f32 v[166:167], v[164:165], v[230:231], v[12:13] op_sel:[0,0,0] op_sel_hi:[1,0,1]
    v_xor_b32 v1, 128, v9
    v_cvt_pk_bf16_f32 v22, v148, -v164
    v_cvt_pk_bf16_f32 v23, v149, -v165
    ds_write2st64_b32 v1, v22, v23 offset0:8 offset1:24
    s_add_u32 s13, s13, 8192
    s_waitcnt lgkmcnt(1)
    buffer_store_dwordx4 v[32:35], v21, s[8:11], s13 offen sc0 sc1
    v_pk_fma_f32 v[10:11], v[166:167], v[230:231], v[152:153] op_sel:[0,1,0] op_sel_hi:[1,1,1] neg_lo:[0,1,0] neg_hi:[0,1,0]
    v_pk_fma_f32 v[12:13], v[150:151], v[230:231], v[168:169] op_sel:[0,1,0] op_sel_hi:[1,1,1]
    v_pk_fma_f32 v[152:153], v[150:151], v[230:231], v[10:11] op_sel:[0,0,0] op_sel_hi:[1,0,1]
    v_pk_fma_f32 v[168:169], v[166:167], v[230:231], v[12:13] op_sel:[0,0,0] op_sel_hi:[1,0,1]
    v_xor_b32 v8, 144, v9
    v_cvt_pk_bf16_f32 v26, v150, -v166
    v_cvt_pk_bf16_f32 v27, v151, -v167
    ds_write2st64_b32 v8, v26, v27 offset0:9 offset1:25
    v_xor_b32 v16, 128, v20
    ds_read_b128 v[28:31], v16 offset:2048
    v_pk_fma_f32 v[10:11], v[168:169], v[230:231], v[154:155] op_sel:[0,1,0] op_sel_hi:[1,1,1] neg_lo:[0,1,0] neg_hi:[0,1,0]
    v_pk_fma_f32 v[12:13], v[152:153], v[230:231], v[170:171] op_sel:[0,1,0] op_sel_hi:[1,1,1]
    v_pk_fma_f32 v[154:155], v[152:153], v[230:231], v[10:11] op_sel:[0,0,0] op_sel_hi:[1,0,1]
    v_pk_fma_f32 v[170:171], v[168:169], v[230:231], v[12:13] op_sel:[0,0,0] op_sel_hi:[1,0,1]
    v_xor_b32 v1, 160, v9
    v_cvt_pk_bf16_f32 v22, v152, -v168
    v_cvt_pk_bf16_f32 v23, v153, -v169
    ds_write2st64_b32 v1, v22, v23 offset0:10 offset1:26
    s_add_u32 s13, s13, 8192
    s_waitcnt lgkmcnt(1)
    buffer_store_dwordx4 v[28:31], v21, s[8:11], s13 offen sc0 sc1
    v_pk_fma_f32 v[10:11], v[170:171], v[230:231], v[156:157] op_sel:[0,1,0] op_sel_hi:[1,1,1] neg_lo:[0,1,0] neg_hi:[0,1,0]
    v_pk_fma_f32 v[12:13], v[154:155], v[230:231], v[172:173] op_sel:[0,1,0] op_sel_hi:[1,1,1]
    v_pk_fma_f32 v[156:157], v[154:155], v[230:231], v[10:11] op_sel:[0,0,0] op_sel_hi:[1,0,1]
    v_pk_fma_f32 v[172:173], v[170:171], v[230:231], v[12:13] op_sel:[0,0,0] op_sel_hi:[1,0,1]
    v_xor_b32 v8, 176, v9
    v_cvt_pk_bf16_f32 v26, v154, -v170
    v_cvt_pk_bf16_f32 v27, v155, -v171
    ds_write2st64_b32 v8, v26, v27 offset0:11 offset1:27
    v_xor_b32 v16, 160, v20
    ds_read_b128 v[32:35], v16 offset:2560
    v_pk_fma_f32 v[10:11], v[172:173], v[230:231], v[158:159] op_sel:[0,1,0] op_sel_hi:[1,1,1] neg_lo:[0,1,0] neg_hi:[0,1,0]
    v_pk_fma_f32 v[12:13], v[156:157], v[230:231], v[174:175] op_sel:[0,1,0] op_sel_hi:[1,1,1]
    v_pk_fma_f32 v[158:159], v[156:157], v[230:231], v[10:11] op_sel:[0,0,0] op_sel_hi:[1,0,1]
    v_pk_fma_f32 v[174:175], v[172:173], v[230:231], v[12:13] op_sel:[0,0,0] op_sel_hi:[1,0,1]
    v_xor_b32 v1, 192, v9
    v_cvt_pk_bf16_f32 v22, v156, -v172
    v_cvt_pk_bf16_f32 v23, v157, -v173
    ds_write2st64_b32 v1, v22, v23 offset0:12 offset1:28
    s_add_u32 s13, s13, 8192
    s_waitcnt lgkmcnt(1)
    buffer_store_dwordx4 v[32:35], v21, s[8:11], s13 offen sc0 sc1
    v_pk_fma_f32 v[10:11], v[174:175], v[230:231], v[160:161] op_sel:[0,1,0] op_sel_hi:[1,1,1] neg_lo:[0,1,0] neg_hi:[0,1,0]
    v_pk_fma_f32 v[12:13], v[158:159], v[230:231], v[176:177] op_sel:[0,1,0] op_sel_hi:[1,1,1]
    v_pk_fma_f32 v[160:161], v[158:159], v[230:231], v[10:11] op_sel:[0,0,0] op_sel_hi:[1,0,1]
    v_pk_fma_f32 v[176:177], v[174:175], v[230:231], v[12:13] op_sel:[0,0,0] op_sel_hi:[1,0,1]
    v_xor_b32 v8, 208, v9
    v_cvt_pk_bf16_f32 v26, v158, -v174
    v_cvt_pk_bf16_f32 v27, v159, -v175
    ds_write2st64_b32 v8, v26, v27 offset0:13 offset1:29
    v_xor_b32 v16, 192, v20
    ds_read_b128 v[28:31], v16 offset:3072
    v_pk_fma_f32 v[10:11], v[176:177], v[230:231], v[162:163] op_sel:[0,1,0] op_sel_hi:[1,1,1] neg_lo:[0,1,0] neg_hi:[0,1,0]
    v_pk_fma_f32 v[12:13], v[160:161], v[230:231], v[178:179] op_sel:[0,1,0] op_sel_hi:[1,1,1]
    v_pk_fma_f32 v[162:163], v[160:161], v[230:231], v[10:11] op_sel:[0,0,0] op_sel_hi:[1,0,1]
    v_pk_fma_f32 v[178:179], v[176:177], v[230:231], v[12:13] op_sel:[0,0,0] op_sel_hi:[1,0,1]
    v_xor_b32 v1, 224, v9
    v_cvt_pk_bf16_f32 v22, v160, -v176
    v_cvt_pk_bf16_f32 v23, v161, -v177
    ds_write2st64_b32 v1, v22, v23 offset0:14 offset1:30
    s_add_u32 s13, s13, 8192
    s_waitcnt lgkmcnt(1)
    buffer_store_dwordx4 v[28:31], v21, s[8:11], s13 offen sc0 sc1
    v_xor_b32 v8, 240, v9
    v_cvt_pk_bf16_f32 v26, v162, -v178
    v_cvt_pk_bf16_f32 v27, v163, -v179
    ds_write2st64_b32 v8, v26, v27 offset0:15 offset1:31
    v_xor_b32 v16, 224, v20
    ds_read_b128 v[32:35], v16 offset:3584
    s_add_u32 s13, s13, 8192
    s_waitcnt lgkmcnt(0)
    buffer_store_dwordx4 v[32:35], v21, s[8:11], s13 offen sc0 sc1
    s_mov_b32 s4, 0
    s_waitcnt vmcnt(8)
    v_cmp_ne_u64 vcc, s[42:43], v[4:5]
    s_nop 4
    s_cbranch_vccz Lfdone_gate_9
Lfpoll_gate_10:
    buffer_load_dwordx2 v[4:5], v3, s[8:11], 0 offen sc0 sc1
    s_waitcnt vmcnt(0)
    v_cmp_ne_u64 vcc, s[42:43], v[4:5]
    s_nop 4
    s_add_u32 s4, s4, 1
    s_cmp_gt_u32 s4, 20000
    s_cbranch_scc1 Lfdone_gate_9
    s_cbranch_vccnz Lfpoll_gate_10
Lfdone_gate_9:
    s_barrier
    ds_read_b64 v[84:85], v186 offset:448
    ds_read_b64 v[86:87], v186 offset:456
    ds_read_b128 v[88:91], v187 offset:16128
    ds_read_b64 v[92:93], v186 offset:960
    ds_read_b64 v[94:95], v186 offset:968
    ds_read_b128 v[96:99], v187 offset:14080
    ds_read_b64 v[100:101], v186 offset:1472
    ds_read_b64 v[102:103], v186 offset:1480
    ds_read_b128 v[104:107], v187 offset:12032
    s_waitcnt lgkmcnt(1)
    v_mfma_f32_16x16x32_bf16 v[46:49], v[84:87], v[88:91], 0
    s_lshl_b32 s4, s45, 4
    s_add_u32 s4, s4, s46
    v_mfma_f32_16x16x32_bf16 v[50:53], v[92:95], v[88:91], 0
    ds_read_b64 v[108:109], v186 offset:1984
    ds_read_b64 v[110:111], v186 offset:1992
    v_mfma_f32_16x16x32_bf16 v[50:53], v[84:87], v[96:99], v[50:53]
    ds_read_b128 v[112:115], v187 offset:9984
    s_add_u32 s12, s6, s7
    v_mfma_f32_16x16x32_bf16 v[54:57], v[92:95], v[96:99], 0
    buffer_load_dwordx4 a[0:3], v17, s[8:11], s12 offen offset:0 sc0 sc1
    v_mfma_f32_16x16x32_bf16 v[54:57], v[100:103], v[88:91], v[54:57]
    s_lshl_b32 s4, s4, 2
    s_waitcnt lgkmcnt(3)
    v_mfma_f32_16x16x32_bf16 v[54:57], v[84:87], v[104:107], v[54:57]
    s_add_u32 s4, s4, s44
    s_lshl_b32 s4, s4, 3
    v_mfma_f32_16x16x32_bf16 v[58:61], v[100:103], v[96:99], 0
    buffer_load_dwordx4 a[4:7], v17, s[8:11], s12 offen offset:1024 sc0 sc1
    v_mfma_f32_16x16x32_bf16 v[58:61], v[92:95], v[104:107], v[58:61]
    s_add_u32 s4, s4, 21512192
    s_lshl_b32 s3, s45, 9
    v_mfma_f32_16x16x32_bf16 v[66:69], v[100:103], v[104:107], 0
    ds_read_b64 v[116:117], v186 offset:2496
    s_waitcnt lgkmcnt(1)
    v_mfma_f32_16x16x32_bf16 v[58:61], v[108:111], v[88:91], v[58:61]
    ds_read_b64 v[118:119], v186 offset:2504
    ds_read_b128 v[120:123], v187 offset:7936
    v_mfma_f32_16x16x32_bf16 v[58:61], v[84:87], v[112:115], v[58:61]
    buffer_load_dwordx4 a[8:11], v17, s[8:11], s12 offen offset:2048 sc0 sc1
    v_mfma_f32_16x16x32_bf16 v[66:69], v[108:111], v[96:99], v[66:69]
    s_add_u32 s3, s3, 21512192
    v_lshrrev_b32 v182, 1, v17
    v_mfma_f32_16x16x32_bf16 v[66:69], v[92:95], v[112:115], v[66:69]
    v_add_u32 v182, s3, v182
    v_lshrrev_b32 v1, 4, v2
    v_mfma_f32_16x16x32_bf16 v[70:73], v[108:111], v[104:107], 0
    v_and_b32 v3, 15, v2
    v_xor_b32 v3, v3, v1
    v_mfma_f32_16x16x32_bf16 v[70:73], v[100:103], v[112:115], v[70:73]
    v_lshlrev_b32 v3, 4, v3
    v_lshl_add_u32 v7, v1, 12, v3
    v_mfma_f32_16x16x32_bf16 v[74:77], v[108:111], v[112:115], 0
    buffer_load_dwordx4 a[12:15], v17, s[8:11], s12 offen offset:3072 sc0 sc1
    s_waitcnt lgkmcnt(0)
    v_mfma_f32_16x16x32_bf16 v[66:69], v[116:119], v[88:91], v[66:69]
    ds_read_b64 v[124:125], v186 offset:3008
    ds_read_b64 v[126:127], v186 offset:3016
    v_mfma_f32_16x16x32_bf16 v[66:69], v[84:87], v[120:123], v[66:69]
    ds_read_b128 v[128:131], v187 offset:5888
    v_xor_b32 v1, 64, v7
    v_mfma_f32_16x16x32_bf16 v[70:73], v[116:119], v[96:99], v[70:73]
    v_add_u32 v8, 16384, v1
    v_xor_b32 v1, 128, v7
    v_mfma_f32_16x16x32_bf16 v[70:73], v[92:95], v[120:123], v[70:73]
    s_bfe_u32 s7, s14, 0x40000
    s_lshl_b32 s7, s7, 12
    v_mfma_f32_16x16x32_bf16 v[74:77], v[116:119], v[104:107], v[74:77]
    s_add_u32 s12, s6, s7
    buffer_load_dwordx4 a[16:19], v17, s[8:11], s12 offen offset:0 sc0 sc1
    v_mfma_f32_16x16x32_bf16 v[74:77], v[100:103], v[120:123], v[74:77]
    v_add_u32 v9, 32768, v1
    v_xor_b32 v1, 192, v7
    v_mfma_f32_16x16x32_bf16 v[78:81], v[116:119], v[112:115], 0
    ds_read_b64 v[132:133], v186 offset:3520
    ds_read_b64 v[134:135], v186 offset:3528
    v_mfma_f32_16x16x32_bf16 v[78:81], v[108:111], v[120:123], v[78:81]
    ds_read_b128 v[136:139], v187 offset:3840
    s_waitcnt lgkmcnt(3)
    v_mfma_f32_16x16x32_bf16 v[70:73], v[124:127], v[88:91], v[70:73]
    buffer_load_dwordx4 a[20:23], v17, s[8:11], s12 offen offset:1024 sc0 sc1
    v_mfma_f32_16x16x32_bf16 v[70:73], v[84:87], v[128:131], v[70:73]
    v_add_u32 v10, 49152, v1
    s_lshl_b32 s16, s45, 19
    v_mfma_f32_16x16x32_bf16 v[74:77], v[124:127], v[96:99], v[74:77]
    ds_read_b64 v[116:117], v186 offset:4032
    ds_read_b64 v[118:119], v186 offset:4040
    v_mfma_f32_16x16x32_bf16 v[74:77], v[92:95], v[128:131], v[74:77]
    ds_read_b128 v[112:115], v187 offset:1792
    s_lshl_b32 s3, s44, 17
    v_mfma_f32_16x16x32_bf16 v[78:81], v[124:127], v[104:107], v[78:81]
    ds_read_b64 v[108:109], v186 offset:384
    ds_read_b64 v[110:111], v186 offset:392
    v_mfma_f32_16x16x32_bf16 v[78:81], v[100:103], v[128:131], v[78:81]
    ds_read_b128 v[120:123], v188 offset:15872
    s_waitcnt lgkmcnt(6)
    v_mfma_f32_16x16x32_bf16 v[74:77], v[132:135], v[88:91], v[74:77]
    ds_read_b64 v[124:125], v186 offset:896
    ds_read_b64 v[126:127], v186 offset:904
    v_mfma_f32_16x16x32_bf16 v[74:77], v[84:87], v[136:139], v[74:77]
    ds_read_b128 v[104:107], v188 offset:13824
    buffer_load_dwordx4 a[24:27], v17, s[8:11], s12 offen offset:2048 sc0 sc1
    v_mfma_f32_16x16x32_bf16 v[78:81], v[132:135], v[96:99], v[78:81]
    ds_read_b64 v[100:101], v186 offset:1408
    ds_read_b64 v[102:103], v186 offset:1416
    v_mfma_f32_16x16x32_bf16 v[78:81], v[92:95], v[136:139], v[78:81]
    ds_read_b128 v[128:131], v188 offset:11776
    s_waitcnt lgkmcnt(6)
    v_mfma_f32_16x16x32_bf16 v[78:81], v[116:119], v[88:91], v[78:81]
    buffer_load_dwordx4 a[28:31], v17, s[8:11], s12 offen offset:3072 sc0 sc1
    v_mfma_f32_16x16x32_bf16 v[78:81], v[84:87], v[112:115], v[78:81]
    s_add_u32 s16, s16, s3
    s_lshl_b32 s17, s46, 8
    v_mfma_f32_16x16x32_bf16 v[46:49], v[108:111], v[120:123], v[46:49]
    s_lshl_b32 s18, s44, 13
    s_waitcnt lgkmcnt(1)
    v_mfma_f32_16x16x32_bf16 v[50:53], v[124:127], v[120:123], v[50:53]
    ds_read_b64 v[132:133], v186 offset:1920
    ds_read_b64 v[134:135], v186 offset:1928
    v_mfma_f32_16x16x32_bf16 v[50:53], v[108:111], v[104:107], v[50:53]
    ds_read_b128 v[96:99], v188 offset:9728
    s_bfe_u32 s7, s14, 0x40004
    v_mfma_f32_16x16x32_bf16 v[54:57], v[124:127], v[104:107], v[54:57]
    s_lshl_b32 s7, s7, 12
    s_add_u32 s12, s6, s7
    v_mfma_f32_16x16x32_bf16 v[54:57], v[100:103], v[120:123], v[54:57]
    buffer_load_dwordx4 a[32:35], v17, s[8:11], s12 offen offset:0 sc0 sc1
    s_waitcnt lgkmcnt(3)
    v_mfma_f32_16x16x32_bf16 v[54:57], v[108:111], v[128:131], v[54:57]
    buffer_load_dwordx4 a[36:39], v17, s[8:11], s12 offen offset:1024 sc0 sc1
    v_mfma_f32_16x16x32_bf16 v[58:61], v[100:103], v[104:107], v[58:61]
    s_lshr_b32 s28, s44, 1
    v_and_b32 v26, 31, v2
    v_mfma_f32_16x16x32_bf16 v[58:61], v[124:127], v[128:131], v[58:61]
    v_lshrrev_b32 v27, 5, v2
    v_lshlrev_b32 v27, 2, v27
    v_mfma_f32_16x16x32_bf16 v[66:69], v[100:103], v[128:131], v[66:69]
    ds_read_b64 v[92:93], v186 offset:2432
    s_waitcnt lgkmcnt(1)
    v_mfma_f32_16x16x32_bf16 v[58:61], v[132:135], v[120:123], v[58:61]
    ds_read_b64 v[94:95], v186 offset:2440
    ds_read_b128 v[136:139], v188 offset:7680
    v_mfma_f32_16x16x32_bf16 v[58:61], v[108:111], v[96:99], v[58:61]
    buffer_load_dwordx4 a[40:43], v17, s[8:11], s12 offen offset:2048 sc0 sc1
    v_mfma_f32_16x16x32_bf16 v[66:69], v[132:135], v[104:107], v[66:69]
    s_lshl_b32 s3, s28, 3
    v_add_u32 v27, s3, v27
    v_mfma_f32_16x16x32_bf16 v[66:69], v[124:127], v[96:99], v[66:69]
    v_and_b32 v28, 15, v26
    v_xor_b32 v27, v27, v28
    v_mfma_f32_16x16x32_bf16 v[70:73], v[132:135], v[128:131], v[70:73]
    v_lshlrev_b32 v27, 4, v27
    v_lshl_add_u32 v27, v26, 8, v27
    v_mfma_f32_16x16x32_bf16 v[70:73], v[100:103], v[96:99], v[70:73]
    buffer_load_dwordx4 a[44:47], v17, s[8:11], s12 offen offset:3072 sc0 sc1
    v_mfma_f32_16x16x32_bf16 v[74:77], v[132:135], v[96:99], v[74:77]
    s_lshl_b32 s3, s28, 14
    s_waitcnt lgkmcnt(0)
    v_mfma_f32_16x16x32_bf16 v[66:69], v[92:95], v[120:123], v[66:69]
    ds_read_b64 v[116:117], v186 offset:2944
    ds_read_b64 v[118:119], v186 offset:2952
    v_mfma_f32_16x16x32_bf16 v[66:69], v[108:111], v[136:139], v[66:69]
    ds_read_b128 v[88:91], v188 offset:5632
    v_add_u32 v27, s3, v27
    v_mfma_f32_16x16x32_bf16 v[70:73], v[92:95], v[104:107], v[70:73]
    s_bfe_u32 s7, s14, 0x40008
    s_lshl_b32 s7, s7, 12
    v_mfma_f32_16x16x32_bf16 v[70:73], v[124:127], v[136:139], v[70:73]
    s_add_u32 s12, s6, s7
    buffer_load_dwordx4 a[48:51], v17, s[8:11], s12 offen offset:0 sc0 sc1
    v_mfma_f32_16x16x32_bf16 v[74:77], v[92:95], v[128:131], v[74:77]
    v_xor_b32 v4, 0, v27
    v_xor_b32 v18, 0x4000, v4
    v_mfma_f32_16x16x32_bf16 v[74:77], v[100:103], v[136:139], v[74:77]
    v_add_u32 v13, 65536, v4
    v_add_u32 v22, 65536, v18
    v_mfma_f32_16x16x32_bf16 v[78:81], v[92:95], v[96:99], v[78:81]
    ds_read_b64 v[84:85], v186 offset:3456
    ds_read_b64 v[86:87], v186 offset:3464
    v_mfma_f32_16x16x32_bf16 v[78:81], v[132:135], v[136:139], v[78:81]
    ds_read_b128 v[112:115], v188 offset:3584
    s_waitcnt lgkmcnt(3)
    v_mfma_f32_16x16x32_bf16 v[70:73], v[116:119], v[120:123], v[70:73]
    buffer_load_dwordx4 a[52:55], v17, s[8:11], s12 offen offset:1024 sc0 sc1
    v_mfma_f32_16x16x32_bf16 v[70:73], v[108:111], v[88:91], v[70:73]
    v_xor_b32 v5, 16, v27
    v_xor_b32 v19, 0x4000, v5
    v_mfma_f32_16x16x32_bf16 v[74:77], v[116:119], v[104:107], v[74:77]
    ds_read_b64 v[92:93], v186 offset:3968
    ds_read_b64 v[94:95], v186 offset:3976
    v_mfma_f32_16x16x32_bf16 v[74:77], v[124:127], v[88:91], v[74:77]
    ds_read_b128 v[96:99], v188 offset:1536
    buffer_load_dwordx4 a[56:59], v17, s[8:11], s12 offen offset:2048 sc0 sc1
    v_mfma_f32_16x16x32_bf16 v[78:81], v[116:119], v[128:131], v[78:81]
    ds_read_b64 v[132:133], v186 offset:320
    ds_read_b64 v[134:135], v186 offset:328
    v_mfma_f32_16x16x32_bf16 v[78:81], v[100:103], v[88:91], v[78:81]
    ds_read_b128 v[136:139], v189 offset:15616
    s_waitcnt lgkmcnt(6)
    v_mfma_f32_16x16x32_bf16 v[74:77], v[84:87], v[120:123], v[74:77]
    ds_read_b64 v[116:117], v186 offset:832
    ds_read_b64 v[118:119], v186 offset:840
    v_mfma_f32_16x16x32_bf16 v[74:77], v[108:111], v[112:115], v[74:77]
    ds_read_b128 v[128:131], v189 offset:13568
    v_add_u32 v14, 65536, v5
    v_mfma_f32_16x16x32_bf16 v[78:81], v[84:87], v[104:107], v[78:81]
    ds_read_b64 v[100:101], v186 offset:1344
    ds_read_b64 v[102:103], v186 offset:1352
    v_mfma_f32_16x16x32_bf16 v[78:81], v[124:127], v[112:115], v[78:81]
    ds_read_b128 v[88:91], v189 offset:11520
    s_waitcnt lgkmcnt(6)
    v_mfma_f32_16x16x32_bf16 v[78:81], v[92:95], v[120:123], v[78:81]
    buffer_load_dwordx4 a[60:63], v17, s[8:11], s12 offen offset:3072 sc0 sc1
    v_mfma_f32_16x16x32_bf16 v[78:81], v[108:111], v[96:99], v[78:81]
    s_waitcnt vmcnt(16)
    v_mov_b32 v82, s42
    v_mov_b32 v83, s43
    s_mov_b64 s[48:49], exec
    s_mov_b64 exec, 1
    buffer_store_dwordx2 v[82:83], v6, s[8:11], s4 offen sc0 sc1
    s_mov_b64 exec, s[48:49]
    v_mfma_f32_16x16x32_bf16 v[46:49], v[132:135], v[136:139], v[46:49]
    s_bfe_u32 s7, s14, 0x4000c
    s_waitcnt lgkmcnt(1)
    v_mfma_f32_16x16x32_bf16 v[50:53], v[116:119], v[136:139], v[50:53]
    ds_read_b64 v[84:85], v186 offset:1856
    ds_read_b64 v[86:87], v186 offset:1864
    v_mfma_f32_16x16x32_bf16 v[50:53], v[132:135], v[128:131], v[50:53]
    ds_read_b128 v[104:107], v189 offset:9472
    s_lshl_b32 s7, s7, 12
    v_mfma_f32_16x16x32_bf16 v[54:57], v[116:119], v[128:131], v[54:57]
    s_add_u32 s12, s6, s7
    buffer_load_dwordx4 a[64:67], v17, s[8:11], s12 offen offset:0 sc0 sc1
    v_mfma_f32_16x16x32_bf16 v[54:57], v[100:103], v[136:139], v[54:57]
    buffer_load_dwordx4 a[68:71], v17, s[8:11], s12 offen offset:1024 sc0 sc1
    s_waitcnt lgkmcnt(3)
    v_mfma_f32_16x16x32_bf16 v[54:57], v[132:135], v[88:91], v[54:57]
    v_add_u32 v23, 65536, v19
    v_xor_b32 v11, 32, v27
    v_mfma_f32_16x16x32_bf16 v[58:61], v[100:103], v[128:131], v[58:61]
    v_xor_b32 v20, 0x4000, v11
    v_add_u32 v15, 65536, v11
    v_mfma_f32_16x16x32_bf16 v[58:61], v[116:119], v[88:91], v[58:61]
    v_add_u32 v24, 65536, v20
    v_xor_b32 v12, 48, v27
    v_mfma_f32_16x16x32_bf16 v[66:69], v[100:103], v[88:91], v[66:69]
    ds_read_b64 v[124:125], v186 offset:2368
    s_waitcnt lgkmcnt(1)
    v_mfma_f32_16x16x32_bf16 v[58:61], v[84:87], v[136:139], v[58:61]
    ds_read_b64 v[126:127], v186 offset:2376
    ds_read_b128 v[112:115], v189 offset:7424
    v_mfma_f32_16x16x32_bf16 v[58:61], v[132:135], v[104:107], v[58:61]
    buffer_load_dwordx4 a[72:75], v17, s[8:11], s12 offen offset:2048 sc0 sc1
    v_mfma_f32_16x16x32_bf16 v[66:69], v[84:87], v[128:131], v[66:69]
    v_xor_b32 v21, 0x4000, v12
    v_add_u32 v16, 65536, v12
    v_mfma_f32_16x16x32_bf16 v[66:69], v[116:119], v[104:107], v[66:69]
    v_add_u32 v25, 65536, v21
    s_lshl_b32 s13, s46, 4
    v_mfma_f32_16x16x32_bf16 v[70:73], v[84:87], v[88:91], v[70:73]
    buffer_load_dwordx4 a[76:79], v17, s[8:11], s12 offen offset:3072 sc0 sc1
    v_mfma_f32_16x16x32_bf16 v[70:73], v[100:103], v[104:107], v[70:73]
    s_add_u32 s13, s13, s45
    s_lshl_b32 s13, s13, 2
    v_mfma_f32_16x16x32_bf16 v[74:77], v[84:87], v[104:107], v[74:77]
    s_add_u32 s13, s13, s44
    s_waitcnt lgkmcnt(0)
    v_mfma_f32_16x16x32_bf16 v[66:69], v[124:127], v[136:139], v[66:69]
    ds_read_b64 v[92:93], v186 offset:2880
    ds_read_b64 v[94:95], v186 offset:2888
    v_mfma_f32_16x16x32_bf16 v[66:69], v[132:135], v[112:115], v[66:69]
    ds_read_b128 v[120:123], v189 offset:5376
    s_lshl_b32 s13, s13, 3
    v_mfma_f32_16x16x32_bf16 v[70:73], v[124:127], v[128:131], v[70:73]
    s_bfe_u32 s7, s14, 0x40010
    s_lshl_b32 s7, s7, 12
    v_mfma_f32_16x16x32_bf16 v[70:73], v[116:119], v[112:115], v[70:73]
    s_add_u32 s12, s6, s7
    buffer_load_dwordx4 a[80:83], v17, s[8:11], s12 offen offset:0 sc0 sc1
    v_mfma_f32_16x16x32_bf16 v[74:77], v[124:127], v[88:91], v[74:77]
    s_add_u32 s13, s13, 21520384
    s_mov_b32 s32, s36
    v_mfma_f32_16x16x32_bf16 v[74:77], v[100:103], v[112:115], v[74:77]
    s_mov_b32 s33, s37
    s_mov_b32 s34, 8388608
    v_mfma_f32_16x16x32_bf16 v[78:81], v[124:127], v[104:107], v[78:81]
    ds_read_b64 v[108:109], v186 offset:3392
    ds_read_b64 v[110:111], v186 offset:3400
    v_mfma_f32_16x16x32_bf16 v[78:81], v[84:87], v[112:115], v[78:81]
    ds_read_b128 v[96:99], v189 offset:3328
    s_waitcnt lgkmcnt(3)
    v_mfma_f32_16x16x32_bf16 v[70:73], v[92:95], v[136:139], v[70:73]
    buffer_load_dwordx4 a[84:87], v17, s[8:11], s12 offen offset:1024 sc0 sc1
    v_mfma_f32_16x16x32_bf16 v[70:73], v[132:135], v[120:123], v[70:73]
    s_mov_b32 s35, 131072
    s_lshr_b32 s29, s44, 1
    v_mfma_f32_16x16x32_bf16 v[74:77], v[92:95], v[128:131], v[74:77]
    ds_read_b64 v[124:125], v186 offset:3904
    ds_read_b64 v[126:127], v186 offset:3912
    v_mfma_f32_16x16x32_bf16 v[74:77], v[116:119], v[120:123], v[74:77]
    ds_read_b128 v[104:107], v189 offset:1280
    buffer_load_dwordx4 a[88:91], v17, s[8:11], s12 offen offset:2048 sc0 sc1
    v_mfma_f32_16x16x32_bf16 v[78:81], v[92:95], v[88:91], v[78:81]
    ds_read_b64 v[84:85], v186 offset:256
    ds_read_b64 v[86:87], v186 offset:264
    v_mfma_f32_16x16x32_bf16 v[78:81], v[100:103], v[120:123], v[78:81]
    ds_read_b128 v[112:115], v190 offset:15360
    s_waitcnt lgkmcnt(6)
    v_mfma_f32_16x16x32_bf16 v[74:77], v[108:111], v[136:139], v[74:77]
    ds_read_b64 v[92:93], v186 offset:768
    ds_read_b64 v[94:95], v186 offset:776
    v_mfma_f32_16x16x32_bf16 v[74:77], v[132:135], v[96:99], v[74:77]
    ds_read_b128 v[88:91], v190 offset:13312
    buffer_load_dwordx4 a[92:95], v17, s[8:11], s12 offen offset:3072 sc0 sc1
    v_mfma_f32_16x16x32_bf16 v[78:81], v[108:111], v[128:131], v[78:81]
    ds_read_b64 v[100:101], v186 offset:1280
    ds_read_b64 v[102:103], v186 offset:1288
    v_mfma_f32_16x16x32_bf16 v[78:81], v[116:119], v[96:99], v[78:81]
    ds_read_b128 v[120:123], v190 offset:11264
    s_waitcnt lgkmcnt(6)
    v_mfma_f32_16x16x32_bf16 v[78:81], v[124:127], v[136:139], v[78:81]
    s_and_b32 s30, s44, 1
    v_bfe_u32 v32, v2, 4, 1
    v_mfma_f32_16x16x32_bf16 v[78:81], v[132:135], v[104:107], v[78:81]
    s_bfe_u32 s7, s14, 0x40014
    s_lshl_b32 s7, s7, 12
    v_mfma_f32_16x16x32_bf16 v[46:49], v[84:87], v[112:115], v[46:49]
    s_add_u32 s12, s6, s7
    s_waitcnt lgkmcnt(1)
    v_mfma_f32_16x16x32_bf16 v[50:53], v[92:95], v[112:115], v[50:53]
    ds_read_b64 v[108:109], v186 offset:1792
    ds_read_b64 v[110:111], v186 offset:1800
    v_mfma_f32_16x16x32_bf16 v[50:53], v[84:87], v[88:91], v[50:53]
    ds_read_b128 v[128:131], v190 offset:9216
    buffer_load_dwordx4 a[96:99], v17, s[8:11], s12 offen offset:0 sc0 sc1
    v_mfma_f32_16x16x32_bf16 v[54:57], v[92:95], v[88:91], v[54:57]
    v_lshlrev_b32 v32, 2, v32
    v_and_b32 v33, 7, v2
    v_mfma_f32_16x16x32_bf16 v[54:57], v[100:103], v[112:115], v[54:57]
    buffer_load_dwordx4 a[100:103], v17, s[8:11], s12 offen offset:1024 sc0 sc1
    s_waitcnt lgkmcnt(3)
    v_mfma_f32_16x16x32_bf16 v[54:57], v[84:87], v[120:123], v[54:57]
    v_xor_b32 v33, v33, v32
    v_lshlrev_b32 v33, 4, v33
    v_mfma_f32_16x16x32_bf16 v[58:61], v[100:103], v[88:91], v[58:61]
    v_lshrrev_b32 v32, 3, v2
    v_lshl_add_u32 v35, v32, 11, v33
    v_mfma_f32_16x16x32_bf16 v[58:61], v[92:95], v[120:123], v[58:61]
    s_lshl_b32 s31, s45, 18
    s_lshl_b32 s3, s44, 16
    v_mfma_f32_16x16x32_bf16 v[66:69], v[100:103], v[120:123], v[66:69]
    ds_read_b64 v[116:117], v186 offset:2304
    s_waitcnt lgkmcnt(1)
    v_mfma_f32_16x16x32_bf16 v[58:61], v[108:111], v[112:115], v[58:61]
    ds_read_b64 v[118:119], v186 offset:2312
    ds_read_b128 v[96:99], v190 offset:7168
    v_mfma_f32_16x16x32_bf16 v[58:61], v[84:87], v[128:131], v[58:61]
    buffer_load_dwordx4 a[104:107], v17, s[8:11], s12 offen offset:2048 sc0 sc1
    v_mfma_f32_16x16x32_bf16 v[66:69], v[108:111], v[88:91], v[66:69]
    s_add_u32 s31, s31, s3
    s_lshl_b32 s3, s46, 7
    v_mfma_f32_16x16x32_bf16 v[66:69], v[92:95], v[128:131], v[66:69]
    buffer_load_dwordx4 a[108:111], v17, s[8:11], s12 offen offset:3072 sc0 sc1
    v_mfma_f32_16x16x32_bf16 v[70:73], v[108:111], v[120:123], v[70:73]
    s_add_u32 s31, s31, s3
    s_lshl_b32 s38, s46, 18
    v_mfma_f32_16x16x32_bf16 v[70:73], v[100:103], v[128:131], v[70:73]
    s_lshl_b32 s3, s44, 16
    s_add_u32 s38, s38, s3
    v_mfma_f32_16x16x32_bf16 v[74:77], v[108:111], v[128:131], v[74:77]
    s_lshl_b32 s3, s45, 8
    s_waitcnt lgkmcnt(0)
    v_mfma_f32_16x16x32_bf16 v[66:69], v[116:119], v[112:115], v[66:69]
    ds_read_b64 v[124:125], v186 offset:2816
    ds_read_b64 v[126:127], v186 offset:2824
    v_mfma_f32_16x16x32_bf16 v[66:69], v[84:87], v[96:99], v[66:69]
    ds_read_b128 v[136:139], v190 offset:5120
    s_bfe_u32 s7, s14, 0x40018
    v_mfma_f32_16x16x32_bf16 v[70:73], v[116:119], v[88:91], v[70:73]
    s_lshl_b32 s7, s7, 12
    s_add_u32 s12, s6, s7
    v_mfma_f32_16x16x32_bf16 v[70:73], v[92:95], v[96:99], v[70:73]
    buffer_load_dwordx4 a[112:115], v17, s[8:11], s12 offen offset:0 sc0 sc1
    v_mfma_f32_16x16x32_bf16 v[74:77], v[116:119], v[120:123], v[74:77]
    s_add_u32 s38, s38, s3
    s_add_u32 s38, s38, 12582912
    v_mfma_f32_16x16x32_bf16 v[74:77], v[100:103], v[96:99], v[74:77]
    buffer_load_dwordx4 a[116:119], v17, s[8:11], s12 offen offset:1024 sc0 sc1
    v_mfma_f32_16x16x32_bf16 v[78:81], v[116:119], v[128:131], v[78:81]
    ds_read_b64 v[132:133], v186 offset:3328
    ds_read_b64 v[134:135], v186 offset:3336
    v_mfma_f32_16x16x32_bf16 v[78:81], v[108:111], v[96:99], v[78:81]
    ds_read_b128 v[104:107], v190 offset:3072
    s_waitcnt lgkmcnt(3)
    v_mfma_f32_16x16x32_bf16 v[70:73], v[124:127], v[112:115], v[70:73]
    v_bfe_u32 v34, v2, 2, 2
    v_bfe_u32 v32, v2, 4, 1
    v_mfma_f32_16x16x32_bf16 v[70:73], v[84:87], v[136:139], v[70:73]
    v_lshlrev_b32 v32, 1, v32
    v_bfe_u32 v33, v2, 1, 1
    v_mfma_f32_16x16x32_bf16 v[74:77], v[124:127], v[88:91], v[74:77]
    ds_read_b64 v[116:117], v186 offset:3840
    ds_read_b64 v[118:119], v186 offset:3848
    v_mfma_f32_16x16x32_bf16 v[74:77], v[92:95], v[136:139], v[74:77]
    ds_read_b128 v[128:131], v190 offset:1024
    buffer_load_dwordx4 a[120:123], v17, s[8:11], s12 offen offset:2048 sc0 sc1
    v_mfma_f32_16x16x32_bf16 v[78:81], v[124:127], v[120:123], v[78:81]
    ds_read_b64 v[108:109], v186 offset:192
    ds_read_b64 v[110:111], v186 offset:200
    v_mfma_f32_16x16x32_bf16 v[78:81], v[100:103], v[136:139], v[78:81]
    ds_read_b128 v[96:99], v187 offset:15104
    s_waitcnt lgkmcnt(6)
    v_mfma_f32_16x16x32_bf16 v[74:77], v[132:135], v[112:115], v[74:77]
    ds_read_b64 v[124:125], v186 offset:704
    ds_read_b64 v[126:127], v186 offset:712
    v_mfma_f32_16x16x32_bf16 v[74:77], v[84:87], v[104:107], v[74:77]
    ds_read_b128 v[120:123], v187 offset:13056
    buffer_load_dwordx4 a[124:127], v17, s[8:11], s12 offen offset:3072 sc0 sc1
    v_mfma_f32_16x16x32_bf16 v[78:81], v[132:135], v[88:91], v[78:81]
    ds_read_b64 v[100:101], v186 offset:1216
    ds_read_b64 v[102:103], v186 offset:1224
    v_mfma_f32_16x16x32_bf16 v[78:81], v[92:95], v[104:107], v[78:81]
    ds_read_b128 v[136:139], v187 offset:11008
    s_waitcnt lgkmcnt(6)
    v_mfma_f32_16x16x32_bf16 v[78:81], v[116:119], v[112:115], v[78:81]
    s_bfe_u32 s7, s14, 0x4001c
    s_lshl_b32 s7, s7, 12
    v_mfma_f32_16x16x32_bf16 v[78:81], v[84:87], v[128:131], v[78:81]
    s_add_u32 s12, s6, s7
    buffer_load_dwordx4 a[128:131], v17, s[8:11], s12 offen offset:0 sc0 sc1
    v_mfma_f32_16x16x32_bf16 v[46:49], v[108:111], v[96:99], v[46:49]
    v_add_u32 v32, v32, v33
    s_waitcnt lgkmcnt(1)
    v_mfma_f32_16x16x32_bf16 v[50:53], v[124:127], v[96:99], v[50:53]
    ds_read_b64 v[132:133], v186 offset:1728
    ds_read_b64 v[134:135], v186 offset:1736
    v_mfma_f32_16x16x32_bf16 v[50:53], v[108:111], v[120:123], v[50:53]
    ds_read_b128 v[88:91], v187 offset:8960
    s_lshl_b32 s3, s30, 2
    v_mfma_f32_16x16x32_bf16 v[54:57], v[124:127], v[120:123], v[54:57]
    buffer_load_dwordx4 a[132:135], v17, s[8:11], s12 offen offset:1024 sc0 sc1
    v_mfma_f32_16x16x32_bf16 v[54:57], v[100:103], v[96:99], v[54:57]
    v_add_u32 v32, s3, v32
    s_waitcnt lgkmcnt(3)
    v_mfma_f32_16x16x32_bf16 v[54:57], v[108:111], v[136:139], v[54:57]
    v_bfe_u32 v33, v2, 3, 1
    v_lshlrev_b32 v33, 2, v33
    v_mfma_f32_16x16x32_bf16 v[58:61], v[100:103], v[120:123], v[58:61]
    v_xor_b32 v32, v32, v33
    v_lshlrev_b32 v32, 4, v32
    v_mfma_f32_16x16x32_bf16 v[58:61], v[124:127], v[136:139], v[58:61]
    buffer_load_dwordx4 a[136:139], v17, s[8:11], s12 offen offset:2048 sc0 sc1
    v_mfma_f32_16x16x32_bf16 v[66:69], v[100:103], v[136:139], v[66:69]
    ds_read_b64 v[92:93], v186 offset:2240
    s_waitcnt lgkmcnt(1)
    v_mfma_f32_16x16x32_bf16 v[58:61], v[132:135], v[96:99], v[58:61]
    ds_read_b64 v[94:95], v186 offset:2248
    ds_read_b128 v[104:107], v187 offset:6912
    v_mfma_f32_16x16x32_bf16 v[58:61], v[108:111], v[88:91], v[58:61]
    v_and_b32 v33, 1, v2
    v_lshl_add_u32 v32, v33, 3, v32
    v_mfma_f32_16x16x32_bf16 v[66:69], v[132:135], v[120:123], v[66:69]
    v_lshrrev_b32 v33, 5, v2
    v_lshl_add_u32 v34, v33, 2, v34
    v_mfma_f32_16x16x32_bf16 v[66:69], v[124:127], v[88:91], v[66:69]
    buffer_load_dwordx4 a[140:143], v17, s[8:11], s12 offen offset:3072 sc0 sc1
    v_mfma_f32_16x16x32_bf16 v[70:73], v[132:135], v[136:139], v[70:73]
    v_lshl_add_u32 v32, v34, 7, v32
    s_lshl_b32 s3, s29, 13
    v_mfma_f32_16x16x32_bf16 v[70:73], v[100:103], v[88:91], v[70:73]
    s_add_u32 s3, s3, 131072
    v_add_u32 v36, s3, v32
    v_mfma_f32_16x16x32_bf16 v[74:77], v[132:135], v[88:91], v[74:77]
    v_and_b32 v32, 15, v2
    s_waitcnt lgkmcnt(0)
    v_mfma_f32_16x16x32_bf16 v[66:69], v[92:95], v[96:99], v[66:69]
    ds_read_b64 v[116:117], v186 offset:2752
    ds_read_b64 v[118:119], v186 offset:2760
    v_mfma_f32_16x16x32_bf16 v[66:69], v[108:111], v[104:107], v[66:69]
    ds_read_b128 v[112:115], v187 offset:4864
    s_bfe_u32 s7, s15, 0x40000
    v_mfma_f32_16x16x32_bf16 v[70:73], v[92:95], v[120:123], v[70:73]
    s_lshl_b32 s7, s7, 12
    s_add_u32 s12, s6, s7
    v_mfma_f32_16x16x32_bf16 v[70:73], v[124:127], v[104:107], v[70:73]
    buffer_load_dwordx4 a[144:147], v17, s[8:11], s12 offen offset:0 sc0 sc1
    v_mfma_f32_16x16x32_bf16 v[74:77], v[92:95], v[136:139], v[74:77]
    buffer_load_dwordx4 a[148:151], v17, s[8:11], s12 offen offset:1024 sc0 sc1
    v_mfma_f32_16x16x32_bf16 v[74:77], v[100:103], v[104:107], v[74:77]
    s_lshl_b32 s3, s29, 3
    v_xor_b32 v32, s3, v32
    v_mfma_f32_16x16x32_bf16 v[78:81], v[92:95], v[88:91], v[78:81]
    ds_read_b64 v[84:85], v186 offset:3264
    ds_read_b64 v[86:87], v186 offset:3272
    v_mfma_f32_16x16x32_bf16 v[78:81], v[132:135], v[104:107], v[78:81]
    ds_read_b128 v[128:131], v187 offset:2816
    s_waitcnt lgkmcnt(3)
    v_mfma_f32_16x16x32_bf16 v[70:73], v[116:119], v[96:99], v[70:73]
    v_lshlrev_b32 v32, 4, v32
    v_and_b32 v34, 31, v2
    v_mfma_f32_16x16x32_bf16 v[70:73], v[108:111], v[112:115], v[70:73]
    buffer_load_dwordx4 a[152:155], v17, s[8:11], s12 offen offset:2048 sc0 sc1
    v_mfma_f32_16x16x32_bf16 v[74:77], v[116:119], v[120:123], v[74:77]
    ds_read_b64 v[92:93], v186 offset:3776
    ds_read_b64 v[94:95], v186 offset:3784
    v_mfma_f32_16x16x32_bf16 v[74:77], v[124:127], v[112:115], v[74:77]
    ds_read_b128 v[88:91], v187 offset:768
    v_lshl_add_u32 v32, v34, 8, v32
    v_mfma_f32_16x16x32_bf16 v[78:81], v[116:119], v[136:139], v[78:81]
    ds_read_b64 v[132:133], v186 offset:128
    ds_read_b64 v[134:135], v186 offset:136
    v_mfma_f32_16x16x32_bf16 v[78:81], v[100:103], v[112:115], v[78:81]
    ds_read_b128 v[104:107], v188 offset:14848
    s_waitcnt lgkmcnt(6)
    v_mfma_f32_16x16x32_bf16 v[74:77], v[84:87], v[96:99], v[74:77]
    ds_read_b64 v[116:117], v186 offset:640
    ds_read_b64 v[118:119], v186 offset:648
    v_mfma_f32_16x16x32_bf16 v[74:77], v[108:111], v[128:131], v[74:77]
    ds_read_b128 v[136:139], v188 offset:12800
    buffer_load_dwordx4 a[156:159], v17, s[8:11], s12 offen offset:3072 sc0 sc1
    v_mfma_f32_16x16x32_bf16 v[78:81], v[84:87], v[120:123], v[78:81]
    ds_read_b64 v[100:101], v186 offset:1152
    ds_read_b64 v[102:103], v186 offset:1160
    v_mfma_f32_16x16x32_bf16 v[78:81], v[124:127], v[128:131], v[78:81]
    ds_read_b128 v[112:115], v188 offset:10752
    s_waitcnt lgkmcnt(6)
    v_mfma_f32_16x16x32_bf16 v[78:81], v[92:95], v[96:99], v[78:81]
    s_bfe_u32 s7, s15, 0x40004
    s_lshl_b32 s7, s7, 12
    v_mfma_f32_16x16x32_bf16 v[78:81], v[108:111], v[88:91], v[78:81]
    s_add_u32 s12, s6, s7
    buffer_load_dwordx4 a[160:163], v17, s[8:11], s12 offen offset:0 sc0 sc1
    v_mfma_f32_16x16x32_bf16 v[46:49], v[132:135], v[104:107], v[46:49]
    v_lshl_add_u32 v32, v33, 3, v32
    s_waitcnt lgkmcnt(1)
    v_mfma_f32_16x16x32_bf16 v[50:53], v[116:119], v[104:107], v[50:53]
    ds_read_b64 v[84:85], v186 offset:1664
    ds_read_b64 v[86:87], v186 offset:1672
    v_mfma_f32_16x16x32_bf16 v[50:53], v[132:135], v[136:139], v[50:53]
    ds_read_b128 v[120:123], v188 offset:8704
    buffer_load_dwordx4 a[164:167], v17, s[8:11], s12 offen offset:1024 sc0 sc1
    v_mfma_f32_16x16x32_bf16 v[54:57], v[116:119], v[136:139], v[54:57]
    s_lshl_b32 s3, s30, 13
    s_add_u32 s3, s3, 147456
    v_mfma_f32_16x16x32_bf16 v[54:57], v[100:103], v[104:107], v[54:57]
    v_add_u32 v37, s3, v32
    s_waitcnt lgkmcnt(3)
    v_mfma_f32_16x16x32_bf16 v[54:57], v[132:135], v[112:115], v[54:57]
    v_and_b32 v32, 15, v2
    v_lshlrev_b32 v32, 4, v32
    v_mfma_f32_16x16x32_bf16 v[58:61], v[100:103], v[136:139], v[58:61]
    buffer_load_dwordx4 a[168:171], v17, s[8:11], s12 offen offset:2048 sc0 sc1
    v_mfma_f32_16x16x32_bf16 v[58:61], v[116:119], v[112:115], v[58:61]
    v_and_b32 v34, 16, v2
    v_lshl_add_u32 v32, v34, 9, v32
    v_mfma_f32_16x16x32_bf16 v[66:69], v[100:103], v[112:115], v[66:69]
    ds_read_b64 v[124:125], v186 offset:2176
    s_waitcnt lgkmcnt(1)
    v_mfma_f32_16x16x32_bf16 v[58:61], v[84:87], v[104:107], v[58:61]
    ds_read_b64 v[126:127], v186 offset:2184
    ds_read_b128 v[128:131], v188 offset:6656
    v_mfma_f32_16x16x32_bf16 v[58:61], v[132:135], v[120:123], v[58:61]
    buffer_load_dwordx2 v[82:83], v182, s[8:11], 0 offen sc0 sc1
    v_mfma_f32_16x16x32_bf16 v[66:69], v[84:87], v[136:139], v[66:69]
    buffer_load_dwordx4 a[172:175], v17, s[8:11], s12 offen offset:3072 sc0 sc1
    v_mfma_f32_16x16x32_bf16 v[66:69], v[116:119], v[120:123], v[66:69]
    s_lshl_b32 s3, s45, 9
    s_add_u32 s3, s3, 20971520
    v_mfma_f32_16x16x32_bf16 v[70:73], v[84:87], v[112:115], v[70:73]
    v_add_u32 v32, s3, v32
    s_lshl_b32 s3, s29, 8
    v_mfma_f32_16x16x32_bf16 v[70:73], v[100:103], v[120:123], v[70:73]
    v_add_u32 v38, s3, v32
    s_lshl_b32 s3, s44, 10
    v_mfma_f32_16x16x32_bf16 v[74:77], v[84:87], v[120:123], v[74:77]
    s_bfe_u32 s7, s15, 0x40008
    s_waitcnt lgkmcnt(0)
    v_mfma_f32_16x16x32_bf16 v[66:69], v[124:127], v[104:107], v[66:69]
    ds_read_b64 v[92:93], v186 offset:2688
    ds_read_b64 v[94:95], v186 offset:2696
    v_mfma_f32_16x16x32_bf16 v[66:69], v[132:135], v[128:131], v[66:69]
    ds_read_b128 v[96:99], v188 offset:4608
    s_lshl_b32 s7, s7, 12
    v_mfma_f32_16x16x32_bf16 v[70:73], v[124:127], v[136:139], v[70:73]
    s_add_u32 s12, s6, s7
    buffer_load_dwordx4 a[176:179], v17, s[8:11], s12 offen offset:0 sc0 sc1
    v_mfma_f32_16x16x32_bf16 v[70:73], v[116:119], v[128:131], v[70:73]
    s_add_u32 s3, s3, 147456
    v_lshl_add_u32 v39, v33, 4, s3
    v_mfma_f32_16x16x32_bf16 v[74:77], v[124:127], v[112:115], v[74:77]
    buffer_load_dwordx4 a[180:183], v17, s[8:11], s12 offen offset:1024 sc0 sc1
    v_mfma_f32_16x16x32_bf16 v[74:77], v[100:103], v[128:131], v[74:77]
    v_and_b32 v32, 31, v2
    s_lshl_b32 s3, s30, 5
    v_mfma_f32_16x16x32_bf16 v[78:81], v[124:127], v[120:123], v[78:81]
    ds_read_b64 v[108:109], v186 offset:3200
    ds_read_b64 v[110:111], v186 offset:3208
    v_mfma_f32_16x16x32_bf16 v[78:81], v[84:87], v[128:131], v[78:81]
    ds_read_b128 v[88:91], v188 offset:2560
    s_waitcnt lgkmcnt(3)
    v_mfma_f32_16x16x32_bf16 v[70:73], v[92:95], v[104:107], v[70:73]
    buffer_load_dwordx4 a[184:187], v17, s[8:11], s12 offen offset:2048 sc0 sc1
    v_mfma_f32_16x16x32_bf16 v[70:73], v[132:135], v[96:99], v[70:73]
    v_add_u32 v32, s3, v32
    s_lshl_b32 s3, s46, 6
    v_mfma_f32_16x16x32_bf16 v[74:77], v[92:95], v[136:139], v[74:77]
    ds_read_b64 v[124:125], v186 offset:3712
    ds_read_b64 v[126:127], v186 offset:3720
    v_mfma_f32_16x16x32_bf16 v[74:77], v[116:119], v[96:99], v[74:77]
    ds_read_b128 v[120:123], v188 offset:512
    v_add_u32 v32, s3, v32
    v_mfma_f32_16x16x32_bf16 v[78:81], v[92:95], v[112:115], v[78:81]
    ds_read_b64 v[84:85], v186 offset:64
    ds_read_b64 v[86:87], v186 offset:72
    v_mfma_f32_16x16x32_bf16 v[78:81], v[100:103], v[96:99], v[78:81]
    ds_read_b128 v[128:131], v189 offset:14592
    s_waitcnt lgkmcnt(6)
    v_mfma_f32_16x16x32_bf16 v[74:77], v[108:111], v[104:107], v[74:77]
    ds_read_b64 v[92:93], v186 offset:576
    ds_read_b64 v[94:95], v186 offset:584
    v_mfma_f32_16x16x32_bf16 v[74:77], v[132:135], v[88:91], v[74:77]
    ds_read_b128 v[112:115], v189 offset:12544
    buffer_load_dwordx4 a[188:191], v17, s[8:11], s12 offen offset:3072 sc0 sc1
    v_mfma_f32_16x16x32_bf16 v[78:81], v[108:111], v[136:139], v[78:81]
    ds_read_b64 v[100:101], v186 offset:1088
    ds_read_b64 v[102:103], v186 offset:1096
    v_mfma_f32_16x16x32_bf16 v[78:81], v[116:119], v[88:91], v[78:81]
    ds_read_b128 v[96:99], v189 offset:10496
    s_waitcnt lgkmcnt(6)
    v_mfma_f32_16x16x32_bf16 v[78:81], v[124:127], v[104:107], v[78:81]
    s_bfe_u32 s7, s15, 0x4000c
    s_lshl_b32 s7, s7, 12
    v_mfma_f32_16x16x32_bf16 v[78:81], v[132:135], v[120:123], v[78:81]
    s_add_u32 s12, s6, s7
    buffer_load_dwordx4 a[192:195], v17, s[8:11], s12 offen offset:0 sc0 sc1
    v_mfma_f32_16x16x32_bf16 v[46:49], v[84:87], v[128:131], v[46:49]
    v_lshlrev_b32 v33, 14, v33
    s_waitcnt lgkmcnt(1)
    v_mfma_f32_16x16x32_bf16 v[50:53], v[92:95], v[128:131], v[50:53]
    ds_read_b64 v[108:109], v186 offset:1600
    ds_read_b64 v[110:111], v186 offset:1608
    v_mfma_f32_16x16x32_bf16 v[50:53], v[84:87], v[112:115], v[50:53]
    ds_read_b128 v[136:139], v189 offset:8448
    buffer_load_dwordx4 a[196:199], v17, s[8:11], s12 offen offset:1024 sc0 sc1
    v_mfma_f32_16x16x32_bf16 v[54:57], v[92:95], v[112:115], v[54:57]
    v_lshl_add_u32 v40, v32, 2, v33
    v_add_u32 v41, 4096, v40
    v_mfma_f32_16x16x32_bf16 v[54:57], v[100:103], v[128:131], v[54:57]
    v_add_u32 v42, 8192, v40
    s_waitcnt lgkmcnt(3)
    v_mfma_f32_16x16x32_bf16 v[54:57], v[84:87], v[96:99], v[54:57]
    v_add_u32 v43, 12288, v40
    s_lshl_b32 s39, s45, 19
    v_mfma_f32_16x16x32_bf16 v[58:61], v[100:103], v[112:115], v[58:61]
    buffer_load_dwordx4 a[200:203], v17, s[8:11], s12 offen offset:2048 sc0 sc1
    v_mfma_f32_16x16x32_bf16 v[58:61], v[92:95], v[96:99], v[58:61]
    s_lshl_b32 s3, s29, 18
    s_add_u32 s39, s39, s3
    v_mfma_f32_16x16x32_bf16 v[66:69], v[100:103], v[96:99], v[66:69]
    ds_read_b64 v[116:117], v186 offset:2112
    s_waitcnt lgkmcnt(1)
    v_mfma_f32_16x16x32_bf16 v[58:61], v[108:111], v[128:131], v[58:61]
    ds_read_b64 v[118:119], v186 offset:2120
    ds_read_b128 v[88:91], v189 offset:6400
    v_mfma_f32_16x16x32_bf16 v[58:61], v[84:87], v[136:139], v[58:61]
    buffer_load_dwordx4 a[204:207], v17, s[8:11], s12 offen offset:3072 sc0 sc1
    v_mfma_f32_16x16x32_bf16 v[66:69], v[108:111], v[112:115], v[66:69]
    s_lshl_b32 s47, s44, 12
    s_lshl_b32 s3, s44, 13
    v_mfma_f32_16x16x32_bf16 v[66:69], v[92:95], v[136:139], v[66:69]
    s_add_u32 s3, s3, 0
    v_add_u32 v44, s3, v17
    v_mfma_f32_16x16x32_bf16 v[70:73], v[108:111], v[96:99], v[70:73]
    v_xor_b32 v45, 0x4000, v44
    s_lshl_b32 s3, s46, 9
    v_mfma_f32_16x16x32_bf16 v[70:73], v[100:103], v[136:139], v[70:73]
    s_bfe_u32 s7, s15, 0x40010
    s_lshl_b32 s7, s7, 12
    v_mfma_f32_16x16x32_bf16 v[74:77], v[108:111], v[136:139], v[74:77]
    s_add_u32 s12, s6, s7
    s_waitcnt lgkmcnt(0)
    v_mfma_f32_16x16x32_bf16 v[66:69], v[116:119], v[128:131], v[66:69]
    ds_read_b64 v[124:125], v186 offset:2624
    ds_read_b64 v[126:127], v186 offset:2632
    v_mfma_f32_16x16x32_bf16 v[66:69], v[84:87], v[88:91], v[66:69]
    ds_read_b128 v[104:107], v189 offset:4352
    buffer_load_dwordx4 a[208:211], v17, s[8:11], s12 offen offset:0 sc0 sc1
    v_mfma_f32_16x16x32_bf16 v[70:73], v[116:119], v[112:115], v[70:73]
    s_mov_b32 s50, 0
    s_waitcnt vmcnt(10)
    v_cmp_ne_u64 vcc, s[42:43], v[82:83]
    s_nop 4
    s_cbranch_vccz Lfdone_gate_11
Lfpoll_gate_12:
    buffer_load_dwordx2 v[82:83], v182, s[8:11], 0 offen sc0 sc1
    s_waitcnt vmcnt(0)
    v_cmp_ne_u64 vcc, s[42:43], v[82:83]
    s_nop 4
    s_add_u32 s50, s50, 1
    s_cmp_gt_u32 s50, 20000
    s_cbranch_scc1 Lfdone_gate_11
    s_cbranch_vccnz Lfpoll_gate_12
Lfdone_gate_11:
    v_mfma_f32_16x16x32_bf16 v[70:73], v[92:95], v[88:91], v[70:73]
    s_bfe_u32 s17, s14, 0x40000
    s_lshl_b32 s17, s17, 8
    v_mfma_f32_16x16x32_bf16 v[74:77], v[116:119], v[96:99], v[74:77]
    s_add_u32 s20, s16, s17
    s_add_u32 m0, s18, 32768
    v_mfma_f32_16x16x32_bf16 v[74:77], v[100:103], v[88:91], v[74:77]
    buffer_load_dwordx4 v7, s[8:11], s20 offen sc0 sc1 lds
    v_mfma_f32_16x16x32_bf16 v[78:81], v[116:119], v[136:139], v[78:81]
    ds_read_b64 v[132:133], v186 offset:3136
    ds_read_b64 v[134:135], v186 offset:3144
    v_mfma_f32_16x16x32_bf16 v[78:81], v[108:111], v[88:91], v[78:81]
    ds_read_b128 v[120:123], v189 offset:2304
    s_waitcnt lgkmcnt(3)
    v_mfma_f32_16x16x32_bf16 v[70:73], v[124:127], v[128:131], v[70:73]
    buffer_load_dwordx4 a[212:215], v17, s[8:11], s12 offen offset:1024 sc0 sc1
    v_mfma_f32_16x16x32_bf16 v[70:73], v[84:87], v[104:107], v[70:73]
    s_add_u32 m0, s18, 33792
    s_nop 0
    buffer_load_dwordx4 v8, s[8:11], s20 offen sc0 sc1 lds
    v_mfma_f32_16x16x32_bf16 v[74:77], v[124:127], v[112:115], v[74:77]
    ds_read_b64 v[116:117], v186 offset:3648
    ds_read_b64 v[118:119], v186 offset:3656
    v_mfma_f32_16x16x32_bf16 v[74:77], v[92:95], v[104:107], v[74:77]
    ds_read_b128 v[136:139], v189 offset:256
    buffer_load_dwordx4 a[216:219], v17, s[8:11], s12 offen offset:2048 sc0 sc1
    v_mfma_f32_16x16x32_bf16 v[78:81], v[124:127], v[96:99], v[78:81]
    ds_read_b64 v[108:109], v186 offset:0
    ds_read_b64 v[110:111], v186 offset:8
    v_mfma_f32_16x16x32_bf16 v[78:81], v[100:103], v[104:107], v[78:81]
    ds_read_b128 v[88:91], v190 offset:14336
    s_waitcnt lgkmcnt(6)
    v_mfma_f32_16x16x32_bf16 v[74:77], v[132:135], v[128:131], v[74:77]
    ds_read_b64 v[124:125], v186 offset:512
    ds_read_b64 v[126:127], v186 offset:520
    v_mfma_f32_16x16x32_bf16 v[74:77], v[84:87], v[120:123], v[74:77]
    ds_read_b128 v[96:99], v190 offset:12288
    s_add_u32 m0, s18, 34816
    v_mfma_f32_16x16x32_bf16 v[78:81], v[132:135], v[112:115], v[78:81]
    ds_read_b64 v[100:101], v186 offset:1024
    ds_read_b64 v[102:103], v186 offset:1032
    v_mfma_f32_16x16x32_bf16 v[78:81], v[92:95], v[120:123], v[78:81]
    ds_read_b128 v[104:107], v190 offset:10240
    s_waitcnt lgkmcnt(6)
    v_mfma_f32_16x16x32_bf16 v[78:81], v[116:119], v[128:131], v[78:81]
    buffer_load_dwordx4 v9, s[8:11], s20 offen sc0 sc1 lds
    v_mfma_f32_16x16x32_bf16 v[78:81], v[84:87], v[136:139], v[78:81]
    buffer_load_dwordx4 a[220:223], v17, s[8:11], s12 offen offset:3072 sc0 sc1
    v_mfma_f32_16x16x32_bf16 v[46:49], v[108:111], v[88:91], v[46:49]
    s_add_u32 m0, s18, 35840
    s_waitcnt lgkmcnt(1)
    v_mfma_f32_16x16x32_bf16 v[50:53], v[124:127], v[88:91], v[50:53]
    ds_read_b64 v[132:133], v186 offset:1536
    ds_read_b64 v[134:135], v186 offset:1544
    v_mfma_f32_16x16x32_bf16 v[50:53], v[108:111], v[96:99], v[50:53]
    ds_read_b128 v[112:115], v190 offset:8192
    buffer_load_dwordx4 v10, s[8:11], s20 offen sc0 sc1 lds
    v_mfma_f32_16x16x32_bf16 v[54:57], v[124:127], v[96:99], v[54:57]
    s_bfe_u32 s7, s15, 0x40014
    s_lshl_b32 s7, s7, 12
    v_mfma_f32_16x16x32_bf16 v[54:57], v[100:103], v[88:91], v[54:57]
    s_add_u32 s12, s6, s7
    s_waitcnt lgkmcnt(3)
    v_mfma_f32_16x16x32_bf16 v[54:57], v[108:111], v[104:107], v[54:57]
    buffer_load_dwordx4 a[224:227], v17, s[8:11], s12 offen offset:0 sc0 sc1
    v_mfma_f32_16x16x32_bf16 v[58:61], v[100:103], v[96:99], v[58:61]
    s_add_u32 s21, s20, 65536
    s_add_u32 m0, s18, 36864
    v_mfma_f32_16x16x32_bf16 v[58:61], v[124:127], v[104:107], v[58:61]
    buffer_load_dwordx4 v7, s[8:11], s21 offen sc0 sc1 lds
    v_mfma_f32_16x16x32_bf16 v[66:69], v[100:103], v[104:107], v[66:69]
    ds_read_b64 v[92:93], v186 offset:2048
    s_waitcnt lgkmcnt(1)
    v_mfma_f32_16x16x32_bf16 v[58:61], v[132:135], v[88:91], v[58:61]
    ds_read_b64 v[94:95], v186 offset:2056
    ds_read_b128 v[120:123], v190 offset:6144
    v_mfma_f32_16x16x32_bf16 v[58:61], v[108:111], v[112:115], v[58:61]
    buffer_load_dwordx4 a[228:231], v17, s[8:11], s12 offen offset:1024 sc0 sc1
    v_mfma_f32_16x16x32_bf16 v[66:69], v[132:135], v[96:99], v[66:69]
    s_add_u32 m0, s18, 37888
    s_nop 0
    buffer_load_dwordx4 v8, s[8:11], s21 offen sc0 sc1 lds
    v_mfma_f32_16x16x32_bf16 v[66:69], v[124:127], v[112:115], v[66:69]
    buffer_load_dwordx4 a[232:235], v17, s[8:11], s12 offen offset:2048 sc0 sc1
    v_mfma_f32_16x16x32_bf16 v[70:73], v[132:135], v[104:107], v[70:73]
    buffer_load_dwordx4 a[236:239], v17, s[8:11], s12 offen offset:3072 sc0 sc1
    v_mfma_f32_16x16x32_bf16 v[70:73], v[100:103], v[112:115], v[70:73]
    s_add_u32 m0, s18, 38912
    s_nop 0
    buffer_load_dwordx4 v9, s[8:11], s21 offen sc0 sc1 lds
    v_mfma_f32_16x16x32_bf16 v[74:77], v[132:135], v[112:115], v[74:77]
    s_bfe_u32 s7, s15, 0x40018
    s_waitcnt lgkmcnt(0)
    v_mfma_f32_16x16x32_bf16 v[66:69], v[92:95], v[88:91], v[66:69]
    ds_read_b64 v[116:117], v186 offset:2560
    ds_read_b64 v[118:119], v186 offset:2568
    v_mfma_f32_16x16x32_bf16 v[66:69], v[108:111], v[120:123], v[66:69]
    ds_read_b128 v[128:131], v190 offset:4096
    s_lshl_b32 s7, s7, 12
    v_mfma_f32_16x16x32_bf16 v[70:73], v[92:95], v[96:99], v[70:73]
    s_add_u32 s12, s6, s7
    buffer_load_dwordx4 a[240:243], v17, s[8:11], s12 offen offset:0 sc0 sc1
    v_mfma_f32_16x16x32_bf16 v[70:73], v[124:127], v[120:123], v[70:73]
    s_add_u32 m0, s18, 39936
    s_nop 0
    buffer_load_dwordx4 v10, s[8:11], s21 offen sc0 sc1 lds
    v_mfma_f32_16x16x32_bf16 v[74:77], v[92:95], v[104:107], v[74:77]
    buffer_load_dwordx4 a[244:247], v17, s[8:11], s12 offen offset:1024 sc0 sc1
    v_mfma_f32_16x16x32_bf16 v[74:77], v[100:103], v[120:123], v[74:77]
    s_add_u32 s3, s3, 21520384
    v_lshrrev_b32 v29, 1, v17
    v_mfma_f32_16x16x32_bf16 v[78:81], v[92:95], v[112:115], v[78:81]
    ds_read_b64 v[84:85], v186 offset:3072
    ds_read_b64 v[86:87], v186 offset:3080
    v_mfma_f32_16x16x32_bf16 v[78:81], v[132:135], v[120:123], v[78:81]
    ds_read_b128 v[136:139], v190 offset:2048
    s_waitcnt lgkmcnt(3)
    v_mfma_f32_16x16x32_bf16 v[70:73], v[116:119], v[88:91], v[70:73]
    buffer_load_dwordx4 a[248:251], v17, s[8:11], s12 offen offset:2048 sc0 sc1
    v_mfma_f32_16x16x32_bf16 v[70:73], v[108:111], v[128:131], v[70:73]
    v_add_u32 v29, s3, v29
    v_mfma_f32_16x16x32_bf16 v[74:77], v[116:119], v[96:99], v[74:77]
    ds_read_b64 v[92:93], v186 offset:3584
    ds_read_b64 v[94:95], v186 offset:3592
    v_mfma_f32_16x16x32_bf16 v[74:77], v[124:127], v[128:131], v[74:77]
    ds_read_b128 v[112:115], v190 offset:0
    buffer_load_dwordx4 a[252:255], v17, s[8:11], s12 offen offset:3072 sc0 sc1
    v_mfma_f32_16x16x32_bf16 v[78:81], v[116:119], v[104:107], v[78:81]
    v_mfma_f32_16x16x32_bf16 v[78:81], v[100:103], v[128:131], v[78:81]
    s_waitcnt lgkmcnt(3)
    v_mfma_f32_16x16x32_bf16 v[74:77], v[84:87], v[88:91], v[74:77]
    v_mfma_f32_16x16x32_bf16 v[74:77], v[108:111], v[136:139], v[74:77]
    v_mfma_f32_16x16x32_bf16 v[78:81], v[84:87], v[96:99], v[78:81]
    v_mfma_f32_16x16x32_bf16 v[78:81], v[124:127], v[136:139], v[78:81]
    s_waitcnt lgkmcnt(0)
    v_mfma_f32_16x16x32_bf16 v[78:81], v[92:95], v[88:91], v[78:81]
    v_mfma_f32_16x16x32_bf16 v[78:81], v[108:111], v[112:115], v[78:81]
    s_barrier
    ds_read_b128 v[84:87], v4 offset:0
    ds_read_b128 v[88:91], v4 offset:8192
    ds_read_b128 v[92:95], v18 offset:0
    ds_read_b128 v[96:99], v18 offset:8192
    s_bfe_u32 s17, s14, 0x40004
    s_lshl_b32 s17, s17, 8
    s_add_u32 s20, s16, s17
    s_add_u32 m0, s18, 65536
    s_waitcnt lgkmcnt(3)
    v_mfma_f32_32x32x16_bf16 v[116:131], v[84:87], a[0:3], 0
    ds_read_b128 v[100:103], v5 offset:0
    ds_read_b128 v[104:107], v5 offset:8192
    buffer_load_dwordx4 v7, s[8:11], s20 offen sc0 sc1 lds
    ds_read_b64 v[26:27], v191 offset:14336
    ds_read_b64 v[32:33], v191 offset:12288
    ds_read_b64 v[62:63], v191 offset:10240
    ds_read_b64 v[180:181], v191 offset:8192
    ds_read_b64 v[184:185], v191 offset:6144
    ds_read_b64 v[194:195], v191 offset:4096
    s_add_u32 m0, s18, 66560
    s_waitcnt lgkmcnt(10)
    v_mfma_f32_32x32x16_bf16 v[132:147], v[88:91], a[0:3], 0
    ds_read_b128 v[108:111], v19 offset:0
    ds_read_b128 v[112:115], v19 offset:8192
    buffer_load_dwordx4 v8, s[8:11], s20 offen sc0 sc1 lds
    ds_read_b64 v[196:197], v191 offset:2048
    ds_read_b64 v[198:199], v191 offset:0
    s_add_u32 s4, s22, 12582912
    s_waitcnt lgkmcnt(9)
    v_and_b32 v200, s5, v27
    v_lshlrev_b32 v201, 16, v27
    v_and_b32 v202, s5, v26
    s_add_u32 m0, s18, 67584
    v_mfma_f32_32x32x16_bf16 v[148:163], v[92:95], a[0:3], 0
    buffer_load_dwordx4 v9, s[8:11], s20 offen sc0 sc1 lds
    v_lshlrev_b32 v203, 16, v26
    v_fmac_f32 v46, v183, v200
    v_fmac_f32 v47, v183, v201
    v_fmac_f32 v48, v183, v202
    v_fmac_f32 v49, v183, v203
    v_cvt_pk_bf16_f32 v204, v46, v47
    v_cvt_pk_bf16_f32 v205, v48, v49
    s_waitcnt lgkmcnt(8)
    v_and_b32 v200, s5, v33
    s_add_u32 m0, s18, 68608
    v_mfma_f32_32x32x16_bf16 v[164:179], v[96:99], a[0:3], 0
    buffer_load_dwordx4 v10, s[8:11], s20 offen sc0 sc1 lds
    v_lshlrev_b32 v201, 16, v33
    v_and_b32 v202, s5, v32
    v_lshlrev_b32 v203, 16, v32
    v_fmac_f32 v50, v183, v200
    v_fmac_f32 v51, v183, v201
    v_fmac_f32 v52, v183, v202
    v_fmac_f32 v53, v183, v203
    v_cvt_pk_bf16_f32 v206, v50, v51
    v_cvt_pk_bf16_f32 v207, v52, v53
    s_add_u32 s21, s20, 65536
    s_add_u32 m0, s18, 69632
    v_mfma_f32_32x32x16_bf16 v[116:131], v[100:103], a[4:7], v[116:131]
    ds_read_b128 v[84:87], v11 offset:0
    ds_read_b128 v[88:91], v11 offset:8192
    buffer_load_dwordx4 v7, s[8:11], s21 offen sc0 sc1 lds
    v_permlane16_swap_b32 v204, v206
    v_permlane16_swap_b32 v205, v207
    s_waitcnt lgkmcnt(9)
    v_and_b32 v200, s5, v63
    v_lshlrev_b32 v201, 16, v63
    v_and_b32 v202, s5, v62
    v_lshlrev_b32 v203, 16, v62
    s_add_u32 m0, s18, 70656
    v_mfma_f32_32x32x16_bf16 v[132:147], v[104:107], a[4:7], v[132:147]
    ds_read_b128 v[92:95], v20 offset:0
    ds_read_b128 v[96:99], v20 offset:8192
    buffer_load_dwordx4 v8, s[8:11], s21 offen sc0 sc1 lds
    v_fmac_f32 v54, v183, v200
    v_fmac_f32 v55, v183, v201
    v_fmac_f32 v56, v183, v202
    v_fmac_f32 v57, v183, v203
    v_cvt_pk_bf16_f32 v208, v54, v55
    v_cvt_pk_bf16_f32 v209, v56, v57
    s_add_u32 m0, s18, 71680
    s_waitcnt lgkmcnt(7)
    v_mfma_f32_32x32x16_bf16 v[148:163], v[108:111], a[4:7], v[148:163]
    buffer_load_dwordx4 v9, s[8:11], s21 offen sc0 sc1 lds
    v_and_b32 v200, s5, v181
    v_lshlrev_b32 v201, 16, v181
    v_and_b32 v202, s5, v180
    v_lshlrev_b32 v203, 16, v180
    v_fmac_f32 v58, v183, v200
    v_fmac_f32 v59, v183, v201
    v_fmac_f32 v60, v183, v202
    v_fmac_f32 v61, v183, v203
    s_add_u32 m0, s18, 72704
    s_waitcnt lgkmcnt(6)
    v_mfma_f32_32x32x16_bf16 v[164:179], v[112:115], a[4:7], v[164:179]
    buffer_load_dwordx4 v10, s[8:11], s21 offen sc0 sc1 lds
    v_cvt_pk_bf16_f32 v210, v58, v59
    v_cvt_pk_bf16_f32 v211, v60, v61
    s_nop 0
    v_permlane16_swap_b32 v208, v210
    v_permlane16_swap_b32 v209, v211
    v_and_b32 v200, s5, v185
    v_lshlrev_b32 v201, 16, v185
    v_and_b32 v202, s5, v184
    v_lshlrev_b32 v203, 16, v184
    v_fmac_f32 v66, v183, v200
    s_bfe_u32 s17, s14, 0x40008
    s_lshl_b32 s17, s17, 8
    s_add_u32 s20, s16, s17
    s_add_u32 m0, s18, 98304
    s_waitcnt lgkmcnt(3)
    v_mfma_f32_32x32x16_bf16 v[116:131], v[84:87], a[8:11], v[116:131]
    ds_read_b128 v[100:103], v12 offset:0
    ds_read_b128 v[104:107], v12 offset:8192
    buffer_load_dwordx4 v7, s[8:11], s20 offen sc0 sc1 lds
    v_fmac_f32 v67, v183, v201
    v_fmac_f32 v68, v183, v202
    v_fmac_f32 v69, v183, v203
    v_cvt_pk_bf16_f32 v212, v66, v67
    v_cvt_pk_bf16_f32 v213, v68, v69
    v_and_b32 v200, s5, v195
    s_add_u32 m0, s18, 99328
    s_waitcnt lgkmcnt(4)
    v_mfma_f32_32x32x16_bf16 v[132:147], v[88:91], a[8:11], v[132:147]
    ds_read_b128 v[108:111], v21 offset:0
    ds_read_b128 v[112:115], v21 offset:8192
    buffer_load_dwordx4 v8, s[8:11], s20 offen sc0 sc1 lds
    v_lshlrev_b32 v201, 16, v195
    v_and_b32 v202, s5, v194
    v_lshlrev_b32 v203, 16, v194
    v_fmac_f32 v70, v183, v200
    v_fmac_f32 v71, v183, v201
    v_fmac_f32 v72, v183, v202
    s_add_u32 m0, s18, 100352
    s_waitcnt lgkmcnt(5)
    v_mfma_f32_32x32x16_bf16 v[148:163], v[92:95], a[8:11], v[148:163]
    buffer_load_dwordx4 v9, s[8:11], s20 offen sc0 sc1 lds
    v_fmac_f32 v73, v183, v203
    v_cvt_pk_bf16_f32 v214, v70, v71
    v_cvt_pk_bf16_f32 v215, v72, v73
    s_nop 0
    v_permlane16_swap_b32 v212, v214
    v_permlane16_swap_b32 v213, v215
    v_and_b32 v200, s5, v197
    v_lshlrev_b32 v201, 16, v197
    v_and_b32 v202, s5, v196
    s_add_u32 m0, s18, 101376
    s_waitcnt lgkmcnt(4)
    v_mfma_f32_32x32x16_bf16 v[164:179], v[96:99], a[8:11], v[164:179]
    buffer_load_dwordx4 v10, s[8:11], s20 offen sc0 sc1 lds
    v_lshlrev_b32 v203, 16, v196
    v_fmac_f32 v74, v183, v200
    v_fmac_f32 v75, v183, v201
    v_fmac_f32 v76, v183, v202
    v_fmac_f32 v77, v183, v203
    v_cvt_pk_bf16_f32 v216, v74, v75
    v_cvt_pk_bf16_f32 v217, v76, v77
    v_and_b32 v200, s5, v199
    v_lshlrev_b32 v201, 16, v199
    s_waitcnt lgkmcnt(0)
    s_waitcnt vmcnt(15)
    s_barrier
    s_add_u32 s21, s20, 65536
    s_add_u32 m0, s18, 102400
    v_mfma_f32_32x32x16_bf16 v[116:131], v[100:103], a[12:15], v[116:131]
    ds_read_b128 v[84:87], v4 offset:32768
    ds_read_b128 v[88:91], v4 offset:40960
    buffer_load_dwordx4 v7, s[8:11], s21 offen sc0 sc1 lds
    v_and_b32 v202, s5, v198
    v_lshlrev_b32 v203, 16, v198
    v_fmac_f32 v78, v183, v200
    v_fmac_f32 v79, v183, v201
    v_fmac_f32 v80, v183, v202
    v_fmac_f32 v81, v183, v203
    s_add_u32 m0, s18, 103424
    v_mfma_f32_32x32x16_bf16 v[132:147], v[104:107], a[12:15], v[132:147]
    ds_read_b128 v[92:95], v18 offset:32768
    ds_read_b128 v[96:99], v18 offset:40960
    buffer_load_dwordx4 v8, s[8:11], s21 offen sc0 sc1 lds
    v_cvt_pk_bf16_f32 v218, v78, v79
    v_cvt_pk_bf16_f32 v219, v80, v81
    s_nop 0
    v_permlane16_swap_b32 v216, v218
    v_permlane16_swap_b32 v217, v219
    s_add_u32 m0, s18, 104448
    v_mfma_f32_32x32x16_bf16 v[148:163], v[108:111], a[12:15], v[148:163]
    buffer_load_dwordx4 v9, s[8:11], s21 offen sc0 sc1 lds
    s_add_u32 m0, s18, 105472
    v_mfma_f32_32x32x16_bf16 v[164:179], v[112:115], a[12:15], v[164:179]
    buffer_load_dwordx4 v10, s[8:11], s21 offen sc0 sc1 lds
    s_waitcnt lgkmcnt(3)
    v_mfma_f32_32x32x16_bf16 v[116:131], v[84:87], a[16:19], v[116:131]
    ds_read_b128 v[100:103], v5 offset:32768
    ds_read_b128 v[104:107], v5 offset:40960
    buffer_store_dwordx4 v[204:207], v192, s[8:11], s4 offen offset:0 sc0 sc1
    buffer_store_dwordx4 v[208:211], v192, s[8:11], s4 offen offset:1024 sc0 sc1
    buffer_store_dwordx4 v[212:215], v192, s[8:11], s4 offen offset:2048 sc0 sc1
    s_waitcnt lgkmcnt(4)
    v_mfma_f32_32x32x16_bf16 v[132:147], v[88:91], a[16:19], v[132:147]
    ds_read_b128 v[108:111], v19 offset:32768
    ds_read_b128 v[112:115], v19 offset:40960
    s_bfe_u32 s17, s14, 0x4000c
    s_lshl_b32 s17, s17, 8
    s_add_u32 s20, s16, s17
    s_add_u32 m0, s18, 0
    s_waitcnt lgkmcnt(5)
    v_mfma_f32_32x32x16_bf16 v[148:163], v[92:95], a[16:19], v[148:163]
    buffer_load_dwordx4 v7, s[8:11], s20 offen sc0 sc1 lds
    buffer_store_dwordx4 v[216:219], v192, s[8:11], s4 offen offset:3072 sc0 sc1
    s_add_u32 m0, s18, 1024
    s_waitcnt lgkmcnt(4)
    v_mfma_f32_32x32x16_bf16 v[164:179], v[96:99], a[16:19], v[164:179]
    buffer_load_dwordx4 v8, s[8:11], s20 offen sc0 sc1 lds
    s_waitcnt lgkmcnt(3)
    v_mfma_f32_32x32x16_bf16 v[116:131], v[100:103], a[20:23], v[116:131]
    ds_read_b128 v[84:87], v11 offset:32768
    ds_read_b128 v[88:91], v11 offset:40960
    s_waitcnt lgkmcnt(4)
    v_mfma_f32_32x32x16_bf16 v[132:147], v[104:107], a[20:23], v[132:147]
    ds_read_b128 v[92:95], v20 offset:32768
    ds_read_b128 v[96:99], v20 offset:40960
    s_add_u32 m0, s18, 2048
    s_waitcnt lgkmcnt(5)
    v_mfma_f32_32x32x16_bf16 v[148:163], v[108:111], a[20:23], v[148:163]
    buffer_load_dwordx4 v9, s[8:11], s20 offen sc0 sc1 lds
    s_add_u32 m0, s18, 3072
    s_waitcnt lgkmcnt(4)
    v_mfma_f32_32x32x16_bf16 v[164:179], v[112:115], a[20:23], v[164:179]
    buffer_load_dwordx4 v10, s[8:11], s20 offen sc0 sc1 lds
    s_waitcnt lgkmcnt(3)
    v_mfma_f32_32x32x16_bf16 v[116:131], v[84:87], a[24:27], v[116:131]
    ds_read_b128 v[100:103], v12 offset:32768
    ds_read_b128 v[104:107], v12 offset:40960
    s_waitcnt lgkmcnt(4)
    v_mfma_f32_32x32x16_bf16 v[132:147], v[88:91], a[24:27], v[132:147]
    ds_read_b128 v[108:111], v21 offset:32768
    ds_read_b128 v[112:115], v21 offset:40960
    s_add_u32 s21, s20, 65536
    s_add_u32 m0, s18, 4096
    s_waitcnt lgkmcnt(5)
    v_mfma_f32_32x32x16_bf16 v[148:163], v[92:95], a[24:27], v[148:163]
    buffer_load_dwordx4 v7, s[8:11], s21 offen sc0 sc1 lds
    s_add_u32 m0, s18, 5120
    s_waitcnt lgkmcnt(4)
    v_mfma_f32_32x32x16_bf16 v[164:179], v[96:99], a[24:27], v[164:179]
    buffer_load_dwordx4 v8, s[8:11], s21 offen sc0 sc1 lds
    s_waitcnt lgkmcnt(0)
    s_waitcnt vmcnt(18)
    s_barrier
    v_mfma_f32_32x32x16_bf16 v[116:131], v[100:103], a[28:31], v[116:131]
    ds_read_b128 v[84:87], v13 offset:0
    ds_read_b128 v[88:91], v13 offset:8192
    v_mfma_f32_32x32x16_bf16 v[132:147], v[104:107], a[28:31], v[132:147]
    ds_read_b128 v[92:95], v22 offset:0
    ds_read_b128 v[96:99], v22 offset:8192
    s_add_u32 m0, s18, 6144
    v_mfma_f32_32x32x16_bf16 v[148:163], v[108:111], a[28:31], v[148:163]
    buffer_load_dwordx4 v9, s[8:11], s21 offen sc0 sc1 lds
    s_add_u32 m0, s18, 7168
    v_mfma_f32_32x32x16_bf16 v[164:179], v[112:115], a[28:31], v[164:179]
    buffer_load_dwordx4 v10, s[8:11], s21 offen sc0 sc1 lds
    s_waitcnt lgkmcnt(3)
    v_mfma_f32_32x32x16_bf16 v[116:131], v[84:87], a[32:35], v[116:131]
    ds_read_b128 v[100:103], v14 offset:0
    ds_read_b128 v[104:107], v14 offset:8192
    s_waitcnt lgkmcnt(4)
    v_mfma_f32_32x32x16_bf16 v[132:147], v[88:91], a[32:35], v[132:147]
    ds_read_b128 v[108:111], v23 offset:0
    ds_read_b128 v[112:115], v23 offset:8192
    s_bfe_u32 s17, s14, 0x40010
    s_lshl_b32 s17, s17, 8
    s_add_u32 s20, s16, s17
    s_add_u32 m0, s18, 32768
    s_waitcnt lgkmcnt(5)
    v_mfma_f32_32x32x16_bf16 v[148:163], v[92:95], a[32:35], v[148:163]
    buffer_load_dwordx4 v7, s[8:11], s20 offen sc0 sc1 lds
    s_add_u32 m0, s18, 33792
    s_waitcnt lgkmcnt(4)
    v_mfma_f32_32x32x16_bf16 v[164:179], v[96:99], a[32:35], v[164:179]
    buffer_load_dwordx4 v8, s[8:11], s20 offen sc0 sc1 lds
    s_waitcnt lgkmcnt(3)
    v_mfma_f32_32x32x16_bf16 v[116:131], v[100:103], a[36:39], v[116:131]
    ds_read_b128 v[84:87], v15 offset:0
    ds_read_b128 v[88:91], v15 offset:8192
    s_waitcnt lgkmcnt(4)
    v_mfma_f32_32x32x16_bf16 v[132:147], v[104:107], a[36:39], v[132:147]
    ds_read_b128 v[92:95], v24 offset:0
    ds_read_b128 v[96:99], v24 offset:8192
    s_add_u32 m0, s18, 34816
    s_waitcnt lgkmcnt(5)
    v_mfma_f32_32x32x16_bf16 v[148:163], v[108:111], a[36:39], v[148:163]
    buffer_load_dwordx4 v9, s[8:11], s20 offen sc0 sc1 lds
    s_add_u32 m0, s18, 35840
    s_waitcnt lgkmcnt(4)
    v_mfma_f32_32x32x16_bf16 v[164:179], v[112:115], a[36:39], v[164:179]
    buffer_load_dwordx4 v10, s[8:11], s20 offen sc0 sc1 lds
    s_waitcnt lgkmcnt(3)
    v_mfma_f32_32x32x16_bf16 v[116:131], v[84:87], a[40:43], v[116:131]
    ds_read_b128 v[100:103], v16 offset:0
    ds_read_b128 v[104:107], v16 offset:8192
    s_waitcnt lgkmcnt(4)
    v_mfma_f32_32x32x16_bf16 v[132:147], v[88:91], a[40:43], v[132:147]
    ds_read_b128 v[108:111], v25 offset:0
    ds_read_b128 v[112:115], v25 offset:8192
    s_add_u32 s21, s20, 65536
    s_add_u32 m0, s18, 36864
    s_waitcnt lgkmcnt(5)
    v_mfma_f32_32x32x16_bf16 v[148:163], v[92:95], a[40:43], v[148:163]
    buffer_load_dwordx4 v7, s[8:11], s21 offen sc0 sc1 lds
    s_add_u32 m0, s18, 37888
    s_waitcnt lgkmcnt(4)
    v_mfma_f32_32x32x16_bf16 v[164:179], v[96:99], a[40:43], v[164:179]
    buffer_load_dwordx4 v8, s[8:11], s21 offen sc0 sc1 lds
    s_waitcnt lgkmcnt(0)
    s_waitcnt vmcnt(18)
    s_barrier
    v_mfma_f32_32x32x16_bf16 v[116:131], v[100:103], a[44:47], v[116:131]
    ds_read_b128 v[84:87], v13 offset:32768
    ds_read_b128 v[88:91], v13 offset:40960
    v_mfma_f32_32x32x16_bf16 v[132:147], v[104:107], a[44:47], v[132:147]
    ds_read_b128 v[92:95], v22 offset:32768
    ds_read_b128 v[96:99], v22 offset:40960
    s_add_u32 m0, s18, 38912
    v_mfma_f32_32x32x16_bf16 v[148:163], v[108:111], a[44:47], v[148:163]
    buffer_load_dwordx4 v9, s[8:11], s21 offen sc0 sc1 lds
    s_add_u32 m0, s18, 39936
    v_mfma_f32_32x32x16_bf16 v[164:179], v[112:115], a[44:47], v[164:179]
    buffer_load_dwordx4 v10, s[8:11], s21 offen sc0 sc1 lds
    s_waitcnt lgkmcnt(3)
    v_mfma_f32_32x32x16_bf16 v[116:131], v[84:87], a[48:51], v[116:131]
    ds_read_b128 v[100:103], v14 offset:32768
    ds_read_b128 v[104:107], v14 offset:40960
    s_waitcnt lgkmcnt(4)
    v_mfma_f32_32x32x16_bf16 v[132:147], v[88:91], a[48:51], v[132:147]
    ds_read_b128 v[108:111], v23 offset:32768
    ds_read_b128 v[112:115], v23 offset:40960
    s_bfe_u32 s17, s14, 0x40014
    s_lshl_b32 s17, s17, 8
    s_add_u32 s20, s16, s17
    s_add_u32 m0, s18, 65536
    s_waitcnt lgkmcnt(5)
    v_mfma_f32_32x32x16_bf16 v[148:163], v[92:95], a[48:51], v[148:163]
    buffer_load_dwordx4 v7, s[8:11], s20 offen sc0 sc1 lds
    s_add_u32 m0, s18, 66560
    s_waitcnt lgkmcnt(4)
    v_mfma_f32_32x32x16_bf16 v[164:179], v[96:99], a[48:51], v[164:179]
    buffer_load_dwordx4 v8, s[8:11], s20 offen sc0 sc1 lds
    s_waitcnt lgkmcnt(3)
    v_mfma_f32_32x32x16_bf16 v[116:131], v[100:103], a[52:55], v[116:131]
    ds_read_b128 v[84:87], v15 offset:32768
    ds_read_b128 v[88:91], v15 offset:40960
    s_waitcnt lgkmcnt(4)
    v_mfma_f32_32x32x16_bf16 v[132:147], v[104:107], a[52:55], v[132:147]
    ds_read_b128 v[92:95], v24 offset:32768
    ds_read_b128 v[96:99], v24 offset:40960
    s_add_u32 m0, s18, 67584
    s_waitcnt lgkmcnt(5)
    v_mfma_f32_32x32x16_bf16 v[148:163], v[108:111], a[52:55], v[148:163]
    buffer_load_dwordx4 v9, s[8:11], s20 offen sc0 sc1 lds
    s_add_u32 m0, s18, 68608
    s_waitcnt lgkmcnt(4)
    v_mfma_f32_32x32x16_bf16 v[164:179], v[112:115], a[52:55], v[164:179]
    buffer_load_dwordx4 v10, s[8:11], s20 offen sc0 sc1 lds
    s_waitcnt lgkmcnt(3)
    v_mfma_f32_32x32x16_bf16 v[116:131], v[84:87], a[56:59], v[116:131]
    ds_read_b128 v[100:103], v16 offset:32768
    ds_read_b128 v[104:107], v16 offset:40960
    s_waitcnt lgkmcnt(4)
    v_mfma_f32_32x32x16_bf16 v[132:147], v[88:91], a[56:59], v[132:147]
    ds_read_b128 v[108:111], v25 offset:32768
    ds_read_b128 v[112:115], v25 offset:40960
    s_add_u32 s21, s20, 65536
    s_add_u32 m0, s18, 69632
    s_waitcnt lgkmcnt(5)
    v_mfma_f32_32x32x16_bf16 v[148:163], v[92:95], a[56:59], v[148:163]
    buffer_load_dwordx4 v7, s[8:11], s21 offen sc0 sc1 lds
    s_add_u32 m0, s18, 70656
    s_waitcnt lgkmcnt(4)
    v_mfma_f32_32x32x16_bf16 v[164:179], v[96:99], a[56:59], v[164:179]
    buffer_load_dwordx4 v8, s[8:11], s21 offen sc0 sc1 lds
    s_waitcnt lgkmcnt(0)
    s_waitcnt vmcnt(14)
    s_barrier
    v_mfma_f32_32x32x16_bf16 v[116:131], v[100:103], a[60:63], v[116:131]
    ds_read_b128 v[84:87], v4 offset:0
    ds_read_b128 v[88:91], v4 offset:8192
    v_mfma_f32_32x32x16_bf16 v[132:147], v[104:107], a[60:63], v[132:147]
    ds_read_b128 v[92:95], v18 offset:0
    ds_read_b128 v[96:99], v18 offset:8192
    s_add_u32 m0, s18, 71680
    v_mfma_f32_32x32x16_bf16 v[148:163], v[108:111], a[60:63], v[148:163]
    buffer_load_dwordx4 v9, s[8:11], s21 offen sc0 sc1 lds
    s_add_u32 m0, s18, 72704
    v_mfma_f32_32x32x16_bf16 v[164:179], v[112:115], a[60:63], v[164:179]
    buffer_load_dwordx4 v10, s[8:11], s21 offen sc0 sc1 lds
    s_waitcnt lgkmcnt(3)
    v_mfma_f32_32x32x16_bf16 v[116:131], v[84:87], a[64:67], v[116:131]
    ds_read_b128 v[100:103], v5 offset:0
    ds_read_b128 v[104:107], v5 offset:8192
    v_mov_b32 v82, s42
    v_mov_b32 v83, s43
    s_mov_b64 s[22:23], exec
    s_mov_b64 exec, 1
    buffer_store_dwordx2 v[82:83], v6, s[8:11], s13 offen sc0 sc1
    s_mov_b64 exec, s[22:23]
    s_waitcnt lgkmcnt(4)
    v_mfma_f32_32x32x16_bf16 v[132:147], v[88:91], a[64:67], v[132:147]
    ds_read_b128 v[108:111], v19 offset:0
    ds_read_b128 v[112:115], v19 offset:8192
    s_bfe_u32 s17, s14, 0x40018
    s_lshl_b32 s17, s17, 8
    s_add_u32 s20, s16, s17
    s_add_u32 m0, s18, 98304
    s_waitcnt lgkmcnt(5)
    v_mfma_f32_32x32x16_bf16 v[148:163], v[92:95], a[64:67], v[148:163]
    buffer_load_dwordx4 v7, s[8:11], s20 offen sc0 sc1 lds
    s_add_u32 m0, s18, 99328
    s_waitcnt lgkmcnt(4)
    v_mfma_f32_32x32x16_bf16 v[164:179], v[96:99], a[64:67], v[164:179]
    buffer_load_dwordx4 v8, s[8:11], s20 offen sc0 sc1 lds
    s_waitcnt lgkmcnt(3)
    v_mfma_f32_32x32x16_bf16 v[116:131], v[100:103], a[68:71], v[116:131]
    ds_read_b128 v[84:87], v11 offset:0
    ds_read_b128 v[88:91], v11 offset:8192
    s_waitcnt lgkmcnt(4)
    v_mfma_f32_32x32x16_bf16 v[132:147], v[104:107], a[68:71], v[132:147]
    ds_read_b128 v[92:95], v20 offset:0
    ds_read_b128 v[96:99], v20 offset:8192
    s_add_u32 m0, s18, 100352
    s_waitcnt lgkmcnt(5)
    v_mfma_f32_32x32x16_bf16 v[148:163], v[108:111], a[68:71], v[148:163]
    buffer_load_dwordx4 v9, s[8:11], s20 offen sc0 sc1 lds
    s_add_u32 m0, s18, 101376
    s_waitcnt lgkmcnt(4)
    v_mfma_f32_32x32x16_bf16 v[164:179], v[112:115], a[68:71], v[164:179]
    buffer_load_dwordx4 v10, s[8:11], s20 offen sc0 sc1 lds
    s_waitcnt lgkmcnt(3)
    v_mfma_f32_32x32x16_bf16 v[116:131], v[84:87], a[72:75], v[116:131]
    ds_read_b128 v[100:103], v12 offset:0
    ds_read_b128 v[104:107], v12 offset:8192
    s_waitcnt lgkmcnt(4)
    v_mfma_f32_32x32x16_bf16 v[132:147], v[88:91], a[72:75], v[132:147]
    ds_read_b128 v[108:111], v21 offset:0
    ds_read_b128 v[112:115], v21 offset:8192
    s_add_u32 s21, s20, 65536
    s_add_u32 m0, s18, 102400
    s_waitcnt lgkmcnt(5)
    v_mfma_f32_32x32x16_bf16 v[148:163], v[92:95], a[72:75], v[148:163]
    buffer_load_dwordx4 v7, s[8:11], s21 offen sc0 sc1 lds
    s_add_u32 m0, s18, 103424
    s_waitcnt lgkmcnt(4)
    v_mfma_f32_32x32x16_bf16 v[164:179], v[96:99], a[72:75], v[164:179]
    buffer_load_dwordx4 v8, s[8:11], s21 offen sc0 sc1 lds
    s_waitcnt lgkmcnt(0)
    s_waitcnt vmcnt(15)
    s_barrier
    v_mfma_f32_32x32x16_bf16 v[116:131], v[100:103], a[76:79], v[116:131]
    ds_read_b128 v[84:87], v4 offset:32768
    ds_read_b128 v[88:91], v4 offset:40960
    v_mfma_f32_32x32x16_bf16 v[132:147], v[104:107], a[76:79], v[132:147]
    ds_read_b128 v[92:95], v18 offset:32768
    ds_read_b128 v[96:99], v18 offset:40960
    s_add_u32 m0, s18, 104448
    v_mfma_f32_32x32x16_bf16 v[148:163], v[108:111], a[76:79], v[148:163]
    buffer_load_dwordx4 v9, s[8:11], s21 offen sc0 sc1 lds
    s_add_u32 m0, s18, 105472
    v_mfma_f32_32x32x16_bf16 v[164:179], v[112:115], a[76:79], v[164:179]
    buffer_load_dwordx4 v10, s[8:11], s21 offen sc0 sc1 lds
    s_waitcnt lgkmcnt(3)
    v_mfma_f32_32x32x16_bf16 v[116:131], v[84:87], a[80:83], v[116:131]
    ds_read_b128 v[100:103], v5 offset:32768
    ds_read_b128 v[104:107], v5 offset:40960
    s_add_u32 m0, s47, 131072
    s_nop 0
    buffer_load_dwordx4 v35, s[56:59], s31 offen lds
    s_add_u32 s31, s31, 16384
    s_add_u32 m0, s47, 132096
    s_nop 0
    buffer_load_dwordx4 v35, s[56:59], s31 offen lds
    s_waitcnt lgkmcnt(4)
    v_mfma_f32_32x32x16_bf16 v[132:147], v[88:91], a[80:83], v[132:147]
    ds_read_b128 v[108:111], v19 offset:32768
    ds_read_b128 v[112:115], v19 offset:40960
    s_bfe_u32 s17, s14, 0x4001c
    s_lshl_b32 s17, s17, 8
    s_add_u32 s20, s16, s17
    s_add_u32 m0, s18, 0
    s_waitcnt lgkmcnt(5)
    v_mfma_f32_32x32x16_bf16 v[148:163], v[92:95], a[80:83], v[148:163]
    buffer_load_dwordx4 v7, s[8:11], s20 offen sc0 sc1 lds
    s_add_u32 s31, s31, 16384
    s_add_u32 m0, s47, 133120
    s_nop 0
    buffer_load_dwordx4 v35, s[56:59], s31 offen lds
    s_add_u32 s31, s31, 16384
    s_add_u32 m0, s18, 1024
    s_waitcnt lgkmcnt(4)
    v_mfma_f32_32x32x16_bf16 v[164:179], v[96:99], a[80:83], v[164:179]
    buffer_load_dwordx4 v8, s[8:11], s20 offen sc0 sc1 lds
    s_add_u32 m0, s47, 134144
    s_nop 0
    buffer_load_dwordx4 v35, s[56:59], s31 offen lds
    s_lshr_b32 s3, s47, 2
    s_add_u32 m0, s3, 147456
    s_nop 0
    buffer_load_dwordx4 v38, s[8:11], 0 offen sc0 sc1 lds
    s_waitcnt lgkmcnt(3)
    v_mfma_f32_32x32x16_bf16 v[116:131], v[100:103], a[84:87], v[116:131]
    ds_read_b128 v[84:87], v11 offset:32768
    ds_read_b128 v[88:91], v11 offset:40960
    s_waitcnt lgkmcnt(4)
    v_mfma_f32_32x32x16_bf16 v[132:147], v[104:107], a[84:87], v[132:147]
    ds_read_b128 v[92:95], v20 offset:32768
    ds_read_b128 v[96:99], v20 offset:40960
    s_add_u32 m0, s18, 2048
    s_waitcnt lgkmcnt(5)
    v_mfma_f32_32x32x16_bf16 v[148:163], v[108:111], a[84:87], v[148:163]
    buffer_load_dwordx4 v9, s[8:11], s20 offen sc0 sc1 lds
    s_add_u32 m0, s18, 3072
    s_waitcnt lgkmcnt(4)
    v_mfma_f32_32x32x16_bf16 v[164:179], v[112:115], a[84:87], v[164:179]
    buffer_load_dwordx4 v10, s[8:11], s20 offen sc0 sc1 lds
    s_waitcnt lgkmcnt(3)
    v_mfma_f32_32x32x16_bf16 v[116:131], v[84:87], a[88:91], v[116:131]
    ds_read_b128 v[100:103], v12 offset:32768
    ds_read_b128 v[104:107], v12 offset:40960
    s_waitcnt lgkmcnt(4)
    v_mfma_f32_32x32x16_bf16 v[132:147], v[88:91], a[88:91], v[132:147]
    ds_read_b128 v[108:111], v21 offset:32768
    ds_read_b128 v[112:115], v21 offset:40960
    s_add_u32 s21, s20, 65536
    s_add_u32 m0, s18, 4096
    s_waitcnt lgkmcnt(5)
    v_mfma_f32_32x32x16_bf16 v[148:163], v[92:95], a[88:91], v[148:163]
    buffer_load_dwordx4 v7, s[8:11], s21 offen sc0 sc1 lds
    s_add_u32 m0, s18, 5120
    s_waitcnt lgkmcnt(4)
    v_mfma_f32_32x32x16_bf16 v[164:179], v[96:99], a[88:91], v[164:179]
    buffer_load_dwordx4 v8, s[8:11], s21 offen sc0 sc1 lds
    s_waitcnt lgkmcnt(0)
    s_waitcnt vmcnt(20)
    s_barrier
    v_mfma_f32_32x32x16_bf16 v[116:131], v[100:103], a[92:95], v[116:131]
    ds_read_b128 v[84:87], v13 offset:0
    ds_read_b128 v[88:91], v13 offset:8192
    v_mfma_f32_32x32x16_bf16 v[132:147], v[104:107], a[92:95], v[132:147]
    ds_read_b128 v[92:95], v22 offset:0
    ds_read_b128 v[96:99], v22 offset:8192
    s_add_u32 m0, s18, 6144
    v_mfma_f32_32x32x16_bf16 v[148:163], v[108:111], a[92:95], v[148:163]
    buffer_load_dwordx4 v9, s[8:11], s21 offen sc0 sc1 lds
    s_add_u32 m0, s18, 7168
    v_mfma_f32_32x32x16_bf16 v[164:179], v[112:115], a[92:95], v[164:179]
    buffer_load_dwordx4 v10, s[8:11], s21 offen sc0 sc1 lds
    s_waitcnt lgkmcnt(3)
    v_mfma_f32_32x32x16_bf16 v[116:131], v[84:87], a[96:99], v[116:131]
    ds_read_b128 v[100:103], v14 offset:0
    ds_read_b128 v[104:107], v14 offset:8192
    s_waitcnt lgkmcnt(4)
    v_mfma_f32_32x32x16_bf16 v[132:147], v[88:91], a[96:99], v[132:147]
    ds_read_b128 v[108:111], v23 offset:0
    ds_read_b128 v[112:115], v23 offset:8192
    s_bfe_u32 s17, s15, 0x40000
    s_lshl_b32 s17, s17, 8
    s_add_u32 s20, s16, s17
    s_add_u32 m0, s18, 32768
    s_waitcnt lgkmcnt(5)
    v_mfma_f32_32x32x16_bf16 v[148:163], v[92:95], a[96:99], v[148:163]
    buffer_load_dwordx4 v7, s[8:11], s20 offen sc0 sc1 lds
    s_add_u32 m0, s18, 33792
    s_waitcnt lgkmcnt(4)
    v_mfma_f32_32x32x16_bf16 v[164:179], v[96:99], a[96:99], v[164:179]
    buffer_load_dwordx4 v8, s[8:11], s20 offen sc0 sc1 lds
    s_waitcnt lgkmcnt(3)
    v_mfma_f32_32x32x16_bf16 v[116:131], v[100:103], a[100:103], v[116:131]
    ds_read_b128 v[84:87], v15 offset:0
    ds_read_b128 v[88:91], v15 offset:8192
    s_waitcnt lgkmcnt(4)
    v_mfma_f32_32x32x16_bf16 v[132:147], v[104:107], a[100:103], v[132:147]
    ds_read_b128 v[92:95], v24 offset:0
    ds_read_b128 v[96:99], v24 offset:8192
    s_add_u32 m0, s18, 34816
    s_waitcnt lgkmcnt(5)
    v_mfma_f32_32x32x16_bf16 v[148:163], v[108:111], a[100:103], v[148:163]
    buffer_load_dwordx4 v9, s[8:11], s20 offen sc0 sc1 lds
    s_add_u32 m0, s18, 35840
    s_waitcnt lgkmcnt(4)
    v_mfma_f32_32x32x16_bf16 v[164:179], v[112:115], a[100:103], v[164:179]
    buffer_load_dwordx4 v10, s[8:11], s20 offen sc0 sc1 lds
    s_waitcnt lgkmcnt(3)
    v_mfma_f32_32x32x16_bf16 v[116:131], v[84:87], a[104:107], v[116:131]
    ds_read_b128 v[100:103], v16 offset:0
    ds_read_b128 v[104:107], v16 offset:8192
    s_waitcnt lgkmcnt(4)
    v_mfma_f32_32x32x16_bf16 v[132:147], v[88:91], a[104:107], v[132:147]
    ds_read_b128 v[108:111], v25 offset:0
    ds_read_b128 v[112:115], v25 offset:8192
    s_add_u32 s21, s20, 65536
    s_add_u32 m0, s18, 36864
    s_waitcnt lgkmcnt(5)
    v_mfma_f32_32x32x16_bf16 v[148:163], v[92:95], a[104:107], v[148:163]
    buffer_load_dwordx4 v7, s[8:11], s21 offen sc0 sc1 lds
    s_add_u32 m0, s18, 37888
    s_waitcnt lgkmcnt(4)
    v_mfma_f32_32x32x16_bf16 v[164:179], v[96:99], a[104:107], v[164:179]
    buffer_load_dwordx4 v8, s[8:11], s21 offen sc0 sc1 lds
    s_waitcnt lgkmcnt(0)
    s_waitcnt vmcnt(19)
    s_barrier
    v_mfma_f32_32x32x16_bf16 v[116:131], v[100:103], a[108:111], v[116:131]
    ds_read_b128 v[84:87], v13 offset:32768
    ds_read_b128 v[88:91], v13 offset:40960
    v_mfma_f32_32x32x16_bf16 v[132:147], v[104:107], a[108:111], v[132:147]
    ds_read_b128 v[92:95], v22 offset:32768
    ds_read_b128 v[96:99], v22 offset:40960
    s_add_u32 m0, s18, 38912
    v_mfma_f32_32x32x16_bf16 v[148:163], v[108:111], a[108:111], v[148:163]
    buffer_load_dwordx4 v9, s[8:11], s21 offen sc0 sc1 lds
    s_add_u32 m0, s18, 39936
    v_mfma_f32_32x32x16_bf16 v[164:179], v[112:115], a[108:111], v[164:179]
    buffer_load_dwordx4 v10, s[8:11], s21 offen sc0 sc1 lds
    s_waitcnt lgkmcnt(3)
    v_mfma_f32_32x32x16_bf16 v[116:131], v[84:87], a[112:115], v[116:131]
    ds_read_b128 v[100:103], v14 offset:32768
    ds_read_b128 v[104:107], v14 offset:40960
    s_waitcnt vmcnt(14)
    ds_read_b128 v[46:49], v39 offset:0
    ds_read_b128 v[184:187], v39 offset:256
    s_waitcnt lgkmcnt(6)
    v_mfma_f32_32x32x16_bf16 v[132:147], v[88:91], a[112:115], v[132:147]
    ds_read_b128 v[108:111], v23 offset:32768
    ds_read_b128 v[112:115], v23 offset:40960
    s_bfe_u32 s17, s15, 0x40004
    s_lshl_b32 s17, s17, 8
    s_add_u32 s20, s16, s17
    s_add_u32 m0, s18, 65536
    s_waitcnt lgkmcnt(7)
    v_mfma_f32_32x32x16_bf16 v[148:163], v[92:95], a[112:115], v[148:163]
    buffer_load_dwordx4 v7, s[8:11], s20 offen sc0 sc1 lds
    ds_read_b128 v[50:53], v39 offset:32
    ds_read_b128 v[188:191], v39 offset:288
    ds_read_b128 v[54:57], v39 offset:64
    s_add_u32 m0, s18, 66560
    s_waitcnt lgkmcnt(9)
    v_mfma_f32_32x32x16_bf16 v[164:179], v[96:99], a[112:115], v[164:179]
    buffer_load_dwordx4 v8, s[8:11], s20 offen sc0 sc1 lds
    ds_read_b128 v[192:195], v39 offset:320
    ds_read_b128 v[58:61], v39 offset:96
    ds_read_b128 v[196:199], v39 offset:352
    ds_read_b128 v[66:69], v39 offset:128
    s_waitcnt lgkmcnt(12)
    v_mfma_f32_32x32x16_bf16 v[116:131], v[100:103], a[116:119], v[116:131]
    ds_read_b128 v[84:87], v15 offset:32768
    ds_read_b128 v[88:91], v15 offset:40960
    ds_read_b128 v[200:203], v39 offset:384
    ds_read_b128 v[70:73], v39 offset:160
    ds_read_b128 v[204:207], v39 offset:416
    s_waitcnt lgkmcnt(15)
    v_mfma_f32_32x32x16_bf16 v[132:147], v[104:107], a[116:119], v[132:147]
    ds_read_b128 v[92:95], v24 offset:32768
    ds_read_b128 v[96:99], v24 offset:40960
    ds_read_b128 v[74:77], v39 offset:192
    ds_read_b128 v[208:211], v39 offset:448
    s_add_u32 m0, s18, 67584
    s_waitcnt lgkmcnt(15)
    v_mfma_f32_32x32x16_bf16 v[148:163], v[108:111], a[116:119], v[148:163]
    buffer_load_dwordx4 v9, s[8:11], s20 offen sc0 sc1 lds
    ds_read_b128 v[78:81], v39 offset:224
    ds_read_b128 v[212:215], v39 offset:480
    buffer_load_dwordx2 v[30:31], v29, s[8:11], 0 offen sc0 sc1
    s_add_u32 m0, s18, 68608
    v_mfma_f32_32x32x16_bf16 v[164:179], v[112:115], a[116:119], v[164:179]
    buffer_load_dwordx4 v10, s[8:11], s20 offen sc0 sc1 lds
    s_waitcnt lgkmcnt(10)
    v_mfma_f32_32x32x16_bf16 v[116:131], v[84:87], a[120:123], v[116:131]
    ds_read_b128 v[100:103], v16 offset:32768
    ds_read_b128 v[104:107], v16 offset:40960
    s_waitcnt lgkmcnt(11)
    v_mfma_f32_32x32x16_bf16 v[132:147], v[88:91], a[120:123], v[132:147]
    ds_read_b128 v[108:111], v25 offset:32768
    ds_read_b128 v[112:115], v25 offset:40960
    s_add_u32 s21, s20, 65536
    s_add_u32 m0, s18, 69632
    s_waitcnt lgkmcnt(9)
    v_mfma_f32_32x32x16_bf16 v[148:163], v[92:95], a[120:123], v[148:163]
    buffer_load_dwordx4 v7, s[8:11], s21 offen sc0 sc1 lds
    s_add_u32 m0, s18, 70656
    s_waitcnt lgkmcnt(8)
    v_mfma_f32_32x32x16_bf16 v[164:179], v[96:99], a[120:123], v[164:179]
    buffer_load_dwordx4 v8, s[8:11], s21 offen sc0 sc1 lds
    s_waitcnt lgkmcnt(0)
    s_waitcnt vmcnt(15)
    s_barrier
    v_mfma_f32_32x32x16_bf16 v[116:131], v[100:103], a[124:127], v[116:131]
    ds_read_b128 v[84:87], v4 offset:0
    ds_read_b128 v[88:91], v4 offset:8192
    v_mfma_f32_32x32x16_bf16 v[132:147], v[104:107], a[124:127], v[132:147]
    ds_read_b128 v[92:95], v18 offset:0
    ds_read_b128 v[96:99], v18 offset:8192
    s_add_u32 m0, s18, 71680
    v_mfma_f32_32x32x16_bf16 v[148:163], v[108:111], a[124:127], v[148:163]
    buffer_load_dwordx4 v9, s[8:11], s21 offen sc0 sc1 lds
    s_add_u32 m0, s18, 72704
    v_mfma_f32_32x32x16_bf16 v[164:179], v[112:115], a[124:127], v[164:179]
    buffer_load_dwordx4 v10, s[8:11], s21 offen sc0 sc1 lds
    s_waitcnt lgkmcnt(3)
    v_mfma_f32_32x32x16_bf16 v[116:131], v[84:87], a[128:131], v[116:131]
    ds_read_b128 v[100:103], v5 offset:0
    ds_read_b128 v[104:107], v5 offset:8192
    s_waitcnt lgkmcnt(4)
    v_mfma_f32_32x32x16_bf16 v[132:147], v[88:91], a[128:131], v[132:147]
    ds_read_b128 v[108:111], v19 offset:0
    ds_read_b128 v[112:115], v19 offset:8192
    s_bfe_u32 s17, s15, 0x40008
    s_lshl_b32 s17, s17, 8
    s_add_u32 s20, s16, s17
    s_add_u32 m0, s18, 98304
    s_waitcnt lgkmcnt(5)
    v_mfma_f32_32x32x16_bf16 v[148:163], v[92:95], a[128:131], v[148:163]
    buffer_load_dwordx4 v7, s[8:11], s20 offen sc0 sc1 lds
    s_add_u32 m0, s18, 99328
    s_waitcnt lgkmcnt(4)
    v_mfma_f32_32x32x16_bf16 v[164:179], v[96:99], a[128:131], v[164:179]
    buffer_load_dwordx4 v8, s[8:11], s20 offen sc0 sc1 lds
    s_waitcnt lgkmcnt(3)
    v_mfma_f32_32x32x16_bf16 v[116:131], v[100:103], a[132:135], v[116:131]
    ds_read_b128 v[84:87], v11 offset:0
    ds_read_b128 v[88:91], v11 offset:8192
    s_waitcnt lgkmcnt(4)
    v_mfma_f32_32x32x16_bf16 v[132:147], v[104:107], a[132:135], v[132:147]
    ds_read_b128 v[92:95], v20 offset:0
    ds_read_b128 v[96:99], v20 offset:8192
    s_add_u32 m0, s18, 100352
    s_waitcnt lgkmcnt(5)
    v_mfma_f32_32x32x16_bf16 v[148:163], v[108:111], a[132:135], v[148:163]
    buffer_load_dwordx4 v9, s[8:11], s20 offen sc0 sc1 lds
    s_add_u32 m0, s18, 101376
    s_waitcnt lgkmcnt(4)
    v_mfma_f32_32x32x16_bf16 v[164:179], v[112:115], a[132:135], v[164:179]
    buffer_load_dwordx4 v10, s[8:11], s20 offen sc0 sc1 lds
    s_waitcnt lgkmcnt(3)
    v_mfma_f32_32x32x16_bf16 v[116:131], v[84:87], a[136:139], v[116:131]
    ds_read_b128 v[100:103], v12 offset:0
    ds_read_b128 v[104:107], v12 offset:8192
    s_waitcnt lgkmcnt(4)
    v_mfma_f32_32x32x16_bf16 v[132:147], v[88:91], a[136:139], v[132:147]
    ds_read_b128 v[108:111], v21 offset:0
    ds_read_b128 v[112:115], v21 offset:8192
    s_add_u32 s21, s20, 65536
    s_add_u32 m0, s18, 102400
    s_waitcnt lgkmcnt(5)
    v_mfma_f32_32x32x16_bf16 v[148:163], v[92:95], a[136:139], v[148:163]
    buffer_load_dwordx4 v7, s[8:11], s21 offen sc0 sc1 lds
    s_add_u32 m0, s18, 103424
    s_waitcnt lgkmcnt(4)
    v_mfma_f32_32x32x16_bf16 v[164:179], v[96:99], a[136:139], v[164:179]
    buffer_load_dwordx4 v8, s[8:11], s21 offen sc0 sc1 lds
    s_waitcnt lgkmcnt(0)
    s_waitcnt vmcnt(15)
    s_barrier
    v_mfma_f32_32x32x16_bf16 v[116:131], v[100:103], a[140:143], v[116:131]
    ds_read_b128 v[84:87], v4 offset:32768
    ds_read_b128 v[88:91], v4 offset:40960
    v_mfma_f32_32x32x16_bf16 v[132:147], v[104:107], a[140:143], v[132:147]
    ds_read_b128 v[92:95], v18 offset:32768
    ds_read_b128 v[96:99], v18 offset:40960
    s_add_u32 m0, s18, 104448
    v_mfma_f32_32x32x16_bf16 v[148:163], v[108:111], a[140:143], v[148:163]
    buffer_load_dwordx4 v9, s[8:11], s21 offen sc0 sc1 lds
    s_add_u32 m0, s18, 105472
    v_mfma_f32_32x32x16_bf16 v[164:179], v[112:115], a[140:143], v[164:179]
    buffer_load_dwordx4 v10, s[8:11], s21 offen sc0 sc1 lds
    s_waitcnt lgkmcnt(3)
    v_mfma_f32_32x32x16_bf16 v[116:131], v[84:87], a[144:147], v[116:131]
    ds_read_b128 v[100:103], v5 offset:32768
    ds_read_b128 v[104:107], v5 offset:40960
    s_mov_b32 s4, 0
    s_waitcnt vmcnt(13)
    v_cmp_ne_u64 vcc, s[42:43], v[30:31]
    s_nop 4
    s_cbranch_vccz Lfdone_gate_13
Lfpoll_gate_14:
    buffer_load_dwordx2 v[30:31], v29, s[8:11], 0 offen sc0 sc1
    s_waitcnt vmcnt(0)
    v_cmp_ne_u64 vcc, s[42:43], v[30:31]
    s_nop 4
    s_add_u32 s4, s4, 1
    s_cmp_gt_u32 s4, 20000
    s_cbranch_scc1 Lfdone_gate_13
    s_cbranch_vccnz Lfpoll_gate_14
Lfdone_gate_13:
    s_add_u32 m0, s47, 147456
    s_nop 0
    buffer_load_dwordx4 v7, s[8:11], s38 offen sc0 sc1 lds
    s_add_u32 m0, s47, 148480
    s_nop 0
    buffer_load_dwordx4 v8, s[8:11], s38 offen sc0 sc1 lds
    s_waitcnt lgkmcnt(4)
    v_mfma_f32_32x32x16_bf16 v[132:147], v[88:91], a[144:147], v[132:147]
    ds_read_b128 v[108:111], v19 offset:32768
    ds_read_b128 v[112:115], v19 offset:40960
    s_bfe_u32 s17, s15, 0x4000c
    s_lshl_b32 s17, s17, 8
    s_add_u32 s20, s16, s17
    s_add_u32 m0, s18, 0
    s_waitcnt lgkmcnt(5)
    v_mfma_f32_32x32x16_bf16 v[148:163], v[92:95], a[144:147], v[148:163]
    buffer_load_dwordx4 v7, s[8:11], s20 offen sc0 sc1 lds
    s_add_u32 m0, s47, 149504
    s_nop 0
    buffer_load_dwordx4 v9, s[8:11], s38 offen sc0 sc1 lds
    s_add_u32 m0, s47, 150528
    s_nop 0
    buffer_load_dwordx4 v10, s[8:11], s38 offen sc0 sc1 lds
    s_add_u32 m0, s18, 1024
    s_waitcnt lgkmcnt(4)
    v_mfma_f32_32x32x16_bf16 v[164:179], v[96:99], a[144:147], v[164:179]
    buffer_load_dwordx4 v8, s[8:11], s20 offen sc0 sc1 lds
    s_waitcnt lgkmcnt(3)
    v_mfma_f32_32x32x16_bf16 v[116:131], v[100:103], a[148:151], v[116:131]
    ds_read_b128 v[84:87], v11 offset:32768
    ds_read_b128 v[88:91], v11 offset:40960
    s_waitcnt lgkmcnt(4)
    v_mfma_f32_32x32x16_bf16 v[132:147], v[104:107], a[148:151], v[132:147]
    ds_read_b128 v[92:95], v20 offset:32768
    ds_read_b128 v[96:99], v20 offset:40960
    s_add_u32 m0, s18, 2048
    s_waitcnt lgkmcnt(5)
    v_mfma_f32_32x32x16_bf16 v[148:163], v[108:111], a[148:151], v[148:163]
    buffer_load_dwordx4 v9, s[8:11], s20 offen sc0 sc1 lds
    s_add_u32 m0, s18, 3072
    s_waitcnt lgkmcnt(4)
    v_mfma_f32_32x32x16_bf16 v[164:179], v[112:115], a[148:151], v[164:179]
    buffer_load_dwordx4 v10, s[8:11], s20 offen sc0 sc1 lds
    s_waitcnt lgkmcnt(3)
    v_mfma_f32_32x32x16_bf16 v[116:131], v[84:87], a[152:155], v[116:131]
    ds_read_b128 v[100:103], v12 offset:32768
    ds_read_b128 v[104:107], v12 offset:40960
    s_waitcnt lgkmcnt(4)
    v_mfma_f32_32x32x16_bf16 v[132:147], v[88:91], a[152:155], v[132:147]
    ds_read_b128 v[108:111], v21 offset:32768
    ds_read_b128 v[112:115], v21 offset:40960
    s_add_u32 s21, s20, 65536
    s_add_u32 m0, s18, 4096
    s_waitcnt lgkmcnt(5)
    v_mfma_f32_32x32x16_bf16 v[148:163], v[92:95], a[152:155], v[148:163]
    buffer_load_dwordx4 v7, s[8:11], s21 offen sc0 sc1 lds
    s_add_u32 m0, s18, 5120
    s_waitcnt lgkmcnt(4)
    v_mfma_f32_32x32x16_bf16 v[164:179], v[96:99], a[152:155], v[164:179]
    buffer_load_dwordx4 v8, s[8:11], s21 offen sc0 sc1 lds
    s_waitcnt lgkmcnt(0)
    s_waitcnt vmcnt(18)
    s_barrier
    v_mfma_f32_32x32x16_bf16 v[116:131], v[100:103], a[156:159], v[116:131]
    ds_read_b128 v[84:87], v13 offset:0
    ds_read_b128 v[88:91], v13 offset:8192
    v_mfma_f32_32x32x16_bf16 v[132:147], v[104:107], a[156:159], v[132:147]
    ds_read_b128 v[92:95], v22 offset:0
    ds_read_b128 v[96:99], v22 offset:8192
    s_add_u32 m0, s18, 6144
    v_mfma_f32_32x32x16_bf16 v[148:163], v[108:111], a[156:159], v[148:163]
    buffer_load_dwordx4 v9, s[8:11], s21 offen sc0 sc1 lds
    s_add_u32 m0, s18, 7168
    v_mfma_f32_32x32x16_bf16 v[164:179], v[112:115], a[156:159], v[164:179]
    buffer_load_dwordx4 v10, s[8:11], s21 offen sc0 sc1 lds
    s_waitcnt lgkmcnt(3)
    v_mfma_f32_32x32x16_bf16 v[116:131], v[84:87], a[160:163], v[116:131]
    ds_read_b128 v[100:103], v14 offset:0
    ds_read_b128 v[104:107], v14 offset:8192
    s_waitcnt lgkmcnt(4)
    v_mfma_f32_32x32x16_bf16 v[132:147], v[88:91], a[160:163], v[132:147]
    ds_read_b128 v[108:111], v23 offset:0
    ds_read_b128 v[112:115], v23 offset:8192
    s_bfe_u32 s17, s15, 0x40010
    s_lshl_b32 s17, s17, 8
    s_add_u32 s20, s16, s17
    s_add_u32 m0, s18, 32768
    s_waitcnt lgkmcnt(5)
    v_mfma_f32_32x32x16_bf16 v[148:163], v[92:95], a[160:163], v[148:163]
    buffer_load_dwordx4 v7, s[8:11], s20 offen sc0 sc1 lds
    s_add_u32 m0, s18, 33792
    s_waitcnt lgkmcnt(4)
    v_mfma_f32_32x32x16_bf16 v[164:179], v[96:99], a[160:163], v[164:179]
    buffer_load_dwordx4 v8, s[8:11], s20 offen sc0 sc1 lds
    s_waitcnt lgkmcnt(3)
    v_mfma_f32_32x32x16_bf16 v[116:131], v[100:103], a[164:167], v[116:131]
    ds_read_b128 v[84:87], v15 offset:0
    ds_read_b128 v[88:91], v15 offset:8192
    s_waitcnt lgkmcnt(4)
    v_mfma_f32_32x32x16_bf16 v[132:147], v[104:107], a[164:167], v[132:147]
    ds_read_b128 v[92:95], v24 offset:0
    ds_read_b128 v[96:99], v24 offset:8192
    s_add_u32 m0, s18, 34816
    s_waitcnt lgkmcnt(5)
    v_mfma_f32_32x32x16_bf16 v[148:163], v[108:111], a[164:167], v[148:163]
    buffer_load_dwordx4 v9, s[8:11], s20 offen sc0 sc1 lds
    s_add_u32 m0, s18, 35840
    s_waitcnt lgkmcnt(4)
    v_mfma_f32_32x32x16_bf16 v[164:179], v[112:115], a[164:167], v[164:179]
    buffer_load_dwordx4 v10, s[8:11], s20 offen sc0 sc1 lds
    s_waitcnt lgkmcnt(3)
    v_mfma_f32_32x32x16_bf16 v[116:131], v[84:87], a[168:171], v[116:131]
    ds_read_b128 v[100:103], v16 offset:0
    ds_read_b128 v[104:107], v16 offset:8192
    s_waitcnt lgkmcnt(4)
    v_mfma_f32_32x32x16_bf16 v[132:147], v[88:91], a[168:171], v[132:147]
    ds_read_b128 v[108:111], v25 offset:0
    ds_read_b128 v[112:115], v25 offset:8192
    s_add_u32 s21, s20, 65536
    s_add_u32 m0, s18, 36864
    s_waitcnt lgkmcnt(5)
    v_mfma_f32_32x32x16_bf16 v[148:163], v[92:95], a[168:171], v[148:163]
    buffer_load_dwordx4 v7, s[8:11], s21 offen sc0 sc1 lds
    s_add_u32 m0, s18, 37888
    s_waitcnt lgkmcnt(4)
    v_mfma_f32_32x32x16_bf16 v[164:179], v[96:99], a[168:171], v[164:179]
    buffer_load_dwordx4 v8, s[8:11], s21 offen sc0 sc1 lds
    s_waitcnt lgkmcnt(0)
    s_waitcnt vmcnt(18)
    s_barrier
    v_mfma_f32_32x32x16_bf16 v[116:131], v[100:103], a[172:175], v[116:131]
    ds_read_b128 v[84:87], v13 offset:32768
    ds_read_b128 v[88:91], v13 offset:40960
    v_mfma_f32_32x32x16_bf16 v[132:147], v[104:107], a[172:175], v[132:147]
    ds_read_b128 v[92:95], v22 offset:32768
    ds_read_b128 v[96:99], v22 offset:40960
    s_add_u32 m0, s18, 38912
    v_mfma_f32_32x32x16_bf16 v[148:163], v[108:111], a[172:175], v[148:163]
    buffer_load_dwordx4 v9, s[8:11], s21 offen sc0 sc1 lds
    s_add_u32 m0, s18, 39936
    v_mfma_f32_32x32x16_bf16 v[164:179], v[112:115], a[172:175], v[164:179]
    buffer_load_dwordx4 v10, s[8:11], s21 offen sc0 sc1 lds
    s_waitcnt lgkmcnt(3)
    v_mfma_f32_32x32x16_bf16 v[116:131], v[84:87], a[176:179], v[116:131]
    ds_read_b128 v[100:103], v14 offset:32768
    ds_read_b128 v[104:107], v14 offset:40960
    s_waitcnt lgkmcnt(4)
    v_mfma_f32_32x32x16_bf16 v[132:147], v[88:91], a[176:179], v[132:147]
    ds_read_b128 v[108:111], v23 offset:32768
    ds_read_b128 v[112:115], v23 offset:40960
    s_bfe_u32 s17, s15, 0x40014
    s_lshl_b32 s17, s17, 8
    s_add_u32 s20, s16, s17
    s_add_u32 m0, s18, 65536
    s_waitcnt lgkmcnt(5)
    v_mfma_f32_32x32x16_bf16 v[148:163], v[92:95], a[176:179], v[148:163]
    buffer_load_dwordx4 v7, s[8:11], s20 offen sc0 sc1 lds
    s_add_u32 m0, s18, 66560
    s_waitcnt lgkmcnt(4)
    v_mfma_f32_32x32x16_bf16 v[164:179], v[96:99], a[176:179], v[164:179]
    buffer_load_dwordx4 v8, s[8:11], s20 offen sc0 sc1 lds
    s_waitcnt lgkmcnt(3)
    v_mfma_f32_32x32x16_bf16 v[116:131], v[100:103], a[180:183], v[116:131]
    ds_read_b128 v[84:87], v15 offset:32768
    ds_read_b128 v[88:91], v15 offset:40960
    s_waitcnt lgkmcnt(4)
    v_mfma_f32_32x32x16_bf16 v[132:147], v[104:107], a[180:183], v[132:147]
    ds_read_b128 v[92:95], v24 offset:32768
    ds_read_b128 v[96:99], v24 offset:40960
    s_add_u32 m0, s18, 67584
    s_waitcnt lgkmcnt(5)
    v_mfma_f32_32x32x16_bf16 v[148:163], v[108:111], a[180:183], v[148:163]
    buffer_load_dwordx4 v9, s[8:11], s20 offen sc0 sc1 lds
    s_add_u32 m0, s18, 68608
    s_waitcnt lgkmcnt(4)
    v_mfma_f32_32x32x16_bf16 v[164:179], v[112:115], a[180:183], v[164:179]
    buffer_load_dwordx4 v10, s[8:11], s20 offen sc0 sc1 lds
    s_waitcnt lgkmcnt(3)
    v_mfma_f32_32x32x16_bf16 v[116:131], v[84:87], a[184:187], v[116:131]
    ds_read_b128 v[100:103], v16 offset:32768
    ds_read_b128 v[104:107], v16 offset:40960
    s_waitcnt lgkmcnt(4)
    v_mfma_f32_32x32x16_bf16 v[132:147], v[88:91], a[184:187], v[132:147]
    ds_read_b128 v[108:111], v25 offset:32768
    ds_read_b128 v[112:115], v25 offset:40960
    s_add_u32 s21, s20, 65536
    s_add_u32 m0, s18, 69632
    s_waitcnt lgkmcnt(5)
    v_mfma_f32_32x32x16_bf16 v[148:163], v[92:95], a[184:187], v[148:163]
    buffer_load_dwordx4 v7, s[8:11], s21 offen sc0 sc1 lds
    s_add_u32 m0, s18, 70656
    s_waitcnt lgkmcnt(4)
    v_mfma_f32_32x32x16_bf16 v[164:179], v[96:99], a[184:187], v[164:179]
    buffer_load_dwordx4 v8, s[8:11], s21 offen sc0 sc1 lds
    s_waitcnt lgkmcnt(0)
    s_waitcnt vmcnt(14)
    s_barrier
    v_mfma_f32_32x32x16_bf16 v[116:131], v[100:103], a[188:191], v[116:131]
    ds_read_b128 v[84:87], v4 offset:0
    ds_read_b128 v[88:91], v4 offset:8192
    v_mfma_f32_32x32x16_bf16 v[132:147], v[104:107], a[188:191], v[132:147]
    ds_read_b128 v[92:95], v18 offset:0
    ds_read_b128 v[96:99], v18 offset:8192
    s_add_u32 m0, s18, 71680
    v_mfma_f32_32x32x16_bf16 v[148:163], v[108:111], a[188:191], v[148:163]
    buffer_load_dwordx4 v9, s[8:11], s21 offen sc0 sc1 lds
    s_add_u32 m0, s18, 72704
    v_mfma_f32_32x32x16_bf16 v[164:179], v[112:115], a[188:191], v[164:179]
    buffer_load_dwordx4 v10, s[8:11], s21 offen sc0 sc1 lds
    s_waitcnt lgkmcnt(3)
    v_mfma_f32_32x32x16_bf16 v[116:131], v[84:87], a[192:195], v[116:131]
    ds_read_b128 v[100:103], v5 offset:0
    ds_read_b128 v[104:107], v5 offset:8192
    v_lshlrev_b32 v65, 16, v65
    ds_read_b64_tr_b16 v[26:27], v36 offset:0
    v_xor_b32 v1, 0, v37
    s_waitcnt lgkmcnt(5)
    v_mfma_f32_32x32x16_bf16 v[132:147], v[88:91], a[192:195], v[132:147]
    ds_read_b128 v[108:111], v19 offset:0
    ds_read_b128 v[112:115], v19 offset:8192
    s_bfe_u32 s17, s15, 0x40018
    s_lshl_b32 s17, s17, 8
    s_add_u32 s20, s16, s17
    s_add_u32 m0, s18, 98304
    s_waitcnt lgkmcnt(6)
    v_mfma_f32_32x32x16_bf16 v[148:163], v[92:95], a[192:195], v[148:163]
    buffer_load_dwordx4 v7, s[8:11], s20 offen sc0 sc1 lds
    ds_read_b64 v[62:63], v1
    s_waitcnt lgkmcnt(0)
    v_lshlrev_b32 v216, 16, v62
    v_lshlrev_b32 v220, 16, v26
    s_add_u32 m0, s18, 99328
    v_mfma_f32_32x32x16_bf16 v[164:179], v[96:99], a[192:195], v[164:179]
    buffer_load_dwordx4 v8, s[8:11], s20 offen sc0 sc1 lds
    v_and_b32 v217, s5, v62
    v_and_b32 v221, s5, v26
    v_lshlrev_b32 v218, 16, v63
    v_lshlrev_b32 v222, 16, v27
    v_mfma_f32_32x32x16_bf16 v[116:131], v[100:103], a[196:199], v[116:131]
    ds_read_b128 v[84:87], v11 offset:0
    ds_read_b128 v[88:91], v11 offset:8192
    v_and_b32 v219, s5, v63
    v_and_b32 v223, s5, v27
    ds_read_b64_tr_b16 v[32:33], v36 offset:1024
    v_mfma_f32_32x32x16_bf16 v[132:147], v[104:107], a[196:199], v[132:147]
    ds_read_b128 v[92:95], v20 offset:0
    ds_read_b128 v[96:99], v20 offset:8192
    v_xor_b32 v1, 16, v37
    ds_read_b64 v[180:181], v1
    s_add_u32 m0, s18, 100352
    v_mfma_f32_32x32x16_bf16 v[148:163], v[108:111], a[196:199], v[148:163]
    buffer_load_dwordx4 v9, s[8:11], s20 offen sc0 sc1 lds
    v_mul_f32 v184, v184, v216
    v_mul_f32 v185, v185, v217
    v_mul_f32 v186, v186, v218
    s_add_u32 m0, s18, 101376
    v_mfma_f32_32x32x16_bf16 v[164:179], v[112:115], a[196:199], v[164:179]
    buffer_load_dwordx4 v10, s[8:11], s20 offen sc0 sc1 lds
    v_mul_f32 v187, v187, v219
    v_fmac_f32 v184, v46, v65
    v_fmac_f32 v185, v47, v65
    v_fmac_f32 v186, v48, v65
    s_waitcnt lgkmcnt(5)
    v_mfma_f32_32x32x16_bf16 v[116:131], v[84:87], a[200:203], v[116:131]
    ds_read_b128 v[100:103], v12 offset:0
    ds_read_b128 v[104:107], v12 offset:8192
    v_fmac_f32 v187, v49, v65
    v_mul_f32 v184, v184, v220
    v_mul_f32 v185, v185, v221
    s_waitcnt lgkmcnt(6)
    v_mfma_f32_32x32x16_bf16 v[132:147], v[88:91], a[200:203], v[132:147]
    ds_read_b128 v[108:111], v21 offset:0
    ds_read_b128 v[112:115], v21 offset:8192
    v_mul_f32 v186, v186, v222
    s_add_u32 s21, s20, 65536
    s_add_u32 m0, s18, 102400
    s_waitcnt lgkmcnt(6)
    v_mfma_f32_32x32x16_bf16 v[148:163], v[92:95], a[200:203], v[148:163]
    buffer_load_dwordx4 v7, s[8:11], s21 offen sc0 sc1 lds
    v_mul_f32 v187, v187, v223
    s_waitcnt lgkmcnt(4)
    v_lshlrev_b32 v216, 16, v180
    v_lshlrev_b32 v220, 16, v32
    s_add_u32 m0, s18, 103424
    v_mfma_f32_32x32x16_bf16 v[164:179], v[96:99], a[200:203], v[164:179]
    buffer_load_dwordx4 v8, s[8:11], s21 offen sc0 sc1 lds
    v_and_b32 v217, s5, v180
    v_and_b32 v221, s5, v32
    v_lshlrev_b32 v218, 16, v181
    v_lshlrev_b32 v222, 16, v33
    s_waitcnt lgkmcnt(0)
    s_waitcnt vmcnt(14)
    s_barrier
    v_mfma_f32_32x32x16_bf16 v[116:131], v[100:103], a[204:207], v[116:131]
    ds_read_b128 v[84:87], v4 offset:32768
    ds_read_b128 v[88:91], v4 offset:40960
    v_and_b32 v219, s5, v181
    v_and_b32 v223, s5, v33
    ds_read_b64_tr_b16 v[26:27], v36 offset:2048
    v_mfma_f32_32x32x16_bf16 v[132:147], v[104:107], a[204:207], v[132:147]
    ds_read_b128 v[92:95], v18 offset:32768
    ds_read_b128 v[96:99], v18 offset:40960
    v_xor_b32 v1, 32, v37
    ds_read_b64 v[62:63], v1
    s_add_u32 m0, s18, 104448
    v_mfma_f32_32x32x16_bf16 v[148:163], v[108:111], a[204:207], v[148:163]
    buffer_load_dwordx4 v9, s[8:11], s21 offen sc0 sc1 lds
    v_mul_f32 v188, v188, v216
    v_mul_f32 v189, v189, v217
    v_mul_f32 v190, v190, v218
    s_add_u32 m0, s18, 105472
    v_mfma_f32_32x32x16_bf16 v[164:179], v[112:115], a[204:207], v[164:179]
    buffer_load_dwordx4 v10, s[8:11], s21 offen sc0 sc1 lds
    v_mul_f32 v191, v191, v219
    v_fmac_f32 v188, v50, v65
    v_fmac_f32 v189, v51, v65
    v_fmac_f32 v190, v52, v65
    s_waitcnt lgkmcnt(5)
    v_mfma_f32_32x32x16_bf16 v[116:131], v[84:87], a[208:211], v[116:131]
    ds_read_b128 v[100:103], v5 offset:32768
    ds_read_b128 v[104:107], v5 offset:40960
    v_fmac_f32 v191, v53, v65
    v_mul_f32 v188, v188, v220
    v_mul_f32 v189, v189, v221
    s_waitcnt lgkmcnt(6)
    v_mfma_f32_32x32x16_bf16 v[132:147], v[88:91], a[208:211], v[132:147]
    ds_read_b128 v[108:111], v19 offset:32768
    ds_read_b128 v[112:115], v19 offset:40960
    v_mul_f32 v190, v190, v222
    v_mul_f32 v191, v191, v223
    s_waitcnt lgkmcnt(4)
    v_lshlrev_b32 v216, 16, v62
    v_mfma_f32_32x32x16_bf16 v[148:163], v[92:95], a[208:211], v[148:163]
    v_lshlrev_b32 v220, 16, v26
    v_and_b32 v217, s5, v62
    v_and_b32 v221, s5, v26
    v_lshlrev_b32 v218, 16, v63
    v_lshlrev_b32 v222, 16, v27
    v_mfma_f32_32x32x16_bf16 v[164:179], v[96:99], a[208:211], v[164:179]
    v_and_b32 v219, s5, v63
    v_and_b32 v223, s5, v27
    ds_read_b64_tr_b16 v[32:33], v36 offset:3072
    v_xor_b32 v1, 48, v37
    ds_read_b64 v[180:181], v1
    s_waitcnt lgkmcnt(5)
    v_mfma_f32_32x32x16_bf16 v[116:131], v[100:103], a[212:215], v[116:131]
    ds_read_b128 v[84:87], v11 offset:32768
    ds_read_b128 v[88:91], v11 offset:40960
    v_mul_f32 v192, v192, v216
    v_mul_f32 v193, v193, v217
    v_mul_f32 v194, v194, v218
    s_waitcnt lgkmcnt(6)
    v_mfma_f32_32x32x16_bf16 v[132:147], v[104:107], a[212:215], v[132:147]
    ds_read_b128 v[92:95], v20 offset:32768
    ds_read_b128 v[96:99], v20 offset:40960
    v_mul_f32 v195, v195, v219
    v_fmac_f32 v192, v54, v65
    v_fmac_f32 v193, v55, v65
    s_waitcnt lgkmcnt(7)
    v_mfma_f32_32x32x16_bf16 v[148:163], v[108:111], a[212:215], v[148:163]
    v_fmac_f32 v194, v56, v65
    v_fmac_f32 v195, v57, v65
    v_mul_f32 v192, v192, v220
    v_mul_f32 v193, v193, v221
    v_mul_f32 v194, v194, v222
    s_waitcnt lgkmcnt(6)
    v_mfma_f32_32x32x16_bf16 v[164:179], v[112:115], a[212:215], v[164:179]
    v_mul_f32 v195, v195, v223
    s_waitcnt lgkmcnt(4)
    v_lshlrev_b32 v216, 16, v180
    v_lshlrev_b32 v220, 16, v32
    v_and_b32 v217, s5, v180
    v_and_b32 v221, s5, v32
    s_waitcnt lgkmcnt(3)
    v_mfma_f32_32x32x16_bf16 v[116:131], v[84:87], a[216:219], v[116:131]
    ds_read_b128 v[100:103], v12 offset:32768
    ds_read_b128 v[104:107], v12 offset:40960
    v_lshlrev_b32 v218, 16, v181
    v_lshlrev_b32 v222, 16, v33
    v_and_b32 v219, s5, v181
    s_waitcnt lgkmcnt(4)
    v_mfma_f32_32x32x16_bf16 v[132:147], v[88:91], a[216:219], v[132:147]
    ds_read_b128 v[108:111], v21 offset:32768
    ds_read_b128 v[112:115], v21 offset:40960
    v_and_b32 v223, s5, v33
    ds_read_b64_tr_b16 v[26:27], v36 offset:4096
    v_xor_b32 v1, 64, v37
    s_waitcnt lgkmcnt(6)
    v_mfma_f32_32x32x16_bf16 v[148:163], v[92:95], a[216:219], v[148:163]
    ds_read_b64 v[62:63], v1
    v_mul_f32 v196, v196, v216
    v_mul_f32 v197, v197, v217
    v_mul_f32 v198, v198, v218
    v_mul_f32 v199, v199, v219
    s_waitcnt lgkmcnt(6)
    v_mfma_f32_32x32x16_bf16 v[164:179], v[96:99], a[216:219], v[164:179]
    v_fmac_f32 v196, v58, v65
    v_fmac_f32 v197, v59, v65
    v_fmac_f32 v198, v60, v65
    v_fmac_f32 v199, v61, v65
    v_mul_f32 v196, v196, v220
    s_waitcnt lgkmcnt(2)
    s_waitcnt vmcnt(8)
    s_barrier
    v_mfma_f32_32x32x16_bf16 v[116:131], v[100:103], a[220:223], v[116:131]
    ds_read_b128 v[84:87], v13 offset:0
    ds_read_b128 v[88:91], v13 offset:8192
    v_mul_f32 v197, v197, v221
    v_mul_f32 v198, v198, v222
    v_mul_f32 v199, v199, v223
    v_mfma_f32_32x32x16_bf16 v[132:147], v[104:107], a[220:223], v[132:147]
    ds_read_b128 v[92:95], v22 offset:0
    ds_read_b128 v[96:99], v22 offset:8192
    s_waitcnt lgkmcnt(4)
    v_lshlrev_b32 v216, 16, v62
    v_lshlrev_b32 v220, 16, v26
    v_and_b32 v217, s5, v62
    v_mfma_f32_32x32x16_bf16 v[148:163], v[108:111], a[220:223], v[148:163]
    v_and_b32 v221, s5, v26
    v_lshlrev_b32 v218, 16, v63
    v_lshlrev_b32 v222, 16, v27
    v_and_b32 v219, s5, v63
    v_and_b32 v223, s5, v27
    v_mfma_f32_32x32x16_bf16 v[164:179], v[112:115], a[220:223], v[164:179]
    ds_read_b64_tr_b16 v[32:33], v36 offset:5120
    v_xor_b32 v1, 80, v37
    ds_read_b64 v[180:181], v1
    v_mul_f32 v200, v200, v216
    v_mul_f32 v201, v201, v217
    s_waitcnt lgkmcnt(5)
    v_mfma_f32_32x32x16_bf16 v[116:131], v[84:87], a[224:227], v[116:131]
    ds_read_b128 v[100:103], v14 offset:0
    ds_read_b128 v[104:107], v14 offset:8192
    v_mul_f32 v202, v202, v218
    v_mul_f32 v203, v203, v219
    v_fmac_f32 v200, v66, v65
    s_waitcnt lgkmcnt(6)
    v_mfma_f32_32x32x16_bf16 v[132:147], v[88:91], a[224:227], v[132:147]
    ds_read_b128 v[108:111], v23 offset:0
    ds_read_b128 v[112:115], v23 offset:8192
    v_fmac_f32 v201, v67, v65
    v_fmac_f32 v202, v68, v65
    v_fmac_f32 v203, v69, v65
    s_waitcnt lgkmcnt(7)
    v_mfma_f32_32x32x16_bf16 v[148:163], v[92:95], a[224:227], v[148:163]
    v_mul_f32 v200, v200, v220
    v_mul_f32 v201, v201, v221
    v_mul_f32 v202, v202, v222
    v_mul_f32 v203, v203, v223
    s_waitcnt lgkmcnt(4)
    v_lshlrev_b32 v216, 16, v180
    v_mfma_f32_32x32x16_bf16 v[164:179], v[96:99], a[224:227], v[164:179]
    v_lshlrev_b32 v220, 16, v32
    v_and_b32 v217, s5, v180
    v_and_b32 v221, s5, v32
    v_lshlrev_b32 v218, 16, v181
    v_lshlrev_b32 v222, 16, v33
    s_waitcnt lgkmcnt(3)
    v_mfma_f32_32x32x16_bf16 v[116:131], v[100:103], a[228:231], v[116:131]
    ds_read_b128 v[84:87], v15 offset:0
    ds_read_b128 v[88:91], v15 offset:8192
    v_and_b32 v219, s5, v181
    v_and_b32 v223, s5, v33
    ds_read_b64_tr_b16 v[26:27], v36 offset:6144
    s_waitcnt lgkmcnt(5)
    v_mfma_f32_32x32x16_bf16 v[132:147], v[104:107], a[228:231], v[132:147]
    ds_read_b128 v[92:95], v24 offset:0
    ds_read_b128 v[96:99], v24 offset:8192
    v_xor_b32 v1, 96, v37
    ds_read_b64 v[62:63], v1
    v_mul_f32 v204, v204, v216
    s_waitcnt lgkmcnt(7)
    v_mfma_f32_32x32x16_bf16 v[148:163], v[108:111], a[228:231], v[148:163]
    v_mul_f32 v205, v205, v217
    v_mul_f32 v206, v206, v218
    v_mul_f32 v207, v207, v219
    v_fmac_f32 v204, v70, v65
    v_fmac_f32 v205, v71, v65
    s_waitcnt lgkmcnt(6)
    v_mfma_f32_32x32x16_bf16 v[164:179], v[112:115], a[228:231], v[164:179]
    v_fmac_f32 v206, v72, v65
    v_fmac_f32 v207, v73, v65
    v_mul_f32 v204, v204, v220
    v_mul_f32 v205, v205, v221
    v_mul_f32 v206, v206, v222
    s_waitcnt lgkmcnt(5)
    v_mfma_f32_32x32x16_bf16 v[116:131], v[84:87], a[232:235], v[116:131]
    ds_read_b128 v[100:103], v16 offset:0
    ds_read_b128 v[104:107], v16 offset:8192
    v_mul_f32 v207, v207, v223
    s_waitcnt lgkmcnt(2)
    v_lshlrev_b32 v216, 16, v62
    v_lshlrev_b32 v220, 16, v26
    v_mfma_f32_32x32x16_bf16 v[132:147], v[88:91], a[232:235], v[132:147]
    ds_read_b128 v[108:111], v25 offset:0
    ds_read_b128 v[112:115], v25 offset:8192
    v_and_b32 v217, s5, v62
    v_and_b32 v221, s5, v26
    v_lshlrev_b32 v218, 16, v63
    v_mfma_f32_32x32x16_bf16 v[148:163], v[92:95], a[232:235], v[148:163]
    v_lshlrev_b32 v222, 16, v27
    v_and_b32 v219, s5, v63
    v_and_b32 v223, s5, v27
    ds_read_b64_tr_b16 v[32:33], v36 offset:7168
    v_xor_b32 v1, 112, v37
    v_mfma_f32_32x32x16_bf16 v[164:179], v[96:99], a[232:235], v[164:179]
    ds_read_b64 v[180:181], v1
    v_mul_f32 v208, v208, v216
    v_mul_f32 v209, v209, v217
    v_mul_f32 v210, v210, v218
    v_mul_f32 v211, v211, v219
    s_waitcnt lgkmcnt(2)
    s_waitcnt vmcnt(0)
    s_barrier
    v_mfma_f32_32x32x16_bf16 v[116:131], v[100:103], a[236:239], v[116:131]
    ds_read_b128 v[84:87], v22 offset:32768
    ds_read_b128 v[88:91], v22 offset:40960
    v_fmac_f32 v208, v74, v65
    v_fmac_f32 v209, v75, v65
    v_fmac_f32 v210, v76, v65
    v_mfma_f32_32x32x16_bf16 v[132:147], v[104:107], a[236:239], v[132:147]
    ds_read_b128 v[92:95], v23 offset:32768
    ds_read_b128 v[96:99], v23 offset:40960
    v_fmac_f32 v211, v77, v65
    v_mul_f32 v208, v208, v220
    v_mul_f32 v209, v209, v221
    v_mfma_f32_32x32x16_bf16 v[148:163], v[108:111], a[236:239], v[148:163]
    v_mul_f32 v210, v210, v222
    v_mul_f32 v211, v211, v223
    s_waitcnt lgkmcnt(4)
    v_lshlrev_b32 v216, 16, v180
    v_lshlrev_b32 v220, 16, v32
    v_and_b32 v217, s5, v180
    v_mfma_f32_32x32x16_bf16 v[164:179], v[112:115], a[236:239], v[164:179]
    v_and_b32 v221, s5, v32
    v_lshlrev_b32 v218, 16, v181
    v_lshlrev_b32 v222, 16, v33
    v_and_b32 v219, s5, v181
    v_and_b32 v223, s5, v33
    s_waitcnt lgkmcnt(3)
    v_mfma_f32_32x32x16_bf16 v[148:163], v[84:87], a[240:243], v[148:163]
    ds_read_b128 v[100:103], v24 offset:32768
    ds_read_b128 v[104:107], v24 offset:40960
    v_mul_f32 v212, v212, v216
    v_mul_f32 v213, v213, v217
    v_mul_f32 v214, v214, v218
    s_waitcnt lgkmcnt(4)
    v_mfma_f32_32x32x16_bf16 v[164:179], v[88:91], a[240:243], v[164:179]
    ds_read_b128 v[108:111], v25 offset:32768
    ds_read_b128 v[112:115], v25 offset:40960
    v_mul_f32 v215, v215, v219
    v_fmac_f32 v212, v78, v65
    v_fmac_f32 v213, v79, v65
    s_waitcnt lgkmcnt(5)
    v_mfma_f32_32x32x16_bf16 v[148:163], v[92:95], a[244:247], v[148:163]
    v_fmac_f32 v214, v80, v65
    v_fmac_f32 v215, v81, v65
    v_mul_f32 v212, v212, v220
    v_mul_f32 v213, v213, v221
    v_mul_f32 v214, v214, v222
    s_waitcnt lgkmcnt(4)
    v_mfma_f32_32x32x16_bf16 v[164:179], v[96:99], a[244:247], v[164:179]
    v_mul_f32 v215, v215, v223
    s_waitcnt lgkmcnt(3)
    v_mfma_f32_32x32x16_bf16 v[148:163], v[100:103], a[248:251], v[148:163]
    ds_read_b128 v[84:87], v13 offset:32768
    ds_read_b128 v[88:91], v13 offset:40960
    s_waitcnt lgkmcnt(4)
    v_mfma_f32_32x32x16_bf16 v[164:179], v[104:107], a[248:251], v[164:179]
    ds_read_b128 v[92:95], v14 offset:32768
    ds_read_b128 v[96:99], v14 offset:40960
    s_waitcnt lgkmcnt(5)
    v_mfma_f32_32x32x16_bf16 v[148:163], v[108:111], a[252:255], v[148:163]
    s_waitcnt lgkmcnt(4)
    v_mfma_f32_32x32x16_bf16 v[164:179], v[112:115], a[252:255], v[164:179]
    s_waitcnt lgkmcnt(3)
    v_mfma_f32_32x32x16_bf16 v[116:131], v[84:87], a[240:243], v[116:131]
    ds_read_b128 v[100:103], v15 offset:32768
    ds_read_b128 v[104:107], v15 offset:40960
    s_nop 5
    ds_write_b128 v44, v[148:151] offset:0
    s_waitcnt lgkmcnt(5)
    v_mfma_f32_32x32x16_bf16 v[132:147], v[88:91], a[240:243], v[132:147]
    ds_read_b128 v[108:111], v16 offset:32768
    ds_read_b128 v[112:115], v16 offset:40960
    ds_write_b128 v44, v[152:155] offset:1024
    s_waitcnt lgkmcnt(7)
    v_mfma_f32_32x32x16_bf16 v[116:131], v[92:95], a[244:247], v[116:131]
    ds_write_b128 v44, v[156:159] offset:2048
    s_waitcnt lgkmcnt(7)
    v_mfma_f32_32x32x16_bf16 v[132:147], v[96:99], a[244:247], v[132:147]
    ds_write_b128 v44, v[160:163] offset:3072
    s_waitcnt lgkmcnt(3)
    v_mfma_f32_32x32x16_bf16 v[116:131], v[100:103], a[248:251], v[116:131]
    ds_write_b128 v44, v[164:167] offset:4096
    v_mfma_f32_32x32x16_bf16 v[132:147], v[104:107], a[248:251], v[132:147]
    ds_write_b128 v44, v[168:171] offset:5120
    v_mfma_f32_32x32x16_bf16 v[116:131], v[108:111], a[252:255], v[116:131]
    ds_write_b128 v44, v[172:175] offset:6144
    v_mfma_f32_32x32x16_bf16 v[132:147], v[112:115], a[252:255], v[132:147]
    ds_write_b128 v44, v[176:179] offset:7168
    s_waitcnt lgkmcnt(0)
    s_barrier
    ds_read_b128 v[84:87], v45 offset:0
    ds_read_b128 v[88:91], v45 offset:1024
    ds_read_b128 v[92:95], v45 offset:2048
    ds_read_b128 v[96:99], v45 offset:3072
    ds_read_b128 v[100:103], v45 offset:4096
    ds_read_b128 v[104:107], v45 offset:5120
    ds_read_b128 v[108:111], v45 offset:6144
    ds_read_b128 v[112:115], v45 offset:7168
    s_waitcnt lgkmcnt(7)
    v_add_f32 v116, v116, v84
    v_add_f32 v117, v117, v85
    v_add_f32 v118, v118, v86
    v_add_f32 v119, v119, v87
    v_fma_f32 v116, v46, v116, v184
    v_fma_f32 v117, v47, v117, v185
    v_fma_f32 v118, v48, v118, v186
    v_fma_f32 v119, v49, v119, v187
    buffer_store_dword v116, v40, s[32:35], s39 offen
    buffer_store_dword v117, v41, s[32:35], s39 offen
    buffer_store_dword v118, v42, s[32:35], s39 offen
    buffer_store_dword v119, v43, s[32:35], s39 offen
    s_waitcnt lgkmcnt(6)
    v_add_f32 v120, v120, v88
    v_add_f32 v121, v121, v89
    v_add_f32 v122, v122, v90
    v_add_f32 v123, v123, v91
    v_fma_f32 v120, v50, v120, v188
    v_fma_f32 v121, v51, v121, v189
    v_fma_f32 v122, v52, v122, v190
    v_fma_f32 v123, v53, v123, v191
    s_add_u32 s39, s39, 32768
    buffer_store_dword v120, v40, s[32:35], s39 offen
    buffer_store_dword v121, v41, s[32:35], s39 offen
    buffer_store_dword v122, v42, s[32:35], s39 offen
    buffer_store_dword v123, v43, s[32:35], s39 offen
    s_waitcnt lgkmcnt(5)
    v_add_f32 v124, v124, v92
    v_add_f32 v125, v125, v93
    v_add_f32 v126, v126, v94
    v_add_f32 v127, v127, v95
    v_fma_f32 v124, v54, v124, v192
    v_fma_f32 v125, v55, v125, v193
    v_fma_f32 v126, v56, v126, v194
    v_fma_f32 v127, v57, v127, v195
    s_add_u32 s39, s39, 32768
    buffer_store_dword v124, v40, s[32:35], s39 offen
    buffer_store_dword v125, v41, s[32:35], s39 offen
    buffer_store_dword v126, v42, s[32:35], s39 offen
    buffer_store_dword v127, v43, s[32:35], s39 offen
    s_waitcnt lgkmcnt(4)
    v_add_f32 v128, v128, v96
    v_add_f32 v129, v129, v97
    v_add_f32 v130, v130, v98
    v_add_f32 v131, v131, v99
    v_fma_f32 v128, v58, v128, v196
    v_fma_f32 v129, v59, v129, v197
    v_fma_f32 v130, v60, v130, v198
    v_fma_f32 v131, v61, v131, v199
    s_add_u32 s39, s39, 32768
    buffer_store_dword v128, v40, s[32:35], s39 offen
    buffer_store_dword v129, v41, s[32:35], s39 offen
    buffer_store_dword v130, v42, s[32:35], s39 offen
    buffer_store_dword v131, v43, s[32:35], s39 offen
    s_waitcnt lgkmcnt(3)
    v_add_f32 v132, v132, v100
    v_add_f32 v133, v133, v101
    v_add_f32 v134, v134, v102
    v_add_f32 v135, v135, v103
    v_fma_f32 v132, v66, v132, v200
    v_fma_f32 v133, v67, v133, v201
    v_fma_f32 v134, v68, v134, v202
    v_fma_f32 v135, v69, v135, v203
    s_add_u32 s39, s39, 32768
    buffer_store_dword v132, v40, s[32:35], s39 offen
    buffer_store_dword v133, v41, s[32:35], s39 offen
    buffer_store_dword v134, v42, s[32:35], s39 offen
    buffer_store_dword v135, v43, s[32:35], s39 offen
    s_waitcnt lgkmcnt(2)
    v_add_f32 v136, v136, v104
    v_add_f32 v137, v137, v105
    v_add_f32 v138, v138, v106
    v_add_f32 v139, v139, v107
    v_fma_f32 v136, v70, v136, v204
    v_fma_f32 v137, v71, v137, v205
    v_fma_f32 v138, v72, v138, v206
    v_fma_f32 v139, v73, v139, v207
    s_add_u32 s39, s39, 32768
    buffer_store_dword v136, v40, s[32:35], s39 offen
    buffer_store_dword v137, v41, s[32:35], s39 offen
    buffer_store_dword v138, v42, s[32:35], s39 offen
    buffer_store_dword v139, v43, s[32:35], s39 offen
    s_waitcnt lgkmcnt(1)
    v_add_f32 v140, v140, v108
    v_add_f32 v141, v141, v109
    v_add_f32 v142, v142, v110
    v_add_f32 v143, v143, v111
    v_fma_f32 v140, v74, v140, v208
    v_fma_f32 v141, v75, v141, v209
    v_fma_f32 v142, v76, v142, v210
    v_fma_f32 v143, v77, v143, v211
    s_add_u32 s39, s39, 32768
    buffer_store_dword v140, v40, s[32:35], s39 offen
    buffer_store_dword v141, v41, s[32:35], s39 offen
    buffer_store_dword v142, v42, s[32:35], s39 offen
    buffer_store_dword v143, v43, s[32:35], s39 offen
    s_waitcnt lgkmcnt(0)
    v_add_f32 v144, v144, v112
    v_add_f32 v145, v145, v113
    v_add_f32 v146, v146, v114
    v_add_f32 v147, v147, v115
    v_fma_f32 v144, v78, v144, v212
    v_fma_f32 v145, v79, v145, v213
    v_fma_f32 v146, v80, v146, v214
    v_fma_f32 v147, v81, v147, v215
    s_add_u32 s39, s39, 32768
    buffer_store_dword v144, v40, s[32:35], s39 offen
    buffer_store_dword v145, v41, s[32:35], s39 offen
    buffer_store_dword v146, v42, s[32:35], s39 offen
    buffer_store_dword v147, v43, s[32:35], s39 offen
Lend_gated_mix__ssm_conv_s5__ssm_conv_h3__prompt_kernel:
Lcode_last:
    s_endpgm

.section .rodata,"a"
.p2align 6
.amdhsa_kernel gated_mix__ssm_conv_s5__ssm_conv_h3__prompt_kernel
  .amdhsa_next_free_vgpr 504
  .amdhsa_next_free_sgpr 92
  .amdhsa_accum_offset 248
  .amdhsa_group_segment_fixed_size 0
  .amdhsa_kernarg_size 152
  .amdhsa_user_sgpr_count 2
  .amdhsa_user_sgpr_kernarg_segment_ptr 1
  .amdhsa_system_sgpr_workgroup_id_x 1
  .amdhsa_float_denorm_mode_32 3
.end_amdhsa_kernel
```

```asm
; @launch grid=(256,1,1) block=(256,1,1) lds=163840
.amdgcn_target "amdgcn-amd-amdhsa--gfx950"
.text
.globl gated_mix__ssm_conv_s5__ssm_conv_h3__prompt_kernel
.p2align 8
.type gated_mix__ssm_conv_s5__ssm_conv_h3__prompt_kernel,@function
gated_mix__ssm_conv_s5__ssm_conv_h3__prompt_kernel:
    s_cmp_ge_u32 s2, 256
    s_cbranch_scc1 Lend_gated_mix__ssm_conv_s5__ssm_conv_h3__prompt_kernel
    s_load_dwordx16 s[4:19], s[0:1], 0
    s_load_dwordx16 s[20:35], s[0:1], 64
    s_load_dwordx4 s[36:39], s[0:1], 128
    s_load_dwordx2 s[40:41], s[0:1], 144
    s_getpc_b64 s[42:43]
Lcpf_pc:
    s_bfe_u32 s3, s2, 0x10003
    s_lshl_b32 s3, s3, 15
    v_lshlrev_b32 v1, 7, v0
    v_add_u32 v1, s3, v1
    v_min_u32 v1, Lcode_last-Lcpf_pc, v1
    v_mov_b32 v3, s43
    v_add_co_u32 v2, vcc, s42, v1
    s_nop 1
    v_addc_co_u32 v3, vcc, 0, v3, vcc
    global_load_dword v1, v[2:3], off
    s_memrealtime s[42:43]
    v_lshrrev_b32 v2, 6, v0
    s_nop 0
    v_readfirstlane_b32 s44, v2
    v_and_b32 v2, 63, v0
    s_and_b32 s47, s2, 7
    s_lshr_b32 s45, s47, 1
    s_lshl_b32 s45, s45, 2
    s_and_b32 s46, s47, 1
    s_lshl_b32 s46, s46, 3
    s_lshr_b32 s47, s2, 3
    s_and_b32 s3, s47, 3
    s_add_u32 s45, s45, s3
    s_lshr_b32 s47, s47, 2
    s_add_u32 s46, s46, s47
    v_mov_b32 v4, 0
    v_mov_b32 v5, 0
    v_mov_b32 v6, 0
    v_mov_b32 v7, 0
    v_lshlrev_b32 v3, 4, v0
    v_add_u32 v3, 148480, v3
    ds_write_b128 v3, v[4:7]
    v_lshlrev_b32 v3, 2, v0
    v_add_u32 v3, 152576, v3
    ds_write_b32 v3, v4
    v_lshrrev_b32 v16, 4, v2
    v_and_b32 v17, 7, v2
    v_xor_b32 v17, v17, v16
    v_lshlrev_b32 v17, 4, v17
    v_lshrrev_b32 v16, 3, v2
    v_lshl_add_u32 v12, v16, 11, v17
    v_and_b32 v16, 32, v2
    v_lshl_add_u32 v8, v16, 11, v17
    v_and_b32 v16, 8, v2
    v_lshl_add_u32 v8, v16, 12, v8
    v_and_b32 v16, 16, v2
    v_lshl_add_u32 v8, v16, 7, v8
    v_xor_b32 v16, 64, v8
    v_xor_b32 v17, 64, v12
    v_add_u32 v9, 4096, v16
    v_add_u32 v10, 8192, v8
    v_add_u32 v11, 12288, v16
    v_add_u32 v13, 16384, v17
    v_add_u32 v14, 32768, v12
    v_add_u32 v15, 49152, v17
    s_lshr_b32 s50, s44, 1
    s_lshl_b32 s47, s45, 7
    s_lshl_b32 s3, s50, 6
    s_add_u32 s47, s47, s3
    s_and_b32 s3, s44, 1
    s_lshl_b32 s3, s3, 3
    s_add_u32 s47, s47, s3
    s_lshl_b32 s47, s47, 11
    s_lshl_b32 s48, s46, 6
    s_lshl_b32 s3, s50, 5
    s_add_u32 s48, s48, s3
    s_lshl_b32 s48, s48, 11
    s_lshl_b32 s49, s44, 12
    s_and_b32 s3, s2, 7
    s_lshl_b32 s51, s3, 8
    v_bfe_u32 v17, v2, 3, 2
    v_lshrrev_b32 v18, 5, v2
    v_lshlrev_b32 v18, 2, v18
    v_lshl_add_u32 v17, v17, 3, v18
    v_and_b32 v18, 7, v2
    v_lshlrev_b32 v18, 4, v18
    v_lshl_add_u32 v16, v17, 11, v18
    s_lshl_b32 s50, s45, 7
    s_lshl_b32 s3, s44, 5
    s_add_u32 s50, s50, s3
    s_lshl_b32 s50, s50, 11
    s_lshl_b32 s3, s46, 7
    s_add_u32 s50, s50, s3
    v_add_u32 v16, s50, v16
    v_subrev_u32 v18, 6144, v16
    v_min_u32 v18, 0x7fff0000, v18
    v_subrev_u32 v22, 4096, v16
    v_min_u32 v22, 0x7fff0000, v22
    v_subrev_u32 v26, 2048, v16
    v_min_u32 v26, 0x7fff0000, v26
    s_mov_b32 s50, 4096
    s_lshl_b32 s54, s46, 9
    v_lshlrev_b32 v17, 4, v2
    s_waitcnt lgkmcnt(0)
    s_mov_b32 s56, s4
    s_mov_b32 s57, s5
    s_mov_b32 s58, 4194304
    s_mov_b32 s59, 131072
    s_and_b32 s3, s44, 1
    s_cmp_eq_u32 s3, 0
    s_cselect_b32 s60, s10, s12
    s_cselect_b32 s61, s11, s13
    s_mov_b32 s62, 2097152
    s_mov_b32 s63, 131072
    s_add_u32 s52, s47, s51
    s_add_u32 m0, s49, 0
    s_nop 0
    buffer_load_dwordx4 v8, s[56:59], s52 offen  lds
    s_add_u32 m0, s49, 1024
    s_nop 0
    buffer_load_dwordx4 v9, s[56:59], s52 offen  lds
    s_add_u32 m0, s49, 2048
    s_nop 0
    buffer_load_dwordx4 v10, s[56:59], s52 offen  lds
    s_add_u32 m0, s49, 3072
    s_nop 0
    buffer_load_dwordx4 v11, s[56:59], s52 offen  lds
    s_add_u32 s53, s48, s51
    s_add_u32 m0, s49, 16384
    s_nop 0
    buffer_load_dwordx4 v12, s[60:63], s53 offen  lds
    s_add_u32 m0, s49, 17408
    s_nop 0
    buffer_load_dwordx4 v13, s[60:63], s53 offen  lds
    s_add_u32 m0, s49, 18432
    s_nop 0
    buffer_load_dwordx4 v14, s[60:63], s53 offen  lds
    s_add_u32 m0, s49, 19456
    s_nop 0
    buffer_load_dwordx4 v15, s[60:63], s53 offen  lds
    s_add_u32 s51, s51, 128
    s_and_b32 s51, s51, 0x7ff
    s_add_u32 s52, s47, s51
    s_add_u32 m0, s49, 32768
    s_nop 0
    buffer_load_dwordx4 v8, s[56:59], s52 offen  lds
    s_add_u32 m0, s49, 33792
    s_nop 0
    buffer_load_dwordx4 v9, s[56:59], s52 offen  lds
    s_add_u32 m0, s49, 34816
    s_nop 0
    buffer_load_dwordx4 v10, s[56:59], s52 offen  lds
    s_add_u32 m0, s49, 35840
    s_nop 0
    buffer_load_dwordx4 v11, s[56:59], s52 offen  lds
    s_add_u32 s53, s48, s51
    s_add_u32 m0, s49, 49152
    s_nop 0
    buffer_load_dwordx4 v12, s[60:63], s53 offen  lds
    s_add_u32 m0, s49, 50176
    s_nop 0
    buffer_load_dwordx4 v13, s[60:63], s53 offen  lds
    s_add_u32 m0, s49, 51200
    s_nop 0
    buffer_load_dwordx4 v14, s[60:63], s53 offen  lds
    s_add_u32 m0, s49, 52224
    s_nop 0
    buffer_load_dwordx4 v15, s[60:63], s53 offen  lds
    s_mov_b32 s64, s28
    s_mov_b32 s65, s29
    s_mov_b32 s66, 8192
    s_mov_b32 s67, 131072
    s_mov_b32 s68, s24
    s_mov_b32 s69, s25
    s_mov_b32 s70, 4194304
    s_mov_b32 s71, 131072
    s_mov_b32 s72, s26
    s_mov_b32 s73, s27
    s_mov_b32 s74, 4194304
    s_mov_b32 s75, 131072
    s_lshl_b32 s3, s44, 10
    s_add_u32 s4, s3, 157696
    s_mov_b32 s24, s38
    s_mov_b32 s25, s39
    s_mov_b32 s26, 256
    s_mov_b32 s27, 131072
    s_or_b32 s3, s2, s44
    s_cmp_lg_u32 s3, 0
    s_cbranch_scc1 Lnonce_gate_1
    v_mov_b32 v4, s42
    v_mov_b32 v5, s43
    v_mov_b32 v3, 0
    buffer_store_dwordx2 v[4:5], v3, s[24:27], 0 offen sc0 sc1
    s_nop 1
Lnonce_gate_1:
    s_mov_b32 s5, 0xffff0000
    v_mov_b32 v6, 0
    s_and_b32 s3, s44, 1
    s_lshl_b32 s3, s3, 5
    v_and_b32 v7, 31, v2
    v_add_u32 v7, s3, v7
    s_lshl_b32 s3, s46, 6
    v_add_u32 v62, s3, v7
    v_lshlrev_b32 v62, 1, v62
    s_mov_b32 s76, s6
    s_mov_b32 s77, s7
    s_mov_b32 s78, 2048
    s_mov_b32 s79, 131072
    buffer_load_ushort v63, v62, s[76:79], 0 offen
    s_mov_b32 s76, s8
    s_mov_b32 s77, s9
    s_mov_b32 s78, 2048
    s_mov_b32 s79, 131072
    buffer_load_ushort v64, v62, s[76:79], 0 offen
    s_mov_b32 s8, s18
    s_mov_b32 s9, s19
    s_mov_b32 s10, 2048
    s_mov_b32 s11, 131072
    buffer_load_ushort v65, v62, s[8:11], 0 offen
    v_and_b32 v82, 31, v2
    v_bfe_u32 v83, v82, 1, 3
    v_lshrrev_b32 v84, 5, v2
    v_xor_b32 v83, v83, v84
    v_lshlrev_b32 v83, 4, v83
    v_lshl_add_u32 v83, v82, 7, v83
    s_lshr_b32 s6, s44, 1
    s_lshl_b32 s6, s6, 13
    s_and_b32 s7, s44, 1
    s_lshl_b32 s7, s7, 13
    s_add_u32 s7, s7, 16384
    v_xor_b32 v84, 0, v83
    v_add_u32 v66, s6, v84
    v_add_u32 v74, s7, v84
    v_add_u32 v70, 0x10000, v66
    v_add_u32 v78, 0x10000, v74
    v_xor_b32 v84, 32, v83
    v_add_u32 v67, s6, v84
    v_add_u32 v75, s7, v84
    v_add_u32 v71, 0x10000, v67
    v_add_u32 v79, 0x10000, v75
    v_xor_b32 v84, 64, v83
    v_add_u32 v68, s6, v84
    v_add_u32 v76, s7, v84
    v_add_u32 v72, 0x10000, v68
    v_add_u32 v80, 0x10000, v76
    v_xor_b32 v84, 96, v83
    v_add_u32 v69, s6, v84
    v_add_u32 v77, s7, v84
    v_add_u32 v73, 0x10000, v69
    v_add_u32 v81, 0x10000, v77
    s_mov_b32 s8, s40
    s_mov_b32 s9, s41
    s_mov_b32 s10, 33554432
    s_mov_b32 s11, 131072
    v_and_b32 v82, 7, v2
    s_lshl_b32 s3, s44, 10
    s_add_u32 s3, s3, 157696
    v_lshl_add_u32 v180, v82, 6, s3
    v_bfe_u32 v82, v2, 2, 1
    v_lshlrev_b32 v82, 3, v82
    v_lshrrev_b32 v83, 5, v2
    v_add_u32 v82, v82, v83
    v_lshlrev_b32 v181, 14, v82
    v_bfe_u32 v82, v2, 3, 2
    v_sub_u32 v82, 3, v82
    v_lshl_add_u32 v181, v82, 6, v181
    v_and_b32 v82, 3, v2
    v_lshl_add_u32 v181, v82, 4, v181
    s_lshl_b32 s6, s46, 18
    s_add_u32 s6, s6, 8404736
    s_lshl_b32 s3, s45, 10
    s_sub_u32 s6, s6, s3
    s_lshl_b32 s3, s44, 8
    s_sub_u32 s6, s6, s3
    s_lshl_b32 s13, s46, 4
    s_add_u32 s13, s13, s45
    s_lshl_b32 s13, s13, 2
    s_add_u32 s13, s13, s44
    s_lshl_b32 s13, s13, 3
    s_add_u32 s13, s13, 21495808
    s_lshl_b32 s18, s46, 2
    s_add_u32 s18, s18, s44
    s_lshl_b32 s18, s18, 4
    s_add_u32 s18, s18, s45
    s_lshl_b32 s18, s18, 3
    s_add_u32 s18, s18, 21504000
    s_lshl_b32 s3, s46, 9
    s_add_u32 s3, s3, 21495808
    v_lshrrev_b32 v182, 1, v17
    v_add_u32 v182, s3, v182
    s_lshl_b32 s19, s46, 6
    s_lshr_b32 s3, s45, 3
    s_lshl_b32 s3, s3, 5
    s_add_u32 s19, s19, s3
    s_lshl_b32 s3, s44, 3
    s_add_u32 s19, s19, s3
    s_and_b32 s3, s45, 7
    s_add_u32 s19, s19, s3
    s_lshl_b32 s22, s19, 12
    s_add_u32 s76, s30, s22
    s_addc_u32 s77, s31, 0
    s_mov_b32 s78, 4096
    s_mov_b32 s79, 131072
    s_mov_b32 s80, s32
    s_mov_b32 s81, s33
    s_mov_b32 s82, 2048
    s_mov_b32 s83, 131072
    s_lshl_b32 s3, s19, 1
    v_mov_b32 v183, s3
    buffer_load_ushort v183, v183, s[80:83], 0 offen
    s_mul_i32 s23, s44, 8320
    s_add_u32 s23, s23, 65536
    v_lshrrev_b32 v224, 4, v2
    v_and_b32 v225, 3, v2
    v_xor_b32 v225, v225, v224
    v_lshlrev_b32 v225, 4, v225
    v_lshrrev_b32 v224, 2, v2
    v_lshl_add_u32 v207, v224, 6, v225
    s_lshl_b32 s28, s46, 4
    s_add_u32 s28, s28, s45
    s_lshl_b32 s28, s28, 14
    s_lshl_b32 s29, s44, 12
    s_add_u32 s28, s28, s29
    s_add_u32 s28, s28, 8388608
    s_add_u32 s29, s29, 132096
    s_mov_b32 s80, s14
    s_mov_b32 s81, s15
    s_mov_b32 s82, 2097152
    s_mov_b32 s83, 131072
    s_mov_b32 s84, s16
    s_mov_b32 s85, s17
    s_mov_b32 s86, 2097152
    s_mov_b32 s87, 131072
    v_lshrrev_b32 v225, 2, v2
    v_lshrrev_b32 v226, 4, v2
    v_xor_b32 v226, v226, v2
    v_and_b32 v226, 3, v226
    v_lshlrev_b32 v226, 4, v226
    v_lshl_add_u32 v224, v225, 11, v226
    s_lshl_b32 s14, s46, 17
    s_and_b32 s3, s44, 1
    s_lshl_b32 s3, s3, 16
    s_add_u32 s14, s14, s3
    s_lshl_b32 s3, s45, 7
    s_add_u32 s14, s14, s3
    s_lshr_b32 s3, s44, 1
    s_lshl_b32 s3, s3, 6
    s_add_u32 s14, s14, s3
    s_add_u32 s15, s14, 32768
    s_lshl_b32 s16, s44, 12
    s_add_u32 s16, s16, 132096
    s_mov_b32 s88, s34
    s_mov_b32 s89, s35
    s_mov_b32 s90, 2048
    s_mov_b32 s91, 131072
    s_lshl_b32 s17, s45, 7
    s_lshl_b32 s3, s46, 3
    s_add_u32 s17, s17, s3
    s_lshl_b32 s3, s44, 1
    s_add_u32 s17, s17, s3
    s_lshl_b32 s3, s17, 2
    s_add_u32 s3, s3, 20971520
    v_mov_b32 v225, s3
    s_lshl_b32 s17, s17, 11
    s_mov_b32 s32, 8192
    buffer_load_dwordx4 v[208:211], v17, s[88:91], 0 offen offset:0
    buffer_load_dwordx4 v[212:215], v17, s[88:91], 0 offen offset:1024
    buffer_load_dwordx4 v[46:49], v17, s[56:59], s17 offen offset:0
    buffer_load_dwordx4 v[50:53], v17, s[56:59], s17 offen offset:1024
    buffer_load_dwordx4 v[54:57], v17, s[56:59], s17 offen offset:2048
    buffer_load_dwordx4 v[58:61], v17, s[56:59], s17 offen offset:3072
    s_waitcnt vmcnt(18)
    s_barrier
    ds_read_b128 v[84:87], v66 offset:0
    ds_read_b128 v[92:95], v74 offset:0
    ds_read_b128 v[96:99], v74 offset:4096
    ds_read_b128 v[88:91], v66 offset:4096
    s_add_u32 s51, s51, 128
    s_and_b32 s51, s51, 0x7ff
    s_add_u32 s52, s47, s51
    s_add_u32 m0, s49, 65536
    s_waitcnt lgkmcnt(2)
    v_mfma_f32_32x32x16_bf16 v[116:131], v[84:87], v[92:95], 0
    ds_read_b128 v[100:103], v67 offset:0
    ds_read_b128 v[108:111], v75 offset:0
    buffer_load_dwordx4 v8, s[56:59], s52 offen  lds
    s_add_u32 m0, s49, 66560
    s_waitcnt lgkmcnt(3)
    v_mfma_f32_32x32x16_bf16 v[132:147], v[84:87], v[96:99], 0
    ds_read_b128 v[112:115], v75 offset:4096
    ds_read_b128 v[104:107], v67 offset:4096
    buffer_load_dwordx4 v9, s[56:59], s52 offen  lds
    s_add_u32 m0, s49, 67584
    s_waitcnt lgkmcnt(4)
    v_mfma_f32_32x32x16_bf16 v[148:163], v[88:91], v[92:95], 0
    buffer_load_dwordx4 v10, s[56:59], s52 offen  lds
    s_add_u32 m0, s49, 68608
    v_mfma_f32_32x32x16_bf16 v[164:179], v[88:91], v[96:99], 0
    buffer_load_dwordx4 v11, s[56:59], s52 offen  lds
    s_add_u32 s53, s48, s51
    s_add_u32 m0, s49, 81920
    s_waitcnt lgkmcnt(2)
    v_mfma_f32_32x32x16_bf16 v[116:131], v[100:103], v[108:111], v[116:131]
    ds_read_b128 v[84:87], v68 offset:0
    ds_read_b128 v[92:95], v76 offset:0
    buffer_load_dwordx4 v12, s[60:63], s53 offen  lds
    s_add_u32 m0, s49, 82944
    s_waitcnt lgkmcnt(3)
    v_mfma_f32_32x32x16_bf16 v[132:147], v[100:103], v[112:115], v[132:147]
    ds_read_b128 v[96:99], v76 offset:4096
    ds_read_b128 v[88:91], v68 offset:4096
    buffer_load_dwordx4 v13, s[60:63], s53 offen  lds
    s_add_u32 m0, s49, 83968
    s_waitcnt lgkmcnt(4)
    v_mfma_f32_32x32x16_bf16 v[148:163], v[104:107], v[108:111], v[148:163]
    buffer_load_dwordx4 v14, s[60:63], s53 offen  lds
    s_add_u32 m0, s49, 84992
    v_mfma_f32_32x32x16_bf16 v[164:179], v[104:107], v[112:115], v[164:179]
    buffer_load_dwordx4 v15, s[60:63], s53 offen  lds
    s_add_u32 s51, s51, 128
    s_and_b32 s51, s51, 0x7ff
    s_add_u32 s52, s47, s51
    s_add_u32 m0, s49, 98304
    s_waitcnt lgkmcnt(2)
    v_mfma_f32_32x32x16_bf16 v[116:131], v[84:87], v[92:95], v[116:131]
    ds_read_b128 v[100:103], v69 offset:0
    ds_read_b128 v[108:111], v77 offset:0
    buffer_load_dwordx4 v8, s[56:59], s52 offen  lds
    s_add_u32 m0, s49, 99328
    s_waitcnt lgkmcnt(3)
    v_mfma_f32_32x32x16_bf16 v[132:147], v[84:87], v[96:99], v[132:147]
    ds_read_b128 v[112:115], v77 offset:4096
    ds_read_b128 v[104:107], v69 offset:4096
    buffer_load_dwordx4 v9, s[56:59], s52 offen  lds
    s_add_u32 m0, s49, 100352
    s_waitcnt lgkmcnt(4)
    v_mfma_f32_32x32x16_bf16 v[148:163], v[88:91], v[92:95], v[148:163]
    buffer_load_dwordx4 v10, s[56:59], s52 offen  lds
    s_add_u32 m0, s49, 101376
    v_mfma_f32_32x32x16_bf16 v[164:179], v[88:91], v[96:99], v[164:179]
    buffer_load_dwordx4 v11, s[56:59], s52 offen  lds
    s_waitcnt lgkmcnt(0)
    s_waitcnt vmcnt(22)
    s_barrier
    s_add_u32 s53, s48, s51
    s_add_u32 m0, s49, 114688
    v_mfma_f32_32x32x16_bf16 v[116:131], v[100:103], v[108:111], v[116:131]
    ds_read_b128 v[84:87], v66 offset:32768
    ds_read_b128 v[92:95], v74 offset:32768
    buffer_load_dwordx4 v12, s[60:63], s53 offen  lds
    s_waitcnt vmcnt(22)
    v_lshlrev_b32 v63, 16, v63
    s_waitcnt vmcnt(21)
    v_lshlrev_b32 v64, 16, v64
    s_waitcnt vmcnt(20)
    v_lshlrev_b32 v65, 16, v65
    v_mul_f32 v242, 1069066811, v65
    s_add_u32 m0, s49, 115712
    v_mfma_f32_32x32x16_bf16 v[132:147], v[100:103], v[112:115], v[132:147]
    ds_read_b128 v[96:99], v74 offset:36864
    ds_read_b128 v[88:91], v66 offset:36864
    buffer_load_dwordx4 v13, s[60:63], s53 offen  lds
    v_exp_f32 v242, v242
    s_nop 0
    v_cvt_pk_bf16_f32 v242, v242, v242
    v_lshlrev_b32 v242, 16, v242
    v_mul_f32 v243, v242, v63
    s_add_u32 m0, s49, 116736
    v_mfma_f32_32x32x16_bf16 v[148:163], v[104:107], v[108:111], v[148:163]
    buffer_load_dwordx4 v14, s[60:63], s53 offen  lds
    v_mul_f32 v244, v242, v64
    v_mul_f32 v243, 1069066811, v243
    v_exp_f32 v243, v243
    v_mul_f32 v244, 1042479491, v244
    v_fract_f32 v244, v244
    v_cos_f32 v245, v244
    s_add_u32 m0, s49, 117760
    v_mfma_f32_32x32x16_bf16 v[164:179], v[104:107], v[112:115], v[164:179]
    buffer_load_dwordx4 v15, s[60:63], s53 offen  lds
    v_sin_f32 v246, v244
    v_mul_f32 v230, v243, v245
    v_mul_f32 v231, v243, v246
    v_add_f32 v242, -1.0, v230
    v_mul_f32 v243, v63, v63
    v_fmac_f32 v243, v64, v64
    v_rcp_f32 v243, v243
    s_add_u32 s51, s51, 128
    s_and_b32 s51, s51, 0x7ff
    s_add_u32 s52, s47, s51
    s_add_u32 m0, s49, 0
    s_waitcnt lgkmcnt(2)
    v_mfma_f32_32x32x16_bf16 v[116:131], v[84:87], v[92:95], v[116:131]
    ds_read_b128 v[100:103], v67 offset:32768
    ds_read_b128 v[108:111], v75 offset:32768
    buffer_load_dwordx4 v8, s[56:59], s52 offen  lds
    v_add_f32 v243, v243, v243
    v_mul_f32 v244, v242, v63
    v_fmac_f32 v244, v231, v64
    v_mul_f32 v245, v231, v63
    s_add_u32 m0, s49, 1024
    s_waitcnt lgkmcnt(3)
    v_mfma_f32_32x32x16_bf16 v[132:147], v[84:87], v[96:99], v[132:147]
    ds_read_b128 v[112:115], v75 offset:36864
    ds_read_b128 v[104:107], v67 offset:36864
    buffer_load_dwordx4 v9, s[56:59], s52 offen  lds
    v_fma_f32 v245, -v242, v64, v245
    v_mul_f32 v232, v244, v243
    v_mul_f32 v233, v245, v243
    v_mul_f32 v242, v231, v231
    s_add_u32 m0, s49, 2048
    s_waitcnt lgkmcnt(4)
    v_mfma_f32_32x32x16_bf16 v[148:163], v[88:91], v[92:95], v[148:163]
    buffer_load_dwordx4 v10, s[56:59], s52 offen  lds
    v_fma_f32 v242, v230, v230, -v242
    v_mul_f32 v243, v230, v231
    v_add_f32 v243, v243, v243
    v_mul_f32 v244, v243, v243
    v_fma_f32 v244, v242, v242, -v244
    v_mul_f32 v245, v242, v243
    s_add_u32 m0, s49, 3072
    v_mfma_f32_32x32x16_bf16 v[164:179], v[88:91], v[96:99], v[164:179]
    buffer_load_dwordx4 v11, s[56:59], s52 offen  lds
    v_add_f32 v245, v245, v245
    v_mul_f32 v242, v245, v245
    v_fma_f32 v242, v244, v244, -v242
    v_mul_f32 v243, v244, v245
    v_add_f32 v243, v243, v243
    v_mul_f32 v234, v243, v243
    v_fma_f32 v234, v242, v242, -v234
    s_add_u32 s53, s48, s51
    s_add_u32 m0, s49, 16384
    s_waitcnt lgkmcnt(2)
    v_mfma_f32_32x32x16_bf16 v[116:131], v[100:103], v[108:111], v[116:131]
    ds_read_b128 v[84:87], v68 offset:32768
    ds_read_b128 v[92:95], v76 offset:32768
    buffer_load_dwordx4 v12, s[60:63], s53 offen  lds
    v_mul_f32 v235, v242, v243
    v_add_f32 v235, v235, v235
    v_mul_f32 v242, v235, v235
    v_fma_f32 v242, v234, v234, -v242
    s_add_u32 m0, s49, 17408
    s_waitcnt lgkmcnt(3)
    v_mfma_f32_32x32x16_bf16 v[132:147], v[100:103], v[112:115], v[132:147]
    ds_read_b128 v[96:99], v76 offset:36864
    ds_read_b128 v[88:91], v68 offset:36864
    buffer_load_dwordx4 v13, s[60:63], s53 offen  lds
    v_mul_f32 v243, v234, v235
    v_add_f32 v243, v243, v243
    v_mul_f32 v244, v243, v243
    v_fma_f32 v244, v242, v242, -v244
    s_add_u32 m0, s49, 18432
    s_waitcnt lgkmcnt(4)
    v_mfma_f32_32x32x16_bf16 v[148:163], v[104:107], v[108:111], v[148:163]
    buffer_load_dwordx4 v14, s[60:63], s53 offen  lds
    v_mul_f32 v245, v242, v243
    v_add_f32 v245, v245, v245
    v_mul_f32 v236, v245, v245
    v_fma_f32 v236, v244, v244, -v236
    v_mul_f32 v237, v244, v245
    v_add_f32 v237, v237, v237
    s_add_u32 m0, s49, 19456
    v_mfma_f32_32x32x16_bf16 v[164:179], v[104:107], v[112:115], v[164:179]
    buffer_load_dwordx4 v15, s[60:63], s53 offen  lds
    s_mov_b32 s34, 0
    s_mov_b32 s35, -1
    s_lshr_b32 s3, s44, 1
    s_cmp_eq_u32 s3, 1
    s_cselect_b32 s38, -1, 0
    s_cselect_b32 s39, -1, 0
    v_cndmask_b32 v242, 1.0, v242, s[34:35]
    v_cndmask_b32 v243, 0, v243, s[34:35]
    v_cndmask_b32 v244, 1.0, v244, s[38:39]
    s_waitcnt lgkmcnt(2)
    v_mfma_f32_32x32x16_bf16 v[116:131], v[84:87], v[92:95], v[116:131]
    ds_read_b128 v[100:103], v69 offset:32768
    ds_read_b128 v[108:111], v77 offset:32768
    v_cndmask_b32 v245, 0, v245, s[38:39]
    v_mul_f32 v246, v243, v245
    v_fma_f32 v246, v242, v244, -v246
    v_mul_f32 v247, v242, v245
    v_fmac_f32 v247, v243, v244
    v_mul_f32 v242, v247, v235
    s_waitcnt lgkmcnt(3)
    v_mfma_f32_32x32x16_bf16 v[132:147], v[84:87], v[96:99], v[132:147]
    ds_read_b128 v[112:115], v77 offset:36864
    ds_read_b128 v[104:107], v69 offset:36864
    v_fma_f32 v242, v246, v234, -v242
    v_mul_f32 v243, v246, v235
    v_fmac_f32 v243, v247, v234
    v_mov_b32 v238, v246
    v_mov_b32 v239, v242
    v_mov_b32 v240, v247
    s_waitcnt lgkmcnt(4)
    v_mfma_f32_32x32x16_bf16 v[148:163], v[88:91], v[92:95], v[148:163]
    v_mov_b32 v241, v243
    v_mfma_f32_32x32x16_bf16 v[164:179], v[88:91], v[96:99], v[164:179]
    s_waitcnt lgkmcnt(0)
    s_waitcnt vmcnt(16)
    s_barrier
    s_add_u32 s51, s51, 128
    s_and_b32 s51, s51, 0x7ff
    s_add_u32 s52, s47, s51
    s_add_u32 m0, s49, 32768
    v_mfma_f32_32x32x16_bf16 v[116:131], v[100:103], v[108:111], v[116:131]
    ds_read_b128 v[84:87], v70 offset:0
    ds_read_b128 v[92:95], v78 offset:0
    buffer_load_dwordx4 v8, s[56:59], s52 offen  lds
    v_lshlrev_b32 v203, 16, v208
    v_and_b32 v204, s5, v208
    v_lshlrev_b32 v205, 16, v46
    v_and_b32 v206, s5, v46
    s_add_u32 m0, s49, 33792
    v_mfma_f32_32x32x16_bf16 v[132:147], v[100:103], v[112:115], v[132:147]
    ds_read_b128 v[96:99], v78 offset:4096
    ds_read_b128 v[88:91], v70 offset:4096
    buffer_load_dwordx4 v9, s[56:59], s52 offen  lds
    v_mul_f32 v226, v203, v205
    v_fmac_f32 v226, v204, v206
    v_lshlrev_b32 v205, 16, v54
    v_and_b32 v206, s5, v54
    s_add_u32 m0, s49, 34816
    v_mfma_f32_32x32x16_bf16 v[148:163], v[104:107], v[108:111], v[148:163]
    buffer_load_dwordx4 v10, s[56:59], s52 offen  lds
    v_mul_f32 v227, v203, v205
    v_fmac_f32 v227, v204, v206
    v_lshlrev_b32 v203, 16, v209
    v_and_b32 v204, s5, v209
    v_lshlrev_b32 v205, 16, v47
    v_and_b32 v206, s5, v47
    s_add_u32 m0, s49, 35840
    v_mfma_f32_32x32x16_bf16 v[164:179], v[104:107], v[112:115], v[164:179]
    buffer_load_dwordx4 v11, s[56:59], s52 offen  lds
    v_fmac_f32 v226, v203, v205
    v_fmac_f32 v226, v204, v206
    v_lshlrev_b32 v205, 16, v55
    v_and_b32 v206, s5, v55
    v_fmac_f32 v227, v203, v205
    v_fmac_f32 v227, v204, v206
    v_lshlrev_b32 v203, 16, v210
    s_add_u32 s53, s48, s51
    s_add_u32 m0, s49, 49152
    s_waitcnt lgkmcnt(2)
    v_mfma_f32_32x32x16_bf16 v[116:131], v[84:87], v[92:95], v[116:131]
    ds_read_b128 v[100:103], v71 offset:0
    ds_read_b128 v[108:111], v79 offset:0
    buffer_load_dwordx4 v12, s[60:63], s53 offen  lds
    v_and_b32 v204, s5, v210
    v_lshlrev_b32 v205, 16, v48
    v_and_b32 v206, s5, v48
    v_fmac_f32 v226, v203, v205
    s_add_u32 m0, s49, 50176
    s_waitcnt lgkmcnt(3)
    v_mfma_f32_32x32x16_bf16 v[132:147], v[84:87], v[96:99], v[132:147]
    ds_read_b128 v[112:115], v79 offset:4096
    ds_read_b128 v[104:107], v71 offset:4096
    buffer_load_dwordx4 v13, s[60:63], s53 offen  lds
    v_fmac_f32 v226, v204, v206
    v_lshlrev_b32 v205, 16, v56
    v_and_b32 v206, s5, v56
    v_fmac_f32 v227, v203, v205
    s_add_u32 m0, s49, 51200
    s_waitcnt lgkmcnt(4)
    v_mfma_f32_32x32x16_bf16 v[148:163], v[88:91], v[92:95], v[148:163]
    buffer_load_dwordx4 v14, s[60:63], s53 offen  lds
    v_fmac_f32 v227, v204, v206
    v_lshlrev_b32 v203, 16, v211
    v_and_b32 v204, s5, v211
    v_lshlrev_b32 v205, 16, v49
    v_and_b32 v206, s5, v49
    v_fmac_f32 v226, v203, v205
    s_add_u32 m0, s49, 52224
    v_mfma_f32_32x32x16_bf16 v[164:179], v[88:91], v[96:99], v[164:179]
    buffer_load_dwordx4 v15, s[60:63], s53 offen  lds
    v_fmac_f32 v226, v204, v206
    v_lshlrev_b32 v205, 16, v57
    v_and_b32 v206, s5, v57
    v_fmac_f32 v227, v203, v205
    v_fmac_f32 v227, v204, v206
    v_lshlrev_b32 v203, 16, v212
    v_and_b32 v204, s5, v212
    s_waitcnt lgkmcnt(2)
    v_mfma_f32_32x32x16_bf16 v[116:131], v[100:103], v[108:111], v[116:131]
    ds_read_b128 v[84:87], v72 offset:0
    ds_read_b128 v[92:95], v80 offset:0
    v_lshlrev_b32 v205, 16, v50
    v_and_b32 v206, s5, v50
    v_fmac_f32 v226, v203, v205
    v_fmac_f32 v226, v204, v206
    v_lshlrev_b32 v205, 16, v58
    v_and_b32 v206, s5, v58
    s_waitcnt lgkmcnt(3)
    v_mfma_f32_32x32x16_bf16 v[132:147], v[100:103], v[112:115], v[132:147]
    ds_read_b128 v[96:99], v80 offset:4096
    ds_read_b128 v[88:91], v72 offset:4096
    v_fmac_f32 v227, v203, v205
    v_fmac_f32 v227, v204, v206
    v_lshlrev_b32 v203, 16, v213
    v_and_b32 v204, s5, v213
    v_lshlrev_b32 v205, 16, v51
    v_and_b32 v206, s5, v51
    s_waitcnt lgkmcnt(4)
    v_mfma_f32_32x32x16_bf16 v[148:163], v[104:107], v[108:111], v[148:163]
    v_fmac_f32 v226, v203, v205
    v_fmac_f32 v226, v204, v206
    v_lshlrev_b32 v205, 16, v59
    v_and_b32 v206, s5, v59
    v_fmac_f32 v227, v203, v205
    v_fmac_f32 v227, v204, v206
    v_lshlrev_b32 v203, 16, v214
    v_and_b32 v204, s5, v214
    v_mfma_f32_32x32x16_bf16 v[164:179], v[104:107], v[112:115], v[164:179]
    v_lshlrev_b32 v205, 16, v52
    v_and_b32 v206, s5, v52
    v_fmac_f32 v226, v203, v205
    v_fmac_f32 v226, v204, v206
    v_lshlrev_b32 v205, 16, v60
    v_and_b32 v206, s5, v60
    v_fmac_f32 v227, v203, v205
    v_fmac_f32 v227, v204, v206
    s_waitcnt lgkmcnt(2)
    v_mfma_f32_32x32x16_bf16 v[116:131], v[84:87], v[92:95], v[116:131]
    ds_read_b128 v[100:103], v73 offset:0
    ds_read_b128 v[108:111], v81 offset:0
    v_lshlrev_b32 v203, 16, v215
    v_and_b32 v204, s5, v215
    v_lshlrev_b32 v205, 16, v53
    v_and_b32 v206, s5, v53
    v_fmac_f32 v226, v203, v205
    v_fmac_f32 v226, v204, v206
    s_waitcnt lgkmcnt(3)
    v_mfma_f32_32x32x16_bf16 v[132:147], v[84:87], v[96:99], v[132:147]
    ds_read_b128 v[112:115], v81 offset:4096
    ds_read_b128 v[104:107], v73 offset:4096
    v_lshlrev_b32 v205, 16, v61
    v_and_b32 v206, s5, v61
    v_fmac_f32 v227, v203, v205
    v_fmac_f32 v227, v204, v206
    v_add_f32_dpp v226, v226, v226 row_shr:1 row_mask:0xf bank_mask:0xf bound_ctrl:0
    s_nop 0
    v_add_f32_dpp v227, v227, v227 row_shr:1 row_mask:0xf bank_mask:0xf bound_ctrl:0
    s_waitcnt lgkmcnt(4)
    v_mfma_f32_32x32x16_bf16 v[148:163], v[88:91], v[92:95], v[148:163]
    v_add_f32_dpp v226, v226, v226 row_shr:2 row_mask:0xf bank_mask:0xf bound_ctrl:0
    v_add_f32_dpp v227, v227, v227 row_shr:2 row_mask:0xf bank_mask:0xf bound_ctrl:0
    s_nop 0
    v_add_f32_dpp v226, v226, v226 row_shr:4 row_mask:0xf bank_mask:0xf bound_ctrl:0
    v_add_f32_dpp v227, v227, v227 row_shr:4 row_mask:0xf bank_mask:0xf bound_ctrl:0
    s_nop 0
    v_add_f32_dpp v226, v226, v226 row_shr:8 row_mask:0xf bank_mask:0xf bound_ctrl:0
    v_add_f32_dpp v227, v227, v227 row_shr:8 row_mask:0xf bank_mask:0xf bound_ctrl:0
    s_nop 0
    v_add_f32_dpp v226, v226, v226 row_bcast:15 row_mask:0xa bank_mask:0xf
    v_add_f32_dpp v227, v227, v227 row_bcast:15 row_mask:0xa bank_mask:0xf
    v_mfma_f32_32x32x16_bf16 v[164:179], v[88:91], v[96:99], v[164:179]
    v_add_f32_dpp v226, v226, v226 row_bcast:31 row_mask:0xc bank_mask:0xf
    v_add_f32_dpp v227, v227, v227 row_bcast:31 row_mask:0xc bank_mask:0xf
    v_cvt_pk_bf16_f32 v203, v226, v227
    v_lshlrev_b32 v226, 16, v203
    v_and_b32 v227, s5, v203
    v_mul_f32 v226, 0xbfb8aa3b, v226
    v_mul_f32 v227, 0xbfb8aa3b, v227
    v_exp_f32 v226, v226
    s_waitcnt lgkmcnt(0)
    s_waitcnt vmcnt(16)
    s_barrier
    s_add_u32 s51, s51, 128
    s_and_b32 s51, s51, 0x7ff
    s_add_u32 s52, s47, s51
    s_add_u32 m0, s49, 65536
    v_mfma_f32_32x32x16_bf16 v[116:131], v[100:103], v[108:111], v[116:131]
    ds_read_b128 v[84:87], v70 offset:32768
    ds_read_b128 v[92:95], v78 offset:32768
    buffer_load_dwordx4 v8, s[56:59], s52 offen  lds
    v_exp_f32 v227, v227
    v_add_f32 v226, 1.0, v226
    v_add_f32 v227, 1.0, v227
    v_rcp_f32 v226, v226
    s_add_u32 m0, s49, 66560
    v_mfma_f32_32x32x16_bf16 v[132:147], v[100:103], v[112:115], v[132:147]
    ds_read_b128 v[96:99], v78 offset:36864
    ds_read_b128 v[88:91], v70 offset:36864
    buffer_load_dwordx4 v9, s[56:59], s52 offen  lds
    v_rcp_f32 v227, v227
    s_nop 0
    v_cvt_pk_bf16_f32 v203, v226, v227
    v_lshlrev_b32 v226, 16, v203
    v_and_b32 v227, s5, v203
    s_add_u32 m0, s49, 67584
    v_mfma_f32_32x32x16_bf16 v[148:163], v[104:107], v[108:111], v[148:163]
    buffer_load_dwordx4 v10, s[56:59], s52 offen  lds
    v_sub_f32 v228, 1.0, v226
    v_sub_f32 v229, 1.0, v227
    v_cvt_pk_bf16_f32 v203, v228, v229
    v_lshlrev_b32 v228, 16, v203
    v_and_b32 v229, s5, v203
    s_add_u32 m0, s49, 68608
    v_mfma_f32_32x32x16_bf16 v[164:179], v[104:107], v[112:115], v[164:179]
    buffer_load_dwordx4 v11, s[56:59], s52 offen  lds
    s_add_u32 s53, s48, s51
    s_add_u32 m0, s49, 81920
    s_waitcnt lgkmcnt(2)
    v_mfma_f32_32x32x16_bf16 v[116:131], v[84:87], v[92:95], v[116:131]
    ds_read_b128 v[100:103], v71 offset:32768
    ds_read_b128 v[108:111], v79 offset:32768
    buffer_load_dwordx4 v12, s[60:63], s53 offen  lds
    s_add_u32 m0, s49, 82944
    s_waitcnt lgkmcnt(3)
    v_mfma_f32_32x32x16_bf16 v[132:147], v[84:87], v[96:99], v[132:147]
    ds_read_b128 v[112:115], v79 offset:36864
    ds_read_b128 v[104:107], v71 offset:36864
    buffer_load_dwordx4 v13, s[60:63], s53 offen  lds
    s_add_u32 m0, s49, 83968
    s_waitcnt lgkmcnt(4)
    v_mfma_f32_32x32x16_bf16 v[148:163], v[88:91], v[92:95], v[148:163]
    buffer_load_dwordx4 v14, s[60:63], s53 offen  lds
    s_add_u32 m0, s49, 84992
    v_mfma_f32_32x32x16_bf16 v[164:179], v[88:91], v[96:99], v[164:179]
    buffer_load_dwordx4 v15, s[60:63], s53 offen  lds
    s_mov_b32 m0, s4
    s_waitcnt lgkmcnt(2)
    v_mfma_f32_32x32x16_bf16 v[116:131], v[100:103], v[108:111], v[116:131]
    ds_read_b128 v[84:87], v72 offset:32768
    ds_read_b128 v[92:95], v80 offset:32768
    buffer_load_dwordx4 v17, s[64:67], s54 offen lds
    s_waitcnt lgkmcnt(3)
    v_mfma_f32_32x32x16_bf16 v[132:147], v[100:103], v[112:115], v[132:147]
    ds_read_b128 v[96:99], v80 offset:36864
    ds_read_b128 v[88:91], v72 offset:36864
    buffer_load_dwordx4 v[18:21], v18, s[68:71], 0 offen
    s_waitcnt lgkmcnt(4)
    v_mfma_f32_32x32x16_bf16 v[148:163], v[104:107], v[108:111], v[148:163]
    buffer_load_dwordx4 v[22:25], v22, s[68:71], 0 offen
    v_mfma_f32_32x32x16_bf16 v[164:179], v[104:107], v[112:115], v[164:179]
    buffer_load_dwordx4 v[26:29], v26, s[68:71], 0 offen
    s_waitcnt lgkmcnt(2)
    v_mfma_f32_32x32x16_bf16 v[116:131], v[84:87], v[92:95], v[116:131]
    ds_read_b128 v[100:103], v73 offset:32768
    ds_read_b128 v[108:111], v81 offset:32768
    buffer_load_dwordx4 v[30:33], v16, s[68:71], 0 offen offset:0
    s_waitcnt lgkmcnt(3)
    v_mfma_f32_32x32x16_bf16 v[132:147], v[84:87], v[96:99], v[132:147]
    ds_read_b128 v[112:115], v81 offset:36864
    ds_read_b128 v[104:107], v73 offset:36864
    buffer_load_dwordx4 v[34:37], v16, s[68:71], 0 offen offset:2048
    s_waitcnt lgkmcnt(4)
    v_mfma_f32_32x32x16_bf16 v[148:163], v[88:91], v[92:95], v[148:163]
    buffer_load_dwordx4 v[38:41], v16, s[68:71], s50 offen offset:0
    v_mfma_f32_32x32x16_bf16 v[164:179], v[88:91], v[96:99], v[164:179]
    buffer_load_dwordx4 v[42:45], v16, s[68:71], s50 offen offset:2048
    s_waitcnt lgkmcnt(0)
    s_waitcnt vmcnt(24)
    s_barrier
    v_mfma_f32_32x32x16_bf16 v[116:131], v[100:103], v[108:111], v[116:131]
    ds_read_b128 v[84:87], v66 offset:0
    ds_read_b128 v[92:95], v74 offset:0
    buffer_load_dwordx4 v[46:49], v16, s[72:75], 0 offen offset:0
    v_mfma_f32_32x32x16_bf16 v[132:147], v[100:103], v[112:115], v[132:147]
    ds_read_b128 v[96:99], v74 offset:4096
    ds_read_b128 v[88:91], v66 offset:4096
    buffer_load_dwordx4 v[50:53], v16, s[72:75], 0 offen offset:2048
    v_mfma_f32_32x32x16_bf16 v[148:163], v[104:107], v[108:111], v[148:163]
    buffer_load_dwordx4 v[54:57], v16, s[72:75], s50 offen offset:0
    v_mfma_f32_32x32x16_bf16 v[164:179], v[104:107], v[112:115], v[164:179]
    buffer_load_dwordx4 v[58:61], v16, s[72:75], s50 offen offset:2048
    s_add_u32 s51, s51, 128
    s_and_b32 s51, s51, 0x7ff
    s_add_u32 s52, s47, s51
    s_add_u32 m0, s49, 98304
    s_waitcnt lgkmcnt(2)
    v_mfma_f32_32x32x16_bf16 v[116:131], v[84:87], v[92:95], v[116:131]
    ds_read_b128 v[100:103], v67 offset:0
    ds_read_b128 v[108:111], v75 offset:0
    buffer_load_dwordx4 v8, s[56:59], s52 offen  lds
    s_add_u32 m0, s49, 99328
    s_waitcnt lgkmcnt(3)
    v_mfma_f32_32x32x16_bf16 v[132:147], v[84:87], v[96:99], v[132:147]
    ds_read_b128 v[112:115], v75 offset:4096
    ds_read_b128 v[104:107], v67 offset:4096
    buffer_load_dwordx4 v9, s[56:59], s52 offen  lds
    s_add_u32 m0, s49, 100352
    s_waitcnt lgkmcnt(4)
    v_mfma_f32_32x32x16_bf16 v[148:163], v[88:91], v[92:95], v[148:163]
    buffer_load_dwordx4 v10, s[56:59], s52 offen  lds
    s_add_u32 m0, s49, 101376
    v_mfma_f32_32x32x16_bf16 v[164:179], v[88:91], v[96:99], v[164:179]
    buffer_load_dwordx4 v11, s[56:59], s52 offen  lds
    s_add_u32 s53, s48, s51
    s_add_u32 m0, s49, 114688
    s_waitcnt lgkmcnt(2)
    v_mfma_f32_32x32x16_bf16 v[116:131], v[100:103], v[108:111], v[116:131]
    ds_read_b128 v[84:87], v68 offset:0
    ds_read_b128 v[92:95], v76 offset:0
    buffer_load_dwordx4 v12, s[60:63], s53 offen  lds
    s_add_u32 m0, s49, 115712
    s_waitcnt lgkmcnt(3)
    v_mfma_f32_32x32x16_bf16 v[132:147], v[100:103], v[112:115], v[132:147]
    ds_read_b128 v[96:99], v76 offset:4096
    ds_read_b128 v[88:91], v68 offset:4096
    buffer_load_dwordx4 v13, s[60:63], s53 offen  lds
    s_add_u32 m0, s49, 116736
    s_waitcnt lgkmcnt(4)
    v_mfma_f32_32x32x16_bf16 v[148:163], v[104:107], v[108:111], v[148:163]
    buffer_load_dwordx4 v14, s[60:63], s53 offen  lds
    s_add_u32 m0, s49, 117760
    v_mfma_f32_32x32x16_bf16 v[164:179], v[104:107], v[112:115], v[164:179]
    buffer_load_dwordx4 v15, s[60:63], s53 offen  lds
    s_waitcnt lgkmcnt(2)
    v_mfma_f32_32x32x16_bf16 v[116:131], v[84:87], v[92:95], v[116:131]
    ds_read_b128 v[100:103], v69 offset:0
    ds_read_b128 v[108:111], v77 offset:0
    s_waitcnt lgkmcnt(3)
    v_mfma_f32_32x32x16_bf16 v[132:147], v[84:87], v[96:99], v[132:147]
    ds_read_b128 v[112:115], v77 offset:4096
    ds_read_b128 v[104:107], v69 offset:4096
    s_waitcnt lgkmcnt(4)
    v_mfma_f32_32x32x16_bf16 v[148:163], v[88:91], v[92:95], v[148:163]
    v_mfma_f32_32x32x16_bf16 v[164:179], v[88:91], v[96:99], v[164:179]
    s_waitcnt lgkmcnt(0)
    s_waitcnt vmcnt(28)
    s_barrier
    s_add_u32 s51, s51, 128
    s_and_b32 s51, s51, 0x7ff
    s_add_u32 s52, s47, s51
    s_add_u32 m0, s49, 0
    v_mfma_f32_32x32x16_bf16 v[116:131], v[100:103], v[108:111], v[116:131]
    ds_read_b128 v[84:87], v66 offset:32768
    ds_read_b128 v[92:95], v74 offset:32768
    buffer_load_dwordx4 v8, s[56:59], s52 offen  lds
    s_add_u32 m0, s49, 1024
    v_mfma_f32_32x32x16_bf16 v[132:147], v[100:103], v[112:115], v[132:147]
    ds_read_b128 v[96:99], v74 offset:36864
    ds_read_b128 v[88:91], v66 offset:36864
    buffer_load_dwordx4 v9, s[56:59], s52 offen  lds
    s_add_u32 m0, s49, 2048
    v_mfma_f32_32x32x16_bf16 v[148:163], v[104:107], v[108:111], v[148:163]
    buffer_load_dwordx4 v10, s[56:59], s52 offen  lds
    s_add_u32 m0, s49, 3072
    v_mfma_f32_32x32x16_bf16 v[164:179], v[104:107], v[112:115], v[164:179]
    buffer_load_dwordx4 v11, s[56:59], s52 offen  lds
    s_waitcnt lgkmcnt(2)
    v_mfma_f32_32x32x16_bf16 v[116:131], v[84:87], v[92:95], v[116:131]
    ds_read_b128 v[100:103], v67 offset:32768
    ds_read_b128 v[108:111], v75 offset:32768
    s_mov_b32 s7, 0x05040100
    s_mov_b32 s12, 0x07060302
    s_waitcnt vmcnt(23)
    s_waitcnt lgkmcnt(3)
    v_mfma_f32_32x32x16_bf16 v[132:147], v[84:87], v[96:99], v[132:147]
    ds_read_b128 v[112:115], v75 offset:36864
    ds_read_b128 v[104:107], v67 offset:36864
    ds_read_b128 v[184:187], v180 offset:0
    s_add_u32 s53, s48, s51
    s_add_u32 m0, s49, 16384
    s_waitcnt lgkmcnt(5)
    v_mfma_f32_32x32x16_bf16 v[148:163], v[88:91], v[92:95], v[148:163]
    buffer_load_dwordx4 v12, s[60:63], s53 offen  lds
    ds_read_b128 v[188:191], v180 offset:16
    s_waitcnt vmcnt(22)
    v_perm_b32 v196, v18, v22, s7
    s_waitcnt vmcnt(21)
    v_perm_b32 v197, v22, v26, s7
    s_add_u32 m0, s49, 17408
    v_mfma_f32_32x32x16_bf16 v[164:179], v[88:91], v[96:99], v[164:179]
    buffer_load_dwordx4 v13, s[60:63], s53 offen  lds
    s_waitcnt vmcnt(21)
    v_perm_b32 v198, v26, v30, s7
    s_waitcnt vmcnt(20)
    v_perm_b32 v199, v30, v34, s7
    s_waitcnt vmcnt(19)
    v_perm_b32 v200, v34, v38, s7
    s_waitcnt vmcnt(18)
    v_perm_b32 v201, v38, v42, s7
    s_waitcnt lgkmcnt(4)
    v_mfma_f32_32x32x16_bf16 v[116:131], v[100:103], v[108:111], v[116:131]
    ds_read_b128 v[84:87], v68 offset:32768
    ds_read_b128 v[92:95], v76 offset:32768
    s_waitcnt vmcnt(17)
    v_lshlrev_b32 v192, 16, v46
    s_waitcnt vmcnt(16)
    v_lshlrev_b32 v193, 16, v50
    s_waitcnt vmcnt(15)
    v_lshlrev_b32 v194, 16, v54
    s_waitcnt lgkmcnt(5)
    v_mfma_f32_32x32x16_bf16 v[132:147], v[100:103], v[112:115], v[132:147]
    ds_read_b128 v[96:99], v76 offset:36864
    ds_read_b128 v[88:91], v68 offset:36864
    s_waitcnt vmcnt(14)
    v_lshlrev_b32 v195, 16, v58
    s_waitcnt lgkmcnt(5)
    v_dot2_f32_bf16 v203, v196, v185, 0
    s_add_u32 m0, s49, 18432
    v_mfma_f32_32x32x16_bf16 v[148:163], v[104:107], v[108:111], v[148:163]
    buffer_load_dwordx4 v14, s[60:63], s53 offen  lds
    v_dot2_f32_bf16 v204, v197, v185, 0
    v_dot2_f32_bf16 v205, v198, v185, 0
    v_dot2_f32_bf16 v206, v199, v185, 0
    s_add_u32 m0, s49, 19456
    v_mfma_f32_32x32x16_bf16 v[164:179], v[104:107], v[112:115], v[164:179]
    buffer_load_dwordx4 v15, s[60:63], s53 offen  lds
    v_dot2c_f32_bf16 v203, v198, v184
    v_dot2c_f32_bf16 v204, v199, v184
    v_dot2c_f32_bf16 v205, v200, v184
    v_dot2c_f32_bf16 v206, v201, v184
    s_waitcnt lgkmcnt(2)
    v_mfma_f32_32x32x16_bf16 v[116:131], v[84:87], v[92:95], v[116:131]
    ds_read_b128 v[100:103], v69 offset:32768
    ds_read_b128 v[108:111], v77 offset:32768
    v_mul_f32 v203, v203, v192
    v_mul_f32 v204, v204, v193
    v_mul_f32 v205, v205, v194
    s_waitcnt lgkmcnt(3)
    v_mfma_f32_32x32x16_bf16 v[132:147], v[84:87], v[96:99], v[132:147]
    ds_read_b128 v[112:115], v77 offset:36864
    ds_read_b128 v[104:107], v69 offset:36864
    v_mul_f32 v206, v206, v195
    v_cvt_pk_bf16_f32 v210, v206, v205
    v_cvt_pk_bf16_f32 v211, v204, v203
    s_waitcnt lgkmcnt(4)
    v_mfma_f32_32x32x16_bf16 v[148:163], v[88:91], v[92:95], v[148:163]
    v_perm_b32 v196, v18, v22, s12
    v_perm_b32 v197, v22, v26, s12
    v_perm_b32 v198, v26, v30, s12
    v_perm_b32 v199, v30, v34, s12
    v_perm_b32 v200, v34, v38, s12
    v_mfma_f32_32x32x16_bf16 v[164:179], v[88:91], v[96:99], v[164:179]
    v_perm_b32 v201, v38, v42, s12
    v_and_b32 v192, s5, v46
    v_and_b32 v193, s5, v50
    v_and_b32 v194, s5, v54
    v_and_b32 v195, s5, v58
    s_waitcnt lgkmcnt(0)
    s_barrier
    v_mfma_f32_32x32x16_bf16 v[116:131], v[100:103], v[108:111], v[116:131]
    ds_read_b128 v[84:87], v70 offset:0
    ds_read_b128 v[92:95], v78 offset:0
    v_dot2_f32_bf16 v203, v196, v187, 0
    v_dot2_f32_bf16 v204, v197, v187, 0
    v_dot2_f32_bf16 v205, v198, v187, 0
    v_mfma_f32_32x32x16_bf16 v[132:147], v[100:103], v[112:115], v[132:147]
    ds_read_b128 v[96:99], v78 offset:4096
    ds_read_b128 v[88:91], v70 offset:4096
    s_add_u32 s51, s51, 128
    s_and_b32 s51, s51, 0x7ff
    s_add_u32 s52, s47, s51
    s_add_u32 m0, s49, 32768
    v_mfma_f32_32x32x16_bf16 v[148:163], v[104:107], v[108:111], v[148:163]
    buffer_load_dwordx4 v8, s[56:59], s52 offen  lds
    v_dot2_f32_bf16 v206, v199, v187, 0
    v_dot2c_f32_bf16 v203, v198, v186
    v_dot2c_f32_bf16 v204, v199, v186
    s_add_u32 m0, s49, 33792
    v_mfma_f32_32x32x16_bf16 v[164:179], v[104:107], v[112:115], v[164:179]
    buffer_load_dwordx4 v9, s[56:59], s52 offen  lds
    v_dot2c_f32_bf16 v205, v200, v186
    v_dot2c_f32_bf16 v206, v201, v186
    v_mul_f32 v203, v203, v192
    v_mul_f32 v204, v204, v193
    s_waitcnt lgkmcnt(2)
    v_mfma_f32_32x32x16_bf16 v[116:131], v[84:87], v[92:95], v[116:131]
    ds_read_b128 v[100:103], v71 offset:0
    ds_read_b128 v[108:111], v79 offset:0
    v_mul_f32 v205, v205, v194
    v_mul_f32 v206, v206, v195
    v_cvt_pk_bf16_f32 v208, v206, v205
    s_waitcnt lgkmcnt(3)
    v_mfma_f32_32x32x16_bf16 v[132:147], v[84:87], v[96:99], v[132:147]
    ds_read_b128 v[112:115], v79 offset:4096
    ds_read_b128 v[104:107], v71 offset:4096
    v_cvt_pk_bf16_f32 v209, v204, v203
    ds_read_b128 v[184:187], v180 offset:32
    s_add_u32 m0, s49, 34816
    s_waitcnt lgkmcnt(5)
    v_mfma_f32_32x32x16_bf16 v[148:163], v[88:91], v[92:95], v[148:163]
    buffer_load_dwordx4 v10, s[56:59], s52 offen  lds
    v_perm_b32 v196, v19, v23, s7
    v_perm_b32 v197, v23, v27, s7
    v_permlane32_swap_b32 v210, v208
    s_add_u32 m0, s49, 35840
    v_mfma_f32_32x32x16_bf16 v[164:179], v[88:91], v[96:99], v[164:179]
    buffer_load_dwordx4 v11, s[56:59], s52 offen  lds
    v_permlane32_swap_b32 v211, v209
    v_perm_b32 v198, v27, v31, s7
    v_perm_b32 v199, v31, v35, s7
    v_perm_b32 v200, v35, v39, s7
    s_waitcnt lgkmcnt(3)
    v_mfma_f32_32x32x16_bf16 v[116:131], v[100:103], v[108:111], v[116:131]
    ds_read_b128 v[84:87], v72 offset:0
    ds_read_b128 v[92:95], v80 offset:0
    v_perm_b32 v201, v39, v43, s7
    v_lshlrev_b32 v192, 16, v47
    v_lshlrev_b32 v193, 16, v51
    s_waitcnt lgkmcnt(4)
    v_mfma_f32_32x32x16_bf16 v[132:147], v[100:103], v[112:115], v[132:147]
    ds_read_b128 v[96:99], v80 offset:4096
    ds_read_b128 v[88:91], v72 offset:4096
    v_lshlrev_b32 v194, 16, v55
    s_add_u32 s53, s48, s51
    s_add_u32 m0, s49, 49152
    s_waitcnt lgkmcnt(5)
    v_mfma_f32_32x32x16_bf16 v[148:163], v[104:107], v[108:111], v[148:163]
    buffer_load_dwordx4 v12, s[60:63], s53 offen  lds
    v_lshlrev_b32 v195, 16, v59
    v_dot2_f32_bf16 v203, v196, v189, 0
    v_dot2_f32_bf16 v204, v197, v189, 0
    s_add_u32 m0, s49, 50176
    v_mfma_f32_32x32x16_bf16 v[164:179], v[104:107], v[112:115], v[164:179]
    buffer_load_dwordx4 v13, s[60:63], s53 offen  lds
    v_dot2_f32_bf16 v205, v198, v189, 0
    v_dot2_f32_bf16 v206, v199, v189, 0
    v_dot2c_f32_bf16 v203, v198, v188
    v_dot2c_f32_bf16 v204, v199, v188
    s_waitcnt lgkmcnt(2)
    v_mfma_f32_32x32x16_bf16 v[116:131], v[84:87], v[92:95], v[116:131]
    ds_read_b128 v[100:103], v73 offset:0
    ds_read_b128 v[108:111], v81 offset:0
    v_dot2c_f32_bf16 v205, v200, v188
    v_dot2c_f32_bf16 v206, v201, v188
    v_mul_f32 v203, v203, v192
    s_waitcnt lgkmcnt(3)
    v_mfma_f32_32x32x16_bf16 v[132:147], v[84:87], v[96:99], v[132:147]
    ds_read_b128 v[112:115], v81 offset:4096
    ds_read_b128 v[104:107], v73 offset:4096
    v_mul_f32 v204, v204, v193
    v_mul_f32 v205, v205, v194
    s_add_u32 m0, s49, 51200
    s_waitcnt lgkmcnt(4)
    v_mfma_f32_32x32x16_bf16 v[148:163], v[88:91], v[92:95], v[148:163]
    buffer_load_dwordx4 v14, s[60:63], s53 offen  lds
    v_mul_f32 v206, v206, v195
    v_cvt_pk_bf16_f32 v214, v206, v205
    v_cvt_pk_bf16_f32 v215, v204, v203
    s_add_u32 m0, s49, 52224
    v_mfma_f32_32x32x16_bf16 v[164:179], v[88:91], v[96:99], v[164:179]
    buffer_load_dwordx4 v15, s[60:63], s53 offen  lds
    v_perm_b32 v196, v19, v23, s12
    v_perm_b32 v197, v23, v27, s12
    v_perm_b32 v198, v27, v31, s12
    v_perm_b32 v199, v31, v35, s12
    s_waitcnt lgkmcnt(0)
    s_waitcnt vmcnt(16)
    s_barrier
    v_mfma_f32_32x32x16_bf16 v[116:131], v[100:103], v[108:111], v[116:131]
    ds_read_b128 v[84:87], v70 offset:32768
    ds_read_b128 v[92:95], v78 offset:32768
    v_perm_b32 v200, v35, v39, s12
    v_perm_b32 v201, v39, v43, s12
    v_and_b32 v192, s5, v47
    v_mfma_f32_32x32x16_bf16 v[132:147], v[100:103], v[112:115], v[132:147]
    ds_read_b128 v[96:99], v78 offset:36864
    ds_read_b128 v[88:91], v70 offset:36864
    s_add_u32 s51, s51, 128
    s_and_b32 s51, s51, 0x7ff
    s_add_u32 s52, s47, s51
    s_add_u32 m0, s49, 65536
    v_mfma_f32_32x32x16_bf16 v[148:163], v[104:107], v[108:111], v[148:163]
    buffer_load_dwordx4 v8, s[56:59], s52 offen  lds
    v_and_b32 v193, s5, v51
    v_and_b32 v194, s5, v55
    v_and_b32 v195, s5, v59
    s_add_u32 m0, s49, 66560
    v_mfma_f32_32x32x16_bf16 v[164:179], v[104:107], v[112:115], v[164:179]
    buffer_load_dwordx4 v9, s[56:59], s52 offen  lds
    v_dot2_f32_bf16 v203, v196, v191, 0
    v_dot2_f32_bf16 v204, v197, v191, 0
    v_dot2_f32_bf16 v205, v198, v191, 0
    v_dot2_f32_bf16 v206, v199, v191, 0
    s_waitcnt lgkmcnt(2)
    v_mfma_f32_32x32x16_bf16 v[116:131], v[84:87], v[92:95], v[116:131]
    ds_read_b128 v[100:103], v71 offset:32768
    ds_read_b128 v[108:111], v79 offset:32768
    v_dot2c_f32_bf16 v203, v198, v190
    v_dot2c_f32_bf16 v204, v199, v190
    s_add_u32 m0, s49, 67584
    s_waitcnt lgkmcnt(3)
    v_mfma_f32_32x32x16_bf16 v[132:147], v[84:87], v[96:99], v[132:147]
    ds_read_b128 v[112:115], v79 offset:36864
    ds_read_b128 v[104:107], v71 offset:36864
    buffer_load_dwordx4 v10, s[56:59], s52 offen  lds
    v_dot2c_f32_bf16 v205, v200, v190
    s_add_u32 m0, s49, 68608
    s_waitcnt lgkmcnt(4)
    v_mfma_f32_32x32x16_bf16 v[148:163], v[88:91], v[92:95], v[148:163]
    buffer_load_dwordx4 v11, s[56:59], s52 offen  lds
    v_dot2c_f32_bf16 v206, v201, v190
    v_mul_f32 v203, v203, v192
    s_add_u32 s53, s48, s51
    s_add_u32 m0, s49, 81920
    v_mfma_f32_32x32x16_bf16 v[164:179], v[88:91], v[96:99], v[164:179]
    buffer_load_dwordx4 v12, s[60:63], s53 offen  lds
    v_mul_f32 v204, v204, v193
    v_mul_f32 v205, v205, v194
    v_mul_f32 v206, v206, v195
    v_cvt_pk_bf16_f32 v212, v206, v205
    s_waitcnt lgkmcnt(2)
    v_mfma_f32_32x32x16_bf16 v[116:131], v[100:103], v[108:111], v[116:131]
    ds_read_b128 v[84:87], v72 offset:32768
    ds_read_b128 v[92:95], v80 offset:32768
    v_cvt_pk_bf16_f32 v213, v204, v203
    ds_read_b128 v[188:191], v180 offset:48
    s_add_u32 m0, s49, 82944
    s_waitcnt lgkmcnt(4)
    v_mfma_f32_32x32x16_bf16 v[132:147], v[100:103], v[112:115], v[132:147]
    ds_read_b128 v[96:99], v80 offset:36864
    ds_read_b128 v[88:91], v72 offset:36864
    buffer_load_dwordx4 v13, s[60:63], s53 offen  lds
    v_perm_b32 v196, v20, v24, s7
    s_add_u32 m0, s49, 83968
    s_waitcnt lgkmcnt(5)
    v_mfma_f32_32x32x16_bf16 v[148:163], v[104:107], v[108:111], v[148:163]
    buffer_load_dwordx4 v14, s[60:63], s53 offen  lds
    v_perm_b32 v197, v24, v28, s7
    v_permlane32_swap_b32 v214, v212
    v_permlane32_swap_b32 v215, v213
    s_add_u32 m0, s49, 84992
    v_mfma_f32_32x32x16_bf16 v[164:179], v[104:107], v[112:115], v[164:179]
    buffer_load_dwordx4 v15, s[60:63], s53 offen  lds
    v_perm_b32 v198, v28, v32, s7
    v_perm_b32 v199, v32, v36, s7
    v_perm_b32 v200, v36, v40, s7
    v_perm_b32 v201, v40, v44, s7
    s_waitcnt lgkmcnt(3)
    v_mfma_f32_32x32x16_bf16 v[116:131], v[84:87], v[92:95], v[116:131]
    ds_read_b128 v[100:103], v73 offset:32768
    ds_read_b128 v[108:111], v81 offset:32768
    v_lshlrev_b32 v192, 16, v48
    v_lshlrev_b32 v193, 16, v52
    s_add_u32 m0, s16, 0
    s_waitcnt lgkmcnt(3)
    v_mfma_f32_32x32x16_bf16 v[132:147], v[84:87], v[96:99], v[132:147]
    ds_read_b128 v[112:115], v81 offset:36864
    ds_read_b128 v[104:107], v73 offset:36864
    buffer_load_dwordx4 v224, s[80:83], s14 offen  lds
    v_lshlrev_b32 v194, 16, v56
    s_add_u32 m0, s16, 1024
    s_waitcnt lgkmcnt(4)
    v_mfma_f32_32x32x16_bf16 v[148:163], v[88:91], v[92:95], v[148:163]
    buffer_load_dwordx4 v224, s[80:83], s15 offen  lds
    v_lshlrev_b32 v195, 16, v60
    v_dot2_f32_bf16 v203, v196, v185, 0
    v_dot2_f32_bf16 v204, v197, v185, 0
    s_add_u32 m0, s16, 2048
    v_mfma_f32_32x32x16_bf16 v[164:179], v[88:91], v[96:99], v[164:179]
    buffer_load_dwordx4 v224, s[84:87], s14 offen  lds
    v_dot2_f32_bf16 v205, v198, v185, 0
    v_dot2_f32_bf16 v206, v199, v185, 0
    v_dot2c_f32_bf16 v203, v198, v184
    v_dot2c_f32_bf16 v204, v199, v184
    s_waitcnt lgkmcnt(0)
    s_waitcnt vmcnt(19)
    s_barrier
    v_mfma_f32_32x32x16_bf16 v[116:131], v[100:103], v[108:111], v[116:131]
    ds_read_b128 v[84:87], v66 offset:0
    ds_read_b128 v[92:95], v74 offset:0
    v_dot2c_f32_bf16 v205, v200, v184
    v_dot2c_f32_bf16 v206, v201, v184
    s_add_u32 m0, s16, 3072
    v_mfma_f32_32x32x16_bf16 v[132:147], v[100:103], v[112:115], v[132:147]
    ds_read_b128 v[96:99], v74 offset:4096
    ds_read_b128 v[88:91], v66 offset:4096
    buffer_load_dwordx4 v224, s[84:87], s15 offen  lds
    s_add_u32 s51, s51, 128
    s_and_b32 s51, s51, 0x7ff
    s_add_u32 s52, s47, s51
    s_add_u32 m0, s49, 98304
    v_mfma_f32_32x32x16_bf16 v[148:163], v[104:107], v[108:111], v[148:163]
    buffer_load_dwordx4 v8, s[56:59], s52 offen  lds
    v_mul_f32 v203, v203, v192
    v_mul_f32 v204, v204, v193
    v_mul_f32 v205, v205, v194
    s_add_u32 m0, s49, 99328
    v_mfma_f32_32x32x16_bf16 v[164:179], v[104:107], v[112:115], v[164:179]
    buffer_load_dwordx4 v9, s[56:59], s52 offen  lds
    v_mul_f32 v206, v206, v195
    v_cvt_pk_bf16_f32 v218, v206, v205
    v_cvt_pk_bf16_f32 v219, v204, v203
    v_perm_b32 v196, v20, v24, s12
    s_waitcnt lgkmcnt(2)
    v_mfma_f32_32x32x16_bf16 v[116:131], v[84:87], v[92:95], v[116:131]
    ds_read_b128 v[100:103], v67 offset:0
    ds_read_b128 v[108:111], v75 offset:0
    v_perm_b32 v197, v24, v28, s12
    v_perm_b32 v198, v28, v32, s12
    v_perm_b32 v199, v32, v36, s12
    s_waitcnt lgkmcnt(3)
    v_mfma_f32_32x32x16_bf16 v[132:147], v[84:87], v[96:99], v[132:147]
    ds_read_b128 v[112:115], v75 offset:4096
    ds_read_b128 v[104:107], v67 offset:4096
    v_perm_b32 v200, v36, v40, s12
    v_perm_b32 v201, v40, v44, s12
    s_add_u32 m0, s49, 100352
    s_waitcnt lgkmcnt(4)
    v_mfma_f32_32x32x16_bf16 v[148:163], v[88:91], v[92:95], v[148:163]
    buffer_load_dwordx4 v10, s[56:59], s52 offen  lds
    v_and_b32 v192, s5, v48
    v_and_b32 v193, s5, v52
    v_and_b32 v194, s5, v56
    s_add_u32 m0, s49, 101376
    v_mfma_f32_32x32x16_bf16 v[164:179], v[88:91], v[96:99], v[164:179]
    buffer_load_dwordx4 v11, s[56:59], s52 offen  lds
    v_and_b32 v195, s5, v60
    v_dot2_f32_bf16 v203, v196, v187, 0
    v_dot2_f32_bf16 v204, v197, v187, 0
    v_dot2_f32_bf16 v205, v198, v187, 0
    s_waitcnt lgkmcnt(2)
    v_mfma_f32_32x32x16_bf16 v[116:131], v[100:103], v[108:111], v[116:131]
    ds_read_b128 v[84:87], v68 offset:0
    ds_read_b128 v[92:95], v76 offset:0
    v_dot2_f32_bf16 v206, v199, v187, 0
    v_dot2c_f32_bf16 v203, v198, v186
    v_dot2c_f32_bf16 v204, v199, v186
    s_waitcnt lgkmcnt(3)
    v_mfma_f32_32x32x16_bf16 v[132:147], v[100:103], v[112:115], v[132:147]
    ds_read_b128 v[96:99], v76 offset:4096
    ds_read_b128 v[88:91], v68 offset:4096
    v_dot2c_f32_bf16 v205, v200, v186
    s_add_u32 s53, s48, s51
    s_add_u32 m0, s49, 114688
    s_waitcnt lgkmcnt(4)
    v_mfma_f32_32x32x16_bf16 v[148:163], v[104:107], v[108:111], v[148:163]
    buffer_load_dwordx4 v12, s[60:63], s53 offen  lds
    v_dot2c_f32_bf16 v206, v201, v186
    v_mul_f32 v203, v203, v192
    v_mul_f32 v204, v204, v193
    s_add_u32 m0, s49, 115712
    v_mfma_f32_32x32x16_bf16 v[164:179], v[104:107], v[112:115], v[164:179]
    buffer_load_dwordx4 v13, s[60:63], s53 offen  lds
    v_mul_f32 v205, v205, v194
    v_mul_f32 v206, v206, v195
    v_cvt_pk_bf16_f32 v216, v206, v205
    v_cvt_pk_bf16_f32 v217, v204, v203
    s_waitcnt lgkmcnt(2)
    v_mfma_f32_32x32x16_bf16 v[116:131], v[84:87], v[92:95], v[116:131]
    ds_read_b128 v[100:103], v69 offset:0
    ds_read_b128 v[108:111], v77 offset:0
    v_perm_b32 v196, v21, v25, s7
    v_perm_b32 v197, v25, v29, s7
    v_permlane32_swap_b32 v218, v216
    s_waitcnt lgkmcnt(3)
    v_mfma_f32_32x32x16_bf16 v[132:147], v[84:87], v[96:99], v[132:147]
    ds_read_b128 v[112:115], v77 offset:4096
    ds_read_b128 v[104:107], v69 offset:4096
    v_permlane32_swap_b32 v219, v217
    v_perm_b32 v198, v29, v33, s7
    s_add_u32 m0, s49, 116736
    s_waitcnt lgkmcnt(4)
    v_mfma_f32_32x32x16_bf16 v[148:163], v[88:91], v[92:95], v[148:163]
    buffer_load_dwordx4 v14, s[60:63], s53 offen  lds
    v_perm_b32 v199, v33, v37, s7
    v_perm_b32 v200, v37, v41, s7
    v_perm_b32 v201, v41, v45, s7
    s_add_u32 m0, s49, 117760
    v_mfma_f32_32x32x16_bf16 v[164:179], v[88:91], v[96:99], v[164:179]
    buffer_load_dwordx4 v15, s[60:63], s53 offen  lds
    v_lshlrev_b32 v192, 16, v49
    v_lshlrev_b32 v193, 16, v53
    v_lshlrev_b32 v194, 16, v57
    v_lshlrev_b32 v195, 16, v61
    s_waitcnt lgkmcnt(0)
    s_waitcnt vmcnt(20)
    s_barrier
    v_mfma_f32_32x32x16_bf16 v[116:131], v[100:103], v[108:111], v[116:131]
    ds_read_b128 v[84:87], v66 offset:32768
    ds_read_b128 v[92:95], v74 offset:32768
    v_dot2_f32_bf16 v203, v196, v189, 0
    v_dot2_f32_bf16 v204, v197, v189, 0
    v_dot2_f32_bf16 v205, v198, v189, 0
    v_mfma_f32_32x32x16_bf16 v[132:147], v[100:103], v[112:115], v[132:147]
    ds_read_b128 v[96:99], v74 offset:36864
    ds_read_b128 v[88:91], v66 offset:36864
    s_add_u32 s51, s51, 128
    s_and_b32 s51, s51, 0x7ff
    s_add_u32 s52, s47, s51
    s_add_u32 m0, s49, 0
    v_mfma_f32_32x32x16_bf16 v[148:163], v[104:107], v[108:111], v[148:163]
    buffer_load_dwordx4 v8, s[56:59], s52 offen  lds
    v_dot2_f32_bf16 v206, v199, v189, 0
    v_dot2c_f32_bf16 v203, v198, v188
    v_dot2c_f32_bf16 v204, v199, v188
    s_add_u32 m0, s49, 1024
    v_mfma_f32_32x32x16_bf16 v[164:179], v[104:107], v[112:115], v[164:179]
    buffer_load_dwordx4 v9, s[56:59], s52 offen  lds
    v_dot2c_f32_bf16 v205, v200, v188
    v_dot2c_f32_bf16 v206, v201, v188
    v_mul_f32 v203, v203, v192
    v_mul_f32 v204, v204, v193
    s_waitcnt lgkmcnt(2)
    v_mfma_f32_32x32x16_bf16 v[116:131], v[84:87], v[92:95], v[116:131]
    ds_read_b128 v[100:103], v67 offset:32768
    ds_read_b128 v[108:111], v75 offset:32768
    v_mul_f32 v205, v205, v194
    v_mul_f32 v206, v206, v195
    v_cvt_pk_bf16_f32 v222, v206, v205
    s_waitcnt lgkmcnt(3)
    v_mfma_f32_32x32x16_bf16 v[132:147], v[84:87], v[96:99], v[132:147]
    ds_read_b128 v[112:115], v75 offset:36864
    ds_read_b128 v[104:107], v67 offset:36864
    v_cvt_pk_bf16_f32 v223, v204, v203
    v_perm_b32 v196, v21, v25, s12
    s_add_u32 m0, s49, 2048
    s_waitcnt lgkmcnt(4)
    v_mfma_f32_32x32x16_bf16 v[148:163], v[88:91], v[92:95], v[148:163]
    buffer_load_dwordx4 v10, s[56:59], s52 offen  lds
    v_perm_b32 v197, v25, v29, s12
    v_perm_b32 v198, v29, v33, s12
    v_perm_b32 v199, v33, v37, s12
    s_add_u32 m0, s49, 3072
    v_mfma_f32_32x32x16_bf16 v[164:179], v[88:91], v[96:99], v[164:179]
    buffer_load_dwordx4 v11, s[56:59], s52 offen  lds
    v_perm_b32 v200, v37, v41, s12
    v_perm_b32 v201, v41, v45, s12
    v_and_b32 v192, s5, v49
    v_and_b32 v193, s5, v53
    s_waitcnt lgkmcnt(2)
    v_mfma_f32_32x32x16_bf16 v[116:131], v[100:103], v[108:111], v[116:131]
    ds_read_b128 v[84:87], v68 offset:32768
    ds_read_b128 v[92:95], v76 offset:32768
    v_and_b32 v194, s5, v57
    v_and_b32 v195, s5, v61
    v_dot2_f32_bf16 v203, v196, v191, 0
    s_waitcnt lgkmcnt(3)
    v_mfma_f32_32x32x16_bf16 v[132:147], v[100:103], v[112:115], v[132:147]
    ds_read_b128 v[96:99], v76 offset:36864
    ds_read_b128 v[88:91], v68 offset:36864
    v_dot2_f32_bf16 v204, v197, v191, 0
    s_add_u32 s53, s48, s51
    s_add_u32 m0, s49, 16384
    s_waitcnt lgkmcnt(4)
    v_mfma_f32_32x32x16_bf16 v[148:163], v[104:107], v[108:111], v[148:163]
    buffer_load_dwordx4 v12, s[60:63], s53 offen  lds
    v_dot2_f32_bf16 v205, v198, v191, 0
    v_dot2_f32_bf16 v206, v199, v191, 0
    v_dot2c_f32_bf16 v203, v198, v190
    s_add_u32 m0, s49, 17408
    v_mfma_f32_32x32x16_bf16 v[164:179], v[104:107], v[112:115], v[164:179]
    buffer_load_dwordx4 v13, s[60:63], s53 offen  lds
    v_dot2c_f32_bf16 v204, v199, v190
    v_dot2c_f32_bf16 v205, v200, v190
    v_dot2c_f32_bf16 v206, v201, v190
    v_mul_f32 v203, v203, v192
    s_waitcnt lgkmcnt(2)
    v_mfma_f32_32x32x16_bf16 v[116:131], v[84:87], v[92:95], v[116:131]
    ds_read_b128 v[100:103], v69 offset:32768
    ds_read_b128 v[108:111], v77 offset:32768
    v_mul_f32 v204, v204, v193
    v_mul_f32 v205, v205, v194
    v_mul_f32 v206, v206, v195
    s_waitcnt lgkmcnt(3)
    v_mfma_f32_32x32x16_bf16 v[132:147], v[84:87], v[96:99], v[132:147]
    ds_read_b128 v[112:115], v77 offset:36864
    ds_read_b128 v[104:107], v69 offset:36864
    v_cvt_pk_bf16_f32 v220, v206, v205
    v_cvt_pk_bf16_f32 v221, v204, v203
    s_add_u32 m0, s49, 18432
    s_waitcnt lgkmcnt(4)
    v_mfma_f32_32x32x16_bf16 v[148:163], v[88:91], v[92:95], v[148:163]
    buffer_load_dwordx4 v14, s[60:63], s53 offen  lds
    v_permlane32_swap_b32 v222, v220
    v_permlane32_swap_b32 v223, v221
    s_add_u32 m0, s49, 19456
    v_mfma_f32_32x32x16_bf16 v[164:179], v[88:91], v[96:99], v[164:179]
    buffer_load_dwordx4 v15, s[60:63], s53 offen  lds
    s_waitcnt lgkmcnt(0)
    s_waitcnt vmcnt(20)
    s_barrier
    v_mfma_f32_32x32x16_bf16 v[116:131], v[100:103], v[108:111], v[116:131]
    ds_read_b128 v[84:87], v70 offset:0
    ds_read_b128 v[92:95], v78 offset:0
    v_mfma_f32_32x32x16_bf16 v[132:147], v[100:103], v[112:115], v[132:147]
    ds_read_b128 v[96:99], v78 offset:4096
    ds_read_b128 v[88:91], v70 offset:4096
    s_add_u32 s51, s51, 128
    s_and_b32 s51, s51, 0x7ff
    s_add_u32 s52, s47, s51
    s_add_u32 m0, s49, 32768
    v_mfma_f32_32x32x16_bf16 v[148:163], v[104:107], v[108:111], v[148:163]
    buffer_load_dwordx4 v8, s[56:59], s52 offen  lds
    s_add_u32 m0, s49, 33792
    v_mfma_f32_32x32x16_bf16 v[164:179], v[104:107], v[112:115], v[164:179]
    buffer_load_dwordx4 v9, s[56:59], s52 offen  lds
    s_waitcnt lgkmcnt(2)
    v_mfma_f32_32x32x16_bf16 v[116:131], v[84:87], v[92:95], v[116:131]
    ds_read_b128 v[100:103], v71 offset:0
    ds_read_b128 v[108:111], v79 offset:0
    s_waitcnt lgkmcnt(3)
    v_mfma_f32_32x32x16_bf16 v[132:147], v[84:87], v[96:99], v[132:147]
    ds_read_b128 v[112:115], v79 offset:4096
    ds_read_b128 v[104:107], v71 offset:4096
    s_add_u32 m0, s49, 34816
    s_waitcnt lgkmcnt(4)
    v_mfma_f32_32x32x16_bf16 v[148:163], v[88:91], v[92:95], v[148:163]
    buffer_load_dwordx4 v10, s[56:59], s52 offen  lds
    s_add_u32 m0, s49, 35840
    v_mfma_f32_32x32x16_bf16 v[164:179], v[88:91], v[96:99], v[164:179]
    buffer_load_dwordx4 v11, s[56:59], s52 offen  lds
    s_waitcnt lgkmcnt(2)
    v_mfma_f32_32x32x16_bf16 v[116:131], v[100:103], v[108:111], v[116:131]
    ds_read_b128 v[84:87], v72 offset:0
    ds_read_b128 v[92:95], v80 offset:0
    s_waitcnt lgkmcnt(3)
    v_mfma_f32_32x32x16_bf16 v[132:147], v[100:103], v[112:115], v[132:147]
    ds_read_b128 v[96:99], v80 offset:4096
    ds_read_b128 v[88:91], v72 offset:4096
    s_add_u32 s53, s48, s51
    s_add_u32 m0, s49, 49152
    s_waitcnt lgkmcnt(4)
    v_mfma_f32_32x32x16_bf16 v[148:163], v[104:107], v[108:111], v[148:163]
    buffer_load_dwordx4 v12, s[60:63], s53 offen  lds
    s_add_u32 m0, s49, 50176
    v_mfma_f32_32x32x16_bf16 v[164:179], v[104:107], v[112:115], v[164:179]
    buffer_load_dwordx4 v13, s[60:63], s53 offen  lds
    s_waitcnt lgkmcnt(2)
    v_mfma_f32_32x32x16_bf16 v[116:131], v[84:87], v[92:95], v[116:131]
    ds_read_b128 v[100:103], v73 offset:0
    ds_read_b128 v[108:111], v81 offset:0
    s_waitcnt lgkmcnt(3)
    v_mfma_f32_32x32x16_bf16 v[132:147], v[84:87], v[96:99], v[132:147]
    ds_read_b128 v[112:115], v81 offset:4096
    ds_read_b128 v[104:107], v73 offset:4096
    s_add_u32 m0, s49, 51200
    s_waitcnt lgkmcnt(4)
    v_mfma_f32_32x32x16_bf16 v[148:163], v[88:91], v[92:95], v[148:163]
    buffer_load_dwordx4 v14, s[60:63], s53 offen  lds
    s_add_u32 m0, s49, 52224
    v_mfma_f32_32x32x16_bf16 v[164:179], v[88:91], v[96:99], v[164:179]
    buffer_load_dwordx4 v15, s[60:63], s53 offen  lds
    s_waitcnt lgkmcnt(0)
    s_waitcnt vmcnt(16)
    s_barrier
    v_mfma_f32_32x32x16_bf16 v[116:131], v[100:103], v[108:111], v[116:131]
    ds_read_b128 v[84:87], v70 offset:32768
    ds_read_b128 v[92:95], v78 offset:32768
    v_mov_b32 v3, 0
    buffer_load_dwordx2 v[4:5], v3, s[24:27], 0 offen sc0 sc1
    v_mfma_f32_32x32x16_bf16 v[132:147], v[100:103], v[112:115], v[132:147]
    ds_read_b128 v[96:99], v78 offset:36864
    ds_read_b128 v[88:91], v70 offset:36864
    s_add_u32 s51, s51, 128
    s_and_b32 s51, s51, 0x7ff
    s_add_u32 s52, s47, s51
    s_add_u32 m0, s49, 65536
    v_mfma_f32_32x32x16_bf16 v[148:163], v[104:107], v[108:111], v[148:163]
    buffer_load_dwordx4 v8, s[56:59], s52 offen  lds
    buffer_store_dwordx4 v[208:211], v181, s[8:11], s6 offen sc0 sc1
    s_add_u32 m0, s49, 66560
    v_mfma_f32_32x32x16_bf16 v[164:179], v[104:107], v[112:115], v[164:179]
    buffer_load_dwordx4 v9, s[56:59], s52 offen  lds
    s_add_u32 s6, s6, 32768
    buffer_store_dwordx4 v[212:215], v181, s[8:11], s6 offen sc0 sc1
    s_waitcnt lgkmcnt(2)
    v_mfma_f32_32x32x16_bf16 v[116:131], v[84:87], v[92:95], v[116:131]
    ds_read_b128 v[100:103], v71 offset:32768
    ds_read_b128 v[108:111], v79 offset:32768
    s_add_u32 s6, s6, 32768
    buffer_store_dwordx4 v[216:219], v181, s[8:11], s6 offen sc0 sc1
    s_waitcnt lgkmcnt(3)
    v_mfma_f32_32x32x16_bf16 v[132:147], v[84:87], v[96:99], v[132:147]
    ds_read_b128 v[112:115], v79 offset:36864
    ds_read_b128 v[104:107], v71 offset:36864
    s_add_u32 s6, s6, 32768
    s_add_u32 m0, s49, 67584
    s_waitcnt lgkmcnt(4)
    v_mfma_f32_32x32x16_bf16 v[148:163], v[88:91], v[92:95], v[148:163]
    buffer_load_dwordx4 v10, s[56:59], s52 offen  lds
    buffer_store_dwordx4 v[220:223], v181, s[8:11], s6 offen sc0 sc1
    s_add_u32 m0, s49, 68608
    v_mfma_f32_32x32x16_bf16 v[164:179], v[88:91], v[96:99], v[164:179]
    buffer_load_dwordx4 v11, s[56:59], s52 offen  lds
    s_mov_b64 s[30:31], exec
    s_mov_b32 exec_lo, 0
    s_mov_b32 exec_hi, 0x80000000
    buffer_store_dwordx2 v[226:227], v225, s[8:11], 0 offen sc0 sc1
    buffer_store_dwordx2 v[228:229], v225, s[8:11], s32 offen sc0 sc1
    s_mov_b64 exec, s[30:31]
    s_waitcnt lgkmcnt(2)
    v_mfma_f32_32x32x16_bf16 v[116:131], v[100:103], v[108:111], v[116:131]
    ds_read_b128 v[84:87], v72 offset:32768
    ds_read_b128 v[92:95], v80 offset:32768
    s_waitcnt lgkmcnt(3)
    v_mfma_f32_32x32x16_bf16 v[132:147], v[100:103], v[112:115], v[132:147]
    ds_read_b128 v[96:99], v80 offset:36864
    ds_read_b128 v[88:91], v72 offset:36864
    s_add_u32 s53, s48, s51
    s_add_u32 m0, s49, 81920
    s_waitcnt lgkmcnt(4)
    v_mfma_f32_32x32x16_bf16 v[148:163], v[104:107], v[108:111], v[148:163]
    buffer_load_dwordx4 v12, s[60:63], s53 offen  lds
    s_add_u32 m0, s49, 82944
    v_mfma_f32_32x32x16_bf16 v[164:179], v[104:107], v[112:115], v[164:179]
    buffer_load_dwordx4 v13, s[60:63], s53 offen  lds
    s_waitcnt lgkmcnt(2)
    v_mfma_f32_32x32x16_bf16 v[116:131], v[84:87], v[92:95], v[116:131]
    ds_read_b128 v[100:103], v73 offset:32768
    ds_read_b128 v[108:111], v81 offset:32768
    s_waitcnt lgkmcnt(3)
    v_mfma_f32_32x32x16_bf16 v[132:147], v[84:87], v[96:99], v[132:147]
    ds_read_b128 v[112:115], v81 offset:36864
    ds_read_b128 v[104:107], v73 offset:36864
    s_add_u32 m0, s49, 83968
    s_waitcnt lgkmcnt(4)
    v_mfma_f32_32x32x16_bf16 v[148:163], v[88:91], v[92:95], v[148:163]
    buffer_load_dwordx4 v14, s[60:63], s53 offen  lds
    s_add_u32 m0, s49, 84992
    v_mfma_f32_32x32x16_bf16 v[164:179], v[88:91], v[96:99], v[164:179]
    buffer_load_dwordx4 v15, s[60:63], s53 offen  lds
    s_waitcnt lgkmcnt(0)
    s_waitcnt vmcnt(23)
    s_barrier
    v_mfma_f32_32x32x16_bf16 v[116:131], v[100:103], v[108:111], v[116:131]
    ds_read_b128 v[84:87], v66 offset:0
    ds_read_b128 v[92:95], v74 offset:0
    v_mfma_f32_32x32x16_bf16 v[132:147], v[100:103], v[112:115], v[132:147]
    ds_read_b128 v[96:99], v74 offset:4096
    ds_read_b128 v[88:91], v66 offset:4096
    s_add_u32 s51, s51, 128
    s_and_b32 s51, s51, 0x7ff
    s_add_u32 s52, s47, s51
    s_add_u32 m0, s49, 98304
    v_mfma_f32_32x32x16_bf16 v[148:163], v[104:107], v[108:111], v[148:163]
    buffer_load_dwordx4 v8, s[56:59], s52 offen  lds
    s_add_u32 m0, s49, 99328
    v_mfma_f32_32x32x16_bf16 v[164:179], v[104:107], v[112:115], v[164:179]
    buffer_load_dwordx4 v9, s[56:59], s52 offen  lds
    s_waitcnt lgkmcnt(2)
    v_mfma_f32_32x32x16_bf16 v[116:131], v[84:87], v[92:95], v[116:131]
    ds_read_b128 v[100:103], v67 offset:0
    ds_read_b128 v[108:111], v75 offset:0
    s_waitcnt lgkmcnt(3)
    v_mfma_f32_32x32x16_bf16 v[132:147], v[84:87], v[96:99], v[132:147]
    ds_read_b128 v[112:115], v75 offset:4096
    ds_read_b128 v[104:107], v67 offset:4096
    s_add_u32 m0, s49, 100352
    s_waitcnt lgkmcnt(4)
    v_mfma_f32_32x32x16_bf16 v[148:163], v[88:91], v[92:95], v[148:163]
    buffer_load_dwordx4 v10, s[56:59], s52 offen  lds
    s_add_u32 m0, s49, 101376
    v_mfma_f32_32x32x16_bf16 v[164:179], v[88:91], v[96:99], v[164:179]
    buffer_load_dwordx4 v11, s[56:59], s52 offen  lds
    s_waitcnt lgkmcnt(2)
    v_mfma_f32_32x32x16_bf16 v[116:131], v[100:103], v[108:111], v[116:131]
    ds_read_b128 v[84:87], v68 offset:0
    ds_read_b128 v[92:95], v76 offset:0
    s_waitcnt lgkmcnt(3)
    v_mfma_f32_32x32x16_bf16 v[132:147], v[100:103], v[112:115], v[132:147]
    ds_read_b128 v[96:99], v76 offset:4096
    ds_read_b128 v[88:91], v68 offset:4096
    s_add_u32 s53, s48, s51
    s_add_u32 m0, s49, 114688
    s_waitcnt lgkmcnt(4)
    v_mfma_f32_32x32x16_bf16 v[148:163], v[104:107], v[108:111], v[148:163]
    buffer_load_dwordx4 v12, s[60:63], s53 offen  lds
    s_add_u32 m0, s49, 115712
    v_mfma_f32_32x32x16_bf16 v[164:179], v[104:107], v[112:115], v[164:179]
    buffer_load_dwordx4 v13, s[60:63], s53 offen  lds
    s_waitcnt lgkmcnt(2)
    v_mfma_f32_32x32x16_bf16 v[116:131], v[84:87], v[92:95], v[116:131]
    ds_read_b128 v[100:103], v69 offset:0
    ds_read_b128 v[108:111], v77 offset:0
    s_waitcnt lgkmcnt(3)
    v_mfma_f32_32x32x16_bf16 v[132:147], v[84:87], v[96:99], v[132:147]
    ds_read_b128 v[112:115], v77 offset:4096
    ds_read_b128 v[104:107], v69 offset:4096
    s_add_u32 m0, s49, 116736
    s_waitcnt lgkmcnt(4)
    v_mfma_f32_32x32x16_bf16 v[148:163], v[88:91], v[92:95], v[148:163]
    buffer_load_dwordx4 v14, s[60:63], s53 offen  lds
    s_add_u32 m0, s49, 117760
    v_mfma_f32_32x32x16_bf16 v[164:179], v[88:91], v[96:99], v[164:179]
    buffer_load_dwordx4 v15, s[60:63], s53 offen  lds
    s_waitcnt lgkmcnt(0)
    s_waitcnt vmcnt(23)
    s_barrier
    v_mfma_f32_32x32x16_bf16 v[116:131], v[100:103], v[108:111], v[116:131]
    ds_read_b128 v[84:87], v66 offset:32768
    ds_read_b128 v[92:95], v74 offset:32768
    s_lshl_b32 s6, s46, 2
    s_add_u32 s6, s6, s44
    s_lshl_b32 s6, s6, 16
    s_lshl_b32 s3, s45, 12
    v_mfma_f32_32x32x16_bf16 v[132:147], v[100:103], v[112:115], v[132:147]
    ds_read_b128 v[96:99], v74 offset:36864
    ds_read_b128 v[88:91], v66 offset:36864
    s_add_u32 s6, s6, s3
    s_add_u32 s6, s6, 16777216
    s_mov_b32 s7, 0x05040100
    s_mov_b32 s12, 0x07060302
    v_mfma_f32_32x32x16_bf16 v[148:163], v[104:107], v[108:111], v[148:163]
    v_and_b32 v20, 31, v2
    v_lshlrev_b32 v18, 6, v20
    v_bfe_u32 v20, v2, 2, 2
    v_lshrrev_b32 v21, 5, v2
    v_lshlrev_b32 v21, 1, v21
    v_xor_b32 v20, v20, v21
    v_mfma_f32_32x32x16_bf16 v[164:179], v[104:107], v[112:115], v[164:179]
    v_lshl_add_u32 v18, v20, 4, v18
    v_add_u32 v18, s16, v18
    v_xor_b32 v19, 16, v18
    ds_read_b128 v[22:25], v18 offset:0
    ds_read_b128 v[26:29], v19 offset:0
    s_waitcnt lgkmcnt(4)
    v_mfma_f32_32x32x16_bf16 v[116:131], v[84:87], v[92:95], v[116:131]
    ds_read_b128 v[100:103], v67 offset:32768
    ds_read_b128 v[108:111], v75 offset:32768
    ds_read_b128 v[30:33], v18 offset:2048
    ds_read_b128 v[34:37], v19 offset:2048
    s_waitcnt lgkmcnt(1)
    v_perm_b32 v38, v30, v22, s7
    v_perm_b32 v39, v30, v22, s12
    v_mfma_f32_32x32x16_bf16 v[132:147], v[84:87], v[96:99], v[132:147]
    ds_read_b128 v[112:115], v75 offset:36864
    ds_read_b128 v[104:107], v67 offset:36864
    v_perm_b32 v40, v31, v23, s7
    v_perm_b32 v41, v31, v23, s12
    buffer_store_dwordx4 v[38:41], v17, s[8:11], s6 offen offset:0 sc0 sc1
    v_perm_b32 v42, v32, v24, s7
    v_mfma_f32_32x32x16_bf16 v[148:163], v[88:91], v[92:95], v[148:163]
    v_perm_b32 v43, v32, v24, s12
    v_perm_b32 v44, v33, v25, s7
    v_perm_b32 v45, v33, v25, s12
    buffer_store_dwordx4 v[42:45], v17, s[8:11], s6 offen offset:1024 sc0 sc1
    s_waitcnt lgkmcnt(2)
    v_perm_b32 v38, v34, v26, s7
    v_perm_b32 v39, v34, v26, s12
    v_mfma_f32_32x32x16_bf16 v[164:179], v[88:91], v[96:99], v[164:179]
    v_perm_b32 v40, v35, v27, s7
    v_perm_b32 v41, v35, v27, s12
    buffer_store_dwordx4 v[38:41], v17, s[8:11], s6 offen offset:2048 sc0 sc1
    v_perm_b32 v42, v36, v28, s7
    v_perm_b32 v43, v36, v28, s12
    v_perm_b32 v44, v37, v29, s7
    v_mfma_f32_32x32x16_bf16 v[116:131], v[100:103], v[108:111], v[116:131]
    ds_read_b128 v[84:87], v68 offset:32768
    ds_read_b128 v[92:95], v76 offset:32768
    v_perm_b32 v45, v37, v29, s12
    buffer_store_dwordx4 v[42:45], v17, s[8:11], s6 offen offset:3072 sc0 sc1
    v_subrev_u32 v50, 32, v17
    s_waitcnt lgkmcnt(3)
    v_mfma_f32_32x32x16_bf16 v[132:147], v[100:103], v[112:115], v[132:147]
    ds_read_b128 v[96:99], v76 offset:36864
    ds_read_b128 v[88:91], v68 offset:36864
    v_min_u32 v50, 0x7fff0000, v50
    v_add_u32 v51, s23, v17
    buffer_load_dwordx4 v[38:41], v50, s[76:79], 0 offen
    s_waitcnt lgkmcnt(4)
    v_mfma_f32_32x32x16_bf16 v[148:163], v[104:107], v[108:111], v[148:163]
    buffer_load_dwordx4 v[22:25], v17, s[76:79], 0 offen offset:0
    v_mfma_f32_32x32x16_bf16 v[164:179], v[104:107], v[112:115], v[164:179]
    buffer_load_dwordx4 v[26:29], v17, s[76:79], 0 offen offset:1024
    buffer_load_dwordx4 v[30:33], v17, s[76:79], 0 offen offset:2048
    s_waitcnt lgkmcnt(2)
    v_mfma_f32_32x32x16_bf16 v[116:131], v[84:87], v[92:95], v[116:131]
    ds_read_b128 v[100:103], v69 offset:32768
    ds_read_b128 v[108:111], v77 offset:32768
    buffer_load_dwordx4 v[34:37], v17, s[76:79], 0 offen offset:3072
    s_waitcnt lgkmcnt(3)
    v_mfma_f32_32x32x16_bf16 v[132:147], v[84:87], v[96:99], v[132:147]
    ds_read_b128 v[112:115], v77 offset:36864
    ds_read_b128 v[104:107], v69 offset:36864
    s_mov_b32 s88, s20
    s_mov_b32 s89, s21
    s_waitcnt lgkmcnt(4)
    v_mfma_f32_32x32x16_bf16 v[148:163], v[88:91], v[92:95], v[148:163]
    s_mov_b32 s90, 2048
    s_mov_b32 s91, 131072
    s_and_b32 s3, s44, 1
    s_lshl_b32 s3, s3, 5
    s_and_b32 s3, s44, 1
    s_lshl_b32 s3, s3, 6
    v_and_b32 v52, 31, v2
    v_lshl_add_u32 v52, v52, 1, s3
    s_lshl_b32 s3, s46, 7
    buffer_load_ushort v52, v52, s[88:91], s3 offen
    v_mfma_f32_32x32x16_bf16 v[164:179], v[88:91], v[96:99], v[164:179]
    s_waitcnt lgkmcnt(0)
    s_waitcnt vmcnt(18)
    s_barrier
    v_mfma_f32_32x32x16_bf16 v[116:131], v[100:103], v[108:111], v[116:131]
    ds_read_b128 v[84:87], v70 offset:0
    ds_read_b128 v[92:95], v78 offset:0
    v_and_b32 v53, 15, v2
    v_lshrrev_b32 v54, 4, v2
    v_add_u32 v55, 1, v53
    v_and_b32 v56, 1, v55
    v_mfma_f32_32x32x16_bf16 v[132:147], v[100:103], v[112:115], v[132:147]
    ds_read_b128 v[96:99], v78 offset:4096
    ds_read_b128 v[88:91], v70 offset:4096
    v_mul_u32_u24 v56, 4160, v56
    v_and_b32 v55, 30, v55
    v_lshl_add_u32 v56, v55, 1, v56
    v_lshl_add_u32 v56, v54, 4, v56
    v_mfma_f32_32x32x16_bf16 v[148:163], v[104:107], v[108:111], v[148:163]
    v_add_u32 v57, s23, v56
    v_add_u32 v63, 1024, v57
    v_add_u32 v64, 2048, v57
    v_add_u32 v65, 3072, v57
    v_lshlrev_b32 v55, 1, v53
    v_sub_u32 v55, v54, v55
    v_mfma_f32_32x32x16_bf16 v[164:179], v[104:107], v[112:115], v[164:179]
    v_add_u32 v55, 30, v55
    v_lshrrev_b32 v56, 2, v55
    v_lshlrev_b32 v55, 6, v55
    v_add_u32 v55, 132096, v55
    v_add_u32 v58, 63, v56
    v_and_b32 v58, 3, v58
    s_waitcnt lgkmcnt(2)
    v_mfma_f32_32x32x16_bf16 v[116:131], v[84:87], v[92:95], v[116:131]
    ds_read_b128 v[100:103], v71 offset:0
    ds_read_b128 v[108:111], v79 offset:0
    v_xor_b32 v58, s44, v58
    v_lshl_add_u32 v58, v58, 4, v55
    v_add_u32 v59, 62, v56
    v_and_b32 v59, 3, v59
    s_waitcnt lgkmcnt(3)
    v_mfma_f32_32x32x16_bf16 v[132:147], v[84:87], v[96:99], v[132:147]
    ds_read_b128 v[112:115], v79 offset:4096
    ds_read_b128 v[104:107], v71 offset:4096
    v_xor_b32 v59, s44, v59
    v_lshl_add_u32 v59, v59, 4, v55
    v_add_u32 v60, 61, v56
    v_and_b32 v60, 3, v60
    s_waitcnt lgkmcnt(4)
    v_mfma_f32_32x32x16_bf16 v[148:163], v[88:91], v[92:95], v[148:163]
    v_xor_b32 v60, s44, v60
    v_lshl_add_u32 v60, v60, 4, v55
    v_add_u32 v61, 60, v56
    v_and_b32 v61, 3, v61
    v_xor_b32 v61, s44, v61
    v_lshl_add_u32 v61, v61, 4, v55
    v_mfma_f32_32x32x16_bf16 v[164:179], v[88:91], v[96:99], v[164:179]
    v_lshlrev_b32 v55, 5, v53
    v_lshl_add_u32 v55, v54, 3, v55
    v_sub_u32 v55, 504, v55
    v_and_b32 v62, 8, v55
    v_lshrrev_b32 v55, 4, v55
    v_lshl_add_u32 v62, v55, 6, v62
    s_waitcnt lgkmcnt(2)
    v_mfma_f32_32x32x16_bf16 v[116:131], v[100:103], v[108:111], v[116:131]
    ds_read_b128 v[84:87], v72 offset:0
    ds_read_b128 v[92:95], v80 offset:0
    v_bfe_u32 v55, v55, 2, 2
    v_xor_b32 v55, s44, v55
    v_lshl_add_u32 v62, v55, 4, v62
    v_add_u32 v62, 132096, v62
    s_waitcnt lgkmcnt(3)
    v_mfma_f32_32x32x16_bf16 v[132:147], v[100:103], v[112:115], v[132:147]
    ds_read_b128 v[96:99], v80 offset:4096
    ds_read_b128 v[88:91], v72 offset:4096
    v_and_b32 v55, 1, v54
    v_lshlrev_b32 v55, 9, v55
    v_lshl_add_u32 v55, v53, 5, v55
    v_lshrrev_b32 v56, 1, v54
    s_waitcnt lgkmcnt(4)
    v_mfma_f32_32x32x16_bf16 v[148:163], v[104:107], v[108:111], v[148:163]
    v_lshl_add_u32 v180, v56, 4, v55
    s_mov_b32 s6, 0
    v_readfirstlane_b32 s42, v4
    v_readfirstlane_b32 s43, v5
    s_nop 3
    s_or_b32 s3, s42, s43
    s_cmp_lg_u32 s3, 0
    s_cbranch_scc1 Lnok_gate_2
Lnretry_gate_3:
    buffer_load_dwordx2 v[4:5], v3, s[24:27], 0 offen sc0 sc1
    s_waitcnt vmcnt(0)
    v_readfirstlane_b32 s42, v4
    v_readfirstlane_b32 s43, v5
    s_add_u32 s6, s6, 1
    s_nop 3
    s_or_b32 s3, s42, s43
    s_cmp_gt_u32 s6, 20000
    s_cbranch_scc1 Lnok_gate_2
    s_cmp_eq_u32 s3, 0
    s_cbranch_scc1 Lnretry_gate_3
Lnok_gate_2:
    v_mov_b32 v82, s42
    v_mov_b32 v83, s43
    s_mov_b64 s[6:7], exec
    s_mov_b64 exec, 1
    buffer_store_dwordx2 v[82:83], v6, s[8:11], s13 offen sc0 sc1
    s_mov_b64 exec, s[6:7]
    v_mfma_f32_32x32x16_bf16 v[164:179], v[104:107], v[112:115], v[164:179]
    s_waitcnt lgkmcnt(2)
    v_mfma_f32_32x32x16_bf16 v[116:131], v[84:87], v[92:95], v[116:131]
    ds_read_b128 v[100:103], v73 offset:0
    ds_read_b128 v[108:111], v81 offset:0
    s_waitcnt lgkmcnt(3)
    v_mfma_f32_32x32x16_bf16 v[132:147], v[84:87], v[96:99], v[132:147]
    ds_read_b128 v[112:115], v81 offset:4096
    ds_read_b128 v[104:107], v73 offset:4096
    s_waitcnt lgkmcnt(4)
    v_mfma_f32_32x32x16_bf16 v[148:163], v[88:91], v[92:95], v[148:163]
    v_mfma_f32_32x32x16_bf16 v[164:179], v[88:91], v[96:99], v[164:179]
    s_waitcnt lgkmcnt(0)
    s_waitcnt vmcnt(11)
    s_barrier
    v_mfma_f32_32x32x16_bf16 v[116:131], v[100:103], v[108:111], v[116:131]
    ds_read_b128 v[84:87], v70 offset:32768
    ds_read_b128 v[92:95], v78 offset:32768
    v_mfma_f32_32x32x16_bf16 v[132:147], v[100:103], v[112:115], v[132:147]
    ds_read_b128 v[96:99], v78 offset:36864
    ds_read_b128 v[88:91], v70 offset:36864
    v_mfma_f32_32x32x16_bf16 v[148:163], v[104:107], v[108:111], v[148:163]
    v_mfma_f32_32x32x16_bf16 v[164:179], v[104:107], v[112:115], v[164:179]
    s_waitcnt lgkmcnt(2)
    v_mfma_f32_32x32x16_bf16 v[116:131], v[84:87], v[92:95], v[116:131]
    ds_read_b128 v[100:103], v71 offset:32768
    ds_read_b128 v[108:111], v79 offset:32768
    s_waitcnt lgkmcnt(3)
    v_mfma_f32_32x32x16_bf16 v[132:147], v[84:87], v[96:99], v[132:147]
    ds_read_b128 v[112:115], v79 offset:36864
    ds_read_b128 v[104:107], v71 offset:36864
    s_waitcnt lgkmcnt(4)
    v_mfma_f32_32x32x16_bf16 v[148:163], v[88:91], v[92:95], v[148:163]
    v_mfma_f32_32x32x16_bf16 v[164:179], v[88:91], v[96:99], v[164:179]
    s_waitcnt lgkmcnt(2)
    v_mfma_f32_32x32x16_bf16 v[116:131], v[100:103], v[108:111], v[116:131]
    ds_read_b128 v[84:87], v72 offset:32768
    ds_read_b128 v[92:95], v80 offset:32768
    s_waitcnt lgkmcnt(3)
    v_mfma_f32_32x32x16_bf16 v[132:147], v[100:103], v[112:115], v[132:147]
    ds_read_b128 v[96:99], v80 offset:36864
    ds_read_b128 v[88:91], v72 offset:36864
    s_waitcnt lgkmcnt(4)
    v_mfma_f32_32x32x16_bf16 v[148:163], v[104:107], v[108:111], v[148:163]
    v_mfma_f32_32x32x16_bf16 v[164:179], v[104:107], v[112:115], v[164:179]
    s_waitcnt lgkmcnt(2)
    v_mfma_f32_32x32x16_bf16 v[116:131], v[84:87], v[92:95], v[116:131]
    ds_read_b128 v[100:103], v73 offset:32768
    ds_read_b128 v[108:111], v81 offset:32768
    s_waitcnt lgkmcnt(3)
    v_mfma_f32_32x32x16_bf16 v[132:147], v[84:87], v[96:99], v[132:147]
    ds_read_b128 v[112:115], v81 offset:36864
    ds_read_b128 v[104:107], v73 offset:36864
    s_waitcnt lgkmcnt(4)
    v_mfma_f32_32x32x16_bf16 v[148:163], v[88:91], v[92:95], v[148:163]
    v_mfma_f32_32x32x16_bf16 v[164:179], v[88:91], v[96:99], v[164:179]
    s_waitcnt lgkmcnt(0)
    v_mfma_f32_32x32x16_bf16 v[116:131], v[100:103], v[108:111], v[116:131]
    v_mfma_f32_32x32x16_bf16 v[132:147], v[100:103], v[112:115], v[132:147]
    v_mfma_f32_32x32x16_bf16 v[148:163], v[104:107], v[108:111], v[148:163]
    v_mfma_f32_32x32x16_bf16 v[164:179], v[104:107], v[112:115], v[164:179]
    s_waitcnt vmcnt(7)
    v_mov_b32 v82, s42
    v_mov_b32 v83, s43
    s_mov_b64 s[6:7], exec
    s_mov_b64 exec, 1
    buffer_store_dwordx2 v[82:83], v6, s[8:11], s18 offen sc0 sc1
    s_mov_b64 exec, s[6:7]
    s_nop 2
    v_pk_fma_f32 v[10:11], v[132:133], v[230:231], v[118:119] op_sel:[0,1,0] op_sel_hi:[1,1,1] neg_lo:[0,1,0] neg_hi:[0,1,0]
    v_pk_fma_f32 v[12:13], v[116:117], v[230:231], v[134:135] op_sel:[0,1,0] op_sel_hi:[1,1,1]
    v_pk_fma_f32 v[4:5], v[116:117], v[230:231], v[10:11] op_sel:[0,0,0] op_sel_hi:[1,0,1]
    v_pk_fma_f32 v[8:9], v[132:133], v[230:231], v[12:13] op_sel:[0,0,0] op_sel_hi:[1,0,1]
    v_pk_fma_f32 v[10:11], v[8:9], v[230:231], v[120:121] op_sel:[0,1,0] op_sel_hi:[1,1,1] neg_lo:[0,1,0] neg_hi:[0,1,0]
    v_pk_fma_f32 v[12:13], v[4:5], v[230:231], v[136:137] op_sel:[0,1,0] op_sel_hi:[1,1,1]
    v_pk_fma_f32 v[4:5], v[4:5], v[230:231], v[10:11] op_sel:[0,0,0] op_sel_hi:[1,0,1]
    v_pk_fma_f32 v[8:9], v[8:9], v[230:231], v[12:13] op_sel:[0,0,0] op_sel_hi:[1,0,1]
    v_pk_fma_f32 v[10:11], v[8:9], v[230:231], v[122:123] op_sel:[0,1,0] op_sel_hi:[1,1,1] neg_lo:[0,1,0] neg_hi:[0,1,0]
    v_pk_fma_f32 v[12:13], v[4:5], v[230:231], v[138:139] op_sel:[0,1,0] op_sel_hi:[1,1,1]
    v_pk_fma_f32 v[4:5], v[4:5], v[230:231], v[10:11] op_sel:[0,0,0] op_sel_hi:[1,0,1]
    v_pk_fma_f32 v[8:9], v[8:9], v[230:231], v[12:13] op_sel:[0,0,0] op_sel_hi:[1,0,1]
    v_pk_fma_f32 v[10:11], v[8:9], v[230:231], v[124:125] op_sel:[0,1,0] op_sel_hi:[1,1,1] neg_lo:[0,1,0] neg_hi:[0,1,0]
    v_pk_fma_f32 v[12:13], v[4:5], v[230:231], v[140:141] op_sel:[0,1,0] op_sel_hi:[1,1,1]
    v_pk_fma_f32 v[4:5], v[4:5], v[230:231], v[10:11] op_sel:[0,0,0] op_sel_hi:[1,0,1]
    v_pk_fma_f32 v[8:9], v[8:9], v[230:231], v[12:13] op_sel:[0,0,0] op_sel_hi:[1,0,1]
    v_pk_fma_f32 v[10:11], v[8:9], v[230:231], v[126:127] op_sel:[0,1,0] op_sel_hi:[1,1,1] neg_lo:[0,1,0] neg_hi:[0,1,0]
    v_pk_fma_f32 v[12:13], v[4:5], v[230:231], v[142:143] op_sel:[0,1,0] op_sel_hi:[1,1,1]
    v_pk_fma_f32 v[4:5], v[4:5], v[230:231], v[10:11] op_sel:[0,0,0] op_sel_hi:[1,0,1]
    v_pk_fma_f32 v[8:9], v[8:9], v[230:231], v[12:13] op_sel:[0,0,0] op_sel_hi:[1,0,1]
    v_pk_fma_f32 v[10:11], v[8:9], v[230:231], v[128:129] op_sel:[0,1,0] op_sel_hi:[1,1,1] neg_lo:[0,1,0] neg_hi:[0,1,0]
    v_pk_fma_f32 v[12:13], v[4:5], v[230:231], v[144:145] op_sel:[0,1,0] op_sel_hi:[1,1,1]
    v_pk_fma_f32 v[4:5], v[4:5], v[230:231], v[10:11] op_sel:[0,0,0] op_sel_hi:[1,0,1]
    v_pk_fma_f32 v[8:9], v[8:9], v[230:231], v[12:13] op_sel:[0,0,0] op_sel_hi:[1,0,1]
    v_pk_fma_f32 v[10:11], v[8:9], v[230:231], v[130:131] op_sel:[0,1,0] op_sel_hi:[1,1,1] neg_lo:[0,1,0] neg_hi:[0,1,0]
    v_pk_fma_f32 v[12:13], v[4:5], v[230:231], v[146:147] op_sel:[0,1,0] op_sel_hi:[1,1,1]
    v_pk_fma_f32 v[4:5], v[4:5], v[230:231], v[10:11] op_sel:[0,0,0] op_sel_hi:[1,0,1]
    v_pk_fma_f32 v[8:9], v[8:9], v[230:231], v[12:13] op_sel:[0,0,0] op_sel_hi:[1,0,1]
    v_pk_fma_f32 v[10:11], v[8:9], v[230:231], v[148:149] op_sel:[0,1,0] op_sel_hi:[1,1,1] neg_lo:[0,1,0] neg_hi:[0,1,0]
    v_pk_fma_f32 v[12:13], v[4:5], v[230:231], v[164:165] op_sel:[0,1,0] op_sel_hi:[1,1,1]
    v_pk_fma_f32 v[4:5], v[4:5], v[230:231], v[10:11] op_sel:[0,0,0] op_sel_hi:[1,0,1]
    v_pk_fma_f32 v[8:9], v[8:9], v[230:231], v[12:13] op_sel:[0,0,0] op_sel_hi:[1,0,1]
    v_pk_fma_f32 v[10:11], v[8:9], v[230:231], v[150:151] op_sel:[0,1,0] op_sel_hi:[1,1,1] neg_lo:[0,1,0] neg_hi:[0,1,0]
    v_pk_fma_f32 v[12:13], v[4:5], v[230:231], v[166:167] op_sel:[0,1,0] op_sel_hi:[1,1,1]
    v_pk_fma_f32 v[4:5], v[4:5], v[230:231], v[10:11] op_sel:[0,0,0] op_sel_hi:[1,0,1]
    v_pk_fma_f32 v[8:9], v[8:9], v[230:231], v[12:13] op_sel:[0,0,0] op_sel_hi:[1,0,1]
    v_pk_fma_f32 v[10:11], v[8:9], v[230:231], v[152:153] op_sel:[0,1,0] op_sel_hi:[1,1,1] neg_lo:[0,1,0] neg_hi:[0,1,0]
    v_pk_fma_f32 v[12:13], v[4:5], v[230:231], v[168:169] op_sel:[0,1,0] op_sel_hi:[1,1,1]
    v_pk_fma_f32 v[4:5], v[4:5], v[230:231], v[10:11] op_sel:[0,0,0] op_sel_hi:[1,0,1]
    v_pk_fma_f32 v[8:9], v[8:9], v[230:231], v[12:13] op_sel:[0,0,0] op_sel_hi:[1,0,1]
    v_pk_fma_f32 v[10:11], v[8:9], v[230:231], v[154:155] op_sel:[0,1,0] op_sel_hi:[1,1,1] neg_lo:[0,1,0] neg_hi:[0,1,0]
    v_pk_fma_f32 v[12:13], v[4:5], v[230:231], v[170:171] op_sel:[0,1,0] op_sel_hi:[1,1,1]
    v_pk_fma_f32 v[4:5], v[4:5], v[230:231], v[10:11] op_sel:[0,0,0] op_sel_hi:[1,0,1]
    v_pk_fma_f32 v[8:9], v[8:9], v[230:231], v[12:13] op_sel:[0,0,0] op_sel_hi:[1,0,1]
    v_pk_fma_f32 v[10:11], v[8:9], v[230:231], v[156:157] op_sel:[0,1,0] op_sel_hi:[1,1,1] neg_lo:[0,1,0] neg_hi:[0,1,0]
    v_pk_fma_f32 v[12:13], v[4:5], v[230:231], v[172:173] op_sel:[0,1,0] op_sel_hi:[1,1,1]
    v_pk_fma_f32 v[4:5], v[4:5], v[230:231], v[10:11] op_sel:[0,0,0] op_sel_hi:[1,0,1]
    v_pk_fma_f32 v[8:9], v[8:9], v[230:231], v[12:13] op_sel:[0,0,0] op_sel_hi:[1,0,1]
    v_pk_fma_f32 v[10:11], v[8:9], v[230:231], v[158:159] op_sel:[0,1,0] op_sel_hi:[1,1,1] neg_lo:[0,1,0] neg_hi:[0,1,0]
    v_pk_fma_f32 v[12:13], v[4:5], v[230:231], v[174:175] op_sel:[0,1,0] op_sel_hi:[1,1,1]
    v_pk_fma_f32 v[4:5], v[4:5], v[230:231], v[10:11] op_sel:[0,0,0] op_sel_hi:[1,0,1]
    v_pk_fma_f32 v[8:9], v[8:9], v[230:231], v[12:13] op_sel:[0,0,0] op_sel_hi:[1,0,1]
    v_pk_fma_f32 v[10:11], v[8:9], v[230:231], v[160:161] op_sel:[0,1,0] op_sel_hi:[1,1,1] neg_lo:[0,1,0] neg_hi:[0,1,0]
    v_pk_fma_f32 v[12:13], v[4:5], v[230:231], v[176:177] op_sel:[0,1,0] op_sel_hi:[1,1,1]
    v_pk_fma_f32 v[4:5], v[4:5], v[230:231], v[10:11] op_sel:[0,0,0] op_sel_hi:[1,0,1]
    v_pk_fma_f32 v[8:9], v[8:9], v[230:231], v[12:13] op_sel:[0,0,0] op_sel_hi:[1,0,1]
    v_pk_fma_f32 v[10:11], v[8:9], v[230:231], v[162:163] op_sel:[0,1,0] op_sel_hi:[1,1,1] neg_lo:[0,1,0] neg_hi:[0,1,0]
    v_pk_fma_f32 v[12:13], v[4:5], v[230:231], v[178:179] op_sel:[0,1,0] op_sel_hi:[1,1,1]
    v_pk_fma_f32 v[4:5], v[4:5], v[230:231], v[10:11] op_sel:[0,0,0] op_sel_hi:[1,0,1]
    v_pk_fma_f32 v[8:9], v[8:9], v[230:231], v[12:13] op_sel:[0,0,0] op_sel_hi:[1,0,1]
    v_lshrrev_b32 v3, 5, v2
    v_lshlrev_b32 v3, 10, v3
    v_lshl_add_u32 v1, v7, 2, v3
    s_lshr_b32 s3, s44, 1
    s_lshl_b32 s3, s3, 11
    s_add_u32 s3, s3, 150528
    v_add_u32 v1, s3, v1
    ds_write2st64_b32 v1, v4, v8 offset0:12 offset1:13
    ds_write2st64_b32 v1, v5, v9 offset0:14 offset1:15
    s_waitcnt lgkmcnt(0)
    s_barrier
    ds_read2st64_b32 v[66:67], v1 offset0:0 offset1:1
    ds_read2st64_b32 v[68:69], v1 offset0:2 offset1:3
    ds_read2st64_b32 v[70:71], v1 offset0:4 offset1:5
    ds_read2st64_b32 v[72:73], v1 offset0:6 offset1:7
    ds_read2st64_b32 v[74:75], v1 offset0:8 offset1:9
    ds_read2st64_b32 v[76:77], v1 offset0:10 offset1:11
    s_waitcnt lgkmcnt(4)
    v_fma_f32 v20, -v235, v67, v68
    v_fma_f32 v21, v235, v66, v69
    v_fma_f32 v68, v234, v66, v20
    v_fma_f32 v69, v234, v67, v21
    s_waitcnt lgkmcnt(3)
    v_fma_f32 v20, -v235, v69, v70
    v_fma_f32 v21, v235, v68, v71
    v_fma_f32 v70, v234, v68, v20
    v_fma_f32 v71, v234, v69, v21
    s_waitcnt lgkmcnt(2)
    v_fma_f32 v20, -v235, v71, v72
    v_fma_f32 v21, v235, v70, v73
    v_fma_f32 v72, v234, v70, v20
    v_fma_f32 v73, v234, v71, v21
    s_waitcnt lgkmcnt(1)
    v_fma_f32 v20, -v235, v73, v74
    v_fma_f32 v21, v235, v72, v75
    v_fma_f32 v74, v234, v72, v20
    v_fma_f32 v75, v234, v73, v21
    s_waitcnt lgkmcnt(0)
    v_fma_f32 v20, -v235, v75, v76
    v_fma_f32 v21, v235, v74, v77
    v_fma_f32 v76, v234, v74, v20
    v_fma_f32 v77, v234, v75, v21
    v_fma_f32 v20, -v235, v77, v4
    v_fma_f32 v21, v235, v76, v8
    v_fma_f32 v14, v234, v76, v20
    v_fma_f32 v15, v234, v77, v21
    v_fma_f32 v20, -v235, v15, v5
    v_fma_f32 v21, v235, v14, v9
    v_fma_f32 v54, v234, v14, v20
    v_fma_f32 v55, v234, v15, v21
    v_mov_b32 v84, v76
    v_mov_b32 v85, v14
    v_mov_b32 v86, v77
    v_mov_b32 v87, v15
    s_lshl_b32 s3, s46, 14
    s_add_u32 s3, s3, 21037056
    s_add_u32 s48, s40, s3
    s_addc_u32 s49, s41, 0
    s_mov_b32 s50, 16384
    s_mov_b32 s51, 131072
    v_lshlrev_b32 v1, 4, v7
    s_lshl_b32 s4, s45, 10
    s_lshr_b32 s3, s44, 1
    s_cmp_eq_u32 s3, 0
    s_cbranch_scc1 Lnopub_gate_4
    v_mov_b32 v66, v54
    v_mov_b32 v67, v55
    v_mov_b32 v68, s42
    v_mov_b32 v69, s43
    s_mov_b64 s[6:7], exec
    s_mov_b64 exec, s[34:35]
    buffer_store_dwordx4 v[66:69], v1, s[48:51], s4 offen sc0 sc1
    s_mov_b64 exec, s[6:7]
    s_nop 1
Lnopub_gate_4:
    s_lshl_b32 s3, s46, 2
    s_add_u32 s3, s3, s44
    s_lshl_b32 s3, s3, 7
    s_add_u32 s3, s3, 21504000
    v_and_b32 v3, 15, v2
    v_lshlrev_b32 v3, 3, v3
    v_add_u32 v3, s3, v3
    v_lshrrev_b32 v9, 5, v2
    v_lshlrev_b32 v9, 10, v9
    v_sub_u32 v9, v1, v9
    s_sub_u32 s3, s4, 1024
    v_add_u32 v8, s3, v9
    v_mul_f32 v14, v237, v237
    v_fma_f32 v14, v236, v236, -v14
    v_mul_f32 v15, v236, v237
    v_add_f32 v15, v15, v15
    v_lshrrev_b32 v9, 5, v2
    v_sub_u32 v9, s45, v9
    v_add_u32 v9, 1, v9
    v_lshrrev_b32 v16, 1, v9
    s_lshl_b32 s3, s46, 2
    s_add_u32 s3, s3, s44
    s_lshl_b32 s6, s3, 16
    s_add_u32 s6, s6, 16777216
    s_lshl_b32 s7, s46, 12
    s_and_b32 s3, s46, 7
    s_lshl_b32 s3, s3, 2
    s_lshl_b32 s13, -1, s3
    s_and_b32 s13, s13, 0x01111111
    s_add_u32 s13, s13, 0x06543210
    s_bitcmp1_b32 s46, 3
    s_cselect_b32 s17, 0x08888888, 0
    s_add_u32 s13, s13, s17
    s_bitcmp1_b32 s46, 3
    s_cselect_b32 s17, 0, 0x88888888
    s_add_u32 s16, s17, 0x76543210
    s_lshl_b32 s17, s16, 28
    s_or_b32 s14, s13, s17
    s_lshr_b32 s15, s16, 4
    buffer_load_dwordx2 v[82:83], v182, s[8:11], 0 offen sc0 sc1
    v_pk_mul_f32 v[10:11], v[132:133], v[232:233] op_sel:[0,1] op_sel_hi:[1,1] neg_lo:[0,1] neg_hi:[0,1]
    v_pk_mul_f32 v[12:13], v[116:117], v[232:233] op_sel:[0,1] op_sel_hi:[1,1]
    v_pk_fma_f32 v[116:117], v[116:117], v[232:233], v[10:11] op_sel:[0,0,0] op_sel_hi:[1,0,1]
    v_pk_fma_f32 v[132:133], v[132:133], v[232:233], v[12:13] op_sel:[0,0,0] op_sel_hi:[1,0,1]
    v_pk_mul_f32 v[10:11], v[134:135], v[232:233] op_sel:[0,1] op_sel_hi:[1,1] neg_lo:[0,1] neg_hi:[0,1]
    v_pk_mul_f32 v[12:13], v[118:119], v[232:233] op_sel:[0,1] op_sel_hi:[1,1]
    v_pk_fma_f32 v[118:119], v[118:119], v[232:233], v[10:11] op_sel:[0,0,0] op_sel_hi:[1,0,1]
    v_pk_fma_f32 v[134:135], v[134:135], v[232:233], v[12:13] op_sel:[0,0,0] op_sel_hi:[1,0,1]
    v_pk_mul_f32 v[10:11], v[136:137], v[232:233] op_sel:[0,1] op_sel_hi:[1,1] neg_lo:[0,1] neg_hi:[0,1]
    v_pk_mul_f32 v[12:13], v[120:121], v[232:233] op_sel:[0,1] op_sel_hi:[1,1]
    v_pk_fma_f32 v[120:121], v[120:121], v[232:233], v[10:11] op_sel:[0,0,0] op_sel_hi:[1,0,1]
    v_pk_fma_f32 v[136:137], v[136:137], v[232:233], v[12:13] op_sel:[0,0,0] op_sel_hi:[1,0,1]
    v_pk_mul_f32 v[10:11], v[138:139], v[232:233] op_sel:[0,1] op_sel_hi:[1,1] neg_lo:[0,1] neg_hi:[0,1]
    v_pk_mul_f32 v[12:13], v[122:123], v[232:233] op_sel:[0,1] op_sel_hi:[1,1]
    v_pk_fma_f32 v[122:123], v[122:123], v[232:233], v[10:11] op_sel:[0,0,0] op_sel_hi:[1,0,1]
    v_pk_fma_f32 v[138:139], v[138:139], v[232:233], v[12:13] op_sel:[0,0,0] op_sel_hi:[1,0,1]
    v_pk_mul_f32 v[10:11], v[140:141], v[232:233] op_sel:[0,1] op_sel_hi:[1,1] neg_lo:[0,1] neg_hi:[0,1]
    v_pk_mul_f32 v[12:13], v[124:125], v[232:233] op_sel:[0,1] op_sel_hi:[1,1]
    v_pk_fma_f32 v[124:125], v[124:125], v[232:233], v[10:11] op_sel:[0,0,0] op_sel_hi:[1,0,1]
    v_pk_fma_f32 v[140:141], v[140:141], v[232:233], v[12:13] op_sel:[0,0,0] op_sel_hi:[1,0,1]
    v_pk_mul_f32 v[10:11], v[142:143], v[232:233] op_sel:[0,1] op_sel_hi:[1,1] neg_lo:[0,1] neg_hi:[0,1]
    v_pk_mul_f32 v[12:13], v[126:127], v[232:233] op_sel:[0,1] op_sel_hi:[1,1]
    v_pk_fma_f32 v[126:127], v[126:127], v[232:233], v[10:11] op_sel:[0,0,0] op_sel_hi:[1,0,1]
    v_pk_fma_f32 v[142:143], v[142:143], v[232:233], v[12:13] op_sel:[0,0,0] op_sel_hi:[1,0,1]
    v_pk_mul_f32 v[10:11], v[144:145], v[232:233] op_sel:[0,1] op_sel_hi:[1,1] neg_lo:[0,1] neg_hi:[0,1]
    v_pk_mul_f32 v[12:13], v[128:129], v[232:233] op_sel:[0,1] op_sel_hi:[1,1]
    v_pk_fma_f32 v[128:129], v[128:129], v[232:233], v[10:11] op_sel:[0,0,0] op_sel_hi:[1,0,1]
    v_pk_fma_f32 v[144:145], v[144:145], v[232:233], v[12:13] op_sel:[0,0,0] op_sel_hi:[1,0,1]
    v_pk_mul_f32 v[10:11], v[146:147], v[232:233] op_sel:[0,1] op_sel_hi:[1,1] neg_lo:[0,1] neg_hi:[0,1]
    v_pk_mul_f32 v[12:13], v[130:131], v[232:233] op_sel:[0,1] op_sel_hi:[1,1]
    v_pk_fma_f32 v[130:131], v[130:131], v[232:233], v[10:11] op_sel:[0,0,0] op_sel_hi:[1,0,1]
    v_pk_fma_f32 v[146:147], v[146:147], v[232:233], v[12:13] op_sel:[0,0,0] op_sel_hi:[1,0,1]
    v_pk_mul_f32 v[10:11], v[164:165], v[232:233] op_sel:[0,1] op_sel_hi:[1,1] neg_lo:[0,1] neg_hi:[0,1]
    v_pk_mul_f32 v[12:13], v[148:149], v[232:233] op_sel:[0,1] op_sel_hi:[1,1]
    v_pk_fma_f32 v[148:149], v[148:149], v[232:233], v[10:11] op_sel:[0,0,0] op_sel_hi:[1,0,1]
    v_pk_fma_f32 v[164:165], v[164:165], v[232:233], v[12:13] op_sel:[0,0,0] op_sel_hi:[1,0,1]
    v_pk_mul_f32 v[10:11], v[166:167], v[232:233] op_sel:[0,1] op_sel_hi:[1,1] neg_lo:[0,1] neg_hi:[0,1]
    v_pk_mul_f32 v[12:13], v[150:151], v[232:233] op_sel:[0,1] op_sel_hi:[1,1]
    v_pk_fma_f32 v[150:151], v[150:151], v[232:233], v[10:11] op_sel:[0,0,0] op_sel_hi:[1,0,1]
    v_pk_fma_f32 v[166:167], v[166:167], v[232:233], v[12:13] op_sel:[0,0,0] op_sel_hi:[1,0,1]
    v_pk_mul_f32 v[10:11], v[168:169], v[232:233] op_sel:[0,1] op_sel_hi:[1,1] neg_lo:[0,1] neg_hi:[0,1]
    v_pk_mul_f32 v[12:13], v[152:153], v[232:233] op_sel:[0,1] op_sel_hi:[1,1]
    v_pk_fma_f32 v[152:153], v[152:153], v[232:233], v[10:11] op_sel:[0,0,0] op_sel_hi:[1,0,1]
    v_pk_fma_f32 v[168:169], v[168:169], v[232:233], v[12:13] op_sel:[0,0,0] op_sel_hi:[1,0,1]
    v_pk_mul_f32 v[10:11], v[170:171], v[232:233] op_sel:[0,1] op_sel_hi:[1,1] neg_lo:[0,1] neg_hi:[0,1]
    v_pk_mul_f32 v[12:13], v[154:155], v[232:233] op_sel:[0,1] op_sel_hi:[1,1]
    v_pk_fma_f32 v[154:155], v[154:155], v[232:233], v[10:11] op_sel:[0,0,0] op_sel_hi:[1,0,1]
    v_pk_fma_f32 v[170:171], v[170:171], v[232:233], v[12:13] op_sel:[0,0,0] op_sel_hi:[1,0,1]
    v_pk_mul_f32 v[10:11], v[172:173], v[232:233] op_sel:[0,1] op_sel_hi:[1,1] neg_lo:[0,1] neg_hi:[0,1]
    v_pk_mul_f32 v[12:13], v[156:157], v[232:233] op_sel:[0,1] op_sel_hi:[1,1]
    v_pk_fma_f32 v[156:157], v[156:157], v[232:233], v[10:11] op_sel:[0,0,0] op_sel_hi:[1,0,1]
    v_pk_fma_f32 v[172:173], v[172:173], v[232:233], v[12:13] op_sel:[0,0,0] op_sel_hi:[1,0,1]
    v_pk_mul_f32 v[10:11], v[174:175], v[232:233] op_sel:[0,1] op_sel_hi:[1,1] neg_lo:[0,1] neg_hi:[0,1]
    v_pk_mul_f32 v[12:13], v[158:159], v[232:233] op_sel:[0,1] op_sel_hi:[1,1]
    v_pk_fma_f32 v[158:159], v[158:159], v[232:233], v[10:11] op_sel:[0,0,0] op_sel_hi:[1,0,1]
    v_pk_fma_f32 v[174:175], v[174:175], v[232:233], v[12:13] op_sel:[0,0,0] op_sel_hi:[1,0,1]
    v_pk_mul_f32 v[10:11], v[176:177], v[232:233] op_sel:[0,1] op_sel_hi:[1,1] neg_lo:[0,1] neg_hi:[0,1]
    v_pk_mul_f32 v[12:13], v[160:161], v[232:233] op_sel:[0,1] op_sel_hi:[1,1]
    v_pk_fma_f32 v[160:161], v[160:161], v[232:233], v[10:11] op_sel:[0,0,0] op_sel_hi:[1,0,1]
    v_pk_fma_f32 v[176:177], v[176:177], v[232:233], v[12:13] op_sel:[0,0,0] op_sel_hi:[1,0,1]
    v_pk_mul_f32 v[10:11], v[178:179], v[232:233] op_sel:[0,1] op_sel_hi:[1,1] neg_lo:[0,1] neg_hi:[0,1]
    v_pk_mul_f32 v[12:13], v[162:163], v[232:233] op_sel:[0,1] op_sel_hi:[1,1]
    v_pk_fma_f32 v[162:163], v[162:163], v[232:233], v[10:11] op_sel:[0,0,0] op_sel_hi:[1,0,1]
    v_pk_fma_f32 v[178:179], v[178:179], v[232:233], v[12:13] op_sel:[0,0,0] op_sel_hi:[1,0,1]
    s_lshr_b32 s16, s44, 1
    v_lshrrev_b32 v53, 5, v2
    v_lshlrev_b32 v53, 13, v53
    v_lshl_add_u32 v9, v7, 2, v53
    s_lshl_b32 s3, s16, 14
    s_add_u32 s3, s3, 0
    v_add_u32 v9, s3, v9
    v_lshrrev_b32 v53, 4, v2
    v_lshlrev_b32 v53, 4, v53
    v_bfe_u32 v54, v2, 3, 1
    v_add_u32 v53, v53, v54
    v_and_b32 v21, 7, v2
    v_xor_b32 v54, v54, v21
    s_and_b32 s3, s44, 1
    s_lshl_b32 s3, s3, 3
    v_or_b32 v54, s3, v54
    v_lshlrev_b32 v54, 4, v54
    v_lshl_add_u32 v20, v53, 8, v54
    s_lshl_b32 s3, s16, 14
    s_add_u32 s3, s3, 0
    v_add_u32 v20, s3, v20
    v_lshlrev_b32 v21, 4, v21
    v_lshl_add_u32 v21, v53, 12, v21
    s_lshl_b32 s13, s45, 19
    s_lshl_b32 s3, s16, 18
    s_add_u32 s13, s13, s3
    s_lshl_b32 s3, s46, 8
    s_add_u32 s13, s13, s3
    s_and_b32 s3, s44, 1
    s_lshl_b32 s3, s3, 7
    s_add_u32 s13, s13, s3
    v_mov_b32 v18, 0
    s_waitcnt vmcnt(8)
    ds_write_b128 v51, v[38:41] offset:0
    v_alignbit_b32 v42, v39, v38, 16
    v_alignbit_b32 v43, v40, v39, 16
    v_mov_b32_dpp v18, v38 wave_shl:1 row_mask:0xf bank_mask:0xf
    v_alignbit_b32 v44, v41, v40, 16
    v_alignbit_b32 v45, v18, v41, 16
    ds_write_b128 v51, v[42:45] offset:4160
    v_subrev_u32 v66, 0, v8
    v_min_u32 v66, 0x7fff0000, v66
    buffer_load_dwordx4 v[66:69], v66, s[48:51], 0 offen sc0 sc1
    v_subrev_u32 v70, 2048, v8
    v_min_u32 v70, 0x7fff0000, v70
    buffer_load_dwordx4 v[70:73], v70, s[48:51], 0 offen sc0 sc1
    v_subrev_u32 v74, 4096, v8
    v_min_u32 v74, 0x7fff0000, v74
    buffer_load_dwordx4 v[74:77], v74, s[48:51], 0 offen sc0 sc1
    v_subrev_u32 v78, 6144, v8
    v_min_u32 v78, 0x7fff0000, v78
    buffer_load_dwordx4 v[78:81], v78, s[48:51], 0 offen sc0 sc1
    v_subrev_u32 v88, 8192, v8
    v_min_u32 v88, 0x7fff0000, v88
    buffer_load_dwordx4 v[88:91], v88, s[48:51], 0 offen sc0 sc1
    v_subrev_u32 v92, 10240, v8
    v_min_u32 v92, 0x7fff0000, v92
    buffer_load_dwordx4 v[92:95], v92, s[48:51], 0 offen sc0 sc1
    v_subrev_u32 v96, 12288, v8
    v_min_u32 v96, 0x7fff0000, v96
    buffer_load_dwordx4 v[96:99], v96, s[48:51], 0 offen sc0 sc1
    v_subrev_u32 v100, 14336, v8
    v_min_u32 v100, 0x7fff0000, v100
    buffer_load_dwordx4 v[100:103], v100, s[48:51], 0 offen sc0 sc1
    s_waitcnt vmcnt(14)
    v_readfirstlane_b32 s3, v26
    s_nop 1
    v_mov_b32 v19, s3
    ds_write_b128 v51, v[22:25] offset:32
    v_alignbit_b32 v46, v23, v22, 16
    v_alignbit_b32 v47, v24, v23, 16
    v_mov_b32_dpp v19, v22 wave_shl:1 row_mask:0xf bank_mask:0xf
    v_alignbit_b32 v48, v25, v24, 16
    v_alignbit_b32 v49, v19, v25, 16
    ds_write_b128 v51, v[46:49] offset:4192
    s_waitcnt vmcnt(13)
    v_readfirstlane_b32 s3, v30
    s_nop 1
    v_mov_b32 v18, s3
    ds_write_b128 v51, v[26:29] offset:1056
    v_alignbit_b32 v42, v27, v26, 16
    v_alignbit_b32 v43, v28, v27, 16
    v_mov_b32_dpp v18, v26 wave_shl:1 row_mask:0xf bank_mask:0xf
    v_alignbit_b32 v44, v29, v28, 16
    v_alignbit_b32 v45, v18, v29, 16
    ds_write_b128 v51, v[42:45] offset:5216
    s_waitcnt vmcnt(12)
    v_readfirstlane_b32 s3, v34
    s_nop 1
    v_mov_b32 v19, s3
    ds_write_b128 v51, v[30:33] offset:2080
    v_alignbit_b32 v46, v31, v30, 16
    v_alignbit_b32 v47, v32, v31, 16
    v_mov_b32_dpp v19, v30 wave_shl:1 row_mask:0xf bank_mask:0xf
    v_alignbit_b32 v48, v33, v32, 16
    v_alignbit_b32 v49, v19, v33, 16
    ds_write_b128 v51, v[46:49] offset:6240
    v_mov_b32 v18, 0
    ds_write_b128 v51, v[34:37] offset:3104
    v_alignbit_b32 v42, v35, v34, 16
    v_alignbit_b32 v43, v36, v35, 16
    v_mov_b32_dpp v18, v34 wave_shl:1 row_mask:0xf bank_mask:0xf
    v_alignbit_b32 v44, v37, v36, 16
    v_alignbit_b32 v45, v18, v37, 16
    ds_write_b128 v51, v[42:45] offset:7264
    v_lshlrev_b32 v183, 16, v183
    s_mov_b32 s18, 0
    s_waitcnt vmcnt(8)
    v_cmp_ne_u64 vcc, s[42:43], v[82:83]
    s_nop 4
    s_cbranch_vccz Lfdone_gate_5
Lfpoll_gate_6:
    buffer_load_dwordx2 v[82:83], v182, s[8:11], 0 offen sc0 sc1
    s_waitcnt vmcnt(0)
    v_cmp_ne_u64 vcc, s[42:43], v[82:83]
    s_nop 4
    s_add_u32 s18, s18, 1
    s_cmp_gt_u32 s18, 20000
    s_cbranch_scc1 Lfdone_gate_5
    s_cbranch_vccnz Lfpoll_gate_6
Lfdone_gate_5:
    s_mov_b32 m0, s29
    s_nop 0
    buffer_load_dwordx4 v207, s[8:11], s28 offen offset:0 sc0 sc1 lds
    buffer_load_dwordx4 v207, s[8:11], s28 offen offset:1024 sc0 sc1 lds
    buffer_load_dwordx4 v207, s[8:11], s28 offen offset:2048 sc0 sc1 lds
    buffer_load_dwordx4 v207, s[8:11], s28 offen offset:3072 sc0 sc1 lds
    buffer_load_dwordx2 v[4:5], v3, s[8:11], 0 offen sc0 sc1
    s_mov_b32 s16, 0
    v_mov_b32 v18, 0
    s_waitcnt vmcnt(12)
    v_cmp_eq_u64 s[60:61], s[42:43], v[68:69]
    s_waitcnt vmcnt(11)
    v_cmp_eq_u64 s[62:63], s[42:43], v[72:73]
    s_waitcnt vmcnt(10)
    v_cmp_eq_u64 s[64:65], s[42:43], v[76:77]
    s_waitcnt vmcnt(9)
    v_cmp_eq_u64 s[66:67], s[42:43], v[80:81]
    v_addc_co_u32 v18, vcc, 0, v18, s[60:61]
    v_addc_co_u32 v18, vcc, 0, v18, s[62:63]
    v_addc_co_u32 v18, vcc, 0, v18, s[64:65]
    v_addc_co_u32 v18, vcc, 0, v18, s[66:67]
    s_waitcnt vmcnt(8)
    v_cmp_eq_u64 s[60:61], s[42:43], v[90:91]
    s_waitcnt vmcnt(7)
    v_cmp_eq_u64 s[62:63], s[42:43], v[94:95]
    s_waitcnt vmcnt(6)
    v_cmp_eq_u64 s[64:65], s[42:43], v[98:99]
    s_waitcnt vmcnt(5)
    v_cmp_eq_u64 s[66:67], s[42:43], v[102:103]
    v_addc_co_u32 v18, vcc, 0, v18, s[60:61]
    v_addc_co_u32 v18, vcc, 0, v18, s[62:63]
    v_addc_co_u32 v18, vcc, 0, v18, s[64:65]
    v_addc_co_u32 v18, vcc, 0, v18, s[66:67]
    v_cmp_ne_u32 vcc, v16, v18
    s_nop 4
    s_cbranch_vccz Lpolldone_gate_7
Lpoll_gate_8:
    v_subrev_u32 v66, 0, v8
    v_min_u32 v66, 0x7fff0000, v66
    buffer_load_dwordx4 v[66:69], v66, s[48:51], 0 offen sc0 sc1
    v_subrev_u32 v70, 2048, v8
    v_min_u32 v70, 0x7fff0000, v70
    buffer_load_dwordx4 v[70:73], v70, s[48:51], 0 offen sc0 sc1
    v_subrev_u32 v74, 4096, v8
    v_min_u32 v74, 0x7fff0000, v74
    buffer_load_dwordx4 v[74:77], v74, s[48:51], 0 offen sc0 sc1
    v_subrev_u32 v78, 6144, v8
    v_min_u32 v78, 0x7fff0000, v78
    buffer_load_dwordx4 v[78:81], v78, s[48:51], 0 offen sc0 sc1
    v_subrev_u32 v88, 8192, v8
    v_min_u32 v88, 0x7fff0000, v88
    buffer_load_dwordx4 v[88:91], v88, s[48:51], 0 offen sc0 sc1
    v_subrev_u32 v92, 10240, v8
    v_min_u32 v92, 0x7fff0000, v92
    buffer_load_dwordx4 v[92:95], v92, s[48:51], 0 offen sc0 sc1
    v_subrev_u32 v96, 12288, v8
    v_min_u32 v96, 0x7fff0000, v96
    buffer_load_dwordx4 v[96:99], v96, s[48:51], 0 offen sc0 sc1
    v_subrev_u32 v100, 14336, v8
    v_min_u32 v100, 0x7fff0000, v100
    buffer_load_dwordx4 v[100:103], v100, s[48:51], 0 offen sc0 sc1
    s_waitcnt vmcnt(0) lgkmcnt(0)
    v_mov_b32 v18, 0
    v_cmp_eq_u64 s[60:61], s[42:43], v[68:69]
    v_cmp_eq_u64 s[62:63], s[42:43], v[72:73]
    v_cmp_eq_u64 s[64:65], s[42:43], v[76:77]
    v_cmp_eq_u64 s[66:67], s[42:43], v[80:81]
    v_addc_co_u32 v18, vcc, 0, v18, s[60:61]
    v_addc_co_u32 v18, vcc, 0, v18, s[62:63]
    v_addc_co_u32 v18, vcc, 0, v18, s[64:65]
    v_addc_co_u32 v18, vcc, 0, v18, s[66:67]
    v_cmp_eq_u64 s[60:61], s[42:43], v[90:91]
    v_cmp_eq_u64 s[62:63], s[42:43], v[94:95]
    v_cmp_eq_u64 s[64:65], s[42:43], v[98:99]
    v_cmp_eq_u64 s[66:67], s[42:43], v[102:103]
    v_addc_co_u32 v18, vcc, 0, v18, s[60:61]
    v_addc_co_u32 v18, vcc, 0, v18, s[62:63]
    v_addc_co_u32 v18, vcc, 0, v18, s[64:65]
    v_addc_co_u32 v18, vcc, 0, v18, s[66:67]
    v_cmp_ne_u32 vcc, v16, v18
    s_add_u32 s16, s16, 1
    s_cmp_gt_u32 s16, 20000
    s_cbranch_scc1 Lpolldone_gate_7
    s_nop 1
    s_cbranch_vccnz Lpoll_gate_8
Lpolldone_gate_7:
    s_nop 4
    v_fma_f32 v22, -v15, v101, v96
    v_fma_f32 v23, v15, v100, v97
    v_fma_f32 v96, v14, v100, v22
    v_fma_f32 v97, v14, v101, v23
    v_fma_f32 v22, -v15, v97, v92
    v_fma_f32 v23, v15, v96, v93
    v_fma_f32 v92, v14, v96, v22
    v_fma_f32 v93, v14, v97, v23
    v_fma_f32 v22, -v15, v93, v88
    v_fma_f32 v23, v15, v92, v89
    v_fma_f32 v88, v14, v92, v22
    v_fma_f32 v89, v14, v93, v23
    v_fma_f32 v22, -v15, v89, v78
    v_fma_f32 v23, v15, v88, v79
    v_fma_f32 v78, v14, v88, v22
    v_fma_f32 v79, v14, v89, v23
    v_fma_f32 v22, -v15, v79, v74
    v_fma_f32 v23, v15, v78, v75
    v_fma_f32 v74, v14, v78, v22
    v_fma_f32 v75, v14, v79, v23
    v_fma_f32 v22, -v15, v75, v70
    v_fma_f32 v23, v15, v74, v71
    v_fma_f32 v70, v14, v74, v22
    v_fma_f32 v71, v14, v75, v23
    v_fma_f32 v22, -v15, v71, v66
    v_fma_f32 v23, v15, v70, v67
    v_fma_f32 v66, v14, v70, v22
    v_fma_f32 v67, v14, v71, v23
    v_mov_b32 v70, v66
    v_mov_b32 v71, v67
    s_nop 0
    v_permlane32_swap_b32 v66, v70
    v_permlane32_swap_b32 v67, v71
    v_fma_f32 v22, -v237, v71, v66
    v_fma_f32 v23, v237, v70, v67
    v_fma_f32 v24, v236, v70, v22
    v_fma_f32 v25, v236, v71, v23
    s_mov_b32 s4, 0
    s_waitcnt vmcnt(0)
    v_cmp_ne_u64 vcc, s[42:43], v[4:5]
    s_nop 4
    s_cbranch_vccz Lfdone_gate_9
Lfpoll_gate_10:
    buffer_load_dwordx2 v[4:5], v3, s[8:11], 0 offen sc0 sc1
    s_waitcnt vmcnt(0)
    v_cmp_ne_u64 vcc, s[42:43], v[4:5]
    s_nop 4
    s_add_u32 s4, s4, 1
    s_cmp_gt_u32 s4, 20000
    s_cbranch_scc1 Lfdone_gate_9
    s_cbranch_vccnz Lfpoll_gate_10
Lfdone_gate_9:
    v_pk_fma_f32 v[10:11], v[240:241], v[24:25], v[84:85] op_sel:[0,1,0] op_sel_hi:[1,1,1] neg_lo:[0,1,0] neg_hi:[0,1,0]
    v_pk_fma_f32 v[12:13], v[238:239], v[24:25], v[86:87] op_sel:[0,1,0] op_sel_hi:[1,1,1]
    v_pk_fma_f32 v[4:5], v[238:239], v[24:25], v[10:11] op_sel:[0,0,0] op_sel_hi:[1,0,1]
    v_pk_fma_f32 v[14:15], v[240:241], v[24:25], v[12:13] op_sel:[0,0,0] op_sel_hi:[1,0,1]
    v_pk_mul_f32 v[10:11], v[14:15], v[232:233] op_sel:[0,1] op_sel_hi:[1,1] neg_lo:[0,1] neg_hi:[0,1]
    v_pk_mul_f32 v[12:13], v[4:5], v[232:233] op_sel:[0,1] op_sel_hi:[1,1]
    v_pk_fma_f32 v[4:5], v[4:5], v[232:233], v[10:11] op_sel:[0,0,0] op_sel_hi:[1,0,1]
    v_pk_fma_f32 v[14:15], v[14:15], v[232:233], v[12:13] op_sel:[0,0,0] op_sel_hi:[1,0,1]
    v_pk_fma_f32 v[10:11], v[14:15], v[230:231], v[116:117] op_sel:[0,1,0] op_sel_hi:[1,1,1] neg_lo:[0,1,0] neg_hi:[0,1,0]
    v_pk_fma_f32 v[12:13], v[4:5], v[230:231], v[132:133] op_sel:[0,1,0] op_sel_hi:[1,1,1]
    v_pk_fma_f32 v[116:117], v[4:5], v[230:231], v[10:11] op_sel:[0,0,0] op_sel_hi:[1,0,1]
    v_pk_fma_f32 v[132:133], v[14:15], v[230:231], v[12:13] op_sel:[0,0,0] op_sel_hi:[1,0,1]
    s_add_u32 s12, s6, s7
    buffer_load_dwordx4 a[0:3], v17, s[8:11], s12 offen offset:0 sc0 sc1
    v_pk_fma_f32 v[10:11], v[132:133], v[230:231], v[118:119] op_sel:[0,1,0] op_sel_hi:[1,1,1] neg_lo:[0,1,0] neg_hi:[0,1,0]
    v_pk_fma_f32 v[12:13], v[116:117], v[230:231], v[134:135] op_sel:[0,1,0] op_sel_hi:[1,1,1]
    v_pk_fma_f32 v[118:119], v[116:117], v[230:231], v[10:11] op_sel:[0,0,0] op_sel_hi:[1,0,1]
    v_pk_fma_f32 v[134:135], v[132:133], v[230:231], v[12:13] op_sel:[0,0,0] op_sel_hi:[1,0,1]
    v_cvt_pk_bf16_f32 v18, v116, -v132
    v_cvt_pk_bf16_f32 v19, v117, -v133
    ds_write2st64_b32 v9, v18, v19 offset0:0 offset1:16
    buffer_load_dwordx4 a[4:7], v17, s[8:11], s12 offen offset:1024 sc0 sc1
    v_pk_fma_f32 v[10:11], v[134:135], v[230:231], v[120:121] op_sel:[0,1,0] op_sel_hi:[1,1,1] neg_lo:[0,1,0] neg_hi:[0,1,0]
    v_pk_fma_f32 v[12:13], v[118:119], v[230:231], v[136:137] op_sel:[0,1,0] op_sel_hi:[1,1,1]
    v_pk_fma_f32 v[120:121], v[118:119], v[230:231], v[10:11] op_sel:[0,0,0] op_sel_hi:[1,0,1]
    v_pk_fma_f32 v[136:137], v[134:135], v[230:231], v[12:13] op_sel:[0,0,0] op_sel_hi:[1,0,1]
    v_xor_b32 v3, 16, v9
    v_cvt_pk_bf16_f32 v22, v118, -v134
    v_cvt_pk_bf16_f32 v23, v119, -v135
    ds_write2st64_b32 v3, v22, v23 offset0:1 offset1:17
    ds_read_b128 v[28:31], v20 offset:0
    buffer_load_dwordx4 a[8:11], v17, s[8:11], s12 offen offset:2048 sc0 sc1
    v_pk_fma_f32 v[10:11], v[136:137], v[230:231], v[122:123] op_sel:[0,1,0] op_sel_hi:[1,1,1] neg_lo:[0,1,0] neg_hi:[0,1,0]
    v_pk_fma_f32 v[12:13], v[120:121], v[230:231], v[138:139] op_sel:[0,1,0] op_sel_hi:[1,1,1]
    v_pk_fma_f32 v[122:123], v[120:121], v[230:231], v[10:11] op_sel:[0,0,0] op_sel_hi:[1,0,1]
    v_pk_fma_f32 v[138:139], v[136:137], v[230:231], v[12:13] op_sel:[0,0,0] op_sel_hi:[1,0,1]
    v_xor_b32 v1, 32, v9
    v_cvt_pk_bf16_f32 v18, v120, -v136
    v_cvt_pk_bf16_f32 v19, v121, -v137
    ds_write2st64_b32 v1, v18, v19 offset0:2 offset1:18
    s_waitcnt lgkmcnt(1)
    buffer_store_dwordx4 v[28:31], v21, s[8:11], s13 offen sc0 sc1
    buffer_load_dwordx4 a[12:15], v17, s[8:11], s12 offen offset:3072 sc0 sc1
    v_pk_fma_f32 v[10:11], v[138:139], v[230:231], v[124:125] op_sel:[0,1,0] op_sel_hi:[1,1,1] neg_lo:[0,1,0] neg_hi:[0,1,0]
    v_pk_fma_f32 v[12:13], v[122:123], v[230:231], v[140:141] op_sel:[0,1,0] op_sel_hi:[1,1,1]
    v_pk_fma_f32 v[124:125], v[122:123], v[230:231], v[10:11] op_sel:[0,0,0] op_sel_hi:[1,0,1]
    v_pk_fma_f32 v[140:141], v[138:139], v[230:231], v[12:13] op_sel:[0,0,0] op_sel_hi:[1,0,1]
    v_xor_b32 v3, 48, v9
    v_cvt_pk_bf16_f32 v22, v122, -v138
    v_cvt_pk_bf16_f32 v23, v123, -v139
    ds_write2st64_b32 v3, v22, v23 offset0:3 offset1:19
    v_xor_b32 v8, 32, v20
    ds_read_b128 v[32:35], v8 offset:512
    s_bfe_u32 s7, s14, 0x40000
    s_lshl_b32 s7, s7, 12
    s_add_u32 s12, s6, s7
    buffer_load_dwordx4 a[16:19], v17, s[8:11], s12 offen offset:0 sc0 sc1
    v_pk_fma_f32 v[10:11], v[140:141], v[230:231], v[126:127] op_sel:[0,1,0] op_sel_hi:[1,1,1] neg_lo:[0,1,0] neg_hi:[0,1,0]
    v_pk_fma_f32 v[12:13], v[124:125], v[230:231], v[142:143] op_sel:[0,1,0] op_sel_hi:[1,1,1]
    v_pk_fma_f32 v[126:127], v[124:125], v[230:231], v[10:11] op_sel:[0,0,0] op_sel_hi:[1,0,1]
    v_pk_fma_f32 v[142:143], v[140:141], v[230:231], v[12:13] op_sel:[0,0,0] op_sel_hi:[1,0,1]
    v_xor_b32 v1, 64, v9
    v_cvt_pk_bf16_f32 v18, v124, -v140
    v_cvt_pk_bf16_f32 v19, v125, -v141
    ds_write2st64_b32 v1, v18, v19 offset0:4 offset1:20
    s_add_u32 s13, s13, 8192
    s_waitcnt lgkmcnt(1)
    buffer_store_dwordx4 v[32:35], v21, s[8:11], s13 offen sc0 sc1
    buffer_load_dwordx4 a[20:23], v17, s[8:11], s12 offen offset:1024 sc0 sc1
    v_pk_fma_f32 v[10:11], v[142:143], v[230:231], v[128:129] op_sel:[0,1,0] op_sel_hi:[1,1,1] neg_lo:[0,1,0] neg_hi:[0,1,0]
    v_pk_fma_f32 v[12:13], v[126:127], v[230:231], v[144:145] op_sel:[0,1,0] op_sel_hi:[1,1,1]
    v_pk_fma_f32 v[128:129], v[126:127], v[230:231], v[10:11] op_sel:[0,0,0] op_sel_hi:[1,0,1]
    v_pk_fma_f32 v[144:145], v[142:143], v[230:231], v[12:13] op_sel:[0,0,0] op_sel_hi:[1,0,1]
    v_xor_b32 v3, 80, v9
    v_cvt_pk_bf16_f32 v22, v126, -v142
    v_cvt_pk_bf16_f32 v23, v127, -v143
    ds_write2st64_b32 v3, v22, v23 offset0:5 offset1:21
    v_xor_b32 v8, 64, v20
    ds_read_b128 v[28:31], v8 offset:1024
    buffer_load_dwordx4 a[24:27], v17, s[8:11], s12 offen offset:2048 sc0 sc1
    v_pk_fma_f32 v[10:11], v[144:145], v[230:231], v[130:131] op_sel:[0,1,0] op_sel_hi:[1,1,1] neg_lo:[0,1,0] neg_hi:[0,1,0]
    v_pk_fma_f32 v[12:13], v[128:129], v[230:231], v[146:147] op_sel:[0,1,0] op_sel_hi:[1,1,1]
    v_pk_fma_f32 v[130:131], v[128:129], v[230:231], v[10:11] op_sel:[0,0,0] op_sel_hi:[1,0,1]
    v_pk_fma_f32 v[146:147], v[144:145], v[230:231], v[12:13] op_sel:[0,0,0] op_sel_hi:[1,0,1]
    v_xor_b32 v1, 96, v9
    v_cvt_pk_bf16_f32 v18, v128, -v144
    v_cvt_pk_bf16_f32 v19, v129, -v145
    ds_write2st64_b32 v1, v18, v19 offset0:6 offset1:22
    s_add_u32 s13, s13, 8192
    s_waitcnt lgkmcnt(1)
    buffer_store_dwordx4 v[28:31], v21, s[8:11], s13 offen sc0 sc1
    buffer_load_dwordx4 a[28:31], v17, s[8:11], s12 offen offset:3072 sc0 sc1
    v_pk_fma_f32 v[10:11], v[146:147], v[230:231], v[148:149] op_sel:[0,1,0] op_sel_hi:[1,1,1] neg_lo:[0,1,0] neg_hi:[0,1,0]
    v_pk_fma_f32 v[12:13], v[130:131], v[230:231], v[164:165] op_sel:[0,1,0] op_sel_hi:[1,1,1]
    v_pk_fma_f32 v[148:149], v[130:131], v[230:231], v[10:11] op_sel:[0,0,0] op_sel_hi:[1,0,1]
    v_pk_fma_f32 v[164:165], v[146:147], v[230:231], v[12:13] op_sel:[0,0,0] op_sel_hi:[1,0,1]
    v_xor_b32 v3, 112, v9
    v_cvt_pk_bf16_f32 v22, v130, -v146
    v_cvt_pk_bf16_f32 v23, v131, -v147
    ds_write2st64_b32 v3, v22, v23 offset0:7 offset1:23
    v_xor_b32 v8, 96, v20
    ds_read_b128 v[32:35], v8 offset:1536
    v_pk_fma_f32 v[10:11], v[164:165], v[230:231], v[150:151] op_sel:[0,1,0] op_sel_hi:[1,1,1] neg_lo:[0,1,0] neg_hi:[0,1,0]
    v_pk_fma_f32 v[12:13], v[148:149], v[230:231], v[166:167] op_sel:[0,1,0] op_sel_hi:[1,1,1]
    v_pk_fma_f32 v[150:151], v[148:149], v[230:231], v[10:11] op_sel:[0,0,0] op_sel_hi:[1,0,1]
    v_pk_fma_f32 v[166:167], v[164:165], v[230:231], v[12:13] op_sel:[0,0,0] op_sel_hi:[1,0,1]
    v_xor_b32 v1, 128, v9
    v_cvt_pk_bf16_f32 v18, v148, -v164
    v_cvt_pk_bf16_f32 v19, v149, -v165
    ds_write2st64_b32 v1, v18, v19 offset0:8 offset1:24
    s_add_u32 s13, s13, 8192
    s_waitcnt lgkmcnt(1)
    buffer_store_dwordx4 v[32:35], v21, s[8:11], s13 offen sc0 sc1
    v_pk_fma_f32 v[10:11], v[166:167], v[230:231], v[152:153] op_sel:[0,1,0] op_sel_hi:[1,1,1] neg_lo:[0,1,0] neg_hi:[0,1,0]
    v_pk_fma_f32 v[12:13], v[150:151], v[230:231], v[168:169] op_sel:[0,1,0] op_sel_hi:[1,1,1]
    v_pk_fma_f32 v[152:153], v[150:151], v[230:231], v[10:11] op_sel:[0,0,0] op_sel_hi:[1,0,1]
    v_pk_fma_f32 v[168:169], v[166:167], v[230:231], v[12:13] op_sel:[0,0,0] op_sel_hi:[1,0,1]
    v_xor_b32 v3, 144, v9
    v_cvt_pk_bf16_f32 v22, v150, -v166
    v_cvt_pk_bf16_f32 v23, v151, -v167
    ds_write2st64_b32 v3, v22, v23 offset0:9 offset1:25
    v_xor_b32 v8, 128, v20
    ds_read_b128 v[28:31], v8 offset:2048
    v_pk_fma_f32 v[10:11], v[168:169], v[230:231], v[154:155] op_sel:[0,1,0] op_sel_hi:[1,1,1] neg_lo:[0,1,0] neg_hi:[0,1,0]
    v_pk_fma_f32 v[12:13], v[152:153], v[230:231], v[170:171] op_sel:[0,1,0] op_sel_hi:[1,1,1]
    v_pk_fma_f32 v[154:155], v[152:153], v[230:231], v[10:11] op_sel:[0,0,0] op_sel_hi:[1,0,1]
    v_pk_fma_f32 v[170:171], v[168:169], v[230:231], v[12:13] op_sel:[0,0,0] op_sel_hi:[1,0,1]
    v_xor_b32 v1, 160, v9
    v_cvt_pk_bf16_f32 v18, v152, -v168
    v_cvt_pk_bf16_f32 v19, v153, -v169
    ds_write2st64_b32 v1, v18, v19 offset0:10 offset1:26
    s_add_u32 s13, s13, 8192
    s_waitcnt lgkmcnt(1)
    buffer_store_dwordx4 v[28:31], v21, s[8:11], s13 offen sc0 sc1
    v_pk_fma_f32 v[10:11], v[170:171], v[230:231], v[156:157] op_sel:[0,1,0] op_sel_hi:[1,1,1] neg_lo:[0,1,0] neg_hi:[0,1,0]
    v_pk_fma_f32 v[12:13], v[154:155], v[230:231], v[172:173] op_sel:[0,1,0] op_sel_hi:[1,1,1]
    v_pk_fma_f32 v[156:157], v[154:155], v[230:231], v[10:11] op_sel:[0,0,0] op_sel_hi:[1,0,1]
    v_pk_fma_f32 v[172:173], v[170:171], v[230:231], v[12:13] op_sel:[0,0,0] op_sel_hi:[1,0,1]
    v_xor_b32 v3, 176, v9
    v_cvt_pk_bf16_f32 v22, v154, -v170
    v_cvt_pk_bf16_f32 v23, v155, -v171
    ds_write2st64_b32 v3, v22, v23 offset0:11 offset1:27
    v_xor_b32 v8, 160, v20
    ds_read_b128 v[32:35], v8 offset:2560
    v_pk_fma_f32 v[10:11], v[172:173], v[230:231], v[158:159] op_sel:[0,1,0] op_sel_hi:[1,1,1] neg_lo:[0,1,0] neg_hi:[0,1,0]
    v_pk_fma_f32 v[12:13], v[156:157], v[230:231], v[174:175] op_sel:[0,1,0] op_sel_hi:[1,1,1]
    v_pk_fma_f32 v[158:159], v[156:157], v[230:231], v[10:11] op_sel:[0,0,0] op_sel_hi:[1,0,1]
    v_pk_fma_f32 v[174:175], v[172:173], v[230:231], v[12:13] op_sel:[0,0,0] op_sel_hi:[1,0,1]
    v_xor_b32 v1, 192, v9
    v_cvt_pk_bf16_f32 v18, v156, -v172
    v_cvt_pk_bf16_f32 v19, v157, -v173
    ds_write2st64_b32 v1, v18, v19 offset0:12 offset1:28
    s_add_u32 s13, s13, 8192
    s_waitcnt lgkmcnt(1)
    buffer_store_dwordx4 v[32:35], v21, s[8:11], s13 offen sc0 sc1
    v_pk_fma_f32 v[10:11], v[174:175], v[230:231], v[160:161] op_sel:[0,1,0] op_sel_hi:[1,1,1] neg_lo:[0,1,0] neg_hi:[0,1,0]
    v_pk_fma_f32 v[12:13], v[158:159], v[230:231], v[176:177] op_sel:[0,1,0] op_sel_hi:[1,1,1]
    v_pk_fma_f32 v[160:161], v[158:159], v[230:231], v[10:11] op_sel:[0,0,0] op_sel_hi:[1,0,1]
    v_pk_fma_f32 v[176:177], v[174:175], v[230:231], v[12:13] op_sel:[0,0,0] op_sel_hi:[1,0,1]
    v_xor_b32 v3, 208, v9
    v_cvt_pk_bf16_f32 v22, v158, -v174
    v_cvt_pk_bf16_f32 v23, v159, -v175
    ds_write2st64_b32 v3, v22, v23 offset0:13 offset1:29
    v_xor_b32 v8, 192, v20
    ds_read_b128 v[28:31], v8 offset:3072
    v_pk_fma_f32 v[10:11], v[176:177], v[230:231], v[162:163] op_sel:[0,1,0] op_sel_hi:[1,1,1] neg_lo:[0,1,0] neg_hi:[0,1,0]
    v_pk_fma_f32 v[12:13], v[160:161], v[230:231], v[178:179] op_sel:[0,1,0] op_sel_hi:[1,1,1]
    v_pk_fma_f32 v[162:163], v[160:161], v[230:231], v[10:11] op_sel:[0,0,0] op_sel_hi:[1,0,1]
    v_pk_fma_f32 v[178:179], v[176:177], v[230:231], v[12:13] op_sel:[0,0,0] op_sel_hi:[1,0,1]
    v_xor_b32 v1, 224, v9
    v_cvt_pk_bf16_f32 v18, v160, -v176
    v_cvt_pk_bf16_f32 v19, v161, -v177
    ds_write2st64_b32 v1, v18, v19 offset0:14 offset1:30
    s_add_u32 s13, s13, 8192
    s_waitcnt lgkmcnt(1)
    buffer_store_dwordx4 v[28:31], v21, s[8:11], s13 offen sc0 sc1
    v_xor_b32 v3, 240, v9
    v_cvt_pk_bf16_f32 v22, v162, -v178
    v_cvt_pk_bf16_f32 v23, v163, -v179
    ds_write2st64_b32 v3, v22, v23 offset0:15 offset1:31
    v_xor_b32 v8, 224, v20
    ds_read_b128 v[32:35], v8 offset:3584
    s_add_u32 s13, s13, 8192
    s_waitcnt lgkmcnt(0)
    buffer_store_dwordx4 v[32:35], v21, s[8:11], s13 offen sc0 sc1
    s_barrier
    ds_read2_b32 v[96:97], v57 offset0:112 offset1:113
    ds_read2_b32 v[98:99], v57 offset0:114 offset1:115
    ds_read_b128 v[100:103], v58 offset:16128
    ds_read2_b32 v[104:105], v57 offset0:240 offset1:241
    ds_read2_b32 v[106:107], v57 offset0:242 offset1:243
    ds_read_b128 v[108:111], v58 offset:14080
    ds_read2_b32 v[112:113], v63 offset0:112 offset1:113
    ds_read2_b32 v[114:115], v63 offset0:114 offset1:115
    ds_read_b128 v[116:119], v58 offset:12032
    s_waitcnt lgkmcnt(1)
    v_mfma_f32_16x16x32_bf16 v[46:49], v[96:99], v[100:103], 0
    s_lshl_b32 s4, s45, 4
    s_add_u32 s4, s4, s46
    v_mfma_f32_16x16x32_bf16 v[66:69], v[104:107], v[100:103], 0
    ds_read2_b32 v[120:121], v63 offset0:240 offset1:241
    ds_read2_b32 v[122:123], v63 offset0:242 offset1:243
    v_mfma_f32_16x16x32_bf16 v[66:69], v[96:99], v[108:111], v[66:69]
    ds_read_b128 v[124:127], v58 offset:9984
    s_bfe_u32 s7, s14, 0x40004
    v_mfma_f32_16x16x32_bf16 v[70:73], v[104:107], v[108:111], 0
    s_lshl_b32 s7, s7, 12
    s_add_u32 s12, s6, s7
    v_mfma_f32_16x16x32_bf16 v[70:73], v[112:115], v[100:103], v[70:73]
    buffer_load_dwordx4 a[32:35], v17, s[8:11], s12 offen offset:0 sc0 sc1
    s_waitcnt lgkmcnt(3)
    v_mfma_f32_16x16x32_bf16 v[70:73], v[96:99], v[116:119], v[70:73]
    s_lshl_b32 s4, s4, 2
    s_add_u32 s4, s4, s44
    v_mfma_f32_16x16x32_bf16 v[74:77], v[112:115], v[108:111], 0
    s_lshl_b32 s4, s4, 3
    s_add_u32 s4, s4, 21512192
    v_mfma_f32_16x16x32_bf16 v[74:77], v[104:107], v[116:119], v[74:77]
    buffer_load_dwordx4 a[36:39], v17, s[8:11], s12 offen offset:1024 sc0 sc1
    v_mfma_f32_16x16x32_bf16 v[78:81], v[112:115], v[116:119], 0
    ds_read2_b32 v[128:129], v64 offset0:112 offset1:113
    s_waitcnt lgkmcnt(1)
    v_mfma_f32_16x16x32_bf16 v[74:77], v[120:123], v[100:103], v[74:77]
    ds_read2_b32 v[130:131], v64 offset0:114 offset1:115
    ds_read_b128 v[132:135], v58 offset:7936
    v_mfma_f32_16x16x32_bf16 v[74:77], v[96:99], v[124:127], v[74:77]
    s_lshl_b32 s3, s45, 9
    s_add_u32 s3, s3, 21512192
    v_mfma_f32_16x16x32_bf16 v[78:81], v[120:123], v[108:111], v[78:81]
    v_lshrrev_b32 v182, 1, v17
    v_add_u32 v182, s3, v182
    v_mfma_f32_16x16x32_bf16 v[78:81], v[104:107], v[124:127], v[78:81]
    buffer_load_dwordx4 a[40:43], v17, s[8:11], s12 offen offset:2048 sc0 sc1
    v_mfma_f32_16x16x32_bf16 v[84:87], v[120:123], v[116:119], 0
    v_lshrrev_b32 v1, 4, v2
    v_and_b32 v3, 15, v2
    v_mfma_f32_16x16x32_bf16 v[84:87], v[112:115], v[124:127], v[84:87]
    v_xor_b32 v3, v3, v1
    v_lshlrev_b32 v3, 4, v3
    v_mfma_f32_16x16x32_bf16 v[88:91], v[120:123], v[124:127], 0
    v_lshl_add_u32 v7, v1, 12, v3
    s_waitcnt lgkmcnt(0)
    v_mfma_f32_16x16x32_bf16 v[78:81], v[128:131], v[100:103], v[78:81]
    ds_read2_b32 v[136:137], v64 offset0:240 offset1:241
    ds_read2_b32 v[138:139], v64 offset0:242 offset1:243
    v_mfma_f32_16x16x32_bf16 v[78:81], v[96:99], v[132:135], v[78:81]
    ds_read_b128 v[140:143], v58 offset:5888
    buffer_load_dwordx4 a[44:47], v17, s[8:11], s12 offen offset:3072 sc0 sc1
    v_mfma_f32_16x16x32_bf16 v[84:87], v[128:131], v[108:111], v[84:87]
    v_xor_b32 v1, 64, v7
    v_add_u32 v8, 16384, v1
    v_mfma_f32_16x16x32_bf16 v[84:87], v[104:107], v[132:135], v[84:87]
    v_xor_b32 v1, 128, v7
    v_add_u32 v9, 32768, v1
    v_mfma_f32_16x16x32_bf16 v[88:91], v[128:131], v[116:119], v[88:91]
    v_xor_b32 v1, 192, v7
    v_add_u32 v10, 49152, v1
    v_mfma_f32_16x16x32_bf16 v[88:91], v[112:115], v[132:135], v[88:91]
    s_lshl_b32 s16, s45, 19
    s_lshl_b32 s3, s44, 17
    v_mfma_f32_16x16x32_bf16 v[92:95], v[128:131], v[124:127], 0
    ds_read2_b32 v[144:145], v65 offset0:112 offset1:113
    ds_read2_b32 v[146:147], v65 offset0:114 offset1:115
    v_mfma_f32_16x16x32_bf16 v[92:95], v[120:123], v[132:135], v[92:95]
    ds_read_b128 v[148:151], v58 offset:3840
    s_waitcnt lgkmcnt(3)
    v_mfma_f32_16x16x32_bf16 v[84:87], v[136:139], v[100:103], v[84:87]
    s_bfe_u32 s7, s14, 0x40008
    s_lshl_b32 s7, s7, 12
    v_mfma_f32_16x16x32_bf16 v[84:87], v[96:99], v[140:143], v[84:87]
    s_add_u32 s12, s6, s7
    buffer_load_dwordx4 a[48:51], v17, s[8:11], s12 offen offset:0 sc0 sc1
    v_mfma_f32_16x16x32_bf16 v[88:91], v[136:139], v[108:111], v[88:91]
    ds_read2_b32 v[128:129], v65 offset0:240 offset1:241
    ds_read2_b32 v[130:131], v65 offset0:242 offset1:243
    v_mfma_f32_16x16x32_bf16 v[88:91], v[104:107], v[140:143], v[88:91]
    ds_read_b128 v[124:127], v58 offset:1792
    buffer_load_dwordx4 a[52:55], v17, s[8:11], s12 offen offset:1024 sc0 sc1
    v_mfma_f32_16x16x32_bf16 v[92:95], v[136:139], v[116:119], v[92:95]
    ds_read2_b32 v[120:121], v57 offset0:96 offset1:97
    ds_read2_b32 v[122:123], v57 offset0:98 offset1:99
    v_mfma_f32_16x16x32_bf16 v[92:95], v[112:115], v[140:143], v[92:95]
    ds_read_b128 v[132:135], v59 offset:15872
    s_waitcnt lgkmcnt(6)
    v_mfma_f32_16x16x32_bf16 v[88:91], v[144:147], v[100:103], v[88:91]
    ds_read2_b32 v[136:137], v57 offset0:224 offset1:225
    ds_read2_b32 v[138:139], v57 offset0:226 offset1:227
    v_mfma_f32_16x16x32_bf16 v[88:91], v[96:99], v[148:151], v[88:91]
    ds_read_b128 v[116:119], v59 offset:13824
    s_add_u32 s16, s16, s3
    v_mfma_f32_16x16x32_bf16 v[92:95], v[144:147], v[108:111], v[92:95]
    ds_read2_b32 v[112:113], v63 offset0:96 offset1:97
    ds_read2_b32 v[114:115], v63 offset0:98 offset1:99
    v_mfma_f32_16x16x32_bf16 v[92:95], v[104:107], v[148:151], v[92:95]
    ds_read_b128 v[140:143], v59 offset:11776
    s_waitcnt lgkmcnt(6)
    v_mfma_f32_16x16x32_bf16 v[92:95], v[128:131], v[100:103], v[92:95]
    buffer_load_dwordx4 a[56:59], v17, s[8:11], s12 offen offset:2048 sc0 sc1
    v_mfma_f32_16x16x32_bf16 v[92:95], v[96:99], v[124:127], v[92:95]
    s_lshl_b32 s17, s46, 8
    s_lshl_b32 s18, s44, 13
    v_mfma_f32_16x16x32_bf16 v[46:49], v[120:123], v[132:135], v[46:49]
    s_lshr_b32 s28, s44, 1
    s_waitcnt lgkmcnt(1)
    v_mfma_f32_16x16x32_bf16 v[66:69], v[136:139], v[132:135], v[66:69]
    ds_read2_b32 v[144:145], v63 offset0:224 offset1:225
    ds_read2_b32 v[146:147], v63 offset0:226 offset1:227
    v_mfma_f32_16x16x32_bf16 v[66:69], v[120:123], v[116:119], v[66:69]
    ds_read_b128 v[108:111], v59 offset:9728
    buffer_load_dwordx4 a[60:63], v17, s[8:11], s12 offen offset:3072 sc0 sc1
    v_mfma_f32_16x16x32_bf16 v[70:73], v[136:139], v[116:119], v[70:73]
    v_and_b32 v26, 31, v2
    v_lshrrev_b32 v27, 5, v2
    v_mfma_f32_16x16x32_bf16 v[70:73], v[112:115], v[132:135], v[70:73]
    v_lshlrev_b32 v27, 2, v27
    s_waitcnt lgkmcnt(3)
    v_mfma_f32_16x16x32_bf16 v[70:73], v[120:123], v[140:143], v[70:73]
    s_lshl_b32 s3, s28, 3
    v_add_u32 v27, s3, v27
    v_mfma_f32_16x16x32_bf16 v[74:77], v[112:115], v[116:119], v[74:77]
    s_bfe_u32 s7, s14, 0x4000c
    s_lshl_b32 s7, s7, 12
    v_mfma_f32_16x16x32_bf16 v[74:77], v[136:139], v[140:143], v[74:77]
    s_add_u32 s12, s6, s7
    buffer_load_dwordx4 a[64:67], v17, s[8:11], s12 offen offset:0 sc0 sc1
    v_mfma_f32_16x16x32_bf16 v[78:81], v[112:115], v[140:143], v[78:81]
    ds_read2_b32 v[104:105], v64 offset0:96 offset1:97
    s_waitcnt lgkmcnt(1)
    v_mfma_f32_16x16x32_bf16 v[74:77], v[144:147], v[132:135], v[74:77]
    ds_read2_b32 v[106:107], v64 offset0:98 offset1:99
    ds_read_b128 v[148:151], v59 offset:7680
    v_mfma_f32_16x16x32_bf16 v[74:77], v[120:123], v[108:111], v[74:77]
    v_and_b32 v28, 15, v26
    v_xor_b32 v27, v27, v28
    v_mfma_f32_16x16x32_bf16 v[78:81], v[144:147], v[116:119], v[78:81]
    buffer_load_dwordx4 a[68:71], v17, s[8:11], s12 offen offset:1024 sc0 sc1
    v_mfma_f32_16x16x32_bf16 v[78:81], v[136:139], v[108:111], v[78:81]
    v_lshlrev_b32 v27, 4, v27
    v_lshl_add_u32 v27, v26, 8, v27
    v_mfma_f32_16x16x32_bf16 v[84:87], v[144:147], v[140:143], v[84:87]
    s_lshl_b32 s3, s28, 14
    v_add_u32 v27, s3, v27
    v_mfma_f32_16x16x32_bf16 v[84:87], v[112:115], v[108:111], v[84:87]
    v_xor_b32 v4, 0, v27
    v_xor_b32 v18, 0x4000, v4
    v_mfma_f32_16x16x32_bf16 v[88:91], v[144:147], v[108:111], v[88:91]
    v_add_u32 v13, 65536, v4
    s_waitcnt lgkmcnt(0)
    v_mfma_f32_16x16x32_bf16 v[78:81], v[104:107], v[132:135], v[78:81]
    ds_read2_b32 v[128:129], v64 offset0:224 offset1:225
    ds_read2_b32 v[130:131], v64 offset0:226 offset1:227
    v_mfma_f32_16x16x32_bf16 v[78:81], v[120:123], v[148:151], v[78:81]
    ds_read_b128 v[100:103], v59 offset:5632
    buffer_load_dwordx4 a[72:75], v17, s[8:11], s12 offen offset:2048 sc0 sc1
    v_mfma_f32_16x16x32_bf16 v[84:87], v[104:107], v[116:119], v[84:87]
    v_add_u32 v22, 65536, v18
    v_xor_b32 v5, 16, v27
    v_mfma_f32_16x16x32_bf16 v[84:87], v[136:139], v[148:151], v[84:87]
    v_xor_b32 v19, 0x4000, v5
    v_add_u32 v14, 65536, v5
    v_mfma_f32_16x16x32_bf16 v[88:91], v[104:107], v[140:143], v[88:91]
    v_add_u32 v23, 65536, v19
    v_xor_b32 v11, 32, v27
    v_mfma_f32_16x16x32_bf16 v[88:91], v[112:115], v[148:151], v[88:91]
    buffer_load_dwordx4 a[76:79], v17, s[8:11], s12 offen offset:3072 sc0 sc1
    v_mfma_f32_16x16x32_bf16 v[92:95], v[104:107], v[108:111], v[92:95]
    ds_read2_b32 v[96:97], v65 offset0:96 offset1:97
    ds_read2_b32 v[98:99], v65 offset0:98 offset1:99
    v_mfma_f32_16x16x32_bf16 v[92:95], v[144:147], v[148:151], v[92:95]
    ds_read_b128 v[124:127], v59 offset:3584
    s_waitcnt lgkmcnt(3)
    v_mfma_f32_16x16x32_bf16 v[84:87], v[128:131], v[132:135], v[84:87]
    v_xor_b32 v20, 0x4000, v11
    v_add_u32 v15, 65536, v11
    v_mfma_f32_16x16x32_bf16 v[84:87], v[120:123], v[100:103], v[84:87]
    v_add_u32 v24, 65536, v20
    v_xor_b32 v12, 48, v27
    v_mfma_f32_16x16x32_bf16 v[88:91], v[128:131], v[116:119], v[88:91]
    ds_read2_b32 v[104:105], v65 offset0:224 offset1:225
    ds_read2_b32 v[106:107], v65 offset0:226 offset1:227
    v_mfma_f32_16x16x32_bf16 v[88:91], v[136:139], v[100:103], v[88:91]
    ds_read_b128 v[108:111], v59 offset:1536
    s_bfe_u32 s7, s14, 0x40010
    v_mfma_f32_16x16x32_bf16 v[92:95], v[128:131], v[140:143], v[92:95]
    ds_read2_b32 v[144:145], v57 offset0:80 offset1:81
    ds_read2_b32 v[146:147], v57 offset0:82 offset1:83
    v_mfma_f32_16x16x32_bf16 v[92:95], v[112:115], v[100:103], v[92:95]
    ds_read_b128 v[148:151], v60 offset:15616
    s_waitcnt lgkmcnt(6)
    v_mfma_f32_16x16x32_bf16 v[88:91], v[96:99], v[132:135], v[88:91]
    ds_read2_b32 v[128:129], v57 offset0:208 offset1:209
    ds_read2_b32 v[130:131], v57 offset0:210 offset1:211
    v_mfma_f32_16x16x32_bf16 v[88:91], v[120:123], v[124:127], v[88:91]
    ds_read_b128 v[140:143], v60 offset:13568
    s_lshl_b32 s7, s7, 12
    v_mfma_f32_16x16x32_bf16 v[92:95], v[96:99], v[116:119], v[92:95]
    ds_read2_b32 v[112:113], v63 offset0:80 offset1:81
    ds_read2_b32 v[114:115], v63 offset0:82 offset1:83
    v_mfma_f32_16x16x32_bf16 v[92:95], v[136:139], v[124:127], v[92:95]
    ds_read_b128 v[100:103], v60 offset:11520
    s_waitcnt lgkmcnt(6)
    v_mfma_f32_16x16x32_bf16 v[92:95], v[104:107], v[132:135], v[92:95]
    s_add_u32 s12, s6, s7
    buffer_load_dwordx4 a[80:83], v17, s[8:11], s12 offen offset:0 sc0 sc1
    v_mfma_f32_16x16x32_bf16 v[92:95], v[120:123], v[108:111], v[92:95]
    buffer_load_dwordx4 a[84:87], v17, s[8:11], s12 offen offset:1024 sc0 sc1
    v_mfma_f32_16x16x32_bf16 v[46:49], v[144:147], v[148:151], v[46:49]
    s_waitcnt vmcnt(14)
    s_waitcnt lgkmcnt(1)
    v_mfma_f32_16x16x32_bf16 v[66:69], v[128:131], v[148:151], v[66:69]
    ds_read2_b32 v[96:97], v63 offset0:208 offset1:209
    ds_read2_b32 v[98:99], v63 offset0:210 offset1:211
    v_mfma_f32_16x16x32_bf16 v[66:69], v[144:147], v[140:143], v[66:69]
    ds_read_b128 v[116:119], v60 offset:9472
    v_mov_b32 v82, s42
    v_mov_b32 v83, s43
    s_mov_b64 s[48:49], exec
    s_mov_b64 exec, 1
    buffer_store_dwordx2 v[82:83], v6, s[8:11], s4 offen sc0 sc1
    s_mov_b64 exec, s[48:49]
    v_mfma_f32_16x16x32_bf16 v[70:73], v[128:131], v[140:143], v[70:73]
    buffer_load_dwordx4 a[88:91], v17, s[8:11], s12 offen offset:2048 sc0 sc1
    v_mfma_f32_16x16x32_bf16 v[70:73], v[112:115], v[148:151], v[70:73]
    v_xor_b32 v21, 0x4000, v12
    s_waitcnt lgkmcnt(3)
    v_mfma_f32_16x16x32_bf16 v[70:73], v[144:147], v[100:103], v[70:73]
    buffer_load_dwordx4 a[92:95], v17, s[8:11], s12 offen offset:3072 sc0 sc1
    v_mfma_f32_16x16x32_bf16 v[74:77], v[112:115], v[140:143], v[74:77]
    v_add_u32 v16, 65536, v12
    v_add_u32 v25, 65536, v21
    v_mfma_f32_16x16x32_bf16 v[74:77], v[128:131], v[100:103], v[74:77]
    s_lshl_b32 s13, s46, 4
    s_add_u32 s13, s13, s45
    v_mfma_f32_16x16x32_bf16 v[78:81], v[112:115], v[100:103], v[78:81]
    ds_read2_b32 v[136:137], v64 offset0:80 offset1:81
    s_waitcnt lgkmcnt(1)
    v_mfma_f32_16x16x32_bf16 v[74:77], v[96:99], v[148:151], v[74:77]
    ds_read2_b32 v[138:139], v64 offset0:82 offset1:83
    ds_read_b128 v[124:127], v60 offset:7424
    v_mfma_f32_16x16x32_bf16 v[74:77], v[144:147], v[116:119], v[74:77]
    s_bfe_u32 s7, s14, 0x40014
    s_lshl_b32 s7, s7, 12
    v_mfma_f32_16x16x32_bf16 v[78:81], v[96:99], v[140:143], v[78:81]
    s_add_u32 s12, s6, s7
    buffer_load_dwordx4 a[96:99], v17, s[8:11], s12 offen offset:0 sc0 sc1
    v_mfma_f32_16x16x32_bf16 v[78:81], v[128:131], v[116:119], v[78:81]
    s_lshl_b32 s13, s13, 2
    s_add_u32 s13, s13, s44
    v_mfma_f32_16x16x32_bf16 v[84:87], v[96:99], v[100:103], v[84:87]
    s_lshl_b32 s13, s13, 3
    s_add_u32 s13, s13, 21520384
    v_mfma_f32_16x16x32_bf16 v[84:87], v[112:115], v[116:119], v[84:87]
    s_mov_b32 s32, s36
    s_mov_b32 s33, s37
    v_mfma_f32_16x16x32_bf16 v[88:91], v[96:99], v[116:119], v[88:91]
    buffer_load_dwordx4 a[100:103], v17, s[8:11], s12 offen offset:1024 sc0 sc1
    s_waitcnt lgkmcnt(0)
    v_mfma_f32_16x16x32_bf16 v[78:81], v[136:139], v[148:151], v[78:81]
    ds_read2_b32 v[104:105], v64 offset0:208 offset1:209
    ds_read2_b32 v[106:107], v64 offset0:210 offset1:211
    v_mfma_f32_16x16x32_bf16 v[78:81], v[144:147], v[124:127], v[78:81]
    ds_read_b128 v[132:135], v60 offset:5376
    s_mov_b32 s34, 8388608
    v_mfma_f32_16x16x32_bf16 v[84:87], v[136:139], v[140:143], v[84:87]
    s_mov_b32 s35, 131072
    s_lshr_b32 s29, s44, 1
    v_mfma_f32_16x16x32_bf16 v[84:87], v[128:131], v[124:127], v[84:87]
    s_and_b32 s30, s44, 1
    v_bfe_u32 v32, v2, 4, 1
    v_mfma_f32_16x16x32_bf16 v[88:91], v[136:139], v[100:103], v[88:91]
    buffer_load_dwordx4 a[104:107], v17, s[8:11], s12 offen offset:2048 sc0 sc1
    v_mfma_f32_16x16x32_bf16 v[88:91], v[112:115], v[124:127], v[88:91]
    v_lshlrev_b32 v32, 2, v32
    v_and_b32 v33, 7, v2
    v_mfma_f32_16x16x32_bf16 v[92:95], v[136:139], v[116:119], v[92:95]
    ds_read2_b32 v[120:121], v65 offset0:80 offset1:81
    ds_read2_b32 v[122:123], v65 offset0:82 offset1:83
    v_mfma_f32_16x16x32_bf16 v[92:95], v[96:99], v[124:127], v[92:95]
    ds_read_b128 v[108:111], v60 offset:3328
    s_waitcnt lgkmcnt(3)
    v_mfma_f32_16x16x32_bf16 v[84:87], v[104:107], v[148:151], v[84:87]
    v_xor_b32 v33, v33, v32
    v_lshlrev_b32 v33, 4, v33
    v_mfma_f32_16x16x32_bf16 v[84:87], v[144:147], v[132:135], v[84:87]
    buffer_load_dwordx4 a[108:111], v17, s[8:11], s12 offen offset:3072 sc0 sc1
    v_mfma_f32_16x16x32_bf16 v[88:91], v[104:107], v[140:143], v[88:91]
    ds_read2_b32 v[136:137], v65 offset0:208 offset1:209
    ds_read2_b32 v[138:139], v65 offset0:210 offset1:211
    v_mfma_f32_16x16x32_bf16 v[88:91], v[128:131], v[132:135], v[88:91]
    ds_read_b128 v[116:119], v60 offset:1280
    v_lshrrev_b32 v32, 3, v2
    v_mfma_f32_16x16x32_bf16 v[92:95], v[104:107], v[100:103], v[92:95]
    ds_read2_b32 v[96:97], v57 offset0:64 offset1:65
    ds_read2_b32 v[98:99], v57 offset0:66 offset1:67
    v_mfma_f32_16x16x32_bf16 v[92:95], v[112:115], v[132:135], v[92:95]
    ds_read_b128 v[124:127], v61 offset:15360
    s_waitcnt lgkmcnt(6)
    v_mfma_f32_16x16x32_bf16 v[88:91], v[120:123], v[148:151], v[88:91]
    ds_read2_b32 v[104:105], v57 offset0:192 offset1:193
    ds_read2_b32 v[106:107], v57 offset0:194 offset1:195
    v_mfma_f32_16x16x32_bf16 v[88:91], v[144:147], v[108:111], v[88:91]
    ds_read_b128 v[100:103], v61 offset:13312
    s_bfe_u32 s7, s14, 0x40018
    v_mfma_f32_16x16x32_bf16 v[92:95], v[120:123], v[140:143], v[92:95]
    ds_read2_b32 v[112:113], v63 offset0:64 offset1:65
    ds_read2_b32 v[114:115], v63 offset0:66 offset1:67
    v_mfma_f32_16x16x32_bf16 v[92:95], v[128:131], v[108:111], v[92:95]
    ds_read_b128 v[132:135], v61 offset:11264
    s_waitcnt lgkmcnt(6)
    v_mfma_f32_16x16x32_bf16 v[92:95], v[136:139], v[148:151], v[92:95]
    s_lshl_b32 s7, s7, 12
    s_add_u32 s12, s6, s7
    v_mfma_f32_16x16x32_bf16 v[92:95], v[144:147], v[116:119], v[92:95]
    buffer_load_dwordx4 a[112:115], v17, s[8:11], s12 offen offset:0 sc0 sc1
    v_mfma_f32_16x16x32_bf16 v[46:49], v[96:99], v[124:127], v[46:49]
    buffer_load_dwordx4 a[116:119], v17, s[8:11], s12 offen offset:1024 sc0 sc1
    s_waitcnt lgkmcnt(1)
    v_mfma_f32_16x16x32_bf16 v[66:69], v[104:107], v[124:127], v[66:69]
    ds_read2_b32 v[120:121], v63 offset0:192 offset1:193
    ds_read2_b32 v[122:123], v63 offset0:194 offset1:195
    v_mfma_f32_16x16x32_bf16 v[66:69], v[96:99], v[100:103], v[66:69]
    ds_read_b128 v[140:143], v61 offset:9216
    v_lshl_add_u32 v35, v32, 11, v33
    v_mfma_f32_16x16x32_bf16 v[70:73], v[104:107], v[100:103], v[70:73]
    s_lshl_b32 s31, s45, 18
    s_lshl_b32 s3, s44, 16
    v_mfma_f32_16x16x32_bf16 v[70:73], v[112:115], v[124:127], v[70:73]
    buffer_load_dwordx4 a[120:123], v17, s[8:11], s12 offen offset:2048 sc0 sc1
    s_waitcnt lgkmcnt(3)
    v_mfma_f32_16x16x32_bf16 v[70:73], v[96:99], v[132:135], v[70:73]
    s_add_u32 s31, s31, s3
    s_lshl_b32 s3, s46, 7
    v_mfma_f32_16x16x32_bf16 v[74:77], v[112:115], v[100:103], v[74:77]
    s_add_u32 s31, s31, s3
    s_lshl_b32 s38, s46, 18
    v_mfma_f32_16x16x32_bf16 v[74:77], v[104:107], v[132:135], v[74:77]
    s_lshl_b32 s3, s44, 16
    s_add_u32 s38, s38, s3
    v_mfma_f32_16x16x32_bf16 v[78:81], v[112:115], v[132:135], v[78:81]
    ds_read2_b32 v[128:129], v64 offset0:64 offset1:65
    s_waitcnt lgkmcnt(1)
    v_mfma_f32_16x16x32_bf16 v[74:77], v[120:123], v[124:127], v[74:77]
    ds_read2_b32 v[130:131], v64 offset0:66 offset1:67
    ds_read_b128 v[108:111], v61 offset:7168
    v_mfma_f32_16x16x32_bf16 v[74:77], v[96:99], v[140:143], v[74:77]
    buffer_load_dwordx4 a[124:127], v17, s[8:11], s12 offen offset:3072 sc0 sc1
    v_mfma_f32_16x16x32_bf16 v[78:81], v[120:123], v[100:103], v[78:81]
    s_lshl_b32 s3, s45, 8
    s_add_u32 s38, s38, s3
    v_mfma_f32_16x16x32_bf16 v[78:81], v[104:107], v[140:143], v[78:81]
    s_add_u32 s38, s38, 12582912
    v_bfe_u32 v34, v2, 2, 2
    v_mfma_f32_16x16x32_bf16 v[84:87], v[120:123], v[132:135], v[84:87]
    v_bfe_u32 v32, v2, 4, 1
    v_lshlrev_b32 v32, 1, v32
    v_mfma_f32_16x16x32_bf16 v[84:87], v[112:115], v[140:143], v[84:87]
    s_bfe_u32 s7, s14, 0x4001c
    s_lshl_b32 s7, s7, 12
    v_mfma_f32_16x16x32_bf16 v[88:91], v[120:123], v[140:143], v[88:91]
    s_add_u32 s12, s6, s7
    s_waitcnt lgkmcnt(0)
    v_mfma_f32_16x16x32_bf16 v[78:81], v[128:131], v[124:127], v[78:81]
    ds_read2_b32 v[136:137], v64 offset0:192 offset1:193
    ds_read2_b32 v[138:139], v64 offset0:194 offset1:195
    v_mfma_f32_16x16x32_bf16 v[78:81], v[96:99], v[108:111], v[78:81]
    ds_read_b128 v[148:151], v61 offset:5120
    buffer_load_dwordx4 a[128:131], v17, s[8:11], s12 offen offset:0 sc0 sc1
    v_mfma_f32_16x16x32_bf16 v[84:87], v[128:131], v[100:103], v[84:87]
    v_bfe_u32 v33, v2, 1, 1
    v_add_u32 v32, v32, v33
    v_mfma_f32_16x16x32_bf16 v[84:87], v[104:107], v[108:111], v[84:87]
    buffer_load_dwordx4 a[132:135], v17, s[8:11], s12 offen offset:1024 sc0 sc1
    v_mfma_f32_16x16x32_bf16 v[88:91], v[128:131], v[132:135], v[88:91]
    s_lshl_b32 s3, s30, 2
    v_add_u32 v32, s3, v32
    v_mfma_f32_16x16x32_bf16 v[88:91], v[112:115], v[108:111], v[88:91]
    v_bfe_u32 v33, v2, 3, 1
    v_lshlrev_b32 v33, 2, v33
    v_mfma_f32_16x16x32_bf16 v[92:95], v[128:131], v[140:143], v[92:95]
    ds_read2_b32 v[144:145], v65 offset0:64 offset1:65
    ds_read2_b32 v[146:147], v65 offset0:66 offset1:67
    v_mfma_f32_16x16x32_bf16 v[92:95], v[120:123], v[108:111], v[92:95]
    ds_read_b128 v[116:119], v61 offset:3072
    s_waitcnt lgkmcnt(3)
    v_mfma_f32_16x16x32_bf16 v[84:87], v[136:139], v[124:127], v[84:87]
    buffer_load_dwordx4 a[136:139], v17, s[8:11], s12 offen offset:2048 sc0 sc1
    v_mfma_f32_16x16x32_bf16 v[84:87], v[96:99], v[148:151], v[84:87]
    v_xor_b32 v32, v32, v33
    v_lshlrev_b32 v32, 4, v32
    v_mfma_f32_16x16x32_bf16 v[88:91], v[136:139], v[100:103], v[88:91]
    ds_read2_b32 v[128:129], v65 offset0:192 offset1:193
    ds_read2_b32 v[130:131], v65 offset0:194 offset1:195
    v_mfma_f32_16x16x32_bf16 v[88:91], v[104:107], v[148:151], v[88:91]
    ds_read_b128 v[140:143], v61 offset:1024
    v_and_b32 v33, 1, v2
    v_mfma_f32_16x16x32_bf16 v[92:95], v[136:139], v[132:135], v[92:95]
    ds_read2_b32 v[120:121], v57 offset0:48 offset1:49
    ds_read2_b32 v[122:123], v57 offset0:50 offset1:51
    v_mfma_f32_16x16x32_bf16 v[92:95], v[112:115], v[148:151], v[92:95]
    ds_read_b128 v[108:111], v58 offset:15104
    s_waitcnt lgkmcnt(6)
    v_mfma_f32_16x16x32_bf16 v[88:91], v[144:147], v[124:127], v[88:91]
    ds_read2_b32 v[136:137], v57 offset0:176 offset1:177
    ds_read2_b32 v[138:139], v57 offset0:178 offset1:179
    v_mfma_f32_16x16x32_bf16 v[88:91], v[96:99], v[116:119], v[88:91]
    ds_read_b128 v[132:135], v58 offset:13056
    buffer_load_dwordx4 a[140:143], v17, s[8:11], s12 offen offset:3072 sc0 sc1
    v_mfma_f32_16x16x32_bf16 v[92:95], v[144:147], v[100:103], v[92:95]
    ds_read2_b32 v[112:113], v63 offset0:48 offset1:49
    ds_read2_b32 v[114:115], v63 offset0:50 offset1:51
    v_mfma_f32_16x16x32_bf16 v[92:95], v[104:107], v[116:119], v[92:95]
    ds_read_b128 v[148:151], v58 offset:11008
    s_waitcnt lgkmcnt(6)
    v_mfma_f32_16x16x32_bf16 v[92:95], v[128:131], v[124:127], v[92:95]
    s_bfe_u32 s7, s15, 0x40000
    s_lshl_b32 s7, s7, 12
    v_mfma_f32_16x16x32_bf16 v[92:95], v[96:99], v[140:143], v[92:95]
    s_add_u32 s12, s6, s7
    buffer_load_dwordx4 a[144:147], v17, s[8:11], s12 offen offset:0 sc0 sc1
    v_mfma_f32_16x16x32_bf16 v[46:49], v[120:123], v[108:111], v[46:49]
    v_lshl_add_u32 v32, v33, 3, v32
    s_waitcnt lgkmcnt(1)
    v_mfma_f32_16x16x32_bf16 v[66:69], v[136:139], v[108:111], v[66:69]
    ds_read2_b32 v[144:145], v63 offset0:176 offset1:177
    ds_read2_b32 v[146:147], v63 offset0:178 offset1:179
    v_mfma_f32_16x16x32_bf16 v[66:69], v[120:123], v[132:135], v[66:69]
    ds_read_b128 v[100:103], v58 offset:8960
    v_lshrrev_b32 v33, 5, v2
    v_mfma_f32_16x16x32_bf16 v[70:73], v[136:139], v[132:135], v[70:73]
    buffer_load_dwordx4 a[148:151], v17, s[8:11], s12 offen offset:1024 sc0 sc1
    v_mfma_f32_16x16x32_bf16 v[70:73], v[112:115], v[108:111], v[70:73]
    v_lshl_add_u32 v34, v33, 2, v34
    s_waitcnt lgkmcnt(3)
    v_mfma_f32_16x16x32_bf16 v[70:73], v[120:123], v[148:151], v[70:73]
    v_lshl_add_u32 v32, v34, 7, v32
    s_lshl_b32 s3, s29, 13
    v_mfma_f32_16x16x32_bf16 v[74:77], v[112:115], v[132:135], v[74:77]
    s_add_u32 s3, s3, 131072
    v_add_u32 v36, s3, v32
    v_mfma_f32_16x16x32_bf16 v[74:77], v[136:139], v[148:151], v[74:77]
    v_and_b32 v32, 15, v2
    s_lshl_b32 s3, s29, 3
    v_mfma_f32_16x16x32_bf16 v[78:81], v[112:115], v[148:151], v[78:81]
    ds_read2_b32 v[104:105], v64 offset0:48 offset1:49
    s_waitcnt lgkmcnt(1)
    v_mfma_f32_16x16x32_bf16 v[74:77], v[144:147], v[108:111], v[74:77]
    ds_read2_b32 v[106:107], v64 offset0:50 offset1:51
    ds_read_b128 v[116:119], v58 offset:6912
    v_mfma_f32_16x16x32_bf16 v[74:77], v[120:123], v[100:103], v[74:77]
    buffer_load_dwordx4 a[152:155], v17, s[8:11], s12 offen offset:2048 sc0 sc1
    v_mfma_f32_16x16x32_bf16 v[78:81], v[144:147], v[132:135], v[78:81]
    v_xor_b32 v32, s3, v32
    v_lshlrev_b32 v32, 4, v32
    v_mfma_f32_16x16x32_bf16 v[78:81], v[136:139], v[100:103], v[78:81]
    v_and_b32 v34, 31, v2
    v_lshl_add_u32 v32, v34, 8, v32
    v_mfma_f32_16x16x32_bf16 v[84:87], v[144:147], v[148:151], v[84:87]
    buffer_load_dwordx4 a[156:159], v17, s[8:11], s12 offen offset:3072 sc0 sc1
    v_mfma_f32_16x16x32_bf16 v[84:87], v[112:115], v[100:103], v[84:87]
    v_lshl_add_u32 v32, v33, 3, v32
    s_lshl_b32 s3, s30, 13
    v_mfma_f32_16x16x32_bf16 v[88:91], v[144:147], v[100:103], v[88:91]
    s_add_u32 s3, s3, 147456
    s_waitcnt lgkmcnt(0)
    v_mfma_f32_16x16x32_bf16 v[78:81], v[104:107], v[108:111], v[78:81]
    ds_read2_b32 v[128:129], v64 offset0:176 offset1:177
    ds_read2_b32 v[130:131], v64 offset0:178 offset1:179
    v_mfma_f32_16x16x32_bf16 v[78:81], v[120:123], v[116:119], v[78:81]
    ds_read_b128 v[124:127], v58 offset:4864
    v_add_u32 v37, s3, v32
    v_mfma_f32_16x16x32_bf16 v[84:87], v[104:107], v[132:135], v[84:87]
    s_bfe_u32 s7, s15, 0x40004
    s_lshl_b32 s7, s7, 12
    v_mfma_f32_16x16x32_bf16 v[84:87], v[136:139], v[116:119], v[84:87]
    s_add_u32 s12, s6, s7
    buffer_load_dwordx4 a[160:163], v17, s[8:11], s12 offen offset:0 sc0 sc1
    v_mfma_f32_16x16x32_bf16 v[88:91], v[104:107], v[148:151], v[88:91]
    v_and_b32 v32, 15, v2
    v_lshlrev_b32 v32, 4, v32
    v_mfma_f32_16x16x32_bf16 v[88:91], v[112:115], v[116:119], v[88:91]
    v_and_b32 v34, 16, v2
    v_lshl_add_u32 v32, v34, 9, v32
    v_mfma_f32_16x16x32_bf16 v[92:95], v[104:107], v[100:103], v[92:95]
    ds_read2_b32 v[96:97], v65 offset0:48 offset1:49
    ds_read2_b32 v[98:99], v65 offset0:50 offset1:51
    v_mfma_f32_16x16x32_bf16 v[92:95], v[144:147], v[116:119], v[92:95]
    ds_read_b128 v[140:143], v58 offset:2816
    s_waitcnt lgkmcnt(3)
    v_mfma_f32_16x16x32_bf16 v[84:87], v[128:131], v[108:111], v[84:87]
    buffer_load_dwordx4 a[164:167], v17, s[8:11], s12 offen offset:1024 sc0 sc1
    v_mfma_f32_16x16x32_bf16 v[84:87], v[120:123], v[124:127], v[84:87]
    s_lshl_b32 s3, s45, 9
    s_add_u32 s3, s3, 20971520
    v_mfma_f32_16x16x32_bf16 v[88:91], v[128:131], v[132:135], v[88:91]
    ds_read2_b32 v[104:105], v65 offset0:176 offset1:177
    ds_read2_b32 v[106:107], v65 offset0:178 offset1:179
    v_mfma_f32_16x16x32_bf16 v[88:91], v[136:139], v[124:127], v[88:91]
    ds_read_b128 v[100:103], v58 offset:768
    v_add_u32 v32, s3, v32
    v_mfma_f32_16x16x32_bf16 v[92:95], v[128:131], v[148:151], v[92:95]
    ds_read2_b32 v[144:145], v57 offset0:32 offset1:33
    ds_read2_b32 v[146:147], v57 offset0:34 offset1:35
    v_mfma_f32_16x16x32_bf16 v[92:95], v[112:115], v[124:127], v[92:95]
    ds_read_b128 v[116:119], v59 offset:14848
    s_waitcnt lgkmcnt(6)
    v_mfma_f32_16x16x32_bf16 v[88:91], v[96:99], v[108:111], v[88:91]
    ds_read2_b32 v[128:129], v57 offset0:160 offset1:161
    ds_read2_b32 v[130:131], v57 offset0:162 offset1:163
    v_mfma_f32_16x16x32_bf16 v[88:91], v[120:123], v[140:143], v[88:91]
    ds_read_b128 v[148:151], v59 offset:12800
    buffer_load_dwordx4 a[168:171], v17, s[8:11], s12 offen offset:2048 sc0 sc1
    v_mfma_f32_16x16x32_bf16 v[92:95], v[96:99], v[132:135], v[92:95]
    ds_read2_b32 v[112:113], v63 offset0:32 offset1:33
    ds_read2_b32 v[114:115], v63 offset0:34 offset1:35
    v_mfma_f32_16x16x32_bf16 v[92:95], v[136:139], v[140:143], v[92:95]
    ds_read_b128 v[124:127], v59 offset:10752
    s_waitcnt lgkmcnt(6)
    v_mfma_f32_16x16x32_bf16 v[92:95], v[104:107], v[108:111], v[92:95]
    buffer_load_dwordx4 a[172:175], v17, s[8:11], s12 offen offset:3072 sc0 sc1
    v_mfma_f32_16x16x32_bf16 v[92:95], v[120:123], v[100:103], v[92:95]
    s_lshl_b32 s3, s29, 8
    v_add_u32 v38, s3, v32
    v_mfma_f32_16x16x32_bf16 v[46:49], v[144:147], v[116:119], v[46:49]
    s_lshl_b32 s3, s44, 10
    s_waitcnt lgkmcnt(1)
    v_mfma_f32_16x16x32_bf16 v[66:69], v[128:131], v[116:119], v[66:69]
    ds_read2_b32 v[96:97], v63 offset0:160 offset1:161
    ds_read2_b32 v[98:99], v63 offset0:162 offset1:163
    v_mfma_f32_16x16x32_bf16 v[66:69], v[144:147], v[148:151], v[66:69]
    ds_read_b128 v[132:135], v59 offset:8704
    s_bfe_u32 s7, s15, 0x40008
    v_mfma_f32_16x16x32_bf16 v[70:73], v[128:131], v[148:151], v[70:73]
    s_lshl_b32 s7, s7, 12
    s_add_u32 s12, s6, s7
    v_mfma_f32_16x16x32_bf16 v[70:73], v[112:115], v[116:119], v[70:73]
    buffer_load_dwordx4 a[176:179], v17, s[8:11], s12 offen offset:0 sc0 sc1
    s_waitcnt lgkmcnt(3)
    v_mfma_f32_16x16x32_bf16 v[70:73], v[144:147], v[124:127], v[70:73]
    s_add_u32 s3, s3, 147456
    v_lshl_add_u32 v39, v33, 4, s3
    v_mfma_f32_16x16x32_bf16 v[74:77], v[112:115], v[148:151], v[74:77]
    v_and_b32 v32, 31, v2
    s_lshl_b32 s3, s30, 5
    v_mfma_f32_16x16x32_bf16 v[74:77], v[128:131], v[124:127], v[74:77]
    buffer_load_dwordx4 a[180:183], v17, s[8:11], s12 offen offset:1024 sc0 sc1
    v_mfma_f32_16x16x32_bf16 v[78:81], v[112:115], v[124:127], v[78:81]
    ds_read2_b32 v[136:137], v64 offset0:32 offset1:33
    s_waitcnt lgkmcnt(1)
    v_mfma_f32_16x16x32_bf16 v[74:77], v[96:99], v[116:119], v[74:77]
    ds_read2_b32 v[138:139], v64 offset0:34 offset1:35
    ds_read_b128 v[140:143], v59 offset:6656
    v_mfma_f32_16x16x32_bf16 v[74:77], v[144:147], v[132:135], v[74:77]
    buffer_load_dwordx2 v[82:83], v182, s[8:11], 0 offen sc0 sc1
    v_mfma_f32_16x16x32_bf16 v[78:81], v[96:99], v[148:151], v[78:81]
    v_add_u32 v32, s3, v32
    s_lshl_b32 s3, s46, 6
    v_mfma_f32_16x16x32_bf16 v[78:81], v[128:131], v[132:135], v[78:81]
    buffer_load_dwordx4 a[184:187], v17, s[8:11], s12 offen offset:2048 sc0 sc1
    v_mfma_f32_16x16x32_bf16 v[84:87], v[96:99], v[124:127], v[84:87]
    v_add_u32 v32, s3, v32
    v_lshlrev_b32 v33, 14, v33
    v_mfma_f32_16x16x32_bf16 v[84:87], v[112:115], v[132:135], v[84:87]
    v_lshl_add_u32 v40, v32, 2, v33
    v_add_u32 v41, 4096, v40
    v_mfma_f32_16x16x32_bf16 v[88:91], v[96:99], v[132:135], v[88:91]
    v_add_u32 v42, 8192, v40
    s_waitcnt lgkmcnt(0)
    v_mfma_f32_16x16x32_bf16 v[78:81], v[136:139], v[116:119], v[78:81]
    ds_read2_b32 v[104:105], v64 offset0:160 offset1:161
    ds_read2_b32 v[106:107], v64 offset0:162 offset1:163
    v_mfma_f32_16x16x32_bf16 v[78:81], v[144:147], v[140:143], v[78:81]
    ds_read_b128 v[108:111], v59 offset:4608
    buffer_load_dwordx4 a[188:191], v17, s[8:11], s12 offen offset:3072 sc0 sc1
    v_mfma_f32_16x16x32_bf16 v[84:87], v[136:139], v[148:151], v[84:87]
    v_add_u32 v43, 12288, v40
    s_lshl_b32 s39, s45, 19
    v_mfma_f32_16x16x32_bf16 v[84:87], v[128:131], v[140:143], v[84:87]
    s_lshl_b32 s3, s29, 18
    s_add_u32 s39, s39, s3
    v_mfma_f32_16x16x32_bf16 v[88:91], v[136:139], v[124:127], v[88:91]
    s_lshl_b32 s47, s44, 12
    s_lshl_b32 s3, s44, 13
    v_mfma_f32_16x16x32_bf16 v[88:91], v[112:115], v[140:143], v[88:91]
    s_add_u32 s3, s3, 0
    v_add_u32 v44, s3, v17
    v_mfma_f32_16x16x32_bf16 v[92:95], v[136:139], v[132:135], v[92:95]
    ds_read2_b32 v[120:121], v65 offset0:32 offset1:33
    ds_read2_b32 v[122:123], v65 offset0:34 offset1:35
    v_mfma_f32_16x16x32_bf16 v[92:95], v[96:99], v[140:143], v[92:95]
    ds_read_b128 v[100:103], v59 offset:2560
    s_waitcnt lgkmcnt(3)
    v_mfma_f32_16x16x32_bf16 v[84:87], v[104:107], v[116:119], v[84:87]
    s_bfe_u32 s7, s15, 0x4000c
    s_lshl_b32 s7, s7, 12
    v_mfma_f32_16x16x32_bf16 v[84:87], v[144:147], v[108:111], v[84:87]
    s_add_u32 s12, s6, s7
    buffer_load_dwordx4 a[192:195], v17, s[8:11], s12 offen offset:0 sc0 sc1
    v_mfma_f32_16x16x32_bf16 v[88:91], v[104:107], v[148:151], v[88:91]
    ds_read2_b32 v[136:137], v65 offset0:160 offset1:161
    ds_read2_b32 v[138:139], v65 offset0:162 offset1:163
    v_mfma_f32_16x16x32_bf16 v[88:91], v[128:131], v[108:111], v[88:91]
    ds_read_b128 v[132:135], v59 offset:512
    buffer_load_dwordx4 a[196:199], v17, s[8:11], s12 offen offset:1024 sc0 sc1
    v_mfma_f32_16x16x32_bf16 v[92:95], v[104:107], v[124:127], v[92:95]
    ds_read2_b32 v[96:97], v57 offset0:16 offset1:17
    ds_read2_b32 v[98:99], v57 offset0:18 offset1:19
    v_mfma_f32_16x16x32_bf16 v[92:95], v[112:115], v[108:111], v[92:95]
    ds_read_b128 v[140:143], v60 offset:14592
    s_waitcnt lgkmcnt(6)
    v_mfma_f32_16x16x32_bf16 v[88:91], v[120:123], v[116:119], v[88:91]
    ds_read2_b32 v[104:105], v57 offset0:144 offset1:145
    ds_read2_b32 v[106:107], v57 offset0:146 offset1:147
    v_mfma_f32_16x16x32_bf16 v[88:91], v[144:147], v[100:103], v[88:91]
    ds_read_b128 v[124:127], v60 offset:12544
    v_xor_b32 v45, 0x4000, v44
    v_mfma_f32_16x16x32_bf16 v[92:95], v[120:123], v[148:151], v[92:95]
    ds_read2_b32 v[112:113], v63 offset0:16 offset1:17
    ds_read2_b32 v[114:115], v63 offset0:18 offset1:19
    v_mfma_f32_16x16x32_bf16 v[92:95], v[128:131], v[100:103], v[92:95]
    ds_read_b128 v[108:111], v60 offset:10496
    s_waitcnt lgkmcnt(6)
    v_mfma_f32_16x16x32_bf16 v[92:95], v[136:139], v[116:119], v[92:95]
    buffer_load_dwordx4 a[200:203], v17, s[8:11], s12 offen offset:2048 sc0 sc1
    v_mfma_f32_16x16x32_bf16 v[92:95], v[144:147], v[132:135], v[92:95]
    s_lshl_b32 s3, s46, 9
    s_add_u32 s3, s3, 21520384
    v_mfma_f32_16x16x32_bf16 v[46:49], v[96:99], v[140:143], v[46:49]
    v_lshrrev_b32 v29, 1, v17
    s_waitcnt lgkmcnt(1)
    v_mfma_f32_16x16x32_bf16 v[66:69], v[104:107], v[140:143], v[66:69]
    ds_read2_b32 v[120:121], v63 offset0:144 offset1:145
    ds_read2_b32 v[122:123], v63 offset0:146 offset1:147
    v_mfma_f32_16x16x32_bf16 v[66:69], v[96:99], v[124:127], v[66:69]
    ds_read_b128 v[148:151], v60 offset:8448
    buffer_load_dwordx4 a[204:207], v17, s[8:11], s12 offen offset:3072 sc0 sc1
    v_mfma_f32_16x16x32_bf16 v[70:73], v[104:107], v[124:127], v[70:73]
    v_add_u32 v29, s3, v29
    v_mfma_f32_16x16x32_bf16 v[70:73], v[112:115], v[140:143], v[70:73]
    s_waitcnt lgkmcnt(3)
    v_mfma_f32_16x16x32_bf16 v[70:73], v[96:99], v[108:111], v[70:73]
    v_mfma_f32_16x16x32_bf16 v[74:77], v[112:115], v[124:127], v[74:77]
    s_bfe_u32 s7, s15, 0x40010
    s_lshl_b32 s7, s7, 12
    v_mfma_f32_16x16x32_bf16 v[74:77], v[104:107], v[108:111], v[74:77]
    s_add_u32 s12, s6, s7
    buffer_load_dwordx4 a[208:211], v17, s[8:11], s12 offen offset:0 sc0 sc1
    v_mfma_f32_16x16x32_bf16 v[78:81], v[112:115], v[108:111], v[78:81]
    ds_read2_b32 v[128:129], v64 offset0:16 offset1:17
    s_waitcnt lgkmcnt(1)
    v_mfma_f32_16x16x32_bf16 v[74:77], v[120:123], v[140:143], v[74:77]
    ds_read2_b32 v[130:131], v64 offset0:18 offset1:19
    ds_read_b128 v[100:103], v60 offset:6400
    v_mfma_f32_16x16x32_bf16 v[74:77], v[96:99], v[148:151], v[74:77]
    v_mfma_f32_16x16x32_bf16 v[78:81], v[120:123], v[124:127], v[78:81]
    buffer_load_dwordx4 a[212:215], v17, s[8:11], s12 offen offset:1024 sc0 sc1
    v_mfma_f32_16x16x32_bf16 v[78:81], v[104:107], v[148:151], v[78:81]
    v_mfma_f32_16x16x32_bf16 v[84:87], v[120:123], v[108:111], v[84:87]
    v_mfma_f32_16x16x32_bf16 v[84:87], v[112:115], v[148:151], v[84:87]
    s_mov_b32 s50, 0
    s_waitcnt vmcnt(8)
    v_cmp_ne_u64 vcc, s[42:43], v[82:83]
    s_nop 4
    s_cbranch_vccz Lfdone_gate_11
Lfpoll_gate_12:
    buffer_load_dwordx2 v[82:83], v182, s[8:11], 0 offen sc0 sc1
    s_waitcnt vmcnt(0)
    v_cmp_ne_u64 vcc, s[42:43], v[82:83]
    s_nop 4
    s_add_u32 s50, s50, 1
    s_cmp_gt_u32 s50, 20000
    s_cbranch_scc1 Lfdone_gate_11
    s_cbranch_vccnz Lfpoll_gate_12
Lfdone_gate_11:
    v_mfma_f32_16x16x32_bf16 v[88:91], v[120:123], v[148:151], v[88:91]
    s_bfe_u32 s17, s14, 0x40000
    s_waitcnt lgkmcnt(0)
    v_mfma_f32_16x16x32_bf16 v[78:81], v[128:131], v[140:143], v[78:81]
    ds_read2_b32 v[136:137], v64 offset0:144 offset1:145
    ds_read2_b32 v[138:139], v64 offset0:146 offset1:147
    v_mfma_f32_16x16x32_bf16 v[78:81], v[96:99], v[100:103], v[78:81]
    ds_read_b128 v[116:119], v60 offset:4352
    s_lshl_b32 s17, s17, 8
    v_mfma_f32_16x16x32_bf16 v[84:87], v[128:131], v[124:127], v[84:87]
    s_add_u32 s20, s16, s17
    s_add_u32 m0, s18, 32768
    v_mfma_f32_16x16x32_bf16 v[84:87], v[104:107], v[100:103], v[84:87]
    buffer_load_dwordx4 v7, s[8:11], s20 offen sc0 sc1 lds
    v_mfma_f32_16x16x32_bf16 v[88:91], v[128:131], v[108:111], v[88:91]
    buffer_load_dwordx4 a[216:219], v17, s[8:11], s12 offen offset:2048 sc0 sc1
    v_mfma_f32_16x16x32_bf16 v[88:91], v[112:115], v[100:103], v[88:91]
    s_add_u32 m0, s18, 33792
    s_nop 0
    buffer_load_dwordx4 v8, s[8:11], s20 offen sc0 sc1 lds
    v_mfma_f32_16x16x32_bf16 v[92:95], v[128:131], v[148:151], v[92:95]
    ds_read2_b32 v[144:145], v65 offset0:16 offset1:17
    ds_read2_b32 v[146:147], v65 offset0:18 offset1:19
    v_mfma_f32_16x16x32_bf16 v[92:95], v[120:123], v[100:103], v[92:95]
    ds_read_b128 v[132:135], v60 offset:2304
    s_waitcnt lgkmcnt(3)
    v_mfma_f32_16x16x32_bf16 v[84:87], v[136:139], v[140:143], v[84:87]
    buffer_load_dwordx4 a[220:223], v17, s[8:11], s12 offen offset:3072 sc0 sc1
    v_mfma_f32_16x16x32_bf16 v[84:87], v[96:99], v[116:119], v[84:87]
    s_add_u32 m0, s18, 34816
    s_nop 0
    buffer_load_dwordx4 v9, s[8:11], s20 offen sc0 sc1 lds
    v_mfma_f32_16x16x32_bf16 v[88:91], v[136:139], v[124:127], v[88:91]
    ds_read2_b32 v[128:129], v65 offset0:144 offset1:145
    ds_read2_b32 v[130:131], v65 offset0:146 offset1:147
    v_mfma_f32_16x16x32_bf16 v[88:91], v[104:107], v[116:119], v[88:91]
    ds_read_b128 v[148:151], v60 offset:256
    s_bfe_u32 s7, s15, 0x40014
    v_mfma_f32_16x16x32_bf16 v[92:95], v[136:139], v[108:111], v[92:95]
    ds_read2_b32 v[120:121], v57 offset0:0 offset1:1
    ds_read2_b32 v[122:123], v57 offset0:2 offset1:3
    v_mfma_f32_16x16x32_bf16 v[92:95], v[112:115], v[116:119], v[92:95]
    ds_read_b128 v[100:103], v61 offset:14336
    s_waitcnt lgkmcnt(6)
    v_mfma_f32_16x16x32_bf16 v[88:91], v[144:147], v[140:143], v[88:91]
    ds_read2_b32 v[136:137], v57 offset0:128 offset1:129
    ds_read2_b32 v[138:139], v57 offset0:130 offset1:131
    v_mfma_f32_16x16x32_bf16 v[88:91], v[96:99], v[132:135], v[88:91]
    ds_read_b128 v[108:111], v61 offset:12288
    s_lshl_b32 s7, s7, 12
    v_mfma_f32_16x16x32_bf16 v[92:95], v[144:147], v[124:127], v[92:95]
    ds_read2_b32 v[112:113], v63 offset0:0 offset1:1
    ds_read2_b32 v[114:115], v63 offset0:2 offset1:3
    v_mfma_f32_16x16x32_bf16 v[92:95], v[104:107], v[132:135], v[92:95]
    ds_read_b128 v[116:119], v61 offset:10240
    s_waitcnt lgkmcnt(6)
    v_mfma_f32_16x16x32_bf16 v[92:95], v[128:131], v[140:143], v[92:95]
    s_add_u32 s12, s6, s7
    buffer_load_dwordx4 a[224:227], v17, s[8:11], s12 offen offset:0 sc0 sc1
    v_mfma_f32_16x16x32_bf16 v[92:95], v[96:99], v[148:151], v[92:95]
    s_add_u32 m0, s18, 35840
    s_nop 0
    buffer_load_dwordx4 v10, s[8:11], s20 offen sc0 sc1 lds
    v_mfma_f32_16x16x32_bf16 v[46:49], v[120:123], v[100:103], v[46:49]
    buffer_load_dwordx4 a[228:231], v17, s[8:11], s12 offen offset:1024 sc0 sc1
    s_waitcnt lgkmcnt(1)
    v_mfma_f32_16x16x32_bf16 v[66:69], v[136:139], v[100:103], v[66:69]
    ds_read2_b32 v[144:145], v63 offset0:128 offset1:129
    ds_read2_b32 v[146:147], v63 offset0:130 offset1:131
    v_mfma_f32_16x16x32_bf16 v[66:69], v[120:123], v[108:111], v[66:69]
    ds_read_b128 v[124:127], v61 offset:8192
    s_add_u32 s21, s20, 65536
    v_mfma_f32_16x16x32_bf16 v[70:73], v[136:139], v[108:111], v[70:73]
    s_add_u32 m0, s18, 36864
    s_nop 0
    buffer_load_dwordx4 v7, s[8:11], s21 offen sc0 sc1 lds
    v_mfma_f32_16x16x32_bf16 v[70:73], v[112:115], v[100:103], v[70:73]
    buffer_load_dwordx4 a[232:235], v17, s[8:11], s12 offen offset:2048 sc0 sc1
    s_waitcnt lgkmcnt(3)
    v_mfma_f32_16x16x32_bf16 v[70:73], v[120:123], v[116:119], v[70:73]
    s_add_u32 m0, s18, 37888
    s_nop 0
    buffer_load_dwordx4 v8, s[8:11], s21 offen sc0 sc1 lds
    v_mfma_f32_16x16x32_bf16 v[74:77], v[112:115], v[108:111], v[74:77]
    buffer_load_dwordx4 a[236:239], v17, s[8:11], s12 offen offset:3072 sc0 sc1
    v_mfma_f32_16x16x32_bf16 v[74:77], v[136:139], v[116:119], v[74:77]
    v_mfma_f32_16x16x32_bf16 v[78:81], v[112:115], v[116:119], v[78:81]
    ds_read2_b32 v[104:105], v64 offset0:0 offset1:1
    s_waitcnt lgkmcnt(1)
    v_mfma_f32_16x16x32_bf16 v[74:77], v[144:147], v[100:103], v[74:77]
    ds_read2_b32 v[106:107], v64 offset0:2 offset1:3
    ds_read_b128 v[132:135], v61 offset:6144
    v_mfma_f32_16x16x32_bf16 v[74:77], v[120:123], v[124:127], v[74:77]
    s_add_u32 m0, s18, 38912
    s_nop 0
    buffer_load_dwordx4 v9, s[8:11], s21 offen sc0 sc1 lds
    v_mfma_f32_16x16x32_bf16 v[78:81], v[144:147], v[108:111], v[78:81]
    s_bfe_u32 s7, s15, 0x40018
    s_lshl_b32 s7, s7, 12
    v_mfma_f32_16x16x32_bf16 v[78:81], v[136:139], v[124:127], v[78:81]
    s_add_u32 s12, s6, s7
    buffer_load_dwordx4 a[240:243], v17, s[8:11], s12 offen offset:0 sc0 sc1
    v_mfma_f32_16x16x32_bf16 v[84:87], v[144:147], v[116:119], v[84:87]
    v_mfma_f32_16x16x32_bf16 v[84:87], v[112:115], v[124:127], v[84:87]
    s_add_u32 m0, s18, 39936
    s_nop 0
    buffer_load_dwordx4 v10, s[8:11], s21 offen sc0 sc1 lds
    v_mfma_f32_16x16x32_bf16 v[88:91], v[144:147], v[124:127], v[88:91]
    buffer_load_dwordx4 a[244:247], v17, s[8:11], s12 offen offset:1024 sc0 sc1
    s_waitcnt lgkmcnt(0)
    v_mfma_f32_16x16x32_bf16 v[78:81], v[104:107], v[100:103], v[78:81]
    ds_read2_b32 v[128:129], v64 offset0:128 offset1:129
    ds_read2_b32 v[130:131], v64 offset0:130 offset1:131
    v_mfma_f32_16x16x32_bf16 v[78:81], v[120:123], v[132:135], v[78:81]
    ds_read_b128 v[140:143], v61 offset:4096
    v_mfma_f32_16x16x32_bf16 v[84:87], v[104:107], v[108:111], v[84:87]
    v_mfma_f32_16x16x32_bf16 v[84:87], v[136:139], v[132:135], v[84:87]
    v_mfma_f32_16x16x32_bf16 v[88:91], v[104:107], v[116:119], v[88:91]
    buffer_load_dwordx4 a[248:251], v17, s[8:11], s12 offen offset:2048 sc0 sc1
    v_mfma_f32_16x16x32_bf16 v[88:91], v[112:115], v[132:135], v[88:91]
    v_mfma_f32_16x16x32_bf16 v[92:95], v[104:107], v[124:127], v[92:95]
    ds_read2_b32 v[96:97], v65 offset0:0 offset1:1
    ds_read2_b32 v[98:99], v65 offset0:2 offset1:3
    v_mfma_f32_16x16x32_bf16 v[92:95], v[144:147], v[132:135], v[92:95]
    ds_read_b128 v[148:151], v61 offset:2048
    s_waitcnt lgkmcnt(3)
    v_mfma_f32_16x16x32_bf16 v[84:87], v[128:131], v[100:103], v[84:87]
    v_mfma_f32_16x16x32_bf16 v[84:87], v[120:123], v[140:143], v[84:87]
    buffer_load_dwordx4 a[252:255], v17, s[8:11], s12 offen offset:3072 sc0 sc1
    v_mfma_f32_16x16x32_bf16 v[88:91], v[128:131], v[108:111], v[88:91]
    ds_read2_b32 v[104:105], v65 offset0:128 offset1:129
    ds_read2_b32 v[106:107], v65 offset0:130 offset1:131
    v_mfma_f32_16x16x32_bf16 v[88:91], v[136:139], v[140:143], v[88:91]
    ds_read_b128 v[124:127], v61 offset:0
    v_mfma_f32_16x16x32_bf16 v[92:95], v[128:131], v[116:119], v[92:95]
    v_mfma_f32_16x16x32_bf16 v[92:95], v[112:115], v[140:143], v[92:95]
    s_waitcnt lgkmcnt(3)
    v_mfma_f32_16x16x32_bf16 v[88:91], v[96:99], v[100:103], v[88:91]
    v_mfma_f32_16x16x32_bf16 v[88:91], v[120:123], v[148:151], v[88:91]
    v_mfma_f32_16x16x32_bf16 v[92:95], v[96:99], v[108:111], v[92:95]
    v_mfma_f32_16x16x32_bf16 v[92:95], v[136:139], v[148:151], v[92:95]
    s_waitcnt lgkmcnt(0)
    v_mfma_f32_16x16x32_bf16 v[92:95], v[104:107], v[100:103], v[92:95]
    v_mfma_f32_16x16x32_bf16 v[92:95], v[120:123], v[124:127], v[92:95]
    s_barrier
    ds_read_b128 v[96:99], v4 offset:0
    ds_read_b128 v[100:103], v4 offset:8192
    ds_read_b128 v[104:107], v18 offset:0
    ds_read_b128 v[108:111], v18 offset:8192
    s_bfe_u32 s17, s14, 0x40004
    s_lshl_b32 s17, s17, 8
    s_add_u32 s20, s16, s17
    s_add_u32 m0, s18, 65536
    s_waitcnt lgkmcnt(3)
    v_mfma_f32_32x32x16_bf16 v[128:143], v[96:99], a[0:3], 0
    ds_read_b128 v[112:115], v5 offset:0
    ds_read_b128 v[116:119], v5 offset:8192
    buffer_load_dwordx4 v7, s[8:11], s20 offen sc0 sc1 lds
    ds_read_b64 v[26:27], v62 offset:14336
    ds_read_b64 v[32:33], v62 offset:12288
    ds_read_b64 v[50:51], v62 offset:10240
    ds_read_b64 v[54:55], v62 offset:8192
    ds_read_b64 v[176:177], v62 offset:6144
    ds_read_b64 v[178:179], v62 offset:4096
    s_add_u32 m0, s18, 66560
    s_waitcnt lgkmcnt(10)
    v_mfma_f32_32x32x16_bf16 v[144:159], v[100:103], a[0:3], 0
    ds_read_b128 v[120:123], v19 offset:0
    ds_read_b128 v[124:127], v19 offset:8192
    buffer_load_dwordx4 v8, s[8:11], s20 offen sc0 sc1 lds
    ds_read_b64 v[200:201], v62 offset:2048
    ds_read_b64 v[202:203], v62 offset:0
    s_add_u32 s4, s22, 12582912
    s_waitcnt lgkmcnt(9)
    v_and_b32 v204, s5, v27
    v_lshlrev_b32 v205, 16, v27
    v_and_b32 v206, s5, v26
    s_add_u32 m0, s18, 67584
    v_mfma_f32_32x32x16_bf16 v[160:175], v[104:107], a[0:3], 0
    buffer_load_dwordx4 v9, s[8:11], s20 offen sc0 sc1 lds
    v_lshlrev_b32 v207, 16, v26
    v_fmac_f32 v46, v183, v204
    v_fmac_f32 v47, v183, v205
    v_fmac_f32 v48, v183, v206
    v_fmac_f32 v49, v183, v207
    v_cvt_pk_bf16_f32 v208, v46, v47
    v_cvt_pk_bf16_f32 v209, v48, v49
    s_waitcnt lgkmcnt(8)
    v_and_b32 v204, s5, v33
    s_add_u32 m0, s18, 68608
    v_mfma_f32_32x32x16_bf16 v[184:199], v[108:111], a[0:3], 0
    buffer_load_dwordx4 v10, s[8:11], s20 offen sc0 sc1 lds
    v_lshlrev_b32 v205, 16, v33
    v_and_b32 v206, s5, v32
    v_lshlrev_b32 v207, 16, v32
    v_fmac_f32 v66, v183, v204
    v_fmac_f32 v67, v183, v205
    v_fmac_f32 v68, v183, v206
    v_fmac_f32 v69, v183, v207
    v_cvt_pk_bf16_f32 v210, v66, v67
    v_cvt_pk_bf16_f32 v211, v68, v69
    s_add_u32 s21, s20, 65536
    s_add_u32 m0, s18, 69632
    v_mfma_f32_32x32x16_bf16 v[128:143], v[112:115], a[4:7], v[128:143]
    ds_read_b128 v[96:99], v11 offset:0
    ds_read_b128 v[100:103], v11 offset:8192
    buffer_load_dwordx4 v7, s[8:11], s21 offen sc0 sc1 lds
    v_permlane16_swap_b32 v208, v210
    v_permlane16_swap_b32 v209, v211
    s_waitcnt lgkmcnt(9)
    v_and_b32 v204, s5, v51
    v_lshlrev_b32 v205, 16, v51
    v_and_b32 v206, s5, v50
    v_lshlrev_b32 v207, 16, v50
    s_add_u32 m0, s18, 70656
    v_mfma_f32_32x32x16_bf16 v[144:159], v[116:119], a[4:7], v[144:159]
    ds_read_b128 v[104:107], v20 offset:0
    ds_read_b128 v[108:111], v20 offset:8192
    buffer_load_dwordx4 v8, s[8:11], s21 offen sc0 sc1 lds
    v_fmac_f32 v70, v183, v204
    v_fmac_f32 v71, v183, v205
    v_fmac_f32 v72, v183, v206
    v_fmac_f32 v73, v183, v207
    v_cvt_pk_bf16_f32 v212, v70, v71
    v_cvt_pk_bf16_f32 v213, v72, v73
    s_add_u32 m0, s18, 71680
    s_waitcnt lgkmcnt(7)
    v_mfma_f32_32x32x16_bf16 v[160:175], v[120:123], a[4:7], v[160:175]
    buffer_load_dwordx4 v9, s[8:11], s21 offen sc0 sc1 lds
    v_and_b32 v204, s5, v55
    v_lshlrev_b32 v205, 16, v55
    v_and_b32 v206, s5, v54
    v_lshlrev_b32 v207, 16, v54
    v_fmac_f32 v74, v183, v204
    v_fmac_f32 v75, v183, v205
    v_fmac_f32 v76, v183, v206
    v_fmac_f32 v77, v183, v207
    s_add_u32 m0, s18, 72704
    s_waitcnt lgkmcnt(6)
    v_mfma_f32_32x32x16_bf16 v[184:199], v[124:127], a[4:7], v[184:199]
    buffer_load_dwordx4 v10, s[8:11], s21 offen sc0 sc1 lds
    v_cvt_pk_bf16_f32 v214, v74, v75
    v_cvt_pk_bf16_f32 v215, v76, v77
    s_nop 0
    v_permlane16_swap_b32 v212, v214
    v_permlane16_swap_b32 v213, v215
    v_and_b32 v204, s5, v177
    v_lshlrev_b32 v205, 16, v177
    v_and_b32 v206, s5, v176
    v_lshlrev_b32 v207, 16, v176
    v_fmac_f32 v78, v183, v204
    s_bfe_u32 s17, s14, 0x40008
    s_lshl_b32 s17, s17, 8
    s_add_u32 s20, s16, s17
    s_add_u32 m0, s18, 98304
    s_waitcnt lgkmcnt(3)
    v_mfma_f32_32x32x16_bf16 v[128:143], v[96:99], a[8:11], v[128:143]
    ds_read_b128 v[112:115], v12 offset:0
    ds_read_b128 v[116:119], v12 offset:8192
    buffer_load_dwordx4 v7, s[8:11], s20 offen sc0 sc1 lds
    v_fmac_f32 v79, v183, v205
    v_fmac_f32 v80, v183, v206
    v_fmac_f32 v81, v183, v207
    v_cvt_pk_bf16_f32 v216, v78, v79
    v_cvt_pk_bf16_f32 v217, v80, v81
    v_and_b32 v204, s5, v179
    s_add_u32 m0, s18, 99328
    s_waitcnt lgkmcnt(4)
    v_mfma_f32_32x32x16_bf16 v[144:159], v[100:103], a[8:11], v[144:159]
    ds_read_b128 v[120:123], v21 offset:0
    ds_read_b128 v[124:127], v21 offset:8192
    buffer_load_dwordx4 v8, s[8:11], s20 offen sc0 sc1 lds
    v_lshlrev_b32 v205, 16, v179
    v_and_b32 v206, s5, v178
    v_lshlrev_b32 v207, 16, v178
    v_fmac_f32 v84, v183, v204
    v_fmac_f32 v85, v183, v205
    v_fmac_f32 v86, v183, v206
    s_add_u32 m0, s18, 100352
    s_waitcnt lgkmcnt(5)
    v_mfma_f32_32x32x16_bf16 v[160:175], v[104:107], a[8:11], v[160:175]
    buffer_load_dwordx4 v9, s[8:11], s20 offen sc0 sc1 lds
    v_fmac_f32 v87, v183, v207
    v_cvt_pk_bf16_f32 v218, v84, v85
    v_cvt_pk_bf16_f32 v219, v86, v87
    s_nop 0
    v_permlane16_swap_b32 v216, v218
    v_permlane16_swap_b32 v217, v219
    v_and_b32 v204, s5, v201
    v_lshlrev_b32 v205, 16, v201
    v_and_b32 v206, s5, v200
    s_add_u32 m0, s18, 101376
    s_waitcnt lgkmcnt(4)
    v_mfma_f32_32x32x16_bf16 v[184:199], v[108:111], a[8:11], v[184:199]
    buffer_load_dwordx4 v10, s[8:11], s20 offen sc0 sc1 lds
    v_lshlrev_b32 v207, 16, v200
    v_fmac_f32 v88, v183, v204
    v_fmac_f32 v89, v183, v205
    v_fmac_f32 v90, v183, v206
    v_fmac_f32 v91, v183, v207
    v_cvt_pk_bf16_f32 v220, v88, v89
    v_cvt_pk_bf16_f32 v221, v90, v91
    v_and_b32 v204, s5, v203
    v_lshlrev_b32 v205, 16, v203
    s_waitcnt lgkmcnt(0)
    s_waitcnt vmcnt(15)
    s_barrier
    s_add_u32 s21, s20, 65536
    s_add_u32 m0, s18, 102400
    v_mfma_f32_32x32x16_bf16 v[128:143], v[112:115], a[12:15], v[128:143]
    ds_read_b128 v[96:99], v4 offset:32768
    ds_read_b128 v[100:103], v4 offset:40960
    buffer_load_dwordx4 v7, s[8:11], s21 offen sc0 sc1 lds
    v_and_b32 v206, s5, v202
    v_lshlrev_b32 v207, 16, v202
    v_fmac_f32 v92, v183, v204
    v_fmac_f32 v93, v183, v205
    v_fmac_f32 v94, v183, v206
    v_fmac_f32 v95, v183, v207
    s_add_u32 m0, s18, 103424
    v_mfma_f32_32x32x16_bf16 v[144:159], v[116:119], a[12:15], v[144:159]
    ds_read_b128 v[104:107], v18 offset:32768
    ds_read_b128 v[108:111], v18 offset:40960
    buffer_load_dwordx4 v8, s[8:11], s21 offen sc0 sc1 lds
    v_cvt_pk_bf16_f32 v222, v92, v93
    v_cvt_pk_bf16_f32 v223, v94, v95
    s_nop 0
    v_permlane16_swap_b32 v220, v222
    v_permlane16_swap_b32 v221, v223
    s_add_u32 m0, s18, 104448
    v_mfma_f32_32x32x16_bf16 v[160:175], v[120:123], a[12:15], v[160:175]
    buffer_load_dwordx4 v9, s[8:11], s21 offen sc0 sc1 lds
    s_add_u32 m0, s18, 105472
    v_mfma_f32_32x32x16_bf16 v[184:199], v[124:127], a[12:15], v[184:199]
    buffer_load_dwordx4 v10, s[8:11], s21 offen sc0 sc1 lds
    s_waitcnt lgkmcnt(3)
    v_mfma_f32_32x32x16_bf16 v[128:143], v[96:99], a[16:19], v[128:143]
    ds_read_b128 v[112:115], v5 offset:32768
    ds_read_b128 v[116:119], v5 offset:40960
    buffer_store_dwordx4 v[208:211], v180, s[8:11], s4 offen offset:0 sc0 sc1
    buffer_store_dwordx4 v[212:215], v180, s[8:11], s4 offen offset:1024 sc0 sc1
    buffer_store_dwordx4 v[216:219], v180, s[8:11], s4 offen offset:2048 sc0 sc1
    s_waitcnt lgkmcnt(4)
    v_mfma_f32_32x32x16_bf16 v[144:159], v[100:103], a[16:19], v[144:159]
    ds_read_b128 v[120:123], v19 offset:32768
    ds_read_b128 v[124:127], v19 offset:40960
    s_bfe_u32 s17, s14, 0x4000c
    s_lshl_b32 s17, s17, 8
    s_add_u32 s20, s16, s17
    s_add_u32 m0, s18, 0
    s_waitcnt lgkmcnt(5)
    v_mfma_f32_32x32x16_bf16 v[160:175], v[104:107], a[16:19], v[160:175]
    buffer_load_dwordx4 v7, s[8:11], s20 offen sc0 sc1 lds
    buffer_store_dwordx4 v[220:223], v180, s[8:11], s4 offen offset:3072 sc0 sc1
    s_add_u32 m0, s18, 1024
    s_waitcnt lgkmcnt(4)
    v_mfma_f32_32x32x16_bf16 v[184:199], v[108:111], a[16:19], v[184:199]
    buffer_load_dwordx4 v8, s[8:11], s20 offen sc0 sc1 lds
    s_waitcnt lgkmcnt(3)
    v_mfma_f32_32x32x16_bf16 v[128:143], v[112:115], a[20:23], v[128:143]
    ds_read_b128 v[96:99], v11 offset:32768
    ds_read_b128 v[100:103], v11 offset:40960
    s_waitcnt lgkmcnt(4)
    v_mfma_f32_32x32x16_bf16 v[144:159], v[116:119], a[20:23], v[144:159]
    ds_read_b128 v[104:107], v20 offset:32768
    ds_read_b128 v[108:111], v20 offset:40960
    s_add_u32 m0, s18, 2048
    s_waitcnt lgkmcnt(5)
    v_mfma_f32_32x32x16_bf16 v[160:175], v[120:123], a[20:23], v[160:175]
    buffer_load_dwordx4 v9, s[8:11], s20 offen sc0 sc1 lds
    s_add_u32 m0, s18, 3072
    s_waitcnt lgkmcnt(4)
    v_mfma_f32_32x32x16_bf16 v[184:199], v[124:127], a[20:23], v[184:199]
    buffer_load_dwordx4 v10, s[8:11], s20 offen sc0 sc1 lds
    s_waitcnt lgkmcnt(3)
    v_mfma_f32_32x32x16_bf16 v[128:143], v[96:99], a[24:27], v[128:143]
    ds_read_b128 v[112:115], v12 offset:32768
    ds_read_b128 v[116:119], v12 offset:40960
    s_waitcnt lgkmcnt(4)
    v_mfma_f32_32x32x16_bf16 v[144:159], v[100:103], a[24:27], v[144:159]
    ds_read_b128 v[120:123], v21 offset:32768
    ds_read_b128 v[124:127], v21 offset:40960
    s_add_u32 s21, s20, 65536
    s_add_u32 m0, s18, 4096
    s_waitcnt lgkmcnt(5)
    v_mfma_f32_32x32x16_bf16 v[160:175], v[104:107], a[24:27], v[160:175]
    buffer_load_dwordx4 v7, s[8:11], s21 offen sc0 sc1 lds
    s_add_u32 m0, s18, 5120
    s_waitcnt lgkmcnt(4)
    v_mfma_f32_32x32x16_bf16 v[184:199], v[108:111], a[24:27], v[184:199]
    buffer_load_dwordx4 v8, s[8:11], s21 offen sc0 sc1 lds
    s_waitcnt lgkmcnt(0)
    s_waitcnt vmcnt(18)
    s_barrier
    v_mfma_f32_32x32x16_bf16 v[128:143], v[112:115], a[28:31], v[128:143]
    ds_read_b128 v[96:99], v13 offset:0
    ds_read_b128 v[100:103], v13 offset:8192
    v_mfma_f32_32x32x16_bf16 v[144:159], v[116:119], a[28:31], v[144:159]
    ds_read_b128 v[104:107], v22 offset:0
    ds_read_b128 v[108:111], v22 offset:8192
    s_add_u32 m0, s18, 6144
    v_mfma_f32_32x32x16_bf16 v[160:175], v[120:123], a[28:31], v[160:175]
    buffer_load_dwordx4 v9, s[8:11], s21 offen sc0 sc1 lds
    s_add_u32 m0, s18, 7168
    v_mfma_f32_32x32x16_bf16 v[184:199], v[124:127], a[28:31], v[184:199]
    buffer_load_dwordx4 v10, s[8:11], s21 offen sc0 sc1 lds
    s_waitcnt lgkmcnt(3)
    v_mfma_f32_32x32x16_bf16 v[128:143], v[96:99], a[32:35], v[128:143]
    ds_read_b128 v[112:115], v14 offset:0
    ds_read_b128 v[116:119], v14 offset:8192
    s_waitcnt lgkmcnt(4)
    v_mfma_f32_32x32x16_bf16 v[144:159], v[100:103], a[32:35], v[144:159]
    ds_read_b128 v[120:123], v23 offset:0
    ds_read_b128 v[124:127], v23 offset:8192
    s_bfe_u32 s17, s14, 0x40010
    s_lshl_b32 s17, s17, 8
    s_add_u32 s20, s16, s17
    s_add_u32 m0, s18, 32768
    s_waitcnt lgkmcnt(5)
    v_mfma_f32_32x32x16_bf16 v[160:175], v[104:107], a[32:35], v[160:175]
    buffer_load_dwordx4 v7, s[8:11], s20 offen sc0 sc1 lds
    s_add_u32 m0, s18, 33792
    s_waitcnt lgkmcnt(4)
    v_mfma_f32_32x32x16_bf16 v[184:199], v[108:111], a[32:35], v[184:199]
    buffer_load_dwordx4 v8, s[8:11], s20 offen sc0 sc1 lds
    s_waitcnt lgkmcnt(3)
    v_mfma_f32_32x32x16_bf16 v[128:143], v[112:115], a[36:39], v[128:143]
    ds_read_b128 v[96:99], v15 offset:0
    ds_read_b128 v[100:103], v15 offset:8192
    s_waitcnt lgkmcnt(4)
    v_mfma_f32_32x32x16_bf16 v[144:159], v[116:119], a[36:39], v[144:159]
    ds_read_b128 v[104:107], v24 offset:0
    ds_read_b128 v[108:111], v24 offset:8192
    s_add_u32 m0, s18, 34816
    s_waitcnt lgkmcnt(5)
    v_mfma_f32_32x32x16_bf16 v[160:175], v[120:123], a[36:39], v[160:175]
    buffer_load_dwordx4 v9, s[8:11], s20 offen sc0 sc1 lds
    s_add_u32 m0, s18, 35840
    s_waitcnt lgkmcnt(4)
    v_mfma_f32_32x32x16_bf16 v[184:199], v[124:127], a[36:39], v[184:199]
    buffer_load_dwordx4 v10, s[8:11], s20 offen sc0 sc1 lds
    s_waitcnt lgkmcnt(3)
    v_mfma_f32_32x32x16_bf16 v[128:143], v[96:99], a[40:43], v[128:143]
    ds_read_b128 v[112:115], v16 offset:0
    ds_read_b128 v[116:119], v16 offset:8192
    s_waitcnt lgkmcnt(4)
    v_mfma_f32_32x32x16_bf16 v[144:159], v[100:103], a[40:43], v[144:159]
    ds_read_b128 v[120:123], v25 offset:0
    ds_read_b128 v[124:127], v25 offset:8192
    s_add_u32 s21, s20, 65536
    s_add_u32 m0, s18, 36864
    s_waitcnt lgkmcnt(5)
    v_mfma_f32_32x32x16_bf16 v[160:175], v[104:107], a[40:43], v[160:175]
    buffer_load_dwordx4 v7, s[8:11], s21 offen sc0 sc1 lds
    s_add_u32 m0, s18, 37888
    s_waitcnt lgkmcnt(4)
    v_mfma_f32_32x32x16_bf16 v[184:199], v[108:111], a[40:43], v[184:199]
    buffer_load_dwordx4 v8, s[8:11], s21 offen sc0 sc1 lds
    s_waitcnt lgkmcnt(0)
    s_waitcnt vmcnt(18)
    s_barrier
    v_mfma_f32_32x32x16_bf16 v[128:143], v[112:115], a[44:47], v[128:143]
    ds_read_b128 v[96:99], v13 offset:32768
    ds_read_b128 v[100:103], v13 offset:40960
    v_mfma_f32_32x32x16_bf16 v[144:159], v[116:119], a[44:47], v[144:159]
    ds_read_b128 v[104:107], v22 offset:32768
    ds_read_b128 v[108:111], v22 offset:40960
    s_add_u32 m0, s18, 38912
    v_mfma_f32_32x32x16_bf16 v[160:175], v[120:123], a[44:47], v[160:175]
    buffer_load_dwordx4 v9, s[8:11], s21 offen sc0 sc1 lds
    s_add_u32 m0, s18, 39936
    v_mfma_f32_32x32x16_bf16 v[184:199], v[124:127], a[44:47], v[184:199]
    buffer_load_dwordx4 v10, s[8:11], s21 offen sc0 sc1 lds
    s_waitcnt lgkmcnt(3)
    v_mfma_f32_32x32x16_bf16 v[128:143], v[96:99], a[48:51], v[128:143]
    ds_read_b128 v[112:115], v14 offset:32768
    ds_read_b128 v[116:119], v14 offset:40960
    s_waitcnt lgkmcnt(4)
    v_mfma_f32_32x32x16_bf16 v[144:159], v[100:103], a[48:51], v[144:159]
    ds_read_b128 v[120:123], v23 offset:32768
    ds_read_b128 v[124:127], v23 offset:40960
    s_bfe_u32 s17, s14, 0x40014
    s_lshl_b32 s17, s17, 8
    s_add_u32 s20, s16, s17
    s_add_u32 m0, s18, 65536
    s_waitcnt lgkmcnt(5)
    v_mfma_f32_32x32x16_bf16 v[160:175], v[104:107], a[48:51], v[160:175]
    buffer_load_dwordx4 v7, s[8:11], s20 offen sc0 sc1 lds
    s_add_u32 m0, s18, 66560
    s_waitcnt lgkmcnt(4)
    v_mfma_f32_32x32x16_bf16 v[184:199], v[108:111], a[48:51], v[184:199]
    buffer_load_dwordx4 v8, s[8:11], s20 offen sc0 sc1 lds
    s_waitcnt lgkmcnt(3)
    v_mfma_f32_32x32x16_bf16 v[128:143], v[112:115], a[52:55], v[128:143]
    ds_read_b128 v[96:99], v15 offset:32768
    ds_read_b128 v[100:103], v15 offset:40960
    s_waitcnt lgkmcnt(4)
    v_mfma_f32_32x32x16_bf16 v[144:159], v[116:119], a[52:55], v[144:159]
    ds_read_b128 v[104:107], v24 offset:32768
    ds_read_b128 v[108:111], v24 offset:40960
    s_add_u32 m0, s18, 67584
    s_waitcnt lgkmcnt(5)
    v_mfma_f32_32x32x16_bf16 v[160:175], v[120:123], a[52:55], v[160:175]
    buffer_load_dwordx4 v9, s[8:11], s20 offen sc0 sc1 lds
    s_add_u32 m0, s18, 68608
    s_waitcnt lgkmcnt(4)
    v_mfma_f32_32x32x16_bf16 v[184:199], v[124:127], a[52:55], v[184:199]
    buffer_load_dwordx4 v10, s[8:11], s20 offen sc0 sc1 lds
    s_waitcnt lgkmcnt(3)
    v_mfma_f32_32x32x16_bf16 v[128:143], v[96:99], a[56:59], v[128:143]
    ds_read_b128 v[112:115], v16 offset:32768
    ds_read_b128 v[116:119], v16 offset:40960
    s_waitcnt lgkmcnt(4)
    v_mfma_f32_32x32x16_bf16 v[144:159], v[100:103], a[56:59], v[144:159]
    ds_read_b128 v[120:123], v25 offset:32768
    ds_read_b128 v[124:127], v25 offset:40960
    s_add_u32 s21, s20, 65536
    s_add_u32 m0, s18, 69632
    s_waitcnt lgkmcnt(5)
    v_mfma_f32_32x32x16_bf16 v[160:175], v[104:107], a[56:59], v[160:175]
    buffer_load_dwordx4 v7, s[8:11], s21 offen sc0 sc1 lds
    s_add_u32 m0, s18, 70656
    s_waitcnt lgkmcnt(4)
    v_mfma_f32_32x32x16_bf16 v[184:199], v[108:111], a[56:59], v[184:199]
    buffer_load_dwordx4 v8, s[8:11], s21 offen sc0 sc1 lds
    s_waitcnt lgkmcnt(0)
    s_waitcnt vmcnt(14)
    s_barrier
    v_mfma_f32_32x32x16_bf16 v[128:143], v[112:115], a[60:63], v[128:143]
    ds_read_b128 v[96:99], v4 offset:0
    ds_read_b128 v[100:103], v4 offset:8192
    v_mfma_f32_32x32x16_bf16 v[144:159], v[116:119], a[60:63], v[144:159]
    ds_read_b128 v[104:107], v18 offset:0
    ds_read_b128 v[108:111], v18 offset:8192
    s_add_u32 m0, s18, 71680
    v_mfma_f32_32x32x16_bf16 v[160:175], v[120:123], a[60:63], v[160:175]
    buffer_load_dwordx4 v9, s[8:11], s21 offen sc0 sc1 lds
    s_add_u32 m0, s18, 72704
    v_mfma_f32_32x32x16_bf16 v[184:199], v[124:127], a[60:63], v[184:199]
    buffer_load_dwordx4 v10, s[8:11], s21 offen sc0 sc1 lds
    s_waitcnt lgkmcnt(3)
    v_mfma_f32_32x32x16_bf16 v[128:143], v[96:99], a[64:67], v[128:143]
    ds_read_b128 v[112:115], v5 offset:0
    ds_read_b128 v[116:119], v5 offset:8192
    v_mov_b32 v82, s42
    v_mov_b32 v83, s43
    s_mov_b64 s[22:23], exec
    s_mov_b64 exec, 1
    buffer_store_dwordx2 v[82:83], v6, s[8:11], s13 offen sc0 sc1
    s_mov_b64 exec, s[22:23]
    s_waitcnt lgkmcnt(4)
    v_mfma_f32_32x32x16_bf16 v[144:159], v[100:103], a[64:67], v[144:159]
    ds_read_b128 v[120:123], v19 offset:0
    ds_read_b128 v[124:127], v19 offset:8192
    s_bfe_u32 s17, s14, 0x40018
    s_lshl_b32 s17, s17, 8
    s_add_u32 s20, s16, s17
    s_add_u32 m0, s18, 98304
    s_waitcnt lgkmcnt(5)
    v_mfma_f32_32x32x16_bf16 v[160:175], v[104:107], a[64:67], v[160:175]
    buffer_load_dwordx4 v7, s[8:11], s20 offen sc0 sc1 lds
    s_add_u32 m0, s18, 99328
    s_waitcnt lgkmcnt(4)
    v_mfma_f32_32x32x16_bf16 v[184:199], v[108:111], a[64:67], v[184:199]
    buffer_load_dwordx4 v8, s[8:11], s20 offen sc0 sc1 lds
    s_waitcnt lgkmcnt(3)
    v_mfma_f32_32x32x16_bf16 v[128:143], v[112:115], a[68:71], v[128:143]
    ds_read_b128 v[96:99], v11 offset:0
    ds_read_b128 v[100:103], v11 offset:8192
    s_waitcnt lgkmcnt(4)
    v_mfma_f32_32x32x16_bf16 v[144:159], v[116:119], a[68:71], v[144:159]
    ds_read_b128 v[104:107], v20 offset:0
    ds_read_b128 v[108:111], v20 offset:8192
    s_add_u32 m0, s18, 100352
    s_waitcnt lgkmcnt(5)
    v_mfma_f32_32x32x16_bf16 v[160:175], v[120:123], a[68:71], v[160:175]
    buffer_load_dwordx4 v9, s[8:11], s20 offen sc0 sc1 lds
    s_add_u32 m0, s18, 101376
    s_waitcnt lgkmcnt(4)
    v_mfma_f32_32x32x16_bf16 v[184:199], v[124:127], a[68:71], v[184:199]
    buffer_load_dwordx4 v10, s[8:11], s20 offen sc0 sc1 lds
    s_waitcnt lgkmcnt(3)
    v_mfma_f32_32x32x16_bf16 v[128:143], v[96:99], a[72:75], v[128:143]
    ds_read_b128 v[112:115], v12 offset:0
    ds_read_b128 v[116:119], v12 offset:8192
    s_waitcnt lgkmcnt(4)
    v_mfma_f32_32x32x16_bf16 v[144:159], v[100:103], a[72:75], v[144:159]
    ds_read_b128 v[120:123], v21 offset:0
    ds_read_b128 v[124:127], v21 offset:8192
    s_add_u32 s21, s20, 65536
    s_add_u32 m0, s18, 102400
    s_waitcnt lgkmcnt(5)
    v_mfma_f32_32x32x16_bf16 v[160:175], v[104:107], a[72:75], v[160:175]
    buffer_load_dwordx4 v7, s[8:11], s21 offen sc0 sc1 lds
    s_add_u32 m0, s18, 103424
    s_waitcnt lgkmcnt(4)
    v_mfma_f32_32x32x16_bf16 v[184:199], v[108:111], a[72:75], v[184:199]
    buffer_load_dwordx4 v8, s[8:11], s21 offen sc0 sc1 lds
    s_waitcnt lgkmcnt(0)
    s_waitcnt vmcnt(15)
    s_barrier
    v_mfma_f32_32x32x16_bf16 v[128:143], v[112:115], a[76:79], v[128:143]
    ds_read_b128 v[96:99], v4 offset:32768
    ds_read_b128 v[100:103], v4 offset:40960
    v_mfma_f32_32x32x16_bf16 v[144:159], v[116:119], a[76:79], v[144:159]
    ds_read_b128 v[104:107], v18 offset:32768
    ds_read_b128 v[108:111], v18 offset:40960
    s_add_u32 m0, s18, 104448
    v_mfma_f32_32x32x16_bf16 v[160:175], v[120:123], a[76:79], v[160:175]
    buffer_load_dwordx4 v9, s[8:11], s21 offen sc0 sc1 lds
    s_add_u32 m0, s18, 105472
    v_mfma_f32_32x32x16_bf16 v[184:199], v[124:127], a[76:79], v[184:199]
    buffer_load_dwordx4 v10, s[8:11], s21 offen sc0 sc1 lds
    s_waitcnt lgkmcnt(3)
    v_mfma_f32_32x32x16_bf16 v[128:143], v[96:99], a[80:83], v[128:143]
    ds_read_b128 v[112:115], v5 offset:32768
    ds_read_b128 v[116:119], v5 offset:40960
    s_add_u32 m0, s47, 131072
    s_nop 0
    buffer_load_dwordx4 v35, s[56:59], s31 offen lds
    s_add_u32 s31, s31, 16384
    s_add_u32 m0, s47, 132096
    s_nop 0
    buffer_load_dwordx4 v35, s[56:59], s31 offen lds
    s_waitcnt lgkmcnt(4)
    v_mfma_f32_32x32x16_bf16 v[144:159], v[100:103], a[80:83], v[144:159]
    ds_read_b128 v[120:123], v19 offset:32768
    ds_read_b128 v[124:127], v19 offset:40960
    s_bfe_u32 s17, s14, 0x4001c
    s_lshl_b32 s17, s17, 8
    s_add_u32 s20, s16, s17
    s_add_u32 m0, s18, 0
    s_waitcnt lgkmcnt(5)
    v_mfma_f32_32x32x16_bf16 v[160:175], v[104:107], a[80:83], v[160:175]
    buffer_load_dwordx4 v7, s[8:11], s20 offen sc0 sc1 lds
    s_add_u32 s31, s31, 16384
    s_add_u32 m0, s47, 133120
    s_nop 0
    buffer_load_dwordx4 v35, s[56:59], s31 offen lds
    s_add_u32 s31, s31, 16384
    s_add_u32 m0, s18, 1024
    s_waitcnt lgkmcnt(4)
    v_mfma_f32_32x32x16_bf16 v[184:199], v[108:111], a[80:83], v[184:199]
    buffer_load_dwordx4 v8, s[8:11], s20 offen sc0 sc1 lds
    s_add_u32 m0, s47, 134144
    s_nop 0
    buffer_load_dwordx4 v35, s[56:59], s31 offen lds
    s_lshr_b32 s3, s47, 2
    s_add_u32 m0, s3, 147456
    s_nop 0
    buffer_load_dwordx4 v38, s[8:11], 0 offen sc0 sc1 lds
    s_waitcnt lgkmcnt(3)
    v_mfma_f32_32x32x16_bf16 v[128:143], v[112:115], a[84:87], v[128:143]
    ds_read_b128 v[96:99], v11 offset:32768
    ds_read_b128 v[100:103], v11 offset:40960
    s_waitcnt lgkmcnt(4)
    v_mfma_f32_32x32x16_bf16 v[144:159], v[116:119], a[84:87], v[144:159]
    ds_read_b128 v[104:107], v20 offset:32768
    ds_read_b128 v[108:111], v20 offset:40960
    s_add_u32 m0, s18, 2048
    s_waitcnt lgkmcnt(5)
    v_mfma_f32_32x32x16_bf16 v[160:175], v[120:123], a[84:87], v[160:175]
    buffer_load_dwordx4 v9, s[8:11], s20 offen sc0 sc1 lds
    s_add_u32 m0, s18, 3072
    s_waitcnt lgkmcnt(4)
    v_mfma_f32_32x32x16_bf16 v[184:199], v[124:127], a[84:87], v[184:199]
    buffer_load_dwordx4 v10, s[8:11], s20 offen sc0 sc1 lds
    s_waitcnt lgkmcnt(3)
    v_mfma_f32_32x32x16_bf16 v[128:143], v[96:99], a[88:91], v[128:143]
    ds_read_b128 v[112:115], v12 offset:32768
    ds_read_b128 v[116:119], v12 offset:40960
    s_waitcnt lgkmcnt(4)
    v_mfma_f32_32x32x16_bf16 v[144:159], v[100:103], a[88:91], v[144:159]
    ds_read_b128 v[120:123], v21 offset:32768
    ds_read_b128 v[124:127], v21 offset:40960
    s_add_u32 s21, s20, 65536
    s_add_u32 m0, s18, 4096
    s_waitcnt lgkmcnt(5)
    v_mfma_f32_32x32x16_bf16 v[160:175], v[104:107], a[88:91], v[160:175]
    buffer_load_dwordx4 v7, s[8:11], s21 offen sc0 sc1 lds
    s_add_u32 m0, s18, 5120
    s_waitcnt lgkmcnt(4)
    v_mfma_f32_32x32x16_bf16 v[184:199], v[108:111], a[88:91], v[184:199]
    buffer_load_dwordx4 v8, s[8:11], s21 offen sc0 sc1 lds
    s_waitcnt lgkmcnt(0)
    s_waitcnt vmcnt(20)
    s_barrier
    v_mfma_f32_32x32x16_bf16 v[128:143], v[112:115], a[92:95], v[128:143]
    ds_read_b128 v[96:99], v13 offset:0
    ds_read_b128 v[100:103], v13 offset:8192
    v_mfma_f32_32x32x16_bf16 v[144:159], v[116:119], a[92:95], v[144:159]
    ds_read_b128 v[104:107], v22 offset:0
    ds_read_b128 v[108:111], v22 offset:8192
    s_add_u32 m0, s18, 6144
    v_mfma_f32_32x32x16_bf16 v[160:175], v[120:123], a[92:95], v[160:175]
    buffer_load_dwordx4 v9, s[8:11], s21 offen sc0 sc1 lds
    s_add_u32 m0, s18, 7168
    v_mfma_f32_32x32x16_bf16 v[184:199], v[124:127], a[92:95], v[184:199]
    buffer_load_dwordx4 v10, s[8:11], s21 offen sc0 sc1 lds
    s_waitcnt lgkmcnt(3)
    v_mfma_f32_32x32x16_bf16 v[128:143], v[96:99], a[96:99], v[128:143]
    ds_read_b128 v[112:115], v14 offset:0
    ds_read_b128 v[116:119], v14 offset:8192
    s_waitcnt lgkmcnt(4)
    v_mfma_f32_32x32x16_bf16 v[144:159], v[100:103], a[96:99], v[144:159]
    ds_read_b128 v[120:123], v23 offset:0
    ds_read_b128 v[124:127], v23 offset:8192
    s_bfe_u32 s17, s15, 0x40000
    s_lshl_b32 s17, s17, 8
    s_add_u32 s20, s16, s17
    s_add_u32 m0, s18, 32768
    s_waitcnt lgkmcnt(5)
    v_mfma_f32_32x32x16_bf16 v[160:175], v[104:107], a[96:99], v[160:175]
    buffer_load_dwordx4 v7, s[8:11], s20 offen sc0 sc1 lds
    s_add_u32 m0, s18, 33792
    s_waitcnt lgkmcnt(4)
    v_mfma_f32_32x32x16_bf16 v[184:199], v[108:111], a[96:99], v[184:199]
    buffer_load_dwordx4 v8, s[8:11], s20 offen sc0 sc1 lds
    s_waitcnt lgkmcnt(3)
    v_mfma_f32_32x32x16_bf16 v[128:143], v[112:115], a[100:103], v[128:143]
    ds_read_b128 v[96:99], v15 offset:0
    ds_read_b128 v[100:103], v15 offset:8192
    s_waitcnt lgkmcnt(4)
    v_mfma_f32_32x32x16_bf16 v[144:159], v[116:119], a[100:103], v[144:159]
    ds_read_b128 v[104:107], v24 offset:0
    ds_read_b128 v[108:111], v24 offset:8192
    s_add_u32 m0, s18, 34816
    s_waitcnt lgkmcnt(5)
    v_mfma_f32_32x32x16_bf16 v[160:175], v[120:123], a[100:103], v[160:175]
    buffer_load_dwordx4 v9, s[8:11], s20 offen sc0 sc1 lds
    s_add_u32 m0, s18, 35840
    s_waitcnt lgkmcnt(4)
    v_mfma_f32_32x32x16_bf16 v[184:199], v[124:127], a[100:103], v[184:199]
    buffer_load_dwordx4 v10, s[8:11], s20 offen sc0 sc1 lds
    s_waitcnt lgkmcnt(3)
    v_mfma_f32_32x32x16_bf16 v[128:143], v[96:99], a[104:107], v[128:143]
    ds_read_b128 v[112:115], v16 offset:0
    ds_read_b128 v[116:119], v16 offset:8192
    s_waitcnt lgkmcnt(4)
    v_mfma_f32_32x32x16_bf16 v[144:159], v[100:103], a[104:107], v[144:159]
    ds_read_b128 v[120:123], v25 offset:0
    ds_read_b128 v[124:127], v25 offset:8192
    s_add_u32 s21, s20, 65536
    s_add_u32 m0, s18, 36864
    s_waitcnt lgkmcnt(5)
    v_mfma_f32_32x32x16_bf16 v[160:175], v[104:107], a[104:107], v[160:175]
    buffer_load_dwordx4 v7, s[8:11], s21 offen sc0 sc1 lds
    s_add_u32 m0, s18, 37888
    s_waitcnt lgkmcnt(4)
    v_mfma_f32_32x32x16_bf16 v[184:199], v[108:111], a[104:107], v[184:199]
    buffer_load_dwordx4 v8, s[8:11], s21 offen sc0 sc1 lds
    s_waitcnt lgkmcnt(0)
    s_waitcnt vmcnt(19)
    s_barrier
    v_mfma_f32_32x32x16_bf16 v[128:143], v[112:115], a[108:111], v[128:143]
    ds_read_b128 v[96:99], v13 offset:32768
    ds_read_b128 v[100:103], v13 offset:40960
    v_mfma_f32_32x32x16_bf16 v[144:159], v[116:119], a[108:111], v[144:159]
    ds_read_b128 v[104:107], v22 offset:32768
    ds_read_b128 v[108:111], v22 offset:40960
    s_add_u32 m0, s18, 38912
    v_mfma_f32_32x32x16_bf16 v[160:175], v[120:123], a[108:111], v[160:175]
    buffer_load_dwordx4 v9, s[8:11], s21 offen sc0 sc1 lds
    s_add_u32 m0, s18, 39936
    v_mfma_f32_32x32x16_bf16 v[184:199], v[124:127], a[108:111], v[184:199]
    buffer_load_dwordx4 v10, s[8:11], s21 offen sc0 sc1 lds
    s_waitcnt lgkmcnt(3)
    v_mfma_f32_32x32x16_bf16 v[128:143], v[96:99], a[112:115], v[128:143]
    ds_read_b128 v[112:115], v14 offset:32768
    ds_read_b128 v[116:119], v14 offset:40960
    s_waitcnt vmcnt(14)
    ds_read_b128 v[46:49], v39 offset:0
    ds_read_b128 v[84:87], v39 offset:256
    s_waitcnt lgkmcnt(6)
    v_mfma_f32_32x32x16_bf16 v[144:159], v[100:103], a[112:115], v[144:159]
    ds_read_b128 v[120:123], v23 offset:32768
    ds_read_b128 v[124:127], v23 offset:40960
    s_bfe_u32 s17, s15, 0x40004
    s_lshl_b32 s17, s17, 8
    s_add_u32 s20, s16, s17
    s_add_u32 m0, s18, 65536
    s_waitcnt lgkmcnt(7)
    v_mfma_f32_32x32x16_bf16 v[160:175], v[104:107], a[112:115], v[160:175]
    buffer_load_dwordx4 v7, s[8:11], s20 offen sc0 sc1 lds
    ds_read_b128 v[54:57], v39 offset:32
    ds_read_b128 v[88:91], v39 offset:288
    ds_read_b128 v[58:61], v39 offset:64
    s_add_u32 m0, s18, 66560
    s_waitcnt lgkmcnt(9)
    v_mfma_f32_32x32x16_bf16 v[184:199], v[108:111], a[112:115], v[184:199]
    buffer_load_dwordx4 v8, s[8:11], s20 offen sc0 sc1 lds
    ds_read_b128 v[92:95], v39 offset:320
    ds_read_b128 v[62:65], v39 offset:96
    ds_read_b128 v[176:179], v39 offset:352
    ds_read_b128 v[66:69], v39 offset:128
    s_waitcnt lgkmcnt(12)
    v_mfma_f32_32x32x16_bf16 v[128:143], v[112:115], a[116:119], v[128:143]
    ds_read_b128 v[96:99], v15 offset:32768
    ds_read_b128 v[100:103], v15 offset:40960
    ds_read_b128 v[200:203], v39 offset:384
    ds_read_b128 v[70:73], v39 offset:160
    ds_read_b128 v[204:207], v39 offset:416
    s_waitcnt lgkmcnt(15)
    v_mfma_f32_32x32x16_bf16 v[144:159], v[116:119], a[116:119], v[144:159]
    ds_read_b128 v[104:107], v24 offset:32768
    ds_read_b128 v[108:111], v24 offset:40960
    ds_read_b128 v[74:77], v39 offset:192
    ds_read_b128 v[208:211], v39 offset:448
    s_add_u32 m0, s18, 67584
    s_waitcnt lgkmcnt(15)
    v_mfma_f32_32x32x16_bf16 v[160:175], v[120:123], a[116:119], v[160:175]
    buffer_load_dwordx4 v9, s[8:11], s20 offen sc0 sc1 lds
    ds_read_b128 v[78:81], v39 offset:224
    ds_read_b128 v[212:215], v39 offset:480
    buffer_load_dwordx2 v[30:31], v29, s[8:11], 0 offen sc0 sc1
    s_add_u32 m0, s18, 68608
    v_mfma_f32_32x32x16_bf16 v[184:199], v[124:127], a[116:119], v[184:199]
    buffer_load_dwordx4 v10, s[8:11], s20 offen sc0 sc1 lds
    s_waitcnt lgkmcnt(10)
    v_mfma_f32_32x32x16_bf16 v[128:143], v[96:99], a[120:123], v[128:143]
    ds_read_b128 v[112:115], v16 offset:32768
    ds_read_b128 v[116:119], v16 offset:40960
    s_waitcnt lgkmcnt(11)
    v_mfma_f32_32x32x16_bf16 v[144:159], v[100:103], a[120:123], v[144:159]
    ds_read_b128 v[120:123], v25 offset:32768
    ds_read_b128 v[124:127], v25 offset:40960
    s_add_u32 s21, s20, 65536
    s_add_u32 m0, s18, 69632
    s_waitcnt lgkmcnt(9)
    v_mfma_f32_32x32x16_bf16 v[160:175], v[104:107], a[120:123], v[160:175]
    buffer_load_dwordx4 v7, s[8:11], s21 offen sc0 sc1 lds
    s_add_u32 m0, s18, 70656
    s_waitcnt lgkmcnt(8)
    v_mfma_f32_32x32x16_bf16 v[184:199], v[108:111], a[120:123], v[184:199]
    buffer_load_dwordx4 v8, s[8:11], s21 offen sc0 sc1 lds
    s_waitcnt lgkmcnt(0)
    s_waitcnt vmcnt(15)
    s_barrier
    v_mfma_f32_32x32x16_bf16 v[128:143], v[112:115], a[124:127], v[128:143]
    ds_read_b128 v[96:99], v4 offset:0
    ds_read_b128 v[100:103], v4 offset:8192
    v_mfma_f32_32x32x16_bf16 v[144:159], v[116:119], a[124:127], v[144:159]
    ds_read_b128 v[104:107], v18 offset:0
    ds_read_b128 v[108:111], v18 offset:8192
    s_add_u32 m0, s18, 71680
    v_mfma_f32_32x32x16_bf16 v[160:175], v[120:123], a[124:127], v[160:175]
    buffer_load_dwordx4 v9, s[8:11], s21 offen sc0 sc1 lds
    s_add_u32 m0, s18, 72704
    v_mfma_f32_32x32x16_bf16 v[184:199], v[124:127], a[124:127], v[184:199]
    buffer_load_dwordx4 v10, s[8:11], s21 offen sc0 sc1 lds
    s_waitcnt lgkmcnt(3)
    v_mfma_f32_32x32x16_bf16 v[128:143], v[96:99], a[128:131], v[128:143]
    ds_read_b128 v[112:115], v5 offset:0
    ds_read_b128 v[116:119], v5 offset:8192
    s_waitcnt lgkmcnt(4)
    v_mfma_f32_32x32x16_bf16 v[144:159], v[100:103], a[128:131], v[144:159]
    ds_read_b128 v[120:123], v19 offset:0
    ds_read_b128 v[124:127], v19 offset:8192
    s_bfe_u32 s17, s15, 0x40008
    s_lshl_b32 s17, s17, 8
    s_add_u32 s20, s16, s17
    s_add_u32 m0, s18, 98304
    s_waitcnt lgkmcnt(5)
    v_mfma_f32_32x32x16_bf16 v[160:175], v[104:107], a[128:131], v[160:175]
    buffer_load_dwordx4 v7, s[8:11], s20 offen sc0 sc1 lds
    s_add_u32 m0, s18, 99328
    s_waitcnt lgkmcnt(4)
    v_mfma_f32_32x32x16_bf16 v[184:199], v[108:111], a[128:131], v[184:199]
    buffer_load_dwordx4 v8, s[8:11], s20 offen sc0 sc1 lds
    s_waitcnt lgkmcnt(3)
    v_mfma_f32_32x32x16_bf16 v[128:143], v[112:115], a[132:135], v[128:143]
    ds_read_b128 v[96:99], v11 offset:0
    ds_read_b128 v[100:103], v11 offset:8192
    s_waitcnt lgkmcnt(4)
    v_mfma_f32_32x32x16_bf16 v[144:159], v[116:119], a[132:135], v[144:159]
    ds_read_b128 v[104:107], v20 offset:0
    ds_read_b128 v[108:111], v20 offset:8192
    s_add_u32 m0, s18, 100352
    s_waitcnt lgkmcnt(5)
    v_mfma_f32_32x32x16_bf16 v[160:175], v[120:123], a[132:135], v[160:175]
    buffer_load_dwordx4 v9, s[8:11], s20 offen sc0 sc1 lds
    s_add_u32 m0, s18, 101376
    s_waitcnt lgkmcnt(4)
    v_mfma_f32_32x32x16_bf16 v[184:199], v[124:127], a[132:135], v[184:199]
    buffer_load_dwordx4 v10, s[8:11], s20 offen sc0 sc1 lds
    s_waitcnt lgkmcnt(3)
    v_mfma_f32_32x32x16_bf16 v[128:143], v[96:99], a[136:139], v[128:143]
    ds_read_b128 v[112:115], v12 offset:0
    ds_read_b128 v[116:119], v12 offset:8192
    s_waitcnt lgkmcnt(4)
    v_mfma_f32_32x32x16_bf16 v[144:159], v[100:103], a[136:139], v[144:159]
    ds_read_b128 v[120:123], v21 offset:0
    ds_read_b128 v[124:127], v21 offset:8192
    s_add_u32 s21, s20, 65536
    s_add_u32 m0, s18, 102400
    s_waitcnt lgkmcnt(5)
    v_mfma_f32_32x32x16_bf16 v[160:175], v[104:107], a[136:139], v[160:175]
    buffer_load_dwordx4 v7, s[8:11], s21 offen sc0 sc1 lds
    s_add_u32 m0, s18, 103424
    s_waitcnt lgkmcnt(4)
    v_mfma_f32_32x32x16_bf16 v[184:199], v[108:111], a[136:139], v[184:199]
    buffer_load_dwordx4 v8, s[8:11], s21 offen sc0 sc1 lds
    s_waitcnt lgkmcnt(0)
    s_waitcnt vmcnt(15)
    s_barrier
    v_mfma_f32_32x32x16_bf16 v[128:143], v[112:115], a[140:143], v[128:143]
    ds_read_b128 v[96:99], v4 offset:32768
    ds_read_b128 v[100:103], v4 offset:40960
    v_mfma_f32_32x32x16_bf16 v[144:159], v[116:119], a[140:143], v[144:159]
    ds_read_b128 v[104:107], v18 offset:32768
    ds_read_b128 v[108:111], v18 offset:40960
    s_add_u32 m0, s18, 104448
    v_mfma_f32_32x32x16_bf16 v[160:175], v[120:123], a[140:143], v[160:175]
    buffer_load_dwordx4 v9, s[8:11], s21 offen sc0 sc1 lds
    s_add_u32 m0, s18, 105472
    v_mfma_f32_32x32x16_bf16 v[184:199], v[124:127], a[140:143], v[184:199]
    buffer_load_dwordx4 v10, s[8:11], s21 offen sc0 sc1 lds
    s_waitcnt lgkmcnt(3)
    v_mfma_f32_32x32x16_bf16 v[128:143], v[96:99], a[144:147], v[128:143]
    ds_read_b128 v[112:115], v5 offset:32768
    ds_read_b128 v[116:119], v5 offset:40960
    s_mov_b32 s4, 0
    s_waitcnt vmcnt(13)
    v_cmp_ne_u64 vcc, s[42:43], v[30:31]
    s_nop 4
    s_cbranch_vccz Lfdone_gate_13
Lfpoll_gate_14:
    buffer_load_dwordx2 v[30:31], v29, s[8:11], 0 offen sc0 sc1
    s_waitcnt vmcnt(0)
    v_cmp_ne_u64 vcc, s[42:43], v[30:31]
    s_nop 4
    s_add_u32 s4, s4, 1
    s_cmp_gt_u32 s4, 20000
    s_cbranch_scc1 Lfdone_gate_13
    s_cbranch_vccnz Lfpoll_gate_14
Lfdone_gate_13:
    s_add_u32 m0, s47, 147456
    s_nop 0
    buffer_load_dwordx4 v7, s[8:11], s38 offen sc0 sc1 lds
    s_add_u32 m0, s47, 148480
    s_nop 0
    buffer_load_dwordx4 v8, s[8:11], s38 offen sc0 sc1 lds
    s_waitcnt lgkmcnt(4)
    v_mfma_f32_32x32x16_bf16 v[144:159], v[100:103], a[144:147], v[144:159]
    ds_read_b128 v[120:123], v19 offset:32768
    ds_read_b128 v[124:127], v19 offset:40960
    s_bfe_u32 s17, s15, 0x4000c
    s_lshl_b32 s17, s17, 8
    s_add_u32 s20, s16, s17
    s_add_u32 m0, s18, 0
    s_waitcnt lgkmcnt(5)
    v_mfma_f32_32x32x16_bf16 v[160:175], v[104:107], a[144:147], v[160:175]
    buffer_load_dwordx4 v7, s[8:11], s20 offen sc0 sc1 lds
    s_add_u32 m0, s47, 149504
    s_nop 0
    buffer_load_dwordx4 v9, s[8:11], s38 offen sc0 sc1 lds
    s_add_u32 m0, s47, 150528
    s_nop 0
    buffer_load_dwordx4 v10, s[8:11], s38 offen sc0 sc1 lds
    s_add_u32 m0, s18, 1024
    s_waitcnt lgkmcnt(4)
    v_mfma_f32_32x32x16_bf16 v[184:199], v[108:111], a[144:147], v[184:199]
    buffer_load_dwordx4 v8, s[8:11], s20 offen sc0 sc1 lds
    s_waitcnt lgkmcnt(3)
    v_mfma_f32_32x32x16_bf16 v[128:143], v[112:115], a[148:151], v[128:143]
    ds_read_b128 v[96:99], v11 offset:32768
    ds_read_b128 v[100:103], v11 offset:40960
    s_waitcnt lgkmcnt(4)
    v_mfma_f32_32x32x16_bf16 v[144:159], v[116:119], a[148:151], v[144:159]
    ds_read_b128 v[104:107], v20 offset:32768
    ds_read_b128 v[108:111], v20 offset:40960
    s_add_u32 m0, s18, 2048
    s_waitcnt lgkmcnt(5)
    v_mfma_f32_32x32x16_bf16 v[160:175], v[120:123], a[148:151], v[160:175]
    buffer_load_dwordx4 v9, s[8:11], s20 offen sc0 sc1 lds
    s_add_u32 m0, s18, 3072
    s_waitcnt lgkmcnt(4)
    v_mfma_f32_32x32x16_bf16 v[184:199], v[124:127], a[148:151], v[184:199]
    buffer_load_dwordx4 v10, s[8:11], s20 offen sc0 sc1 lds
    s_waitcnt lgkmcnt(3)
    v_mfma_f32_32x32x16_bf16 v[128:143], v[96:99], a[152:155], v[128:143]
    ds_read_b128 v[112:115], v12 offset:32768
    ds_read_b128 v[116:119], v12 offset:40960
    s_waitcnt lgkmcnt(4)
    v_mfma_f32_32x32x16_bf16 v[144:159], v[100:103], a[152:155], v[144:159]
    ds_read_b128 v[120:123], v21 offset:32768
    ds_read_b128 v[124:127], v21 offset:40960
    s_add_u32 s21, s20, 65536
    s_add_u32 m0, s18, 4096
    s_waitcnt lgkmcnt(5)
    v_mfma_f32_32x32x16_bf16 v[160:175], v[104:107], a[152:155], v[160:175]
    buffer_load_dwordx4 v7, s[8:11], s21 offen sc0 sc1 lds
    s_add_u32 m0, s18, 5120
    s_waitcnt lgkmcnt(4)
    v_mfma_f32_32x32x16_bf16 v[184:199], v[108:111], a[152:155], v[184:199]
    buffer_load_dwordx4 v8, s[8:11], s21 offen sc0 sc1 lds
    s_waitcnt lgkmcnt(0)
    s_waitcnt vmcnt(18)
    s_barrier
    v_mfma_f32_32x32x16_bf16 v[128:143], v[112:115], a[156:159], v[128:143]
    ds_read_b128 v[96:99], v13 offset:0
    ds_read_b128 v[100:103], v13 offset:8192
    v_mfma_f32_32x32x16_bf16 v[144:159], v[116:119], a[156:159], v[144:159]
    ds_read_b128 v[104:107], v22 offset:0
    ds_read_b128 v[108:111], v22 offset:8192
    s_add_u32 m0, s18, 6144
    v_mfma_f32_32x32x16_bf16 v[160:175], v[120:123], a[156:159], v[160:175]
    buffer_load_dwordx4 v9, s[8:11], s21 offen sc0 sc1 lds
    s_add_u32 m0, s18, 7168
    v_mfma_f32_32x32x16_bf16 v[184:199], v[124:127], a[156:159], v[184:199]
    buffer_load_dwordx4 v10, s[8:11], s21 offen sc0 sc1 lds
    s_waitcnt lgkmcnt(3)
    v_mfma_f32_32x32x16_bf16 v[128:143], v[96:99], a[160:163], v[128:143]
    ds_read_b128 v[112:115], v14 offset:0
    ds_read_b128 v[116:119], v14 offset:8192
    s_waitcnt lgkmcnt(4)
    v_mfma_f32_32x32x16_bf16 v[144:159], v[100:103], a[160:163], v[144:159]
    ds_read_b128 v[120:123], v23 offset:0
    ds_read_b128 v[124:127], v23 offset:8192
    s_bfe_u32 s17, s15, 0x40010
    s_lshl_b32 s17, s17, 8
    s_add_u32 s20, s16, s17
    s_add_u32 m0, s18, 32768
    s_waitcnt lgkmcnt(5)
    v_mfma_f32_32x32x16_bf16 v[160:175], v[104:107], a[160:163], v[160:175]
    buffer_load_dwordx4 v7, s[8:11], s20 offen sc0 sc1 lds
    s_add_u32 m0, s18, 33792
    s_waitcnt lgkmcnt(4)
    v_mfma_f32_32x32x16_bf16 v[184:199], v[108:111], a[160:163], v[184:199]
    buffer_load_dwordx4 v8, s[8:11], s20 offen sc0 sc1 lds
    s_waitcnt lgkmcnt(3)
    v_mfma_f32_32x32x16_bf16 v[128:143], v[112:115], a[164:167], v[128:143]
    ds_read_b128 v[96:99], v15 offset:0
    ds_read_b128 v[100:103], v15 offset:8192
    s_waitcnt lgkmcnt(4)
    v_mfma_f32_32x32x16_bf16 v[144:159], v[116:119], a[164:167], v[144:159]
    ds_read_b128 v[104:107], v24 offset:0
    ds_read_b128 v[108:111], v24 offset:8192
    s_add_u32 m0, s18, 34816
    s_waitcnt lgkmcnt(5)
    v_mfma_f32_32x32x16_bf16 v[160:175], v[120:123], a[164:167], v[160:175]
    buffer_load_dwordx4 v9, s[8:11], s20 offen sc0 sc1 lds
    s_add_u32 m0, s18, 35840
    s_waitcnt lgkmcnt(4)
    v_mfma_f32_32x32x16_bf16 v[184:199], v[124:127], a[164:167], v[184:199]
    buffer_load_dwordx4 v10, s[8:11], s20 offen sc0 sc1 lds
    s_waitcnt lgkmcnt(3)
    v_mfma_f32_32x32x16_bf16 v[128:143], v[96:99], a[168:171], v[128:143]
    ds_read_b128 v[112:115], v16 offset:0
    ds_read_b128 v[116:119], v16 offset:8192
    s_waitcnt lgkmcnt(4)
    v_mfma_f32_32x32x16_bf16 v[144:159], v[100:103], a[168:171], v[144:159]
    ds_read_b128 v[120:123], v25 offset:0
    ds_read_b128 v[124:127], v25 offset:8192
    s_add_u32 s21, s20, 65536
    s_add_u32 m0, s18, 36864
    s_waitcnt lgkmcnt(5)
    v_mfma_f32_32x32x16_bf16 v[160:175], v[104:107], a[168:171], v[160:175]
    buffer_load_dwordx4 v7, s[8:11], s21 offen sc0 sc1 lds
    s_add_u32 m0, s18, 37888
    s_waitcnt lgkmcnt(4)
    v_mfma_f32_32x32x16_bf16 v[184:199], v[108:111], a[168:171], v[184:199]
    buffer_load_dwordx4 v8, s[8:11], s21 offen sc0 sc1 lds
    s_waitcnt lgkmcnt(0)
    s_waitcnt vmcnt(18)
    s_barrier
    v_mfma_f32_32x32x16_bf16 v[128:143], v[112:115], a[172:175], v[128:143]
    ds_read_b128 v[96:99], v13 offset:32768
    ds_read_b128 v[100:103], v13 offset:40960
    v_mfma_f32_32x32x16_bf16 v[144:159], v[116:119], a[172:175], v[144:159]
    ds_read_b128 v[104:107], v22 offset:32768
    ds_read_b128 v[108:111], v22 offset:40960
    s_add_u32 m0, s18, 38912
    v_mfma_f32_32x32x16_bf16 v[160:175], v[120:123], a[172:175], v[160:175]
    buffer_load_dwordx4 v9, s[8:11], s21 offen sc0 sc1 lds
    s_add_u32 m0, s18, 39936
    v_mfma_f32_32x32x16_bf16 v[184:199], v[124:127], a[172:175], v[184:199]
    buffer_load_dwordx4 v10, s[8:11], s21 offen sc0 sc1 lds
    s_waitcnt lgkmcnt(3)
    v_mfma_f32_32x32x16_bf16 v[128:143], v[96:99], a[176:179], v[128:143]
    ds_read_b128 v[112:115], v14 offset:32768
    ds_read_b128 v[116:119], v14 offset:40960
    s_waitcnt lgkmcnt(4)
    v_mfma_f32_32x32x16_bf16 v[144:159], v[100:103], a[176:179], v[144:159]
    ds_read_b128 v[120:123], v23 offset:32768
    ds_read_b128 v[124:127], v23 offset:40960
    s_bfe_u32 s17, s15, 0x40014
    s_lshl_b32 s17, s17, 8
    s_add_u32 s20, s16, s17
    s_add_u32 m0, s18, 65536
    s_waitcnt lgkmcnt(5)
    v_mfma_f32_32x32x16_bf16 v[160:175], v[104:107], a[176:179], v[160:175]
    buffer_load_dwordx4 v7, s[8:11], s20 offen sc0 sc1 lds
    s_add_u32 m0, s18, 66560
    s_waitcnt lgkmcnt(4)
    v_mfma_f32_32x32x16_bf16 v[184:199], v[108:111], a[176:179], v[184:199]
    buffer_load_dwordx4 v8, s[8:11], s20 offen sc0 sc1 lds
    s_waitcnt lgkmcnt(3)
    v_mfma_f32_32x32x16_bf16 v[128:143], v[112:115], a[180:183], v[128:143]
    ds_read_b128 v[96:99], v15 offset:32768
    ds_read_b128 v[100:103], v15 offset:40960
    s_waitcnt lgkmcnt(4)
    v_mfma_f32_32x32x16_bf16 v[144:159], v[116:119], a[180:183], v[144:159]
    ds_read_b128 v[104:107], v24 offset:32768
    ds_read_b128 v[108:111], v24 offset:40960
    s_add_u32 m0, s18, 67584
    s_waitcnt lgkmcnt(5)
    v_mfma_f32_32x32x16_bf16 v[160:175], v[120:123], a[180:183], v[160:175]
    buffer_load_dwordx4 v9, s[8:11], s20 offen sc0 sc1 lds
    s_add_u32 m0, s18, 68608
    s_waitcnt lgkmcnt(4)
    v_mfma_f32_32x32x16_bf16 v[184:199], v[124:127], a[180:183], v[184:199]
    buffer_load_dwordx4 v10, s[8:11], s20 offen sc0 sc1 lds
    s_waitcnt lgkmcnt(3)
    v_mfma_f32_32x32x16_bf16 v[128:143], v[96:99], a[184:187], v[128:143]
    ds_read_b128 v[112:115], v16 offset:32768
    ds_read_b128 v[116:119], v16 offset:40960
    s_waitcnt lgkmcnt(4)
    v_mfma_f32_32x32x16_bf16 v[144:159], v[100:103], a[184:187], v[144:159]
    ds_read_b128 v[120:123], v25 offset:32768
    ds_read_b128 v[124:127], v25 offset:40960
    s_add_u32 s21, s20, 65536
    s_add_u32 m0, s18, 69632
    s_waitcnt lgkmcnt(5)
    v_mfma_f32_32x32x16_bf16 v[160:175], v[104:107], a[184:187], v[160:175]
    buffer_load_dwordx4 v7, s[8:11], s21 offen sc0 sc1 lds
    s_add_u32 m0, s18, 70656
    s_waitcnt lgkmcnt(4)
    v_mfma_f32_32x32x16_bf16 v[184:199], v[108:111], a[184:187], v[184:199]
    buffer_load_dwordx4 v8, s[8:11], s21 offen sc0 sc1 lds
    s_waitcnt lgkmcnt(0)
    s_waitcnt vmcnt(14)
    s_barrier
    v_mfma_f32_32x32x16_bf16 v[128:143], v[112:115], a[188:191], v[128:143]
    ds_read_b128 v[96:99], v4 offset:0
    ds_read_b128 v[100:103], v4 offset:8192
    v_mfma_f32_32x32x16_bf16 v[144:159], v[116:119], a[188:191], v[144:159]
    ds_read_b128 v[104:107], v18 offset:0
    ds_read_b128 v[108:111], v18 offset:8192
    s_add_u32 m0, s18, 71680
    v_mfma_f32_32x32x16_bf16 v[160:175], v[120:123], a[188:191], v[160:175]
    buffer_load_dwordx4 v9, s[8:11], s21 offen sc0 sc1 lds
    s_add_u32 m0, s18, 72704
    v_mfma_f32_32x32x16_bf16 v[184:199], v[124:127], a[188:191], v[184:199]
    buffer_load_dwordx4 v10, s[8:11], s21 offen sc0 sc1 lds
    s_waitcnt lgkmcnt(3)
    v_mfma_f32_32x32x16_bf16 v[128:143], v[96:99], a[192:195], v[128:143]
    ds_read_b128 v[112:115], v5 offset:0
    ds_read_b128 v[116:119], v5 offset:8192
    v_lshlrev_b32 v52, 16, v52
    ds_read_b64_tr_b16 v[26:27], v36 offset:0
    v_xor_b32 v1, 0, v37
    s_waitcnt lgkmcnt(5)
    v_mfma_f32_32x32x16_bf16 v[144:159], v[100:103], a[192:195], v[144:159]
    ds_read_b128 v[120:123], v19 offset:0
    ds_read_b128 v[124:127], v19 offset:8192
    s_bfe_u32 s17, s15, 0x40018
    s_lshl_b32 s17, s17, 8
    s_add_u32 s20, s16, s17
    s_add_u32 m0, s18, 98304
    s_waitcnt lgkmcnt(6)
    v_mfma_f32_32x32x16_bf16 v[160:175], v[104:107], a[192:195], v[160:175]
    buffer_load_dwordx4 v7, s[8:11], s20 offen sc0 sc1 lds
    ds_read_b64 v[50:51], v1
    s_waitcnt lgkmcnt(0)
    v_lshlrev_b32 v216, 16, v50
    v_lshlrev_b32 v220, 16, v26
    s_add_u32 m0, s18, 99328
    v_mfma_f32_32x32x16_bf16 v[184:199], v[108:111], a[192:195], v[184:199]
    buffer_load_dwordx4 v8, s[8:11], s20 offen sc0 sc1 lds
    v_and_b32 v217, s5, v50
    v_and_b32 v221, s5, v26
    v_lshlrev_b32 v218, 16, v51
    v_lshlrev_b32 v222, 16, v27
    v_mfma_f32_32x32x16_bf16 v[128:143], v[112:115], a[196:199], v[128:143]
    ds_read_b128 v[96:99], v11 offset:0
    ds_read_b128 v[100:103], v11 offset:8192
    v_and_b32 v219, s5, v51
    v_and_b32 v223, s5, v27
    ds_read_b64_tr_b16 v[32:33], v36 offset:1024
    v_mfma_f32_32x32x16_bf16 v[144:159], v[116:119], a[196:199], v[144:159]
    ds_read_b128 v[104:107], v20 offset:0
    ds_read_b128 v[108:111], v20 offset:8192
    v_xor_b32 v1, 16, v37
    ds_read_b64 v[180:181], v1
    s_add_u32 m0, s18, 100352
    v_mfma_f32_32x32x16_bf16 v[160:175], v[120:123], a[196:199], v[160:175]
    buffer_load_dwordx4 v9, s[8:11], s20 offen sc0 sc1 lds
    v_mul_f32 v84, v84, v216
    v_mul_f32 v85, v85, v217
    v_mul_f32 v86, v86, v218
    s_add_u32 m0, s18, 101376
    v_mfma_f32_32x32x16_bf16 v[184:199], v[124:127], a[196:199], v[184:199]
    buffer_load_dwordx4 v10, s[8:11], s20 offen sc0 sc1 lds
    v_mul_f32 v87, v87, v219
    v_fmac_f32 v84, v46, v52
    v_fmac_f32 v85, v47, v52
    v_fmac_f32 v86, v48, v52
    s_waitcnt lgkmcnt(5)
    v_mfma_f32_32x32x16_bf16 v[128:143], v[96:99], a[200:203], v[128:143]
    ds_read_b128 v[112:115], v12 offset:0
    ds_read_b128 v[116:119], v12 offset:8192
    v_fmac_f32 v87, v49, v52
    v_mul_f32 v84, v84, v220
    v_mul_f32 v85, v85, v221
    s_waitcnt lgkmcnt(6)
    v_mfma_f32_32x32x16_bf16 v[144:159], v[100:103], a[200:203], v[144:159]
    ds_read_b128 v[120:123], v21 offset:0
    ds_read_b128 v[124:127], v21 offset:8192
    v_mul_f32 v86, v86, v222
    s_add_u32 s21, s20, 65536
    s_add_u32 m0, s18, 102400
    s_waitcnt lgkmcnt(6)
    v_mfma_f32_32x32x16_bf16 v[160:175], v[104:107], a[200:203], v[160:175]
    buffer_load_dwordx4 v7, s[8:11], s21 offen sc0 sc1 lds
    v_mul_f32 v87, v87, v223
    s_waitcnt lgkmcnt(4)
    v_lshlrev_b32 v216, 16, v180
    v_lshlrev_b32 v220, 16, v32
    s_add_u32 m0, s18, 103424
    v_mfma_f32_32x32x16_bf16 v[184:199], v[108:111], a[200:203], v[184:199]
    buffer_load_dwordx4 v8, s[8:11], s21 offen sc0 sc1 lds
    v_and_b32 v217, s5, v180
    v_and_b32 v221, s5, v32
    v_lshlrev_b32 v218, 16, v181
    v_lshlrev_b32 v222, 16, v33
    s_waitcnt lgkmcnt(0)
    s_waitcnt vmcnt(14)
    s_barrier
    v_mfma_f32_32x32x16_bf16 v[128:143], v[112:115], a[204:207], v[128:143]
    ds_read_b128 v[96:99], v4 offset:32768
    ds_read_b128 v[100:103], v4 offset:40960
    v_and_b32 v219, s5, v181
    v_and_b32 v223, s5, v33
    ds_read_b64_tr_b16 v[26:27], v36 offset:2048
    v_mfma_f32_32x32x16_bf16 v[144:159], v[116:119], a[204:207], v[144:159]
    ds_read_b128 v[104:107], v18 offset:32768
    ds_read_b128 v[108:111], v18 offset:40960
    v_xor_b32 v1, 32, v37
    ds_read_b64 v[50:51], v1
    s_add_u32 m0, s18, 104448
    v_mfma_f32_32x32x16_bf16 v[160:175], v[120:123], a[204:207], v[160:175]
    buffer_load_dwordx4 v9, s[8:11], s21 offen sc0 sc1 lds
    v_mul_f32 v88, v88, v216
    v_mul_f32 v89, v89, v217
    v_mul_f32 v90, v90, v218
    s_add_u32 m0, s18, 105472
    v_mfma_f32_32x32x16_bf16 v[184:199], v[124:127], a[204:207], v[184:199]
    buffer_load_dwordx4 v10, s[8:11], s21 offen sc0 sc1 lds
    v_mul_f32 v91, v91, v219
    v_fmac_f32 v88, v54, v52
    v_fmac_f32 v89, v55, v52
    v_fmac_f32 v90, v56, v52
    s_waitcnt lgkmcnt(5)
    v_mfma_f32_32x32x16_bf16 v[128:143], v[96:99], a[208:211], v[128:143]
    ds_read_b128 v[112:115], v5 offset:32768
    ds_read_b128 v[116:119], v5 offset:40960
    v_fmac_f32 v91, v57, v52
    v_mul_f32 v88, v88, v220
    v_mul_f32 v89, v89, v221
    s_waitcnt lgkmcnt(6)
    v_mfma_f32_32x32x16_bf16 v[144:159], v[100:103], a[208:211], v[144:159]
    ds_read_b128 v[120:123], v19 offset:32768
    ds_read_b128 v[124:127], v19 offset:40960
    v_mul_f32 v90, v90, v222
    v_mul_f32 v91, v91, v223
    s_waitcnt lgkmcnt(4)
    v_lshlrev_b32 v216, 16, v50
    v_mfma_f32_32x32x16_bf16 v[160:175], v[104:107], a[208:211], v[160:175]
    v_lshlrev_b32 v220, 16, v26
    v_and_b32 v217, s5, v50
    v_and_b32 v221, s5, v26
    v_lshlrev_b32 v218, 16, v51
    v_lshlrev_b32 v222, 16, v27
    v_mfma_f32_32x32x16_bf16 v[184:199], v[108:111], a[208:211], v[184:199]
    v_and_b32 v219, s5, v51
    v_and_b32 v223, s5, v27
    ds_read_b64_tr_b16 v[32:33], v36 offset:3072
    v_xor_b32 v1, 48, v37
    ds_read_b64 v[180:181], v1
    s_waitcnt lgkmcnt(5)
    v_mfma_f32_32x32x16_bf16 v[128:143], v[112:115], a[212:215], v[128:143]
    ds_read_b128 v[96:99], v11 offset:32768
    ds_read_b128 v[100:103], v11 offset:40960
    v_mul_f32 v92, v92, v216
    v_mul_f32 v93, v93, v217
    v_mul_f32 v94, v94, v218
    s_waitcnt lgkmcnt(6)
    v_mfma_f32_32x32x16_bf16 v[144:159], v[116:119], a[212:215], v[144:159]
    ds_read_b128 v[104:107], v20 offset:32768
    ds_read_b128 v[108:111], v20 offset:40960
    v_mul_f32 v95, v95, v219
    v_fmac_f32 v92, v58, v52
    v_fmac_f32 v93, v59, v52
    s_waitcnt lgkmcnt(7)
    v_mfma_f32_32x32x16_bf16 v[160:175], v[120:123], a[212:215], v[160:175]
    v_fmac_f32 v94, v60, v52
    v_fmac_f32 v95, v61, v52
    v_mul_f32 v92, v92, v220
    v_mul_f32 v93, v93, v221
    v_mul_f32 v94, v94, v222
    s_waitcnt lgkmcnt(6)
    v_mfma_f32_32x32x16_bf16 v[184:199], v[124:127], a[212:215], v[184:199]
    v_mul_f32 v95, v95, v223
    s_waitcnt lgkmcnt(4)
    v_lshlrev_b32 v216, 16, v180
    v_lshlrev_b32 v220, 16, v32
    v_and_b32 v217, s5, v180
    v_and_b32 v221, s5, v32
    s_waitcnt lgkmcnt(3)
    v_mfma_f32_32x32x16_bf16 v[128:143], v[96:99], a[216:219], v[128:143]
    ds_read_b128 v[112:115], v12 offset:32768
    ds_read_b128 v[116:119], v12 offset:40960
    v_lshlrev_b32 v218, 16, v181
    v_lshlrev_b32 v222, 16, v33
    v_and_b32 v219, s5, v181
    s_waitcnt lgkmcnt(4)
    v_mfma_f32_32x32x16_bf16 v[144:159], v[100:103], a[216:219], v[144:159]
    ds_read_b128 v[120:123], v21 offset:32768
    ds_read_b128 v[124:127], v21 offset:40960
    v_and_b32 v223, s5, v33
    ds_read_b64_tr_b16 v[26:27], v36 offset:4096
    v_xor_b32 v1, 64, v37
    s_waitcnt lgkmcnt(6)
    v_mfma_f32_32x32x16_bf16 v[160:175], v[104:107], a[216:219], v[160:175]
    ds_read_b64 v[50:51], v1
    v_mul_f32 v176, v176, v216
    v_mul_f32 v177, v177, v217
    v_mul_f32 v178, v178, v218
    v_mul_f32 v179, v179, v219
    s_waitcnt lgkmcnt(6)
    v_mfma_f32_32x32x16_bf16 v[184:199], v[108:111], a[216:219], v[184:199]
    v_fmac_f32 v176, v62, v52
    v_fmac_f32 v177, v63, v52
    v_fmac_f32 v178, v64, v52
    v_fmac_f32 v179, v65, v52
    v_mul_f32 v176, v176, v220
    s_waitcnt lgkmcnt(2)
    s_waitcnt vmcnt(8)
    s_waitcnt vmcnt(0)
    s_barrier
    v_mfma_f32_32x32x16_bf16 v[128:143], v[112:115], a[220:223], v[128:143]
    ds_read_b128 v[96:99], v22 offset:0
    ds_read_b128 v[100:103], v23 offset:0
    v_mul_f32 v177, v177, v221
    v_mul_f32 v178, v178, v222
    v_mul_f32 v179, v179, v223
    v_mfma_f32_32x32x16_bf16 v[144:159], v[116:119], a[220:223], v[144:159]
    ds_read_b128 v[104:107], v24 offset:0
    ds_read_b128 v[108:111], v25 offset:0
    s_waitcnt lgkmcnt(4)
    v_lshlrev_b32 v216, 16, v50
    v_lshlrev_b32 v220, 16, v26
    v_and_b32 v217, s5, v50
    v_mfma_f32_32x32x16_bf16 v[160:175], v[120:123], a[220:223], v[160:175]
    v_and_b32 v221, s5, v26
    v_lshlrev_b32 v218, 16, v51
    v_lshlrev_b32 v222, 16, v27
    v_and_b32 v219, s5, v51
    v_and_b32 v223, s5, v27
    v_mfma_f32_32x32x16_bf16 v[184:199], v[124:127], a[220:223], v[184:199]
    ds_read_b64_tr_b16 v[32:33], v36 offset:5120
    v_xor_b32 v1, 80, v37
    ds_read_b64 v[180:181], v1
    v_mul_f32 v200, v200, v216
    v_mul_f32 v201, v201, v217
    s_waitcnt lgkmcnt(5)
    v_mfma_f32_32x32x16_bf16 v[160:175], v[96:99], a[224:227], v[160:175]
    ds_read_b128 v[112:115], v22 offset:32768
    ds_read_b128 v[116:119], v23 offset:32768
    v_mul_f32 v202, v202, v218
    v_mul_f32 v203, v203, v219
    v_fmac_f32 v200, v66, v52
    s_waitcnt lgkmcnt(6)
    v_mfma_f32_32x32x16_bf16 v[160:175], v[100:103], a[228:231], v[160:175]
    ds_read_b128 v[120:123], v24 offset:32768
    ds_read_b128 v[124:127], v25 offset:32768
    v_fmac_f32 v201, v67, v52
    v_fmac_f32 v202, v68, v52
    v_fmac_f32 v203, v69, v52
    s_waitcnt lgkmcnt(7)
    v_mfma_f32_32x32x16_bf16 v[160:175], v[104:107], a[232:235], v[160:175]
    v_mul_f32 v200, v200, v220
    v_mul_f32 v201, v201, v221
    v_mul_f32 v202, v202, v222
    v_mul_f32 v203, v203, v223
    s_waitcnt lgkmcnt(4)
    v_lshlrev_b32 v216, 16, v180
    v_mfma_f32_32x32x16_bf16 v[160:175], v[108:111], a[236:239], v[160:175]
    v_lshlrev_b32 v220, 16, v32
    v_and_b32 v217, s5, v180
    v_and_b32 v221, s5, v32
    v_lshlrev_b32 v218, 16, v181
    v_lshlrev_b32 v222, 16, v33
    s_waitcnt lgkmcnt(3)
    v_mfma_f32_32x32x16_bf16 v[160:175], v[112:115], a[240:243], v[160:175]
    ds_read_b128 v[96:99], v22 offset:8192
    ds_read_b128 v[100:103], v23 offset:8192
    v_and_b32 v219, s5, v181
    v_and_b32 v223, s5, v33
    ds_read_b64_tr_b16 v[26:27], v36 offset:6144
    s_waitcnt lgkmcnt(5)
    v_mfma_f32_32x32x16_bf16 v[160:175], v[116:119], a[244:247], v[160:175]
    ds_read_b128 v[104:107], v24 offset:8192
    ds_read_b128 v[108:111], v25 offset:8192
    v_xor_b32 v1, 96, v37
    ds_read_b64 v[50:51], v1
    v_mul_f32 v204, v204, v216
    s_waitcnt lgkmcnt(7)
    v_mfma_f32_32x32x16_bf16 v[160:175], v[120:123], a[248:251], v[160:175]
    v_mul_f32 v205, v205, v217
    v_mul_f32 v206, v206, v218
    v_mul_f32 v207, v207, v219
    v_fmac_f32 v204, v70, v52
    v_fmac_f32 v205, v71, v52
    s_waitcnt lgkmcnt(6)
    v_mfma_f32_32x32x16_bf16 v[160:175], v[124:127], a[252:255], v[160:175]
    v_fmac_f32 v206, v72, v52
    v_fmac_f32 v207, v73, v52
    v_mul_f32 v204, v204, v220
    v_mul_f32 v205, v205, v221
    v_mul_f32 v206, v206, v222
    s_waitcnt lgkmcnt(5)
    v_mfma_f32_32x32x16_bf16 v[184:199], v[96:99], a[224:227], v[184:199]
    ds_read_b128 v[112:115], v22 offset:40960
    ds_read_b128 v[116:119], v23 offset:40960
    v_mul_f32 v207, v207, v223
    s_waitcnt lgkmcnt(2)
    v_lshlrev_b32 v216, 16, v50
    v_lshlrev_b32 v220, 16, v26
    v_mfma_f32_32x32x16_bf16 v[184:199], v[100:103], a[228:231], v[184:199]
    ds_read_b128 v[120:123], v24 offset:40960
    ds_read_b128 v[124:127], v25 offset:40960
    ds_write_b128 v44, v[160:163] offset:0
    v_and_b32 v217, s5, v50
    v_and_b32 v221, s5, v26
    v_mfma_f32_32x32x16_bf16 v[184:199], v[104:107], a[232:235], v[184:199]
    ds_write_b128 v44, v[164:167] offset:1024
    ds_write_b128 v44, v[168:171] offset:2048
    v_lshlrev_b32 v218, 16, v51
    v_lshlrev_b32 v222, 16, v27
    v_and_b32 v219, s5, v51
    v_mfma_f32_32x32x16_bf16 v[184:199], v[108:111], a[236:239], v[184:199]
    ds_write_b128 v44, v[172:175] offset:3072
    v_and_b32 v223, s5, v27
    ds_read_b64_tr_b16 v[32:33], v36 offset:7168
    v_xor_b32 v1, 112, v37
    ds_read_b64 v[180:181], v1
    s_waitcnt lgkmcnt(9)
    v_mfma_f32_32x32x16_bf16 v[184:199], v[112:115], a[240:243], v[184:199]
    ds_read_b128 v[96:99], v13 offset:0
    ds_read_b128 v[100:103], v14 offset:0
    v_mul_f32 v208, v208, v216
    v_mul_f32 v209, v209, v217
    v_mul_f32 v210, v210, v218
    s_waitcnt lgkmcnt(10)
    v_mfma_f32_32x32x16_bf16 v[184:199], v[116:119], a[244:247], v[184:199]
    ds_read_b128 v[104:107], v15 offset:0
    ds_read_b128 v[108:111], v16 offset:0
    v_mul_f32 v211, v211, v219
    v_fmac_f32 v208, v74, v52
    v_fmac_f32 v209, v75, v52
    s_waitcnt lgkmcnt(11)
    v_mfma_f32_32x32x16_bf16 v[184:199], v[120:123], a[248:251], v[184:199]
    v_fmac_f32 v210, v76, v52
    v_fmac_f32 v211, v77, v52
    v_mul_f32 v208, v208, v220
    v_mul_f32 v209, v209, v221
    v_mul_f32 v210, v210, v222
    s_waitcnt lgkmcnt(10)
    v_mfma_f32_32x32x16_bf16 v[184:199], v[124:127], a[252:255], v[184:199]
    v_mul_f32 v211, v211, v223
    s_waitcnt lgkmcnt(4)
    v_lshlrev_b32 v216, 16, v180
    v_lshlrev_b32 v220, 16, v32
    v_and_b32 v217, s5, v180
    v_and_b32 v221, s5, v32
    s_waitcnt lgkmcnt(3)
    v_mfma_f32_32x32x16_bf16 v[128:143], v[96:99], a[224:227], v[128:143]
    ds_read_b128 v[112:115], v13 offset:32768
    ds_read_b128 v[116:119], v14 offset:32768
    v_lshlrev_b32 v218, 16, v181
    v_lshlrev_b32 v222, 16, v33
    v_and_b32 v219, s5, v181
    s_waitcnt lgkmcnt(4)
    v_mfma_f32_32x32x16_bf16 v[128:143], v[100:103], a[228:231], v[128:143]
    ds_read_b128 v[120:123], v15 offset:32768
    ds_read_b128 v[124:127], v16 offset:32768
    ds_write_b128 v44, v[184:187] offset:4096
    v_and_b32 v223, s5, v33
    v_mul_f32 v212, v212, v216
    s_waitcnt lgkmcnt(6)
    v_mfma_f32_32x32x16_bf16 v[128:143], v[104:107], a[232:235], v[128:143]
    ds_write_b128 v44, v[188:191] offset:5120
    ds_write_b128 v44, v[192:195] offset:6144
    v_mul_f32 v213, v213, v217
    v_mul_f32 v214, v214, v218
    v_mul_f32 v215, v215, v219
    s_waitcnt lgkmcnt(7)
    v_mfma_f32_32x32x16_bf16 v[128:143], v[108:111], a[236:239], v[128:143]
    ds_write_b128 v44, v[196:199] offset:7168
    v_fmac_f32 v212, v78, v52
    v_fmac_f32 v213, v79, v52
    v_fmac_f32 v214, v80, v52
    v_fmac_f32 v215, v81, v52
    v_mul_f32 v212, v212, v220
    v_mul_f32 v213, v213, v221
    v_mul_f32 v214, v214, v222
    v_mul_f32 v215, v215, v223
    s_waitcnt lgkmcnt(7)
    v_mfma_f32_32x32x16_bf16 v[128:143], v[112:115], a[240:243], v[128:143]
    ds_read_b128 v[96:99], v13 offset:8192
    ds_read_b128 v[100:103], v14 offset:8192
    s_waitcnt lgkmcnt(8)
    v_mfma_f32_32x32x16_bf16 v[128:143], v[116:119], a[244:247], v[128:143]
    ds_read_b128 v[104:107], v15 offset:8192
    ds_read_b128 v[108:111], v16 offset:8192
    s_waitcnt lgkmcnt(9)
    v_mfma_f32_32x32x16_bf16 v[128:143], v[120:123], a[248:251], v[128:143]
    s_waitcnt lgkmcnt(4)
    s_barrier
    ds_read_b128 v[224:227], v45 offset:0
    ds_read_b128 v[228:231], v45 offset:1024
    v_mfma_f32_32x32x16_bf16 v[128:143], v[124:127], a[252:255], v[128:143]
    ds_read_b128 v[232:235], v45 offset:2048
    ds_read_b128 v[236:239], v45 offset:3072
    s_waitcnt lgkmcnt(7)
    v_mfma_f32_32x32x16_bf16 v[144:159], v[96:99], a[224:227], v[144:159]
    ds_read_b128 v[112:115], v13 offset:40960
    ds_read_b128 v[116:119], v14 offset:40960
    s_waitcnt lgkmcnt(8)
    v_mfma_f32_32x32x16_bf16 v[144:159], v[100:103], a[228:231], v[144:159]
    ds_read_b128 v[120:123], v15 offset:40960
    ds_read_b128 v[124:127], v16 offset:40960
    s_waitcnt lgkmcnt(7)
    s_nop 0
    v_add_f32 v128, v128, v224
    v_add_f32 v129, v129, v225
    v_add_f32 v130, v130, v226
    v_add_f32 v131, v131, v227
    v_fma_f32 v128, v46, v128, v84
    v_fma_f32 v129, v47, v129, v85
    v_fma_f32 v130, v48, v130, v86
    v_mfma_f32_32x32x16_bf16 v[144:159], v[104:107], a[232:235], v[144:159]
    v_fma_f32 v131, v49, v131, v87
    buffer_store_dword v128, v40, s[32:35], s39 offen
    buffer_store_dword v129, v41, s[32:35], s39 offen
    buffer_store_dword v130, v42, s[32:35], s39 offen
    buffer_store_dword v131, v43, s[32:35], s39 offen
    s_waitcnt lgkmcnt(6)
    v_add_f32 v132, v132, v228
    v_add_f32 v133, v133, v229
    v_add_f32 v134, v134, v230
    v_add_f32 v135, v135, v231
    v_mfma_f32_32x32x16_bf16 v[144:159], v[108:111], a[236:239], v[144:159]
    v_fma_f32 v132, v54, v132, v88
    v_fma_f32 v133, v55, v133, v89
    v_fma_f32 v134, v56, v134, v90
    v_fma_f32 v135, v57, v135, v91
    s_add_u32 s39, s39, 32768
    buffer_store_dword v132, v40, s[32:35], s39 offen
    buffer_store_dword v133, v41, s[32:35], s39 offen
    buffer_store_dword v134, v42, s[32:35], s39 offen
    buffer_store_dword v135, v43, s[32:35], s39 offen
    s_waitcnt lgkmcnt(3)
    v_mfma_f32_32x32x16_bf16 v[144:159], v[112:115], a[240:243], v[144:159]
    ds_read_b128 v[96:99], v45 offset:4096
    ds_read_b128 v[100:103], v45 offset:5120
    v_add_f32 v136, v136, v232
    v_add_f32 v137, v137, v233
    v_add_f32 v138, v138, v234
    v_add_f32 v139, v139, v235
    v_fma_f32 v136, v58, v136, v92
    v_fma_f32 v137, v59, v137, v93
    v_fma_f32 v138, v60, v138, v94
    s_waitcnt lgkmcnt(4)
    v_mfma_f32_32x32x16_bf16 v[144:159], v[116:119], a[244:247], v[144:159]
    ds_read_b128 v[104:107], v45 offset:6144
    ds_read_b128 v[108:111], v45 offset:7168
    v_fma_f32 v139, v61, v139, v95
    s_add_u32 s39, s39, 32768
    buffer_store_dword v136, v40, s[32:35], s39 offen
    buffer_store_dword v137, v41, s[32:35], s39 offen
    buffer_store_dword v138, v42, s[32:35], s39 offen
    buffer_store_dword v139, v43, s[32:35], s39 offen
    v_add_f32 v140, v140, v236
    s_waitcnt lgkmcnt(5)
    v_mfma_f32_32x32x16_bf16 v[144:159], v[120:123], a[248:251], v[144:159]
    v_add_f32 v141, v141, v237
    v_add_f32 v142, v142, v238
    v_add_f32 v143, v143, v239
    v_fma_f32 v140, v62, v140, v176
    v_fma_f32 v141, v63, v141, v177
    v_fma_f32 v142, v64, v142, v178
    v_fma_f32 v143, v65, v143, v179
    s_add_u32 s39, s39, 32768
    buffer_store_dword v140, v40, s[32:35], s39 offen
    s_waitcnt lgkmcnt(4)
    v_mfma_f32_32x32x16_bf16 v[144:159], v[124:127], a[252:255], v[144:159]
    buffer_store_dword v141, v41, s[32:35], s39 offen
    buffer_store_dword v142, v42, s[32:35], s39 offen
    buffer_store_dword v143, v43, s[32:35], s39 offen
    s_waitcnt lgkmcnt(3)
    s_nop 7
    v_add_f32 v144, v144, v96
    v_add_f32 v145, v145, v97
    v_add_f32 v146, v146, v98
    v_add_f32 v147, v147, v99
    v_fma_f32 v144, v66, v144, v200
    v_fma_f32 v145, v67, v145, v201
    v_fma_f32 v146, v68, v146, v202
    v_fma_f32 v147, v69, v147, v203
    s_add_u32 s39, s39, 32768
    buffer_store_dword v144, v40, s[32:35], s39 offen
    buffer_store_dword v145, v41, s[32:35], s39 offen
    buffer_store_dword v146, v42, s[32:35], s39 offen
    buffer_store_dword v147, v43, s[32:35], s39 offen
    s_waitcnt lgkmcnt(2)
    v_add_f32 v148, v148, v100
    v_add_f32 v149, v149, v101
    v_add_f32 v150, v150, v102
    v_add_f32 v151, v151, v103
    v_fma_f32 v148, v70, v148, v204
    v_fma_f32 v149, v71, v149, v205
    v_fma_f32 v150, v72, v150, v206
    v_fma_f32 v151, v73, v151, v207
    s_add_u32 s39, s39, 32768
    buffer_store_dword v148, v40, s[32:35], s39 offen
    buffer_store_dword v149, v41, s[32:35], s39 offen
    buffer_store_dword v150, v42, s[32:35], s39 offen
    buffer_store_dword v151, v43, s[32:35], s39 offen
    s_waitcnt lgkmcnt(1)
    v_add_f32 v152, v152, v104
    v_add_f32 v153, v153, v105
    v_add_f32 v154, v154, v106
    v_add_f32 v155, v155, v107
    v_fma_f32 v152, v74, v152, v208
    v_fma_f32 v153, v75, v153, v209
    v_fma_f32 v154, v76, v154, v210
    v_fma_f32 v155, v77, v155, v211
    s_add_u32 s39, s39, 32768
    buffer_store_dword v152, v40, s[32:35], s39 offen
    buffer_store_dword v153, v41, s[32:35], s39 offen
    buffer_store_dword v154, v42, s[32:35], s39 offen
    buffer_store_dword v155, v43, s[32:35], s39 offen
    s_waitcnt lgkmcnt(0)
    v_add_f32 v156, v156, v108
    v_add_f32 v157, v157, v109
    v_add_f32 v158, v158, v110
    v_add_f32 v159, v159, v111
    v_fma_f32 v156, v78, v156, v212
    v_fma_f32 v157, v79, v157, v213
    v_fma_f32 v158, v80, v158, v214
    v_fma_f32 v159, v81, v159, v215
    s_add_u32 s39, s39, 32768
    buffer_store_dword v156, v40, s[32:35], s39 offen
    buffer_store_dword v157, v41, s[32:35], s39 offen
    buffer_store_dword v158, v42, s[32:35], s39 offen
    buffer_store_dword v159, v43, s[32:35], s39 offen
Lend_gated_mix__ssm_conv_s5__ssm_conv_h3__prompt_kernel:
Lcode_last:
    s_endpgm

.section .rodata,"a"
.p2align 6
.amdhsa_kernel gated_mix__ssm_conv_s5__ssm_conv_h3__prompt_kernel
  .amdhsa_next_free_vgpr 504
  .amdhsa_next_free_sgpr 92
  .amdhsa_accum_offset 248
  .amdhsa_group_segment_fixed_size 0
  .amdhsa_kernarg_size 152
  .amdhsa_user_sgpr_count 2
  .amdhsa_user_sgpr_kernarg_segment_ptr 1
  .amdhsa_system_sgpr_workgroup_id_x 1
  .amdhsa_float_denorm_mode_32 3
.end_amdhsa_kernel
```

```asm
; @launch grid=(256,1,1) block=(256,1,1) lds=163840
.amdgcn_target "amdgcn-amd-amdhsa--gfx950"
.text
.globl gated_mix__ssm_conv_s5__ssm_conv_h3__prompt_kernel
.p2align 8
.type gated_mix__ssm_conv_s5__ssm_conv_h3__prompt_kernel,@function
gated_mix__ssm_conv_s5__ssm_conv_h3__prompt_kernel:
    s_cmp_ge_u32 s2, 256
    s_cbranch_scc1 Lend_gated_mix__ssm_conv_s5__ssm_conv_h3__prompt_kernel
    s_load_dwordx16 s[4:19], s[0:1], 0
    s_load_dwordx16 s[20:35], s[0:1], 64
    s_load_dwordx4 s[36:39], s[0:1], 128
    s_load_dwordx2 s[40:41], s[0:1], 144
    s_getpc_b64 s[42:43]
Lcpf_pc:
    s_bfe_u32 s3, s2, 0x10003
    s_lshl_b32 s3, s3, 15
    v_lshlrev_b32 v1, 7, v0
    v_add_u32 v1, s3, v1
    v_min_u32 v1, Lcode_last-Lcpf_pc, v1
    v_mov_b32 v3, s43
    v_add_co_u32 v2, vcc, s42, v1
    s_nop 1
    v_addc_co_u32 v3, vcc, 0, v3, vcc
    global_load_dword v1, v[2:3], off
    s_memrealtime s[42:43]
    v_lshrrev_b32 v2, 6, v0
    s_nop 0
    v_readfirstlane_b32 s44, v2
    v_and_b32 v2, 63, v0
    s_and_b32 s47, s2, 7
    s_lshr_b32 s45, s47, 1
    s_lshl_b32 s45, s45, 2
    s_and_b32 s46, s47, 1
    s_lshl_b32 s46, s46, 3
    s_lshr_b32 s47, s2, 3
    s_and_b32 s3, s47, 3
    s_add_u32 s45, s45, s3
    s_lshr_b32 s47, s47, 2
    s_add_u32 s46, s46, s47
    v_mov_b32 v4, 0
    v_mov_b32 v5, 0
    v_mov_b32 v6, 0
    v_mov_b32 v7, 0
    v_lshlrev_b32 v3, 4, v0
    v_add_u32 v3, 148480, v3
    ds_write_b128 v3, v[4:7]
    v_lshlrev_b32 v3, 2, v0
    v_add_u32 v3, 152576, v3
    ds_write_b32 v3, v4
    v_lshrrev_b32 v16, 4, v2
    v_and_b32 v17, 7, v2
    v_xor_b32 v17, v17, v16
    v_lshlrev_b32 v17, 4, v17
    v_lshrrev_b32 v16, 3, v2
    v_lshl_add_u32 v12, v16, 11, v17
    v_and_b32 v16, 32, v2
    v_lshl_add_u32 v8, v16, 11, v17
    v_and_b32 v16, 8, v2
    v_lshl_add_u32 v8, v16, 12, v8
    v_and_b32 v16, 16, v2
    v_lshl_add_u32 v8, v16, 7, v8
    v_xor_b32 v16, 64, v8
    v_xor_b32 v17, 64, v12
    v_add_u32 v9, 4096, v16
    v_add_u32 v10, 8192, v8
    v_add_u32 v11, 12288, v16
    v_add_u32 v13, 16384, v17
    v_add_u32 v14, 32768, v12
    v_add_u32 v15, 49152, v17
    s_lshr_b32 s50, s44, 1
    s_lshl_b32 s47, s45, 7
    s_lshl_b32 s3, s50, 6
    s_add_u32 s47, s47, s3
    s_and_b32 s3, s44, 1
    s_lshl_b32 s3, s3, 3
    s_add_u32 s47, s47, s3
    s_lshl_b32 s47, s47, 11
    s_lshl_b32 s48, s46, 6
    s_lshl_b32 s3, s50, 5
    s_add_u32 s48, s48, s3
    s_lshl_b32 s48, s48, 11
    s_lshl_b32 s49, s44, 12
    s_and_b32 s3, s2, 7
    s_lshl_b32 s51, s3, 8
    v_bfe_u32 v17, v2, 3, 2
    v_lshrrev_b32 v18, 5, v2
    v_lshlrev_b32 v18, 2, v18
    v_lshl_add_u32 v17, v17, 3, v18
    v_and_b32 v18, 7, v2
    v_lshlrev_b32 v18, 4, v18
    v_lshl_add_u32 v16, v17, 11, v18
    s_lshl_b32 s50, s45, 7
    s_lshl_b32 s3, s44, 5
    s_add_u32 s50, s50, s3
    s_lshl_b32 s50, s50, 11
    s_lshl_b32 s3, s46, 7
    s_add_u32 s50, s50, s3
    v_add_u32 v16, s50, v16
    v_subrev_u32 v18, 6144, v16
    v_min_u32 v18, 0x7fff0000, v18
    v_subrev_u32 v22, 4096, v16
    v_min_u32 v22, 0x7fff0000, v22
    v_subrev_u32 v26, 2048, v16
    v_min_u32 v26, 0x7fff0000, v26
    s_mov_b32 s50, 4096
    s_lshl_b32 s54, s46, 9
    v_lshlrev_b32 v17, 4, v2
    s_waitcnt lgkmcnt(0)
    s_mov_b32 s56, s4
    s_mov_b32 s57, s5
    s_mov_b32 s58, 4194304
    s_mov_b32 s59, 131072
    s_and_b32 s3, s44, 1
    s_cmp_eq_u32 s3, 0
    s_cselect_b32 s60, s10, s12
    s_cselect_b32 s61, s11, s13
    s_mov_b32 s62, 2097152
    s_mov_b32 s63, 131072
    s_add_u32 s52, s47, s51
    s_add_u32 m0, s49, 0
    s_nop 0
    buffer_load_dwordx4 v8, s[56:59], s52 offen  lds
    s_add_u32 m0, s49, 1024
    s_nop 0
    buffer_load_dwordx4 v9, s[56:59], s52 offen  lds
    s_add_u32 m0, s49, 2048
    s_nop 0
    buffer_load_dwordx4 v10, s[56:59], s52 offen  lds
    s_add_u32 m0, s49, 3072
    s_nop 0
    buffer_load_dwordx4 v11, s[56:59], s52 offen  lds
    s_add_u32 s53, s48, s51
    s_add_u32 m0, s49, 16384
    s_nop 0
    buffer_load_dwordx4 v12, s[60:63], s53 offen  lds
    s_add_u32 m0, s49, 17408
    s_nop 0
    buffer_load_dwordx4 v13, s[60:63], s53 offen  lds
    s_add_u32 m0, s49, 18432
    s_nop 0
    buffer_load_dwordx4 v14, s[60:63], s53 offen  lds
    s_add_u32 m0, s49, 19456
    s_nop 0
    buffer_load_dwordx4 v15, s[60:63], s53 offen  lds
    s_add_u32 s51, s51, 128
    s_and_b32 s51, s51, 0x7ff
    s_add_u32 s52, s47, s51
    s_add_u32 m0, s49, 32768
    s_nop 0
    buffer_load_dwordx4 v8, s[56:59], s52 offen  lds
    s_add_u32 m0, s49, 33792
    s_nop 0
    buffer_load_dwordx4 v9, s[56:59], s52 offen  lds
    s_add_u32 m0, s49, 34816
    s_nop 0
    buffer_load_dwordx4 v10, s[56:59], s52 offen  lds
    s_add_u32 m0, s49, 35840
    s_nop 0
    buffer_load_dwordx4 v11, s[56:59], s52 offen  lds
    s_add_u32 s53, s48, s51
    s_add_u32 m0, s49, 49152
    s_nop 0
    buffer_load_dwordx4 v12, s[60:63], s53 offen  lds
    s_add_u32 m0, s49, 50176
    s_nop 0
    buffer_load_dwordx4 v13, s[60:63], s53 offen  lds
    s_add_u32 m0, s49, 51200
    s_nop 0
    buffer_load_dwordx4 v14, s[60:63], s53 offen  lds
    s_add_u32 m0, s49, 52224
    s_nop 0
    buffer_load_dwordx4 v15, s[60:63], s53 offen  lds
    s_mov_b32 s64, s28
    s_mov_b32 s65, s29
    s_mov_b32 s66, 8192
    s_mov_b32 s67, 131072
    s_mov_b32 s68, s24
    s_mov_b32 s69, s25
    s_mov_b32 s70, 4194304
    s_mov_b32 s71, 131072
    s_mov_b32 s72, s26
    s_mov_b32 s73, s27
    s_mov_b32 s74, 4194304
    s_mov_b32 s75, 131072
    s_lshl_b32 s3, s44, 10
    s_add_u32 s4, s3, 157696
    s_mov_b32 s24, s38
    s_mov_b32 s25, s39
    s_mov_b32 s26, 256
    s_mov_b32 s27, 131072
    s_or_b32 s3, s2, s44
    s_cmp_lg_u32 s3, 0
    s_cbranch_scc1 Lnonce_gate_1
    v_mov_b32 v4, s42
    v_mov_b32 v5, s43
    v_mov_b32 v3, 0
    buffer_store_dwordx2 v[4:5], v3, s[24:27], 0 offen sc0 sc1
    s_nop 1
Lnonce_gate_1:
    s_mov_b32 s5, 0xffff0000
    v_mov_b32 v6, 0
    s_and_b32 s3, s44, 1
    s_lshl_b32 s3, s3, 5
    v_and_b32 v7, 31, v2
    v_add_u32 v7, s3, v7
    s_lshl_b32 s3, s46, 6
    v_add_u32 v62, s3, v7
    v_lshlrev_b32 v62, 1, v62
    s_mov_b32 s76, s6
    s_mov_b32 s77, s7
    s_mov_b32 s78, 2048
    s_mov_b32 s79, 131072
    buffer_load_ushort v63, v62, s[76:79], 0 offen
    s_mov_b32 s76, s8
    s_mov_b32 s77, s9
    s_mov_b32 s78, 2048
    s_mov_b32 s79, 131072
    buffer_load_ushort v64, v62, s[76:79], 0 offen
    s_mov_b32 s8, s18
    s_mov_b32 s9, s19
    s_mov_b32 s10, 2048
    s_mov_b32 s11, 131072
    buffer_load_ushort v65, v62, s[8:11], 0 offen
    v_and_b32 v82, 31, v2
    v_bfe_u32 v83, v82, 1, 3
    v_lshrrev_b32 v84, 5, v2
    v_xor_b32 v83, v83, v84
    v_lshlrev_b32 v83, 4, v83
    v_lshl_add_u32 v83, v82, 7, v83
    s_lshr_b32 s6, s44, 1
    s_lshl_b32 s6, s6, 13
    s_and_b32 s7, s44, 1
    s_lshl_b32 s7, s7, 13
    s_add_u32 s7, s7, 16384
    v_xor_b32 v84, 0, v83
    v_add_u32 v66, s6, v84
    v_add_u32 v74, s7, v84
    v_add_u32 v70, 0x10000, v66
    v_add_u32 v78, 0x10000, v74
    v_xor_b32 v84, 32, v83
    v_add_u32 v67, s6, v84
    v_add_u32 v75, s7, v84
    v_add_u32 v71, 0x10000, v67
    v_add_u32 v79, 0x10000, v75
    v_xor_b32 v84, 64, v83
    v_add_u32 v68, s6, v84
    v_add_u32 v76, s7, v84
    v_add_u32 v72, 0x10000, v68
    v_add_u32 v80, 0x10000, v76
    v_xor_b32 v84, 96, v83
    v_add_u32 v69, s6, v84
    v_add_u32 v77, s7, v84
    v_add_u32 v73, 0x10000, v69
    v_add_u32 v81, 0x10000, v77
    s_mov_b32 s8, s40
    s_mov_b32 s9, s41
    s_mov_b32 s10, 33554432
    s_mov_b32 s11, 131072
    v_and_b32 v82, 7, v2
    s_lshl_b32 s3, s44, 10
    s_add_u32 s3, s3, 157696
    v_lshl_add_u32 v180, v82, 6, s3
    v_bfe_u32 v82, v2, 2, 1
    v_lshlrev_b32 v82, 3, v82
    v_lshrrev_b32 v83, 5, v2
    v_add_u32 v82, v82, v83
    v_lshlrev_b32 v181, 14, v82
    v_bfe_u32 v82, v2, 3, 2
    v_sub_u32 v82, 3, v82
    v_lshl_add_u32 v181, v82, 6, v181
    v_and_b32 v82, 3, v2
    v_lshl_add_u32 v181, v82, 4, v181
    s_lshl_b32 s6, s46, 18
    s_add_u32 s6, s6, 8404736
    s_lshl_b32 s3, s45, 10
    s_sub_u32 s6, s6, s3
    s_lshl_b32 s3, s44, 8
    s_sub_u32 s6, s6, s3
    s_lshl_b32 s13, s46, 4
    s_add_u32 s13, s13, s45
    s_lshl_b32 s13, s13, 2
    s_add_u32 s13, s13, s44
    s_lshl_b32 s13, s13, 3
    s_add_u32 s13, s13, 21495808
    s_lshl_b32 s18, s46, 2
    s_add_u32 s18, s18, s44
    s_lshl_b32 s18, s18, 4
    s_add_u32 s18, s18, s45
    s_lshl_b32 s18, s18, 3
    s_add_u32 s18, s18, 21504000
    s_lshl_b32 s3, s46, 9
    s_add_u32 s3, s3, 21495808
    v_lshrrev_b32 v182, 1, v17
    v_add_u32 v182, s3, v182
    s_lshl_b32 s19, s46, 6
    s_lshr_b32 s3, s45, 3
    s_lshl_b32 s3, s3, 5
    s_add_u32 s19, s19, s3
    s_lshl_b32 s3, s44, 3
    s_add_u32 s19, s19, s3
    s_and_b32 s3, s45, 7
    s_add_u32 s19, s19, s3
    s_lshl_b32 s22, s19, 12
    s_add_u32 s76, s30, s22
    s_addc_u32 s77, s31, 0
    s_mov_b32 s78, 4096
    s_mov_b32 s79, 131072
    s_mov_b32 s80, s32
    s_mov_b32 s81, s33
    s_mov_b32 s82, 2048
    s_mov_b32 s83, 131072
    s_lshl_b32 s3, s19, 1
    v_mov_b32 v183, s3
    buffer_load_ushort v183, v183, s[80:83], 0 offen
    s_mul_i32 s23, s44, 8320
    s_add_u32 s23, s23, 65536
    v_lshrrev_b32 v224, 4, v2
    v_and_b32 v225, 3, v2
    v_xor_b32 v225, v225, v224
    v_lshlrev_b32 v225, 4, v225
    v_lshrrev_b32 v224, 2, v2
    v_lshl_add_u32 v207, v224, 6, v225
    s_lshl_b32 s28, s46, 4
    s_add_u32 s28, s28, s45
    s_lshl_b32 s28, s28, 14
    s_lshl_b32 s29, s44, 12
    s_add_u32 s28, s28, s29
    s_add_u32 s28, s28, 8388608
    s_add_u32 s29, s29, 132096
    s_mov_b32 s80, s14
    s_mov_b32 s81, s15
    s_mov_b32 s82, 2097152
    s_mov_b32 s83, 131072
    s_mov_b32 s84, s16
    s_mov_b32 s85, s17
    s_mov_b32 s86, 2097152
    s_mov_b32 s87, 131072
    v_lshrrev_b32 v225, 2, v2
    v_lshrrev_b32 v226, 4, v2
    v_xor_b32 v226, v226, v2
    v_and_b32 v226, 3, v226
    v_lshlrev_b32 v226, 4, v226
    v_lshl_add_u32 v224, v225, 11, v226
    s_lshl_b32 s14, s46, 17
    s_and_b32 s3, s44, 1
    s_lshl_b32 s3, s3, 16
    s_add_u32 s14, s14, s3
    s_lshl_b32 s3, s45, 7
    s_add_u32 s14, s14, s3
    s_lshr_b32 s3, s44, 1
    s_lshl_b32 s3, s3, 6
    s_add_u32 s14, s14, s3
    s_add_u32 s15, s14, 32768
    s_lshl_b32 s16, s44, 12
    s_add_u32 s16, s16, 132096
    s_mov_b32 s88, s34
    s_mov_b32 s89, s35
    s_mov_b32 s90, 2048
    s_mov_b32 s91, 131072
    s_lshl_b32 s17, s45, 7
    s_lshl_b32 s3, s46, 3
    s_add_u32 s17, s17, s3
    s_lshl_b32 s3, s44, 1
    s_add_u32 s17, s17, s3
    s_lshl_b32 s3, s17, 2
    s_add_u32 s3, s3, 20971520
    v_mov_b32 v225, s3
    s_lshl_b32 s17, s17, 11
    s_mov_b32 s32, 8192
    buffer_load_dwordx4 v[208:211], v17, s[88:91], 0 offen offset:0
    buffer_load_dwordx4 v[212:215], v17, s[88:91], 0 offen offset:1024
    buffer_load_dwordx4 v[46:49], v17, s[56:59], s17 offen offset:0
    buffer_load_dwordx4 v[50:53], v17, s[56:59], s17 offen offset:1024
    buffer_load_dwordx4 v[54:57], v17, s[56:59], s17 offen offset:2048
    buffer_load_dwordx4 v[58:61], v17, s[56:59], s17 offen offset:3072
    s_waitcnt vmcnt(18)
    s_barrier
    ds_read_b128 v[84:87], v66 offset:0
    ds_read_b128 v[92:95], v74 offset:0
    ds_read_b128 v[96:99], v74 offset:4096
    ds_read_b128 v[88:91], v66 offset:4096
    s_add_u32 s51, s51, 128
    s_and_b32 s51, s51, 0x7ff
    s_add_u32 s52, s47, s51
    s_add_u32 m0, s49, 65536
    s_waitcnt lgkmcnt(2)
    v_mfma_f32_32x32x16_bf16 v[116:131], v[84:87], v[92:95], 0
    ds_read_b128 v[100:103], v67 offset:0
    ds_read_b128 v[108:111], v75 offset:0
    buffer_load_dwordx4 v8, s[56:59], s52 offen  lds
    s_add_u32 m0, s49, 66560
    s_waitcnt lgkmcnt(3)
    v_mfma_f32_32x32x16_bf16 v[132:147], v[84:87], v[96:99], 0
    ds_read_b128 v[112:115], v75 offset:4096
    ds_read_b128 v[104:107], v67 offset:4096
    buffer_load_dwordx4 v9, s[56:59], s52 offen  lds
    s_add_u32 m0, s49, 67584
    s_waitcnt lgkmcnt(4)
    v_mfma_f32_32x32x16_bf16 v[148:163], v[88:91], v[92:95], 0
    buffer_load_dwordx4 v10, s[56:59], s52 offen  lds
    s_add_u32 m0, s49, 68608
    v_mfma_f32_32x32x16_bf16 v[164:179], v[88:91], v[96:99], 0
    buffer_load_dwordx4 v11, s[56:59], s52 offen  lds
    s_add_u32 s53, s48, s51
    s_add_u32 m0, s49, 81920
    s_waitcnt lgkmcnt(2)
    v_mfma_f32_32x32x16_bf16 v[116:131], v[100:103], v[108:111], v[116:131]
    ds_read_b128 v[84:87], v68 offset:0
    ds_read_b128 v[92:95], v76 offset:0
    buffer_load_dwordx4 v12, s[60:63], s53 offen  lds
    s_add_u32 m0, s49, 82944
    s_waitcnt lgkmcnt(3)
    v_mfma_f32_32x32x16_bf16 v[132:147], v[100:103], v[112:115], v[132:147]
    ds_read_b128 v[96:99], v76 offset:4096
    ds_read_b128 v[88:91], v68 offset:4096
    buffer_load_dwordx4 v13, s[60:63], s53 offen  lds
    s_add_u32 m0, s49, 83968
    s_waitcnt lgkmcnt(4)
    v_mfma_f32_32x32x16_bf16 v[148:163], v[104:107], v[108:111], v[148:163]
    buffer_load_dwordx4 v14, s[60:63], s53 offen  lds
    s_add_u32 m0, s49, 84992
    v_mfma_f32_32x32x16_bf16 v[164:179], v[104:107], v[112:115], v[164:179]
    buffer_load_dwordx4 v15, s[60:63], s53 offen  lds
    s_add_u32 s51, s51, 128
    s_and_b32 s51, s51, 0x7ff
    s_add_u32 s52, s47, s51
    s_add_u32 m0, s49, 98304
    s_waitcnt lgkmcnt(2)
    v_mfma_f32_32x32x16_bf16 v[116:131], v[84:87], v[92:95], v[116:131]
    ds_read_b128 v[100:103], v69 offset:0
    ds_read_b128 v[108:111], v77 offset:0
    buffer_load_dwordx4 v8, s[56:59], s52 offen  lds
    s_add_u32 m0, s49, 99328
    s_waitcnt lgkmcnt(3)
    v_mfma_f32_32x32x16_bf16 v[132:147], v[84:87], v[96:99], v[132:147]
    ds_read_b128 v[112:115], v77 offset:4096
    ds_read_b128 v[104:107], v69 offset:4096
    buffer_load_dwordx4 v9, s[56:59], s52 offen  lds
    s_add_u32 m0, s49, 100352
    s_waitcnt lgkmcnt(4)
    v_mfma_f32_32x32x16_bf16 v[148:163], v[88:91], v[92:95], v[148:163]
    buffer_load_dwordx4 v10, s[56:59], s52 offen  lds
    s_add_u32 m0, s49, 101376
    v_mfma_f32_32x32x16_bf16 v[164:179], v[88:91], v[96:99], v[164:179]
    buffer_load_dwordx4 v11, s[56:59], s52 offen  lds
    s_waitcnt lgkmcnt(0)
    s_waitcnt vmcnt(22)
    s_barrier
    s_add_u32 s53, s48, s51
    s_add_u32 m0, s49, 114688
    v_mfma_f32_32x32x16_bf16 v[116:131], v[100:103], v[108:111], v[116:131]
    ds_read_b128 v[84:87], v66 offset:32768
    ds_read_b128 v[92:95], v74 offset:32768
    buffer_load_dwordx4 v12, s[60:63], s53 offen  lds
    s_waitcnt vmcnt(22)
    v_lshlrev_b32 v63, 16, v63
    s_waitcnt vmcnt(21)
    v_lshlrev_b32 v64, 16, v64
    s_waitcnt vmcnt(20)
    v_lshlrev_b32 v65, 16, v65
    v_mul_f32 v242, 1069066811, v65
    s_add_u32 m0, s49, 115712
    v_mfma_f32_32x32x16_bf16 v[132:147], v[100:103], v[112:115], v[132:147]
    ds_read_b128 v[96:99], v74 offset:36864
    ds_read_b128 v[88:91], v66 offset:36864
    buffer_load_dwordx4 v13, s[60:63], s53 offen  lds
    v_exp_f32 v242, v242
    s_nop 0
    v_cvt_pk_bf16_f32 v242, v242, v242
    v_lshlrev_b32 v242, 16, v242
    v_mul_f32 v243, v242, v63
    s_add_u32 m0, s49, 116736
    v_mfma_f32_32x32x16_bf16 v[148:163], v[104:107], v[108:111], v[148:163]
    buffer_load_dwordx4 v14, s[60:63], s53 offen  lds
    v_mul_f32 v244, v242, v64
    v_mul_f32 v243, 1069066811, v243
    v_exp_f32 v243, v243
    v_mul_f32 v244, 1042479491, v244
    v_fract_f32 v244, v244
    v_cos_f32 v245, v244
    s_add_u32 m0, s49, 117760
    v_mfma_f32_32x32x16_bf16 v[164:179], v[104:107], v[112:115], v[164:179]
    buffer_load_dwordx4 v15, s[60:63], s53 offen  lds
    v_sin_f32 v246, v244
    v_mul_f32 v230, v243, v245
    v_mul_f32 v231, v243, v246
    v_add_f32 v242, -1.0, v230
    v_mul_f32 v243, v63, v63
    v_fmac_f32 v243, v64, v64
    v_rcp_f32 v243, v243
    s_add_u32 s51, s51, 128
    s_and_b32 s51, s51, 0x7ff
    s_add_u32 s52, s47, s51
    s_add_u32 m0, s49, 0
    s_waitcnt lgkmcnt(2)
    v_mfma_f32_32x32x16_bf16 v[116:131], v[84:87], v[92:95], v[116:131]
    ds_read_b128 v[100:103], v67 offset:32768
    ds_read_b128 v[108:111], v75 offset:32768
    buffer_load_dwordx4 v8, s[56:59], s52 offen  lds
    v_add_f32 v243, v243, v243
    v_mul_f32 v244, v242, v63
    v_fmac_f32 v244, v231, v64
    v_mul_f32 v245, v231, v63
    s_add_u32 m0, s49, 1024
    s_waitcnt lgkmcnt(3)
    v_mfma_f32_32x32x16_bf16 v[132:147], v[84:87], v[96:99], v[132:147]
    ds_read_b128 v[112:115], v75 offset:36864
    ds_read_b128 v[104:107], v67 offset:36864
    buffer_load_dwordx4 v9, s[56:59], s52 offen  lds
    v_fma_f32 v245, -v242, v64, v245
    v_mul_f32 v232, v244, v243
    v_mul_f32 v233, v245, v243
    v_mul_f32 v242, v231, v231
    s_add_u32 m0, s49, 2048
    s_waitcnt lgkmcnt(4)
    v_mfma_f32_32x32x16_bf16 v[148:163], v[88:91], v[92:95], v[148:163]
    buffer_load_dwordx4 v10, s[56:59], s52 offen  lds
    v_fma_f32 v242, v230, v230, -v242
    v_mul_f32 v243, v230, v231
    v_add_f32 v243, v243, v243
    v_mul_f32 v244, v243, v243
    v_fma_f32 v244, v242, v242, -v244
    v_mul_f32 v245, v242, v243
    s_add_u32 m0, s49, 3072
    v_mfma_f32_32x32x16_bf16 v[164:179], v[88:91], v[96:99], v[164:179]
    buffer_load_dwordx4 v11, s[56:59], s52 offen  lds
    v_add_f32 v245, v245, v245
    v_mul_f32 v242, v245, v245
    v_fma_f32 v242, v244, v244, -v242
    v_mul_f32 v243, v244, v245
    v_add_f32 v243, v243, v243
    v_mul_f32 v234, v243, v243
    v_fma_f32 v234, v242, v242, -v234
    s_add_u32 s53, s48, s51
    s_add_u32 m0, s49, 16384
    s_waitcnt lgkmcnt(2)
    v_mfma_f32_32x32x16_bf16 v[116:131], v[100:103], v[108:111], v[116:131]
    ds_read_b128 v[84:87], v68 offset:32768
    ds_read_b128 v[92:95], v76 offset:32768
    buffer_load_dwordx4 v12, s[60:63], s53 offen  lds
    v_mul_f32 v235, v242, v243
    v_add_f32 v235, v235, v235
    v_mul_f32 v242, v235, v235
    v_fma_f32 v242, v234, v234, -v242
    s_add_u32 m0, s49, 17408
    s_waitcnt lgkmcnt(3)
    v_mfma_f32_32x32x16_bf16 v[132:147], v[100:103], v[112:115], v[132:147]
    ds_read_b128 v[96:99], v76 offset:36864
    ds_read_b128 v[88:91], v68 offset:36864
    buffer_load_dwordx4 v13, s[60:63], s53 offen  lds
    v_mul_f32 v243, v234, v235
    v_add_f32 v243, v243, v243
    v_mul_f32 v244, v243, v243
    v_fma_f32 v244, v242, v242, -v244
    s_add_u32 m0, s49, 18432
    s_waitcnt lgkmcnt(4)
    v_mfma_f32_32x32x16_bf16 v[148:163], v[104:107], v[108:111], v[148:163]
    buffer_load_dwordx4 v14, s[60:63], s53 offen  lds
    v_mul_f32 v245, v242, v243
    v_add_f32 v245, v245, v245
    v_mul_f32 v236, v245, v245
    v_fma_f32 v236, v244, v244, -v236
    v_mul_f32 v237, v244, v245
    v_add_f32 v237, v237, v237
    s_add_u32 m0, s49, 19456
    v_mfma_f32_32x32x16_bf16 v[164:179], v[104:107], v[112:115], v[164:179]
    buffer_load_dwordx4 v15, s[60:63], s53 offen  lds
    s_mov_b32 s34, 0
    s_mov_b32 s35, -1
    s_lshr_b32 s3, s44, 1
    s_cmp_eq_u32 s3, 1
    s_cselect_b32 s38, -1, 0
    s_cselect_b32 s39, -1, 0
    v_cndmask_b32 v242, 1.0, v242, s[34:35]
    v_cndmask_b32 v243, 0, v243, s[34:35]
    v_cndmask_b32 v244, 1.0, v244, s[38:39]
    s_waitcnt lgkmcnt(2)
    v_mfma_f32_32x32x16_bf16 v[116:131], v[84:87], v[92:95], v[116:131]
    ds_read_b128 v[100:103], v69 offset:32768
    ds_read_b128 v[108:111], v77 offset:32768
    v_cndmask_b32 v245, 0, v245, s[38:39]
    v_mul_f32 v246, v243, v245
    v_fma_f32 v246, v242, v244, -v246
    v_mul_f32 v247, v242, v245
    v_fmac_f32 v247, v243, v244
    v_mul_f32 v242, v247, v235
    s_waitcnt lgkmcnt(3)
    v_mfma_f32_32x32x16_bf16 v[132:147], v[84:87], v[96:99], v[132:147]
    ds_read_b128 v[112:115], v77 offset:36864
    ds_read_b128 v[104:107], v69 offset:36864
    v_fma_f32 v242, v246, v234, -v242
    v_mul_f32 v243, v246, v235
    v_fmac_f32 v243, v247, v234
    v_mov_b32 v238, v246
    v_mov_b32 v239, v242
    v_mov_b32 v240, v247
    s_waitcnt lgkmcnt(4)
    v_mfma_f32_32x32x16_bf16 v[148:163], v[88:91], v[92:95], v[148:163]
    v_mov_b32 v241, v243
    v_mfma_f32_32x32x16_bf16 v[164:179], v[88:91], v[96:99], v[164:179]
    s_waitcnt lgkmcnt(0)
    s_waitcnt vmcnt(16)
    s_barrier
    s_add_u32 s51, s51, 128
    s_and_b32 s51, s51, 0x7ff
    s_add_u32 s52, s47, s51
    s_add_u32 m0, s49, 32768
    v_mfma_f32_32x32x16_bf16 v[116:131], v[100:103], v[108:111], v[116:131]
    ds_read_b128 v[84:87], v70 offset:0
    ds_read_b128 v[92:95], v78 offset:0
    buffer_load_dwordx4 v8, s[56:59], s52 offen  lds
    v_lshlrev_b32 v203, 16, v208
    v_and_b32 v204, s5, v208
    v_lshlrev_b32 v205, 16, v46
    v_and_b32 v206, s5, v46
    s_add_u32 m0, s49, 33792
    v_mfma_f32_32x32x16_bf16 v[132:147], v[100:103], v[112:115], v[132:147]
    ds_read_b128 v[96:99], v78 offset:4096
    ds_read_b128 v[88:91], v70 offset:4096
    buffer_load_dwordx4 v9, s[56:59], s52 offen  lds
    v_mul_f32 v226, v203, v205
    v_fmac_f32 v226, v204, v206
    v_lshlrev_b32 v205, 16, v54
    v_and_b32 v206, s5, v54
    s_add_u32 m0, s49, 34816
    v_mfma_f32_32x32x16_bf16 v[148:163], v[104:107], v[108:111], v[148:163]
    buffer_load_dwordx4 v10, s[56:59], s52 offen  lds
    v_mul_f32 v227, v203, v205
    v_fmac_f32 v227, v204, v206
    v_lshlrev_b32 v203, 16, v209
    v_and_b32 v204, s5, v209
    v_lshlrev_b32 v205, 16, v47
    v_and_b32 v206, s5, v47
    s_add_u32 m0, s49, 35840
    v_mfma_f32_32x32x16_bf16 v[164:179], v[104:107], v[112:115], v[164:179]
    buffer_load_dwordx4 v11, s[56:59], s52 offen  lds
    v_fmac_f32 v226, v203, v205
    v_fmac_f32 v226, v204, v206
    v_lshlrev_b32 v205, 16, v55
    v_and_b32 v206, s5, v55
    v_fmac_f32 v227, v203, v205
    v_fmac_f32 v227, v204, v206
    v_lshlrev_b32 v203, 16, v210
    s_add_u32 s53, s48, s51
    s_add_u32 m0, s49, 49152
    s_waitcnt lgkmcnt(2)
    v_mfma_f32_32x32x16_bf16 v[116:131], v[84:87], v[92:95], v[116:131]
    ds_read_b128 v[100:103], v71 offset:0
    ds_read_b128 v[108:111], v79 offset:0
    buffer_load_dwordx4 v12, s[60:63], s53 offen  lds
    v_and_b32 v204, s5, v210
    v_lshlrev_b32 v205, 16, v48
    v_and_b32 v206, s5, v48
    v_fmac_f32 v226, v203, v205
    s_add_u32 m0, s49, 50176
    s_waitcnt lgkmcnt(3)
    v_mfma_f32_32x32x16_bf16 v[132:147], v[84:87], v[96:99], v[132:147]
    ds_read_b128 v[112:115], v79 offset:4096
    ds_read_b128 v[104:107], v71 offset:4096
    buffer_load_dwordx4 v13, s[60:63], s53 offen  lds
    v_fmac_f32 v226, v204, v206
    v_lshlrev_b32 v205, 16, v56
    v_and_b32 v206, s5, v56
    v_fmac_f32 v227, v203, v205
    s_add_u32 m0, s49, 51200
    s_waitcnt lgkmcnt(4)
    v_mfma_f32_32x32x16_bf16 v[148:163], v[88:91], v[92:95], v[148:163]
    buffer_load_dwordx4 v14, s[60:63], s53 offen  lds
    v_fmac_f32 v227, v204, v206
    v_lshlrev_b32 v203, 16, v211
    v_and_b32 v204, s5, v211
    v_lshlrev_b32 v205, 16, v49
    v_and_b32 v206, s5, v49
    v_fmac_f32 v226, v203, v205
    s_add_u32 m0, s49, 52224
    v_mfma_f32_32x32x16_bf16 v[164:179], v[88:91], v[96:99], v[164:179]
    buffer_load_dwordx4 v15, s[60:63], s53 offen  lds
    v_fmac_f32 v226, v204, v206
    v_lshlrev_b32 v205, 16, v57
    v_and_b32 v206, s5, v57
    v_fmac_f32 v227, v203, v205
    v_fmac_f32 v227, v204, v206
    v_lshlrev_b32 v203, 16, v212
    v_and_b32 v204, s5, v212
    s_waitcnt lgkmcnt(2)
    v_mfma_f32_32x32x16_bf16 v[116:131], v[100:103], v[108:111], v[116:131]
    ds_read_b128 v[84:87], v72 offset:0
    ds_read_b128 v[92:95], v80 offset:0
    v_lshlrev_b32 v205, 16, v50
    v_and_b32 v206, s5, v50
    v_fmac_f32 v226, v203, v205
    v_fmac_f32 v226, v204, v206
    v_lshlrev_b32 v205, 16, v58
    v_and_b32 v206, s5, v58
    s_waitcnt lgkmcnt(3)
    v_mfma_f32_32x32x16_bf16 v[132:147], v[100:103], v[112:115], v[132:147]
    ds_read_b128 v[96:99], v80 offset:4096
    ds_read_b128 v[88:91], v72 offset:4096
    v_fmac_f32 v227, v203, v205
    v_fmac_f32 v227, v204, v206
    v_lshlrev_b32 v203, 16, v213
    v_and_b32 v204, s5, v213
    v_lshlrev_b32 v205, 16, v51
    v_and_b32 v206, s5, v51
    s_waitcnt lgkmcnt(4)
    v_mfma_f32_32x32x16_bf16 v[148:163], v[104:107], v[108:111], v[148:163]
    v_fmac_f32 v226, v203, v205
    v_fmac_f32 v226, v204, v206
    v_lshlrev_b32 v205, 16, v59
    v_and_b32 v206, s5, v59
    v_fmac_f32 v227, v203, v205
    v_fmac_f32 v227, v204, v206
    v_lshlrev_b32 v203, 16, v214
    v_and_b32 v204, s5, v214
    v_mfma_f32_32x32x16_bf16 v[164:179], v[104:107], v[112:115], v[164:179]
    v_lshlrev_b32 v205, 16, v52
    v_and_b32 v206, s5, v52
    v_fmac_f32 v226, v203, v205
    v_fmac_f32 v226, v204, v206
    v_lshlrev_b32 v205, 16, v60
    v_and_b32 v206, s5, v60
    v_fmac_f32 v227, v203, v205
    v_fmac_f32 v227, v204, v206
    s_waitcnt lgkmcnt(2)
    v_mfma_f32_32x32x16_bf16 v[116:131], v[84:87], v[92:95], v[116:131]
    ds_read_b128 v[100:103], v73 offset:0
    ds_read_b128 v[108:111], v81 offset:0
    v_lshlrev_b32 v203, 16, v215
    v_and_b32 v204, s5, v215
    v_lshlrev_b32 v205, 16, v53
    v_and_b32 v206, s5, v53
    v_fmac_f32 v226, v203, v205
    v_fmac_f32 v226, v204, v206
    s_waitcnt lgkmcnt(3)
    v_mfma_f32_32x32x16_bf16 v[132:147], v[84:87], v[96:99], v[132:147]
    ds_read_b128 v[112:115], v81 offset:4096
    ds_read_b128 v[104:107], v73 offset:4096
    v_lshlrev_b32 v205, 16, v61
    v_and_b32 v206, s5, v61
    v_fmac_f32 v227, v203, v205
    v_fmac_f32 v227, v204, v206
    v_add_f32_dpp v226, v226, v226 row_shr:1 row_mask:0xf bank_mask:0xf bound_ctrl:0
    s_nop 0
    v_add_f32_dpp v227, v227, v227 row_shr:1 row_mask:0xf bank_mask:0xf bound_ctrl:0
    s_waitcnt lgkmcnt(4)
    v_mfma_f32_32x32x16_bf16 v[148:163], v[88:91], v[92:95], v[148:163]
    v_add_f32_dpp v226, v226, v226 row_shr:2 row_mask:0xf bank_mask:0xf bound_ctrl:0
    v_add_f32_dpp v227, v227, v227 row_shr:2 row_mask:0xf bank_mask:0xf bound_ctrl:0
    s_nop 0
    v_add_f32_dpp v226, v226, v226 row_shr:4 row_mask:0xf bank_mask:0xf bound_ctrl:0
    v_add_f32_dpp v227, v227, v227 row_shr:4 row_mask:0xf bank_mask:0xf bound_ctrl:0
    s_nop 0
    v_add_f32_dpp v226, v226, v226 row_shr:8 row_mask:0xf bank_mask:0xf bound_ctrl:0
    v_add_f32_dpp v227, v227, v227 row_shr:8 row_mask:0xf bank_mask:0xf bound_ctrl:0
    s_nop 0
    v_add_f32_dpp v226, v226, v226 row_bcast:15 row_mask:0xa bank_mask:0xf
    v_add_f32_dpp v227, v227, v227 row_bcast:15 row_mask:0xa bank_mask:0xf
    v_mfma_f32_32x32x16_bf16 v[164:179], v[88:91], v[96:99], v[164:179]
    v_add_f32_dpp v226, v226, v226 row_bcast:31 row_mask:0xc bank_mask:0xf
    v_add_f32_dpp v227, v227, v227 row_bcast:31 row_mask:0xc bank_mask:0xf
    v_cvt_pk_bf16_f32 v203, v226, v227
    v_lshlrev_b32 v226, 16, v203
    v_and_b32 v227, s5, v203
    v_mul_f32 v226, 0xbfb8aa3b, v226
    v_mul_f32 v227, 0xbfb8aa3b, v227
    v_exp_f32 v226, v226
    s_waitcnt lgkmcnt(0)
    s_waitcnt vmcnt(16)
    s_barrier
    s_add_u32 s51, s51, 128
    s_and_b32 s51, s51, 0x7ff
    s_add_u32 s52, s47, s51
    s_add_u32 m0, s49, 65536
    v_mfma_f32_32x32x16_bf16 v[116:131], v[100:103], v[108:111], v[116:131]
    ds_read_b128 v[84:87], v70 offset:32768
    ds_read_b128 v[92:95], v78 offset:32768
    buffer_load_dwordx4 v8, s[56:59], s52 offen  lds
    v_exp_f32 v227, v227
    v_add_f32 v226, 1.0, v226
    v_add_f32 v227, 1.0, v227
    v_rcp_f32 v226, v226
    s_add_u32 m0, s49, 66560
    v_mfma_f32_32x32x16_bf16 v[132:147], v[100:103], v[112:115], v[132:147]
    ds_read_b128 v[96:99], v78 offset:36864
    ds_read_b128 v[88:91], v70 offset:36864
    buffer_load_dwordx4 v9, s[56:59], s52 offen  lds
    v_rcp_f32 v227, v227
    s_nop 0
    v_cvt_pk_bf16_f32 v203, v226, v227
    v_lshlrev_b32 v226, 16, v203
    v_and_b32 v227, s5, v203
    s_add_u32 m0, s49, 67584
    v_mfma_f32_32x32x16_bf16 v[148:163], v[104:107], v[108:111], v[148:163]
    buffer_load_dwordx4 v10, s[56:59], s52 offen  lds
    v_sub_f32 v228, 1.0, v226
    v_sub_f32 v229, 1.0, v227
    v_cvt_pk_bf16_f32 v203, v228, v229
    v_lshlrev_b32 v228, 16, v203
    v_and_b32 v229, s5, v203
    s_add_u32 m0, s49, 68608
    v_mfma_f32_32x32x16_bf16 v[164:179], v[104:107], v[112:115], v[164:179]
    buffer_load_dwordx4 v11, s[56:59], s52 offen  lds
    s_add_u32 s53, s48, s51
    s_add_u32 m0, s49, 81920
    s_waitcnt lgkmcnt(2)
    v_mfma_f32_32x32x16_bf16 v[116:131], v[84:87], v[92:95], v[116:131]
    ds_read_b128 v[100:103], v71 offset:32768
    ds_read_b128 v[108:111], v79 offset:32768
    buffer_load_dwordx4 v12, s[60:63], s53 offen  lds
    s_add_u32 m0, s49, 82944
    s_waitcnt lgkmcnt(3)
    v_mfma_f32_32x32x16_bf16 v[132:147], v[84:87], v[96:99], v[132:147]
    ds_read_b128 v[112:115], v79 offset:36864
    ds_read_b128 v[104:107], v71 offset:36864
    buffer_load_dwordx4 v13, s[60:63], s53 offen  lds
    s_add_u32 m0, s49, 83968
    s_waitcnt lgkmcnt(4)
    v_mfma_f32_32x32x16_bf16 v[148:163], v[88:91], v[92:95], v[148:163]
    buffer_load_dwordx4 v14, s[60:63], s53 offen  lds
    s_add_u32 m0, s49, 84992
    v_mfma_f32_32x32x16_bf16 v[164:179], v[88:91], v[96:99], v[164:179]
    buffer_load_dwordx4 v15, s[60:63], s53 offen  lds
    s_mov_b32 m0, s4
    s_waitcnt lgkmcnt(2)
    v_mfma_f32_32x32x16_bf16 v[116:131], v[100:103], v[108:111], v[116:131]
    ds_read_b128 v[84:87], v72 offset:32768
    ds_read_b128 v[92:95], v80 offset:32768
    buffer_load_dwordx4 v17, s[64:67], s54 offen lds
    s_waitcnt lgkmcnt(3)
    v_mfma_f32_32x32x16_bf16 v[132:147], v[100:103], v[112:115], v[132:147]
    ds_read_b128 v[96:99], v80 offset:36864
    ds_read_b128 v[88:91], v72 offset:36864
    buffer_load_dwordx4 v[18:21], v18, s[68:71], 0 offen
    s_waitcnt lgkmcnt(4)
    v_mfma_f32_32x32x16_bf16 v[148:163], v[104:107], v[108:111], v[148:163]
    buffer_load_dwordx4 v[22:25], v22, s[68:71], 0 offen
    v_mfma_f32_32x32x16_bf16 v[164:179], v[104:107], v[112:115], v[164:179]
    buffer_load_dwordx4 v[26:29], v26, s[68:71], 0 offen
    s_waitcnt lgkmcnt(2)
    v_mfma_f32_32x32x16_bf16 v[116:131], v[84:87], v[92:95], v[116:131]
    ds_read_b128 v[100:103], v73 offset:32768
    ds_read_b128 v[108:111], v81 offset:32768
    buffer_load_dwordx4 v[30:33], v16, s[68:71], 0 offen offset:0
    s_waitcnt lgkmcnt(3)
    v_mfma_f32_32x32x16_bf16 v[132:147], v[84:87], v[96:99], v[132:147]
    ds_read_b128 v[112:115], v81 offset:36864
    ds_read_b128 v[104:107], v73 offset:36864
    buffer_load_dwordx4 v[34:37], v16, s[68:71], 0 offen offset:2048
    s_waitcnt lgkmcnt(4)
    v_mfma_f32_32x32x16_bf16 v[148:163], v[88:91], v[92:95], v[148:163]
    buffer_load_dwordx4 v[38:41], v16, s[68:71], s50 offen offset:0
    v_mfma_f32_32x32x16_bf16 v[164:179], v[88:91], v[96:99], v[164:179]
    buffer_load_dwordx4 v[42:45], v16, s[68:71], s50 offen offset:2048
    s_waitcnt lgkmcnt(0)
    s_waitcnt vmcnt(24)
    s_barrier
    v_mfma_f32_32x32x16_bf16 v[116:131], v[100:103], v[108:111], v[116:131]
    ds_read_b128 v[84:87], v66 offset:0
    ds_read_b128 v[92:95], v74 offset:0
    buffer_load_dwordx4 v[46:49], v16, s[72:75], 0 offen offset:0
    v_mfma_f32_32x32x16_bf16 v[132:147], v[100:103], v[112:115], v[132:147]
    ds_read_b128 v[96:99], v74 offset:4096
    ds_read_b128 v[88:91], v66 offset:4096
    buffer_load_dwordx4 v[50:53], v16, s[72:75], 0 offen offset:2048
    v_mfma_f32_32x32x16_bf16 v[148:163], v[104:107], v[108:111], v[148:163]
    buffer_load_dwordx4 v[54:57], v16, s[72:75], s50 offen offset:0
    v_mfma_f32_32x32x16_bf16 v[164:179], v[104:107], v[112:115], v[164:179]
    buffer_load_dwordx4 v[58:61], v16, s[72:75], s50 offen offset:2048
    s_add_u32 s51, s51, 128
    s_and_b32 s51, s51, 0x7ff
    s_add_u32 s52, s47, s51
    s_add_u32 m0, s49, 98304
    s_waitcnt lgkmcnt(2)
    v_mfma_f32_32x32x16_bf16 v[116:131], v[84:87], v[92:95], v[116:131]
    ds_read_b128 v[100:103], v67 offset:0
    ds_read_b128 v[108:111], v75 offset:0
    buffer_load_dwordx4 v8, s[56:59], s52 offen  lds
    s_add_u32 m0, s49, 99328
    s_waitcnt lgkmcnt(3)
    v_mfma_f32_32x32x16_bf16 v[132:147], v[84:87], v[96:99], v[132:147]
    ds_read_b128 v[112:115], v75 offset:4096
    ds_read_b128 v[104:107], v67 offset:4096
    buffer_load_dwordx4 v9, s[56:59], s52 offen  lds
    s_add_u32 m0, s49, 100352
    s_waitcnt lgkmcnt(4)
    v_mfma_f32_32x32x16_bf16 v[148:163], v[88:91], v[92:95], v[148:163]
    buffer_load_dwordx4 v10, s[56:59], s52 offen  lds
    s_add_u32 m0, s49, 101376
    v_mfma_f32_32x32x16_bf16 v[164:179], v[88:91], v[96:99], v[164:179]
    buffer_load_dwordx4 v11, s[56:59], s52 offen  lds
    s_add_u32 s53, s48, s51
    s_add_u32 m0, s49, 114688
    s_waitcnt lgkmcnt(2)
    v_mfma_f32_32x32x16_bf16 v[116:131], v[100:103], v[108:111], v[116:131]
    ds_read_b128 v[84:87], v68 offset:0
    ds_read_b128 v[92:95], v76 offset:0
    buffer_load_dwordx4 v12, s[60:63], s53 offen  lds
    s_add_u32 m0, s49, 115712
    s_waitcnt lgkmcnt(3)
    v_mfma_f32_32x32x16_bf16 v[132:147], v[100:103], v[112:115], v[132:147]
    ds_read_b128 v[96:99], v76 offset:4096
    ds_read_b128 v[88:91], v68 offset:4096
    buffer_load_dwordx4 v13, s[60:63], s53 offen  lds
    s_add_u32 m0, s49, 116736
    s_waitcnt lgkmcnt(4)
    v_mfma_f32_32x32x16_bf16 v[148:163], v[104:107], v[108:111], v[148:163]
    buffer_load_dwordx4 v14, s[60:63], s53 offen  lds
    s_add_u32 m0, s49, 117760
    v_mfma_f32_32x32x16_bf16 v[164:179], v[104:107], v[112:115], v[164:179]
    buffer_load_dwordx4 v15, s[60:63], s53 offen  lds
    s_waitcnt lgkmcnt(2)
    v_mfma_f32_32x32x16_bf16 v[116:131], v[84:87], v[92:95], v[116:131]
    ds_read_b128 v[100:103], v69 offset:0
    ds_read_b128 v[108:111], v77 offset:0
    s_waitcnt lgkmcnt(3)
    v_mfma_f32_32x32x16_bf16 v[132:147], v[84:87], v[96:99], v[132:147]
    ds_read_b128 v[112:115], v77 offset:4096
    ds_read_b128 v[104:107], v69 offset:4096
    s_waitcnt lgkmcnt(4)
    v_mfma_f32_32x32x16_bf16 v[148:163], v[88:91], v[92:95], v[148:163]
    v_mfma_f32_32x32x16_bf16 v[164:179], v[88:91], v[96:99], v[164:179]
    s_waitcnt lgkmcnt(0)
    s_waitcnt vmcnt(28)
    s_barrier
    s_add_u32 s51, s51, 128
    s_and_b32 s51, s51, 0x7ff
    s_add_u32 s52, s47, s51
    s_add_u32 m0, s49, 0
    v_mfma_f32_32x32x16_bf16 v[116:131], v[100:103], v[108:111], v[116:131]
    ds_read_b128 v[84:87], v66 offset:32768
    ds_read_b128 v[92:95], v74 offset:32768
    buffer_load_dwordx4 v8, s[56:59], s52 offen  lds
    s_add_u32 m0, s49, 1024
    v_mfma_f32_32x32x16_bf16 v[132:147], v[100:103], v[112:115], v[132:147]
    ds_read_b128 v[96:99], v74 offset:36864
    ds_read_b128 v[88:91], v66 offset:36864
    buffer_load_dwordx4 v9, s[56:59], s52 offen  lds
    s_add_u32 m0, s49, 2048
    v_mfma_f32_32x32x16_bf16 v[148:163], v[104:107], v[108:111], v[148:163]
    buffer_load_dwordx4 v10, s[56:59], s52 offen  lds
    s_add_u32 m0, s49, 3072
    v_mfma_f32_32x32x16_bf16 v[164:179], v[104:107], v[112:115], v[164:179]
    buffer_load_dwordx4 v11, s[56:59], s52 offen  lds
    s_waitcnt lgkmcnt(2)
    v_mfma_f32_32x32x16_bf16 v[116:131], v[84:87], v[92:95], v[116:131]
    ds_read_b128 v[100:103], v67 offset:32768
    ds_read_b128 v[108:111], v75 offset:32768
    s_mov_b32 s7, 0x05040100
    s_mov_b32 s12, 0x07060302
    s_waitcnt vmcnt(23)
    s_waitcnt lgkmcnt(3)
    v_mfma_f32_32x32x16_bf16 v[132:147], v[84:87], v[96:99], v[132:147]
    ds_read_b128 v[112:115], v75 offset:36864
    ds_read_b128 v[104:107], v67 offset:36864
    ds_read_b128 v[184:187], v180 offset:0
    s_add_u32 s53, s48, s51
    s_add_u32 m0, s49, 16384
    s_waitcnt lgkmcnt(5)
    v_mfma_f32_32x32x16_bf16 v[148:163], v[88:91], v[92:95], v[148:163]
    buffer_load_dwordx4 v12, s[60:63], s53 offen  lds
    ds_read_b128 v[188:191], v180 offset:16
    s_waitcnt vmcnt(22)
    v_perm_b32 v196, v18, v22, s7
    s_waitcnt vmcnt(21)
    v_perm_b32 v197, v22, v26, s7
    s_add_u32 m0, s49, 17408
    v_mfma_f32_32x32x16_bf16 v[164:179], v[88:91], v[96:99], v[164:179]
    buffer_load_dwordx4 v13, s[60:63], s53 offen  lds
    s_waitcnt vmcnt(21)
    v_perm_b32 v198, v26, v30, s7
    s_waitcnt vmcnt(20)
    v_perm_b32 v199, v30, v34, s7
    s_waitcnt vmcnt(19)
    v_perm_b32 v200, v34, v38, s7
    s_waitcnt vmcnt(18)
    v_perm_b32 v201, v38, v42, s7
    s_waitcnt lgkmcnt(4)
    v_mfma_f32_32x32x16_bf16 v[116:131], v[100:103], v[108:111], v[116:131]
    ds_read_b128 v[84:87], v68 offset:32768
    ds_read_b128 v[92:95], v76 offset:32768
    s_waitcnt vmcnt(17)
    v_lshlrev_b32 v192, 16, v46
    s_waitcnt vmcnt(16)
    v_lshlrev_b32 v193, 16, v50
    s_waitcnt vmcnt(15)
    v_lshlrev_b32 v194, 16, v54
    s_waitcnt lgkmcnt(5)
    v_mfma_f32_32x32x16_bf16 v[132:147], v[100:103], v[112:115], v[132:147]
    ds_read_b128 v[96:99], v76 offset:36864
    ds_read_b128 v[88:91], v68 offset:36864
    s_waitcnt vmcnt(14)
    v_lshlrev_b32 v195, 16, v58
    s_waitcnt lgkmcnt(5)
    v_dot2_f32_bf16 v203, v196, v185, 0
    s_add_u32 m0, s49, 18432
    v_mfma_f32_32x32x16_bf16 v[148:163], v[104:107], v[108:111], v[148:163]
    buffer_load_dwordx4 v14, s[60:63], s53 offen  lds
    v_dot2_f32_bf16 v204, v197, v185, 0
    v_dot2_f32_bf16 v205, v198, v185, 0
    v_dot2_f32_bf16 v206, v199, v185, 0
    s_add_u32 m0, s49, 19456
    v_mfma_f32_32x32x16_bf16 v[164:179], v[104:107], v[112:115], v[164:179]
    buffer_load_dwordx4 v15, s[60:63], s53 offen  lds
    v_dot2c_f32_bf16 v203, v198, v184
    v_dot2c_f32_bf16 v204, v199, v184
    v_dot2c_f32_bf16 v205, v200, v184
    v_dot2c_f32_bf16 v206, v201, v184
    s_waitcnt lgkmcnt(2)
    v_mfma_f32_32x32x16_bf16 v[116:131], v[84:87], v[92:95], v[116:131]
    ds_read_b128 v[100:103], v69 offset:32768
    ds_read_b128 v[108:111], v77 offset:32768
    v_mul_f32 v203, v203, v192
    v_mul_f32 v204, v204, v193
    v_mul_f32 v205, v205, v194
    s_waitcnt lgkmcnt(3)
    v_mfma_f32_32x32x16_bf16 v[132:147], v[84:87], v[96:99], v[132:147]
    ds_read_b128 v[112:115], v77 offset:36864
    ds_read_b128 v[104:107], v69 offset:36864
    v_mul_f32 v206, v206, v195
    v_cvt_pk_bf16_f32 v210, v206, v205
    v_cvt_pk_bf16_f32 v211, v204, v203
    s_waitcnt lgkmcnt(4)
    v_mfma_f32_32x32x16_bf16 v[148:163], v[88:91], v[92:95], v[148:163]
    v_perm_b32 v196, v18, v22, s12
    v_perm_b32 v197, v22, v26, s12
    v_perm_b32 v198, v26, v30, s12
    v_perm_b32 v199, v30, v34, s12
    v_perm_b32 v200, v34, v38, s12
    v_mfma_f32_32x32x16_bf16 v[164:179], v[88:91], v[96:99], v[164:179]
    v_perm_b32 v201, v38, v42, s12
    v_and_b32 v192, s5, v46
    v_and_b32 v193, s5, v50
    v_and_b32 v194, s5, v54
    v_and_b32 v195, s5, v58
    s_waitcnt lgkmcnt(0)
    s_barrier
    v_mfma_f32_32x32x16_bf16 v[116:131], v[100:103], v[108:111], v[116:131]
    ds_read_b128 v[84:87], v70 offset:0
    ds_read_b128 v[92:95], v78 offset:0
    v_dot2_f32_bf16 v203, v196, v187, 0
    v_dot2_f32_bf16 v204, v197, v187, 0
    v_dot2_f32_bf16 v205, v198, v187, 0
    v_mfma_f32_32x32x16_bf16 v[132:147], v[100:103], v[112:115], v[132:147]
    ds_read_b128 v[96:99], v78 offset:4096
    ds_read_b128 v[88:91], v70 offset:4096
    s_add_u32 s51, s51, 128
    s_and_b32 s51, s51, 0x7ff
    s_add_u32 s52, s47, s51
    s_add_u32 m0, s49, 32768
    v_mfma_f32_32x32x16_bf16 v[148:163], v[104:107], v[108:111], v[148:163]
    buffer_load_dwordx4 v8, s[56:59], s52 offen  lds
    v_dot2_f32_bf16 v206, v199, v187, 0
    v_dot2c_f32_bf16 v203, v198, v186
    v_dot2c_f32_bf16 v204, v199, v186
    s_add_u32 m0, s49, 33792
    v_mfma_f32_32x32x16_bf16 v[164:179], v[104:107], v[112:115], v[164:179]
    buffer_load_dwordx4 v9, s[56:59], s52 offen  lds
    v_dot2c_f32_bf16 v205, v200, v186
    v_dot2c_f32_bf16 v206, v201, v186
    v_mul_f32 v203, v203, v192
    v_mul_f32 v204, v204, v193
    s_waitcnt lgkmcnt(2)
    v_mfma_f32_32x32x16_bf16 v[116:131], v[84:87], v[92:95], v[116:131]
    ds_read_b128 v[100:103], v71 offset:0
    ds_read_b128 v[108:111], v79 offset:0
    v_mul_f32 v205, v205, v194
    v_mul_f32 v206, v206, v195
    v_cvt_pk_bf16_f32 v208, v206, v205
    s_waitcnt lgkmcnt(3)
    v_mfma_f32_32x32x16_bf16 v[132:147], v[84:87], v[96:99], v[132:147]
    ds_read_b128 v[112:115], v79 offset:4096
    ds_read_b128 v[104:107], v71 offset:4096
    v_cvt_pk_bf16_f32 v209, v204, v203
    ds_read_b128 v[184:187], v180 offset:32
    s_add_u32 m0, s49, 34816
    s_waitcnt lgkmcnt(5)
    v_mfma_f32_32x32x16_bf16 v[148:163], v[88:91], v[92:95], v[148:163]
    buffer_load_dwordx4 v10, s[56:59], s52 offen  lds
    v_perm_b32 v196, v19, v23, s7
    v_perm_b32 v197, v23, v27, s7
    v_permlane32_swap_b32 v210, v208
    s_add_u32 m0, s49, 35840
    v_mfma_f32_32x32x16_bf16 v[164:179], v[88:91], v[96:99], v[164:179]
    buffer_load_dwordx4 v11, s[56:59], s52 offen  lds
    v_permlane32_swap_b32 v211, v209
    v_perm_b32 v198, v27, v31, s7
    v_perm_b32 v199, v31, v35, s7
    v_perm_b32 v200, v35, v39, s7
    s_waitcnt lgkmcnt(3)
    v_mfma_f32_32x32x16_bf16 v[116:131], v[100:103], v[108:111], v[116:131]
    ds_read_b128 v[84:87], v72 offset:0
    ds_read_b128 v[92:95], v80 offset:0
    v_perm_b32 v201, v39, v43, s7
    v_lshlrev_b32 v192, 16, v47
    v_lshlrev_b32 v193, 16, v51
    s_waitcnt lgkmcnt(4)
    v_mfma_f32_32x32x16_bf16 v[132:147], v[100:103], v[112:115], v[132:147]
    ds_read_b128 v[96:99], v80 offset:4096
    ds_read_b128 v[88:91], v72 offset:4096
    v_lshlrev_b32 v194, 16, v55
    s_add_u32 s53, s48, s51
    s_add_u32 m0, s49, 49152
    s_waitcnt lgkmcnt(5)
    v_mfma_f32_32x32x16_bf16 v[148:163], v[104:107], v[108:111], v[148:163]
    buffer_load_dwordx4 v12, s[60:63], s53 offen  lds
    v_lshlrev_b32 v195, 16, v59
    v_dot2_f32_bf16 v203, v196, v189, 0
    v_dot2_f32_bf16 v204, v197, v189, 0
    s_add_u32 m0, s49, 50176
    v_mfma_f32_32x32x16_bf16 v[164:179], v[104:107], v[112:115], v[164:179]
    buffer_load_dwordx4 v13, s[60:63], s53 offen  lds
    v_dot2_f32_bf16 v205, v198, v189, 0
    v_dot2_f32_bf16 v206, v199, v189, 0
    v_dot2c_f32_bf16 v203, v198, v188
    v_dot2c_f32_bf16 v204, v199, v188
    s_waitcnt lgkmcnt(2)
    v_mfma_f32_32x32x16_bf16 v[116:131], v[84:87], v[92:95], v[116:131]
    ds_read_b128 v[100:103], v73 offset:0
    ds_read_b128 v[108:111], v81 offset:0
    v_dot2c_f32_bf16 v205, v200, v188
    v_dot2c_f32_bf16 v206, v201, v188
    v_mul_f32 v203, v203, v192
    s_waitcnt lgkmcnt(3)
    v_mfma_f32_32x32x16_bf16 v[132:147], v[84:87], v[96:99], v[132:147]
    ds_read_b128 v[112:115], v81 offset:4096
    ds_read_b128 v[104:107], v73 offset:4096
    v_mul_f32 v204, v204, v193
    v_mul_f32 v205, v205, v194
    s_add_u32 m0, s49, 51200
    s_waitcnt lgkmcnt(4)
    v_mfma_f32_32x32x16_bf16 v[148:163], v[88:91], v[92:95], v[148:163]
    buffer_load_dwordx4 v14, s[60:63], s53 offen  lds
    v_mul_f32 v206, v206, v195
    v_cvt_pk_bf16_f32 v214, v206, v205
    v_cvt_pk_bf16_f32 v215, v204, v203
    s_add_u32 m0, s49, 52224
    v_mfma_f32_32x32x16_bf16 v[164:179], v[88:91], v[96:99], v[164:179]
    buffer_load_dwordx4 v15, s[60:63], s53 offen  lds
    v_perm_b32 v196, v19, v23, s12
    v_perm_b32 v197, v23, v27, s12
    v_perm_b32 v198, v27, v31, s12
    v_perm_b32 v199, v31, v35, s12
    s_waitcnt lgkmcnt(0)
    s_waitcnt vmcnt(16)
    s_barrier
    v_mfma_f32_32x32x16_bf16 v[116:131], v[100:103], v[108:111], v[116:131]
    ds_read_b128 v[84:87], v70 offset:32768
    ds_read_b128 v[92:95], v78 offset:32768
    v_perm_b32 v200, v35, v39, s12
    v_perm_b32 v201, v39, v43, s12
    v_and_b32 v192, s5, v47
    v_mfma_f32_32x32x16_bf16 v[132:147], v[100:103], v[112:115], v[132:147]
    ds_read_b128 v[96:99], v78 offset:36864
    ds_read_b128 v[88:91], v70 offset:36864
    s_add_u32 s51, s51, 128
    s_and_b32 s51, s51, 0x7ff
    s_add_u32 s52, s47, s51
    s_add_u32 m0, s49, 65536
    v_mfma_f32_32x32x16_bf16 v[148:163], v[104:107], v[108:111], v[148:163]
    buffer_load_dwordx4 v8, s[56:59], s52 offen  lds
    v_and_b32 v193, s5, v51
    v_and_b32 v194, s5, v55
    v_and_b32 v195, s5, v59
    s_add_u32 m0, s49, 66560
    v_mfma_f32_32x32x16_bf16 v[164:179], v[104:107], v[112:115], v[164:179]
    buffer_load_dwordx4 v9, s[56:59], s52 offen  lds
    v_dot2_f32_bf16 v203, v196, v191, 0
    v_dot2_f32_bf16 v204, v197, v191, 0
    v_dot2_f32_bf16 v205, v198, v191, 0
    v_dot2_f32_bf16 v206, v199, v191, 0
    s_waitcnt lgkmcnt(2)
    v_mfma_f32_32x32x16_bf16 v[116:131], v[84:87], v[92:95], v[116:131]
    ds_read_b128 v[100:103], v71 offset:32768
    ds_read_b128 v[108:111], v79 offset:32768
    v_dot2c_f32_bf16 v203, v198, v190
    v_dot2c_f32_bf16 v204, v199, v190
    s_add_u32 m0, s49, 67584
    s_waitcnt lgkmcnt(3)
    v_mfma_f32_32x32x16_bf16 v[132:147], v[84:87], v[96:99], v[132:147]
    ds_read_b128 v[112:115], v79 offset:36864
    ds_read_b128 v[104:107], v71 offset:36864
    buffer_load_dwordx4 v10, s[56:59], s52 offen  lds
    v_dot2c_f32_bf16 v205, v200, v190
    s_add_u32 m0, s49, 68608
    s_waitcnt lgkmcnt(4)
    v_mfma_f32_32x32x16_bf16 v[148:163], v[88:91], v[92:95], v[148:163]
    buffer_load_dwordx4 v11, s[56:59], s52 offen  lds
    v_dot2c_f32_bf16 v206, v201, v190
    v_mul_f32 v203, v203, v192
    s_add_u32 s53, s48, s51
    s_add_u32 m0, s49, 81920
    v_mfma_f32_32x32x16_bf16 v[164:179], v[88:91], v[96:99], v[164:179]
    buffer_load_dwordx4 v12, s[60:63], s53 offen  lds
    v_mul_f32 v204, v204, v193
    v_mul_f32 v205, v205, v194
    v_mul_f32 v206, v206, v195
    v_cvt_pk_bf16_f32 v212, v206, v205
    s_waitcnt lgkmcnt(2)
    v_mfma_f32_32x32x16_bf16 v[116:131], v[100:103], v[108:111], v[116:131]
    ds_read_b128 v[84:87], v72 offset:32768
    ds_read_b128 v[92:95], v80 offset:32768
    v_cvt_pk_bf16_f32 v213, v204, v203
    ds_read_b128 v[188:191], v180 offset:48
    s_add_u32 m0, s49, 82944
    s_waitcnt lgkmcnt(4)
    v_mfma_f32_32x32x16_bf16 v[132:147], v[100:103], v[112:115], v[132:147]
    ds_read_b128 v[96:99], v80 offset:36864
    ds_read_b128 v[88:91], v72 offset:36864
    buffer_load_dwordx4 v13, s[60:63], s53 offen  lds
    v_perm_b32 v196, v20, v24, s7
    s_add_u32 m0, s49, 83968
    s_waitcnt lgkmcnt(5)
    v_mfma_f32_32x32x16_bf16 v[148:163], v[104:107], v[108:111], v[148:163]
    buffer_load_dwordx4 v14, s[60:63], s53 offen  lds
    v_perm_b32 v197, v24, v28, s7
    v_permlane32_swap_b32 v214, v212
    v_permlane32_swap_b32 v215, v213
    s_add_u32 m0, s49, 84992
    v_mfma_f32_32x32x16_bf16 v[164:179], v[104:107], v[112:115], v[164:179]
    buffer_load_dwordx4 v15, s[60:63], s53 offen  lds
    v_perm_b32 v198, v28, v32, s7
    v_perm_b32 v199, v32, v36, s7
    v_perm_b32 v200, v36, v40, s7
    v_perm_b32 v201, v40, v44, s7
    s_waitcnt lgkmcnt(3)
    v_mfma_f32_32x32x16_bf16 v[116:131], v[84:87], v[92:95], v[116:131]
    ds_read_b128 v[100:103], v73 offset:32768
    ds_read_b128 v[108:111], v81 offset:32768
    v_lshlrev_b32 v192, 16, v48
    v_lshlrev_b32 v193, 16, v52
    s_add_u32 m0, s16, 0
    s_waitcnt lgkmcnt(3)
    v_mfma_f32_32x32x16_bf16 v[132:147], v[84:87], v[96:99], v[132:147]
    ds_read_b128 v[112:115], v81 offset:36864
    ds_read_b128 v[104:107], v73 offset:36864
    buffer_load_dwordx4 v224, s[80:83], s14 offen  lds
    v_lshlrev_b32 v194, 16, v56
    s_add_u32 m0, s16, 1024
    s_waitcnt lgkmcnt(4)
    v_mfma_f32_32x32x16_bf16 v[148:163], v[88:91], v[92:95], v[148:163]
    buffer_load_dwordx4 v224, s[80:83], s15 offen  lds
    v_lshlrev_b32 v195, 16, v60
    v_dot2_f32_bf16 v203, v196, v185, 0
    v_dot2_f32_bf16 v204, v197, v185, 0
    s_add_u32 m0, s16, 2048
    v_mfma_f32_32x32x16_bf16 v[164:179], v[88:91], v[96:99], v[164:179]
    buffer_load_dwordx4 v224, s[84:87], s14 offen  lds
    v_dot2_f32_bf16 v205, v198, v185, 0
    v_dot2_f32_bf16 v206, v199, v185, 0
    v_dot2c_f32_bf16 v203, v198, v184
    v_dot2c_f32_bf16 v204, v199, v184
    s_waitcnt lgkmcnt(0)
    s_waitcnt vmcnt(19)
    s_barrier
    v_mfma_f32_32x32x16_bf16 v[116:131], v[100:103], v[108:111], v[116:131]
    ds_read_b128 v[84:87], v66 offset:0
    ds_read_b128 v[92:95], v74 offset:0
    v_dot2c_f32_bf16 v205, v200, v184
    v_dot2c_f32_bf16 v206, v201, v184
    s_add_u32 m0, s16, 3072
    v_mfma_f32_32x32x16_bf16 v[132:147], v[100:103], v[112:115], v[132:147]
    ds_read_b128 v[96:99], v74 offset:4096
    ds_read_b128 v[88:91], v66 offset:4096
    buffer_load_dwordx4 v224, s[84:87], s15 offen  lds
    s_add_u32 s51, s51, 128
    s_and_b32 s51, s51, 0x7ff
    s_add_u32 s52, s47, s51
    s_add_u32 m0, s49, 98304
    v_mfma_f32_32x32x16_bf16 v[148:163], v[104:107], v[108:111], v[148:163]
    buffer_load_dwordx4 v8, s[56:59], s52 offen  lds
    v_mul_f32 v203, v203, v192
    v_mul_f32 v204, v204, v193
    v_mul_f32 v205, v205, v194
    s_add_u32 m0, s49, 99328
    v_mfma_f32_32x32x16_bf16 v[164:179], v[104:107], v[112:115], v[164:179]
    buffer_load_dwordx4 v9, s[56:59], s52 offen  lds
    v_mul_f32 v206, v206, v195
    v_cvt_pk_bf16_f32 v218, v206, v205
    v_cvt_pk_bf16_f32 v219, v204, v203
    v_perm_b32 v196, v20, v24, s12
    s_waitcnt lgkmcnt(2)
    v_mfma_f32_32x32x16_bf16 v[116:131], v[84:87], v[92:95], v[116:131]
    ds_read_b128 v[100:103], v67 offset:0
    ds_read_b128 v[108:111], v75 offset:0
    v_perm_b32 v197, v24, v28, s12
    v_perm_b32 v198, v28, v32, s12
    v_perm_b32 v199, v32, v36, s12
    s_waitcnt lgkmcnt(3)
    v_mfma_f32_32x32x16_bf16 v[132:147], v[84:87], v[96:99], v[132:147]
    ds_read_b128 v[112:115], v75 offset:4096
    ds_read_b128 v[104:107], v67 offset:4096
    v_perm_b32 v200, v36, v40, s12
    v_perm_b32 v201, v40, v44, s12
    s_add_u32 m0, s49, 100352
    s_waitcnt lgkmcnt(4)
    v_mfma_f32_32x32x16_bf16 v[148:163], v[88:91], v[92:95], v[148:163]
    buffer_load_dwordx4 v10, s[56:59], s52 offen  lds
    v_and_b32 v192, s5, v48
    v_and_b32 v193, s5, v52
    v_and_b32 v194, s5, v56
    s_add_u32 m0, s49, 101376
    v_mfma_f32_32x32x16_bf16 v[164:179], v[88:91], v[96:99], v[164:179]
    buffer_load_dwordx4 v11, s[56:59], s52 offen  lds
    v_and_b32 v195, s5, v60
    v_dot2_f32_bf16 v203, v196, v187, 0
    v_dot2_f32_bf16 v204, v197, v187, 0
    v_dot2_f32_bf16 v205, v198, v187, 0
    s_waitcnt lgkmcnt(2)
    v_mfma_f32_32x32x16_bf16 v[116:131], v[100:103], v[108:111], v[116:131]
    ds_read_b128 v[84:87], v68 offset:0
    ds_read_b128 v[92:95], v76 offset:0
    v_dot2_f32_bf16 v206, v199, v187, 0
    v_dot2c_f32_bf16 v203, v198, v186
    v_dot2c_f32_bf16 v204, v199, v186
    s_waitcnt lgkmcnt(3)
    v_mfma_f32_32x32x16_bf16 v[132:147], v[100:103], v[112:115], v[132:147]
    ds_read_b128 v[96:99], v76 offset:4096
    ds_read_b128 v[88:91], v68 offset:4096
    v_dot2c_f32_bf16 v205, v200, v186
    s_add_u32 s53, s48, s51
    s_add_u32 m0, s49, 114688
    s_waitcnt lgkmcnt(4)
    v_mfma_f32_32x32x16_bf16 v[148:163], v[104:107], v[108:111], v[148:163]
    buffer_load_dwordx4 v12, s[60:63], s53 offen  lds
    v_dot2c_f32_bf16 v206, v201, v186
    v_mul_f32 v203, v203, v192
    v_mul_f32 v204, v204, v193
    s_add_u32 m0, s49, 115712
    v_mfma_f32_32x32x16_bf16 v[164:179], v[104:107], v[112:115], v[164:179]
    buffer_load_dwordx4 v13, s[60:63], s53 offen  lds
    v_mul_f32 v205, v205, v194
    v_mul_f32 v206, v206, v195
    v_cvt_pk_bf16_f32 v216, v206, v205
    v_cvt_pk_bf16_f32 v217, v204, v203
    s_waitcnt lgkmcnt(2)
    v_mfma_f32_32x32x16_bf16 v[116:131], v[84:87], v[92:95], v[116:131]
    ds_read_b128 v[100:103], v69 offset:0
    ds_read_b128 v[108:111], v77 offset:0
    v_perm_b32 v196, v21, v25, s7
    v_perm_b32 v197, v25, v29, s7
    v_permlane32_swap_b32 v218, v216
    s_waitcnt lgkmcnt(3)
    v_mfma_f32_32x32x16_bf16 v[132:147], v[84:87], v[96:99], v[132:147]
    ds_read_b128 v[112:115], v77 offset:4096
    ds_read_b128 v[104:107], v69 offset:4096
    v_permlane32_swap_b32 v219, v217
    v_perm_b32 v198, v29, v33, s7
    s_add_u32 m0, s49, 116736
    s_waitcnt lgkmcnt(4)
    v_mfma_f32_32x32x16_bf16 v[148:163], v[88:91], v[92:95], v[148:163]
    buffer_load_dwordx4 v14, s[60:63], s53 offen  lds
    v_perm_b32 v199, v33, v37, s7
    v_perm_b32 v200, v37, v41, s7
    v_perm_b32 v201, v41, v45, s7
    s_add_u32 m0, s49, 117760
    v_mfma_f32_32x32x16_bf16 v[164:179], v[88:91], v[96:99], v[164:179]
    buffer_load_dwordx4 v15, s[60:63], s53 offen  lds
    v_lshlrev_b32 v192, 16, v49
    v_lshlrev_b32 v193, 16, v53
    v_lshlrev_b32 v194, 16, v57
    v_lshlrev_b32 v195, 16, v61
    s_waitcnt lgkmcnt(0)
    s_waitcnt vmcnt(20)
    s_barrier
    v_mfma_f32_32x32x16_bf16 v[116:131], v[100:103], v[108:111], v[116:131]
    ds_read_b128 v[84:87], v66 offset:32768
    ds_read_b128 v[92:95], v74 offset:32768
    v_dot2_f32_bf16 v203, v196, v189, 0
    v_dot2_f32_bf16 v204, v197, v189, 0
    v_dot2_f32_bf16 v205, v198, v189, 0
    v_mfma_f32_32x32x16_bf16 v[132:147], v[100:103], v[112:115], v[132:147]
    ds_read_b128 v[96:99], v74 offset:36864
    ds_read_b128 v[88:91], v66 offset:36864
    s_add_u32 s51, s51, 128
    s_and_b32 s51, s51, 0x7ff
    s_add_u32 s52, s47, s51
    s_add_u32 m0, s49, 0
    v_mfma_f32_32x32x16_bf16 v[148:163], v[104:107], v[108:111], v[148:163]
    buffer_load_dwordx4 v8, s[56:59], s52 offen  lds
    v_dot2_f32_bf16 v206, v199, v189, 0
    v_dot2c_f32_bf16 v203, v198, v188
    v_dot2c_f32_bf16 v204, v199, v188
    s_add_u32 m0, s49, 1024
    v_mfma_f32_32x32x16_bf16 v[164:179], v[104:107], v[112:115], v[164:179]
    buffer_load_dwordx4 v9, s[56:59], s52 offen  lds
    v_dot2c_f32_bf16 v205, v200, v188
    v_dot2c_f32_bf16 v206, v201, v188
    v_mul_f32 v203, v203, v192
    v_mul_f32 v204, v204, v193
    s_waitcnt lgkmcnt(2)
    v_mfma_f32_32x32x16_bf16 v[116:131], v[84:87], v[92:95], v[116:131]
    ds_read_b128 v[100:103], v67 offset:32768
    ds_read_b128 v[108:111], v75 offset:32768
    v_mul_f32 v205, v205, v194
    v_mul_f32 v206, v206, v195
    v_cvt_pk_bf16_f32 v222, v206, v205
    s_waitcnt lgkmcnt(3)
    v_mfma_f32_32x32x16_bf16 v[132:147], v[84:87], v[96:99], v[132:147]
    ds_read_b128 v[112:115], v75 offset:36864
    ds_read_b128 v[104:107], v67 offset:36864
    v_cvt_pk_bf16_f32 v223, v204, v203
    v_perm_b32 v196, v21, v25, s12
    s_add_u32 m0, s49, 2048
    s_waitcnt lgkmcnt(4)
    v_mfma_f32_32x32x16_bf16 v[148:163], v[88:91], v[92:95], v[148:163]
    buffer_load_dwordx4 v10, s[56:59], s52 offen  lds
    v_perm_b32 v197, v25, v29, s12
    v_perm_b32 v198, v29, v33, s12
    v_perm_b32 v199, v33, v37, s12
    s_add_u32 m0, s49, 3072
    v_mfma_f32_32x32x16_bf16 v[164:179], v[88:91], v[96:99], v[164:179]
    buffer_load_dwordx4 v11, s[56:59], s52 offen  lds
    v_perm_b32 v200, v37, v41, s12
    v_perm_b32 v201, v41, v45, s12
    v_and_b32 v192, s5, v49
    v_and_b32 v193, s5, v53
    s_waitcnt lgkmcnt(2)
    v_mfma_f32_32x32x16_bf16 v[116:131], v[100:103], v[108:111], v[116:131]
    ds_read_b128 v[84:87], v68 offset:32768
    ds_read_b128 v[92:95], v76 offset:32768
    v_and_b32 v194, s5, v57
    v_and_b32 v195, s5, v61
    v_dot2_f32_bf16 v203, v196, v191, 0
    s_waitcnt lgkmcnt(3)
    v_mfma_f32_32x32x16_bf16 v[132:147], v[100:103], v[112:115], v[132:147]
    ds_read_b128 v[96:99], v76 offset:36864
    ds_read_b128 v[88:91], v68 offset:36864
    v_dot2_f32_bf16 v204, v197, v191, 0
    s_add_u32 s53, s48, s51
    s_add_u32 m0, s49, 16384
    s_waitcnt lgkmcnt(4)
    v_mfma_f32_32x32x16_bf16 v[148:163], v[104:107], v[108:111], v[148:163]
    buffer_load_dwordx4 v12, s[60:63], s53 offen  lds
    v_dot2_f32_bf16 v205, v198, v191, 0
    v_dot2_f32_bf16 v206, v199, v191, 0
    v_dot2c_f32_bf16 v203, v198, v190
    s_add_u32 m0, s49, 17408
    v_mfma_f32_32x32x16_bf16 v[164:179], v[104:107], v[112:115], v[164:179]
    buffer_load_dwordx4 v13, s[60:63], s53 offen  lds
    v_dot2c_f32_bf16 v204, v199, v190
    v_dot2c_f32_bf16 v205, v200, v190
    v_dot2c_f32_bf16 v206, v201, v190
    v_mul_f32 v203, v203, v192
    s_waitcnt lgkmcnt(2)
    v_mfma_f32_32x32x16_bf16 v[116:131], v[84:87], v[92:95], v[116:131]
    ds_read_b128 v[100:103], v69 offset:32768
    ds_read_b128 v[108:111], v77 offset:32768
    v_mul_f32 v204, v204, v193
    v_mul_f32 v205, v205, v194
    v_mul_f32 v206, v206, v195
    s_waitcnt lgkmcnt(3)
    v_mfma_f32_32x32x16_bf16 v[132:147], v[84:87], v[96:99], v[132:147]
    ds_read_b128 v[112:115], v77 offset:36864
    ds_read_b128 v[104:107], v69 offset:36864
    v_cvt_pk_bf16_f32 v220, v206, v205
    v_cvt_pk_bf16_f32 v221, v204, v203
    s_add_u32 m0, s49, 18432
    s_waitcnt lgkmcnt(4)
    v_mfma_f32_32x32x16_bf16 v[148:163], v[88:91], v[92:95], v[148:163]
    buffer_load_dwordx4 v14, s[60:63], s53 offen  lds
    v_permlane32_swap_b32 v222, v220
    v_permlane32_swap_b32 v223, v221
    s_add_u32 m0, s49, 19456
    v_mfma_f32_32x32x16_bf16 v[164:179], v[88:91], v[96:99], v[164:179]
    buffer_load_dwordx4 v15, s[60:63], s53 offen  lds
    s_waitcnt lgkmcnt(0)
    s_waitcnt vmcnt(20)
    s_barrier
    v_mfma_f32_32x32x16_bf16 v[116:131], v[100:103], v[108:111], v[116:131]
    ds_read_b128 v[84:87], v70 offset:0
    ds_read_b128 v[92:95], v78 offset:0
    v_mfma_f32_32x32x16_bf16 v[132:147], v[100:103], v[112:115], v[132:147]
    ds_read_b128 v[96:99], v78 offset:4096
    ds_read_b128 v[88:91], v70 offset:4096
    s_add_u32 s51, s51, 128
    s_and_b32 s51, s51, 0x7ff
    s_add_u32 s52, s47, s51
    s_add_u32 m0, s49, 32768
    v_mfma_f32_32x32x16_bf16 v[148:163], v[104:107], v[108:111], v[148:163]
    buffer_load_dwordx4 v8, s[56:59], s52 offen  lds
    s_add_u32 m0, s49, 33792
    v_mfma_f32_32x32x16_bf16 v[164:179], v[104:107], v[112:115], v[164:179]
    buffer_load_dwordx4 v9, s[56:59], s52 offen  lds
    s_waitcnt lgkmcnt(2)
    v_mfma_f32_32x32x16_bf16 v[116:131], v[84:87], v[92:95], v[116:131]
    ds_read_b128 v[100:103], v71 offset:0
    ds_read_b128 v[108:111], v79 offset:0
    s_waitcnt lgkmcnt(3)
    v_mfma_f32_32x32x16_bf16 v[132:147], v[84:87], v[96:99], v[132:147]
    ds_read_b128 v[112:115], v79 offset:4096
    ds_read_b128 v[104:107], v71 offset:4096
    s_add_u32 m0, s49, 34816
    s_waitcnt lgkmcnt(4)
    v_mfma_f32_32x32x16_bf16 v[148:163], v[88:91], v[92:95], v[148:163]
    buffer_load_dwordx4 v10, s[56:59], s52 offen  lds
    s_add_u32 m0, s49, 35840
    v_mfma_f32_32x32x16_bf16 v[164:179], v[88:91], v[96:99], v[164:179]
    buffer_load_dwordx4 v11, s[56:59], s52 offen  lds
    s_waitcnt lgkmcnt(2)
    v_mfma_f32_32x32x16_bf16 v[116:131], v[100:103], v[108:111], v[116:131]
    ds_read_b128 v[84:87], v72 offset:0
    ds_read_b128 v[92:95], v80 offset:0
    s_waitcnt lgkmcnt(3)
    v_mfma_f32_32x32x16_bf16 v[132:147], v[100:103], v[112:115], v[132:147]
    ds_read_b128 v[96:99], v80 offset:4096
    ds_read_b128 v[88:91], v72 offset:4096
    s_add_u32 s53, s48, s51
    s_add_u32 m0, s49, 49152
    s_waitcnt lgkmcnt(4)
    v_mfma_f32_32x32x16_bf16 v[148:163], v[104:107], v[108:111], v[148:163]
    buffer_load_dwordx4 v12, s[60:63], s53 offen  lds
    s_add_u32 m0, s49, 50176
    v_mfma_f32_32x32x16_bf16 v[164:179], v[104:107], v[112:115], v[164:179]
    buffer_load_dwordx4 v13, s[60:63], s53 offen  lds
    s_waitcnt lgkmcnt(2)
    v_mfma_f32_32x32x16_bf16 v[116:131], v[84:87], v[92:95], v[116:131]
    ds_read_b128 v[100:103], v73 offset:0
    ds_read_b128 v[108:111], v81 offset:0
    s_waitcnt lgkmcnt(3)
    v_mfma_f32_32x32x16_bf16 v[132:147], v[84:87], v[96:99], v[132:147]
    ds_read_b128 v[112:115], v81 offset:4096
    ds_read_b128 v[104:107], v73 offset:4096
    s_add_u32 m0, s49, 51200
    s_waitcnt lgkmcnt(4)
    v_mfma_f32_32x32x16_bf16 v[148:163], v[88:91], v[92:95], v[148:163]
    buffer_load_dwordx4 v14, s[60:63], s53 offen  lds
    s_add_u32 m0, s49, 52224
    v_mfma_f32_32x32x16_bf16 v[164:179], v[88:91], v[96:99], v[164:179]
    buffer_load_dwordx4 v15, s[60:63], s53 offen  lds
    s_waitcnt lgkmcnt(0)
    s_waitcnt vmcnt(16)
    s_barrier
    v_mfma_f32_32x32x16_bf16 v[116:131], v[100:103], v[108:111], v[116:131]
    ds_read_b128 v[84:87], v70 offset:32768
    ds_read_b128 v[92:95], v78 offset:32768
    v_mov_b32 v3, 0
    buffer_load_dwordx2 v[4:5], v3, s[24:27], 0 offen sc0 sc1
    v_mfma_f32_32x32x16_bf16 v[132:147], v[100:103], v[112:115], v[132:147]
    ds_read_b128 v[96:99], v78 offset:36864
    ds_read_b128 v[88:91], v70 offset:36864
    s_add_u32 s51, s51, 128
    s_and_b32 s51, s51, 0x7ff
    s_add_u32 s52, s47, s51
    s_add_u32 m0, s49, 65536
    v_mfma_f32_32x32x16_bf16 v[148:163], v[104:107], v[108:111], v[148:163]
    buffer_load_dwordx4 v8, s[56:59], s52 offen  lds
    buffer_store_dwordx4 v[208:211], v181, s[8:11], s6 offen sc0 sc1
    s_add_u32 m0, s49, 66560
    v_mfma_f32_32x32x16_bf16 v[164:179], v[104:107], v[112:115], v[164:179]
    buffer_load_dwordx4 v9, s[56:59], s52 offen  lds
    s_add_u32 s6, s6, 32768
    buffer_store_dwordx4 v[212:215], v181, s[8:11], s6 offen sc0 sc1
    s_waitcnt lgkmcnt(2)
    v_mfma_f32_32x32x16_bf16 v[116:131], v[84:87], v[92:95], v[116:131]
    ds_read_b128 v[100:103], v71 offset:32768
    ds_read_b128 v[108:111], v79 offset:32768
    s_add_u32 s6, s6, 32768
    buffer_store_dwordx4 v[216:219], v181, s[8:11], s6 offen sc0 sc1
    s_waitcnt lgkmcnt(3)
    v_mfma_f32_32x32x16_bf16 v[132:147], v[84:87], v[96:99], v[132:147]
    ds_read_b128 v[112:115], v79 offset:36864
    ds_read_b128 v[104:107], v71 offset:36864
    s_add_u32 s6, s6, 32768
    s_add_u32 m0, s49, 67584
    s_waitcnt lgkmcnt(4)
    v_mfma_f32_32x32x16_bf16 v[148:163], v[88:91], v[92:95], v[148:163]
    buffer_load_dwordx4 v10, s[56:59], s52 offen  lds
    buffer_store_dwordx4 v[220:223], v181, s[8:11], s6 offen sc0 sc1
    s_add_u32 m0, s49, 68608
    v_mfma_f32_32x32x16_bf16 v[164:179], v[88:91], v[96:99], v[164:179]
    buffer_load_dwordx4 v11, s[56:59], s52 offen  lds
    s_mov_b64 s[30:31], exec
    s_mov_b32 exec_lo, 0
    s_mov_b32 exec_hi, 0x80000000
    buffer_store_dwordx2 v[226:227], v225, s[8:11], 0 offen sc0 sc1
    buffer_store_dwordx2 v[228:229], v225, s[8:11], s32 offen sc0 sc1
    s_mov_b64 exec, s[30:31]
    s_waitcnt lgkmcnt(2)
    v_mfma_f32_32x32x16_bf16 v[116:131], v[100:103], v[108:111], v[116:131]
    ds_read_b128 v[84:87], v72 offset:32768
    ds_read_b128 v[92:95], v80 offset:32768
    s_waitcnt lgkmcnt(3)
    v_mfma_f32_32x32x16_bf16 v[132:147], v[100:103], v[112:115], v[132:147]
    ds_read_b128 v[96:99], v80 offset:36864
    ds_read_b128 v[88:91], v72 offset:36864
    s_add_u32 s53, s48, s51
    s_add_u32 m0, s49, 81920
    s_waitcnt lgkmcnt(4)
    v_mfma_f32_32x32x16_bf16 v[148:163], v[104:107], v[108:111], v[148:163]
    buffer_load_dwordx4 v12, s[60:63], s53 offen  lds
    s_add_u32 m0, s49, 82944
    v_mfma_f32_32x32x16_bf16 v[164:179], v[104:107], v[112:115], v[164:179]
    buffer_load_dwordx4 v13, s[60:63], s53 offen  lds
    s_waitcnt lgkmcnt(2)
    v_mfma_f32_32x32x16_bf16 v[116:131], v[84:87], v[92:95], v[116:131]
    ds_read_b128 v[100:103], v73 offset:32768
    ds_read_b128 v[108:111], v81 offset:32768
    s_waitcnt lgkmcnt(3)
    v_mfma_f32_32x32x16_bf16 v[132:147], v[84:87], v[96:99], v[132:147]
    ds_read_b128 v[112:115], v81 offset:36864
    ds_read_b128 v[104:107], v73 offset:36864
    s_add_u32 m0, s49, 83968
    s_waitcnt lgkmcnt(4)
    v_mfma_f32_32x32x16_bf16 v[148:163], v[88:91], v[92:95], v[148:163]
    buffer_load_dwordx4 v14, s[60:63], s53 offen  lds
    s_add_u32 m0, s49, 84992
    v_mfma_f32_32x32x16_bf16 v[164:179], v[88:91], v[96:99], v[164:179]
    buffer_load_dwordx4 v15, s[60:63], s53 offen  lds
    s_waitcnt lgkmcnt(0)
    s_waitcnt vmcnt(23)
    s_barrier
    v_mfma_f32_32x32x16_bf16 v[116:131], v[100:103], v[108:111], v[116:131]
    ds_read_b128 v[84:87], v66 offset:0
    ds_read_b128 v[92:95], v74 offset:0
    v_mfma_f32_32x32x16_bf16 v[132:147], v[100:103], v[112:115], v[132:147]
    ds_read_b128 v[96:99], v74 offset:4096
    ds_read_b128 v[88:91], v66 offset:4096
    s_add_u32 s51, s51, 128
    s_and_b32 s51, s51, 0x7ff
    s_add_u32 s52, s47, s51
    s_add_u32 m0, s49, 98304
    v_mfma_f32_32x32x16_bf16 v[148:163], v[104:107], v[108:111], v[148:163]
    buffer_load_dwordx4 v8, s[56:59], s52 offen  lds
    s_add_u32 m0, s49, 99328
    v_mfma_f32_32x32x16_bf16 v[164:179], v[104:107], v[112:115], v[164:179]
    buffer_load_dwordx4 v9, s[56:59], s52 offen  lds
    s_waitcnt lgkmcnt(2)
    v_mfma_f32_32x32x16_bf16 v[116:131], v[84:87], v[92:95], v[116:131]
    ds_read_b128 v[100:103], v67 offset:0
    ds_read_b128 v[108:111], v75 offset:0
    s_waitcnt lgkmcnt(3)
    v_mfma_f32_32x32x16_bf16 v[132:147], v[84:87], v[96:99], v[132:147]
    ds_read_b128 v[112:115], v75 offset:4096
    ds_read_b128 v[104:107], v67 offset:4096
    s_add_u32 m0, s49, 100352
    s_waitcnt lgkmcnt(4)
    v_mfma_f32_32x32x16_bf16 v[148:163], v[88:91], v[92:95], v[148:163]
    buffer_load_dwordx4 v10, s[56:59], s52 offen  lds
    s_add_u32 m0, s49, 101376
    v_mfma_f32_32x32x16_bf16 v[164:179], v[88:91], v[96:99], v[164:179]
    buffer_load_dwordx4 v11, s[56:59], s52 offen  lds
    s_waitcnt lgkmcnt(2)
    v_mfma_f32_32x32x16_bf16 v[116:131], v[100:103], v[108:111], v[116:131]
    ds_read_b128 v[84:87], v68 offset:0
    ds_read_b128 v[92:95], v76 offset:0
    s_waitcnt lgkmcnt(3)
    v_mfma_f32_32x32x16_bf16 v[132:147], v[100:103], v[112:115], v[132:147]
    ds_read_b128 v[96:99], v76 offset:4096
    ds_read_b128 v[88:91], v68 offset:4096
    s_add_u32 s53, s48, s51
    s_add_u32 m0, s49, 114688
    s_waitcnt lgkmcnt(4)
    v_mfma_f32_32x32x16_bf16 v[148:163], v[104:107], v[108:111], v[148:163]
    buffer_load_dwordx4 v12, s[60:63], s53 offen  lds
    s_add_u32 m0, s49, 115712
    v_mfma_f32_32x32x16_bf16 v[164:179], v[104:107], v[112:115], v[164:179]
    buffer_load_dwordx4 v13, s[60:63], s53 offen  lds
    s_waitcnt lgkmcnt(2)
    v_mfma_f32_32x32x16_bf16 v[116:131], v[84:87], v[92:95], v[116:131]
    ds_read_b128 v[100:103], v69 offset:0
    ds_read_b128 v[108:111], v77 offset:0
    s_waitcnt lgkmcnt(3)
    v_mfma_f32_32x32x16_bf16 v[132:147], v[84:87], v[96:99], v[132:147]
    ds_read_b128 v[112:115], v77 offset:4096
    ds_read_b128 v[104:107], v69 offset:4096
    s_add_u32 m0, s49, 116736
    s_waitcnt lgkmcnt(4)
    v_mfma_f32_32x32x16_bf16 v[148:163], v[88:91], v[92:95], v[148:163]
    buffer_load_dwordx4 v14, s[60:63], s53 offen  lds
    s_add_u32 m0, s49, 117760
    v_mfma_f32_32x32x16_bf16 v[164:179], v[88:91], v[96:99], v[164:179]
    buffer_load_dwordx4 v15, s[60:63], s53 offen  lds
    s_waitcnt lgkmcnt(0)
    s_waitcnt vmcnt(23)
    s_barrier
    v_mfma_f32_32x32x16_bf16 v[116:131], v[100:103], v[108:111], v[116:131]
    ds_read_b128 v[84:87], v66 offset:32768
    ds_read_b128 v[92:95], v74 offset:32768
    s_lshl_b32 s6, s46, 2
    s_add_u32 s6, s6, s44
    s_lshl_b32 s6, s6, 16
    s_lshl_b32 s3, s45, 12
    v_mfma_f32_32x32x16_bf16 v[132:147], v[100:103], v[112:115], v[132:147]
    ds_read_b128 v[96:99], v74 offset:36864
    ds_read_b128 v[88:91], v66 offset:36864
    s_add_u32 s6, s6, s3
    s_add_u32 s6, s6, 16777216
    s_mov_b32 s7, 0x05040100
    s_mov_b32 s12, 0x07060302
    v_mfma_f32_32x32x16_bf16 v[148:163], v[104:107], v[108:111], v[148:163]
    v_and_b32 v20, 31, v2
    v_lshlrev_b32 v18, 6, v20
    v_bfe_u32 v20, v2, 2, 2
    v_lshrrev_b32 v21, 5, v2
    v_lshlrev_b32 v21, 1, v21
    v_xor_b32 v20, v20, v21
    v_mfma_f32_32x32x16_bf16 v[164:179], v[104:107], v[112:115], v[164:179]
    v_lshl_add_u32 v18, v20, 4, v18
    v_add_u32 v18, s16, v18
    v_xor_b32 v19, 16, v18
    ds_read_b128 v[22:25], v18 offset:0
    ds_read_b128 v[26:29], v19 offset:0
    s_waitcnt lgkmcnt(4)
    v_mfma_f32_32x32x16_bf16 v[116:131], v[84:87], v[92:95], v[116:131]
    ds_read_b128 v[100:103], v67 offset:32768
    ds_read_b128 v[108:111], v75 offset:32768
    ds_read_b128 v[30:33], v18 offset:2048
    ds_read_b128 v[34:37], v19 offset:2048
    s_waitcnt lgkmcnt(1)
    v_perm_b32 v38, v30, v22, s7
    v_perm_b32 v39, v30, v22, s12
    v_mfma_f32_32x32x16_bf16 v[132:147], v[84:87], v[96:99], v[132:147]
    ds_read_b128 v[112:115], v75 offset:36864
    ds_read_b128 v[104:107], v67 offset:36864
    v_perm_b32 v40, v31, v23, s7
    v_perm_b32 v41, v31, v23, s12
    buffer_store_dwordx4 v[38:41], v17, s[8:11], s6 offen offset:0 sc0 sc1
    v_perm_b32 v42, v32, v24, s7
    v_mfma_f32_32x32x16_bf16 v[148:163], v[88:91], v[92:95], v[148:163]
    v_perm_b32 v43, v32, v24, s12
    v_perm_b32 v44, v33, v25, s7
    v_perm_b32 v45, v33, v25, s12
    buffer_store_dwordx4 v[42:45], v17, s[8:11], s6 offen offset:1024 sc0 sc1
    s_waitcnt lgkmcnt(2)
    v_perm_b32 v38, v34, v26, s7
    v_perm_b32 v39, v34, v26, s12
    v_mfma_f32_32x32x16_bf16 v[164:179], v[88:91], v[96:99], v[164:179]
    v_perm_b32 v40, v35, v27, s7
    v_perm_b32 v41, v35, v27, s12
    buffer_store_dwordx4 v[38:41], v17, s[8:11], s6 offen offset:2048 sc0 sc1
    v_perm_b32 v42, v36, v28, s7
    v_perm_b32 v43, v36, v28, s12
    v_perm_b32 v44, v37, v29, s7
    v_mfma_f32_32x32x16_bf16 v[116:131], v[100:103], v[108:111], v[116:131]
    ds_read_b128 v[84:87], v68 offset:32768
    ds_read_b128 v[92:95], v76 offset:32768
    v_perm_b32 v45, v37, v29, s12
    buffer_store_dwordx4 v[42:45], v17, s[8:11], s6 offen offset:3072 sc0 sc1
    s_waitcnt lgkmcnt(3)
    v_mfma_f32_32x32x16_bf16 v[132:147], v[100:103], v[112:115], v[132:147]
    ds_read_b128 v[96:99], v76 offset:36864
    ds_read_b128 v[88:91], v68 offset:36864
    s_waitcnt lgkmcnt(4)
    v_mfma_f32_32x32x16_bf16 v[148:163], v[104:107], v[108:111], v[148:163]
    v_mfma_f32_32x32x16_bf16 v[164:179], v[104:107], v[112:115], v[164:179]
    s_waitcnt lgkmcnt(2)
    v_mfma_f32_32x32x16_bf16 v[116:131], v[84:87], v[92:95], v[116:131]
    ds_read_b128 v[100:103], v69 offset:32768
    ds_read_b128 v[108:111], v77 offset:32768
    s_waitcnt lgkmcnt(3)
    v_mfma_f32_32x32x16_bf16 v[132:147], v[84:87], v[96:99], v[132:147]
    ds_read_b128 v[112:115], v77 offset:36864
    ds_read_b128 v[104:107], v69 offset:36864
    s_waitcnt lgkmcnt(4)
    v_mfma_f32_32x32x16_bf16 v[148:163], v[88:91], v[92:95], v[148:163]
    v_mfma_f32_32x32x16_bf16 v[164:179], v[88:91], v[96:99], v[164:179]
    s_waitcnt lgkmcnt(0)
    s_waitcnt vmcnt(12)
    s_barrier
    v_mfma_f32_32x32x16_bf16 v[116:131], v[100:103], v[108:111], v[116:131]
    ds_read_b128 v[84:87], v70 offset:0
    ds_read_b128 v[92:95], v78 offset:0
    v_subrev_u32 v50, 32, v17
    v_min_u32 v50, 0x7fff0000, v50
    v_add_u32 v51, s23, v17
    buffer_load_dwordx4 v[38:41], v50, s[76:79], 0 offen
    v_mfma_f32_32x32x16_bf16 v[132:147], v[100:103], v[112:115], v[132:147]
    ds_read_b128 v[96:99], v78 offset:4096
    ds_read_b128 v[88:91], v70 offset:4096
    buffer_load_dwordx4 v[22:25], v17, s[76:79], 0 offen offset:0
    v_mfma_f32_32x32x16_bf16 v[148:163], v[104:107], v[108:111], v[148:163]
    buffer_load_dwordx4 v[26:29], v17, s[76:79], 0 offen offset:1024
    v_mfma_f32_32x32x16_bf16 v[164:179], v[104:107], v[112:115], v[164:179]
    buffer_load_dwordx4 v[30:33], v17, s[76:79], 0 offen offset:2048
    buffer_load_dwordx4 v[34:37], v17, s[76:79], 0 offen offset:3072
    s_waitcnt lgkmcnt(2)
    v_mfma_f32_32x32x16_bf16 v[116:131], v[84:87], v[92:95], v[116:131]
    ds_read_b128 v[100:103], v71 offset:0
    ds_read_b128 v[108:111], v79 offset:0
    s_mov_b32 s88, s20
    s_waitcnt lgkmcnt(3)
    v_mfma_f32_32x32x16_bf16 v[132:147], v[84:87], v[96:99], v[132:147]
    ds_read_b128 v[112:115], v79 offset:4096
    ds_read_b128 v[104:107], v71 offset:4096
    s_mov_b32 s89, s21
    s_mov_b32 s90, 2048
    s_mov_b32 s91, 131072
    s_and_b32 s3, s44, 1
    s_waitcnt lgkmcnt(4)
    v_mfma_f32_32x32x16_bf16 v[148:163], v[88:91], v[92:95], v[148:163]
    s_lshl_b32 s3, s3, 5
    s_and_b32 s3, s44, 1
    s_lshl_b32 s3, s3, 6
    v_and_b32 v52, 31, v2
    v_lshl_add_u32 v52, v52, 1, s3
    s_lshl_b32 s3, s46, 7
    buffer_load_ushort v52, v52, s[88:91], s3 offen
    v_and_b32 v53, 15, v2
    v_lshrrev_b32 v54, 4, v2
    v_mfma_f32_32x32x16_bf16 v[164:179], v[88:91], v[96:99], v[164:179]
    v_add_u32 v55, 1, v53
    v_and_b32 v56, 1, v55
    v_mul_u32_u24 v56, 4160, v56
    v_and_b32 v55, 30, v55
    v_lshl_add_u32 v56, v55, 1, v56
    v_lshl_add_u32 v56, v54, 4, v56
    s_waitcnt lgkmcnt(2)
    v_mfma_f32_32x32x16_bf16 v[116:131], v[100:103], v[108:111], v[116:131]
    ds_read_b128 v[84:87], v72 offset:0
    ds_read_b128 v[92:95], v80 offset:0
    v_add_u32 v57, s23, v56
    v_add_u32 v63, 1024, v57
    v_add_u32 v64, 2048, v57
    v_add_u32 v65, 3072, v57
    s_waitcnt lgkmcnt(3)
    v_mfma_f32_32x32x16_bf16 v[132:147], v[100:103], v[112:115], v[132:147]
    ds_read_b128 v[96:99], v80 offset:4096
    ds_read_b128 v[88:91], v72 offset:4096
    v_lshlrev_b32 v55, 1, v53
    v_sub_u32 v55, v54, v55
    v_add_u32 v55, 30, v55
    v_lshrrev_b32 v56, 2, v55
    s_waitcnt lgkmcnt(4)
    v_mfma_f32_32x32x16_bf16 v[148:163], v[104:107], v[108:111], v[148:163]
    v_lshlrev_b32 v55, 6, v55
    v_add_u32 v55, 132096, v55
    v_add_u32 v58, 63, v56
    v_and_b32 v58, 3, v58
    v_xor_b32 v58, s44, v58
    v_lshl_add_u32 v58, v58, 4, v55
    v_mfma_f32_32x32x16_bf16 v[164:179], v[104:107], v[112:115], v[164:179]
    v_add_u32 v59, 62, v56
    v_and_b32 v59, 3, v59
    v_xor_b32 v59, s44, v59
    v_lshl_add_u32 v59, v59, 4, v55
    v_add_u32 v60, 61, v56
    v_and_b32 v60, 3, v60
    s_waitcnt lgkmcnt(2)
    v_mfma_f32_32x32x16_bf16 v[116:131], v[84:87], v[92:95], v[116:131]
    ds_read_b128 v[100:103], v73 offset:0
    ds_read_b128 v[108:111], v81 offset:0
    v_xor_b32 v60, s44, v60
    v_lshl_add_u32 v60, v60, 4, v55
    v_add_u32 v61, 60, v56
    v_and_b32 v61, 3, v61
    s_waitcnt lgkmcnt(3)
    v_mfma_f32_32x32x16_bf16 v[132:147], v[84:87], v[96:99], v[132:147]
    ds_read_b128 v[112:115], v81 offset:4096
    ds_read_b128 v[104:107], v73 offset:4096
    v_xor_b32 v61, s44, v61
    v_lshl_add_u32 v61, v61, 4, v55
    v_lshlrev_b32 v55, 5, v53
    v_lshl_add_u32 v55, v54, 3, v55
    s_waitcnt lgkmcnt(4)
    v_mfma_f32_32x32x16_bf16 v[148:163], v[88:91], v[92:95], v[148:163]
    v_sub_u32 v55, 504, v55
    v_and_b32 v62, 8, v55
    v_lshrrev_b32 v55, 4, v55
    v_lshl_add_u32 v62, v55, 6, v62
    v_bfe_u32 v55, v55, 2, 2
    v_xor_b32 v55, s44, v55
    v_mfma_f32_32x32x16_bf16 v[164:179], v[88:91], v[96:99], v[164:179]
    v_lshl_add_u32 v62, v55, 4, v62
    v_add_u32 v62, 132096, v62
    v_and_b32 v55, 1, v54
    v_lshlrev_b32 v55, 9, v55
    v_lshl_add_u32 v55, v53, 5, v55
    v_lshrrev_b32 v56, 1, v54
    s_waitcnt lgkmcnt(0)
    s_waitcnt vmcnt(10)
    s_barrier
    v_mfma_f32_32x32x16_bf16 v[116:131], v[100:103], v[108:111], v[116:131]
    ds_read_b128 v[84:87], v70 offset:32768
    ds_read_b128 v[92:95], v78 offset:32768
    v_lshl_add_u32 v180, v56, 4, v55
    s_mov_b32 s6, 0
    v_readfirstlane_b32 s42, v4
    v_readfirstlane_b32 s43, v5
    s_nop 3
    s_or_b32 s3, s42, s43
    s_cmp_lg_u32 s3, 0
    s_cbranch_scc1 Lnok_gate_2
Lnretry_gate_3:
    buffer_load_dwordx2 v[4:5], v3, s[24:27], 0 offen sc0 sc1
    s_waitcnt vmcnt(0)
    v_readfirstlane_b32 s42, v4
    v_readfirstlane_b32 s43, v5
    s_add_u32 s6, s6, 1
    s_nop 3
    s_or_b32 s3, s42, s43
    s_cmp_gt_u32 s6, 20000
    s_cbranch_scc1 Lnok_gate_2
    s_cmp_eq_u32 s3, 0
    s_cbranch_scc1 Lnretry_gate_3
Lnok_gate_2:
    v_mov_b32 v82, s42
    v_mov_b32 v83, s43
    s_mov_b64 s[6:7], exec
    s_mov_b64 exec, 1
    buffer_store_dwordx2 v[82:83], v6, s[8:11], s13 offen sc0 sc1
    s_mov_b64 exec, s[6:7]
    v_mfma_f32_32x32x16_bf16 v[132:147], v[100:103], v[112:115], v[132:147]
    ds_read_b128 v[96:99], v78 offset:36864
    ds_read_b128 v[88:91], v70 offset:36864
    v_mfma_f32_32x32x16_bf16 v[148:163], v[104:107], v[108:111], v[148:163]
    v_mfma_f32_32x32x16_bf16 v[164:179], v[104:107], v[112:115], v[164:179]
    s_waitcnt lgkmcnt(2)
    v_mfma_f32_32x32x16_bf16 v[116:131], v[84:87], v[92:95], v[116:131]
    ds_read_b128 v[100:103], v71 offset:32768
    ds_read_b128 v[108:111], v79 offset:32768
    s_waitcnt lgkmcnt(3)
    v_mfma_f32_32x32x16_bf16 v[132:147], v[84:87], v[96:99], v[132:147]
    ds_read_b128 v[112:115], v79 offset:36864
    ds_read_b128 v[104:107], v71 offset:36864
    s_waitcnt lgkmcnt(4)
    v_mfma_f32_32x32x16_bf16 v[148:163], v[88:91], v[92:95], v[148:163]
    v_mfma_f32_32x32x16_bf16 v[164:179], v[88:91], v[96:99], v[164:179]
    s_waitcnt lgkmcnt(2)
    v_mfma_f32_32x32x16_bf16 v[116:131], v[100:103], v[108:111], v[116:131]
    ds_read_b128 v[84:87], v72 offset:32768
    ds_read_b128 v[92:95], v80 offset:32768
    s_waitcnt lgkmcnt(3)
    v_mfma_f32_32x32x16_bf16 v[132:147], v[100:103], v[112:115], v[132:147]
    ds_read_b128 v[96:99], v80 offset:36864
    ds_read_b128 v[88:91], v72 offset:36864
    s_waitcnt lgkmcnt(4)
    v_mfma_f32_32x32x16_bf16 v[148:163], v[104:107], v[108:111], v[148:163]
    v_mfma_f32_32x32x16_bf16 v[164:179], v[104:107], v[112:115], v[164:179]
    s_waitcnt lgkmcnt(2)
    v_mfma_f32_32x32x16_bf16 v[116:131], v[84:87], v[92:95], v[116:131]
    ds_read_b128 v[100:103], v73 offset:32768
    ds_read_b128 v[108:111], v81 offset:32768
    s_waitcnt lgkmcnt(3)
    v_mfma_f32_32x32x16_bf16 v[132:147], v[84:87], v[96:99], v[132:147]
    ds_read_b128 v[112:115], v81 offset:36864
    ds_read_b128 v[104:107], v73 offset:36864
    s_waitcnt lgkmcnt(4)
    v_mfma_f32_32x32x16_bf16 v[148:163], v[88:91], v[92:95], v[148:163]
    v_mfma_f32_32x32x16_bf16 v[164:179], v[88:91], v[96:99], v[164:179]
    s_waitcnt lgkmcnt(0)
    v_mfma_f32_32x32x16_bf16 v[116:131], v[100:103], v[108:111], v[116:131]
    v_mfma_f32_32x32x16_bf16 v[132:147], v[100:103], v[112:115], v[132:147]
    v_mfma_f32_32x32x16_bf16 v[148:163], v[104:107], v[108:111], v[148:163]
    v_mfma_f32_32x32x16_bf16 v[164:179], v[104:107], v[112:115], v[164:179]
    s_waitcnt vmcnt(7)
    v_mov_b32 v82, s42
    v_mov_b32 v83, s43
    s_mov_b64 s[6:7], exec
    s_mov_b64 exec, 1
    buffer_store_dwordx2 v[82:83], v6, s[8:11], s18 offen sc0 sc1
    s_mov_b64 exec, s[6:7]
    s_nop 2
    v_pk_fma_f32 v[10:11], v[132:133], v[230:231], v[118:119] op_sel:[0,1,0] op_sel_hi:[1,1,1] neg_lo:[0,1,0] neg_hi:[0,1,0]
    v_pk_fma_f32 v[12:13], v[116:117], v[230:231], v[134:135] op_sel:[0,1,0] op_sel_hi:[1,1,1]
    v_pk_fma_f32 v[4:5], v[116:117], v[230:231], v[10:11] op_sel:[0,0,0] op_sel_hi:[1,0,1]
    v_pk_fma_f32 v[8:9], v[132:133], v[230:231], v[12:13] op_sel:[0,0,0] op_sel_hi:[1,0,1]
    v_pk_fma_f32 v[10:11], v[8:9], v[230:231], v[120:121] op_sel:[0,1,0] op_sel_hi:[1,1,1] neg_lo:[0,1,0] neg_hi:[0,1,0]
    v_pk_fma_f32 v[12:13], v[4:5], v[230:231], v[136:137] op_sel:[0,1,0] op_sel_hi:[1,1,1]
    v_pk_fma_f32 v[4:5], v[4:5], v[230:231], v[10:11] op_sel:[0,0,0] op_sel_hi:[1,0,1]
    v_pk_fma_f32 v[8:9], v[8:9], v[230:231], v[12:13] op_sel:[0,0,0] op_sel_hi:[1,0,1]
    v_pk_fma_f32 v[10:11], v[8:9], v[230:231], v[122:123] op_sel:[0,1,0] op_sel_hi:[1,1,1] neg_lo:[0,1,0] neg_hi:[0,1,0]
    v_pk_fma_f32 v[12:13], v[4:5], v[230:231], v[138:139] op_sel:[0,1,0] op_sel_hi:[1,1,1]
    v_pk_fma_f32 v[4:5], v[4:5], v[230:231], v[10:11] op_sel:[0,0,0] op_sel_hi:[1,0,1]
    v_pk_fma_f32 v[8:9], v[8:9], v[230:231], v[12:13] op_sel:[0,0,0] op_sel_hi:[1,0,1]
    v_pk_fma_f32 v[10:11], v[8:9], v[230:231], v[124:125] op_sel:[0,1,0] op_sel_hi:[1,1,1] neg_lo:[0,1,0] neg_hi:[0,1,0]
    v_pk_fma_f32 v[12:13], v[4:5], v[230:231], v[140:141] op_sel:[0,1,0] op_sel_hi:[1,1,1]
    v_pk_fma_f32 v[4:5], v[4:5], v[230:231], v[10:11] op_sel:[0,0,0] op_sel_hi:[1,0,1]
    v_pk_fma_f32 v[8:9], v[8:9], v[230:231], v[12:13] op_sel:[0,0,0] op_sel_hi:[1,0,1]
    v_pk_fma_f32 v[10:11], v[8:9], v[230:231], v[126:127] op_sel:[0,1,0] op_sel_hi:[1,1,1] neg_lo:[0,1,0] neg_hi:[0,1,0]
    v_pk_fma_f32 v[12:13], v[4:5], v[230:231], v[142:143] op_sel:[0,1,0] op_sel_hi:[1,1,1]
    v_pk_fma_f32 v[4:5], v[4:5], v[230:231], v[10:11] op_sel:[0,0,0] op_sel_hi:[1,0,1]
    v_pk_fma_f32 v[8:9], v[8:9], v[230:231], v[12:13] op_sel:[0,0,0] op_sel_hi:[1,0,1]
    v_pk_fma_f32 v[10:11], v[8:9], v[230:231], v[128:129] op_sel:[0,1,0] op_sel_hi:[1,1,1] neg_lo:[0,1,0] neg_hi:[0,1,0]
    v_pk_fma_f32 v[12:13], v[4:5], v[230:231], v[144:145] op_sel:[0,1,0] op_sel_hi:[1,1,1]
    v_pk_fma_f32 v[4:5], v[4:5], v[230:231], v[10:11] op_sel:[0,0,0] op_sel_hi:[1,0,1]
    v_pk_fma_f32 v[8:9], v[8:9], v[230:231], v[12:13] op_sel:[0,0,0] op_sel_hi:[1,0,1]
    v_pk_fma_f32 v[10:11], v[8:9], v[230:231], v[130:131] op_sel:[0,1,0] op_sel_hi:[1,1,1] neg_lo:[0,1,0] neg_hi:[0,1,0]
    v_pk_fma_f32 v[12:13], v[4:5], v[230:231], v[146:147] op_sel:[0,1,0] op_sel_hi:[1,1,1]
    v_pk_fma_f32 v[4:5], v[4:5], v[230:231], v[10:11] op_sel:[0,0,0] op_sel_hi:[1,0,1]
    v_pk_fma_f32 v[8:9], v[8:9], v[230:231], v[12:13] op_sel:[0,0,0] op_sel_hi:[1,0,1]
    v_pk_fma_f32 v[10:11], v[8:9], v[230:231], v[148:149] op_sel:[0,1,0] op_sel_hi:[1,1,1] neg_lo:[0,1,0] neg_hi:[0,1,0]
    v_pk_fma_f32 v[12:13], v[4:5], v[230:231], v[164:165] op_sel:[0,1,0] op_sel_hi:[1,1,1]
    v_pk_fma_f32 v[4:5], v[4:5], v[230:231], v[10:11] op_sel:[0,0,0] op_sel_hi:[1,0,1]
    v_pk_fma_f32 v[8:9], v[8:9], v[230:231], v[12:13] op_sel:[0,0,0] op_sel_hi:[1,0,1]
    v_pk_fma_f32 v[10:11], v[8:9], v[230:231], v[150:151] op_sel:[0,1,0] op_sel_hi:[1,1,1] neg_lo:[0,1,0] neg_hi:[0,1,0]
    v_pk_fma_f32 v[12:13], v[4:5], v[230:231], v[166:167] op_sel:[0,1,0] op_sel_hi:[1,1,1]
    v_pk_fma_f32 v[4:5], v[4:5], v[230:231], v[10:11] op_sel:[0,0,0] op_sel_hi:[1,0,1]
    v_pk_fma_f32 v[8:9], v[8:9], v[230:231], v[12:13] op_sel:[0,0,0] op_sel_hi:[1,0,1]
    v_pk_fma_f32 v[10:11], v[8:9], v[230:231], v[152:153] op_sel:[0,1,0] op_sel_hi:[1,1,1] neg_lo:[0,1,0] neg_hi:[0,1,0]
    v_pk_fma_f32 v[12:13], v[4:5], v[230:231], v[168:169] op_sel:[0,1,0] op_sel_hi:[1,1,1]
    v_pk_fma_f32 v[4:5], v[4:5], v[230:231], v[10:11] op_sel:[0,0,0] op_sel_hi:[1,0,1]
    v_pk_fma_f32 v[8:9], v[8:9], v[230:231], v[12:13] op_sel:[0,0,0] op_sel_hi:[1,0,1]
    v_pk_fma_f32 v[10:11], v[8:9], v[230:231], v[154:155] op_sel:[0,1,0] op_sel_hi:[1,1,1] neg_lo:[0,1,0] neg_hi:[0,1,0]
    v_pk_fma_f32 v[12:13], v[4:5], v[230:231], v[170:171] op_sel:[0,1,0] op_sel_hi:[1,1,1]
    v_pk_fma_f32 v[4:5], v[4:5], v[230:231], v[10:11] op_sel:[0,0,0] op_sel_hi:[1,0,1]
    v_pk_fma_f32 v[8:9], v[8:9], v[230:231], v[12:13] op_sel:[0,0,0] op_sel_hi:[1,0,1]
    v_pk_fma_f32 v[10:11], v[8:9], v[230:231], v[156:157] op_sel:[0,1,0] op_sel_hi:[1,1,1] neg_lo:[0,1,0] neg_hi:[0,1,0]
    v_pk_fma_f32 v[12:13], v[4:5], v[230:231], v[172:173] op_sel:[0,1,0] op_sel_hi:[1,1,1]
    v_pk_fma_f32 v[4:5], v[4:5], v[230:231], v[10:11] op_sel:[0,0,0] op_sel_hi:[1,0,1]
    v_pk_fma_f32 v[8:9], v[8:9], v[230:231], v[12:13] op_sel:[0,0,0] op_sel_hi:[1,0,1]
    v_pk_fma_f32 v[10:11], v[8:9], v[230:231], v[158:159] op_sel:[0,1,0] op_sel_hi:[1,1,1] neg_lo:[0,1,0] neg_hi:[0,1,0]
    v_pk_fma_f32 v[12:13], v[4:5], v[230:231], v[174:175] op_sel:[0,1,0] op_sel_hi:[1,1,1]
    v_pk_fma_f32 v[4:5], v[4:5], v[230:231], v[10:11] op_sel:[0,0,0] op_sel_hi:[1,0,1]
    v_pk_fma_f32 v[8:9], v[8:9], v[230:231], v[12:13] op_sel:[0,0,0] op_sel_hi:[1,0,1]
    v_pk_fma_f32 v[10:11], v[8:9], v[230:231], v[160:161] op_sel:[0,1,0] op_sel_hi:[1,1,1] neg_lo:[0,1,0] neg_hi:[0,1,0]
    v_pk_fma_f32 v[12:13], v[4:5], v[230:231], v[176:177] op_sel:[0,1,0] op_sel_hi:[1,1,1]
    v_pk_fma_f32 v[4:5], v[4:5], v[230:231], v[10:11] op_sel:[0,0,0] op_sel_hi:[1,0,1]
    v_pk_fma_f32 v[8:9], v[8:9], v[230:231], v[12:13] op_sel:[0,0,0] op_sel_hi:[1,0,1]
    v_pk_fma_f32 v[10:11], v[8:9], v[230:231], v[162:163] op_sel:[0,1,0] op_sel_hi:[1,1,1] neg_lo:[0,1,0] neg_hi:[0,1,0]
    v_pk_fma_f32 v[12:13], v[4:5], v[230:231], v[178:179] op_sel:[0,1,0] op_sel_hi:[1,1,1]
    v_pk_fma_f32 v[4:5], v[4:5], v[230:231], v[10:11] op_sel:[0,0,0] op_sel_hi:[1,0,1]
    v_pk_fma_f32 v[8:9], v[8:9], v[230:231], v[12:13] op_sel:[0,0,0] op_sel_hi:[1,0,1]
    v_lshrrev_b32 v3, 5, v2
    v_lshlrev_b32 v3, 10, v3
    v_lshl_add_u32 v1, v7, 2, v3
    s_lshr_b32 s3, s44, 1
    s_lshl_b32 s3, s3, 11
    s_add_u32 s3, s3, 150528
    v_add_u32 v1, s3, v1
    ds_write2st64_b32 v1, v4, v8 offset0:12 offset1:13
    ds_write2st64_b32 v1, v5, v9 offset0:14 offset1:15
    s_waitcnt lgkmcnt(0)
    s_barrier
    ds_read2st64_b32 v[66:67], v1 offset0:0 offset1:1
    ds_read2st64_b32 v[68:69], v1 offset0:2 offset1:3
    ds_read2st64_b32 v[70:71], v1 offset0:4 offset1:5
    ds_read2st64_b32 v[72:73], v1 offset0:6 offset1:7
    ds_read2st64_b32 v[74:75], v1 offset0:8 offset1:9
    ds_read2st64_b32 v[76:77], v1 offset0:10 offset1:11
    s_waitcnt lgkmcnt(4)
    v_fma_f32 v20, -v235, v67, v68
    v_fma_f32 v21, v235, v66, v69
    v_fma_f32 v68, v234, v66, v20
    v_fma_f32 v69, v234, v67, v21
    s_waitcnt lgkmcnt(3)
    v_fma_f32 v20, -v235, v69, v70
    v_fma_f32 v21, v235, v68, v71
    v_fma_f32 v70, v234, v68, v20
    v_fma_f32 v71, v234, v69, v21
    s_waitcnt lgkmcnt(2)
    v_fma_f32 v20, -v235, v71, v72
    v_fma_f32 v21, v235, v70, v73
    v_fma_f32 v72, v234, v70, v20
    v_fma_f32 v73, v234, v71, v21
    s_waitcnt lgkmcnt(1)
    v_fma_f32 v20, -v235, v73, v74
    v_fma_f32 v21, v235, v72, v75
    v_fma_f32 v74, v234, v72, v20
    v_fma_f32 v75, v234, v73, v21
    s_waitcnt lgkmcnt(0)
    v_fma_f32 v20, -v235, v75, v76
    v_fma_f32 v21, v235, v74, v77
    v_fma_f32 v76, v234, v74, v20
    v_fma_f32 v77, v234, v75, v21
    v_fma_f32 v20, -v235, v77, v4
    v_fma_f32 v21, v235, v76, v8
    v_fma_f32 v14, v234, v76, v20
    v_fma_f32 v15, v234, v77, v21
    v_fma_f32 v20, -v235, v15, v5
    v_fma_f32 v21, v235, v14, v9
    v_fma_f32 v54, v234, v14, v20
    v_fma_f32 v55, v234, v15, v21
    v_mov_b32 v84, v76
    v_mov_b32 v85, v14
    v_mov_b32 v86, v77
    v_mov_b32 v87, v15
    s_lshl_b32 s3, s46, 14
    s_add_u32 s3, s3, 21037056
    s_add_u32 s48, s40, s3
    s_addc_u32 s49, s41, 0
    s_mov_b32 s50, 16384
    s_mov_b32 s51, 131072
    v_lshlrev_b32 v1, 4, v7
    s_lshl_b32 s4, s45, 10
    s_lshr_b32 s3, s44, 1
    s_cmp_eq_u32 s3, 0
    s_cbranch_scc1 Lnopub_gate_4
    v_mov_b32 v66, v54
    v_mov_b32 v67, v55
    v_mov_b32 v68, s42
    v_mov_b32 v69, s43
    s_mov_b64 s[6:7], exec
    s_mov_b64 exec, s[34:35]
    buffer_store_dwordx4 v[66:69], v1, s[48:51], s4 offen sc0 sc1
    s_mov_b64 exec, s[6:7]
    s_nop 1
Lnopub_gate_4:
    s_lshl_b32 s3, s46, 2
    s_add_u32 s3, s3, s44
    s_lshl_b32 s3, s3, 7
    s_add_u32 s3, s3, 21504000
    v_and_b32 v3, 15, v2
    v_lshlrev_b32 v3, 3, v3
    v_add_u32 v3, s3, v3
    v_lshrrev_b32 v9, 5, v2
    v_lshlrev_b32 v9, 10, v9
    v_sub_u32 v9, v1, v9
    s_sub_u32 s3, s4, 1024
    v_add_u32 v8, s3, v9
    v_mul_f32 v14, v237, v237
    v_fma_f32 v14, v236, v236, -v14
    v_mul_f32 v15, v236, v237
    v_add_f32 v15, v15, v15
    v_lshrrev_b32 v9, 5, v2
    v_sub_u32 v9, s45, v9
    v_add_u32 v9, 1, v9
    v_lshrrev_b32 v16, 1, v9
    s_lshl_b32 s3, s46, 2
    s_add_u32 s3, s3, s44
    s_lshl_b32 s6, s3, 16
    s_add_u32 s6, s6, 16777216
    s_lshl_b32 s7, s46, 12
    s_and_b32 s3, s46, 7
    s_lshl_b32 s3, s3, 2
    s_lshl_b32 s13, -1, s3
    s_and_b32 s13, s13, 0x01111111
    s_add_u32 s13, s13, 0x06543210
    s_bitcmp1_b32 s46, 3
    s_cselect_b32 s17, 0x08888888, 0
    s_add_u32 s13, s13, s17
    s_bitcmp1_b32 s46, 3
    s_cselect_b32 s17, 0, 0x88888888
    s_add_u32 s16, s17, 0x76543210
    s_lshl_b32 s17, s16, 28
    s_or_b32 s14, s13, s17
    s_lshr_b32 s15, s16, 4
    buffer_load_dwordx2 v[82:83], v182, s[8:11], 0 offen sc0 sc1
    v_pk_mul_f32 v[10:11], v[132:133], v[232:233] op_sel:[0,1] op_sel_hi:[1,1] neg_lo:[0,1] neg_hi:[0,1]
    v_pk_mul_f32 v[12:13], v[116:117], v[232:233] op_sel:[0,1] op_sel_hi:[1,1]
    v_pk_fma_f32 v[116:117], v[116:117], v[232:233], v[10:11] op_sel:[0,0,0] op_sel_hi:[1,0,1]
    v_pk_fma_f32 v[132:133], v[132:133], v[232:233], v[12:13] op_sel:[0,0,0] op_sel_hi:[1,0,1]
    v_pk_mul_f32 v[10:11], v[134:135], v[232:233] op_sel:[0,1] op_sel_hi:[1,1] neg_lo:[0,1] neg_hi:[0,1]
    v_pk_mul_f32 v[12:13], v[118:119], v[232:233] op_sel:[0,1] op_sel_hi:[1,1]
    v_pk_fma_f32 v[118:119], v[118:119], v[232:233], v[10:11] op_sel:[0,0,0] op_sel_hi:[1,0,1]
    v_pk_fma_f32 v[134:135], v[134:135], v[232:233], v[12:13] op_sel:[0,0,0] op_sel_hi:[1,0,1]
    v_pk_mul_f32 v[10:11], v[136:137], v[232:233] op_sel:[0,1] op_sel_hi:[1,1] neg_lo:[0,1] neg_hi:[0,1]
    v_pk_mul_f32 v[12:13], v[120:121], v[232:233] op_sel:[0,1] op_sel_hi:[1,1]
    v_pk_fma_f32 v[120:121], v[120:121], v[232:233], v[10:11] op_sel:[0,0,0] op_sel_hi:[1,0,1]
    v_pk_fma_f32 v[136:137], v[136:137], v[232:233], v[12:13] op_sel:[0,0,0] op_sel_hi:[1,0,1]
    v_pk_mul_f32 v[10:11], v[138:139], v[232:233] op_sel:[0,1] op_sel_hi:[1,1] neg_lo:[0,1] neg_hi:[0,1]
    v_pk_mul_f32 v[12:13], v[122:123], v[232:233] op_sel:[0,1] op_sel_hi:[1,1]
    v_pk_fma_f32 v[122:123], v[122:123], v[232:233], v[10:11] op_sel:[0,0,0] op_sel_hi:[1,0,1]
    v_pk_fma_f32 v[138:139], v[138:139], v[232:233], v[12:13] op_sel:[0,0,0] op_sel_hi:[1,0,1]
    v_pk_mul_f32 v[10:11], v[140:141], v[232:233] op_sel:[0,1] op_sel_hi:[1,1] neg_lo:[0,1] neg_hi:[0,1]
    v_pk_mul_f32 v[12:13], v[124:125], v[232:233] op_sel:[0,1] op_sel_hi:[1,1]
    v_pk_fma_f32 v[124:125], v[124:125], v[232:233], v[10:11] op_sel:[0,0,0] op_sel_hi:[1,0,1]
    v_pk_fma_f32 v[140:141], v[140:141], v[232:233], v[12:13] op_sel:[0,0,0] op_sel_hi:[1,0,1]
    v_pk_mul_f32 v[10:11], v[142:143], v[232:233] op_sel:[0,1] op_sel_hi:[1,1] neg_lo:[0,1] neg_hi:[0,1]
    v_pk_mul_f32 v[12:13], v[126:127], v[232:233] op_sel:[0,1] op_sel_hi:[1,1]
    v_pk_fma_f32 v[126:127], v[126:127], v[232:233], v[10:11] op_sel:[0,0,0] op_sel_hi:[1,0,1]
    v_pk_fma_f32 v[142:143], v[142:143], v[232:233], v[12:13] op_sel:[0,0,0] op_sel_hi:[1,0,1]
    v_pk_mul_f32 v[10:11], v[144:145], v[232:233] op_sel:[0,1] op_sel_hi:[1,1] neg_lo:[0,1] neg_hi:[0,1]
    v_pk_mul_f32 v[12:13], v[128:129], v[232:233] op_sel:[0,1] op_sel_hi:[1,1]
    v_pk_fma_f32 v[128:129], v[128:129], v[232:233], v[10:11] op_sel:[0,0,0] op_sel_hi:[1,0,1]
    v_pk_fma_f32 v[144:145], v[144:145], v[232:233], v[12:13] op_sel:[0,0,0] op_sel_hi:[1,0,1]
    v_pk_mul_f32 v[10:11], v[146:147], v[232:233] op_sel:[0,1] op_sel_hi:[1,1] neg_lo:[0,1] neg_hi:[0,1]
    v_pk_mul_f32 v[12:13], v[130:131], v[232:233] op_sel:[0,1] op_sel_hi:[1,1]
    v_pk_fma_f32 v[130:131], v[130:131], v[232:233], v[10:11] op_sel:[0,0,0] op_sel_hi:[1,0,1]
    v_pk_fma_f32 v[146:147], v[146:147], v[232:233], v[12:13] op_sel:[0,0,0] op_sel_hi:[1,0,1]
    v_pk_mul_f32 v[10:11], v[164:165], v[232:233] op_sel:[0,1] op_sel_hi:[1,1] neg_lo:[0,1] neg_hi:[0,1]
    v_pk_mul_f32 v[12:13], v[148:149], v[232:233] op_sel:[0,1] op_sel_hi:[1,1]
    v_pk_fma_f32 v[148:149], v[148:149], v[232:233], v[10:11] op_sel:[0,0,0] op_sel_hi:[1,0,1]
    v_pk_fma_f32 v[164:165], v[164:165], v[232:233], v[12:13] op_sel:[0,0,0] op_sel_hi:[1,0,1]
    v_pk_mul_f32 v[10:11], v[166:167], v[232:233] op_sel:[0,1] op_sel_hi:[1,1] neg_lo:[0,1] neg_hi:[0,1]
    v_pk_mul_f32 v[12:13], v[150:151], v[232:233] op_sel:[0,1] op_sel_hi:[1,1]
    v_pk_fma_f32 v[150:151], v[150:151], v[232:233], v[10:11] op_sel:[0,0,0] op_sel_hi:[1,0,1]
    v_pk_fma_f32 v[166:167], v[166:167], v[232:233], v[12:13] op_sel:[0,0,0] op_sel_hi:[1,0,1]
    v_pk_mul_f32 v[10:11], v[168:169], v[232:233] op_sel:[0,1] op_sel_hi:[1,1] neg_lo:[0,1] neg_hi:[0,1]
    v_pk_mul_f32 v[12:13], v[152:153], v[232:233] op_sel:[0,1] op_sel_hi:[1,1]
    v_pk_fma_f32 v[152:153], v[152:153], v[232:233], v[10:11] op_sel:[0,0,0] op_sel_hi:[1,0,1]
    v_pk_fma_f32 v[168:169], v[168:169], v[232:233], v[12:13] op_sel:[0,0,0] op_sel_hi:[1,0,1]
    v_pk_mul_f32 v[10:11], v[170:171], v[232:233] op_sel:[0,1] op_sel_hi:[1,1] neg_lo:[0,1] neg_hi:[0,1]
    v_pk_mul_f32 v[12:13], v[154:155], v[232:233] op_sel:[0,1] op_sel_hi:[1,1]
    v_pk_fma_f32 v[154:155], v[154:155], v[232:233], v[10:11] op_sel:[0,0,0] op_sel_hi:[1,0,1]
    v_pk_fma_f32 v[170:171], v[170:171], v[232:233], v[12:13] op_sel:[0,0,0] op_sel_hi:[1,0,1]
    v_pk_mul_f32 v[10:11], v[172:173], v[232:233] op_sel:[0,1] op_sel_hi:[1,1] neg_lo:[0,1] neg_hi:[0,1]
    v_pk_mul_f32 v[12:13], v[156:157], v[232:233] op_sel:[0,1] op_sel_hi:[1,1]
    v_pk_fma_f32 v[156:157], v[156:157], v[232:233], v[10:11] op_sel:[0,0,0] op_sel_hi:[1,0,1]
    v_pk_fma_f32 v[172:173], v[172:173], v[232:233], v[12:13] op_sel:[0,0,0] op_sel_hi:[1,0,1]
    v_pk_mul_f32 v[10:11], v[174:175], v[232:233] op_sel:[0,1] op_sel_hi:[1,1] neg_lo:[0,1] neg_hi:[0,1]
    v_pk_mul_f32 v[12:13], v[158:159], v[232:233] op_sel:[0,1] op_sel_hi:[1,1]
    v_pk_fma_f32 v[158:159], v[158:159], v[232:233], v[10:11] op_sel:[0,0,0] op_sel_hi:[1,0,1]
    v_pk_fma_f32 v[174:175], v[174:175], v[232:233], v[12:13] op_sel:[0,0,0] op_sel_hi:[1,0,1]
    v_pk_mul_f32 v[10:11], v[176:177], v[232:233] op_sel:[0,1] op_sel_hi:[1,1] neg_lo:[0,1] neg_hi:[0,1]
    v_pk_mul_f32 v[12:13], v[160:161], v[232:233] op_sel:[0,1] op_sel_hi:[1,1]
    v_pk_fma_f32 v[160:161], v[160:161], v[232:233], v[10:11] op_sel:[0,0,0] op_sel_hi:[1,0,1]
    v_pk_fma_f32 v[176:177], v[176:177], v[232:233], v[12:13] op_sel:[0,0,0] op_sel_hi:[1,0,1]
    v_pk_mul_f32 v[10:11], v[178:179], v[232:233] op_sel:[0,1] op_sel_hi:[1,1] neg_lo:[0,1] neg_hi:[0,1]
    v_pk_mul_f32 v[12:13], v[162:163], v[232:233] op_sel:[0,1] op_sel_hi:[1,1]
    v_pk_fma_f32 v[162:163], v[162:163], v[232:233], v[10:11] op_sel:[0,0,0] op_sel_hi:[1,0,1]
    v_pk_fma_f32 v[178:179], v[178:179], v[232:233], v[12:13] op_sel:[0,0,0] op_sel_hi:[1,0,1]
    s_mov_b32 s13, 0
    s_waitcnt vmcnt(0)
    v_cmp_ne_u64 vcc, s[42:43], v[82:83]
    s_nop 4
    s_cbranch_vccz Lfdone_gate_5
Lfpoll_gate_6:
    buffer_load_dwordx2 v[82:83], v182, s[8:11], 0 offen sc0 sc1
    s_waitcnt vmcnt(0)
    v_cmp_ne_u64 vcc, s[42:43], v[82:83]
    s_nop 4
    s_add_u32 s13, s13, 1
    s_cmp_gt_u32 s13, 20000
    s_cbranch_scc1 Lfdone_gate_5
    s_cbranch_vccnz Lfpoll_gate_6
Lfdone_gate_5:
    s_mov_b32 m0, s29
    s_nop 0
    buffer_load_dwordx4 v207, s[8:11], s28 offen offset:0 sc0 sc1 lds
    buffer_load_dwordx4 v207, s[8:11], s28 offen offset:1024 sc0 sc1 lds
    buffer_load_dwordx4 v207, s[8:11], s28 offen offset:2048 sc0 sc1 lds
    buffer_load_dwordx4 v207, s[8:11], s28 offen offset:3072 sc0 sc1 lds
    s_lshr_b32 s16, s44, 1
    v_lshrrev_b32 v53, 5, v2
    v_lshlrev_b32 v53, 13, v53
    v_lshl_add_u32 v9, v7, 2, v53
    s_lshl_b32 s3, s16, 14
    s_add_u32 s3, s3, 0
    v_add_u32 v9, s3, v9
    v_lshrrev_b32 v53, 4, v2
    v_lshlrev_b32 v53, 4, v53
    v_bfe_u32 v54, v2, 3, 1
    v_add_u32 v53, v53, v54
    v_and_b32 v21, 7, v2
    v_xor_b32 v54, v54, v21
    s_and_b32 s3, s44, 1
    s_lshl_b32 s3, s3, 3
    v_or_b32 v54, s3, v54
    v_lshlrev_b32 v54, 4, v54
    v_lshl_add_u32 v20, v53, 8, v54
    s_lshl_b32 s3, s16, 14
    s_add_u32 s3, s3, 0
    v_add_u32 v20, s3, v20
    v_lshlrev_b32 v21, 4, v21
    v_lshl_add_u32 v21, v53, 12, v21
    s_lshl_b32 s13, s45, 19
    s_lshl_b32 s3, s16, 18
    s_add_u32 s13, s13, s3
    s_lshl_b32 s3, s46, 8
    s_add_u32 s13, s13, s3
    s_and_b32 s3, s44, 1
    s_lshl_b32 s3, s3, 7
    s_add_u32 s13, s13, s3
    buffer_load_dwordx2 v[4:5], v3, s[8:11], 0 offen sc0 sc1
    v_mov_b32 v18, 0
    ds_write_b128 v51, v[38:41] offset:0
    v_alignbit_b32 v42, v39, v38, 16
    v_alignbit_b32 v43, v40, v39, 16
    v_mov_b32_dpp v18, v38 wave_shl:1 row_mask:0xf bank_mask:0xf
    v_alignbit_b32 v44, v41, v40, 16
    v_alignbit_b32 v45, v18, v41, 16
    ds_write_b128 v51, v[42:45] offset:4160
    v_readfirstlane_b32 s3, v26
    s_nop 1
    v_mov_b32 v19, s3
    ds_write_b128 v51, v[22:25] offset:32
    v_alignbit_b32 v46, v23, v22, 16
    v_alignbit_b32 v47, v24, v23, 16
    v_mov_b32_dpp v19, v22 wave_shl:1 row_mask:0xf bank_mask:0xf
    v_alignbit_b32 v48, v25, v24, 16
    v_alignbit_b32 v49, v19, v25, 16
    ds_write_b128 v51, v[46:49] offset:4192
    v_readfirstlane_b32 s3, v30
    s_nop 1
    v_mov_b32 v18, s3
    ds_write_b128 v51, v[26:29] offset:1056
    v_alignbit_b32 v42, v27, v26, 16
    v_alignbit_b32 v43, v28, v27, 16
    v_mov_b32_dpp v18, v26 wave_shl:1 row_mask:0xf bank_mask:0xf
    v_alignbit_b32 v44, v29, v28, 16
    v_alignbit_b32 v45, v18, v29, 16
    ds_write_b128 v51, v[42:45] offset:5216
    v_subrev_u32 v66, 0, v8
    v_min_u32 v66, 0x7fff0000, v66
    buffer_load_dwordx4 v[66:69], v66, s[48:51], 0 offen sc0 sc1
    v_subrev_u32 v70, 2048, v8
    v_min_u32 v70, 0x7fff0000, v70
    buffer_load_dwordx4 v[70:73], v70, s[48:51], 0 offen sc0 sc1
    v_subrev_u32 v74, 4096, v8
    v_min_u32 v74, 0x7fff0000, v74
    buffer_load_dwordx4 v[74:77], v74, s[48:51], 0 offen sc0 sc1
    v_subrev_u32 v78, 6144, v8
    v_min_u32 v78, 0x7fff0000, v78
    buffer_load_dwordx4 v[78:81], v78, s[48:51], 0 offen sc0 sc1
    v_subrev_u32 v88, 8192, v8
    v_min_u32 v88, 0x7fff0000, v88
    buffer_load_dwordx4 v[88:91], v88, s[48:51], 0 offen sc0 sc1
    v_subrev_u32 v92, 10240, v8
    v_min_u32 v92, 0x7fff0000, v92
    buffer_load_dwordx4 v[92:95], v92, s[48:51], 0 offen sc0 sc1
    v_subrev_u32 v96, 12288, v8
    v_min_u32 v96, 0x7fff0000, v96
    buffer_load_dwordx4 v[96:99], v96, s[48:51], 0 offen sc0 sc1
    v_subrev_u32 v100, 14336, v8
    v_min_u32 v100, 0x7fff0000, v100
    buffer_load_dwordx4 v[100:103], v100, s[48:51], 0 offen sc0 sc1
    v_readfirstlane_b32 s3, v34
    s_nop 1
    v_mov_b32 v19, s3
    ds_write_b128 v51, v[30:33] offset:2080
    v_alignbit_b32 v46, v31, v30, 16
    v_alignbit_b32 v47, v32, v31, 16
    v_mov_b32_dpp v19, v30 wave_shl:1 row_mask:0xf bank_mask:0xf
    v_alignbit_b32 v48, v33, v32, 16
    v_alignbit_b32 v49, v19, v33, 16
    ds_write_b128 v51, v[46:49] offset:6240
    v_mov_b32 v18, 0
    ds_write_b128 v51, v[34:37] offset:3104
    v_alignbit_b32 v42, v35, v34, 16
    v_alignbit_b32 v43, v36, v35, 16
    v_mov_b32_dpp v18, v34 wave_shl:1 row_mask:0xf bank_mask:0xf
    v_alignbit_b32 v44, v37, v36, 16
    v_alignbit_b32 v45, v18, v37, 16
    ds_write_b128 v51, v[42:45] offset:7264
    v_lshlrev_b32 v183, 16, v183
    s_mov_b32 s16, 0
    v_mov_b32 v18, 0
    s_waitcnt vmcnt(7)
    v_cmp_eq_u64 s[60:61], s[42:43], v[68:69]
    s_waitcnt vmcnt(6)
    v_cmp_eq_u64 s[62:63], s[42:43], v[72:73]
    s_waitcnt vmcnt(5)
    v_cmp_eq_u64 s[64:65], s[42:43], v[76:77]
    s_waitcnt vmcnt(4)
    v_cmp_eq_u64 s[66:67], s[42:43], v[80:81]
    v_addc_co_u32 v18, vcc, 0, v18, s[60:61]
    v_addc_co_u32 v18, vcc, 0, v18, s[62:63]
    v_addc_co_u32 v18, vcc, 0, v18, s[64:65]
    v_addc_co_u32 v18, vcc, 0, v18, s[66:67]
    s_waitcnt vmcnt(3)
    v_cmp_eq_u64 s[60:61], s[42:43], v[90:91]
    s_waitcnt vmcnt(2)
    v_cmp_eq_u64 s[62:63], s[42:43], v[94:95]
    s_waitcnt vmcnt(1)
    v_cmp_eq_u64 s[64:65], s[42:43], v[98:99]
    s_waitcnt vmcnt(0)
    v_cmp_eq_u64 s[66:67], s[42:43], v[102:103]
    v_addc_co_u32 v18, vcc, 0, v18, s[60:61]
    v_addc_co_u32 v18, vcc, 0, v18, s[62:63]
    v_addc_co_u32 v18, vcc, 0, v18, s[64:65]
    v_addc_co_u32 v18, vcc, 0, v18, s[66:67]
    v_cmp_ne_u32 vcc, v16, v18
    s_nop 4
    s_cbranch_vccz Lpolldone_gate_7
Lpoll_gate_8:
    v_subrev_u32 v66, 0, v8
    v_min_u32 v66, 0x7fff0000, v66
    buffer_load_dwordx4 v[66:69], v66, s[48:51], 0 offen sc0 sc1
    v_subrev_u32 v70, 2048, v8
    v_min_u32 v70, 0x7fff0000, v70
    buffer_load_dwordx4 v[70:73], v70, s[48:51], 0 offen sc0 sc1
    v_subrev_u32 v74, 4096, v8
    v_min_u32 v74, 0x7fff0000, v74
    buffer_load_dwordx4 v[74:77], v74, s[48:51], 0 offen sc0 sc1
    v_subrev_u32 v78, 6144, v8
    v_min_u32 v78, 0x7fff0000, v78
    buffer_load_dwordx4 v[78:81], v78, s[48:51], 0 offen sc0 sc1
    v_subrev_u32 v88, 8192, v8
    v_min_u32 v88, 0x7fff0000, v88
    buffer_load_dwordx4 v[88:91], v88, s[48:51], 0 offen sc0 sc1
    v_subrev_u32 v92, 10240, v8
    v_min_u32 v92, 0x7fff0000, v92
    buffer_load_dwordx4 v[92:95], v92, s[48:51], 0 offen sc0 sc1
    v_subrev_u32 v96, 12288, v8
    v_min_u32 v96, 0x7fff0000, v96
    buffer_load_dwordx4 v[96:99], v96, s[48:51], 0 offen sc0 sc1
    v_subrev_u32 v100, 14336, v8
    v_min_u32 v100, 0x7fff0000, v100
    buffer_load_dwordx4 v[100:103], v100, s[48:51], 0 offen sc0 sc1
    s_waitcnt vmcnt(0) lgkmcnt(0)
    v_mov_b32 v18, 0
    v_cmp_eq_u64 s[60:61], s[42:43], v[68:69]
    v_cmp_eq_u64 s[62:63], s[42:43], v[72:73]
    v_cmp_eq_u64 s[64:65], s[42:43], v[76:77]
    v_cmp_eq_u64 s[66:67], s[42:43], v[80:81]
    v_addc_co_u32 v18, vcc, 0, v18, s[60:61]
    v_addc_co_u32 v18, vcc, 0, v18, s[62:63]
    v_addc_co_u32 v18, vcc, 0, v18, s[64:65]
    v_addc_co_u32 v18, vcc, 0, v18, s[66:67]
    v_cmp_eq_u64 s[60:61], s[42:43], v[90:91]
    v_cmp_eq_u64 s[62:63], s[42:43], v[94:95]
    v_cmp_eq_u64 s[64:65], s[42:43], v[98:99]
    v_cmp_eq_u64 s[66:67], s[42:43], v[102:103]
    v_addc_co_u32 v18, vcc, 0, v18, s[60:61]
    v_addc_co_u32 v18, vcc, 0, v18, s[62:63]
    v_addc_co_u32 v18, vcc, 0, v18, s[64:65]
    v_addc_co_u32 v18, vcc, 0, v18, s[66:67]
    v_cmp_ne_u32 vcc, v16, v18
    s_add_u32 s16, s16, 1
    s_cmp_gt_u32 s16, 20000
    s_cbranch_scc1 Lpolldone_gate_7
    s_nop 1
    s_cbranch_vccnz Lpoll_gate_8
Lpolldone_gate_7:
    s_nop 4
    v_fma_f32 v22, -v15, v101, v96
    v_fma_f32 v23, v15, v100, v97
    v_fma_f32 v96, v14, v100, v22
    v_fma_f32 v97, v14, v101, v23
    v_fma_f32 v22, -v15, v97, v92
    v_fma_f32 v23, v15, v96, v93
    v_fma_f32 v92, v14, v96, v22
    v_fma_f32 v93, v14, v97, v23
    v_fma_f32 v22, -v15, v93, v88
    v_fma_f32 v23, v15, v92, v89
    v_fma_f32 v88, v14, v92, v22
    v_fma_f32 v89, v14, v93, v23
    v_fma_f32 v22, -v15, v89, v78
    v_fma_f32 v23, v15, v88, v79
    v_fma_f32 v78, v14, v88, v22
    v_fma_f32 v79, v14, v89, v23
    v_fma_f32 v22, -v15, v79, v74
    v_fma_f32 v23, v15, v78, v75
    v_fma_f32 v74, v14, v78, v22
    v_fma_f32 v75, v14, v79, v23
    v_fma_f32 v22, -v15, v75, v70
    v_fma_f32 v23, v15, v74, v71
    v_fma_f32 v70, v14, v74, v22
    v_fma_f32 v71, v14, v75, v23
    v_fma_f32 v22, -v15, v71, v66
    v_fma_f32 v23, v15, v70, v67
    v_fma_f32 v66, v14, v70, v22
    v_fma_f32 v67, v14, v71, v23
    v_mov_b32 v70, v66
    v_mov_b32 v71, v67
    s_nop 0
    v_permlane32_swap_b32 v66, v70
    v_permlane32_swap_b32 v67, v71
    v_fma_f32 v22, -v237, v71, v66
    v_fma_f32 v23, v237, v70, v67
    v_fma_f32 v24, v236, v70, v22
    v_fma_f32 v25, v236, v71, v23
    s_mov_b32 s4, 0
    v_cmp_ne_u64 vcc, s[42:43], v[4:5]
    s_nop 4
    s_cbranch_vccz Lfdone_gate_9
Lfpoll_gate_10:
    buffer_load_dwordx2 v[4:5], v3, s[8:11], 0 offen sc0 sc1
    s_waitcnt vmcnt(0)
    v_cmp_ne_u64 vcc, s[42:43], v[4:5]
    s_nop 4
    s_add_u32 s4, s4, 1
    s_cmp_gt_u32 s4, 20000
    s_cbranch_scc1 Lfdone_gate_9
    s_cbranch_vccnz Lfpoll_gate_10
Lfdone_gate_9:
    v_pk_fma_f32 v[10:11], v[240:241], v[24:25], v[84:85] op_sel:[0,1,0] op_sel_hi:[1,1,1] neg_lo:[0,1,0] neg_hi:[0,1,0]
    v_pk_fma_f32 v[12:13], v[238:239], v[24:25], v[86:87] op_sel:[0,1,0] op_sel_hi:[1,1,1]
    v_pk_fma_f32 v[4:5], v[238:239], v[24:25], v[10:11] op_sel:[0,0,0] op_sel_hi:[1,0,1]
    v_pk_fma_f32 v[14:15], v[240:241], v[24:25], v[12:13] op_sel:[0,0,0] op_sel_hi:[1,0,1]
    v_pk_mul_f32 v[10:11], v[14:15], v[232:233] op_sel:[0,1] op_sel_hi:[1,1] neg_lo:[0,1] neg_hi:[0,1]
    v_pk_mul_f32 v[12:13], v[4:5], v[232:233] op_sel:[0,1] op_sel_hi:[1,1]
    v_pk_fma_f32 v[4:5], v[4:5], v[232:233], v[10:11] op_sel:[0,0,0] op_sel_hi:[1,0,1]
    v_pk_fma_f32 v[14:15], v[14:15], v[232:233], v[12:13] op_sel:[0,0,0] op_sel_hi:[1,0,1]
    v_pk_fma_f32 v[10:11], v[14:15], v[230:231], v[116:117] op_sel:[0,1,0] op_sel_hi:[1,1,1] neg_lo:[0,1,0] neg_hi:[0,1,0]
    v_pk_fma_f32 v[12:13], v[4:5], v[230:231], v[132:133] op_sel:[0,1,0] op_sel_hi:[1,1,1]
    v_pk_fma_f32 v[116:117], v[4:5], v[230:231], v[10:11] op_sel:[0,0,0] op_sel_hi:[1,0,1]
    v_pk_fma_f32 v[132:133], v[14:15], v[230:231], v[12:13] op_sel:[0,0,0] op_sel_hi:[1,0,1]
    s_add_u32 s12, s6, s7
    buffer_load_dwordx4 a[0:3], v17, s[8:11], s12 offen offset:0 sc0 sc1
    v_pk_fma_f32 v[10:11], v[132:133], v[230:231], v[118:119] op_sel:[0,1,0] op_sel_hi:[1,1,1] neg_lo:[0,1,0] neg_hi:[0,1,0]
    v_pk_fma_f32 v[12:13], v[116:117], v[230:231], v[134:135] op_sel:[0,1,0] op_sel_hi:[1,1,1]
    v_pk_fma_f32 v[118:119], v[116:117], v[230:231], v[10:11] op_sel:[0,0,0] op_sel_hi:[1,0,1]
    v_pk_fma_f32 v[134:135], v[132:133], v[230:231], v[12:13] op_sel:[0,0,0] op_sel_hi:[1,0,1]
    v_cvt_pk_bf16_f32 v18, v116, -v132
    v_cvt_pk_bf16_f32 v19, v117, -v133
    ds_write2st64_b32 v9, v18, v19 offset0:0 offset1:16
    buffer_load_dwordx4 a[4:7], v17, s[8:11], s12 offen offset:1024 sc0 sc1
    v_pk_fma_f32 v[10:11], v[134:135], v[230:231], v[120:121] op_sel:[0,1,0] op_sel_hi:[1,1,1] neg_lo:[0,1,0] neg_hi:[0,1,0]
    v_pk_fma_f32 v[12:13], v[118:119], v[230:231], v[136:137] op_sel:[0,1,0] op_sel_hi:[1,1,1]
    v_pk_fma_f32 v[120:121], v[118:119], v[230:231], v[10:11] op_sel:[0,0,0] op_sel_hi:[1,0,1]
    v_pk_fma_f32 v[136:137], v[134:135], v[230:231], v[12:13] op_sel:[0,0,0] op_sel_hi:[1,0,1]
    v_xor_b32 v3, 16, v9
    v_cvt_pk_bf16_f32 v22, v118, -v134
    v_cvt_pk_bf16_f32 v23, v119, -v135
    ds_write2st64_b32 v3, v22, v23 offset0:1 offset1:17
    ds_read_b128 v[28:31], v20 offset:0
    buffer_load_dwordx4 a[8:11], v17, s[8:11], s12 offen offset:2048 sc0 sc1
    v_pk_fma_f32 v[10:11], v[136:137], v[230:231], v[122:123] op_sel:[0,1,0] op_sel_hi:[1,1,1] neg_lo:[0,1,0] neg_hi:[0,1,0]
    v_pk_fma_f32 v[12:13], v[120:121], v[230:231], v[138:139] op_sel:[0,1,0] op_sel_hi:[1,1,1]
    v_pk_fma_f32 v[122:123], v[120:121], v[230:231], v[10:11] op_sel:[0,0,0] op_sel_hi:[1,0,1]
    v_pk_fma_f32 v[138:139], v[136:137], v[230:231], v[12:13] op_sel:[0,0,0] op_sel_hi:[1,0,1]
    v_xor_b32 v1, 32, v9
    v_cvt_pk_bf16_f32 v18, v120, -v136
    v_cvt_pk_bf16_f32 v19, v121, -v137
    ds_write2st64_b32 v1, v18, v19 offset0:2 offset1:18
    s_waitcnt lgkmcnt(1)
    buffer_store_dwordx4 v[28:31], v21, s[8:11], s13 offen sc0 sc1
    buffer_load_dwordx4 a[12:15], v17, s[8:11], s12 offen offset:3072 sc0 sc1
    v_pk_fma_f32 v[10:11], v[138:139], v[230:231], v[124:125] op_sel:[0,1,0] op_sel_hi:[1,1,1] neg_lo:[0,1,0] neg_hi:[0,1,0]
    v_pk_fma_f32 v[12:13], v[122:123], v[230:231], v[140:141] op_sel:[0,1,0] op_sel_hi:[1,1,1]
    v_pk_fma_f32 v[124:125], v[122:123], v[230:231], v[10:11] op_sel:[0,0,0] op_sel_hi:[1,0,1]
    v_pk_fma_f32 v[140:141], v[138:139], v[230:231], v[12:13] op_sel:[0,0,0] op_sel_hi:[1,0,1]
    v_xor_b32 v3, 48, v9
    v_cvt_pk_bf16_f32 v22, v122, -v138
    v_cvt_pk_bf16_f32 v23, v123, -v139
    ds_write2st64_b32 v3, v22, v23 offset0:3 offset1:19
    v_xor_b32 v8, 32, v20
    ds_read_b128 v[32:35], v8 offset:512
    s_bfe_u32 s7, s14, 0x40000
    s_lshl_b32 s7, s7, 12
    s_add_u32 s12, s6, s7
    buffer_load_dwordx4 a[16:19], v17, s[8:11], s12 offen offset:0 sc0 sc1
    v_pk_fma_f32 v[10:11], v[140:141], v[230:231], v[126:127] op_sel:[0,1,0] op_sel_hi:[1,1,1] neg_lo:[0,1,0] neg_hi:[0,1,0]
    v_pk_fma_f32 v[12:13], v[124:125], v[230:231], v[142:143] op_sel:[0,1,0] op_sel_hi:[1,1,1]
    v_pk_fma_f32 v[126:127], v[124:125], v[230:231], v[10:11] op_sel:[0,0,0] op_sel_hi:[1,0,1]
    v_pk_fma_f32 v[142:143], v[140:141], v[230:231], v[12:13] op_sel:[0,0,0] op_sel_hi:[1,0,1]
    v_xor_b32 v1, 64, v9
    v_cvt_pk_bf16_f32 v18, v124, -v140
    v_cvt_pk_bf16_f32 v19, v125, -v141
    ds_write2st64_b32 v1, v18, v19 offset0:4 offset1:20
    s_add_u32 s13, s13, 8192
    s_waitcnt lgkmcnt(1)
    buffer_store_dwordx4 v[32:35], v21, s[8:11], s13 offen sc0 sc1
    buffer_load_dwordx4 a[20:23], v17, s[8:11], s12 offen offset:1024 sc0 sc1
    v_pk_fma_f32 v[10:11], v[142:143], v[230:231], v[128:129] op_sel:[0,1,0] op_sel_hi:[1,1,1] neg_lo:[0,1,0] neg_hi:[0,1,0]
    v_pk_fma_f32 v[12:13], v[126:127], v[230:231], v[144:145] op_sel:[0,1,0] op_sel_hi:[1,1,1]
    v_pk_fma_f32 v[128:129], v[126:127], v[230:231], v[10:11] op_sel:[0,0,0] op_sel_hi:[1,0,1]
    v_pk_fma_f32 v[144:145], v[142:143], v[230:231], v[12:13] op_sel:[0,0,0] op_sel_hi:[1,0,1]
    v_xor_b32 v3, 80, v9
    v_cvt_pk_bf16_f32 v22, v126, -v142
    v_cvt_pk_bf16_f32 v23, v127, -v143
    ds_write2st64_b32 v3, v22, v23 offset0:5 offset1:21
    v_xor_b32 v8, 64, v20
    ds_read_b128 v[28:31], v8 offset:1024
    buffer_load_dwordx4 a[24:27], v17, s[8:11], s12 offen offset:2048 sc0 sc1
    v_pk_fma_f32 v[10:11], v[144:145], v[230:231], v[130:131] op_sel:[0,1,0] op_sel_hi:[1,1,1] neg_lo:[0,1,0] neg_hi:[0,1,0]
    v_pk_fma_f32 v[12:13], v[128:129], v[230:231], v[146:147] op_sel:[0,1,0] op_sel_hi:[1,1,1]
    v_pk_fma_f32 v[130:131], v[128:129], v[230:231], v[10:11] op_sel:[0,0,0] op_sel_hi:[1,0,1]
    v_pk_fma_f32 v[146:147], v[144:145], v[230:231], v[12:13] op_sel:[0,0,0] op_sel_hi:[1,0,1]
    v_xor_b32 v1, 96, v9
    v_cvt_pk_bf16_f32 v18, v128, -v144
    v_cvt_pk_bf16_f32 v19, v129, -v145
    ds_write2st64_b32 v1, v18, v19 offset0:6 offset1:22
    s_add_u32 s13, s13, 8192
    s_waitcnt lgkmcnt(1)
    buffer_store_dwordx4 v[28:31], v21, s[8:11], s13 offen sc0 sc1
    buffer_load_dwordx4 a[28:31], v17, s[8:11], s12 offen offset:3072 sc0 sc1
    v_pk_fma_f32 v[10:11], v[146:147], v[230:231], v[148:149] op_sel:[0,1,0] op_sel_hi:[1,1,1] neg_lo:[0,1,0] neg_hi:[0,1,0]
    v_pk_fma_f32 v[12:13], v[130:131], v[230:231], v[164:165] op_sel:[0,1,0] op_sel_hi:[1,1,1]
    v_pk_fma_f32 v[148:149], v[130:131], v[230:231], v[10:11] op_sel:[0,0,0] op_sel_hi:[1,0,1]
    v_pk_fma_f32 v[164:165], v[146:147], v[230:231], v[12:13] op_sel:[0,0,0] op_sel_hi:[1,0,1]
    v_xor_b32 v3, 112, v9
    v_cvt_pk_bf16_f32 v22, v130, -v146
    v_cvt_pk_bf16_f32 v23, v131, -v147
    ds_write2st64_b32 v3, v22, v23 offset0:7 offset1:23
    v_xor_b32 v8, 96, v20
    ds_read_b128 v[32:35], v8 offset:1536
    v_pk_fma_f32 v[10:11], v[164:165], v[230:231], v[150:151] op_sel:[0,1,0] op_sel_hi:[1,1,1] neg_lo:[0,1,0] neg_hi:[0,1,0]
    v_pk_fma_f32 v[12:13], v[148:149], v[230:231], v[166:167] op_sel:[0,1,0] op_sel_hi:[1,1,1]
    v_pk_fma_f32 v[150:151], v[148:149], v[230:231], v[10:11] op_sel:[0,0,0] op_sel_hi:[1,0,1]
    v_pk_fma_f32 v[166:167], v[164:165], v[230:231], v[12:13] op_sel:[0,0,0] op_sel_hi:[1,0,1]
    v_xor_b32 v1, 128, v9
    v_cvt_pk_bf16_f32 v18, v148, -v164
    v_cvt_pk_bf16_f32 v19, v149, -v165
    ds_write2st64_b32 v1, v18, v19 offset0:8 offset1:24
    s_add_u32 s13, s13, 8192
    s_waitcnt lgkmcnt(1)
    buffer_store_dwordx4 v[32:35], v21, s[8:11], s13 offen sc0 sc1
    v_pk_fma_f32 v[10:11], v[166:167], v[230:231], v[152:153] op_sel:[0,1,0] op_sel_hi:[1,1,1] neg_lo:[0,1,0] neg_hi:[0,1,0]
    v_pk_fma_f32 v[12:13], v[150:151], v[230:231], v[168:169] op_sel:[0,1,0] op_sel_hi:[1,1,1]
    v_pk_fma_f32 v[152:153], v[150:151], v[230:231], v[10:11] op_sel:[0,0,0] op_sel_hi:[1,0,1]
    v_pk_fma_f32 v[168:169], v[166:167], v[230:231], v[12:13] op_sel:[0,0,0] op_sel_hi:[1,0,1]
    v_xor_b32 v3, 144, v9
    v_cvt_pk_bf16_f32 v22, v150, -v166
    v_cvt_pk_bf16_f32 v23, v151, -v167
    ds_write2st64_b32 v3, v22, v23 offset0:9 offset1:25
    v_xor_b32 v8, 128, v20
    ds_read_b128 v[28:31], v8 offset:2048
    v_pk_fma_f32 v[10:11], v[168:169], v[230:231], v[154:155] op_sel:[0,1,0] op_sel_hi:[1,1,1] neg_lo:[0,1,0] neg_hi:[0,1,0]
    v_pk_fma_f32 v[12:13], v[152:153], v[230:231], v[170:171] op_sel:[0,1,0] op_sel_hi:[1,1,1]
    v_pk_fma_f32 v[154:155], v[152:153], v[230:231], v[10:11] op_sel:[0,0,0] op_sel_hi:[1,0,1]
    v_pk_fma_f32 v[170:171], v[168:169], v[230:231], v[12:13] op_sel:[0,0,0] op_sel_hi:[1,0,1]
    v_xor_b32 v1, 160, v9
    v_cvt_pk_bf16_f32 v18, v152, -v168
    v_cvt_pk_bf16_f32 v19, v153, -v169
    ds_write2st64_b32 v1, v18, v19 offset0:10 offset1:26
    s_add_u32 s13, s13, 8192
    s_waitcnt lgkmcnt(1)
    buffer_store_dwordx4 v[28:31], v21, s[8:11], s13 offen sc0 sc1
    v_pk_fma_f32 v[10:11], v[170:171], v[230:231], v[156:157] op_sel:[0,1,0] op_sel_hi:[1,1,1] neg_lo:[0,1,0] neg_hi:[0,1,0]
    v_pk_fma_f32 v[12:13], v[154:155], v[230:231], v[172:173] op_sel:[0,1,0] op_sel_hi:[1,1,1]
    v_pk_fma_f32 v[156:157], v[154:155], v[230:231], v[10:11] op_sel:[0,0,0] op_sel_hi:[1,0,1]
    v_pk_fma_f32 v[172:173], v[170:171], v[230:231], v[12:13] op_sel:[0,0,0] op_sel_hi:[1,0,1]
    v_xor_b32 v3, 176, v9
    v_cvt_pk_bf16_f32 v22, v154, -v170
    v_cvt_pk_bf16_f32 v23, v155, -v171
    ds_write2st64_b32 v3, v22, v23 offset0:11 offset1:27
    v_xor_b32 v8, 160, v20
    ds_read_b128 v[32:35], v8 offset:2560
    v_pk_fma_f32 v[10:11], v[172:173], v[230:231], v[158:159] op_sel:[0,1,0] op_sel_hi:[1,1,1] neg_lo:[0,1,0] neg_hi:[0,1,0]
    v_pk_fma_f32 v[12:13], v[156:157], v[230:231], v[174:175] op_sel:[0,1,0] op_sel_hi:[1,1,1]
    v_pk_fma_f32 v[158:159], v[156:157], v[230:231], v[10:11] op_sel:[0,0,0] op_sel_hi:[1,0,1]
    v_pk_fma_f32 v[174:175], v[172:173], v[230:231], v[12:13] op_sel:[0,0,0] op_sel_hi:[1,0,1]
    v_xor_b32 v1, 192, v9
    v_cvt_pk_bf16_f32 v18, v156, -v172
    v_cvt_pk_bf16_f32 v19, v157, -v173
    ds_write2st64_b32 v1, v18, v19 offset0:12 offset1:28
    s_add_u32 s13, s13, 8192
    s_waitcnt lgkmcnt(1)
    buffer_store_dwordx4 v[32:35], v21, s[8:11], s13 offen sc0 sc1
    v_pk_fma_f32 v[10:11], v[174:175], v[230:231], v[160:161] op_sel:[0,1,0] op_sel_hi:[1,1,1] neg_lo:[0,1,0] neg_hi:[0,1,0]
    v_pk_fma_f32 v[12:13], v[158:159], v[230:231], v[176:177] op_sel:[0,1,0] op_sel_hi:[1,1,1]
    v_pk_fma_f32 v[160:161], v[158:159], v[230:231], v[10:11] op_sel:[0,0,0] op_sel_hi:[1,0,1]
    v_pk_fma_f32 v[176:177], v[174:175], v[230:231], v[12:13] op_sel:[0,0,0] op_sel_hi:[1,0,1]
    v_xor_b32 v3, 208, v9
    v_cvt_pk_bf16_f32 v22, v158, -v174
    v_cvt_pk_bf16_f32 v23, v159, -v175
    ds_write2st64_b32 v3, v22, v23 offset0:13 offset1:29
    v_xor_b32 v8, 192, v20
    ds_read_b128 v[28:31], v8 offset:3072
    v_pk_fma_f32 v[10:11], v[176:177], v[230:231], v[162:163] op_sel:[0,1,0] op_sel_hi:[1,1,1] neg_lo:[0,1,0] neg_hi:[0,1,0]
    v_pk_fma_f32 v[12:13], v[160:161], v[230:231], v[178:179] op_sel:[0,1,0] op_sel_hi:[1,1,1]
    v_pk_fma_f32 v[162:163], v[160:161], v[230:231], v[10:11] op_sel:[0,0,0] op_sel_hi:[1,0,1]
    v_pk_fma_f32 v[178:179], v[176:177], v[230:231], v[12:13] op_sel:[0,0,0] op_sel_hi:[1,0,1]
    v_xor_b32 v1, 224, v9
    v_cvt_pk_bf16_f32 v18, v160, -v176
    v_cvt_pk_bf16_f32 v19, v161, -v177
    ds_write2st64_b32 v1, v18, v19 offset0:14 offset1:30
    s_add_u32 s13, s13, 8192
    s_waitcnt lgkmcnt(1)
    buffer_store_dwordx4 v[28:31], v21, s[8:11], s13 offen sc0 sc1
    v_xor_b32 v3, 240, v9
    v_cvt_pk_bf16_f32 v22, v162, -v178
    v_cvt_pk_bf16_f32 v23, v163, -v179
    ds_write2st64_b32 v3, v22, v23 offset0:15 offset1:31
    v_xor_b32 v8, 224, v20
    ds_read_b128 v[32:35], v8 offset:3584
    s_add_u32 s13, s13, 8192
    s_waitcnt lgkmcnt(0)
    buffer_store_dwordx4 v[32:35], v21, s[8:11], s13 offen sc0 sc1
    s_barrier
    ds_read2_b32 v[96:97], v57 offset0:112 offset1:113
    ds_read2_b32 v[98:99], v57 offset0:114 offset1:115
    ds_read_b128 v[100:103], v58 offset:16128
    ds_read2_b32 v[104:105], v57 offset0:240 offset1:241
    ds_read2_b32 v[106:107], v57 offset0:242 offset1:243
    ds_read_b128 v[108:111], v58 offset:14080
    ds_read2_b32 v[112:113], v63 offset0:112 offset1:113
    ds_read2_b32 v[114:115], v63 offset0:114 offset1:115
    ds_read_b128 v[116:119], v58 offset:12032
    s_waitcnt lgkmcnt(1)
    v_mfma_f32_16x16x32_bf16 v[46:49], v[96:99], v[100:103], 0
    s_lshl_b32 s4, s45, 4
    s_add_u32 s4, s4, s46
    v_mfma_f32_16x16x32_bf16 v[66:69], v[104:107], v[100:103], 0
    ds_read2_b32 v[120:121], v63 offset0:240 offset1:241
    ds_read2_b32 v[122:123], v63 offset0:242 offset1:243
    v_mfma_f32_16x16x32_bf16 v[66:69], v[96:99], v[108:111], v[66:69]
    ds_read_b128 v[124:127], v58 offset:9984
    s_bfe_u32 s7, s14, 0x40004
    v_mfma_f32_16x16x32_bf16 v[70:73], v[104:107], v[108:111], 0
    s_lshl_b32 s7, s7, 12
    s_add_u32 s12, s6, s7
    v_mfma_f32_16x16x32_bf16 v[70:73], v[112:115], v[100:103], v[70:73]
    buffer_load_dwordx4 a[32:35], v17, s[8:11], s12 offen offset:0 sc0 sc1
    s_waitcnt lgkmcnt(3)
    v_mfma_f32_16x16x32_bf16 v[70:73], v[96:99], v[116:119], v[70:73]
    s_lshl_b32 s4, s4, 2
    s_add_u32 s4, s4, s44
    v_mfma_f32_16x16x32_bf16 v[74:77], v[112:115], v[108:111], 0
    s_lshl_b32 s4, s4, 3
    s_add_u32 s4, s4, 21512192
    v_mfma_f32_16x16x32_bf16 v[74:77], v[104:107], v[116:119], v[74:77]
    buffer_load_dwordx4 a[36:39], v17, s[8:11], s12 offen offset:1024 sc0 sc1
    v_mfma_f32_16x16x32_bf16 v[78:81], v[112:115], v[116:119], 0
    ds_read2_b32 v[128:129], v64 offset0:112 offset1:113
    s_waitcnt lgkmcnt(1)
    v_mfma_f32_16x16x32_bf16 v[74:77], v[120:123], v[100:103], v[74:77]
    ds_read2_b32 v[130:131], v64 offset0:114 offset1:115
    ds_read_b128 v[132:135], v58 offset:7936
    v_mfma_f32_16x16x32_bf16 v[74:77], v[96:99], v[124:127], v[74:77]
    s_lshl_b32 s3, s45, 9
    s_add_u32 s3, s3, 21512192
    v_mfma_f32_16x16x32_bf16 v[78:81], v[120:123], v[108:111], v[78:81]
    v_lshrrev_b32 v182, 1, v17
    v_add_u32 v182, s3, v182
    v_mfma_f32_16x16x32_bf16 v[78:81], v[104:107], v[124:127], v[78:81]
    buffer_load_dwordx4 a[40:43], v17, s[8:11], s12 offen offset:2048 sc0 sc1
    v_mfma_f32_16x16x32_bf16 v[84:87], v[120:123], v[116:119], 0
    v_lshrrev_b32 v1, 4, v2
    v_and_b32 v3, 15, v2
    v_mfma_f32_16x16x32_bf16 v[84:87], v[112:115], v[124:127], v[84:87]
    v_xor_b32 v3, v3, v1
    v_lshlrev_b32 v3, 4, v3
    v_mfma_f32_16x16x32_bf16 v[88:91], v[120:123], v[124:127], 0
    v_lshl_add_u32 v7, v1, 12, v3
    s_waitcnt lgkmcnt(0)
    v_mfma_f32_16x16x32_bf16 v[78:81], v[128:131], v[100:103], v[78:81]
    ds_read2_b32 v[136:137], v64 offset0:240 offset1:241
    ds_read2_b32 v[138:139], v64 offset0:242 offset1:243
    v_mfma_f32_16x16x32_bf16 v[78:81], v[96:99], v[132:135], v[78:81]
    ds_read_b128 v[140:143], v58 offset:5888
    buffer_load_dwordx4 a[44:47], v17, s[8:11], s12 offen offset:3072 sc0 sc1
    v_mfma_f32_16x16x32_bf16 v[84:87], v[128:131], v[108:111], v[84:87]
    v_xor_b32 v1, 64, v7
    v_add_u32 v8, 16384, v1
    v_mfma_f32_16x16x32_bf16 v[84:87], v[104:107], v[132:135], v[84:87]
    v_xor_b32 v1, 128, v7
    v_add_u32 v9, 32768, v1
    v_mfma_f32_16x16x32_bf16 v[88:91], v[128:131], v[116:119], v[88:91]
    v_xor_b32 v1, 192, v7
    v_add_u32 v10, 49152, v1
    v_mfma_f32_16x16x32_bf16 v[88:91], v[112:115], v[132:135], v[88:91]
    s_lshl_b32 s16, s45, 19
    s_lshl_b32 s3, s44, 17
    v_mfma_f32_16x16x32_bf16 v[92:95], v[128:131], v[124:127], 0
    ds_read2_b32 v[144:145], v65 offset0:112 offset1:113
    ds_read2_b32 v[146:147], v65 offset0:114 offset1:115
    v_mfma_f32_16x16x32_bf16 v[92:95], v[120:123], v[132:135], v[92:95]
    ds_read_b128 v[148:151], v58 offset:3840
    s_waitcnt lgkmcnt(3)
    v_mfma_f32_16x16x32_bf16 v[84:87], v[136:139], v[100:103], v[84:87]
    s_bfe_u32 s7, s14, 0x40008
    s_lshl_b32 s7, s7, 12
    v_mfma_f32_16x16x32_bf16 v[84:87], v[96:99], v[140:143], v[84:87]
    s_add_u32 s12, s6, s7
    buffer_load_dwordx4 a[48:51], v17, s[8:11], s12 offen offset:0 sc0 sc1
    v_mfma_f32_16x16x32_bf16 v[88:91], v[136:139], v[108:111], v[88:91]
    ds_read2_b32 v[128:129], v65 offset0:240 offset1:241
    ds_read2_b32 v[130:131], v65 offset0:242 offset1:243
    v_mfma_f32_16x16x32_bf16 v[88:91], v[104:107], v[140:143], v[88:91]
    ds_read_b128 v[124:127], v58 offset:1792
    buffer_load_dwordx4 a[52:55], v17, s[8:11], s12 offen offset:1024 sc0 sc1
    v_mfma_f32_16x16x32_bf16 v[92:95], v[136:139], v[116:119], v[92:95]
    ds_read2_b32 v[120:121], v57 offset0:96 offset1:97
    ds_read2_b32 v[122:123], v57 offset0:98 offset1:99
    v_mfma_f32_16x16x32_bf16 v[92:95], v[112:115], v[140:143], v[92:95]
    ds_read_b128 v[132:135], v59 offset:15872
    s_waitcnt lgkmcnt(6)
    v_mfma_f32_16x16x32_bf16 v[88:91], v[144:147], v[100:103], v[88:91]
    ds_read2_b32 v[136:137], v57 offset0:224 offset1:225
    ds_read2_b32 v[138:139], v57 offset0:226 offset1:227
    v_mfma_f32_16x16x32_bf16 v[88:91], v[96:99], v[148:151], v[88:91]
    ds_read_b128 v[116:119], v59 offset:13824
    s_add_u32 s16, s16, s3
    v_mfma_f32_16x16x32_bf16 v[92:95], v[144:147], v[108:111], v[92:95]
    ds_read2_b32 v[112:113], v63 offset0:96 offset1:97
    ds_read2_b32 v[114:115], v63 offset0:98 offset1:99
    v_mfma_f32_16x16x32_bf16 v[92:95], v[104:107], v[148:151], v[92:95]
    ds_read_b128 v[140:143], v59 offset:11776
    s_waitcnt lgkmcnt(6)
    v_mfma_f32_16x16x32_bf16 v[92:95], v[128:131], v[100:103], v[92:95]
    buffer_load_dwordx4 a[56:59], v17, s[8:11], s12 offen offset:2048 sc0 sc1
    v_mfma_f32_16x16x32_bf16 v[92:95], v[96:99], v[124:127], v[92:95]
    s_lshl_b32 s17, s46, 8
    s_lshl_b32 s18, s44, 13
    v_mfma_f32_16x16x32_bf16 v[46:49], v[120:123], v[132:135], v[46:49]
    s_lshr_b32 s28, s44, 1
    s_waitcnt lgkmcnt(1)
    v_mfma_f32_16x16x32_bf16 v[66:69], v[136:139], v[132:135], v[66:69]
    ds_read2_b32 v[144:145], v63 offset0:224 offset1:225
    ds_read2_b32 v[146:147], v63 offset0:226 offset1:227
    v_mfma_f32_16x16x32_bf16 v[66:69], v[120:123], v[116:119], v[66:69]
    ds_read_b128 v[108:111], v59 offset:9728
    buffer_load_dwordx4 a[60:63], v17, s[8:11], s12 offen offset:3072 sc0 sc1
    v_mfma_f32_16x16x32_bf16 v[70:73], v[136:139], v[116:119], v[70:73]
    v_and_b32 v26, 31, v2
    v_lshrrev_b32 v27, 5, v2
    v_mfma_f32_16x16x32_bf16 v[70:73], v[112:115], v[132:135], v[70:73]
    v_lshlrev_b32 v27, 2, v27
    s_waitcnt lgkmcnt(3)
    v_mfma_f32_16x16x32_bf16 v[70:73], v[120:123], v[140:143], v[70:73]
    s_lshl_b32 s3, s28, 3
    v_add_u32 v27, s3, v27
    v_mfma_f32_16x16x32_bf16 v[74:77], v[112:115], v[116:119], v[74:77]
    s_bfe_u32 s7, s14, 0x4000c
    s_lshl_b32 s7, s7, 12
    v_mfma_f32_16x16x32_bf16 v[74:77], v[136:139], v[140:143], v[74:77]
    s_add_u32 s12, s6, s7
    buffer_load_dwordx4 a[64:67], v17, s[8:11], s12 offen offset:0 sc0 sc1
    v_mfma_f32_16x16x32_bf16 v[78:81], v[112:115], v[140:143], v[78:81]
    ds_read2_b32 v[104:105], v64 offset0:96 offset1:97
    s_waitcnt lgkmcnt(1)
    v_mfma_f32_16x16x32_bf16 v[74:77], v[144:147], v[132:135], v[74:77]
    ds_read2_b32 v[106:107], v64 offset0:98 offset1:99
    ds_read_b128 v[148:151], v59 offset:7680
    v_mfma_f32_16x16x32_bf16 v[74:77], v[120:123], v[108:111], v[74:77]
    v_and_b32 v28, 15, v26
    v_xor_b32 v27, v27, v28
    v_mfma_f32_16x16x32_bf16 v[78:81], v[144:147], v[116:119], v[78:81]
    buffer_load_dwordx4 a[68:71], v17, s[8:11], s12 offen offset:1024 sc0 sc1
    v_mfma_f32_16x16x32_bf16 v[78:81], v[136:139], v[108:111], v[78:81]
    v_lshlrev_b32 v27, 4, v27
    v_lshl_add_u32 v27, v26, 8, v27
    v_mfma_f32_16x16x32_bf16 v[84:87], v[144:147], v[140:143], v[84:87]
    s_lshl_b32 s3, s28, 14
    v_add_u32 v27, s3, v27
    v_mfma_f32_16x16x32_bf16 v[84:87], v[112:115], v[108:111], v[84:87]
    v_xor_b32 v4, 0, v27
    v_xor_b32 v18, 0x4000, v4
    v_mfma_f32_16x16x32_bf16 v[88:91], v[144:147], v[108:111], v[88:91]
    v_add_u32 v13, 65536, v4
    s_waitcnt lgkmcnt(0)
    v_mfma_f32_16x16x32_bf16 v[78:81], v[104:107], v[132:135], v[78:81]
    ds_read2_b32 v[128:129], v64 offset0:224 offset1:225
    ds_read2_b32 v[130:131], v64 offset0:226 offset1:227
    v_mfma_f32_16x16x32_bf16 v[78:81], v[120:123], v[148:151], v[78:81]
    ds_read_b128 v[100:103], v59 offset:5632
    buffer_load_dwordx4 a[72:75], v17, s[8:11], s12 offen offset:2048 sc0 sc1
    v_mfma_f32_16x16x32_bf16 v[84:87], v[104:107], v[116:119], v[84:87]
    v_add_u32 v22, 65536, v18
    v_xor_b32 v5, 16, v27
    v_mfma_f32_16x16x32_bf16 v[84:87], v[136:139], v[148:151], v[84:87]
    v_xor_b32 v19, 0x4000, v5
    v_add_u32 v14, 65536, v5
    v_mfma_f32_16x16x32_bf16 v[88:91], v[104:107], v[140:143], v[88:91]
    v_add_u32 v23, 65536, v19
    v_xor_b32 v11, 32, v27
    v_mfma_f32_16x16x32_bf16 v[88:91], v[112:115], v[148:151], v[88:91]
    buffer_load_dwordx4 a[76:79], v17, s[8:11], s12 offen offset:3072 sc0 sc1
    v_mfma_f32_16x16x32_bf16 v[92:95], v[104:107], v[108:111], v[92:95]
    ds_read2_b32 v[96:97], v65 offset0:96 offset1:97
    ds_read2_b32 v[98:99], v65 offset0:98 offset1:99
    v_mfma_f32_16x16x32_bf16 v[92:95], v[144:147], v[148:151], v[92:95]
    ds_read_b128 v[124:127], v59 offset:3584
    s_waitcnt lgkmcnt(3)
    v_mfma_f32_16x16x32_bf16 v[84:87], v[128:131], v[132:135], v[84:87]
    v_xor_b32 v20, 0x4000, v11
    v_add_u32 v15, 65536, v11
    v_mfma_f32_16x16x32_bf16 v[84:87], v[120:123], v[100:103], v[84:87]
    v_add_u32 v24, 65536, v20
    v_xor_b32 v12, 48, v27
    v_mfma_f32_16x16x32_bf16 v[88:91], v[128:131], v[116:119], v[88:91]
    ds_read2_b32 v[104:105], v65 offset0:224 offset1:225
    ds_read2_b32 v[106:107], v65 offset0:226 offset1:227
    v_mfma_f32_16x16x32_bf16 v[88:91], v[136:139], v[100:103], v[88:91]
    ds_read_b128 v[108:111], v59 offset:1536
    s_bfe_u32 s7, s14, 0x40010
    v_mfma_f32_16x16x32_bf16 v[92:95], v[128:131], v[140:143], v[92:95]
    ds_read2_b32 v[144:145], v57 offset0:80 offset1:81
    ds_read2_b32 v[146:147], v57 offset0:82 offset1:83
    v_mfma_f32_16x16x32_bf16 v[92:95], v[112:115], v[100:103], v[92:95]
    ds_read_b128 v[148:151], v60 offset:15616
    s_waitcnt lgkmcnt(6)
    v_mfma_f32_16x16x32_bf16 v[88:91], v[96:99], v[132:135], v[88:91]
    ds_read2_b32 v[128:129], v57 offset0:208 offset1:209
    ds_read2_b32 v[130:131], v57 offset0:210 offset1:211
    v_mfma_f32_16x16x32_bf16 v[88:91], v[120:123], v[124:127], v[88:91]
    ds_read_b128 v[140:143], v60 offset:13568
    s_lshl_b32 s7, s7, 12
    v_mfma_f32_16x16x32_bf16 v[92:95], v[96:99], v[116:119], v[92:95]
    ds_read2_b32 v[112:113], v63 offset0:80 offset1:81
    ds_read2_b32 v[114:115], v63 offset0:82 offset1:83
    v_mfma_f32_16x16x32_bf16 v[92:95], v[136:139], v[124:127], v[92:95]
    ds_read_b128 v[100:103], v60 offset:11520
    s_waitcnt lgkmcnt(6)
    v_mfma_f32_16x16x32_bf16 v[92:95], v[104:107], v[132:135], v[92:95]
    s_add_u32 s12, s6, s7
    buffer_load_dwordx4 a[80:83], v17, s[8:11], s12 offen offset:0 sc0 sc1
    v_mfma_f32_16x16x32_bf16 v[92:95], v[120:123], v[108:111], v[92:95]
    buffer_load_dwordx4 a[84:87], v17, s[8:11], s12 offen offset:1024 sc0 sc1
    v_mfma_f32_16x16x32_bf16 v[46:49], v[144:147], v[148:151], v[46:49]
    s_waitcnt vmcnt(14)
    s_waitcnt lgkmcnt(1)
    v_mfma_f32_16x16x32_bf16 v[66:69], v[128:131], v[148:151], v[66:69]
    ds_read2_b32 v[96:97], v63 offset0:208 offset1:209
    ds_read2_b32 v[98:99], v63 offset0:210 offset1:211
    v_mfma_f32_16x16x32_bf16 v[66:69], v[144:147], v[140:143], v[66:69]
    ds_read_b128 v[116:119], v60 offset:9472
    v_mov_b32 v82, s42
    v_mov_b32 v83, s43
    s_mov_b64 s[48:49], exec
    s_mov_b64 exec, 1
    buffer_store_dwordx2 v[82:83], v6, s[8:11], s4 offen sc0 sc1
    s_mov_b64 exec, s[48:49]
    v_mfma_f32_16x16x32_bf16 v[70:73], v[128:131], v[140:143], v[70:73]
    buffer_load_dwordx4 a[88:91], v17, s[8:11], s12 offen offset:2048 sc0 sc1
    v_mfma_f32_16x16x32_bf16 v[70:73], v[112:115], v[148:151], v[70:73]
    v_xor_b32 v21, 0x4000, v12
    s_waitcnt lgkmcnt(3)
    v_mfma_f32_16x16x32_bf16 v[70:73], v[144:147], v[100:103], v[70:73]
    buffer_load_dwordx4 a[92:95], v17, s[8:11], s12 offen offset:3072 sc0 sc1
    v_mfma_f32_16x16x32_bf16 v[74:77], v[112:115], v[140:143], v[74:77]
    v_add_u32 v16, 65536, v12
    v_add_u32 v25, 65536, v21
    v_mfma_f32_16x16x32_bf16 v[74:77], v[128:131], v[100:103], v[74:77]
    s_lshl_b32 s13, s46, 4
    s_add_u32 s13, s13, s45
    v_mfma_f32_16x16x32_bf16 v[78:81], v[112:115], v[100:103], v[78:81]
    ds_read2_b32 v[136:137], v64 offset0:80 offset1:81
    s_waitcnt lgkmcnt(1)
    v_mfma_f32_16x16x32_bf16 v[74:77], v[96:99], v[148:151], v[74:77]
    ds_read2_b32 v[138:139], v64 offset0:82 offset1:83
    ds_read_b128 v[124:127], v60 offset:7424
    v_mfma_f32_16x16x32_bf16 v[74:77], v[144:147], v[116:119], v[74:77]
    s_bfe_u32 s7, s14, 0x40014
    s_lshl_b32 s7, s7, 12
    v_mfma_f32_16x16x32_bf16 v[78:81], v[96:99], v[140:143], v[78:81]
    s_add_u32 s12, s6, s7
    buffer_load_dwordx4 a[96:99], v17, s[8:11], s12 offen offset:0 sc0 sc1
    v_mfma_f32_16x16x32_bf16 v[78:81], v[128:131], v[116:119], v[78:81]
    s_lshl_b32 s13, s13, 2
    s_add_u32 s13, s13, s44
    v_mfma_f32_16x16x32_bf16 v[84:87], v[96:99], v[100:103], v[84:87]
    s_lshl_b32 s13, s13, 3
    s_add_u32 s13, s13, 21520384
    v_mfma_f32_16x16x32_bf16 v[84:87], v[112:115], v[116:119], v[84:87]
    s_mov_b32 s32, s36
    s_mov_b32 s33, s37
    v_mfma_f32_16x16x32_bf16 v[88:91], v[96:99], v[116:119], v[88:91]
    buffer_load_dwordx4 a[100:103], v17, s[8:11], s12 offen offset:1024 sc0 sc1
    s_waitcnt lgkmcnt(0)
    v_mfma_f32_16x16x32_bf16 v[78:81], v[136:139], v[148:151], v[78:81]
    ds_read2_b32 v[104:105], v64 offset0:208 offset1:209
    ds_read2_b32 v[106:107], v64 offset0:210 offset1:211
    v_mfma_f32_16x16x32_bf16 v[78:81], v[144:147], v[124:127], v[78:81]
    ds_read_b128 v[132:135], v60 offset:5376
    s_mov_b32 s34, 8388608
    v_mfma_f32_16x16x32_bf16 v[84:87], v[136:139], v[140:143], v[84:87]
    s_mov_b32 s35, 131072
    s_lshr_b32 s29, s44, 1
    v_mfma_f32_16x16x32_bf16 v[84:87], v[128:131], v[124:127], v[84:87]
    s_and_b32 s30, s44, 1
    v_bfe_u32 v32, v2, 4, 1
    v_mfma_f32_16x16x32_bf16 v[88:91], v[136:139], v[100:103], v[88:91]
    buffer_load_dwordx4 a[104:107], v17, s[8:11], s12 offen offset:2048 sc0 sc1
    v_mfma_f32_16x16x32_bf16 v[88:91], v[112:115], v[124:127], v[88:91]
    v_lshlrev_b32 v32, 2, v32
    v_and_b32 v33, 7, v2
    v_mfma_f32_16x16x32_bf16 v[92:95], v[136:139], v[116:119], v[92:95]
    ds_read2_b32 v[120:121], v65 offset0:80 offset1:81
    ds_read2_b32 v[122:123], v65 offset0:82 offset1:83
    v_mfma_f32_16x16x32_bf16 v[92:95], v[96:99], v[124:127], v[92:95]
    ds_read_b128 v[108:111], v60 offset:3328
    s_waitcnt lgkmcnt(3)
    v_mfma_f32_16x16x32_bf16 v[84:87], v[104:107], v[148:151], v[84:87]
    v_xor_b32 v33, v33, v32
    v_lshlrev_b32 v33, 4, v33
    v_mfma_f32_16x16x32_bf16 v[84:87], v[144:147], v[132:135], v[84:87]
    buffer_load_dwordx4 a[108:111], v17, s[8:11], s12 offen offset:3072 sc0 sc1
    v_mfma_f32_16x16x32_bf16 v[88:91], v[104:107], v[140:143], v[88:91]
    ds_read2_b32 v[136:137], v65 offset0:208 offset1:209
    ds_read2_b32 v[138:139], v65 offset0:210 offset1:211
    v_mfma_f32_16x16x32_bf16 v[88:91], v[128:131], v[132:135], v[88:91]
    ds_read_b128 v[116:119], v60 offset:1280
    v_lshrrev_b32 v32, 3, v2
    v_mfma_f32_16x16x32_bf16 v[92:95], v[104:107], v[100:103], v[92:95]
    ds_read2_b32 v[96:97], v57 offset0:64 offset1:65
    ds_read2_b32 v[98:99], v57 offset0:66 offset1:67
    v_mfma_f32_16x16x32_bf16 v[92:95], v[112:115], v[132:135], v[92:95]
    ds_read_b128 v[124:127], v61 offset:15360
    s_waitcnt lgkmcnt(6)
    v_mfma_f32_16x16x32_bf16 v[88:91], v[120:123], v[148:151], v[88:91]
    ds_read2_b32 v[104:105], v57 offset0:192 offset1:193
    ds_read2_b32 v[106:107], v57 offset0:194 offset1:195
    v_mfma_f32_16x16x32_bf16 v[88:91], v[144:147], v[108:111], v[88:91]
    ds_read_b128 v[100:103], v61 offset:13312
    s_bfe_u32 s7, s14, 0x40018
    v_mfma_f32_16x16x32_bf16 v[92:95], v[120:123], v[140:143], v[92:95]
    ds_read2_b32 v[112:113], v63 offset0:64 offset1:65
    ds_read2_b32 v[114:115], v63 offset0:66 offset1:67
    v_mfma_f32_16x16x32_bf16 v[92:95], v[128:131], v[108:111], v[92:95]
    ds_read_b128 v[132:135], v61 offset:11264
    s_waitcnt lgkmcnt(6)
    v_mfma_f32_16x16x32_bf16 v[92:95], v[136:139], v[148:151], v[92:95]
    s_lshl_b32 s7, s7, 12
    s_add_u32 s12, s6, s7
    v_mfma_f32_16x16x32_bf16 v[92:95], v[144:147], v[116:119], v[92:95]
    buffer_load_dwordx4 a[112:115], v17, s[8:11], s12 offen offset:0 sc0 sc1
    v_mfma_f32_16x16x32_bf16 v[46:49], v[96:99], v[124:127], v[46:49]
    buffer_load_dwordx4 a[116:119], v17, s[8:11], s12 offen offset:1024 sc0 sc1
    s_waitcnt lgkmcnt(1)
    v_mfma_f32_16x16x32_bf16 v[66:69], v[104:107], v[124:127], v[66:69]
    ds_read2_b32 v[120:121], v63 offset0:192 offset1:193
    ds_read2_b32 v[122:123], v63 offset0:194 offset1:195
    v_mfma_f32_16x16x32_bf16 v[66:69], v[96:99], v[100:103], v[66:69]
    ds_read_b128 v[140:143], v61 offset:9216
    v_lshl_add_u32 v35, v32, 11, v33
    v_mfma_f32_16x16x32_bf16 v[70:73], v[104:107], v[100:103], v[70:73]
    s_lshl_b32 s31, s45, 18
    s_lshl_b32 s3, s44, 16
    v_mfma_f32_16x16x32_bf16 v[70:73], v[112:115], v[124:127], v[70:73]
    buffer_load_dwordx4 a[120:123], v17, s[8:11], s12 offen offset:2048 sc0 sc1
    s_waitcnt lgkmcnt(3)
    v_mfma_f32_16x16x32_bf16 v[70:73], v[96:99], v[132:135], v[70:73]
    s_add_u32 s31, s31, s3
    s_lshl_b32 s3, s46, 7
    v_mfma_f32_16x16x32_bf16 v[74:77], v[112:115], v[100:103], v[74:77]
    s_add_u32 s31, s31, s3
    s_lshl_b32 s38, s46, 18
    v_mfma_f32_16x16x32_bf16 v[74:77], v[104:107], v[132:135], v[74:77]
    s_lshl_b32 s3, s44, 16
    s_add_u32 s38, s38, s3
    v_mfma_f32_16x16x32_bf16 v[78:81], v[112:115], v[132:135], v[78:81]
    ds_read2_b32 v[128:129], v64 offset0:64 offset1:65
    s_waitcnt lgkmcnt(1)
    v_mfma_f32_16x16x32_bf16 v[74:77], v[120:123], v[124:127], v[74:77]
    ds_read2_b32 v[130:131], v64 offset0:66 offset1:67
    ds_read_b128 v[108:111], v61 offset:7168
    v_mfma_f32_16x16x32_bf16 v[74:77], v[96:99], v[140:143], v[74:77]
    buffer_load_dwordx4 a[124:127], v17, s[8:11], s12 offen offset:3072 sc0 sc1
    v_mfma_f32_16x16x32_bf16 v[78:81], v[120:123], v[100:103], v[78:81]
    s_lshl_b32 s3, s45, 8
    s_add_u32 s38, s38, s3
    v_mfma_f32_16x16x32_bf16 v[78:81], v[104:107], v[140:143], v[78:81]
    s_add_u32 s38, s38, 12582912
    v_bfe_u32 v34, v2, 2, 2
    v_mfma_f32_16x16x32_bf16 v[84:87], v[120:123], v[132:135], v[84:87]
    v_bfe_u32 v32, v2, 4, 1
    v_lshlrev_b32 v32, 1, v32
    v_mfma_f32_16x16x32_bf16 v[84:87], v[112:115], v[140:143], v[84:87]
    s_bfe_u32 s7, s14, 0x4001c
    s_lshl_b32 s7, s7, 12
    v_mfma_f32_16x16x32_bf16 v[88:91], v[120:123], v[140:143], v[88:91]
    s_add_u32 s12, s6, s7
    s_waitcnt lgkmcnt(0)
    v_mfma_f32_16x16x32_bf16 v[78:81], v[128:131], v[124:127], v[78:81]
    ds_read2_b32 v[136:137], v64 offset0:192 offset1:193
    ds_read2_b32 v[138:139], v64 offset0:194 offset1:195
    v_mfma_f32_16x16x32_bf16 v[78:81], v[96:99], v[108:111], v[78:81]
    ds_read_b128 v[148:151], v61 offset:5120
    buffer_load_dwordx4 a[128:131], v17, s[8:11], s12 offen offset:0 sc0 sc1
    v_mfma_f32_16x16x32_bf16 v[84:87], v[128:131], v[100:103], v[84:87]
    v_bfe_u32 v33, v2, 1, 1
    v_add_u32 v32, v32, v33
    v_mfma_f32_16x16x32_bf16 v[84:87], v[104:107], v[108:111], v[84:87]
    buffer_load_dwordx4 a[132:135], v17, s[8:11], s12 offen offset:1024 sc0 sc1
    v_mfma_f32_16x16x32_bf16 v[88:91], v[128:131], v[132:135], v[88:91]
    s_lshl_b32 s3, s30, 2
    v_add_u32 v32, s3, v32
    v_mfma_f32_16x16x32_bf16 v[88:91], v[112:115], v[108:111], v[88:91]
    v_bfe_u32 v33, v2, 3, 1
    v_lshlrev_b32 v33, 2, v33
    v_mfma_f32_16x16x32_bf16 v[92:95], v[128:131], v[140:143], v[92:95]
    ds_read2_b32 v[144:145], v65 offset0:64 offset1:65
    ds_read2_b32 v[146:147], v65 offset0:66 offset1:67
    v_mfma_f32_16x16x32_bf16 v[92:95], v[120:123], v[108:111], v[92:95]
    ds_read_b128 v[116:119], v61 offset:3072
    s_waitcnt lgkmcnt(3)
    v_mfma_f32_16x16x32_bf16 v[84:87], v[136:139], v[124:127], v[84:87]
    buffer_load_dwordx4 a[136:139], v17, s[8:11], s12 offen offset:2048 sc0 sc1
    v_mfma_f32_16x16x32_bf16 v[84:87], v[96:99], v[148:151], v[84:87]
    v_xor_b32 v32, v32, v33
    v_lshlrev_b32 v32, 4, v32
    v_mfma_f32_16x16x32_bf16 v[88:91], v[136:139], v[100:103], v[88:91]
    ds_read2_b32 v[128:129], v65 offset0:192 offset1:193
    ds_read2_b32 v[130:131], v65 offset0:194 offset1:195
    v_mfma_f32_16x16x32_bf16 v[88:91], v[104:107], v[148:151], v[88:91]
    ds_read_b128 v[140:143], v61 offset:1024
    v_and_b32 v33, 1, v2
    v_mfma_f32_16x16x32_bf16 v[92:95], v[136:139], v[132:135], v[92:95]
    ds_read2_b32 v[120:121], v57 offset0:48 offset1:49
    ds_read2_b32 v[122:123], v57 offset0:50 offset1:51
    v_mfma_f32_16x16x32_bf16 v[92:95], v[112:115], v[148:151], v[92:95]
    ds_read_b128 v[108:111], v58 offset:15104
    s_waitcnt lgkmcnt(6)
    v_mfma_f32_16x16x32_bf16 v[88:91], v[144:147], v[124:127], v[88:91]
    ds_read2_b32 v[136:137], v57 offset0:176 offset1:177
    ds_read2_b32 v[138:139], v57 offset0:178 offset1:179
    v_mfma_f32_16x16x32_bf16 v[88:91], v[96:99], v[116:119], v[88:91]
    ds_read_b128 v[132:135], v58 offset:13056
    buffer_load_dwordx4 a[140:143], v17, s[8:11], s12 offen offset:3072 sc0 sc1
    v_mfma_f32_16x16x32_bf16 v[92:95], v[144:147], v[100:103], v[92:95]
    ds_read2_b32 v[112:113], v63 offset0:48 offset1:49
    ds_read2_b32 v[114:115], v63 offset0:50 offset1:51
    v_mfma_f32_16x16x32_bf16 v[92:95], v[104:107], v[116:119], v[92:95]
    ds_read_b128 v[148:151], v58 offset:11008
    s_waitcnt lgkmcnt(6)
    v_mfma_f32_16x16x32_bf16 v[92:95], v[128:131], v[124:127], v[92:95]
    s_bfe_u32 s7, s15, 0x40000
    s_lshl_b32 s7, s7, 12
    v_mfma_f32_16x16x32_bf16 v[92:95], v[96:99], v[140:143], v[92:95]
    s_add_u32 s12, s6, s7
    buffer_load_dwordx4 a[144:147], v17, s[8:11], s12 offen offset:0 sc0 sc1
    v_mfma_f32_16x16x32_bf16 v[46:49], v[120:123], v[108:111], v[46:49]
    v_lshl_add_u32 v32, v33, 3, v32
    s_waitcnt lgkmcnt(1)
    v_mfma_f32_16x16x32_bf16 v[66:69], v[136:139], v[108:111], v[66:69]
    ds_read2_b32 v[144:145], v63 offset0:176 offset1:177
    ds_read2_b32 v[146:147], v63 offset0:178 offset1:179
    v_mfma_f32_16x16x32_bf16 v[66:69], v[120:123], v[132:135], v[66:69]
    ds_read_b128 v[100:103], v58 offset:8960
    v_lshrrev_b32 v33, 5, v2
    v_mfma_f32_16x16x32_bf16 v[70:73], v[136:139], v[132:135], v[70:73]
    buffer_load_dwordx4 a[148:151], v17, s[8:11], s12 offen offset:1024 sc0 sc1
    v_mfma_f32_16x16x32_bf16 v[70:73], v[112:115], v[108:111], v[70:73]
    v_lshl_add_u32 v34, v33, 2, v34
    s_waitcnt lgkmcnt(3)
    v_mfma_f32_16x16x32_bf16 v[70:73], v[120:123], v[148:151], v[70:73]
    v_lshl_add_u32 v32, v34, 7, v32
    s_lshl_b32 s3, s29, 13
    v_mfma_f32_16x16x32_bf16 v[74:77], v[112:115], v[132:135], v[74:77]
    s_add_u32 s3, s3, 131072
    v_add_u32 v36, s3, v32
    v_mfma_f32_16x16x32_bf16 v[74:77], v[136:139], v[148:151], v[74:77]
    v_and_b32 v32, 15, v2
    s_lshl_b32 s3, s29, 3
    v_mfma_f32_16x16x32_bf16 v[78:81], v[112:115], v[148:151], v[78:81]
    ds_read2_b32 v[104:105], v64 offset0:48 offset1:49
    s_waitcnt lgkmcnt(1)
    v_mfma_f32_16x16x32_bf16 v[74:77], v[144:147], v[108:111], v[74:77]
    ds_read2_b32 v[106:107], v64 offset0:50 offset1:51
    ds_read_b128 v[116:119], v58 offset:6912
    v_mfma_f32_16x16x32_bf16 v[74:77], v[120:123], v[100:103], v[74:77]
    buffer_load_dwordx4 a[152:155], v17, s[8:11], s12 offen offset:2048 sc0 sc1
    v_mfma_f32_16x16x32_bf16 v[78:81], v[144:147], v[132:135], v[78:81]
    v_xor_b32 v32, s3, v32
    v_lshlrev_b32 v32, 4, v32
    v_mfma_f32_16x16x32_bf16 v[78:81], v[136:139], v[100:103], v[78:81]
    v_and_b32 v34, 31, v2
    v_lshl_add_u32 v32, v34, 8, v32
    v_mfma_f32_16x16x32_bf16 v[84:87], v[144:147], v[148:151], v[84:87]
    buffer_load_dwordx4 a[156:159], v17, s[8:11], s12 offen offset:3072 sc0 sc1
    v_mfma_f32_16x16x32_bf16 v[84:87], v[112:115], v[100:103], v[84:87]
    v_lshl_add_u32 v32, v33, 3, v32
    s_lshl_b32 s3, s30, 13
    v_mfma_f32_16x16x32_bf16 v[88:91], v[144:147], v[100:103], v[88:91]
    s_add_u32 s3, s3, 147456
    s_waitcnt lgkmcnt(0)
    v_mfma_f32_16x16x32_bf16 v[78:81], v[104:107], v[108:111], v[78:81]
    ds_read2_b32 v[128:129], v64 offset0:176 offset1:177
    ds_read2_b32 v[130:131], v64 offset0:178 offset1:179
    v_mfma_f32_16x16x32_bf16 v[78:81], v[120:123], v[116:119], v[78:81]
    ds_read_b128 v[124:127], v58 offset:4864
    v_add_u32 v37, s3, v32
    v_mfma_f32_16x16x32_bf16 v[84:87], v[104:107], v[132:135], v[84:87]
    s_bfe_u32 s7, s15, 0x40004
    s_lshl_b32 s7, s7, 12
    v_mfma_f32_16x16x32_bf16 v[84:87], v[136:139], v[116:119], v[84:87]
    s_add_u32 s12, s6, s7
    buffer_load_dwordx4 a[160:163], v17, s[8:11], s12 offen offset:0 sc0 sc1
    v_mfma_f32_16x16x32_bf16 v[88:91], v[104:107], v[148:151], v[88:91]
    v_and_b32 v32, 15, v2
    v_lshlrev_b32 v32, 4, v32
    v_mfma_f32_16x16x32_bf16 v[88:91], v[112:115], v[116:119], v[88:91]
    v_and_b32 v34, 16, v2
    v_lshl_add_u32 v32, v34, 9, v32
    v_mfma_f32_16x16x32_bf16 v[92:95], v[104:107], v[100:103], v[92:95]
    ds_read2_b32 v[96:97], v65 offset0:48 offset1:49
    ds_read2_b32 v[98:99], v65 offset0:50 offset1:51
    v_mfma_f32_16x16x32_bf16 v[92:95], v[144:147], v[116:119], v[92:95]
    ds_read_b128 v[140:143], v58 offset:2816
    s_waitcnt lgkmcnt(3)
    v_mfma_f32_16x16x32_bf16 v[84:87], v[128:131], v[108:111], v[84:87]
    buffer_load_dwordx4 a[164:167], v17, s[8:11], s12 offen offset:1024 sc0 sc1
    v_mfma_f32_16x16x32_bf16 v[84:87], v[120:123], v[124:127], v[84:87]
    s_lshl_b32 s3, s45, 9
    s_add_u32 s3, s3, 20971520
    v_mfma_f32_16x16x32_bf16 v[88:91], v[128:131], v[132:135], v[88:91]
    ds_read2_b32 v[104:105], v65 offset0:176 offset1:177
    ds_read2_b32 v[106:107], v65 offset0:178 offset1:179
    v_mfma_f32_16x16x32_bf16 v[88:91], v[136:139], v[124:127], v[88:91]
    ds_read_b128 v[100:103], v58 offset:768
    v_add_u32 v32, s3, v32
    v_mfma_f32_16x16x32_bf16 v[92:95], v[128:131], v[148:151], v[92:95]
    ds_read2_b32 v[144:145], v57 offset0:32 offset1:33
    ds_read2_b32 v[146:147], v57 offset0:34 offset1:35
    v_mfma_f32_16x16x32_bf16 v[92:95], v[112:115], v[124:127], v[92:95]
    ds_read_b128 v[116:119], v59 offset:14848
    s_waitcnt lgkmcnt(6)
    v_mfma_f32_16x16x32_bf16 v[88:91], v[96:99], v[108:111], v[88:91]
    ds_read2_b32 v[128:129], v57 offset0:160 offset1:161
    ds_read2_b32 v[130:131], v57 offset0:162 offset1:163
    v_mfma_f32_16x16x32_bf16 v[88:91], v[120:123], v[140:143], v[88:91]
    ds_read_b128 v[148:151], v59 offset:12800
    buffer_load_dwordx4 a[168:171], v17, s[8:11], s12 offen offset:2048 sc0 sc1
    v_mfma_f32_16x16x32_bf16 v[92:95], v[96:99], v[132:135], v[92:95]
    ds_read2_b32 v[112:113], v63 offset0:32 offset1:33
    ds_read2_b32 v[114:115], v63 offset0:34 offset1:35
    v_mfma_f32_16x16x32_bf16 v[92:95], v[136:139], v[140:143], v[92:95]
    ds_read_b128 v[124:127], v59 offset:10752
    s_waitcnt lgkmcnt(6)
    v_mfma_f32_16x16x32_bf16 v[92:95], v[104:107], v[108:111], v[92:95]
    buffer_load_dwordx4 a[172:175], v17, s[8:11], s12 offen offset:3072 sc0 sc1
    v_mfma_f32_16x16x32_bf16 v[92:95], v[120:123], v[100:103], v[92:95]
    s_lshl_b32 s3, s29, 8
    v_add_u32 v38, s3, v32
    v_mfma_f32_16x16x32_bf16 v[46:49], v[144:147], v[116:119], v[46:49]
    s_lshl_b32 s3, s44, 10
    s_waitcnt lgkmcnt(1)
    v_mfma_f32_16x16x32_bf16 v[66:69], v[128:131], v[116:119], v[66:69]
    ds_read2_b32 v[96:97], v63 offset0:160 offset1:161
    ds_read2_b32 v[98:99], v63 offset0:162 offset1:163
    v_mfma_f32_16x16x32_bf16 v[66:69], v[144:147], v[148:151], v[66:69]
    ds_read_b128 v[132:135], v59 offset:8704
    s_bfe_u32 s7, s15, 0x40008
    v_mfma_f32_16x16x32_bf16 v[70:73], v[128:131], v[148:151], v[70:73]
    s_lshl_b32 s7, s7, 12
    s_add_u32 s12, s6, s7
    v_mfma_f32_16x16x32_bf16 v[70:73], v[112:115], v[116:119], v[70:73]
    buffer_load_dwordx4 a[176:179], v17, s[8:11], s12 offen offset:0 sc0 sc1
    s_waitcnt lgkmcnt(3)
    v_mfma_f32_16x16x32_bf16 v[70:73], v[144:147], v[124:127], v[70:73]
    s_add_u32 s3, s3, 147456
    v_lshl_add_u32 v39, v33, 4, s3
    v_mfma_f32_16x16x32_bf16 v[74:77], v[112:115], v[148:151], v[74:77]
    v_and_b32 v32, 31, v2
    s_lshl_b32 s3, s30, 5
    v_mfma_f32_16x16x32_bf16 v[74:77], v[128:131], v[124:127], v[74:77]
    buffer_load_dwordx4 a[180:183], v17, s[8:11], s12 offen offset:1024 sc0 sc1
    v_mfma_f32_16x16x32_bf16 v[78:81], v[112:115], v[124:127], v[78:81]
    ds_read2_b32 v[136:137], v64 offset0:32 offset1:33
    s_waitcnt lgkmcnt(1)
    v_mfma_f32_16x16x32_bf16 v[74:77], v[96:99], v[116:119], v[74:77]
    ds_read2_b32 v[138:139], v64 offset0:34 offset1:35
    ds_read_b128 v[140:143], v59 offset:6656
    v_mfma_f32_16x16x32_bf16 v[74:77], v[144:147], v[132:135], v[74:77]
    buffer_load_dwordx2 v[82:83], v182, s[8:11], 0 offen sc0 sc1
    v_mfma_f32_16x16x32_bf16 v[78:81], v[96:99], v[148:151], v[78:81]
    v_add_u32 v32, s3, v32
    s_lshl_b32 s3, s46, 6
    v_mfma_f32_16x16x32_bf16 v[78:81], v[128:131], v[132:135], v[78:81]
    buffer_load_dwordx4 a[184:187], v17, s[8:11], s12 offen offset:2048 sc0 sc1
    v_mfma_f32_16x16x32_bf16 v[84:87], v[96:99], v[124:127], v[84:87]
    v_add_u32 v32, s3, v32
    v_lshlrev_b32 v33, 14, v33
    v_mfma_f32_16x16x32_bf16 v[84:87], v[112:115], v[132:135], v[84:87]
    v_lshl_add_u32 v40, v32, 2, v33
    v_add_u32 v41, 4096, v40
    v_mfma_f32_16x16x32_bf16 v[88:91], v[96:99], v[132:135], v[88:91]
    v_add_u32 v42, 8192, v40
    s_waitcnt lgkmcnt(0)
    v_mfma_f32_16x16x32_bf16 v[78:81], v[136:139], v[116:119], v[78:81]
    ds_read2_b32 v[104:105], v64 offset0:160 offset1:161
    ds_read2_b32 v[106:107], v64 offset0:162 offset1:163
    v_mfma_f32_16x16x32_bf16 v[78:81], v[144:147], v[140:143], v[78:81]
    ds_read_b128 v[108:111], v59 offset:4608
    buffer_load_dwordx4 a[188:191], v17, s[8:11], s12 offen offset:3072 sc0 sc1
    v_mfma_f32_16x16x32_bf16 v[84:87], v[136:139], v[148:151], v[84:87]
    v_add_u32 v43, 12288, v40
    s_lshl_b32 s39, s45, 19
    v_mfma_f32_16x16x32_bf16 v[84:87], v[128:131], v[140:143], v[84:87]
    s_lshl_b32 s3, s29, 18
    s_add_u32 s39, s39, s3
    v_mfma_f32_16x16x32_bf16 v[88:91], v[136:139], v[124:127], v[88:91]
    s_lshl_b32 s47, s44, 12
    s_lshl_b32 s3, s44, 13
    v_mfma_f32_16x16x32_bf16 v[88:91], v[112:115], v[140:143], v[88:91]
    s_add_u32 s3, s3, 0
    v_add_u32 v44, s3, v17
    v_mfma_f32_16x16x32_bf16 v[92:95], v[136:139], v[132:135], v[92:95]
    ds_read2_b32 v[120:121], v65 offset0:32 offset1:33
    ds_read2_b32 v[122:123], v65 offset0:34 offset1:35
    v_mfma_f32_16x16x32_bf16 v[92:95], v[96:99], v[140:143], v[92:95]
    ds_read_b128 v[100:103], v59 offset:2560
    s_waitcnt lgkmcnt(3)
    v_mfma_f32_16x16x32_bf16 v[84:87], v[104:107], v[116:119], v[84:87]
    s_bfe_u32 s7, s15, 0x4000c
    s_lshl_b32 s7, s7, 12
    v_mfma_f32_16x16x32_bf16 v[84:87], v[144:147], v[108:111], v[84:87]
    s_add_u32 s12, s6, s7
    buffer_load_dwordx4 a[192:195], v17, s[8:11], s12 offen offset:0 sc0 sc1
    v_mfma_f32_16x16x32_bf16 v[88:91], v[104:107], v[148:151], v[88:91]
    ds_read2_b32 v[136:137], v65 offset0:160 offset1:161
    ds_read2_b32 v[138:139], v65 offset0:162 offset1:163
    v_mfma_f32_16x16x32_bf16 v[88:91], v[128:131], v[108:111], v[88:91]
    ds_read_b128 v[132:135], v59 offset:512
    buffer_load_dwordx4 a[196:199], v17, s[8:11], s12 offen offset:1024 sc0 sc1
    v_mfma_f32_16x16x32_bf16 v[92:95], v[104:107], v[124:127], v[92:95]
    ds_read2_b32 v[96:97], v57 offset0:16 offset1:17
    ds_read2_b32 v[98:99], v57 offset0:18 offset1:19
    v_mfma_f32_16x16x32_bf16 v[92:95], v[112:115], v[108:111], v[92:95]
    ds_read_b128 v[140:143], v60 offset:14592
    s_waitcnt lgkmcnt(6)
    v_mfma_f32_16x16x32_bf16 v[88:91], v[120:123], v[116:119], v[88:91]
    ds_read2_b32 v[104:105], v57 offset0:144 offset1:145
    ds_read2_b32 v[106:107], v57 offset0:146 offset1:147
    v_mfma_f32_16x16x32_bf16 v[88:91], v[144:147], v[100:103], v[88:91]
    ds_read_b128 v[124:127], v60 offset:12544
    v_xor_b32 v45, 0x4000, v44
    v_mfma_f32_16x16x32_bf16 v[92:95], v[120:123], v[148:151], v[92:95]
    ds_read2_b32 v[112:113], v63 offset0:16 offset1:17
    ds_read2_b32 v[114:115], v63 offset0:18 offset1:19
    v_mfma_f32_16x16x32_bf16 v[92:95], v[128:131], v[100:103], v[92:95]
    ds_read_b128 v[108:111], v60 offset:10496
    s_waitcnt lgkmcnt(6)
    v_mfma_f32_16x16x32_bf16 v[92:95], v[136:139], v[116:119], v[92:95]
    buffer_load_dwordx4 a[200:203], v17, s[8:11], s12 offen offset:2048 sc0 sc1
    v_mfma_f32_16x16x32_bf16 v[92:95], v[144:147], v[132:135], v[92:95]
    s_lshl_b32 s3, s46, 9
    s_add_u32 s3, s3, 21520384
    v_mfma_f32_16x16x32_bf16 v[46:49], v[96:99], v[140:143], v[46:49]
    v_lshrrev_b32 v29, 1, v17
    s_waitcnt lgkmcnt(1)
    v_mfma_f32_16x16x32_bf16 v[66:69], v[104:107], v[140:143], v[66:69]
    ds_read2_b32 v[120:121], v63 offset0:144 offset1:145
    ds_read2_b32 v[122:123], v63 offset0:146 offset1:147
    v_mfma_f32_16x16x32_bf16 v[66:69], v[96:99], v[124:127], v[66:69]
    ds_read_b128 v[148:151], v60 offset:8448
    buffer_load_dwordx4 a[204:207], v17, s[8:11], s12 offen offset:3072 sc0 sc1
    v_mfma_f32_16x16x32_bf16 v[70:73], v[104:107], v[124:127], v[70:73]
    v_add_u32 v29, s3, v29
    v_mfma_f32_16x16x32_bf16 v[70:73], v[112:115], v[140:143], v[70:73]
    s_waitcnt lgkmcnt(3)
    v_mfma_f32_16x16x32_bf16 v[70:73], v[96:99], v[108:111], v[70:73]
    v_mfma_f32_16x16x32_bf16 v[74:77], v[112:115], v[124:127], v[74:77]
    s_bfe_u32 s7, s15, 0x40010
    s_lshl_b32 s7, s7, 12
    v_mfma_f32_16x16x32_bf16 v[74:77], v[104:107], v[108:111], v[74:77]
    s_add_u32 s12, s6, s7
    buffer_load_dwordx4 a[208:211], v17, s[8:11], s12 offen offset:0 sc0 sc1
    v_mfma_f32_16x16x32_bf16 v[78:81], v[112:115], v[108:111], v[78:81]
    ds_read2_b32 v[128:129], v64 offset0:16 offset1:17
    s_waitcnt lgkmcnt(1)
    v_mfma_f32_16x16x32_bf16 v[74:77], v[120:123], v[140:143], v[74:77]
    ds_read2_b32 v[130:131], v64 offset0:18 offset1:19
    ds_read_b128 v[100:103], v60 offset:6400
    v_mfma_f32_16x16x32_bf16 v[74:77], v[96:99], v[148:151], v[74:77]
    v_mfma_f32_16x16x32_bf16 v[78:81], v[120:123], v[124:127], v[78:81]
    buffer_load_dwordx4 a[212:215], v17, s[8:11], s12 offen offset:1024 sc0 sc1
    v_mfma_f32_16x16x32_bf16 v[78:81], v[104:107], v[148:151], v[78:81]
    v_mfma_f32_16x16x32_bf16 v[84:87], v[120:123], v[108:111], v[84:87]
    v_mfma_f32_16x16x32_bf16 v[84:87], v[112:115], v[148:151], v[84:87]
    s_mov_b32 s50, 0
    s_waitcnt vmcnt(8)
    v_cmp_ne_u64 vcc, s[42:43], v[82:83]
    s_nop 4
    s_cbranch_vccz Lfdone_gate_11
Lfpoll_gate_12:
    buffer_load_dwordx2 v[82:83], v182, s[8:11], 0 offen sc0 sc1
    s_waitcnt vmcnt(0)
    v_cmp_ne_u64 vcc, s[42:43], v[82:83]
    s_nop 4
    s_add_u32 s50, s50, 1
    s_cmp_gt_u32 s50, 20000
    s_cbranch_scc1 Lfdone_gate_11
    s_cbranch_vccnz Lfpoll_gate_12
Lfdone_gate_11:
    v_mfma_f32_16x16x32_bf16 v[88:91], v[120:123], v[148:151], v[88:91]
    s_bfe_u32 s17, s14, 0x40000
    s_waitcnt lgkmcnt(0)
    v_mfma_f32_16x16x32_bf16 v[78:81], v[128:131], v[140:143], v[78:81]
    ds_read2_b32 v[136:137], v64 offset0:144 offset1:145
    ds_read2_b32 v[138:139], v64 offset0:146 offset1:147
    v_mfma_f32_16x16x32_bf16 v[78:81], v[96:99], v[100:103], v[78:81]
    ds_read_b128 v[116:119], v60 offset:4352
    s_lshl_b32 s17, s17, 8
    v_mfma_f32_16x16x32_bf16 v[84:87], v[128:131], v[124:127], v[84:87]
    s_add_u32 s20, s16, s17
    s_add_u32 m0, s18, 32768
    v_mfma_f32_16x16x32_bf16 v[84:87], v[104:107], v[100:103], v[84:87]
    buffer_load_dwordx4 v7, s[8:11], s20 offen sc0 sc1 lds
    v_mfma_f32_16x16x32_bf16 v[88:91], v[128:131], v[108:111], v[88:91]
    buffer_load_dwordx4 a[216:219], v17, s[8:11], s12 offen offset:2048 sc0 sc1
    v_mfma_f32_16x16x32_bf16 v[88:91], v[112:115], v[100:103], v[88:91]
    s_add_u32 m0, s18, 33792
    s_nop 0
    buffer_load_dwordx4 v8, s[8:11], s20 offen sc0 sc1 lds
    v_mfma_f32_16x16x32_bf16 v[92:95], v[128:131], v[148:151], v[92:95]
    ds_read2_b32 v[144:145], v65 offset0:16 offset1:17
    ds_read2_b32 v[146:147], v65 offset0:18 offset1:19
    v_mfma_f32_16x16x32_bf16 v[92:95], v[120:123], v[100:103], v[92:95]
    ds_read_b128 v[132:135], v60 offset:2304
    s_waitcnt lgkmcnt(3)
    v_mfma_f32_16x16x32_bf16 v[84:87], v[136:139], v[140:143], v[84:87]
    buffer_load_dwordx4 a[220:223], v17, s[8:11], s12 offen offset:3072 sc0 sc1
    v_mfma_f32_16x16x32_bf16 v[84:87], v[96:99], v[116:119], v[84:87]
    s_add_u32 m0, s18, 34816
    s_nop 0
    buffer_load_dwordx4 v9, s[8:11], s20 offen sc0 sc1 lds
    v_mfma_f32_16x16x32_bf16 v[88:91], v[136:139], v[124:127], v[88:91]
    ds_read2_b32 v[128:129], v65 offset0:144 offset1:145
    ds_read2_b32 v[130:131], v65 offset0:146 offset1:147
    v_mfma_f32_16x16x32_bf16 v[88:91], v[104:107], v[116:119], v[88:91]
    ds_read_b128 v[148:151], v60 offset:256
    s_bfe_u32 s7, s15, 0x40014
    v_mfma_f32_16x16x32_bf16 v[92:95], v[136:139], v[108:111], v[92:95]
    ds_read2_b32 v[120:121], v57 offset0:0 offset1:1
    ds_read2_b32 v[122:123], v57 offset0:2 offset1:3
    v_mfma_f32_16x16x32_bf16 v[92:95], v[112:115], v[116:119], v[92:95]
    ds_read_b128 v[100:103], v61 offset:14336
    s_waitcnt lgkmcnt(6)
    v_mfma_f32_16x16x32_bf16 v[88:91], v[144:147], v[140:143], v[88:91]
    ds_read2_b32 v[136:137], v57 offset0:128 offset1:129
    ds_read2_b32 v[138:139], v57 offset0:130 offset1:131
    v_mfma_f32_16x16x32_bf16 v[88:91], v[96:99], v[132:135], v[88:91]
    ds_read_b128 v[108:111], v61 offset:12288
    s_lshl_b32 s7, s7, 12
    v_mfma_f32_16x16x32_bf16 v[92:95], v[144:147], v[124:127], v[92:95]
    ds_read2_b32 v[112:113], v63 offset0:0 offset1:1
    ds_read2_b32 v[114:115], v63 offset0:2 offset1:3
    v_mfma_f32_16x16x32_bf16 v[92:95], v[104:107], v[132:135], v[92:95]
    ds_read_b128 v[116:119], v61 offset:10240
    s_waitcnt lgkmcnt(6)
    v_mfma_f32_16x16x32_bf16 v[92:95], v[128:131], v[140:143], v[92:95]
    s_add_u32 s12, s6, s7
    buffer_load_dwordx4 a[224:227], v17, s[8:11], s12 offen offset:0 sc0 sc1
    v_mfma_f32_16x16x32_bf16 v[92:95], v[96:99], v[148:151], v[92:95]
    s_add_u32 m0, s18, 35840
    s_nop 0
    buffer_load_dwordx4 v10, s[8:11], s20 offen sc0 sc1 lds
    v_mfma_f32_16x16x32_bf16 v[46:49], v[120:123], v[100:103], v[46:49]
    buffer_load_dwordx4 a[228:231], v17, s[8:11], s12 offen offset:1024 sc0 sc1
    s_waitcnt lgkmcnt(1)
    v_mfma_f32_16x16x32_bf16 v[66:69], v[136:139], v[100:103], v[66:69]
    ds_read2_b32 v[144:145], v63 offset0:128 offset1:129
    ds_read2_b32 v[146:147], v63 offset0:130 offset1:131
    v_mfma_f32_16x16x32_bf16 v[66:69], v[120:123], v[108:111], v[66:69]
    ds_read_b128 v[124:127], v61 offset:8192
    s_add_u32 s21, s20, 65536
    v_mfma_f32_16x16x32_bf16 v[70:73], v[136:139], v[108:111], v[70:73]
    s_add_u32 m0, s18, 36864
    s_nop 0
    buffer_load_dwordx4 v7, s[8:11], s21 offen sc0 sc1 lds
    v_mfma_f32_16x16x32_bf16 v[70:73], v[112:115], v[100:103], v[70:73]
    buffer_load_dwordx4 a[232:235], v17, s[8:11], s12 offen offset:2048 sc0 sc1
    s_waitcnt lgkmcnt(3)
    v_mfma_f32_16x16x32_bf16 v[70:73], v[120:123], v[116:119], v[70:73]
    s_add_u32 m0, s18, 37888
    s_nop 0
    buffer_load_dwordx4 v8, s[8:11], s21 offen sc0 sc1 lds
    v_mfma_f32_16x16x32_bf16 v[74:77], v[112:115], v[108:111], v[74:77]
    buffer_load_dwordx4 a[236:239], v17, s[8:11], s12 offen offset:3072 sc0 sc1
    v_mfma_f32_16x16x32_bf16 v[74:77], v[136:139], v[116:119], v[74:77]
    v_mfma_f32_16x16x32_bf16 v[78:81], v[112:115], v[116:119], v[78:81]
    ds_read2_b32 v[104:105], v64 offset0:0 offset1:1
    s_waitcnt lgkmcnt(1)
    v_mfma_f32_16x16x32_bf16 v[74:77], v[144:147], v[100:103], v[74:77]
    ds_read2_b32 v[106:107], v64 offset0:2 offset1:3
    ds_read_b128 v[132:135], v61 offset:6144
    v_mfma_f32_16x16x32_bf16 v[74:77], v[120:123], v[124:127], v[74:77]
    s_add_u32 m0, s18, 38912
    s_nop 0
    buffer_load_dwordx4 v9, s[8:11], s21 offen sc0 sc1 lds
    v_mfma_f32_16x16x32_bf16 v[78:81], v[144:147], v[108:111], v[78:81]
    s_bfe_u32 s7, s15, 0x40018
    s_lshl_b32 s7, s7, 12
    v_mfma_f32_16x16x32_bf16 v[78:81], v[136:139], v[124:127], v[78:81]
    s_add_u32 s12, s6, s7
    buffer_load_dwordx4 a[240:243], v17, s[8:11], s12 offen offset:0 sc0 sc1
    v_mfma_f32_16x16x32_bf16 v[84:87], v[144:147], v[116:119], v[84:87]
    v_mfma_f32_16x16x32_bf16 v[84:87], v[112:115], v[124:127], v[84:87]
    s_add_u32 m0, s18, 39936
    s_nop 0
    buffer_load_dwordx4 v10, s[8:11], s21 offen sc0 sc1 lds
    v_mfma_f32_16x16x32_bf16 v[88:91], v[144:147], v[124:127], v[88:91]
    buffer_load_dwordx4 a[244:247], v17, s[8:11], s12 offen offset:1024 sc0 sc1
    s_waitcnt lgkmcnt(0)
    v_mfma_f32_16x16x32_bf16 v[78:81], v[104:107], v[100:103], v[78:81]
    ds_read2_b32 v[128:129], v64 offset0:128 offset1:129
    ds_read2_b32 v[130:131], v64 offset0:130 offset1:131
    v_mfma_f32_16x16x32_bf16 v[78:81], v[120:123], v[132:135], v[78:81]
    ds_read_b128 v[140:143], v61 offset:4096
    v_mfma_f32_16x16x32_bf16 v[84:87], v[104:107], v[108:111], v[84:87]
    v_mfma_f32_16x16x32_bf16 v[84:87], v[136:139], v[132:135], v[84:87]
    v_mfma_f32_16x16x32_bf16 v[88:91], v[104:107], v[116:119], v[88:91]
    buffer_load_dwordx4 a[248:251], v17, s[8:11], s12 offen offset:2048 sc0 sc1
    v_mfma_f32_16x16x32_bf16 v[88:91], v[112:115], v[132:135], v[88:91]
    v_mfma_f32_16x16x32_bf16 v[92:95], v[104:107], v[124:127], v[92:95]
    ds_read2_b32 v[96:97], v65 offset0:0 offset1:1
    ds_read2_b32 v[98:99], v65 offset0:2 offset1:3
    v_mfma_f32_16x16x32_bf16 v[92:95], v[144:147], v[132:135], v[92:95]
    ds_read_b128 v[148:151], v61 offset:2048
    s_waitcnt lgkmcnt(3)
    v_mfma_f32_16x16x32_bf16 v[84:87], v[128:131], v[100:103], v[84:87]
    v_mfma_f32_16x16x32_bf16 v[84:87], v[120:123], v[140:143], v[84:87]
    buffer_load_dwordx4 a[252:255], v17, s[8:11], s12 offen offset:3072 sc0 sc1
    v_mfma_f32_16x16x32_bf16 v[88:91], v[128:131], v[108:111], v[88:91]
    ds_read2_b32 v[104:105], v65 offset0:128 offset1:129
    ds_read2_b32 v[106:107], v65 offset0:130 offset1:131
    v_mfma_f32_16x16x32_bf16 v[88:91], v[136:139], v[140:143], v[88:91]
    ds_read_b128 v[124:127], v61 offset:0
    v_mfma_f32_16x16x32_bf16 v[92:95], v[128:131], v[116:119], v[92:95]
    v_mfma_f32_16x16x32_bf16 v[92:95], v[112:115], v[140:143], v[92:95]
    s_waitcnt lgkmcnt(3)
    v_mfma_f32_16x16x32_bf16 v[88:91], v[96:99], v[100:103], v[88:91]
    v_mfma_f32_16x16x32_bf16 v[88:91], v[120:123], v[148:151], v[88:91]
    v_mfma_f32_16x16x32_bf16 v[92:95], v[96:99], v[108:111], v[92:95]
    v_mfma_f32_16x16x32_bf16 v[92:95], v[136:139], v[148:151], v[92:95]
    s_waitcnt lgkmcnt(0)
    v_mfma_f32_16x16x32_bf16 v[92:95], v[104:107], v[100:103], v[92:95]
    v_mfma_f32_16x16x32_bf16 v[92:95], v[120:123], v[124:127], v[92:95]
    s_barrier
    ds_read_b128 v[96:99], v4 offset:0
    ds_read_b128 v[100:103], v4 offset:8192
    ds_read_b128 v[104:107], v18 offset:0
    ds_read_b128 v[108:111], v18 offset:8192
    s_bfe_u32 s17, s14, 0x40004
    s_lshl_b32 s17, s17, 8
    s_add_u32 s20, s16, s17
    s_add_u32 m0, s18, 65536
    s_waitcnt lgkmcnt(3)
    v_mfma_f32_32x32x16_bf16 v[128:143], v[96:99], a[0:3], 0
    ds_read_b128 v[112:115], v5 offset:0
    ds_read_b128 v[116:119], v5 offset:8192
    buffer_load_dwordx4 v7, s[8:11], s20 offen sc0 sc1 lds
    ds_read_b64 v[26:27], v62 offset:14336
    ds_read_b64 v[32:33], v62 offset:12288
    ds_read_b64 v[50:51], v62 offset:10240
    ds_read_b64 v[54:55], v62 offset:8192
    ds_read_b64 v[176:177], v62 offset:6144
    ds_read_b64 v[178:179], v62 offset:4096
    s_add_u32 m0, s18, 66560
    s_waitcnt lgkmcnt(10)
    v_mfma_f32_32x32x16_bf16 v[144:159], v[100:103], a[0:3], 0
    ds_read_b128 v[120:123], v19 offset:0
    ds_read_b128 v[124:127], v19 offset:8192
    buffer_load_dwordx4 v8, s[8:11], s20 offen sc0 sc1 lds
    ds_read_b64 v[200:201], v62 offset:2048
    ds_read_b64 v[202:203], v62 offset:0
    s_add_u32 s4, s22, 12582912
    s_waitcnt lgkmcnt(9)
    v_and_b32 v204, s5, v27
    v_lshlrev_b32 v205, 16, v27
    v_and_b32 v206, s5, v26
    s_add_u32 m0, s18, 67584
    v_mfma_f32_32x32x16_bf16 v[160:175], v[104:107], a[0:3], 0
    buffer_load_dwordx4 v9, s[8:11], s20 offen sc0 sc1 lds
    v_lshlrev_b32 v207, 16, v26
    v_fmac_f32 v46, v183, v204
    v_fmac_f32 v47, v183, v205
    v_fmac_f32 v48, v183, v206
    v_fmac_f32 v49, v183, v207
    v_cvt_pk_bf16_f32 v208, v46, v47
    v_cvt_pk_bf16_f32 v209, v48, v49
    s_waitcnt lgkmcnt(8)
    v_and_b32 v204, s5, v33
    s_add_u32 m0, s18, 68608
    v_mfma_f32_32x32x16_bf16 v[184:199], v[108:111], a[0:3], 0
    buffer_load_dwordx4 v10, s[8:11], s20 offen sc0 sc1 lds
    v_lshlrev_b32 v205, 16, v33
    v_and_b32 v206, s5, v32
    v_lshlrev_b32 v207, 16, v32
    v_fmac_f32 v66, v183, v204
    v_fmac_f32 v67, v183, v205
    v_fmac_f32 v68, v183, v206
    v_fmac_f32 v69, v183, v207
    v_cvt_pk_bf16_f32 v210, v66, v67
    v_cvt_pk_bf16_f32 v211, v68, v69
    s_add_u32 s21, s20, 65536
    s_add_u32 m0, s18, 69632
    v_mfma_f32_32x32x16_bf16 v[128:143], v[112:115], a[4:7], v[128:143]
    ds_read_b128 v[96:99], v11 offset:0
    ds_read_b128 v[100:103], v11 offset:8192
    buffer_load_dwordx4 v7, s[8:11], s21 offen sc0 sc1 lds
    v_permlane16_swap_b32 v208, v210
    v_permlane16_swap_b32 v209, v211
    s_waitcnt lgkmcnt(9)
    v_and_b32 v204, s5, v51
    v_lshlrev_b32 v205, 16, v51
    v_and_b32 v206, s5, v50
    v_lshlrev_b32 v207, 16, v50
    s_add_u32 m0, s18, 70656
    v_mfma_f32_32x32x16_bf16 v[144:159], v[116:119], a[4:7], v[144:159]
    ds_read_b128 v[104:107], v20 offset:0
    ds_read_b128 v[108:111], v20 offset:8192
    buffer_load_dwordx4 v8, s[8:11], s21 offen sc0 sc1 lds
    v_fmac_f32 v70, v183, v204
    v_fmac_f32 v71, v183, v205
    v_fmac_f32 v72, v183, v206
    v_fmac_f32 v73, v183, v207
    v_cvt_pk_bf16_f32 v212, v70, v71
    v_cvt_pk_bf16_f32 v213, v72, v73
    s_add_u32 m0, s18, 71680
    s_waitcnt lgkmcnt(7)
    v_mfma_f32_32x32x16_bf16 v[160:175], v[120:123], a[4:7], v[160:175]
    buffer_load_dwordx4 v9, s[8:11], s21 offen sc0 sc1 lds
    v_and_b32 v204, s5, v55
    v_lshlrev_b32 v205, 16, v55
    v_and_b32 v206, s5, v54
    v_lshlrev_b32 v207, 16, v54
    v_fmac_f32 v74, v183, v204
    v_fmac_f32 v75, v183, v205
    v_fmac_f32 v76, v183, v206
    v_fmac_f32 v77, v183, v207
    s_add_u32 m0, s18, 72704
    s_waitcnt lgkmcnt(6)
    v_mfma_f32_32x32x16_bf16 v[184:199], v[124:127], a[4:7], v[184:199]
    buffer_load_dwordx4 v10, s[8:11], s21 offen sc0 sc1 lds
    v_cvt_pk_bf16_f32 v214, v74, v75
    v_cvt_pk_bf16_f32 v215, v76, v77
    s_nop 0
    v_permlane16_swap_b32 v212, v214
    v_permlane16_swap_b32 v213, v215
    v_and_b32 v204, s5, v177
    v_lshlrev_b32 v205, 16, v177
    v_and_b32 v206, s5, v176
    v_lshlrev_b32 v207, 16, v176
    v_fmac_f32 v78, v183, v204
    s_bfe_u32 s17, s14, 0x40008
    s_lshl_b32 s17, s17, 8
    s_add_u32 s20, s16, s17
    s_add_u32 m0, s18, 98304
    s_waitcnt lgkmcnt(3)
    v_mfma_f32_32x32x16_bf16 v[128:143], v[96:99], a[8:11], v[128:143]
    ds_read_b128 v[112:115], v12 offset:0
    ds_read_b128 v[116:119], v12 offset:8192
    buffer_load_dwordx4 v7, s[8:11], s20 offen sc0 sc1 lds
    v_fmac_f32 v79, v183, v205
    v_fmac_f32 v80, v183, v206
    v_fmac_f32 v81, v183, v207
    v_cvt_pk_bf16_f32 v216, v78, v79
    v_cvt_pk_bf16_f32 v217, v80, v81
    v_and_b32 v204, s5, v179
    s_add_u32 m0, s18, 99328
    s_waitcnt lgkmcnt(4)
    v_mfma_f32_32x32x16_bf16 v[144:159], v[100:103], a[8:11], v[144:159]
    ds_read_b128 v[120:123], v21 offset:0
    ds_read_b128 v[124:127], v21 offset:8192
    buffer_load_dwordx4 v8, s[8:11], s20 offen sc0 sc1 lds
    v_lshlrev_b32 v205, 16, v179
    v_and_b32 v206, s5, v178
    v_lshlrev_b32 v207, 16, v178
    v_fmac_f32 v84, v183, v204
    v_fmac_f32 v85, v183, v205
    v_fmac_f32 v86, v183, v206
    s_add_u32 m0, s18, 100352
    s_waitcnt lgkmcnt(5)
    v_mfma_f32_32x32x16_bf16 v[160:175], v[104:107], a[8:11], v[160:175]
    buffer_load_dwordx4 v9, s[8:11], s20 offen sc0 sc1 lds
    v_fmac_f32 v87, v183, v207
    v_cvt_pk_bf16_f32 v218, v84, v85
    v_cvt_pk_bf16_f32 v219, v86, v87
    s_nop 0
    v_permlane16_swap_b32 v216, v218
    v_permlane16_swap_b32 v217, v219
    v_and_b32 v204, s5, v201
    v_lshlrev_b32 v205, 16, v201
    v_and_b32 v206, s5, v200
    s_add_u32 m0, s18, 101376
    s_waitcnt lgkmcnt(4)
    v_mfma_f32_32x32x16_bf16 v[184:199], v[108:111], a[8:11], v[184:199]
    buffer_load_dwordx4 v10, s[8:11], s20 offen sc0 sc1 lds
    v_lshlrev_b32 v207, 16, v200
    v_fmac_f32 v88, v183, v204
    v_fmac_f32 v89, v183, v205
    v_fmac_f32 v90, v183, v206
    v_fmac_f32 v91, v183, v207
    v_cvt_pk_bf16_f32 v220, v88, v89
    v_cvt_pk_bf16_f32 v221, v90, v91
    v_and_b32 v204, s5, v203
    v_lshlrev_b32 v205, 16, v203
    s_waitcnt lgkmcnt(0)
    s_waitcnt vmcnt(15)
    s_barrier
    s_add_u32 s21, s20, 65536
    s_add_u32 m0, s18, 102400
    v_mfma_f32_32x32x16_bf16 v[128:143], v[112:115], a[12:15], v[128:143]
    ds_read_b128 v[96:99], v4 offset:32768
    ds_read_b128 v[100:103], v4 offset:40960
    buffer_load_dwordx4 v7, s[8:11], s21 offen sc0 sc1 lds
    v_and_b32 v206, s5, v202
    v_lshlrev_b32 v207, 16, v202
    v_fmac_f32 v92, v183, v204
    v_fmac_f32 v93, v183, v205
    v_fmac_f32 v94, v183, v206
    v_fmac_f32 v95, v183, v207
    s_add_u32 m0, s18, 103424
    v_mfma_f32_32x32x16_bf16 v[144:159], v[116:119], a[12:15], v[144:159]
    ds_read_b128 v[104:107], v18 offset:32768
    ds_read_b128 v[108:111], v18 offset:40960
    buffer_load_dwordx4 v8, s[8:11], s21 offen sc0 sc1 lds
    v_cvt_pk_bf16_f32 v222, v92, v93
    v_cvt_pk_bf16_f32 v223, v94, v95
    s_nop 0
    v_permlane16_swap_b32 v220, v222
    v_permlane16_swap_b32 v221, v223
    s_add_u32 m0, s18, 104448
    v_mfma_f32_32x32x16_bf16 v[160:175], v[120:123], a[12:15], v[160:175]
    buffer_load_dwordx4 v9, s[8:11], s21 offen sc0 sc1 lds
    s_add_u32 m0, s18, 105472
    v_mfma_f32_32x32x16_bf16 v[184:199], v[124:127], a[12:15], v[184:199]
    buffer_load_dwordx4 v10, s[8:11], s21 offen sc0 sc1 lds
    s_waitcnt lgkmcnt(3)
    v_mfma_f32_32x32x16_bf16 v[128:143], v[96:99], a[16:19], v[128:143]
    ds_read_b128 v[112:115], v5 offset:32768
    ds_read_b128 v[116:119], v5 offset:40960
    buffer_store_dwordx4 v[208:211], v180, s[8:11], s4 offen offset:0 sc0 sc1
    buffer_store_dwordx4 v[212:215], v180, s[8:11], s4 offen offset:1024 sc0 sc1
    buffer_store_dwordx4 v[216:219], v180, s[8:11], s4 offen offset:2048 sc0 sc1
    s_waitcnt lgkmcnt(4)
    v_mfma_f32_32x32x16_bf16 v[144:159], v[100:103], a[16:19], v[144:159]
    ds_read_b128 v[120:123], v19 offset:32768
    ds_read_b128 v[124:127], v19 offset:40960
    s_bfe_u32 s17, s14, 0x4000c
    s_lshl_b32 s17, s17, 8
    s_add_u32 s20, s16, s17
    s_add_u32 m0, s18, 0
    s_waitcnt lgkmcnt(5)
    v_mfma_f32_32x32x16_bf16 v[160:175], v[104:107], a[16:19], v[160:175]
    buffer_load_dwordx4 v7, s[8:11], s20 offen sc0 sc1 lds
    buffer_store_dwordx4 v[220:223], v180, s[8:11], s4 offen offset:3072 sc0 sc1
    s_add_u32 m0, s18, 1024
    s_waitcnt lgkmcnt(4)
    v_mfma_f32_32x32x16_bf16 v[184:199], v[108:111], a[16:19], v[184:199]
    buffer_load_dwordx4 v8, s[8:11], s20 offen sc0 sc1 lds
    s_waitcnt lgkmcnt(3)
    v_mfma_f32_32x32x16_bf16 v[128:143], v[112:115], a[20:23], v[128:143]
    ds_read_b128 v[96:99], v11 offset:32768
    ds_read_b128 v[100:103], v11 offset:40960
    s_waitcnt lgkmcnt(4)
    v_mfma_f32_32x32x16_bf16 v[144:159], v[116:119], a[20:23], v[144:159]
    ds_read_b128 v[104:107], v20 offset:32768
    ds_read_b128 v[108:111], v20 offset:40960
    s_add_u32 m0, s18, 2048
    s_waitcnt lgkmcnt(5)
    v_mfma_f32_32x32x16_bf16 v[160:175], v[120:123], a[20:23], v[160:175]
    buffer_load_dwordx4 v9, s[8:11], s20 offen sc0 sc1 lds
    s_add_u32 m0, s18, 3072
    s_waitcnt lgkmcnt(4)
    v_mfma_f32_32x32x16_bf16 v[184:199], v[124:127], a[20:23], v[184:199]
    buffer_load_dwordx4 v10, s[8:11], s20 offen sc0 sc1 lds
    s_waitcnt lgkmcnt(3)
    v_mfma_f32_32x32x16_bf16 v[128:143], v[96:99], a[24:27], v[128:143]
    ds_read_b128 v[112:115], v12 offset:32768
    ds_read_b128 v[116:119], v12 offset:40960
    s_waitcnt lgkmcnt(4)
    v_mfma_f32_32x32x16_bf16 v[144:159], v[100:103], a[24:27], v[144:159]
    ds_read_b128 v[120:123], v21 offset:32768
    ds_read_b128 v[124:127], v21 offset:40960
    s_add_u32 s21, s20, 65536
    s_add_u32 m0, s18, 4096
    s_waitcnt lgkmcnt(5)
    v_mfma_f32_32x32x16_bf16 v[160:175], v[104:107], a[24:27], v[160:175]
    buffer_load_dwordx4 v7, s[8:11], s21 offen sc0 sc1 lds
    s_add_u32 m0, s18, 5120
    s_waitcnt lgkmcnt(4)
    v_mfma_f32_32x32x16_bf16 v[184:199], v[108:111], a[24:27], v[184:199]
    buffer_load_dwordx4 v8, s[8:11], s21 offen sc0 sc1 lds
    s_waitcnt lgkmcnt(0)
    s_waitcnt vmcnt(18)
    s_barrier
    v_mfma_f32_32x32x16_bf16 v[128:143], v[112:115], a[28:31], v[128:143]
    ds_read_b128 v[96:99], v13 offset:0
    ds_read_b128 v[100:103], v13 offset:8192
    v_mfma_f32_32x32x16_bf16 v[144:159], v[116:119], a[28:31], v[144:159]
    ds_read_b128 v[104:107], v22 offset:0
    ds_read_b128 v[108:111], v22 offset:8192
    s_add_u32 m0, s18, 6144
    v_mfma_f32_32x32x16_bf16 v[160:175], v[120:123], a[28:31], v[160:175]
    buffer_load_dwordx4 v9, s[8:11], s21 offen sc0 sc1 lds
    s_add_u32 m0, s18, 7168
    v_mfma_f32_32x32x16_bf16 v[184:199], v[124:127], a[28:31], v[184:199]
    buffer_load_dwordx4 v10, s[8:11], s21 offen sc0 sc1 lds
    s_waitcnt lgkmcnt(3)
    v_mfma_f32_32x32x16_bf16 v[128:143], v[96:99], a[32:35], v[128:143]
    ds_read_b128 v[112:115], v14 offset:0
    ds_read_b128 v[116:119], v14 offset:8192
    s_waitcnt lgkmcnt(4)
    v_mfma_f32_32x32x16_bf16 v[144:159], v[100:103], a[32:35], v[144:159]
    ds_read_b128 v[120:123], v23 offset:0
    ds_read_b128 v[124:127], v23 offset:8192
    s_bfe_u32 s17, s14, 0x40010
    s_lshl_b32 s17, s17, 8
    s_add_u32 s20, s16, s17
    s_add_u32 m0, s18, 32768
    s_waitcnt lgkmcnt(5)
    v_mfma_f32_32x32x16_bf16 v[160:175], v[104:107], a[32:35], v[160:175]
    buffer_load_dwordx4 v7, s[8:11], s20 offen sc0 sc1 lds
    s_add_u32 m0, s18, 33792
    s_waitcnt lgkmcnt(4)
    v_mfma_f32_32x32x16_bf16 v[184:199], v[108:111], a[32:35], v[184:199]
    buffer_load_dwordx4 v8, s[8:11], s20 offen sc0 sc1 lds
    s_waitcnt lgkmcnt(3)
    v_mfma_f32_32x32x16_bf16 v[128:143], v[112:115], a[36:39], v[128:143]
    ds_read_b128 v[96:99], v15 offset:0
    ds_read_b128 v[100:103], v15 offset:8192
    s_waitcnt lgkmcnt(4)
    v_mfma_f32_32x32x16_bf16 v[144:159], v[116:119], a[36:39], v[144:159]
    ds_read_b128 v[104:107], v24 offset:0
    ds_read_b128 v[108:111], v24 offset:8192
    s_add_u32 m0, s18, 34816
    s_waitcnt lgkmcnt(5)
    v_mfma_f32_32x32x16_bf16 v[160:175], v[120:123], a[36:39], v[160:175]
    buffer_load_dwordx4 v9, s[8:11], s20 offen sc0 sc1 lds
    s_add_u32 m0, s18, 35840
    s_waitcnt lgkmcnt(4)
    v_mfma_f32_32x32x16_bf16 v[184:199], v[124:127], a[36:39], v[184:199]
    buffer_load_dwordx4 v10, s[8:11], s20 offen sc0 sc1 lds
    s_waitcnt lgkmcnt(3)
    v_mfma_f32_32x32x16_bf16 v[128:143], v[96:99], a[40:43], v[128:143]
    ds_read_b128 v[112:115], v16 offset:0
    ds_read_b128 v[116:119], v16 offset:8192
    s_waitcnt lgkmcnt(4)
    v_mfma_f32_32x32x16_bf16 v[144:159], v[100:103], a[40:43], v[144:159]
    ds_read_b128 v[120:123], v25 offset:0
    ds_read_b128 v[124:127], v25 offset:8192
    s_add_u32 s21, s20, 65536
    s_add_u32 m0, s18, 36864
    s_waitcnt lgkmcnt(5)
    v_mfma_f32_32x32x16_bf16 v[160:175], v[104:107], a[40:43], v[160:175]
    buffer_load_dwordx4 v7, s[8:11], s21 offen sc0 sc1 lds
    s_add_u32 m0, s18, 37888
    s_waitcnt lgkmcnt(4)
    v_mfma_f32_32x32x16_bf16 v[184:199], v[108:111], a[40:43], v[184:199]
    buffer_load_dwordx4 v8, s[8:11], s21 offen sc0 sc1 lds
    s_waitcnt lgkmcnt(0)
    s_waitcnt vmcnt(18)
    s_barrier
    v_mfma_f32_32x32x16_bf16 v[128:143], v[112:115], a[44:47], v[128:143]
    ds_read_b128 v[96:99], v13 offset:32768
    ds_read_b128 v[100:103], v13 offset:40960
    v_mfma_f32_32x32x16_bf16 v[144:159], v[116:119], a[44:47], v[144:159]
    ds_read_b128 v[104:107], v22 offset:32768
    ds_read_b128 v[108:111], v22 offset:40960
    s_add_u32 m0, s18, 38912
    v_mfma_f32_32x32x16_bf16 v[160:175], v[120:123], a[44:47], v[160:175]
    buffer_load_dwordx4 v9, s[8:11], s21 offen sc0 sc1 lds
    s_add_u32 m0, s18, 39936
    v_mfma_f32_32x32x16_bf16 v[184:199], v[124:127], a[44:47], v[184:199]
    buffer_load_dwordx4 v10, s[8:11], s21 offen sc0 sc1 lds
    s_waitcnt lgkmcnt(3)
    v_mfma_f32_32x32x16_bf16 v[128:143], v[96:99], a[48:51], v[128:143]
    ds_read_b128 v[112:115], v14 offset:32768
    ds_read_b128 v[116:119], v14 offset:40960
    s_waitcnt lgkmcnt(4)
    v_mfma_f32_32x32x16_bf16 v[144:159], v[100:103], a[48:51], v[144:159]
    ds_read_b128 v[120:123], v23 offset:32768
    ds_read_b128 v[124:127], v23 offset:40960
    s_bfe_u32 s17, s14, 0x40014
    s_lshl_b32 s17, s17, 8
    s_add_u32 s20, s16, s17
    s_add_u32 m0, s18, 65536
    s_waitcnt lgkmcnt(5)
    v_mfma_f32_32x32x16_bf16 v[160:175], v[104:107], a[48:51], v[160:175]
    buffer_load_dwordx4 v7, s[8:11], s20 offen sc0 sc1 lds
    s_add_u32 m0, s18, 66560
    s_waitcnt lgkmcnt(4)
    v_mfma_f32_32x32x16_bf16 v[184:199], v[108:111], a[48:51], v[184:199]
    buffer_load_dwordx4 v8, s[8:11], s20 offen sc0 sc1 lds
    s_waitcnt lgkmcnt(3)
    v_mfma_f32_32x32x16_bf16 v[128:143], v[112:115], a[52:55], v[128:143]
    ds_read_b128 v[96:99], v15 offset:32768
    ds_read_b128 v[100:103], v15 offset:40960
    s_waitcnt lgkmcnt(4)
    v_mfma_f32_32x32x16_bf16 v[144:159], v[116:119], a[52:55], v[144:159]
    ds_read_b128 v[104:107], v24 offset:32768
    ds_read_b128 v[108:111], v24 offset:40960
    s_add_u32 m0, s18, 67584
    s_waitcnt lgkmcnt(5)
    v_mfma_f32_32x32x16_bf16 v[160:175], v[120:123], a[52:55], v[160:175]
    buffer_load_dwordx4 v9, s[8:11], s20 offen sc0 sc1 lds
    s_add_u32 m0, s18, 68608
    s_waitcnt lgkmcnt(4)
    v_mfma_f32_32x32x16_bf16 v[184:199], v[124:127], a[52:55], v[184:199]
    buffer_load_dwordx4 v10, s[8:11], s20 offen sc0 sc1 lds
    s_waitcnt lgkmcnt(3)
    v_mfma_f32_32x32x16_bf16 v[128:143], v[96:99], a[56:59], v[128:143]
    ds_read_b128 v[112:115], v16 offset:32768
    ds_read_b128 v[116:119], v16 offset:40960
    s_waitcnt lgkmcnt(4)
    v_mfma_f32_32x32x16_bf16 v[144:159], v[100:103], a[56:59], v[144:159]
    ds_read_b128 v[120:123], v25 offset:32768
    ds_read_b128 v[124:127], v25 offset:40960
    s_add_u32 s21, s20, 65536
    s_add_u32 m0, s18, 69632
    s_waitcnt lgkmcnt(5)
    v_mfma_f32_32x32x16_bf16 v[160:175], v[104:107], a[56:59], v[160:175]
    buffer_load_dwordx4 v7, s[8:11], s21 offen sc0 sc1 lds
    s_add_u32 m0, s18, 70656
    s_waitcnt lgkmcnt(4)
    v_mfma_f32_32x32x16_bf16 v[184:199], v[108:111], a[56:59], v[184:199]
    buffer_load_dwordx4 v8, s[8:11], s21 offen sc0 sc1 lds
    s_waitcnt lgkmcnt(0)
    s_waitcnt vmcnt(14)
    s_barrier
    v_mfma_f32_32x32x16_bf16 v[128:143], v[112:115], a[60:63], v[128:143]
    ds_read_b128 v[96:99], v4 offset:0
    ds_read_b128 v[100:103], v4 offset:8192
    v_mfma_f32_32x32x16_bf16 v[144:159], v[116:119], a[60:63], v[144:159]
    ds_read_b128 v[104:107], v18 offset:0
    ds_read_b128 v[108:111], v18 offset:8192
    s_add_u32 m0, s18, 71680
    v_mfma_f32_32x32x16_bf16 v[160:175], v[120:123], a[60:63], v[160:175]
    buffer_load_dwordx4 v9, s[8:11], s21 offen sc0 sc1 lds
    s_add_u32 m0, s18, 72704
    v_mfma_f32_32x32x16_bf16 v[184:199], v[124:127], a[60:63], v[184:199]
    buffer_load_dwordx4 v10, s[8:11], s21 offen sc0 sc1 lds
    s_waitcnt lgkmcnt(3)
    v_mfma_f32_32x32x16_bf16 v[128:143], v[96:99], a[64:67], v[128:143]
    ds_read_b128 v[112:115], v5 offset:0
    ds_read_b128 v[116:119], v5 offset:8192
    v_mov_b32 v82, s42
    v_mov_b32 v83, s43
    s_mov_b64 s[22:23], exec
    s_mov_b64 exec, 1
    buffer_store_dwordx2 v[82:83], v6, s[8:11], s13 offen sc0 sc1
    s_mov_b64 exec, s[22:23]
    s_waitcnt lgkmcnt(4)
    v_mfma_f32_32x32x16_bf16 v[144:159], v[100:103], a[64:67], v[144:159]
    ds_read_b128 v[120:123], v19 offset:0
    ds_read_b128 v[124:127], v19 offset:8192
    s_bfe_u32 s17, s14, 0x40018
    s_lshl_b32 s17, s17, 8
    s_add_u32 s20, s16, s17
    s_add_u32 m0, s18, 98304
    s_waitcnt lgkmcnt(5)
    v_mfma_f32_32x32x16_bf16 v[160:175], v[104:107], a[64:67], v[160:175]
    buffer_load_dwordx4 v7, s[8:11], s20 offen sc0 sc1 lds
    s_add_u32 m0, s18, 99328
    s_waitcnt lgkmcnt(4)
    v_mfma_f32_32x32x16_bf16 v[184:199], v[108:111], a[64:67], v[184:199]
    buffer_load_dwordx4 v8, s[8:11], s20 offen sc0 sc1 lds
    s_waitcnt lgkmcnt(3)
    v_mfma_f32_32x32x16_bf16 v[128:143], v[112:115], a[68:71], v[128:143]
    ds_read_b128 v[96:99], v11 offset:0
    ds_read_b128 v[100:103], v11 offset:8192
    s_waitcnt lgkmcnt(4)
    v_mfma_f32_32x32x16_bf16 v[144:159], v[116:119], a[68:71], v[144:159]
    ds_read_b128 v[104:107], v20 offset:0
    ds_read_b128 v[108:111], v20 offset:8192
    s_add_u32 m0, s18, 100352
    s_waitcnt lgkmcnt(5)
    v_mfma_f32_32x32x16_bf16 v[160:175], v[120:123], a[68:71], v[160:175]
    buffer_load_dwordx4 v9, s[8:11], s20 offen sc0 sc1 lds
    s_add_u32 m0, s18, 101376
    s_waitcnt lgkmcnt(4)
    v_mfma_f32_32x32x16_bf16 v[184:199], v[124:127], a[68:71], v[184:199]
    buffer_load_dwordx4 v10, s[8:11], s20 offen sc0 sc1 lds
    s_waitcnt lgkmcnt(3)
    v_mfma_f32_32x32x16_bf16 v[128:143], v[96:99], a[72:75], v[128:143]
    ds_read_b128 v[112:115], v12 offset:0
    ds_read_b128 v[116:119], v12 offset:8192
    s_waitcnt lgkmcnt(4)
    v_mfma_f32_32x32x16_bf16 v[144:159], v[100:103], a[72:75], v[144:159]
    ds_read_b128 v[120:123], v21 offset:0
    ds_read_b128 v[124:127], v21 offset:8192
    s_add_u32 s21, s20, 65536
    s_add_u32 m0, s18, 102400
    s_waitcnt lgkmcnt(5)
    v_mfma_f32_32x32x16_bf16 v[160:175], v[104:107], a[72:75], v[160:175]
    buffer_load_dwordx4 v7, s[8:11], s21 offen sc0 sc1 lds
    s_add_u32 m0, s18, 103424
    s_waitcnt lgkmcnt(4)
    v_mfma_f32_32x32x16_bf16 v[184:199], v[108:111], a[72:75], v[184:199]
    buffer_load_dwordx4 v8, s[8:11], s21 offen sc0 sc1 lds
    s_waitcnt lgkmcnt(0)
    s_waitcnt vmcnt(15)
    s_barrier
    v_mfma_f32_32x32x16_bf16 v[128:143], v[112:115], a[76:79], v[128:143]
    ds_read_b128 v[96:99], v4 offset:32768
    ds_read_b128 v[100:103], v4 offset:40960
    v_mfma_f32_32x32x16_bf16 v[144:159], v[116:119], a[76:79], v[144:159]
    ds_read_b128 v[104:107], v18 offset:32768
    ds_read_b128 v[108:111], v18 offset:40960
    s_add_u32 m0, s18, 104448
    v_mfma_f32_32x32x16_bf16 v[160:175], v[120:123], a[76:79], v[160:175]
    buffer_load_dwordx4 v9, s[8:11], s21 offen sc0 sc1 lds
    s_add_u32 m0, s18, 105472
    v_mfma_f32_32x32x16_bf16 v[184:199], v[124:127], a[76:79], v[184:199]
    buffer_load_dwordx4 v10, s[8:11], s21 offen sc0 sc1 lds
    s_waitcnt lgkmcnt(3)
    v_mfma_f32_32x32x16_bf16 v[128:143], v[96:99], a[80:83], v[128:143]
    ds_read_b128 v[112:115], v5 offset:32768
    ds_read_b128 v[116:119], v5 offset:40960
    s_add_u32 m0, s47, 131072
    s_nop 0
    buffer_load_dwordx4 v35, s[56:59], s31 offen lds
    s_add_u32 s31, s31, 16384
    s_add_u32 m0, s47, 132096
    s_nop 0
    buffer_load_dwordx4 v35, s[56:59], s31 offen lds
    s_waitcnt lgkmcnt(4)
    v_mfma_f32_32x32x16_bf16 v[144:159], v[100:103], a[80:83], v[144:159]
    ds_read_b128 v[120:123], v19 offset:32768
    ds_read_b128 v[124:127], v19 offset:40960
    s_bfe_u32 s17, s14, 0x4001c
    s_lshl_b32 s17, s17, 8
    s_add_u32 s20, s16, s17
    s_add_u32 m0, s18, 0
    s_waitcnt lgkmcnt(5)
    v_mfma_f32_32x32x16_bf16 v[160:175], v[104:107], a[80:83], v[160:175]
    buffer_load_dwordx4 v7, s[8:11], s20 offen sc0 sc1 lds
    s_add_u32 s31, s31, 16384
    s_add_u32 m0, s47, 133120
    s_nop 0
    buffer_load_dwordx4 v35, s[56:59], s31 offen lds
    s_add_u32 s31, s31, 16384
    s_add_u32 m0, s18, 1024
    s_waitcnt lgkmcnt(4)
    v_mfma_f32_32x32x16_bf16 v[184:199], v[108:111], a[80:83], v[184:199]
    buffer_load_dwordx4 v8, s[8:11], s20 offen sc0 sc1 lds
    s_add_u32 m0, s47, 134144
    s_nop 0
    buffer_load_dwordx4 v35, s[56:59], s31 offen lds
    s_lshr_b32 s3, s47, 2
    s_add_u32 m0, s3, 147456
    s_nop 0
    buffer_load_dwordx4 v38, s[8:11], 0 offen sc0 sc1 lds
    s_waitcnt lgkmcnt(3)
    v_mfma_f32_32x32x16_bf16 v[128:143], v[112:115], a[84:87], v[128:143]
    ds_read_b128 v[96:99], v11 offset:32768
    ds_read_b128 v[100:103], v11 offset:40960
    s_waitcnt lgkmcnt(4)
    v_mfma_f32_32x32x16_bf16 v[144:159], v[116:119], a[84:87], v[144:159]
    ds_read_b128 v[104:107], v20 offset:32768
    ds_read_b128 v[108:111], v20 offset:40960
    s_add_u32 m0, s18, 2048
    s_waitcnt lgkmcnt(5)
    v_mfma_f32_32x32x16_bf16 v[160:175], v[120:123], a[84:87], v[160:175]
    buffer_load_dwordx4 v9, s[8:11], s20 offen sc0 sc1 lds
    s_add_u32 m0, s18, 3072
    s_waitcnt lgkmcnt(4)
    v_mfma_f32_32x32x16_bf16 v[184:199], v[124:127], a[84:87], v[184:199]
    buffer_load_dwordx4 v10, s[8:11], s20 offen sc0 sc1 lds
    s_waitcnt lgkmcnt(3)
    v_mfma_f32_32x32x16_bf16 v[128:143], v[96:99], a[88:91], v[128:143]
    ds_read_b128 v[112:115], v12 offset:32768
    ds_read_b128 v[116:119], v12 offset:40960
    s_waitcnt lgkmcnt(4)
    v_mfma_f32_32x32x16_bf16 v[144:159], v[100:103], a[88:91], v[144:159]
    ds_read_b128 v[120:123], v21 offset:32768
    ds_read_b128 v[124:127], v21 offset:40960
    s_add_u32 s21, s20, 65536
    s_add_u32 m0, s18, 4096
    s_waitcnt lgkmcnt(5)
    v_mfma_f32_32x32x16_bf16 v[160:175], v[104:107], a[88:91], v[160:175]
    buffer_load_dwordx4 v7, s[8:11], s21 offen sc0 sc1 lds
    s_add_u32 m0, s18, 5120
    s_waitcnt lgkmcnt(4)
    v_mfma_f32_32x32x16_bf16 v[184:199], v[108:111], a[88:91], v[184:199]
    buffer_load_dwordx4 v8, s[8:11], s21 offen sc0 sc1 lds
    s_waitcnt lgkmcnt(0)
    s_waitcnt vmcnt(20)
    s_barrier
    v_mfma_f32_32x32x16_bf16 v[128:143], v[112:115], a[92:95], v[128:143]
    ds_read_b128 v[96:99], v13 offset:0
    ds_read_b128 v[100:103], v13 offset:8192
    v_mfma_f32_32x32x16_bf16 v[144:159], v[116:119], a[92:95], v[144:159]
    ds_read_b128 v[104:107], v22 offset:0
    ds_read_b128 v[108:111], v22 offset:8192
    s_add_u32 m0, s18, 6144
    v_mfma_f32_32x32x16_bf16 v[160:175], v[120:123], a[92:95], v[160:175]
    buffer_load_dwordx4 v9, s[8:11], s21 offen sc0 sc1 lds
    s_add_u32 m0, s18, 7168
    v_mfma_f32_32x32x16_bf16 v[184:199], v[124:127], a[92:95], v[184:199]
    buffer_load_dwordx4 v10, s[8:11], s21 offen sc0 sc1 lds
    s_waitcnt lgkmcnt(3)
    v_mfma_f32_32x32x16_bf16 v[128:143], v[96:99], a[96:99], v[128:143]
    ds_read_b128 v[112:115], v14 offset:0
    ds_read_b128 v[116:119], v14 offset:8192
    s_waitcnt lgkmcnt(4)
    v_mfma_f32_32x32x16_bf16 v[144:159], v[100:103], a[96:99], v[144:159]
    ds_read_b128 v[120:123], v23 offset:0
    ds_read_b128 v[124:127], v23 offset:8192
    s_bfe_u32 s17, s15, 0x40000
    s_lshl_b32 s17, s17, 8
    s_add_u32 s20, s16, s17
    s_add_u32 m0, s18, 32768
    s_waitcnt lgkmcnt(5)
    v_mfma_f32_32x32x16_bf16 v[160:175], v[104:107], a[96:99], v[160:175]
    buffer_load_dwordx4 v7, s[8:11], s20 offen sc0 sc1 lds
    s_add_u32 m0, s18, 33792
    s_waitcnt lgkmcnt(4)
    v_mfma_f32_32x32x16_bf16 v[184:199], v[108:111], a[96:99], v[184:199]
    buffer_load_dwordx4 v8, s[8:11], s20 offen sc0 sc1 lds
    s_waitcnt lgkmcnt(3)
    v_mfma_f32_32x32x16_bf16 v[128:143], v[112:115], a[100:103], v[128:143]
    ds_read_b128 v[96:99], v15 offset:0
    ds_read_b128 v[100:103], v15 offset:8192
    s_waitcnt lgkmcnt(4)
    v_mfma_f32_32x32x16_bf16 v[144:159], v[116:119], a[100:103], v[144:159]
    ds_read_b128 v[104:107], v24 offset:0
    ds_read_b128 v[108:111], v24 offset:8192
    s_add_u32 m0, s18, 34816
    s_waitcnt lgkmcnt(5)
    v_mfma_f32_32x32x16_bf16 v[160:175], v[120:123], a[100:103], v[160:175]
    buffer_load_dwordx4 v9, s[8:11], s20 offen sc0 sc1 lds
    s_add_u32 m0, s18, 35840
    s_waitcnt lgkmcnt(4)
    v_mfma_f32_32x32x16_bf16 v[184:199], v[124:127], a[100:103], v[184:199]
    buffer_load_dwordx4 v10, s[8:11], s20 offen sc0 sc1 lds
    s_waitcnt lgkmcnt(3)
    v_mfma_f32_32x32x16_bf16 v[128:143], v[96:99], a[104:107], v[128:143]
    ds_read_b128 v[112:115], v16 offset:0
    ds_read_b128 v[116:119], v16 offset:8192
    s_waitcnt lgkmcnt(4)
    v_mfma_f32_32x32x16_bf16 v[144:159], v[100:103], a[104:107], v[144:159]
    ds_read_b128 v[120:123], v25 offset:0
    ds_read_b128 v[124:127], v25 offset:8192
    s_add_u32 s21, s20, 65536
    s_add_u32 m0, s18, 36864
    s_waitcnt lgkmcnt(5)
    v_mfma_f32_32x32x16_bf16 v[160:175], v[104:107], a[104:107], v[160:175]
    buffer_load_dwordx4 v7, s[8:11], s21 offen sc0 sc1 lds
    s_add_u32 m0, s18, 37888
    s_waitcnt lgkmcnt(4)
    v_mfma_f32_32x32x16_bf16 v[184:199], v[108:111], a[104:107], v[184:199]
    buffer_load_dwordx4 v8, s[8:11], s21 offen sc0 sc1 lds
    s_waitcnt lgkmcnt(0)
    s_waitcnt vmcnt(19)
    s_barrier
    v_mfma_f32_32x32x16_bf16 v[128:143], v[112:115], a[108:111], v[128:143]
    ds_read_b128 v[96:99], v13 offset:32768
    ds_read_b128 v[100:103], v13 offset:40960
    v_mfma_f32_32x32x16_bf16 v[144:159], v[116:119], a[108:111], v[144:159]
    ds_read_b128 v[104:107], v22 offset:32768
    ds_read_b128 v[108:111], v22 offset:40960
    s_add_u32 m0, s18, 38912
    v_mfma_f32_32x32x16_bf16 v[160:175], v[120:123], a[108:111], v[160:175]
    buffer_load_dwordx4 v9, s[8:11], s21 offen sc0 sc1 lds
    s_add_u32 m0, s18, 39936
    v_mfma_f32_32x32x16_bf16 v[184:199], v[124:127], a[108:111], v[184:199]
    buffer_load_dwordx4 v10, s[8:11], s21 offen sc0 sc1 lds
    s_waitcnt lgkmcnt(3)
    v_mfma_f32_32x32x16_bf16 v[128:143], v[96:99], a[112:115], v[128:143]
    ds_read_b128 v[112:115], v14 offset:32768
    ds_read_b128 v[116:119], v14 offset:40960
    s_waitcnt vmcnt(14)
    ds_read_b128 v[46:49], v39 offset:0
    ds_read_b128 v[84:87], v39 offset:256
    s_waitcnt lgkmcnt(6)
    v_mfma_f32_32x32x16_bf16 v[144:159], v[100:103], a[112:115], v[144:159]
    ds_read_b128 v[120:123], v23 offset:32768
    ds_read_b128 v[124:127], v23 offset:40960
    s_bfe_u32 s17, s15, 0x40004
    s_lshl_b32 s17, s17, 8
    s_add_u32 s20, s16, s17
    s_add_u32 m0, s18, 65536
    s_waitcnt lgkmcnt(7)
    v_mfma_f32_32x32x16_bf16 v[160:175], v[104:107], a[112:115], v[160:175]
    buffer_load_dwordx4 v7, s[8:11], s20 offen sc0 sc1 lds
    ds_read_b128 v[54:57], v39 offset:32
    ds_read_b128 v[88:91], v39 offset:288
    ds_read_b128 v[58:61], v39 offset:64
    s_add_u32 m0, s18, 66560
    s_waitcnt lgkmcnt(9)
    v_mfma_f32_32x32x16_bf16 v[184:199], v[108:111], a[112:115], v[184:199]
    buffer_load_dwordx4 v8, s[8:11], s20 offen sc0 sc1 lds
    ds_read_b128 v[92:95], v39 offset:320
    ds_read_b128 v[62:65], v39 offset:96
    ds_read_b128 v[176:179], v39 offset:352
    ds_read_b128 v[66:69], v39 offset:128
    s_waitcnt lgkmcnt(12)
    v_mfma_f32_32x32x16_bf16 v[128:143], v[112:115], a[116:119], v[128:143]
    ds_read_b128 v[96:99], v15 offset:32768
    ds_read_b128 v[100:103], v15 offset:40960
    ds_read_b128 v[200:203], v39 offset:384
    ds_read_b128 v[70:73], v39 offset:160
    ds_read_b128 v[204:207], v39 offset:416
    s_waitcnt lgkmcnt(15)
    v_mfma_f32_32x32x16_bf16 v[144:159], v[116:119], a[116:119], v[144:159]
    ds_read_b128 v[104:107], v24 offset:32768
    ds_read_b128 v[108:111], v24 offset:40960
    ds_read_b128 v[74:77], v39 offset:192
    ds_read_b128 v[208:211], v39 offset:448
    s_add_u32 m0, s18, 67584
    s_waitcnt lgkmcnt(15)
    v_mfma_f32_32x32x16_bf16 v[160:175], v[120:123], a[116:119], v[160:175]
    buffer_load_dwordx4 v9, s[8:11], s20 offen sc0 sc1 lds
    ds_read_b128 v[78:81], v39 offset:224
    ds_read_b128 v[212:215], v39 offset:480
    buffer_load_dwordx2 v[30:31], v29, s[8:11], 0 offen sc0 sc1
    s_add_u32 m0, s18, 68608
    v_mfma_f32_32x32x16_bf16 v[184:199], v[124:127], a[116:119], v[184:199]
    buffer_load_dwordx4 v10, s[8:11], s20 offen sc0 sc1 lds
    s_waitcnt lgkmcnt(10)
    v_mfma_f32_32x32x16_bf16 v[128:143], v[96:99], a[120:123], v[128:143]
    ds_read_b128 v[112:115], v16 offset:32768
    ds_read_b128 v[116:119], v16 offset:40960
    s_waitcnt lgkmcnt(11)
    v_mfma_f32_32x32x16_bf16 v[144:159], v[100:103], a[120:123], v[144:159]
    ds_read_b128 v[120:123], v25 offset:32768
    ds_read_b128 v[124:127], v25 offset:40960
    s_add_u32 s21, s20, 65536
    s_add_u32 m0, s18, 69632
    s_waitcnt lgkmcnt(9)
    v_mfma_f32_32x32x16_bf16 v[160:175], v[104:107], a[120:123], v[160:175]
    buffer_load_dwordx4 v7, s[8:11], s21 offen sc0 sc1 lds
    s_add_u32 m0, s18, 70656
    s_waitcnt lgkmcnt(8)
    v_mfma_f32_32x32x16_bf16 v[184:199], v[108:111], a[120:123], v[184:199]
    buffer_load_dwordx4 v8, s[8:11], s21 offen sc0 sc1 lds
    s_waitcnt lgkmcnt(0)
    s_waitcnt vmcnt(15)
    s_barrier
    v_mfma_f32_32x32x16_bf16 v[128:143], v[112:115], a[124:127], v[128:143]
    ds_read_b128 v[96:99], v4 offset:0
    ds_read_b128 v[100:103], v4 offset:8192
    v_mfma_f32_32x32x16_bf16 v[144:159], v[116:119], a[124:127], v[144:159]
    ds_read_b128 v[104:107], v18 offset:0
    ds_read_b128 v[108:111], v18 offset:8192
    s_add_u32 m0, s18, 71680
    v_mfma_f32_32x32x16_bf16 v[160:175], v[120:123], a[124:127], v[160:175]
    buffer_load_dwordx4 v9, s[8:11], s21 offen sc0 sc1 lds
    s_add_u32 m0, s18, 72704
    v_mfma_f32_32x32x16_bf16 v[184:199], v[124:127], a[124:127], v[184:199]
    buffer_load_dwordx4 v10, s[8:11], s21 offen sc0 sc1 lds
    s_waitcnt lgkmcnt(3)
    v_mfma_f32_32x32x16_bf16 v[128:143], v[96:99], a[128:131], v[128:143]
    ds_read_b128 v[112:115], v5 offset:0
    ds_read_b128 v[116:119], v5 offset:8192
    s_waitcnt lgkmcnt(4)
    v_mfma_f32_32x32x16_bf16 v[144:159], v[100:103], a[128:131], v[144:159]
    ds_read_b128 v[120:123], v19 offset:0
    ds_read_b128 v[124:127], v19 offset:8192
    s_bfe_u32 s17, s15, 0x40008
    s_lshl_b32 s17, s17, 8
    s_add_u32 s20, s16, s17
    s_add_u32 m0, s18, 98304
    s_waitcnt lgkmcnt(5)
    v_mfma_f32_32x32x16_bf16 v[160:175], v[104:107], a[128:131], v[160:175]
    buffer_load_dwordx4 v7, s[8:11], s20 offen sc0 sc1 lds
    s_add_u32 m0, s18, 99328
    s_waitcnt lgkmcnt(4)
    v_mfma_f32_32x32x16_bf16 v[184:199], v[108:111], a[128:131], v[184:199]
    buffer_load_dwordx4 v8, s[8:11], s20 offen sc0 sc1 lds
    s_waitcnt lgkmcnt(3)
    v_mfma_f32_32x32x16_bf16 v[128:143], v[112:115], a[132:135], v[128:143]
    ds_read_b128 v[96:99], v11 offset:0
    ds_read_b128 v[100:103], v11 offset:8192
    s_waitcnt lgkmcnt(4)
    v_mfma_f32_32x32x16_bf16 v[144:159], v[116:119], a[132:135], v[144:159]
    ds_read_b128 v[104:107], v20 offset:0
    ds_read_b128 v[108:111], v20 offset:8192
    s_add_u32 m0, s18, 100352
    s_waitcnt lgkmcnt(5)
    v_mfma_f32_32x32x16_bf16 v[160:175], v[120:123], a[132:135], v[160:175]
    buffer_load_dwordx4 v9, s[8:11], s20 offen sc0 sc1 lds
    s_add_u32 m0, s18, 101376
    s_waitcnt lgkmcnt(4)
    v_mfma_f32_32x32x16_bf16 v[184:199], v[124:127], a[132:135], v[184:199]
    buffer_load_dwordx4 v10, s[8:11], s20 offen sc0 sc1 lds
    s_waitcnt lgkmcnt(3)
    v_mfma_f32_32x32x16_bf16 v[128:143], v[96:99], a[136:139], v[128:143]
    ds_read_b128 v[112:115], v12 offset:0
    ds_read_b128 v[116:119], v12 offset:8192
    s_waitcnt lgkmcnt(4)
    v_mfma_f32_32x32x16_bf16 v[144:159], v[100:103], a[136:139], v[144:159]
    ds_read_b128 v[120:123], v21 offset:0
    ds_read_b128 v[124:127], v21 offset:8192
    s_add_u32 s21, s20, 65536
    s_add_u32 m0, s18, 102400
    s_waitcnt lgkmcnt(5)
    v_mfma_f32_32x32x16_bf16 v[160:175], v[104:107], a[136:139], v[160:175]
    buffer_load_dwordx4 v7, s[8:11], s21 offen sc0 sc1 lds
    s_add_u32 m0, s18, 103424
    s_waitcnt lgkmcnt(4)
    v_mfma_f32_32x32x16_bf16 v[184:199], v[108:111], a[136:139], v[184:199]
    buffer_load_dwordx4 v8, s[8:11], s21 offen sc0 sc1 lds
    s_waitcnt lgkmcnt(0)
    s_waitcnt vmcnt(15)
    s_barrier
    v_mfma_f32_32x32x16_bf16 v[128:143], v[112:115], a[140:143], v[128:143]
    ds_read_b128 v[96:99], v4 offset:32768
    ds_read_b128 v[100:103], v4 offset:40960
    v_mfma_f32_32x32x16_bf16 v[144:159], v[116:119], a[140:143], v[144:159]
    ds_read_b128 v[104:107], v18 offset:32768
    ds_read_b128 v[108:111], v18 offset:40960
    s_add_u32 m0, s18, 104448
    v_mfma_f32_32x32x16_bf16 v[160:175], v[120:123], a[140:143], v[160:175]
    buffer_load_dwordx4 v9, s[8:11], s21 offen sc0 sc1 lds
    s_add_u32 m0, s18, 105472
    v_mfma_f32_32x32x16_bf16 v[184:199], v[124:127], a[140:143], v[184:199]
    buffer_load_dwordx4 v10, s[8:11], s21 offen sc0 sc1 lds
    s_waitcnt lgkmcnt(3)
    v_mfma_f32_32x32x16_bf16 v[128:143], v[96:99], a[144:147], v[128:143]
    ds_read_b128 v[112:115], v5 offset:32768
    ds_read_b128 v[116:119], v5 offset:40960
    s_mov_b32 s4, 0
    s_waitcnt vmcnt(13)
    v_cmp_ne_u64 vcc, s[42:43], v[30:31]
    s_nop 4
    s_cbranch_vccz Lfdone_gate_13
Lfpoll_gate_14:
    buffer_load_dwordx2 v[30:31], v29, s[8:11], 0 offen sc0 sc1
    s_waitcnt vmcnt(0)
    v_cmp_ne_u64 vcc, s[42:43], v[30:31]
    s_nop 4
    s_add_u32 s4, s4, 1
    s_cmp_gt_u32 s4, 20000
    s_cbranch_scc1 Lfdone_gate_13
    s_cbranch_vccnz Lfpoll_gate_14
Lfdone_gate_13:
    s_add_u32 m0, s47, 147456
    s_nop 0
    buffer_load_dwordx4 v7, s[8:11], s38 offen sc0 sc1 lds
    s_add_u32 m0, s47, 148480
    s_nop 0
    buffer_load_dwordx4 v8, s[8:11], s38 offen sc0 sc1 lds
    s_waitcnt lgkmcnt(4)
    v_mfma_f32_32x32x16_bf16 v[144:159], v[100:103], a[144:147], v[144:159]
    ds_read_b128 v[120:123], v19 offset:32768
    ds_read_b128 v[124:127], v19 offset:40960
    s_bfe_u32 s17, s15, 0x4000c
    s_lshl_b32 s17, s17, 8
    s_add_u32 s20, s16, s17
    s_add_u32 m0, s18, 0
    s_waitcnt lgkmcnt(5)
    v_mfma_f32_32x32x16_bf16 v[160:175], v[104:107], a[144:147], v[160:175]
    buffer_load_dwordx4 v7, s[8:11], s20 offen sc0 sc1 lds
    s_add_u32 m0, s47, 149504
    s_nop 0
    buffer_load_dwordx4 v9, s[8:11], s38 offen sc0 sc1 lds
    s_add_u32 m0, s47, 150528
    s_nop 0
    buffer_load_dwordx4 v10, s[8:11], s38 offen sc0 sc1 lds
    s_add_u32 m0, s18, 1024
    s_waitcnt lgkmcnt(4)
    v_mfma_f32_32x32x16_bf16 v[184:199], v[108:111], a[144:147], v[184:199]
    buffer_load_dwordx4 v8, s[8:11], s20 offen sc0 sc1 lds
    s_waitcnt lgkmcnt(3)
    v_mfma_f32_32x32x16_bf16 v[128:143], v[112:115], a[148:151], v[128:143]
    ds_read_b128 v[96:99], v11 offset:32768
    ds_read_b128 v[100:103], v11 offset:40960
    s_waitcnt lgkmcnt(4)
    v_mfma_f32_32x32x16_bf16 v[144:159], v[116:119], a[148:151], v[144:159]
    ds_read_b128 v[104:107], v20 offset:32768
    ds_read_b128 v[108:111], v20 offset:40960
    s_add_u32 m0, s18, 2048
    s_waitcnt lgkmcnt(5)
    v_mfma_f32_32x32x16_bf16 v[160:175], v[120:123], a[148:151], v[160:175]
    buffer_load_dwordx4 v9, s[8:11], s20 offen sc0 sc1 lds
    s_add_u32 m0, s18, 3072
    s_waitcnt lgkmcnt(4)
    v_mfma_f32_32x32x16_bf16 v[184:199], v[124:127], a[148:151], v[184:199]
    buffer_load_dwordx4 v10, s[8:11], s20 offen sc0 sc1 lds
    s_waitcnt lgkmcnt(3)
    v_mfma_f32_32x32x16_bf16 v[128:143], v[96:99], a[152:155], v[128:143]
    ds_read_b128 v[112:115], v12 offset:32768
    ds_read_b128 v[116:119], v12 offset:40960
    s_waitcnt lgkmcnt(4)
    v_mfma_f32_32x32x16_bf16 v[144:159], v[100:103], a[152:155], v[144:159]
    ds_read_b128 v[120:123], v21 offset:32768
    ds_read_b128 v[124:127], v21 offset:40960
    s_add_u32 s21, s20, 65536
    s_add_u32 m0, s18, 4096
    s_waitcnt lgkmcnt(5)
    v_mfma_f32_32x32x16_bf16 v[160:175], v[104:107], a[152:155], v[160:175]
    buffer_load_dwordx4 v7, s[8:11], s21 offen sc0 sc1 lds
    s_add_u32 m0, s18, 5120
    s_waitcnt lgkmcnt(4)
    v_mfma_f32_32x32x16_bf16 v[184:199], v[108:111], a[152:155], v[184:199]
    buffer_load_dwordx4 v8, s[8:11], s21 offen sc0 sc1 lds
    s_waitcnt lgkmcnt(0)
    s_waitcnt vmcnt(18)
    s_barrier
    v_mfma_f32_32x32x16_bf16 v[128:143], v[112:115], a[156:159], v[128:143]
    ds_read_b128 v[96:99], v13 offset:0
    ds_read_b128 v[100:103], v13 offset:8192
    v_mfma_f32_32x32x16_bf16 v[144:159], v[116:119], a[156:159], v[144:159]
    ds_read_b128 v[104:107], v22 offset:0
    ds_read_b128 v[108:111], v22 offset:8192
    s_add_u32 m0, s18, 6144
    v_mfma_f32_32x32x16_bf16 v[160:175], v[120:123], a[156:159], v[160:175]
    buffer_load_dwordx4 v9, s[8:11], s21 offen sc0 sc1 lds
    s_add_u32 m0, s18, 7168
    v_mfma_f32_32x32x16_bf16 v[184:199], v[124:127], a[156:159], v[184:199]
    buffer_load_dwordx4 v10, s[8:11], s21 offen sc0 sc1 lds
    s_waitcnt lgkmcnt(3)
    v_mfma_f32_32x32x16_bf16 v[128:143], v[96:99], a[160:163], v[128:143]
    ds_read_b128 v[112:115], v14 offset:0
    ds_read_b128 v[116:119], v14 offset:8192
    s_waitcnt lgkmcnt(4)
    v_mfma_f32_32x32x16_bf16 v[144:159], v[100:103], a[160:163], v[144:159]
    ds_read_b128 v[120:123], v23 offset:0
    ds_read_b128 v[124:127], v23 offset:8192
    s_bfe_u32 s17, s15, 0x40010
    s_lshl_b32 s17, s17, 8
    s_add_u32 s20, s16, s17
    s_add_u32 m0, s18, 32768
    s_waitcnt lgkmcnt(5)
    v_mfma_f32_32x32x16_bf16 v[160:175], v[104:107], a[160:163], v[160:175]
    buffer_load_dwordx4 v7, s[8:11], s20 offen sc0 sc1 lds
    s_add_u32 m0, s18, 33792
    s_waitcnt lgkmcnt(4)
    v_mfma_f32_32x32x16_bf16 v[184:199], v[108:111], a[160:163], v[184:199]
    buffer_load_dwordx4 v8, s[8:11], s20 offen sc0 sc1 lds
    s_waitcnt lgkmcnt(3)
    v_mfma_f32_32x32x16_bf16 v[128:143], v[112:115], a[164:167], v[128:143]
    ds_read_b128 v[96:99], v15 offset:0
    ds_read_b128 v[100:103], v15 offset:8192
    s_waitcnt lgkmcnt(4)
    v_mfma_f32_32x32x16_bf16 v[144:159], v[116:119], a[164:167], v[144:159]
    ds_read_b128 v[104:107], v24 offset:0
    ds_read_b128 v[108:111], v24 offset:8192
    s_add_u32 m0, s18, 34816
    s_waitcnt lgkmcnt(5)
    v_mfma_f32_32x32x16_bf16 v[160:175], v[120:123], a[164:167], v[160:175]
    buffer_load_dwordx4 v9, s[8:11], s20 offen sc0 sc1 lds
    s_add_u32 m0, s18, 35840
    s_waitcnt lgkmcnt(4)
    v_mfma_f32_32x32x16_bf16 v[184:199], v[124:127], a[164:167], v[184:199]
    buffer_load_dwordx4 v10, s[8:11], s20 offen sc0 sc1 lds
    s_waitcnt lgkmcnt(3)
    v_mfma_f32_32x32x16_bf16 v[128:143], v[96:99], a[168:171], v[128:143]
    ds_read_b128 v[112:115], v16 offset:0
    ds_read_b128 v[116:119], v16 offset:8192
    s_waitcnt lgkmcnt(4)
    v_mfma_f32_32x32x16_bf16 v[144:159], v[100:103], a[168:171], v[144:159]
    ds_read_b128 v[120:123], v25 offset:0
    ds_read_b128 v[124:127], v25 offset:8192
    s_add_u32 s21, s20, 65536
    s_add_u32 m0, s18, 36864
    s_waitcnt lgkmcnt(5)
    v_mfma_f32_32x32x16_bf16 v[160:175], v[104:107], a[168:171], v[160:175]
    buffer_load_dwordx4 v7, s[8:11], s21 offen sc0 sc1 lds
    s_add_u32 m0, s18, 37888
    s_waitcnt lgkmcnt(4)
    v_mfma_f32_32x32x16_bf16 v[184:199], v[108:111], a[168:171], v[184:199]
    buffer_load_dwordx4 v8, s[8:11], s21 offen sc0 sc1 lds
    s_waitcnt lgkmcnt(0)
    s_waitcnt vmcnt(18)
    s_barrier
    v_mfma_f32_32x32x16_bf16 v[128:143], v[112:115], a[172:175], v[128:143]
    ds_read_b128 v[96:99], v13 offset:32768
    ds_read_b128 v[100:103], v13 offset:40960
    v_mfma_f32_32x32x16_bf16 v[144:159], v[116:119], a[172:175], v[144:159]
    ds_read_b128 v[104:107], v22 offset:32768
    ds_read_b128 v[108:111], v22 offset:40960
    s_add_u32 m0, s18, 38912
    v_mfma_f32_32x32x16_bf16 v[160:175], v[120:123], a[172:175], v[160:175]
    buffer_load_dwordx4 v9, s[8:11], s21 offen sc0 sc1 lds
    s_add_u32 m0, s18, 39936
    v_mfma_f32_32x32x16_bf16 v[184:199], v[124:127], a[172:175], v[184:199]
    buffer_load_dwordx4 v10, s[8:11], s21 offen sc0 sc1 lds
    s_waitcnt lgkmcnt(3)
    v_mfma_f32_32x32x16_bf16 v[128:143], v[96:99], a[176:179], v[128:143]
    ds_read_b128 v[112:115], v14 offset:32768
    ds_read_b128 v[116:119], v14 offset:40960
    s_waitcnt lgkmcnt(4)
    v_mfma_f32_32x32x16_bf16 v[144:159], v[100:103], a[176:179], v[144:159]
    ds_read_b128 v[120:123], v23 offset:32768
    ds_read_b128 v[124:127], v23 offset:40960
    s_bfe_u32 s17, s15, 0x40014
    s_lshl_b32 s17, s17, 8
    s_add_u32 s20, s16, s17
    s_add_u32 m0, s18, 65536
    s_waitcnt lgkmcnt(5)
    v_mfma_f32_32x32x16_bf16 v[160:175], v[104:107], a[176:179], v[160:175]
    buffer_load_dwordx4 v7, s[8:11], s20 offen sc0 sc1 lds
    s_add_u32 m0, s18, 66560
    s_waitcnt lgkmcnt(4)
    v_mfma_f32_32x32x16_bf16 v[184:199], v[108:111], a[176:179], v[184:199]
    buffer_load_dwordx4 v8, s[8:11], s20 offen sc0 sc1 lds
    s_waitcnt lgkmcnt(3)
    v_mfma_f32_32x32x16_bf16 v[128:143], v[112:115], a[180:183], v[128:143]
    ds_read_b128 v[96:99], v15 offset:32768
    ds_read_b128 v[100:103], v15 offset:40960
    s_waitcnt lgkmcnt(4)
    v_mfma_f32_32x32x16_bf16 v[144:159], v[116:119], a[180:183], v[144:159]
    ds_read_b128 v[104:107], v24 offset:32768
    ds_read_b128 v[108:111], v24 offset:40960
    s_add_u32 m0, s18, 67584
    s_waitcnt lgkmcnt(5)
    v_mfma_f32_32x32x16_bf16 v[160:175], v[120:123], a[180:183], v[160:175]
    buffer_load_dwordx4 v9, s[8:11], s20 offen sc0 sc1 lds
    s_add_u32 m0, s18, 68608
    s_waitcnt lgkmcnt(4)
    v_mfma_f32_32x32x16_bf16 v[184:199], v[124:127], a[180:183], v[184:199]
    buffer_load_dwordx4 v10, s[8:11], s20 offen sc0 sc1 lds
    s_waitcnt lgkmcnt(3)
    v_mfma_f32_32x32x16_bf16 v[128:143], v[96:99], a[184:187], v[128:143]
    ds_read_b128 v[112:115], v16 offset:32768
    ds_read_b128 v[116:119], v16 offset:40960
    s_waitcnt lgkmcnt(4)
    v_mfma_f32_32x32x16_bf16 v[144:159], v[100:103], a[184:187], v[144:159]
    ds_read_b128 v[120:123], v25 offset:32768
    ds_read_b128 v[124:127], v25 offset:40960
    s_add_u32 s21, s20, 65536
    s_add_u32 m0, s18, 69632
    s_waitcnt lgkmcnt(5)
    v_mfma_f32_32x32x16_bf16 v[160:175], v[104:107], a[184:187], v[160:175]
    buffer_load_dwordx4 v7, s[8:11], s21 offen sc0 sc1 lds
    s_add_u32 m0, s18, 70656
    s_waitcnt lgkmcnt(4)
    v_mfma_f32_32x32x16_bf16 v[184:199], v[108:111], a[184:187], v[184:199]
    buffer_load_dwordx4 v8, s[8:11], s21 offen sc0 sc1 lds
    s_waitcnt lgkmcnt(0)
    s_waitcnt vmcnt(14)
    s_barrier
    v_mfma_f32_32x32x16_bf16 v[128:143], v[112:115], a[188:191], v[128:143]
    ds_read_b128 v[96:99], v4 offset:0
    ds_read_b128 v[100:103], v4 offset:8192
    v_mfma_f32_32x32x16_bf16 v[144:159], v[116:119], a[188:191], v[144:159]
    ds_read_b128 v[104:107], v18 offset:0
    ds_read_b128 v[108:111], v18 offset:8192
    s_add_u32 m0, s18, 71680
    v_mfma_f32_32x32x16_bf16 v[160:175], v[120:123], a[188:191], v[160:175]
    buffer_load_dwordx4 v9, s[8:11], s21 offen sc0 sc1 lds
    s_add_u32 m0, s18, 72704
    v_mfma_f32_32x32x16_bf16 v[184:199], v[124:127], a[188:191], v[184:199]
    buffer_load_dwordx4 v10, s[8:11], s21 offen sc0 sc1 lds
    s_waitcnt lgkmcnt(3)
    v_mfma_f32_32x32x16_bf16 v[128:143], v[96:99], a[192:195], v[128:143]
    ds_read_b128 v[112:115], v5 offset:0
    ds_read_b128 v[116:119], v5 offset:8192
    v_lshlrev_b32 v52, 16, v52
    ds_read_b64_tr_b16 v[26:27], v36 offset:0
    v_xor_b32 v1, 0, v37
    s_waitcnt lgkmcnt(5)
    v_mfma_f32_32x32x16_bf16 v[144:159], v[100:103], a[192:195], v[144:159]
    ds_read_b128 v[120:123], v19 offset:0
    ds_read_b128 v[124:127], v19 offset:8192
    s_bfe_u32 s17, s15, 0x40018
    s_lshl_b32 s17, s17, 8
    s_add_u32 s20, s16, s17
    s_add_u32 m0, s18, 98304
    s_waitcnt lgkmcnt(6)
    v_mfma_f32_32x32x16_bf16 v[160:175], v[104:107], a[192:195], v[160:175]
    buffer_load_dwordx4 v7, s[8:11], s20 offen sc0 sc1 lds
    ds_read_b64 v[50:51], v1
    s_waitcnt lgkmcnt(0)
    v_lshlrev_b32 v216, 16, v50
    v_lshlrev_b32 v220, 16, v26
    s_add_u32 m0, s18, 99328
    v_mfma_f32_32x32x16_bf16 v[184:199], v[108:111], a[192:195], v[184:199]
    buffer_load_dwordx4 v8, s[8:11], s20 offen sc0 sc1 lds
    v_and_b32 v217, s5, v50
    v_and_b32 v221, s5, v26
    v_lshlrev_b32 v218, 16, v51
    v_lshlrev_b32 v222, 16, v27
    v_mfma_f32_32x32x16_bf16 v[128:143], v[112:115], a[196:199], v[128:143]
    ds_read_b128 v[96:99], v11 offset:0
    ds_read_b128 v[100:103], v11 offset:8192
    v_and_b32 v219, s5, v51
    v_and_b32 v223, s5, v27
    ds_read_b64_tr_b16 v[32:33], v36 offset:1024
    v_mfma_f32_32x32x16_bf16 v[144:159], v[116:119], a[196:199], v[144:159]
    ds_read_b128 v[104:107], v20 offset:0
    ds_read_b128 v[108:111], v20 offset:8192
    v_xor_b32 v1, 16, v37
    ds_read_b64 v[180:181], v1
    s_add_u32 m0, s18, 100352
    v_mfma_f32_32x32x16_bf16 v[160:175], v[120:123], a[196:199], v[160:175]
    buffer_load_dwordx4 v9, s[8:11], s20 offen sc0 sc1 lds
    v_mul_f32 v84, v84, v216
    v_mul_f32 v85, v85, v217
    v_mul_f32 v86, v86, v218
    s_add_u32 m0, s18, 101376
    v_mfma_f32_32x32x16_bf16 v[184:199], v[124:127], a[196:199], v[184:199]
    buffer_load_dwordx4 v10, s[8:11], s20 offen sc0 sc1 lds
    v_mul_f32 v87, v87, v219
    v_fmac_f32 v84, v46, v52
    v_fmac_f32 v85, v47, v52
    v_fmac_f32 v86, v48, v52
    s_waitcnt lgkmcnt(5)
    v_mfma_f32_32x32x16_bf16 v[128:143], v[96:99], a[200:203], v[128:143]
    ds_read_b128 v[112:115], v12 offset:0
    ds_read_b128 v[116:119], v12 offset:8192
    v_fmac_f32 v87, v49, v52
    v_mul_f32 v84, v84, v220
    v_mul_f32 v85, v85, v221
    s_waitcnt lgkmcnt(6)
    v_mfma_f32_32x32x16_bf16 v[144:159], v[100:103], a[200:203], v[144:159]
    ds_read_b128 v[120:123], v21 offset:0
    ds_read_b128 v[124:127], v21 offset:8192
    v_mul_f32 v86, v86, v222
    s_add_u32 s21, s20, 65536
    s_add_u32 m0, s18, 102400
    s_waitcnt lgkmcnt(6)
    v_mfma_f32_32x32x16_bf16 v[160:175], v[104:107], a[200:203], v[160:175]
    buffer_load_dwordx4 v7, s[8:11], s21 offen sc0 sc1 lds
    v_mul_f32 v87, v87, v223
    s_waitcnt lgkmcnt(4)
    v_lshlrev_b32 v216, 16, v180
    v_lshlrev_b32 v220, 16, v32
    s_add_u32 m0, s18, 103424
    v_mfma_f32_32x32x16_bf16 v[184:199], v[108:111], a[200:203], v[184:199]
    buffer_load_dwordx4 v8, s[8:11], s21 offen sc0 sc1 lds
    v_and_b32 v217, s5, v180
    v_and_b32 v221, s5, v32
    v_lshlrev_b32 v218, 16, v181
    v_lshlrev_b32 v222, 16, v33
    s_waitcnt lgkmcnt(0)
    s_waitcnt vmcnt(14)
    s_barrier
    v_mfma_f32_32x32x16_bf16 v[128:143], v[112:115], a[204:207], v[128:143]
    ds_read_b128 v[96:99], v4 offset:32768
    ds_read_b128 v[100:103], v4 offset:40960
    v_and_b32 v219, s5, v181
    v_and_b32 v223, s5, v33
    ds_read_b64_tr_b16 v[26:27], v36 offset:2048
    v_mfma_f32_32x32x16_bf16 v[144:159], v[116:119], a[204:207], v[144:159]
    ds_read_b128 v[104:107], v18 offset:32768
    ds_read_b128 v[108:111], v18 offset:40960
    v_xor_b32 v1, 32, v37
    ds_read_b64 v[50:51], v1
    s_add_u32 m0, s18, 104448
    v_mfma_f32_32x32x16_bf16 v[160:175], v[120:123], a[204:207], v[160:175]
    buffer_load_dwordx4 v9, s[8:11], s21 offen sc0 sc1 lds
    v_mul_f32 v88, v88, v216
    v_mul_f32 v89, v89, v217
    v_mul_f32 v90, v90, v218
    s_add_u32 m0, s18, 105472
    v_mfma_f32_32x32x16_bf16 v[184:199], v[124:127], a[204:207], v[184:199]
    buffer_load_dwordx4 v10, s[8:11], s21 offen sc0 sc1 lds
    v_mul_f32 v91, v91, v219
    v_fmac_f32 v88, v54, v52
    v_fmac_f32 v89, v55, v52
    v_fmac_f32 v90, v56, v52
    s_waitcnt lgkmcnt(5)
    v_mfma_f32_32x32x16_bf16 v[128:143], v[96:99], a[208:211], v[128:143]
    ds_read_b128 v[112:115], v5 offset:32768
    ds_read_b128 v[116:119], v5 offset:40960
    v_fmac_f32 v91, v57, v52
    v_mul_f32 v88, v88, v220
    v_mul_f32 v89, v89, v221
    s_waitcnt lgkmcnt(6)
    v_mfma_f32_32x32x16_bf16 v[144:159], v[100:103], a[208:211], v[144:159]
    ds_read_b128 v[120:123], v19 offset:32768
    ds_read_b128 v[124:127], v19 offset:40960
    v_mul_f32 v90, v90, v222
    v_mul_f32 v91, v91, v223
    s_waitcnt lgkmcnt(4)
    v_lshlrev_b32 v216, 16, v50
    v_mfma_f32_32x32x16_bf16 v[160:175], v[104:107], a[208:211], v[160:175]
    v_lshlrev_b32 v220, 16, v26
    v_and_b32 v217, s5, v50
    v_and_b32 v221, s5, v26
    v_lshlrev_b32 v218, 16, v51
    v_lshlrev_b32 v222, 16, v27
    v_mfma_f32_32x32x16_bf16 v[184:199], v[108:111], a[208:211], v[184:199]
    v_and_b32 v219, s5, v51
    v_and_b32 v223, s5, v27
    ds_read_b64_tr_b16 v[32:33], v36 offset:3072
    v_xor_b32 v1, 48, v37
    ds_read_b64 v[180:181], v1
    s_waitcnt lgkmcnt(5)
    v_mfma_f32_32x32x16_bf16 v[128:143], v[112:115], a[212:215], v[128:143]
    ds_read_b128 v[96:99], v11 offset:32768
    ds_read_b128 v[100:103], v11 offset:40960
    v_mul_f32 v92, v92, v216
    v_mul_f32 v93, v93, v217
    v_mul_f32 v94, v94, v218
    s_waitcnt lgkmcnt(6)
    v_mfma_f32_32x32x16_bf16 v[144:159], v[116:119], a[212:215], v[144:159]
    ds_read_b128 v[104:107], v20 offset:32768
    ds_read_b128 v[108:111], v20 offset:40960
    v_mul_f32 v95, v95, v219
    v_fmac_f32 v92, v58, v52
    v_fmac_f32 v93, v59, v52
    s_waitcnt lgkmcnt(7)
    v_mfma_f32_32x32x16_bf16 v[160:175], v[120:123], a[212:215], v[160:175]
    v_fmac_f32 v94, v60, v52
    v_fmac_f32 v95, v61, v52
    v_mul_f32 v92, v92, v220
    v_mul_f32 v93, v93, v221
    v_mul_f32 v94, v94, v222
    s_waitcnt lgkmcnt(6)
    v_mfma_f32_32x32x16_bf16 v[184:199], v[124:127], a[212:215], v[184:199]
    v_mul_f32 v95, v95, v223
    s_waitcnt lgkmcnt(4)
    v_lshlrev_b32 v216, 16, v180
    v_lshlrev_b32 v220, 16, v32
    v_and_b32 v217, s5, v180
    v_and_b32 v221, s5, v32
    s_waitcnt lgkmcnt(3)
    v_mfma_f32_32x32x16_bf16 v[128:143], v[96:99], a[216:219], v[128:143]
    ds_read_b128 v[112:115], v12 offset:32768
    ds_read_b128 v[116:119], v12 offset:40960
    v_lshlrev_b32 v218, 16, v181
    v_lshlrev_b32 v222, 16, v33
    v_and_b32 v219, s5, v181
    s_waitcnt lgkmcnt(4)
    v_mfma_f32_32x32x16_bf16 v[144:159], v[100:103], a[216:219], v[144:159]
    ds_read_b128 v[120:123], v21 offset:32768
    ds_read_b128 v[124:127], v21 offset:40960
    v_and_b32 v223, s5, v33
    ds_read_b64_tr_b16 v[26:27], v36 offset:4096
    v_xor_b32 v1, 64, v37
    s_waitcnt lgkmcnt(6)
    v_mfma_f32_32x32x16_bf16 v[160:175], v[104:107], a[216:219], v[160:175]
    ds_read_b64 v[50:51], v1
    v_mul_f32 v176, v176, v216
    v_mul_f32 v177, v177, v217
    v_mul_f32 v178, v178, v218
    v_mul_f32 v179, v179, v219
    s_waitcnt lgkmcnt(6)
    v_mfma_f32_32x32x16_bf16 v[184:199], v[108:111], a[216:219], v[184:199]
    v_fmac_f32 v176, v62, v52
    v_fmac_f32 v177, v63, v52
    v_fmac_f32 v178, v64, v52
    v_fmac_f32 v179, v65, v52
    v_mul_f32 v176, v176, v220
    s_waitcnt lgkmcnt(2)
    s_waitcnt vmcnt(8)
    s_waitcnt vmcnt(0)
    s_barrier
    v_mfma_f32_32x32x16_bf16 v[128:143], v[112:115], a[220:223], v[128:143]
    ds_read_b128 v[96:99], v22 offset:0
    ds_read_b128 v[100:103], v23 offset:0
    v_mul_f32 v177, v177, v221
    v_mul_f32 v178, v178, v222
    v_mul_f32 v179, v179, v223
    v_mfma_f32_32x32x16_bf16 v[144:159], v[116:119], a[220:223], v[144:159]
    ds_read_b128 v[104:107], v24 offset:0
    ds_read_b128 v[108:111], v25 offset:0
    s_waitcnt lgkmcnt(4)
    v_lshlrev_b32 v216, 16, v50
    v_lshlrev_b32 v220, 16, v26
    v_and_b32 v217, s5, v50
    v_mfma_f32_32x32x16_bf16 v[160:175], v[120:123], a[220:223], v[160:175]
    v_and_b32 v221, s5, v26
    v_lshlrev_b32 v218, 16, v51
    v_lshlrev_b32 v222, 16, v27
    v_and_b32 v219, s5, v51
    v_and_b32 v223, s5, v27
    v_mfma_f32_32x32x16_bf16 v[184:199], v[124:127], a[220:223], v[184:199]
    ds_read_b64_tr_b16 v[32:33], v36 offset:5120
    v_xor_b32 v1, 80, v37
    ds_read_b64 v[180:181], v1
    v_mul_f32 v200, v200, v216
    v_mul_f32 v201, v201, v217
    s_waitcnt lgkmcnt(5)
    v_mfma_f32_32x32x16_bf16 v[160:175], v[96:99], a[224:227], v[160:175]
    ds_read_b128 v[112:115], v22 offset:32768
    ds_read_b128 v[116:119], v23 offset:32768
    v_mul_f32 v202, v202, v218
    v_mul_f32 v203, v203, v219
    v_fmac_f32 v200, v66, v52
    s_waitcnt lgkmcnt(6)
    v_mfma_f32_32x32x16_bf16 v[160:175], v[100:103], a[228:231], v[160:175]
    ds_read_b128 v[120:123], v24 offset:32768
    ds_read_b128 v[124:127], v25 offset:32768
    v_fmac_f32 v201, v67, v52
    v_fmac_f32 v202, v68, v52
    v_fmac_f32 v203, v69, v52
    s_waitcnt lgkmcnt(7)
    v_mfma_f32_32x32x16_bf16 v[160:175], v[104:107], a[232:235], v[160:175]
    v_mul_f32 v200, v200, v220
    v_mul_f32 v201, v201, v221
    v_mul_f32 v202, v202, v222
    v_mul_f32 v203, v203, v223
    s_waitcnt lgkmcnt(4)
    v_lshlrev_b32 v216, 16, v180
    v_mfma_f32_32x32x16_bf16 v[160:175], v[108:111], a[236:239], v[160:175]
    v_lshlrev_b32 v220, 16, v32
    v_and_b32 v217, s5, v180
    v_and_b32 v221, s5, v32
    v_lshlrev_b32 v218, 16, v181
    v_lshlrev_b32 v222, 16, v33
    s_waitcnt lgkmcnt(3)
    v_mfma_f32_32x32x16_bf16 v[160:175], v[112:115], a[240:243], v[160:175]
    ds_read_b128 v[96:99], v22 offset:8192
    ds_read_b128 v[100:103], v23 offset:8192
    v_and_b32 v219, s5, v181
    v_and_b32 v223, s5, v33
    ds_read_b64_tr_b16 v[26:27], v36 offset:6144
    s_waitcnt lgkmcnt(5)
    v_mfma_f32_32x32x16_bf16 v[160:175], v[116:119], a[244:247], v[160:175]
    ds_read_b128 v[104:107], v24 offset:8192
    ds_read_b128 v[108:111], v25 offset:8192
    v_xor_b32 v1, 96, v37
    ds_read_b64 v[50:51], v1
    v_mul_f32 v204, v204, v216
    s_waitcnt lgkmcnt(7)
    v_mfma_f32_32x32x16_bf16 v[160:175], v[120:123], a[248:251], v[160:175]
    v_mul_f32 v205, v205, v217
    v_mul_f32 v206, v206, v218
    v_mul_f32 v207, v207, v219
    v_fmac_f32 v204, v70, v52
    v_fmac_f32 v205, v71, v52
    s_waitcnt lgkmcnt(6)
    v_mfma_f32_32x32x16_bf16 v[160:175], v[124:127], a[252:255], v[160:175]
    v_fmac_f32 v206, v72, v52
    v_fmac_f32 v207, v73, v52
    v_mul_f32 v204, v204, v220
    v_mul_f32 v205, v205, v221
    v_mul_f32 v206, v206, v222
    s_waitcnt lgkmcnt(5)
    v_mfma_f32_32x32x16_bf16 v[184:199], v[96:99], a[224:227], v[184:199]
    ds_read_b128 v[112:115], v22 offset:40960
    ds_read_b128 v[116:119], v23 offset:40960
    v_mul_f32 v207, v207, v223
    s_waitcnt lgkmcnt(2)
    v_lshlrev_b32 v216, 16, v50
    v_lshlrev_b32 v220, 16, v26
    v_mfma_f32_32x32x16_bf16 v[184:199], v[100:103], a[228:231], v[184:199]
    ds_read_b128 v[120:123], v24 offset:40960
    ds_read_b128 v[124:127], v25 offset:40960
    ds_write_b128 v44, v[160:163] offset:0
    v_and_b32 v217, s5, v50
    v_and_b32 v221, s5, v26
    v_mfma_f32_32x32x16_bf16 v[184:199], v[104:107], a[232:235], v[184:199]
    ds_write_b128 v44, v[164:167] offset:1024
    ds_write_b128 v44, v[168:171] offset:2048
    v_lshlrev_b32 v218, 16, v51
    v_lshlrev_b32 v222, 16, v27
    v_and_b32 v219, s5, v51
    v_mfma_f32_32x32x16_bf16 v[184:199], v[108:111], a[236:239], v[184:199]
    ds_write_b128 v44, v[172:175] offset:3072
    v_and_b32 v223, s5, v27
    ds_read_b64_tr_b16 v[32:33], v36 offset:7168
    v_xor_b32 v1, 112, v37
    ds_read_b64 v[180:181], v1
    s_waitcnt lgkmcnt(9)
    v_mfma_f32_32x32x16_bf16 v[184:199], v[112:115], a[240:243], v[184:199]
    ds_read_b128 v[96:99], v13 offset:0
    ds_read_b128 v[100:103], v14 offset:0
    v_mul_f32 v208, v208, v216
    v_mul_f32 v209, v209, v217
    v_mul_f32 v210, v210, v218
    s_waitcnt lgkmcnt(10)
    v_mfma_f32_32x32x16_bf16 v[184:199], v[116:119], a[244:247], v[184:199]
    ds_read_b128 v[104:107], v15 offset:0
    ds_read_b128 v[108:111], v16 offset:0
    v_mul_f32 v211, v211, v219
    v_fmac_f32 v208, v74, v52
    v_fmac_f32 v209, v75, v52
    s_waitcnt lgkmcnt(11)
    v_mfma_f32_32x32x16_bf16 v[184:199], v[120:123], a[248:251], v[184:199]
    v_fmac_f32 v210, v76, v52
    v_fmac_f32 v211, v77, v52
    v_mul_f32 v208, v208, v220
    v_mul_f32 v209, v209, v221
    v_mul_f32 v210, v210, v222
    s_waitcnt lgkmcnt(10)
    v_mfma_f32_32x32x16_bf16 v[184:199], v[124:127], a[252:255], v[184:199]
    v_mul_f32 v211, v211, v223
    s_waitcnt lgkmcnt(4)
    v_lshlrev_b32 v216, 16, v180
    v_lshlrev_b32 v220, 16, v32
    v_and_b32 v217, s5, v180
    v_and_b32 v221, s5, v32
    s_waitcnt lgkmcnt(3)
    v_mfma_f32_32x32x16_bf16 v[128:143], v[96:99], a[224:227], v[128:143]
    ds_read_b128 v[112:115], v13 offset:32768
    ds_read_b128 v[116:119], v14 offset:32768
    v_lshlrev_b32 v218, 16, v181
    v_lshlrev_b32 v222, 16, v33
    v_and_b32 v219, s5, v181
    s_waitcnt lgkmcnt(4)
    v_mfma_f32_32x32x16_bf16 v[128:143], v[100:103], a[228:231], v[128:143]
    ds_read_b128 v[120:123], v15 offset:32768
    ds_read_b128 v[124:127], v16 offset:32768
    ds_write_b128 v44, v[184:187] offset:4096
    v_and_b32 v223, s5, v33
    v_mul_f32 v212, v212, v216
    s_waitcnt lgkmcnt(6)
    v_mfma_f32_32x32x16_bf16 v[128:143], v[104:107], a[232:235], v[128:143]
    ds_write_b128 v44, v[188:191] offset:5120
    ds_write_b128 v44, v[192:195] offset:6144
    v_mul_f32 v213, v213, v217
    v_mul_f32 v214, v214, v218
    v_mul_f32 v215, v215, v219
    s_waitcnt lgkmcnt(7)
    v_mfma_f32_32x32x16_bf16 v[128:143], v[108:111], a[236:239], v[128:143]
    ds_write_b128 v44, v[196:199] offset:7168
    v_fmac_f32 v212, v78, v52
    v_fmac_f32 v213, v79, v52
    v_fmac_f32 v214, v80, v52
    v_fmac_f32 v215, v81, v52
    v_mul_f32 v212, v212, v220
    v_mul_f32 v213, v213, v221
    v_mul_f32 v214, v214, v222
    v_mul_f32 v215, v215, v223
    s_waitcnt lgkmcnt(7)
    v_mfma_f32_32x32x16_bf16 v[128:143], v[112:115], a[240:243], v[128:143]
    ds_read_b128 v[96:99], v13 offset:8192
    ds_read_b128 v[100:103], v14 offset:8192
    s_waitcnt lgkmcnt(8)
    v_mfma_f32_32x32x16_bf16 v[128:143], v[116:119], a[244:247], v[128:143]
    ds_read_b128 v[104:107], v15 offset:8192
    ds_read_b128 v[108:111], v16 offset:8192
    s_waitcnt lgkmcnt(9)
    v_mfma_f32_32x32x16_bf16 v[128:143], v[120:123], a[248:251], v[128:143]
    s_waitcnt lgkmcnt(4)
    s_barrier
    ds_read_b128 v[224:227], v45 offset:0
    ds_read_b128 v[228:231], v45 offset:1024
    v_mfma_f32_32x32x16_bf16 v[128:143], v[124:127], a[252:255], v[128:143]
    ds_read_b128 v[232:235], v45 offset:2048
    ds_read_b128 v[236:239], v45 offset:3072
    s_waitcnt lgkmcnt(7)
    v_mfma_f32_32x32x16_bf16 v[144:159], v[96:99], a[224:227], v[144:159]
    ds_read_b128 v[112:115], v13 offset:40960
    ds_read_b128 v[116:119], v14 offset:40960
    s_waitcnt lgkmcnt(8)
    v_mfma_f32_32x32x16_bf16 v[144:159], v[100:103], a[228:231], v[144:159]
    ds_read_b128 v[120:123], v15 offset:40960
    ds_read_b128 v[124:127], v16 offset:40960
    s_waitcnt lgkmcnt(7)
    s_nop 0
    v_add_f32 v128, v128, v224
    v_add_f32 v129, v129, v225
    v_add_f32 v130, v130, v226
    v_add_f32 v131, v131, v227
    v_fma_f32 v128, v46, v128, v84
    v_fma_f32 v129, v47, v129, v85
    v_fma_f32 v130, v48, v130, v86
    v_mfma_f32_32x32x16_bf16 v[144:159], v[104:107], a[232:235], v[144:159]
    v_fma_f32 v131, v49, v131, v87
    buffer_store_dword v128, v40, s[32:35], s39 offen
    buffer_store_dword v129, v41, s[32:35], s39 offen
    buffer_store_dword v130, v42, s[32:35], s39 offen
    buffer_store_dword v131, v43, s[32:35], s39 offen
    s_waitcnt lgkmcnt(6)
    v_add_f32 v132, v132, v228
    v_add_f32 v133, v133, v229
    v_add_f32 v134, v134, v230
    v_add_f32 v135, v135, v231
    v_mfma_f32_32x32x16_bf16 v[144:159], v[108:111], a[236:239], v[144:159]
    v_fma_f32 v132, v54, v132, v88
    v_fma_f32 v133, v55, v133, v89
    v_fma_f32 v134, v56, v134, v90
    v_fma_f32 v135, v57, v135, v91
    s_add_u32 s39, s39, 32768
    buffer_store_dword v132, v40, s[32:35], s39 offen
    buffer_store_dword v133, v41, s[32:35], s39 offen
    buffer_store_dword v134, v42, s[32:35], s39 offen
    buffer_store_dword v135, v43, s[32:35], s39 offen
    s_waitcnt lgkmcnt(3)
    v_mfma_f32_32x32x16_bf16 v[144:159], v[112:115], a[240:243], v[144:159]
    ds_read_b128 v[96:99], v45 offset:4096
    ds_read_b128 v[100:103], v45 offset:5120
    v_add_f32 v136, v136, v232
    v_add_f32 v137, v137, v233
    v_add_f32 v138, v138, v234
    v_add_f32 v139, v139, v235
    v_fma_f32 v136, v58, v136, v92
    v_fma_f32 v137, v59, v137, v93
    v_fma_f32 v138, v60, v138, v94
    s_waitcnt lgkmcnt(4)
    v_mfma_f32_32x32x16_bf16 v[144:159], v[116:119], a[244:247], v[144:159]
    ds_read_b128 v[104:107], v45 offset:6144
    ds_read_b128 v[108:111], v45 offset:7168
    v_fma_f32 v139, v61, v139, v95
    s_add_u32 s39, s39, 32768
    buffer_store_dword v136, v40, s[32:35], s39 offen
    buffer_store_dword v137, v41, s[32:35], s39 offen
    buffer_store_dword v138, v42, s[32:35], s39 offen
    buffer_store_dword v139, v43, s[32:35], s39 offen
    v_add_f32 v140, v140, v236
    s_waitcnt lgkmcnt(5)
    v_mfma_f32_32x32x16_bf16 v[144:159], v[120:123], a[248:251], v[144:159]
    v_add_f32 v141, v141, v237
    v_add_f32 v142, v142, v238
    v_add_f32 v143, v143, v239
    v_fma_f32 v140, v62, v140, v176
    v_fma_f32 v141, v63, v141, v177
    v_fma_f32 v142, v64, v142, v178
    v_fma_f32 v143, v65, v143, v179
    s_add_u32 s39, s39, 32768
    buffer_store_dword v140, v40, s[32:35], s39 offen
    s_waitcnt lgkmcnt(4)
    v_mfma_f32_32x32x16_bf16 v[144:159], v[124:127], a[252:255], v[144:159]
    buffer_store_dword v141, v41, s[32:35], s39 offen
    buffer_store_dword v142, v42, s[32:35], s39 offen
    buffer_store_dword v143, v43, s[32:35], s39 offen
    s_waitcnt lgkmcnt(3)
    s_nop 7
    v_add_f32 v144, v144, v96
    v_add_f32 v145, v145, v97
    v_add_f32 v146, v146, v98
    v_add_f32 v147, v147, v99
    v_fma_f32 v144, v66, v144, v200
    v_fma_f32 v145, v67, v145, v201
    v_fma_f32 v146, v68, v146, v202
    v_fma_f32 v147, v69, v147, v203
    s_add_u32 s39, s39, 32768
    buffer_store_dword v144, v40, s[32:35], s39 offen
    buffer_store_dword v145, v41, s[32:35], s39 offen
    buffer_store_dword v146, v42, s[32:35], s39 offen
    buffer_store_dword v147, v43, s[32:35], s39 offen
    s_waitcnt lgkmcnt(2)
    v_add_f32 v148, v148, v100
    v_add_f32 v149, v149, v101
    v_add_f32 v150, v150, v102
    v_add_f32 v151, v151, v103
    v_fma_f32 v148, v70, v148, v204
    v_fma_f32 v149, v71, v149, v205
    v_fma_f32 v150, v72, v150, v206
    v_fma_f32 v151, v73, v151, v207
    s_add_u32 s39, s39, 32768
    buffer_store_dword v148, v40, s[32:35], s39 offen
    buffer_store_dword v149, v41, s[32:35], s39 offen
    buffer_store_dword v150, v42, s[32:35], s39 offen
    buffer_store_dword v151, v43, s[32:35], s39 offen
    s_waitcnt lgkmcnt(1)
    v_add_f32 v152, v152, v104
    v_add_f32 v153, v153, v105
    v_add_f32 v154, v154, v106
    v_add_f32 v155, v155, v107
    v_fma_f32 v152, v74, v152, v208
    v_fma_f32 v153, v75, v153, v209
    v_fma_f32 v154, v76, v154, v210
    v_fma_f32 v155, v77, v155, v211
    s_add_u32 s39, s39, 32768
    buffer_store_dword v152, v40, s[32:35], s39 offen
    buffer_store_dword v153, v41, s[32:35], s39 offen
    buffer_store_dword v154, v42, s[32:35], s39 offen
    buffer_store_dword v155, v43, s[32:35], s39 offen
    s_waitcnt lgkmcnt(0)
    v_add_f32 v156, v156, v108
    v_add_f32 v157, v157, v109
    v_add_f32 v158, v158, v110
    v_add_f32 v159, v159, v111
    v_fma_f32 v156, v78, v156, v212
    v_fma_f32 v157, v79, v157, v213
    v_fma_f32 v158, v80, v158, v214
    v_fma_f32 v159, v81, v159, v215
    s_add_u32 s39, s39, 32768
    buffer_store_dword v156, v40, s[32:35], s39 offen
    buffer_store_dword v157, v41, s[32:35], s39 offen
    buffer_store_dword v158, v42, s[32:35], s39 offen
    buffer_store_dword v159, v43, s[32:35], s39 offen
Lend_gated_mix__ssm_conv_s5__ssm_conv_h3__prompt_kernel:
Lcode_last:
    s_endpgm

.section .rodata,"a"
.p2align 6
.amdhsa_kernel gated_mix__ssm_conv_s5__ssm_conv_h3__prompt_kernel
  .amdhsa_next_free_vgpr 504
  .amdhsa_next_free_sgpr 92
  .amdhsa_accum_offset 248
  .amdhsa_group_segment_fixed_size 0
  .amdhsa_kernarg_size 152
  .amdhsa_user_sgpr_count 2
  .amdhsa_user_sgpr_kernarg_segment_ptr 1
  .amdhsa_system_sgpr_workgroup_id_x 1
  .amdhsa_float_denorm_mode_32 3
.end_amdhsa_kernel
```

```asm
; @launch grid=(256,1,1) block=(256,1,1) lds=163840
.amdgcn_target "amdgcn-amd-amdhsa--gfx950"
.text
.globl gated_mix__ssm_conv_s5__ssm_conv_h3__prompt_kernel
.p2align 8
.type gated_mix__ssm_conv_s5__ssm_conv_h3__prompt_kernel,@function
gated_mix__ssm_conv_s5__ssm_conv_h3__prompt_kernel:
    s_cmp_ge_u32 s2, 256
    s_cbranch_scc1 Lend_gated_mix__ssm_conv_s5__ssm_conv_h3__prompt_kernel
    s_load_dwordx16 s[4:19], s[0:1], 0
    s_load_dwordx16 s[20:35], s[0:1], 64
    s_load_dwordx4 s[36:39], s[0:1], 128
    s_load_dwordx2 s[40:41], s[0:1], 144
    s_getpc_b64 s[42:43]
Lcpf_pc:
    s_bfe_u32 s3, s2, 0x10003
    s_lshl_b32 s3, s3, 15
    v_lshlrev_b32 v1, 7, v0
    v_add_u32 v1, s3, v1
    v_min_u32 v1, Lcode_last-Lcpf_pc, v1
    v_mov_b32 v3, s43
    v_add_co_u32 v2, vcc, s42, v1
    s_nop 1
    v_addc_co_u32 v3, vcc, 0, v3, vcc
    global_load_dword v1, v[2:3], off
    s_memrealtime s[42:43]
    v_lshrrev_b32 v2, 6, v0
    s_nop 0
    v_readfirstlane_b32 s44, v2
    v_and_b32 v2, 63, v0
    s_and_b32 s47, s2, 7
    s_lshr_b32 s45, s47, 1
    s_lshl_b32 s45, s45, 2
    s_and_b32 s46, s47, 1
    s_lshl_b32 s46, s46, 3
    s_lshr_b32 s47, s2, 3
    s_and_b32 s3, s47, 3
    s_add_u32 s45, s45, s3
    s_lshr_b32 s47, s47, 2
    s_add_u32 s46, s46, s47
    v_mov_b32 v4, 0
    v_mov_b32 v5, 0
    v_mov_b32 v6, 0
    v_mov_b32 v7, 0
    v_lshlrev_b32 v3, 4, v0
    v_add_u32 v3, 148480, v3
    ds_write_b128 v3, v[4:7]
    v_lshlrev_b32 v3, 2, v0
    v_add_u32 v3, 152576, v3
    ds_write_b32 v3, v4
    v_lshrrev_b32 v16, 4, v2
    v_and_b32 v17, 7, v2
    v_xor_b32 v17, v17, v16
    v_lshlrev_b32 v17, 4, v17
    v_lshrrev_b32 v16, 3, v2
    v_lshl_add_u32 v12, v16, 11, v17
    v_and_b32 v16, 32, v2
    v_lshl_add_u32 v8, v16, 11, v17
    v_and_b32 v16, 8, v2
    v_lshl_add_u32 v8, v16, 12, v8
    v_and_b32 v16, 16, v2
    v_lshl_add_u32 v8, v16, 7, v8
    v_xor_b32 v16, 64, v8
    v_xor_b32 v17, 64, v12
    v_add_u32 v9, 4096, v16
    v_add_u32 v10, 8192, v8
    v_add_u32 v11, 12288, v16
    v_add_u32 v13, 16384, v17
    v_add_u32 v14, 32768, v12
    v_add_u32 v15, 49152, v17
    s_lshr_b32 s50, s44, 1
    s_lshl_b32 s47, s45, 7
    s_lshl_b32 s3, s50, 6
    s_add_u32 s47, s47, s3
    s_and_b32 s3, s44, 1
    s_lshl_b32 s3, s3, 3
    s_add_u32 s47, s47, s3
    s_lshl_b32 s47, s47, 11
    s_lshl_b32 s48, s46, 6
    s_lshl_b32 s3, s50, 5
    s_add_u32 s48, s48, s3
    s_lshl_b32 s48, s48, 11
    s_lshl_b32 s49, s44, 12
    s_and_b32 s3, s2, 7
    s_lshl_b32 s51, s3, 8
    v_bfe_u32 v17, v2, 3, 2
    v_lshrrev_b32 v18, 5, v2
    v_lshlrev_b32 v18, 2, v18
    v_lshl_add_u32 v17, v17, 3, v18
    v_and_b32 v18, 7, v2
    v_lshlrev_b32 v18, 4, v18
    v_lshl_add_u32 v16, v17, 11, v18
    s_lshl_b32 s50, s45, 7
    s_lshl_b32 s3, s44, 5
    s_add_u32 s50, s50, s3
    s_lshl_b32 s50, s50, 11
    s_lshl_b32 s3, s46, 7
    s_add_u32 s50, s50, s3
    v_add_u32 v16, s50, v16
    v_subrev_u32 v18, 6144, v16
    v_min_u32 v18, 0x7fff0000, v18
    v_subrev_u32 v22, 4096, v16
    v_min_u32 v22, 0x7fff0000, v22
    v_subrev_u32 v26, 2048, v16
    v_min_u32 v26, 0x7fff0000, v26
    s_mov_b32 s50, 4096
    s_lshl_b32 s54, s46, 9
    v_lshlrev_b32 v17, 4, v2
    s_waitcnt lgkmcnt(0)
    s_mov_b32 s56, s4
    s_mov_b32 s57, s5
    s_mov_b32 s58, 4194304
    s_mov_b32 s59, 131072
    s_and_b32 s3, s44, 1
    s_cmp_eq_u32 s3, 0
    s_cselect_b32 s60, s10, s12
    s_cselect_b32 s61, s11, s13
    s_mov_b32 s62, 2097152
    s_mov_b32 s63, 131072
    s_add_u32 s52, s47, s51
    s_add_u32 m0, s49, 0
    s_nop 0
    buffer_load_dwordx4 v8, s[56:59], s52 offen  lds
    s_add_u32 m0, s49, 1024
    s_nop 0
    buffer_load_dwordx4 v9, s[56:59], s52 offen  lds
    s_add_u32 m0, s49, 2048
    s_nop 0
    buffer_load_dwordx4 v10, s[56:59], s52 offen  lds
    s_add_u32 m0, s49, 3072
    s_nop 0
    buffer_load_dwordx4 v11, s[56:59], s52 offen  lds
    s_add_u32 s53, s48, s51
    s_add_u32 m0, s49, 16384
    s_nop 0
    buffer_load_dwordx4 v12, s[60:63], s53 offen  lds
    s_add_u32 m0, s49, 17408
    s_nop 0
    buffer_load_dwordx4 v13, s[60:63], s53 offen  lds
    s_add_u32 m0, s49, 18432
    s_nop 0
    buffer_load_dwordx4 v14, s[60:63], s53 offen  lds
    s_add_u32 m0, s49, 19456
    s_nop 0
    buffer_load_dwordx4 v15, s[60:63], s53 offen  lds
    s_add_u32 s51, s51, 128
    s_and_b32 s51, s51, 0x7ff
    s_add_u32 s52, s47, s51
    s_add_u32 m0, s49, 32768
    s_nop 0
    buffer_load_dwordx4 v8, s[56:59], s52 offen  lds
    s_add_u32 m0, s49, 33792
    s_nop 0
    buffer_load_dwordx4 v9, s[56:59], s52 offen  lds
    s_add_u32 m0, s49, 34816
    s_nop 0
    buffer_load_dwordx4 v10, s[56:59], s52 offen  lds
    s_add_u32 m0, s49, 35840
    s_nop 0
    buffer_load_dwordx4 v11, s[56:59], s52 offen  lds
    s_add_u32 s53, s48, s51
    s_add_u32 m0, s49, 49152
    s_nop 0
    buffer_load_dwordx4 v12, s[60:63], s53 offen  lds
    s_add_u32 m0, s49, 50176
    s_nop 0
    buffer_load_dwordx4 v13, s[60:63], s53 offen  lds
    s_add_u32 m0, s49, 51200
    s_nop 0
    buffer_load_dwordx4 v14, s[60:63], s53 offen  lds
    s_add_u32 m0, s49, 52224
    s_nop 0
    buffer_load_dwordx4 v15, s[60:63], s53 offen  lds
    s_mov_b32 s64, s28
    s_mov_b32 s65, s29
    s_mov_b32 s66, 8192
    s_mov_b32 s67, 131072
    s_mov_b32 s68, s24
    s_mov_b32 s69, s25
    s_mov_b32 s70, 4194304
    s_mov_b32 s71, 131072
    s_mov_b32 s72, s26
    s_mov_b32 s73, s27
    s_mov_b32 s74, 4194304
    s_mov_b32 s75, 131072
    s_lshl_b32 s3, s44, 10
    s_add_u32 s4, s3, 157696
    s_mov_b32 s24, s38
    s_mov_b32 s25, s39
    s_mov_b32 s26, 256
    s_mov_b32 s27, 131072
    s_or_b32 s3, s2, s44
    s_cmp_lg_u32 s3, 0
    s_cbranch_scc1 Lnonce_gate_1
    v_mov_b32 v4, s42
    v_mov_b32 v5, s43
    v_mov_b32 v3, 0
    buffer_store_dwordx2 v[4:5], v3, s[24:27], 0 offen sc0 sc1
    s_nop 1
Lnonce_gate_1:
    s_mov_b32 s5, 0xffff0000
    v_mov_b32 v6, 0
    s_and_b32 s3, s44, 1
    s_lshl_b32 s3, s3, 5
    v_and_b32 v7, 31, v2
    v_add_u32 v7, s3, v7
    s_lshl_b32 s3, s46, 6
    v_add_u32 v62, s3, v7
    v_lshlrev_b32 v62, 1, v62
    s_mov_b32 s76, s6
    s_mov_b32 s77, s7
    s_mov_b32 s78, 2048
    s_mov_b32 s79, 131072
    buffer_load_ushort v63, v62, s[76:79], 0 offen
    s_mov_b32 s76, s8
    s_mov_b32 s77, s9
    s_mov_b32 s78, 2048
    s_mov_b32 s79, 131072
    buffer_load_ushort v64, v62, s[76:79], 0 offen
    s_mov_b32 s8, s18
    s_mov_b32 s9, s19
    s_mov_b32 s10, 2048
    s_mov_b32 s11, 131072
    buffer_load_ushort v65, v62, s[8:11], 0 offen
    v_and_b32 v82, 31, v2
    v_bfe_u32 v83, v82, 1, 3
    v_lshrrev_b32 v84, 5, v2
    v_xor_b32 v83, v83, v84
    v_lshlrev_b32 v83, 4, v83
    v_lshl_add_u32 v83, v82, 7, v83
    s_lshr_b32 s6, s44, 1
    s_lshl_b32 s6, s6, 13
    s_and_b32 s7, s44, 1
    s_lshl_b32 s7, s7, 13
    s_add_u32 s7, s7, 16384
    v_xor_b32 v84, 0, v83
    v_add_u32 v66, s6, v84
    v_add_u32 v74, s7, v84
    v_add_u32 v70, 0x10000, v66
    v_add_u32 v78, 0x10000, v74
    v_xor_b32 v84, 32, v83
    v_add_u32 v67, s6, v84
    v_add_u32 v75, s7, v84
    v_add_u32 v71, 0x10000, v67
    v_add_u32 v79, 0x10000, v75
    v_xor_b32 v84, 64, v83
    v_add_u32 v68, s6, v84
    v_add_u32 v76, s7, v84
    v_add_u32 v72, 0x10000, v68
    v_add_u32 v80, 0x10000, v76
    v_xor_b32 v84, 96, v83
    v_add_u32 v69, s6, v84
    v_add_u32 v77, s7, v84
    v_add_u32 v73, 0x10000, v69
    v_add_u32 v81, 0x10000, v77
    s_mov_b32 s8, s40
    s_mov_b32 s9, s41
    s_mov_b32 s10, 33554432
    s_mov_b32 s11, 131072
    v_and_b32 v82, 7, v2
    s_lshl_b32 s3, s44, 10
    s_add_u32 s3, s3, 157696
    v_lshl_add_u32 v180, v82, 6, s3
    v_bfe_u32 v82, v2, 2, 1
    v_lshlrev_b32 v82, 3, v82
    v_lshrrev_b32 v83, 5, v2
    v_add_u32 v82, v82, v83
    v_lshlrev_b32 v181, 14, v82
    v_bfe_u32 v82, v2, 3, 2
    v_sub_u32 v82, 3, v82
    v_lshl_add_u32 v181, v82, 6, v181
    v_and_b32 v82, 3, v2
    v_lshl_add_u32 v181, v82, 4, v181
    s_lshl_b32 s6, s46, 18
    s_add_u32 s6, s6, 8404736
    s_lshl_b32 s3, s45, 10
    s_sub_u32 s6, s6, s3
    s_lshl_b32 s3, s44, 8
    s_sub_u32 s6, s6, s3
    s_lshl_b32 s13, s46, 4
    s_add_u32 s13, s13, s45
    s_lshl_b32 s13, s13, 2
    s_add_u32 s13, s13, s44
    s_lshl_b32 s13, s13, 3
    s_add_u32 s13, s13, 21495808
    s_lshl_b32 s18, s46, 2
    s_add_u32 s18, s18, s44
    s_lshl_b32 s18, s18, 4
    s_add_u32 s18, s18, s45
    s_lshl_b32 s18, s18, 3
    s_add_u32 s18, s18, 21504000
    s_lshl_b32 s3, s46, 9
    s_add_u32 s3, s3, 21495808
    v_lshrrev_b32 v182, 1, v17
    v_add_u32 v182, s3, v182
    s_lshl_b32 s19, s46, 6
    s_lshr_b32 s3, s45, 3
    s_lshl_b32 s3, s3, 5
    s_add_u32 s19, s19, s3
    s_lshl_b32 s3, s44, 3
    s_add_u32 s19, s19, s3
    s_and_b32 s3, s45, 7
    s_add_u32 s19, s19, s3
    s_lshl_b32 s22, s19, 12
    s_add_u32 s76, s30, s22
    s_addc_u32 s77, s31, 0
    s_mov_b32 s78, 4096
    s_mov_b32 s79, 131072
    s_mov_b32 s80, s32
    s_mov_b32 s81, s33
    s_mov_b32 s82, 2048
    s_mov_b32 s83, 131072
    s_lshl_b32 s3, s19, 1
    v_mov_b32 v183, s3
    buffer_load_ushort v183, v183, s[80:83], 0 offen
    s_mul_i32 s23, s44, 8320
    s_add_u32 s23, s23, 65536
    v_lshrrev_b32 v224, 4, v2
    v_and_b32 v225, 3, v2
    v_xor_b32 v225, v225, v224
    v_lshlrev_b32 v225, 4, v225
    v_lshrrev_b32 v224, 2, v2
    v_lshl_add_u32 v207, v224, 6, v225
    s_lshl_b32 s28, s46, 4
    s_add_u32 s28, s28, s45
    s_lshl_b32 s28, s28, 14
    s_lshl_b32 s29, s44, 12
    s_add_u32 s28, s28, s29
    s_add_u32 s28, s28, 8388608
    s_add_u32 s29, s29, 132096
    s_mov_b32 s80, s14
    s_mov_b32 s81, s15
    s_mov_b32 s82, 2097152
    s_mov_b32 s83, 131072
    s_mov_b32 s84, s16
    s_mov_b32 s85, s17
    s_mov_b32 s86, 2097152
    s_mov_b32 s87, 131072
    v_lshrrev_b32 v225, 2, v2
    v_lshrrev_b32 v226, 4, v2
    v_xor_b32 v226, v226, v2
    v_and_b32 v226, 3, v226
    v_lshlrev_b32 v226, 4, v226
    v_lshl_add_u32 v224, v225, 11, v226
    s_lshl_b32 s14, s46, 17
    s_and_b32 s3, s44, 1
    s_lshl_b32 s3, s3, 16
    s_add_u32 s14, s14, s3
    s_lshl_b32 s3, s45, 7
    s_add_u32 s14, s14, s3
    s_lshr_b32 s3, s44, 1
    s_lshl_b32 s3, s3, 6
    s_add_u32 s14, s14, s3
    s_add_u32 s15, s14, 32768
    s_lshl_b32 s16, s44, 12
    s_add_u32 s16, s16, 132096
    s_mov_b32 s88, s34
    s_mov_b32 s89, s35
    s_mov_b32 s90, 2048
    s_mov_b32 s91, 131072
    s_lshl_b32 s17, s45, 7
    s_lshl_b32 s3, s46, 3
    s_add_u32 s17, s17, s3
    s_lshl_b32 s3, s44, 1
    s_add_u32 s17, s17, s3
    s_lshl_b32 s3, s17, 2
    s_add_u32 s3, s3, 20971520
    v_mov_b32 v225, s3
    s_lshl_b32 s17, s17, 11
    s_mov_b32 s32, 8192
    buffer_load_dwordx4 v[208:211], v17, s[88:91], 0 offen offset:0
    buffer_load_dwordx4 v[212:215], v17, s[88:91], 0 offen offset:1024
    buffer_load_dwordx4 v[46:49], v17, s[56:59], s17 offen offset:0
    buffer_load_dwordx4 v[50:53], v17, s[56:59], s17 offen offset:1024
    buffer_load_dwordx4 v[54:57], v17, s[56:59], s17 offen offset:2048
    buffer_load_dwordx4 v[58:61], v17, s[56:59], s17 offen offset:3072
    s_waitcnt vmcnt(18)
    s_barrier
    ds_read_b128 v[84:87], v66 offset:0
    ds_read_b128 v[92:95], v74 offset:0
    ds_read_b128 v[96:99], v74 offset:4096
    ds_read_b128 v[88:91], v66 offset:4096
    s_add_u32 s51, s51, 128
    s_and_b32 s51, s51, 0x7ff
    s_add_u32 s52, s47, s51
    s_add_u32 m0, s49, 65536
    s_waitcnt lgkmcnt(2)
    v_mfma_f32_32x32x16_bf16 v[116:131], v[84:87], v[92:95], 0
    ds_read_b128 v[100:103], v67 offset:0
    ds_read_b128 v[108:111], v75 offset:0
    buffer_load_dwordx4 v8, s[56:59], s52 offen  lds
    s_add_u32 m0, s49, 66560
    s_waitcnt lgkmcnt(3)
    v_mfma_f32_32x32x16_bf16 v[132:147], v[84:87], v[96:99], 0
    ds_read_b128 v[112:115], v75 offset:4096
    ds_read_b128 v[104:107], v67 offset:4096
    buffer_load_dwordx4 v9, s[56:59], s52 offen  lds
    s_add_u32 m0, s49, 67584
    s_waitcnt lgkmcnt(4)
    v_mfma_f32_32x32x16_bf16 v[148:163], v[88:91], v[92:95], 0
    buffer_load_dwordx4 v10, s[56:59], s52 offen  lds
    s_add_u32 m0, s49, 68608
    v_mfma_f32_32x32x16_bf16 v[164:179], v[88:91], v[96:99], 0
    buffer_load_dwordx4 v11, s[56:59], s52 offen  lds
    s_add_u32 s53, s48, s51
    s_add_u32 m0, s49, 81920
    s_waitcnt lgkmcnt(2)
    v_mfma_f32_32x32x16_bf16 v[116:131], v[100:103], v[108:111], v[116:131]
    ds_read_b128 v[84:87], v68 offset:0
    ds_read_b128 v[92:95], v76 offset:0
    buffer_load_dwordx4 v12, s[60:63], s53 offen  lds
    s_add_u32 m0, s49, 82944
    s_waitcnt lgkmcnt(3)
    v_mfma_f32_32x32x16_bf16 v[132:147], v[100:103], v[112:115], v[132:147]
    ds_read_b128 v[96:99], v76 offset:4096
    ds_read_b128 v[88:91], v68 offset:4096
    buffer_load_dwordx4 v13, s[60:63], s53 offen  lds
    s_add_u32 m0, s49, 83968
    s_waitcnt lgkmcnt(4)
    v_mfma_f32_32x32x16_bf16 v[148:163], v[104:107], v[108:111], v[148:163]
    buffer_load_dwordx4 v14, s[60:63], s53 offen  lds
    s_add_u32 m0, s49, 84992
    v_mfma_f32_32x32x16_bf16 v[164:179], v[104:107], v[112:115], v[164:179]
    buffer_load_dwordx4 v15, s[60:63], s53 offen  lds
    s_add_u32 s51, s51, 128
    s_and_b32 s51, s51, 0x7ff
    s_add_u32 s52, s47, s51
    s_add_u32 m0, s49, 98304
    s_waitcnt lgkmcnt(2)
    v_mfma_f32_32x32x16_bf16 v[116:131], v[84:87], v[92:95], v[116:131]
    ds_read_b128 v[100:103], v69 offset:0
    ds_read_b128 v[108:111], v77 offset:0
    buffer_load_dwordx4 v8, s[56:59], s52 offen  lds
    s_add_u32 m0, s49, 99328
    s_waitcnt lgkmcnt(3)
    v_mfma_f32_32x32x16_bf16 v[132:147], v[84:87], v[96:99], v[132:147]
    ds_read_b128 v[112:115], v77 offset:4096
    ds_read_b128 v[104:107], v69 offset:4096
    buffer_load_dwordx4 v9, s[56:59], s52 offen  lds
    s_add_u32 m0, s49, 100352
    s_waitcnt lgkmcnt(4)
    v_mfma_f32_32x32x16_bf16 v[148:163], v[88:91], v[92:95], v[148:163]
    buffer_load_dwordx4 v10, s[56:59], s52 offen  lds
    s_add_u32 m0, s49, 101376
    v_mfma_f32_32x32x16_bf16 v[164:179], v[88:91], v[96:99], v[164:179]
    buffer_load_dwordx4 v11, s[56:59], s52 offen  lds
    s_waitcnt lgkmcnt(0)
    s_waitcnt vmcnt(22)
    s_barrier
    s_add_u32 s53, s48, s51
    s_add_u32 m0, s49, 114688
    v_mfma_f32_32x32x16_bf16 v[116:131], v[100:103], v[108:111], v[116:131]
    ds_read_b128 v[84:87], v66 offset:32768
    ds_read_b128 v[92:95], v74 offset:32768
    buffer_load_dwordx4 v12, s[60:63], s53 offen  lds
    s_waitcnt vmcnt(22)
    v_lshlrev_b32 v63, 16, v63
    s_waitcnt vmcnt(21)
    v_lshlrev_b32 v64, 16, v64
    s_waitcnt vmcnt(20)
    v_lshlrev_b32 v65, 16, v65
    v_mul_f32 v242, 1069066811, v65
    s_add_u32 m0, s49, 115712
    v_mfma_f32_32x32x16_bf16 v[132:147], v[100:103], v[112:115], v[132:147]
    ds_read_b128 v[96:99], v74 offset:36864
    ds_read_b128 v[88:91], v66 offset:36864
    buffer_load_dwordx4 v13, s[60:63], s53 offen  lds
    v_exp_f32 v242, v242
    s_nop 0
    v_cvt_pk_bf16_f32 v242, v242, v242
    v_lshlrev_b32 v242, 16, v242
    v_mul_f32 v243, v242, v63
    s_add_u32 m0, s49, 116736
    v_mfma_f32_32x32x16_bf16 v[148:163], v[104:107], v[108:111], v[148:163]
    buffer_load_dwordx4 v14, s[60:63], s53 offen  lds
    v_mul_f32 v244, v242, v64
    v_mul_f32 v243, 1069066811, v243
    v_exp_f32 v243, v243
    v_mul_f32 v244, 1042479491, v244
    v_fract_f32 v244, v244
    v_cos_f32 v245, v244
    s_add_u32 m0, s49, 117760
    v_mfma_f32_32x32x16_bf16 v[164:179], v[104:107], v[112:115], v[164:179]
    buffer_load_dwordx4 v15, s[60:63], s53 offen  lds
    v_sin_f32 v246, v244
    v_mul_f32 v230, v243, v245
    v_mul_f32 v231, v243, v246
    v_add_f32 v242, -1.0, v230
    v_mul_f32 v243, v63, v63
    v_fmac_f32 v243, v64, v64
    v_rcp_f32 v243, v243
    s_add_u32 s51, s51, 128
    s_and_b32 s51, s51, 0x7ff
    s_add_u32 s52, s47, s51
    s_add_u32 m0, s49, 0
    s_waitcnt lgkmcnt(2)
    v_mfma_f32_32x32x16_bf16 v[116:131], v[84:87], v[92:95], v[116:131]
    ds_read_b128 v[100:103], v67 offset:32768
    ds_read_b128 v[108:111], v75 offset:32768
    buffer_load_dwordx4 v8, s[56:59], s52 offen  lds
    v_add_f32 v243, v243, v243
    v_mul_f32 v244, v242, v63
    v_fmac_f32 v244, v231, v64
    v_mul_f32 v245, v231, v63
    s_add_u32 m0, s49, 1024
    s_waitcnt lgkmcnt(3)
    v_mfma_f32_32x32x16_bf16 v[132:147], v[84:87], v[96:99], v[132:147]
    ds_read_b128 v[112:115], v75 offset:36864
    ds_read_b128 v[104:107], v67 offset:36864
    buffer_load_dwordx4 v9, s[56:59], s52 offen  lds
    v_fma_f32 v245, -v242, v64, v245
    v_mul_f32 v232, v244, v243
    v_mul_f32 v233, v245, v243
    v_mul_f32 v242, v231, v231
    s_add_u32 m0, s49, 2048
    s_waitcnt lgkmcnt(4)
    v_mfma_f32_32x32x16_bf16 v[148:163], v[88:91], v[92:95], v[148:163]
    buffer_load_dwordx4 v10, s[56:59], s52 offen  lds
    v_fma_f32 v242, v230, v230, -v242
    v_mul_f32 v243, v230, v231
    v_add_f32 v243, v243, v243
    v_mul_f32 v244, v243, v243
    v_fma_f32 v244, v242, v242, -v244
    v_mul_f32 v245, v242, v243
    s_add_u32 m0, s49, 3072
    v_mfma_f32_32x32x16_bf16 v[164:179], v[88:91], v[96:99], v[164:179]
    buffer_load_dwordx4 v11, s[56:59], s52 offen  lds
    v_add_f32 v245, v245, v245
    v_mul_f32 v242, v245, v245
    v_fma_f32 v242, v244, v244, -v242
    v_mul_f32 v243, v244, v245
    v_add_f32 v243, v243, v243
    v_mul_f32 v234, v243, v243
    v_fma_f32 v234, v242, v242, -v234
    s_add_u32 s53, s48, s51
    s_add_u32 m0, s49, 16384
    s_waitcnt lgkmcnt(2)
    v_mfma_f32_32x32x16_bf16 v[116:131], v[100:103], v[108:111], v[116:131]
    ds_read_b128 v[84:87], v68 offset:32768
    ds_read_b128 v[92:95], v76 offset:32768
    buffer_load_dwordx4 v12, s[60:63], s53 offen  lds
    v_mul_f32 v235, v242, v243
    v_add_f32 v235, v235, v235
    v_mul_f32 v242, v235, v235
    v_fma_f32 v242, v234, v234, -v242
    s_add_u32 m0, s49, 17408
    s_waitcnt lgkmcnt(3)
    v_mfma_f32_32x32x16_bf16 v[132:147], v[100:103], v[112:115], v[132:147]
    ds_read_b128 v[96:99], v76 offset:36864
    ds_read_b128 v[88:91], v68 offset:36864
    buffer_load_dwordx4 v13, s[60:63], s53 offen  lds
    v_mul_f32 v243, v234, v235
    v_add_f32 v243, v243, v243
    v_mul_f32 v244, v243, v243
    v_fma_f32 v244, v242, v242, -v244
    s_add_u32 m0, s49, 18432
    s_waitcnt lgkmcnt(4)
    v_mfma_f32_32x32x16_bf16 v[148:163], v[104:107], v[108:111], v[148:163]
    buffer_load_dwordx4 v14, s[60:63], s53 offen  lds
    v_mul_f32 v245, v242, v243
    v_add_f32 v245, v245, v245
    v_mul_f32 v236, v245, v245
    v_fma_f32 v236, v244, v244, -v236
    v_mul_f32 v237, v244, v245
    v_add_f32 v237, v237, v237
    s_add_u32 m0, s49, 19456
    v_mfma_f32_32x32x16_bf16 v[164:179], v[104:107], v[112:115], v[164:179]
    buffer_load_dwordx4 v15, s[60:63], s53 offen  lds
    s_mov_b32 s34, 0
    s_mov_b32 s35, -1
    s_lshr_b32 s3, s44, 1
    s_cmp_eq_u32 s3, 1
    s_cselect_b32 s38, -1, 0
    s_cselect_b32 s39, -1, 0
    v_cndmask_b32 v242, 1.0, v242, s[34:35]
    v_cndmask_b32 v243, 0, v243, s[34:35]
    v_cndmask_b32 v244, 1.0, v244, s[38:39]
    s_waitcnt lgkmcnt(2)
    v_mfma_f32_32x32x16_bf16 v[116:131], v[84:87], v[92:95], v[116:131]
    ds_read_b128 v[100:103], v69 offset:32768
    ds_read_b128 v[108:111], v77 offset:32768
    v_cndmask_b32 v245, 0, v245, s[38:39]
    v_mul_f32 v246, v243, v245
    v_fma_f32 v246, v242, v244, -v246
    v_mul_f32 v247, v242, v245
    v_fmac_f32 v247, v243, v244
    v_mul_f32 v242, v247, v235
    s_waitcnt lgkmcnt(3)
    v_mfma_f32_32x32x16_bf16 v[132:147], v[84:87], v[96:99], v[132:147]
    ds_read_b128 v[112:115], v77 offset:36864
    ds_read_b128 v[104:107], v69 offset:36864
    v_fma_f32 v242, v246, v234, -v242
    v_mul_f32 v243, v246, v235
    v_fmac_f32 v243, v247, v234
    v_mov_b32 v238, v246
    v_mov_b32 v239, v242
    v_mov_b32 v240, v247
    s_waitcnt lgkmcnt(4)
    v_mfma_f32_32x32x16_bf16 v[148:163], v[88:91], v[92:95], v[148:163]
    v_mov_b32 v241, v243
    v_mfma_f32_32x32x16_bf16 v[164:179], v[88:91], v[96:99], v[164:179]
    s_waitcnt lgkmcnt(0)
    s_waitcnt vmcnt(16)
    s_barrier
    s_add_u32 s51, s51, 128
    s_and_b32 s51, s51, 0x7ff
    s_add_u32 s52, s47, s51
    s_add_u32 m0, s49, 32768
    v_mfma_f32_32x32x16_bf16 v[116:131], v[100:103], v[108:111], v[116:131]
    ds_read_b128 v[84:87], v70 offset:0
    ds_read_b128 v[92:95], v78 offset:0
    buffer_load_dwordx4 v8, s[56:59], s52 offen  lds
    v_lshlrev_b32 v203, 16, v208
    v_and_b32 v204, s5, v208
    v_lshlrev_b32 v205, 16, v46
    v_and_b32 v206, s5, v46
    s_add_u32 m0, s49, 33792
    v_mfma_f32_32x32x16_bf16 v[132:147], v[100:103], v[112:115], v[132:147]
    ds_read_b128 v[96:99], v78 offset:4096
    ds_read_b128 v[88:91], v70 offset:4096
    buffer_load_dwordx4 v9, s[56:59], s52 offen  lds
    v_mul_f32 v226, v203, v205
    v_fmac_f32 v226, v204, v206
    v_lshlrev_b32 v205, 16, v54
    v_and_b32 v206, s5, v54
    s_add_u32 m0, s49, 34816
    v_mfma_f32_32x32x16_bf16 v[148:163], v[104:107], v[108:111], v[148:163]
    buffer_load_dwordx4 v10, s[56:59], s52 offen  lds
    v_mul_f32 v227, v203, v205
    v_fmac_f32 v227, v204, v206
    v_lshlrev_b32 v203, 16, v209
    v_and_b32 v204, s5, v209
    v_lshlrev_b32 v205, 16, v47
    v_and_b32 v206, s5, v47
    s_add_u32 m0, s49, 35840
    v_mfma_f32_32x32x16_bf16 v[164:179], v[104:107], v[112:115], v[164:179]
    buffer_load_dwordx4 v11, s[56:59], s52 offen  lds
    v_fmac_f32 v226, v203, v205
    v_fmac_f32 v226, v204, v206
    v_lshlrev_b32 v205, 16, v55
    v_and_b32 v206, s5, v55
    v_fmac_f32 v227, v203, v205
    v_fmac_f32 v227, v204, v206
    v_lshlrev_b32 v203, 16, v210
    s_add_u32 s53, s48, s51
    s_add_u32 m0, s49, 49152
    s_waitcnt lgkmcnt(2)
    v_mfma_f32_32x32x16_bf16 v[116:131], v[84:87], v[92:95], v[116:131]
    ds_read_b128 v[100:103], v71 offset:0
    ds_read_b128 v[108:111], v79 offset:0
    buffer_load_dwordx4 v12, s[60:63], s53 offen  lds
    v_and_b32 v204, s5, v210
    v_lshlrev_b32 v205, 16, v48
    v_and_b32 v206, s5, v48
    v_fmac_f32 v226, v203, v205
    s_add_u32 m0, s49, 50176
    s_waitcnt lgkmcnt(3)
    v_mfma_f32_32x32x16_bf16 v[132:147], v[84:87], v[96:99], v[132:147]
    ds_read_b128 v[112:115], v79 offset:4096
    ds_read_b128 v[104:107], v71 offset:4096
    buffer_load_dwordx4 v13, s[60:63], s53 offen  lds
    v_fmac_f32 v226, v204, v206
    v_lshlrev_b32 v205, 16, v56
    v_and_b32 v206, s5, v56
    v_fmac_f32 v227, v203, v205
    s_add_u32 m0, s49, 51200
    s_waitcnt lgkmcnt(4)
    v_mfma_f32_32x32x16_bf16 v[148:163], v[88:91], v[92:95], v[148:163]
    buffer_load_dwordx4 v14, s[60:63], s53 offen  lds
    v_fmac_f32 v227, v204, v206
    v_lshlrev_b32 v203, 16, v211
    v_and_b32 v204, s5, v211
    v_lshlrev_b32 v205, 16, v49
    v_and_b32 v206, s5, v49
    v_fmac_f32 v226, v203, v205
    s_add_u32 m0, s49, 52224
    v_mfma_f32_32x32x16_bf16 v[164:179], v[88:91], v[96:99], v[164:179]
    buffer_load_dwordx4 v15, s[60:63], s53 offen  lds
    v_fmac_f32 v226, v204, v206
    v_lshlrev_b32 v205, 16, v57
    v_and_b32 v206, s5, v57
    v_fmac_f32 v227, v203, v205
    v_fmac_f32 v227, v204, v206
    v_lshlrev_b32 v203, 16, v212
    v_and_b32 v204, s5, v212
    s_waitcnt lgkmcnt(2)
    v_mfma_f32_32x32x16_bf16 v[116:131], v[100:103], v[108:111], v[116:131]
    ds_read_b128 v[84:87], v72 offset:0
    ds_read_b128 v[92:95], v80 offset:0
    v_lshlrev_b32 v205, 16, v50
    v_and_b32 v206, s5, v50
    v_fmac_f32 v226, v203, v205
    v_fmac_f32 v226, v204, v206
    v_lshlrev_b32 v205, 16, v58
    v_and_b32 v206, s5, v58
    s_waitcnt lgkmcnt(3)
    v_mfma_f32_32x32x16_bf16 v[132:147], v[100:103], v[112:115], v[132:147]
    ds_read_b128 v[96:99], v80 offset:4096
    ds_read_b128 v[88:91], v72 offset:4096
    v_fmac_f32 v227, v203, v205
    v_fmac_f32 v227, v204, v206
    v_lshlrev_b32 v203, 16, v213
    v_and_b32 v204, s5, v213
    v_lshlrev_b32 v205, 16, v51
    v_and_b32 v206, s5, v51
    s_waitcnt lgkmcnt(4)
    v_mfma_f32_32x32x16_bf16 v[148:163], v[104:107], v[108:111], v[148:163]
    v_fmac_f32 v226, v203, v205
    v_fmac_f32 v226, v204, v206
    v_lshlrev_b32 v205, 16, v59
    v_and_b32 v206, s5, v59
    v_fmac_f32 v227, v203, v205
    v_fmac_f32 v227, v204, v206
    v_lshlrev_b32 v203, 16, v214
    v_and_b32 v204, s5, v214
    v_mfma_f32_32x32x16_bf16 v[164:179], v[104:107], v[112:115], v[164:179]
    v_lshlrev_b32 v205, 16, v52
    v_and_b32 v206, s5, v52
    v_fmac_f32 v226, v203, v205
    v_fmac_f32 v226, v204, v206
    v_lshlrev_b32 v205, 16, v60
    v_and_b32 v206, s5, v60
    v_fmac_f32 v227, v203, v205
    v_fmac_f32 v227, v204, v206
    s_waitcnt lgkmcnt(2)
    v_mfma_f32_32x32x16_bf16 v[116:131], v[84:87], v[92:95], v[116:131]
    ds_read_b128 v[100:103], v73 offset:0
    ds_read_b128 v[108:111], v81 offset:0
    v_lshlrev_b32 v203, 16, v215
    v_and_b32 v204, s5, v215
    v_lshlrev_b32 v205, 16, v53
    v_and_b32 v206, s5, v53
    v_fmac_f32 v226, v203, v205
    v_fmac_f32 v226, v204, v206
    s_waitcnt lgkmcnt(3)
    v_mfma_f32_32x32x16_bf16 v[132:147], v[84:87], v[96:99], v[132:147]
    ds_read_b128 v[112:115], v81 offset:4096
    ds_read_b128 v[104:107], v73 offset:4096
    v_lshlrev_b32 v205, 16, v61
    v_and_b32 v206, s5, v61
    v_fmac_f32 v227, v203, v205
    v_fmac_f32 v227, v204, v206
    v_add_f32_dpp v226, v226, v226 row_shr:1 row_mask:0xf bank_mask:0xf bound_ctrl:0
    s_nop 0
    v_add_f32_dpp v227, v227, v227 row_shr:1 row_mask:0xf bank_mask:0xf bound_ctrl:0
    s_waitcnt lgkmcnt(4)
    v_mfma_f32_32x32x16_bf16 v[148:163], v[88:91], v[92:95], v[148:163]
    v_add_f32_dpp v226, v226, v226 row_shr:2 row_mask:0xf bank_mask:0xf bound_ctrl:0
    v_add_f32_dpp v227, v227, v227 row_shr:2 row_mask:0xf bank_mask:0xf bound_ctrl:0
    s_nop 0
    v_add_f32_dpp v226, v226, v226 row_shr:4 row_mask:0xf bank_mask:0xf bound_ctrl:0
    v_add_f32_dpp v227, v227, v227 row_shr:4 row_mask:0xf bank_mask:0xf bound_ctrl:0
    s_nop 0
    v_add_f32_dpp v226, v226, v226 row_shr:8 row_mask:0xf bank_mask:0xf bound_ctrl:0
    v_add_f32_dpp v227, v227, v227 row_shr:8 row_mask:0xf bank_mask:0xf bound_ctrl:0
    s_nop 0
    v_add_f32_dpp v226, v226, v226 row_bcast:15 row_mask:0xa bank_mask:0xf
    v_add_f32_dpp v227, v227, v227 row_bcast:15 row_mask:0xa bank_mask:0xf
    v_mfma_f32_32x32x16_bf16 v[164:179], v[88:91], v[96:99], v[164:179]
    v_add_f32_dpp v226, v226, v226 row_bcast:31 row_mask:0xc bank_mask:0xf
    v_add_f32_dpp v227, v227, v227 row_bcast:31 row_mask:0xc bank_mask:0xf
    v_cvt_pk_bf16_f32 v203, v226, v227
    v_lshlrev_b32 v226, 16, v203
    v_and_b32 v227, s5, v203
    v_mul_f32 v226, 0xbfb8aa3b, v226
    v_mul_f32 v227, 0xbfb8aa3b, v227
    v_exp_f32 v226, v226
    s_waitcnt lgkmcnt(0)
    s_waitcnt vmcnt(16)
    s_barrier
    s_add_u32 s51, s51, 128
    s_and_b32 s51, s51, 0x7ff
    s_add_u32 s52, s47, s51
    s_add_u32 m0, s49, 65536
    v_mfma_f32_32x32x16_bf16 v[116:131], v[100:103], v[108:111], v[116:131]
    ds_read_b128 v[84:87], v70 offset:32768
    ds_read_b128 v[92:95], v78 offset:32768
    buffer_load_dwordx4 v8, s[56:59], s52 offen  lds
    v_exp_f32 v227, v227
    v_add_f32 v226, 1.0, v226
    v_add_f32 v227, 1.0, v227
    v_rcp_f32 v226, v226
    s_add_u32 m0, s49, 66560
    v_mfma_f32_32x32x16_bf16 v[132:147], v[100:103], v[112:115], v[132:147]
    ds_read_b128 v[96:99], v78 offset:36864
    ds_read_b128 v[88:91], v70 offset:36864
    buffer_load_dwordx4 v9, s[56:59], s52 offen  lds
    v_rcp_f32 v227, v227
    s_nop 0
    v_cvt_pk_bf16_f32 v203, v226, v227
    v_lshlrev_b32 v226, 16, v203
    v_and_b32 v227, s5, v203
    s_add_u32 m0, s49, 67584
    v_mfma_f32_32x32x16_bf16 v[148:163], v[104:107], v[108:111], v[148:163]
    buffer_load_dwordx4 v10, s[56:59], s52 offen  lds
    v_sub_f32 v228, 1.0, v226
    v_sub_f32 v229, 1.0, v227
    v_cvt_pk_bf16_f32 v203, v228, v229
    v_lshlrev_b32 v228, 16, v203
    v_and_b32 v229, s5, v203
    s_add_u32 m0, s49, 68608
    v_mfma_f32_32x32x16_bf16 v[164:179], v[104:107], v[112:115], v[164:179]
    buffer_load_dwordx4 v11, s[56:59], s52 offen  lds
    s_add_u32 s53, s48, s51
    s_add_u32 m0, s49, 81920
    s_waitcnt lgkmcnt(2)
    v_mfma_f32_32x32x16_bf16 v[116:131], v[84:87], v[92:95], v[116:131]
    ds_read_b128 v[100:103], v71 offset:32768
    ds_read_b128 v[108:111], v79 offset:32768
    buffer_load_dwordx4 v12, s[60:63], s53 offen  lds
    s_add_u32 m0, s49, 82944
    s_waitcnt lgkmcnt(3)
    v_mfma_f32_32x32x16_bf16 v[132:147], v[84:87], v[96:99], v[132:147]
    ds_read_b128 v[112:115], v79 offset:36864
    ds_read_b128 v[104:107], v71 offset:36864
    buffer_load_dwordx4 v13, s[60:63], s53 offen  lds
    s_add_u32 m0, s49, 83968
    s_waitcnt lgkmcnt(4)
    v_mfma_f32_32x32x16_bf16 v[148:163], v[88:91], v[92:95], v[148:163]
    buffer_load_dwordx4 v14, s[60:63], s53 offen  lds
    s_add_u32 m0, s49, 84992
    v_mfma_f32_32x32x16_bf16 v[164:179], v[88:91], v[96:99], v[164:179]
    buffer_load_dwordx4 v15, s[60:63], s53 offen  lds
    s_mov_b32 m0, s4
    s_waitcnt lgkmcnt(2)
    v_mfma_f32_32x32x16_bf16 v[116:131], v[100:103], v[108:111], v[116:131]
    ds_read_b128 v[84:87], v72 offset:32768
    ds_read_b128 v[92:95], v80 offset:32768
    buffer_load_dwordx4 v17, s[64:67], s54 offen lds
    s_waitcnt lgkmcnt(3)
    v_mfma_f32_32x32x16_bf16 v[132:147], v[100:103], v[112:115], v[132:147]
    ds_read_b128 v[96:99], v80 offset:36864
    ds_read_b128 v[88:91], v72 offset:36864
    buffer_load_dwordx4 v[18:21], v18, s[68:71], 0 offen
    s_waitcnt lgkmcnt(4)
    v_mfma_f32_32x32x16_bf16 v[148:163], v[104:107], v[108:111], v[148:163]
    buffer_load_dwordx4 v[22:25], v22, s[68:71], 0 offen
    v_mfma_f32_32x32x16_bf16 v[164:179], v[104:107], v[112:115], v[164:179]
    buffer_load_dwordx4 v[26:29], v26, s[68:71], 0 offen
    s_waitcnt lgkmcnt(2)
    v_mfma_f32_32x32x16_bf16 v[116:131], v[84:87], v[92:95], v[116:131]
    ds_read_b128 v[100:103], v73 offset:32768
    ds_read_b128 v[108:111], v81 offset:32768
    buffer_load_dwordx4 v[30:33], v16, s[68:71], 0 offen offset:0
    s_waitcnt lgkmcnt(3)
    v_mfma_f32_32x32x16_bf16 v[132:147], v[84:87], v[96:99], v[132:147]
    ds_read_b128 v[112:115], v81 offset:36864
    ds_read_b128 v[104:107], v73 offset:36864
    buffer_load_dwordx4 v[34:37], v16, s[68:71], 0 offen offset:2048
    s_waitcnt lgkmcnt(4)
    v_mfma_f32_32x32x16_bf16 v[148:163], v[88:91], v[92:95], v[148:163]
    buffer_load_dwordx4 v[38:41], v16, s[68:71], s50 offen offset:0
    v_mfma_f32_32x32x16_bf16 v[164:179], v[88:91], v[96:99], v[164:179]
    buffer_load_dwordx4 v[42:45], v16, s[68:71], s50 offen offset:2048
    s_waitcnt lgkmcnt(0)
    s_waitcnt vmcnt(24)
    s_barrier
    v_mfma_f32_32x32x16_bf16 v[116:131], v[100:103], v[108:111], v[116:131]
    ds_read_b128 v[84:87], v66 offset:0
    ds_read_b128 v[92:95], v74 offset:0
    buffer_load_dwordx4 v[46:49], v16, s[72:75], 0 offen offset:0
    v_mfma_f32_32x32x16_bf16 v[132:147], v[100:103], v[112:115], v[132:147]
    ds_read_b128 v[96:99], v74 offset:4096
    ds_read_b128 v[88:91], v66 offset:4096
    buffer_load_dwordx4 v[50:53], v16, s[72:75], 0 offen offset:2048
    v_mfma_f32_32x32x16_bf16 v[148:163], v[104:107], v[108:111], v[148:163]
    buffer_load_dwordx4 v[54:57], v16, s[72:75], s50 offen offset:0
    v_mfma_f32_32x32x16_bf16 v[164:179], v[104:107], v[112:115], v[164:179]
    buffer_load_dwordx4 v[58:61], v16, s[72:75], s50 offen offset:2048
    s_add_u32 s51, s51, 128
    s_and_b32 s51, s51, 0x7ff
    s_add_u32 s52, s47, s51
    s_add_u32 m0, s49, 98304
    s_waitcnt lgkmcnt(2)
    v_mfma_f32_32x32x16_bf16 v[116:131], v[84:87], v[92:95], v[116:131]
    ds_read_b128 v[100:103], v67 offset:0
    ds_read_b128 v[108:111], v75 offset:0
    buffer_load_dwordx4 v8, s[56:59], s52 offen  lds
    s_add_u32 m0, s49, 99328
    s_waitcnt lgkmcnt(3)
    v_mfma_f32_32x32x16_bf16 v[132:147], v[84:87], v[96:99], v[132:147]
    ds_read_b128 v[112:115], v75 offset:4096
    ds_read_b128 v[104:107], v67 offset:4096
    buffer_load_dwordx4 v9, s[56:59], s52 offen  lds
    s_add_u32 m0, s49, 100352
    s_waitcnt lgkmcnt(4)
    v_mfma_f32_32x32x16_bf16 v[148:163], v[88:91], v[92:95], v[148:163]
    buffer_load_dwordx4 v10, s[56:59], s52 offen  lds
    s_add_u32 m0, s49, 101376
    v_mfma_f32_32x32x16_bf16 v[164:179], v[88:91], v[96:99], v[164:179]
    buffer_load_dwordx4 v11, s[56:59], s52 offen  lds
    s_add_u32 s53, s48, s51
    s_add_u32 m0, s49, 114688
    s_waitcnt lgkmcnt(2)
    v_mfma_f32_32x32x16_bf16 v[116:131], v[100:103], v[108:111], v[116:131]
    ds_read_b128 v[84:87], v68 offset:0
    ds_read_b128 v[92:95], v76 offset:0
    buffer_load_dwordx4 v12, s[60:63], s53 offen  lds
    s_add_u32 m0, s49, 115712
    s_waitcnt lgkmcnt(3)
    v_mfma_f32_32x32x16_bf16 v[132:147], v[100:103], v[112:115], v[132:147]
    ds_read_b128 v[96:99], v76 offset:4096
    ds_read_b128 v[88:91], v68 offset:4096
    buffer_load_dwordx4 v13, s[60:63], s53 offen  lds
    s_add_u32 m0, s49, 116736
    s_waitcnt lgkmcnt(4)
    v_mfma_f32_32x32x16_bf16 v[148:163], v[104:107], v[108:111], v[148:163]
    buffer_load_dwordx4 v14, s[60:63], s53 offen  lds
    s_add_u32 m0, s49, 117760
    v_mfma_f32_32x32x16_bf16 v[164:179], v[104:107], v[112:115], v[164:179]
    buffer_load_dwordx4 v15, s[60:63], s53 offen  lds
    s_waitcnt lgkmcnt(2)
    v_mfma_f32_32x32x16_bf16 v[116:131], v[84:87], v[92:95], v[116:131]
    ds_read_b128 v[100:103], v69 offset:0
    ds_read_b128 v[108:111], v77 offset:0
    s_waitcnt lgkmcnt(3)
    v_mfma_f32_32x32x16_bf16 v[132:147], v[84:87], v[96:99], v[132:147]
    ds_read_b128 v[112:115], v77 offset:4096
    ds_read_b128 v[104:107], v69 offset:4096
    s_waitcnt lgkmcnt(4)
    v_mfma_f32_32x32x16_bf16 v[148:163], v[88:91], v[92:95], v[148:163]
    v_mfma_f32_32x32x16_bf16 v[164:179], v[88:91], v[96:99], v[164:179]
    s_waitcnt lgkmcnt(0)
    s_waitcnt vmcnt(28)
    s_barrier
    s_add_u32 s51, s51, 128
    s_and_b32 s51, s51, 0x7ff
    s_add_u32 s52, s47, s51
    s_add_u32 m0, s49, 0
    v_mfma_f32_32x32x16_bf16 v[116:131], v[100:103], v[108:111], v[116:131]
    ds_read_b128 v[84:87], v66 offset:32768
    ds_read_b128 v[92:95], v74 offset:32768
    buffer_load_dwordx4 v8, s[56:59], s52 offen  lds
    s_add_u32 m0, s49, 1024
    v_mfma_f32_32x32x16_bf16 v[132:147], v[100:103], v[112:115], v[132:147]
    ds_read_b128 v[96:99], v74 offset:36864
    ds_read_b128 v[88:91], v66 offset:36864
    buffer_load_dwordx4 v9, s[56:59], s52 offen  lds
    s_add_u32 m0, s49, 2048
    v_mfma_f32_32x32x16_bf16 v[148:163], v[104:107], v[108:111], v[148:163]
    buffer_load_dwordx4 v10, s[56:59], s52 offen  lds
    s_add_u32 m0, s49, 3072
    v_mfma_f32_32x32x16_bf16 v[164:179], v[104:107], v[112:115], v[164:179]
    buffer_load_dwordx4 v11, s[56:59], s52 offen  lds
    s_waitcnt lgkmcnt(2)
    v_mfma_f32_32x32x16_bf16 v[116:131], v[84:87], v[92:95], v[116:131]
    ds_read_b128 v[100:103], v67 offset:32768
    ds_read_b128 v[108:111], v75 offset:32768
    s_mov_b32 s7, 0x05040100
    s_mov_b32 s12, 0x07060302
    s_waitcnt vmcnt(23)
    s_waitcnt lgkmcnt(3)
    v_mfma_f32_32x32x16_bf16 v[132:147], v[84:87], v[96:99], v[132:147]
    ds_read_b128 v[112:115], v75 offset:36864
    ds_read_b128 v[104:107], v67 offset:36864
    ds_read_b128 v[184:187], v180 offset:0
    s_add_u32 s53, s48, s51
    s_add_u32 m0, s49, 16384
    s_waitcnt lgkmcnt(5)
    v_mfma_f32_32x32x16_bf16 v[148:163], v[88:91], v[92:95], v[148:163]
    buffer_load_dwordx4 v12, s[60:63], s53 offen  lds
    ds_read_b128 v[188:191], v180 offset:16
    s_waitcnt vmcnt(22)
    v_perm_b32 v196, v18, v22, s7
    s_waitcnt vmcnt(21)
    v_perm_b32 v197, v22, v26, s7
    s_add_u32 m0, s49, 17408
    v_mfma_f32_32x32x16_bf16 v[164:179], v[88:91], v[96:99], v[164:179]
    buffer_load_dwordx4 v13, s[60:63], s53 offen  lds
    s_waitcnt vmcnt(21)
    v_perm_b32 v198, v26, v30, s7
    s_waitcnt vmcnt(20)
    v_perm_b32 v199, v30, v34, s7
    s_waitcnt vmcnt(19)
    v_perm_b32 v200, v34, v38, s7
    s_waitcnt vmcnt(18)
    v_perm_b32 v201, v38, v42, s7
    s_waitcnt lgkmcnt(4)
    v_mfma_f32_32x32x16_bf16 v[116:131], v[100:103], v[108:111], v[116:131]
    ds_read_b128 v[84:87], v68 offset:32768
    ds_read_b128 v[92:95], v76 offset:32768
    s_waitcnt vmcnt(17)
    v_lshlrev_b32 v192, 16, v46
    s_waitcnt vmcnt(16)
    v_lshlrev_b32 v193, 16, v50
    s_waitcnt vmcnt(15)
    v_lshlrev_b32 v194, 16, v54
    s_waitcnt lgkmcnt(5)
    v_mfma_f32_32x32x16_bf16 v[132:147], v[100:103], v[112:115], v[132:147]
    ds_read_b128 v[96:99], v76 offset:36864
    ds_read_b128 v[88:91], v68 offset:36864
    s_waitcnt vmcnt(14)
    v_lshlrev_b32 v195, 16, v58
    s_waitcnt lgkmcnt(5)
    v_dot2_f32_bf16 v203, v196, v185, 0
    s_add_u32 m0, s49, 18432
    v_mfma_f32_32x32x16_bf16 v[148:163], v[104:107], v[108:111], v[148:163]
    buffer_load_dwordx4 v14, s[60:63], s53 offen  lds
    v_dot2_f32_bf16 v204, v197, v185, 0
    v_dot2_f32_bf16 v205, v198, v185, 0
    v_dot2_f32_bf16 v206, v199, v185, 0
    s_add_u32 m0, s49, 19456
    v_mfma_f32_32x32x16_bf16 v[164:179], v[104:107], v[112:115], v[164:179]
    buffer_load_dwordx4 v15, s[60:63], s53 offen  lds
    v_dot2c_f32_bf16 v203, v198, v184
    v_dot2c_f32_bf16 v204, v199, v184
    v_dot2c_f32_bf16 v205, v200, v184
    v_dot2c_f32_bf16 v206, v201, v184
    s_waitcnt lgkmcnt(2)
    v_mfma_f32_32x32x16_bf16 v[116:131], v[84:87], v[92:95], v[116:131]
    ds_read_b128 v[100:103], v69 offset:32768
    ds_read_b128 v[108:111], v77 offset:32768
    v_mul_f32 v203, v203, v192
    v_mul_f32 v204, v204, v193
    v_mul_f32 v205, v205, v194
    s_waitcnt lgkmcnt(3)
    v_mfma_f32_32x32x16_bf16 v[132:147], v[84:87], v[96:99], v[132:147]
    ds_read_b128 v[112:115], v77 offset:36864
    ds_read_b128 v[104:107], v69 offset:36864
    v_mul_f32 v206, v206, v195
    v_cvt_pk_bf16_f32 v210, v206, v205
    v_cvt_pk_bf16_f32 v211, v204, v203
    s_waitcnt lgkmcnt(4)
    v_mfma_f32_32x32x16_bf16 v[148:163], v[88:91], v[92:95], v[148:163]
    v_perm_b32 v196, v18, v22, s12
    v_perm_b32 v197, v22, v26, s12
    v_perm_b32 v198, v26, v30, s12
    v_perm_b32 v199, v30, v34, s12
    v_perm_b32 v200, v34, v38, s12
    v_mfma_f32_32x32x16_bf16 v[164:179], v[88:91], v[96:99], v[164:179]
    v_perm_b32 v201, v38, v42, s12
    v_and_b32 v192, s5, v46
    v_and_b32 v193, s5, v50
    v_and_b32 v194, s5, v54
    v_and_b32 v195, s5, v58
    s_waitcnt lgkmcnt(0)
    s_barrier
    v_mfma_f32_32x32x16_bf16 v[116:131], v[100:103], v[108:111], v[116:131]
    ds_read_b128 v[84:87], v70 offset:0
    ds_read_b128 v[92:95], v78 offset:0
    v_dot2_f32_bf16 v203, v196, v187, 0
    v_dot2_f32_bf16 v204, v197, v187, 0
    v_dot2_f32_bf16 v205, v198, v187, 0
    v_mfma_f32_32x32x16_bf16 v[132:147], v[100:103], v[112:115], v[132:147]
    ds_read_b128 v[96:99], v78 offset:4096
    ds_read_b128 v[88:91], v70 offset:4096
    s_add_u32 s51, s51, 128
    s_and_b32 s51, s51, 0x7ff
    s_add_u32 s52, s47, s51
    s_add_u32 m0, s49, 32768
    v_mfma_f32_32x32x16_bf16 v[148:163], v[104:107], v[108:111], v[148:163]
    buffer_load_dwordx4 v8, s[56:59], s52 offen  lds
    v_dot2_f32_bf16 v206, v199, v187, 0
    v_dot2c_f32_bf16 v203, v198, v186
    v_dot2c_f32_bf16 v204, v199, v186
    s_add_u32 m0, s49, 33792
    v_mfma_f32_32x32x16_bf16 v[164:179], v[104:107], v[112:115], v[164:179]
    buffer_load_dwordx4 v9, s[56:59], s52 offen  lds
    v_dot2c_f32_bf16 v205, v200, v186
    v_dot2c_f32_bf16 v206, v201, v186
    v_mul_f32 v203, v203, v192
    v_mul_f32 v204, v204, v193
    s_waitcnt lgkmcnt(2)
    v_mfma_f32_32x32x16_bf16 v[116:131], v[84:87], v[92:95], v[116:131]
    ds_read_b128 v[100:103], v71 offset:0
    ds_read_b128 v[108:111], v79 offset:0
    v_mul_f32 v205, v205, v194
    v_mul_f32 v206, v206, v195
    v_cvt_pk_bf16_f32 v208, v206, v205
    s_waitcnt lgkmcnt(3)
    v_mfma_f32_32x32x16_bf16 v[132:147], v[84:87], v[96:99], v[132:147]
    ds_read_b128 v[112:115], v79 offset:4096
    ds_read_b128 v[104:107], v71 offset:4096
    v_cvt_pk_bf16_f32 v209, v204, v203
    ds_read_b128 v[184:187], v180 offset:32
    s_add_u32 m0, s49, 34816
    s_waitcnt lgkmcnt(5)
    v_mfma_f32_32x32x16_bf16 v[148:163], v[88:91], v[92:95], v[148:163]
    buffer_load_dwordx4 v10, s[56:59], s52 offen  lds
    v_perm_b32 v196, v19, v23, s7
    v_perm_b32 v197, v23, v27, s7
    v_permlane32_swap_b32 v210, v208
    s_add_u32 m0, s49, 35840
    v_mfma_f32_32x32x16_bf16 v[164:179], v[88:91], v[96:99], v[164:179]
    buffer_load_dwordx4 v11, s[56:59], s52 offen  lds
    v_permlane32_swap_b32 v211, v209
    v_perm_b32 v198, v27, v31, s7
    v_perm_b32 v199, v31, v35, s7
    v_perm_b32 v200, v35, v39, s7
    s_waitcnt lgkmcnt(3)
    v_mfma_f32_32x32x16_bf16 v[116:131], v[100:103], v[108:111], v[116:131]
    ds_read_b128 v[84:87], v72 offset:0
    ds_read_b128 v[92:95], v80 offset:0
    v_perm_b32 v201, v39, v43, s7
    v_lshlrev_b32 v192, 16, v47
    v_lshlrev_b32 v193, 16, v51
    s_waitcnt lgkmcnt(4)
    v_mfma_f32_32x32x16_bf16 v[132:147], v[100:103], v[112:115], v[132:147]
    ds_read_b128 v[96:99], v80 offset:4096
    ds_read_b128 v[88:91], v72 offset:4096
    v_lshlrev_b32 v194, 16, v55
    s_add_u32 s53, s48, s51
    s_add_u32 m0, s49, 49152
    s_waitcnt lgkmcnt(5)
    v_mfma_f32_32x32x16_bf16 v[148:163], v[104:107], v[108:111], v[148:163]
    buffer_load_dwordx4 v12, s[60:63], s53 offen  lds
    v_lshlrev_b32 v195, 16, v59
    v_dot2_f32_bf16 v203, v196, v189, 0
    v_dot2_f32_bf16 v204, v197, v189, 0
    s_add_u32 m0, s49, 50176
    v_mfma_f32_32x32x16_bf16 v[164:179], v[104:107], v[112:115], v[164:179]
    buffer_load_dwordx4 v13, s[60:63], s53 offen  lds
    v_dot2_f32_bf16 v205, v198, v189, 0
    v_dot2_f32_bf16 v206, v199, v189, 0
    v_dot2c_f32_bf16 v203, v198, v188
    v_dot2c_f32_bf16 v204, v199, v188
    s_waitcnt lgkmcnt(2)
    v_mfma_f32_32x32x16_bf16 v[116:131], v[84:87], v[92:95], v[116:131]
    ds_read_b128 v[100:103], v73 offset:0
    ds_read_b128 v[108:111], v81 offset:0
    v_dot2c_f32_bf16 v205, v200, v188
    v_dot2c_f32_bf16 v206, v201, v188
    v_mul_f32 v203, v203, v192
    s_waitcnt lgkmcnt(3)
    v_mfma_f32_32x32x16_bf16 v[132:147], v[84:87], v[96:99], v[132:147]
    ds_read_b128 v[112:115], v81 offset:4096
    ds_read_b128 v[104:107], v73 offset:4096
    v_mul_f32 v204, v204, v193
    v_mul_f32 v205, v205, v194
    s_add_u32 m0, s49, 51200
    s_waitcnt lgkmcnt(4)
    v_mfma_f32_32x32x16_bf16 v[148:163], v[88:91], v[92:95], v[148:163]
    buffer_load_dwordx4 v14, s[60:63], s53 offen  lds
    v_mul_f32 v206, v206, v195
    v_cvt_pk_bf16_f32 v214, v206, v205
    v_cvt_pk_bf16_f32 v215, v204, v203
    s_add_u32 m0, s49, 52224
    v_mfma_f32_32x32x16_bf16 v[164:179], v[88:91], v[96:99], v[164:179]
    buffer_load_dwordx4 v15, s[60:63], s53 offen  lds
    v_perm_b32 v196, v19, v23, s12
    v_perm_b32 v197, v23, v27, s12
    v_perm_b32 v198, v27, v31, s12
    v_perm_b32 v199, v31, v35, s12
    s_waitcnt lgkmcnt(0)
    s_waitcnt vmcnt(16)
    s_barrier
    v_mfma_f32_32x32x16_bf16 v[116:131], v[100:103], v[108:111], v[116:131]
    ds_read_b128 v[84:87], v70 offset:32768
    ds_read_b128 v[92:95], v78 offset:32768
    v_perm_b32 v200, v35, v39, s12
    v_perm_b32 v201, v39, v43, s12
    v_and_b32 v192, s5, v47
    v_mfma_f32_32x32x16_bf16 v[132:147], v[100:103], v[112:115], v[132:147]
    ds_read_b128 v[96:99], v78 offset:36864
    ds_read_b128 v[88:91], v70 offset:36864
    s_add_u32 s51, s51, 128
    s_and_b32 s51, s51, 0x7ff
    s_add_u32 s52, s47, s51
    s_add_u32 m0, s49, 65536
    v_mfma_f32_32x32x16_bf16 v[148:163], v[104:107], v[108:111], v[148:163]
    buffer_load_dwordx4 v8, s[56:59], s52 offen  lds
    v_and_b32 v193, s5, v51
    v_and_b32 v194, s5, v55
    v_and_b32 v195, s5, v59
    s_add_u32 m0, s49, 66560
    v_mfma_f32_32x32x16_bf16 v[164:179], v[104:107], v[112:115], v[164:179]
    buffer_load_dwordx4 v9, s[56:59], s52 offen  lds
    v_dot2_f32_bf16 v203, v196, v191, 0
    v_dot2_f32_bf16 v204, v197, v191, 0
    v_dot2_f32_bf16 v205, v198, v191, 0
    v_dot2_f32_bf16 v206, v199, v191, 0
    s_waitcnt lgkmcnt(2)
    v_mfma_f32_32x32x16_bf16 v[116:131], v[84:87], v[92:95], v[116:131]
    ds_read_b128 v[100:103], v71 offset:32768
    ds_read_b128 v[108:111], v79 offset:32768
    v_dot2c_f32_bf16 v203, v198, v190
    v_dot2c_f32_bf16 v204, v199, v190
    s_add_u32 m0, s49, 67584
    s_waitcnt lgkmcnt(3)
    v_mfma_f32_32x32x16_bf16 v[132:147], v[84:87], v[96:99], v[132:147]
    ds_read_b128 v[112:115], v79 offset:36864
    ds_read_b128 v[104:107], v71 offset:36864
    buffer_load_dwordx4 v10, s[56:59], s52 offen  lds
    v_dot2c_f32_bf16 v205, v200, v190
    s_add_u32 m0, s49, 68608
    s_waitcnt lgkmcnt(4)
    v_mfma_f32_32x32x16_bf16 v[148:163], v[88:91], v[92:95], v[148:163]
    buffer_load_dwordx4 v11, s[56:59], s52 offen  lds
    v_dot2c_f32_bf16 v206, v201, v190
    v_mul_f32 v203, v203, v192
    s_add_u32 s53, s48, s51
    s_add_u32 m0, s49, 81920
    v_mfma_f32_32x32x16_bf16 v[164:179], v[88:91], v[96:99], v[164:179]
    buffer_load_dwordx4 v12, s[60:63], s53 offen  lds
    v_mul_f32 v204, v204, v193
    v_mul_f32 v205, v205, v194
    v_mul_f32 v206, v206, v195
    v_cvt_pk_bf16_f32 v212, v206, v205
    s_waitcnt lgkmcnt(2)
    v_mfma_f32_32x32x16_bf16 v[116:131], v[100:103], v[108:111], v[116:131]
    ds_read_b128 v[84:87], v72 offset:32768
    ds_read_b128 v[92:95], v80 offset:32768
    v_cvt_pk_bf16_f32 v213, v204, v203
    ds_read_b128 v[188:191], v180 offset:48
    s_add_u32 m0, s49, 82944
    s_waitcnt lgkmcnt(4)
    v_mfma_f32_32x32x16_bf16 v[132:147], v[100:103], v[112:115], v[132:147]
    ds_read_b128 v[96:99], v80 offset:36864
    ds_read_b128 v[88:91], v72 offset:36864
    buffer_load_dwordx4 v13, s[60:63], s53 offen  lds
    v_perm_b32 v196, v20, v24, s7
    s_add_u32 m0, s49, 83968
    s_waitcnt lgkmcnt(5)
    v_mfma_f32_32x32x16_bf16 v[148:163], v[104:107], v[108:111], v[148:163]
    buffer_load_dwordx4 v14, s[60:63], s53 offen  lds
    v_perm_b32 v197, v24, v28, s7
    v_permlane32_swap_b32 v214, v212
    v_permlane32_swap_b32 v215, v213
    s_add_u32 m0, s49, 84992
    v_mfma_f32_32x32x16_bf16 v[164:179], v[104:107], v[112:115], v[164:179]
    buffer_load_dwordx4 v15, s[60:63], s53 offen  lds
    v_perm_b32 v198, v28, v32, s7
    v_perm_b32 v199, v32, v36, s7
    v_perm_b32 v200, v36, v40, s7
    v_perm_b32 v201, v40, v44, s7
    s_waitcnt lgkmcnt(3)
    v_mfma_f32_32x32x16_bf16 v[116:131], v[84:87], v[92:95], v[116:131]
    ds_read_b128 v[100:103], v73 offset:32768
    ds_read_b128 v[108:111], v81 offset:32768
    v_lshlrev_b32 v192, 16, v48
    v_lshlrev_b32 v193, 16, v52
    s_add_u32 m0, s16, 0
    s_waitcnt lgkmcnt(3)
    v_mfma_f32_32x32x16_bf16 v[132:147], v[84:87], v[96:99], v[132:147]
    ds_read_b128 v[112:115], v81 offset:36864
    ds_read_b128 v[104:107], v73 offset:36864
    buffer_load_dwordx4 v224, s[80:83], s14 offen  lds
    v_lshlrev_b32 v194, 16, v56
    s_add_u32 m0, s16, 1024
    s_waitcnt lgkmcnt(4)
    v_mfma_f32_32x32x16_bf16 v[148:163], v[88:91], v[92:95], v[148:163]
    buffer_load_dwordx4 v224, s[80:83], s15 offen  lds
    v_lshlrev_b32 v195, 16, v60
    v_dot2_f32_bf16 v203, v196, v185, 0
    v_dot2_f32_bf16 v204, v197, v185, 0
    s_add_u32 m0, s16, 2048
    v_mfma_f32_32x32x16_bf16 v[164:179], v[88:91], v[96:99], v[164:179]
    buffer_load_dwordx4 v224, s[84:87], s14 offen  lds
    v_dot2_f32_bf16 v205, v198, v185, 0
    v_dot2_f32_bf16 v206, v199, v185, 0
    v_dot2c_f32_bf16 v203, v198, v184
    v_dot2c_f32_bf16 v204, v199, v184
    s_waitcnt lgkmcnt(0)
    s_waitcnt vmcnt(19)
    s_barrier
    v_mfma_f32_32x32x16_bf16 v[116:131], v[100:103], v[108:111], v[116:131]
    ds_read_b128 v[84:87], v66 offset:0
    ds_read_b128 v[92:95], v74 offset:0
    v_dot2c_f32_bf16 v205, v200, v184
    v_dot2c_f32_bf16 v206, v201, v184
    s_add_u32 m0, s16, 3072
    v_mfma_f32_32x32x16_bf16 v[132:147], v[100:103], v[112:115], v[132:147]
    ds_read_b128 v[96:99], v74 offset:4096
    ds_read_b128 v[88:91], v66 offset:4096
    buffer_load_dwordx4 v224, s[84:87], s15 offen  lds
    s_add_u32 s51, s51, 128
    s_and_b32 s51, s51, 0x7ff
    s_add_u32 s52, s47, s51
    s_add_u32 m0, s49, 98304
    v_mfma_f32_32x32x16_bf16 v[148:163], v[104:107], v[108:111], v[148:163]
    buffer_load_dwordx4 v8, s[56:59], s52 offen  lds
    v_mul_f32 v203, v203, v192
    v_mul_f32 v204, v204, v193
    v_mul_f32 v205, v205, v194
    s_add_u32 m0, s49, 99328
    v_mfma_f32_32x32x16_bf16 v[164:179], v[104:107], v[112:115], v[164:179]
    buffer_load_dwordx4 v9, s[56:59], s52 offen  lds
    v_mul_f32 v206, v206, v195
    v_cvt_pk_bf16_f32 v218, v206, v205
    v_cvt_pk_bf16_f32 v219, v204, v203
    v_perm_b32 v196, v20, v24, s12
    s_waitcnt lgkmcnt(2)
    v_mfma_f32_32x32x16_bf16 v[116:131], v[84:87], v[92:95], v[116:131]
    ds_read_b128 v[100:103], v67 offset:0
    ds_read_b128 v[108:111], v75 offset:0
    v_perm_b32 v197, v24, v28, s12
    v_perm_b32 v198, v28, v32, s12
    v_perm_b32 v199, v32, v36, s12
    s_waitcnt lgkmcnt(3)
    v_mfma_f32_32x32x16_bf16 v[132:147], v[84:87], v[96:99], v[132:147]
    ds_read_b128 v[112:115], v75 offset:4096
    ds_read_b128 v[104:107], v67 offset:4096
    v_perm_b32 v200, v36, v40, s12
    v_perm_b32 v201, v40, v44, s12
    s_add_u32 m0, s49, 100352
    s_waitcnt lgkmcnt(4)
    v_mfma_f32_32x32x16_bf16 v[148:163], v[88:91], v[92:95], v[148:163]
    buffer_load_dwordx4 v10, s[56:59], s52 offen  lds
    v_and_b32 v192, s5, v48
    v_and_b32 v193, s5, v52
    v_and_b32 v194, s5, v56
    s_add_u32 m0, s49, 101376
    v_mfma_f32_32x32x16_bf16 v[164:179], v[88:91], v[96:99], v[164:179]
    buffer_load_dwordx4 v11, s[56:59], s52 offen  lds
    v_and_b32 v195, s5, v60
    v_dot2_f32_bf16 v203, v196, v187, 0
    v_dot2_f32_bf16 v204, v197, v187, 0
    v_dot2_f32_bf16 v205, v198, v187, 0
    s_waitcnt lgkmcnt(2)
    v_mfma_f32_32x32x16_bf16 v[116:131], v[100:103], v[108:111], v[116:131]
    ds_read_b128 v[84:87], v68 offset:0
    ds_read_b128 v[92:95], v76 offset:0
    v_dot2_f32_bf16 v206, v199, v187, 0
    v_dot2c_f32_bf16 v203, v198, v186
    v_dot2c_f32_bf16 v204, v199, v186
    s_waitcnt lgkmcnt(3)
    v_mfma_f32_32x32x16_bf16 v[132:147], v[100:103], v[112:115], v[132:147]
    ds_read_b128 v[96:99], v76 offset:4096
    ds_read_b128 v[88:91], v68 offset:4096
    v_dot2c_f32_bf16 v205, v200, v186
    s_add_u32 s53, s48, s51
    s_add_u32 m0, s49, 114688
    s_waitcnt lgkmcnt(4)
    v_mfma_f32_32x32x16_bf16 v[148:163], v[104:107], v[108:111], v[148:163]
    buffer_load_dwordx4 v12, s[60:63], s53 offen  lds
    v_dot2c_f32_bf16 v206, v201, v186
    v_mul_f32 v203, v203, v192
    v_mul_f32 v204, v204, v193
    s_add_u32 m0, s49, 115712
    v_mfma_f32_32x32x16_bf16 v[164:179], v[104:107], v[112:115], v[164:179]
    buffer_load_dwordx4 v13, s[60:63], s53 offen  lds
    v_mul_f32 v205, v205, v194
    v_mul_f32 v206, v206, v195
    v_cvt_pk_bf16_f32 v216, v206, v205
    v_cvt_pk_bf16_f32 v217, v204, v203
    s_waitcnt lgkmcnt(2)
    v_mfma_f32_32x32x16_bf16 v[116:131], v[84:87], v[92:95], v[116:131]
    ds_read_b128 v[100:103], v69 offset:0
    ds_read_b128 v[108:111], v77 offset:0
    v_perm_b32 v196, v21, v25, s7
    v_perm_b32 v197, v25, v29, s7
    v_permlane32_swap_b32 v218, v216
    s_waitcnt lgkmcnt(3)
    v_mfma_f32_32x32x16_bf16 v[132:147], v[84:87], v[96:99], v[132:147]
    ds_read_b128 v[112:115], v77 offset:4096
    ds_read_b128 v[104:107], v69 offset:4096
    v_permlane32_swap_b32 v219, v217
    v_perm_b32 v198, v29, v33, s7
    s_add_u32 m0, s49, 116736
    s_waitcnt lgkmcnt(4)
    v_mfma_f32_32x32x16_bf16 v[148:163], v[88:91], v[92:95], v[148:163]
    buffer_load_dwordx4 v14, s[60:63], s53 offen  lds
    v_perm_b32 v199, v33, v37, s7
    v_perm_b32 v200, v37, v41, s7
    v_perm_b32 v201, v41, v45, s7
    s_add_u32 m0, s49, 117760
    v_mfma_f32_32x32x16_bf16 v[164:179], v[88:91], v[96:99], v[164:179]
    buffer_load_dwordx4 v15, s[60:63], s53 offen  lds
    v_lshlrev_b32 v192, 16, v49
    v_lshlrev_b32 v193, 16, v53
    v_lshlrev_b32 v194, 16, v57
    v_lshlrev_b32 v195, 16, v61
    s_waitcnt lgkmcnt(0)
    s_waitcnt vmcnt(20)
    s_barrier
    v_mfma_f32_32x32x16_bf16 v[116:131], v[100:103], v[108:111], v[116:131]
    ds_read_b128 v[84:87], v66 offset:32768
    ds_read_b128 v[92:95], v74 offset:32768
    v_dot2_f32_bf16 v203, v196, v189, 0
    v_dot2_f32_bf16 v204, v197, v189, 0
    v_dot2_f32_bf16 v205, v198, v189, 0
    v_mfma_f32_32x32x16_bf16 v[132:147], v[100:103], v[112:115], v[132:147]
    ds_read_b128 v[96:99], v74 offset:36864
    ds_read_b128 v[88:91], v66 offset:36864
    s_add_u32 s51, s51, 128
    s_and_b32 s51, s51, 0x7ff
    s_add_u32 s52, s47, s51
    s_add_u32 m0, s49, 0
    v_mfma_f32_32x32x16_bf16 v[148:163], v[104:107], v[108:111], v[148:163]
    buffer_load_dwordx4 v8, s[56:59], s52 offen  lds
    v_dot2_f32_bf16 v206, v199, v189, 0
    v_dot2c_f32_bf16 v203, v198, v188
    v_dot2c_f32_bf16 v204, v199, v188
    s_add_u32 m0, s49, 1024
    v_mfma_f32_32x32x16_bf16 v[164:179], v[104:107], v[112:115], v[164:179]
    buffer_load_dwordx4 v9, s[56:59], s52 offen  lds
    v_dot2c_f32_bf16 v205, v200, v188
    v_dot2c_f32_bf16 v206, v201, v188
    v_mul_f32 v203, v203, v192
    v_mul_f32 v204, v204, v193
    s_waitcnt lgkmcnt(2)
    v_mfma_f32_32x32x16_bf16 v[116:131], v[84:87], v[92:95], v[116:131]
    ds_read_b128 v[100:103], v67 offset:32768
    ds_read_b128 v[108:111], v75 offset:32768
    v_mul_f32 v205, v205, v194
    v_mul_f32 v206, v206, v195
    v_cvt_pk_bf16_f32 v222, v206, v205
    s_waitcnt lgkmcnt(3)
    v_mfma_f32_32x32x16_bf16 v[132:147], v[84:87], v[96:99], v[132:147]
    ds_read_b128 v[112:115], v75 offset:36864
    ds_read_b128 v[104:107], v67 offset:36864
    v_cvt_pk_bf16_f32 v223, v204, v203
    v_perm_b32 v196, v21, v25, s12
    s_add_u32 m0, s49, 2048
    s_waitcnt lgkmcnt(4)
    v_mfma_f32_32x32x16_bf16 v[148:163], v[88:91], v[92:95], v[148:163]
    buffer_load_dwordx4 v10, s[56:59], s52 offen  lds
    v_perm_b32 v197, v25, v29, s12
    v_perm_b32 v198, v29, v33, s12
    v_perm_b32 v199, v33, v37, s12
    s_add_u32 m0, s49, 3072
    v_mfma_f32_32x32x16_bf16 v[164:179], v[88:91], v[96:99], v[164:179]
    buffer_load_dwordx4 v11, s[56:59], s52 offen  lds
    v_perm_b32 v200, v37, v41, s12
    v_perm_b32 v201, v41, v45, s12
    v_and_b32 v192, s5, v49
    v_and_b32 v193, s5, v53
    s_waitcnt lgkmcnt(2)
    v_mfma_f32_32x32x16_bf16 v[116:131], v[100:103], v[108:111], v[116:131]
    ds_read_b128 v[84:87], v68 offset:32768
    ds_read_b128 v[92:95], v76 offset:32768
    v_and_b32 v194, s5, v57
    v_and_b32 v195, s5, v61
    v_dot2_f32_bf16 v203, v196, v191, 0
    s_waitcnt lgkmcnt(3)
    v_mfma_f32_32x32x16_bf16 v[132:147], v[100:103], v[112:115], v[132:147]
    ds_read_b128 v[96:99], v76 offset:36864
    ds_read_b128 v[88:91], v68 offset:36864
    v_dot2_f32_bf16 v204, v197, v191, 0
    s_add_u32 s53, s48, s51
    s_add_u32 m0, s49, 16384
    s_waitcnt lgkmcnt(4)
    v_mfma_f32_32x32x16_bf16 v[148:163], v[104:107], v[108:111], v[148:163]
    buffer_load_dwordx4 v12, s[60:63], s53 offen  lds
    v_dot2_f32_bf16 v205, v198, v191, 0
    v_dot2_f32_bf16 v206, v199, v191, 0
    v_dot2c_f32_bf16 v203, v198, v190
    s_add_u32 m0, s49, 17408
    v_mfma_f32_32x32x16_bf16 v[164:179], v[104:107], v[112:115], v[164:179]
    buffer_load_dwordx4 v13, s[60:63], s53 offen  lds
    v_dot2c_f32_bf16 v204, v199, v190
    v_dot2c_f32_bf16 v205, v200, v190
    v_dot2c_f32_bf16 v206, v201, v190
    v_mul_f32 v203, v203, v192
    s_waitcnt lgkmcnt(2)
    v_mfma_f32_32x32x16_bf16 v[116:131], v[84:87], v[92:95], v[116:131]
    ds_read_b128 v[100:103], v69 offset:32768
    ds_read_b128 v[108:111], v77 offset:32768
    v_mul_f32 v204, v204, v193
    v_mul_f32 v205, v205, v194
    v_mul_f32 v206, v206, v195
    s_waitcnt lgkmcnt(3)
    v_mfma_f32_32x32x16_bf16 v[132:147], v[84:87], v[96:99], v[132:147]
    ds_read_b128 v[112:115], v77 offset:36864
    ds_read_b128 v[104:107], v69 offset:36864
    v_cvt_pk_bf16_f32 v220, v206, v205
    v_cvt_pk_bf16_f32 v221, v204, v203
    s_add_u32 m0, s49, 18432
    s_waitcnt lgkmcnt(4)
    v_mfma_f32_32x32x16_bf16 v[148:163], v[88:91], v[92:95], v[148:163]
    buffer_load_dwordx4 v14, s[60:63], s53 offen  lds
    v_permlane32_swap_b32 v222, v220
    v_permlane32_swap_b32 v223, v221
    s_add_u32 m0, s49, 19456
    v_mfma_f32_32x32x16_bf16 v[164:179], v[88:91], v[96:99], v[164:179]
    buffer_load_dwordx4 v15, s[60:63], s53 offen  lds
    s_waitcnt lgkmcnt(0)
    s_waitcnt vmcnt(20)
    s_barrier
    v_mfma_f32_32x32x16_bf16 v[116:131], v[100:103], v[108:111], v[116:131]
    ds_read_b128 v[84:87], v70 offset:0
    ds_read_b128 v[92:95], v78 offset:0
    v_mfma_f32_32x32x16_bf16 v[132:147], v[100:103], v[112:115], v[132:147]
    ds_read_b128 v[96:99], v78 offset:4096
    ds_read_b128 v[88:91], v70 offset:4096
    s_add_u32 s51, s51, 128
    s_and_b32 s51, s51, 0x7ff
    s_add_u32 s52, s47, s51
    s_add_u32 m0, s49, 32768
    v_mfma_f32_32x32x16_bf16 v[148:163], v[104:107], v[108:111], v[148:163]
    buffer_load_dwordx4 v8, s[56:59], s52 offen  lds
    s_add_u32 m0, s49, 33792
    v_mfma_f32_32x32x16_bf16 v[164:179], v[104:107], v[112:115], v[164:179]
    buffer_load_dwordx4 v9, s[56:59], s52 offen  lds
    s_waitcnt lgkmcnt(2)
    v_mfma_f32_32x32x16_bf16 v[116:131], v[84:87], v[92:95], v[116:131]
    ds_read_b128 v[100:103], v71 offset:0
    ds_read_b128 v[108:111], v79 offset:0
    s_waitcnt lgkmcnt(3)
    v_mfma_f32_32x32x16_bf16 v[132:147], v[84:87], v[96:99], v[132:147]
    ds_read_b128 v[112:115], v79 offset:4096
    ds_read_b128 v[104:107], v71 offset:4096
    s_add_u32 m0, s49, 34816
    s_waitcnt lgkmcnt(4)
    v_mfma_f32_32x32x16_bf16 v[148:163], v[88:91], v[92:95], v[148:163]
    buffer_load_dwordx4 v10, s[56:59], s52 offen  lds
    s_add_u32 m0, s49, 35840
    v_mfma_f32_32x32x16_bf16 v[164:179], v[88:91], v[96:99], v[164:179]
    buffer_load_dwordx4 v11, s[56:59], s52 offen  lds
    s_waitcnt lgkmcnt(2)
    v_mfma_f32_32x32x16_bf16 v[116:131], v[100:103], v[108:111], v[116:131]
    ds_read_b128 v[84:87], v72 offset:0
    ds_read_b128 v[92:95], v80 offset:0
    s_waitcnt lgkmcnt(3)
    v_mfma_f32_32x32x16_bf16 v[132:147], v[100:103], v[112:115], v[132:147]
    ds_read_b128 v[96:99], v80 offset:4096
    ds_read_b128 v[88:91], v72 offset:4096
    s_add_u32 s53, s48, s51
    s_add_u32 m0, s49, 49152
    s_waitcnt lgkmcnt(4)
    v_mfma_f32_32x32x16_bf16 v[148:163], v[104:107], v[108:111], v[148:163]
    buffer_load_dwordx4 v12, s[60:63], s53 offen  lds
    s_add_u32 m0, s49, 50176
    v_mfma_f32_32x32x16_bf16 v[164:179], v[104:107], v[112:115], v[164:179]
    buffer_load_dwordx4 v13, s[60:63], s53 offen  lds
    s_waitcnt lgkmcnt(2)
    v_mfma_f32_32x32x16_bf16 v[116:131], v[84:87], v[92:95], v[116:131]
    ds_read_b128 v[100:103], v73 offset:0
    ds_read_b128 v[108:111], v81 offset:0
    s_waitcnt lgkmcnt(3)
    v_mfma_f32_32x32x16_bf16 v[132:147], v[84:87], v[96:99], v[132:147]
    ds_read_b128 v[112:115], v81 offset:4096
    ds_read_b128 v[104:107], v73 offset:4096
    s_add_u32 m0, s49, 51200
    s_waitcnt lgkmcnt(4)
    v_mfma_f32_32x32x16_bf16 v[148:163], v[88:91], v[92:95], v[148:163]
    buffer_load_dwordx4 v14, s[60:63], s53 offen  lds
    s_add_u32 m0, s49, 52224
    v_mfma_f32_32x32x16_bf16 v[164:179], v[88:91], v[96:99], v[164:179]
    buffer_load_dwordx4 v15, s[60:63], s53 offen  lds
    s_waitcnt lgkmcnt(0)
    s_waitcnt vmcnt(16)
    s_barrier
    v_mfma_f32_32x32x16_bf16 v[116:131], v[100:103], v[108:111], v[116:131]
    ds_read_b128 v[84:87], v70 offset:32768
    ds_read_b128 v[92:95], v78 offset:32768
    v_mov_b32 v3, 0
    buffer_load_dwordx2 v[4:5], v3, s[24:27], 0 offen sc0 sc1
    v_mfma_f32_32x32x16_bf16 v[132:147], v[100:103], v[112:115], v[132:147]
    ds_read_b128 v[96:99], v78 offset:36864
    ds_read_b128 v[88:91], v70 offset:36864
    s_add_u32 s51, s51, 128
    s_and_b32 s51, s51, 0x7ff
    s_add_u32 s52, s47, s51
    s_add_u32 m0, s49, 65536
    v_mfma_f32_32x32x16_bf16 v[148:163], v[104:107], v[108:111], v[148:163]
    buffer_load_dwordx4 v8, s[56:59], s52 offen  lds
    buffer_store_dwordx4 v[208:211], v181, s[8:11], s6 offen sc0 sc1
    s_add_u32 m0, s49, 66560
    v_mfma_f32_32x32x16_bf16 v[164:179], v[104:107], v[112:115], v[164:179]
    buffer_load_dwordx4 v9, s[56:59], s52 offen  lds
    s_add_u32 s6, s6, 32768
    buffer_store_dwordx4 v[212:215], v181, s[8:11], s6 offen sc0 sc1
    s_waitcnt lgkmcnt(2)
    v_mfma_f32_32x32x16_bf16 v[116:131], v[84:87], v[92:95], v[116:131]
    ds_read_b128 v[100:103], v71 offset:32768
    ds_read_b128 v[108:111], v79 offset:32768
    s_add_u32 s6, s6, 32768
    buffer_store_dwordx4 v[216:219], v181, s[8:11], s6 offen sc0 sc1
    s_waitcnt lgkmcnt(3)
    v_mfma_f32_32x32x16_bf16 v[132:147], v[84:87], v[96:99], v[132:147]
    ds_read_b128 v[112:115], v79 offset:36864
    ds_read_b128 v[104:107], v71 offset:36864
    s_add_u32 s6, s6, 32768
    s_add_u32 m0, s49, 67584
    s_waitcnt lgkmcnt(4)
    v_mfma_f32_32x32x16_bf16 v[148:163], v[88:91], v[92:95], v[148:163]
    buffer_load_dwordx4 v10, s[56:59], s52 offen  lds
    buffer_store_dwordx4 v[220:223], v181, s[8:11], s6 offen sc0 sc1
    s_add_u32 m0, s49, 68608
    v_mfma_f32_32x32x16_bf16 v[164:179], v[88:91], v[96:99], v[164:179]
    buffer_load_dwordx4 v11, s[56:59], s52 offen  lds
    s_mov_b64 s[30:31], exec
    s_mov_b32 exec_lo, 0
    s_mov_b32 exec_hi, 0x80000000
    buffer_store_dwordx2 v[226:227], v225, s[8:11], 0 offen sc0 sc1
    buffer_store_dwordx2 v[228:229], v225, s[8:11], s32 offen sc0 sc1
    s_mov_b64 exec, s[30:31]
    s_waitcnt lgkmcnt(2)
    v_mfma_f32_32x32x16_bf16 v[116:131], v[100:103], v[108:111], v[116:131]
    ds_read_b128 v[84:87], v72 offset:32768
    ds_read_b128 v[92:95], v80 offset:32768
    s_waitcnt lgkmcnt(3)
    v_mfma_f32_32x32x16_bf16 v[132:147], v[100:103], v[112:115], v[132:147]
    ds_read_b128 v[96:99], v80 offset:36864
    ds_read_b128 v[88:91], v72 offset:36864
    s_add_u32 s53, s48, s51
    s_add_u32 m0, s49, 81920
    s_waitcnt lgkmcnt(4)
    v_mfma_f32_32x32x16_bf16 v[148:163], v[104:107], v[108:111], v[148:163]
    buffer_load_dwordx4 v12, s[60:63], s53 offen  lds
    s_add_u32 m0, s49, 82944
    v_mfma_f32_32x32x16_bf16 v[164:179], v[104:107], v[112:115], v[164:179]
    buffer_load_dwordx4 v13, s[60:63], s53 offen  lds
    s_waitcnt lgkmcnt(2)
    v_mfma_f32_32x32x16_bf16 v[116:131], v[84:87], v[92:95], v[116:131]
    ds_read_b128 v[100:103], v73 offset:32768
    ds_read_b128 v[108:111], v81 offset:32768
    s_waitcnt lgkmcnt(3)
    v_mfma_f32_32x32x16_bf16 v[132:147], v[84:87], v[96:99], v[132:147]
    ds_read_b128 v[112:115], v81 offset:36864
    ds_read_b128 v[104:107], v73 offset:36864
    s_add_u32 m0, s49, 83968
    s_waitcnt lgkmcnt(4)
    v_mfma_f32_32x32x16_bf16 v[148:163], v[88:91], v[92:95], v[148:163]
    buffer_load_dwordx4 v14, s[60:63], s53 offen  lds
    s_add_u32 m0, s49, 84992
    v_mfma_f32_32x32x16_bf16 v[164:179], v[88:91], v[96:99], v[164:179]
    buffer_load_dwordx4 v15, s[60:63], s53 offen  lds
    s_waitcnt lgkmcnt(0)
    s_waitcnt vmcnt(23)
    s_barrier
    v_mfma_f32_32x32x16_bf16 v[116:131], v[100:103], v[108:111], v[116:131]
    ds_read_b128 v[84:87], v66 offset:0
    ds_read_b128 v[92:95], v74 offset:0
    v_mfma_f32_32x32x16_bf16 v[132:147], v[100:103], v[112:115], v[132:147]
    ds_read_b128 v[96:99], v74 offset:4096
    ds_read_b128 v[88:91], v66 offset:4096
    s_add_u32 s51, s51, 128
    s_and_b32 s51, s51, 0x7ff
    s_add_u32 s52, s47, s51
    s_add_u32 m0, s49, 98304
    v_mfma_f32_32x32x16_bf16 v[148:163], v[104:107], v[108:111], v[148:163]
    buffer_load_dwordx4 v8, s[56:59], s52 offen  lds
    s_add_u32 m0, s49, 99328
    v_mfma_f32_32x32x16_bf16 v[164:179], v[104:107], v[112:115], v[164:179]
    buffer_load_dwordx4 v9, s[56:59], s52 offen  lds
    s_waitcnt lgkmcnt(2)
    v_mfma_f32_32x32x16_bf16 v[116:131], v[84:87], v[92:95], v[116:131]
    ds_read_b128 v[100:103], v67 offset:0
    ds_read_b128 v[108:111], v75 offset:0
    s_waitcnt lgkmcnt(3)
    v_mfma_f32_32x32x16_bf16 v[132:147], v[84:87], v[96:99], v[132:147]
    ds_read_b128 v[112:115], v75 offset:4096
    ds_read_b128 v[104:107], v67 offset:4096
    s_add_u32 m0, s49, 100352
    s_waitcnt lgkmcnt(4)
    v_mfma_f32_32x32x16_bf16 v[148:163], v[88:91], v[92:95], v[148:163]
    buffer_load_dwordx4 v10, s[56:59], s52 offen  lds
    s_add_u32 m0, s49, 101376
    v_mfma_f32_32x32x16_bf16 v[164:179], v[88:91], v[96:99], v[164:179]
    buffer_load_dwordx4 v11, s[56:59], s52 offen  lds
    s_waitcnt lgkmcnt(2)
    v_mfma_f32_32x32x16_bf16 v[116:131], v[100:103], v[108:111], v[116:131]
    ds_read_b128 v[84:87], v68 offset:0
    ds_read_b128 v[92:95], v76 offset:0
    s_waitcnt lgkmcnt(3)
    v_mfma_f32_32x32x16_bf16 v[132:147], v[100:103], v[112:115], v[132:147]
    ds_read_b128 v[96:99], v76 offset:4096
    ds_read_b128 v[88:91], v68 offset:4096
    s_add_u32 s53, s48, s51
    s_add_u32 m0, s49, 114688
    s_waitcnt lgkmcnt(4)
    v_mfma_f32_32x32x16_bf16 v[148:163], v[104:107], v[108:111], v[148:163]
    buffer_load_dwordx4 v12, s[60:63], s53 offen  lds
    s_add_u32 m0, s49, 115712
    v_mfma_f32_32x32x16_bf16 v[164:179], v[104:107], v[112:115], v[164:179]
    buffer_load_dwordx4 v13, s[60:63], s53 offen  lds
    s_waitcnt lgkmcnt(2)
    v_mfma_f32_32x32x16_bf16 v[116:131], v[84:87], v[92:95], v[116:131]
    ds_read_b128 v[100:103], v69 offset:0
    ds_read_b128 v[108:111], v77 offset:0
    s_waitcnt lgkmcnt(3)
    v_mfma_f32_32x32x16_bf16 v[132:147], v[84:87], v[96:99], v[132:147]
    ds_read_b128 v[112:115], v77 offset:4096
    ds_read_b128 v[104:107], v69 offset:4096
    s_add_u32 m0, s49, 116736
    s_waitcnt lgkmcnt(4)
    v_mfma_f32_32x32x16_bf16 v[148:163], v[88:91], v[92:95], v[148:163]
    buffer_load_dwordx4 v14, s[60:63], s53 offen  lds
    s_add_u32 m0, s49, 117760
    v_mfma_f32_32x32x16_bf16 v[164:179], v[88:91], v[96:99], v[164:179]
    buffer_load_dwordx4 v15, s[60:63], s53 offen  lds
    s_waitcnt lgkmcnt(0)
    s_waitcnt vmcnt(23)
    s_barrier
    v_mfma_f32_32x32x16_bf16 v[116:131], v[100:103], v[108:111], v[116:131]
    ds_read_b128 v[84:87], v66 offset:32768
    ds_read_b128 v[92:95], v74 offset:32768
    s_lshl_b32 s6, s46, 2
    s_add_u32 s6, s6, s44
    s_lshl_b32 s6, s6, 16
    s_lshl_b32 s3, s45, 12
    v_mfma_f32_32x32x16_bf16 v[132:147], v[100:103], v[112:115], v[132:147]
    ds_read_b128 v[96:99], v74 offset:36864
    ds_read_b128 v[88:91], v66 offset:36864
    s_add_u32 s6, s6, s3
    s_add_u32 s6, s6, 16777216
    s_mov_b32 s7, 0x05040100
    s_mov_b32 s12, 0x07060302
    v_mfma_f32_32x32x16_bf16 v[148:163], v[104:107], v[108:111], v[148:163]
    v_and_b32 v20, 31, v2
    v_lshlrev_b32 v18, 6, v20
    v_bfe_u32 v20, v2, 2, 2
    v_lshrrev_b32 v21, 5, v2
    v_lshlrev_b32 v21, 1, v21
    v_xor_b32 v20, v20, v21
    v_mfma_f32_32x32x16_bf16 v[164:179], v[104:107], v[112:115], v[164:179]
    v_lshl_add_u32 v18, v20, 4, v18
    v_add_u32 v18, s16, v18
    v_xor_b32 v19, 16, v18
    ds_read_b128 v[22:25], v18 offset:0
    ds_read_b128 v[26:29], v19 offset:0
    s_waitcnt lgkmcnt(4)
    v_mfma_f32_32x32x16_bf16 v[116:131], v[84:87], v[92:95], v[116:131]
    ds_read_b128 v[100:103], v67 offset:32768
    ds_read_b128 v[108:111], v75 offset:32768
    ds_read_b128 v[30:33], v18 offset:2048
    ds_read_b128 v[34:37], v19 offset:2048
    s_waitcnt lgkmcnt(1)
    v_perm_b32 v38, v30, v22, s7
    v_perm_b32 v39, v30, v22, s12
    v_mfma_f32_32x32x16_bf16 v[132:147], v[84:87], v[96:99], v[132:147]
    ds_read_b128 v[112:115], v75 offset:36864
    ds_read_b128 v[104:107], v67 offset:36864
    v_perm_b32 v40, v31, v23, s7
    v_perm_b32 v41, v31, v23, s12
    buffer_store_dwordx4 v[38:41], v17, s[8:11], s6 offen offset:0 sc0 sc1
    v_perm_b32 v42, v32, v24, s7
    v_mfma_f32_32x32x16_bf16 v[148:163], v[88:91], v[92:95], v[148:163]
    v_perm_b32 v43, v32, v24, s12
    v_perm_b32 v44, v33, v25, s7
    v_perm_b32 v45, v33, v25, s12
    buffer_store_dwordx4 v[42:45], v17, s[8:11], s6 offen offset:1024 sc0 sc1
    s_waitcnt lgkmcnt(2)
    v_perm_b32 v38, v34, v26, s7
    v_perm_b32 v39, v34, v26, s12
    v_mfma_f32_32x32x16_bf16 v[164:179], v[88:91], v[96:99], v[164:179]
    v_perm_b32 v40, v35, v27, s7
    v_perm_b32 v41, v35, v27, s12
    buffer_store_dwordx4 v[38:41], v17, s[8:11], s6 offen offset:2048 sc0 sc1
    v_perm_b32 v42, v36, v28, s7
    v_perm_b32 v43, v36, v28, s12
    v_perm_b32 v44, v37, v29, s7
    v_mfma_f32_32x32x16_bf16 v[116:131], v[100:103], v[108:111], v[116:131]
    ds_read_b128 v[84:87], v68 offset:32768
    ds_read_b128 v[92:95], v76 offset:32768
    v_perm_b32 v45, v37, v29, s12
    buffer_store_dwordx4 v[42:45], v17, s[8:11], s6 offen offset:3072 sc0 sc1
    s_waitcnt lgkmcnt(3)
    v_mfma_f32_32x32x16_bf16 v[132:147], v[100:103], v[112:115], v[132:147]
    ds_read_b128 v[96:99], v76 offset:36864
    ds_read_b128 v[88:91], v68 offset:36864
    s_waitcnt lgkmcnt(4)
    v_mfma_f32_32x32x16_bf16 v[148:163], v[104:107], v[108:111], v[148:163]
    v_mfma_f32_32x32x16_bf16 v[164:179], v[104:107], v[112:115], v[164:179]
    s_waitcnt lgkmcnt(2)
    v_mfma_f32_32x32x16_bf16 v[116:131], v[84:87], v[92:95], v[116:131]
    ds_read_b128 v[100:103], v69 offset:32768
    ds_read_b128 v[108:111], v77 offset:32768
    s_waitcnt lgkmcnt(3)
    v_mfma_f32_32x32x16_bf16 v[132:147], v[84:87], v[96:99], v[132:147]
    ds_read_b128 v[112:115], v77 offset:36864
    ds_read_b128 v[104:107], v69 offset:36864
    s_waitcnt lgkmcnt(4)
    v_mfma_f32_32x32x16_bf16 v[148:163], v[88:91], v[92:95], v[148:163]
    v_mfma_f32_32x32x16_bf16 v[164:179], v[88:91], v[96:99], v[164:179]
    s_waitcnt lgkmcnt(0)
    s_waitcnt vmcnt(12)
    s_barrier
    v_mfma_f32_32x32x16_bf16 v[116:131], v[100:103], v[108:111], v[116:131]
    ds_read_b128 v[84:87], v70 offset:0
    ds_read_b128 v[92:95], v78 offset:0
    v_subrev_u32 v50, 32, v17
    v_min_u32 v50, 0x7fff0000, v50
    v_add_u32 v51, s23, v17
    buffer_load_dwordx4 v[38:41], v50, s[76:79], 0 offen nt
    v_mfma_f32_32x32x16_bf16 v[132:147], v[100:103], v[112:115], v[132:147]
    ds_read_b128 v[96:99], v78 offset:4096
    ds_read_b128 v[88:91], v70 offset:4096
    buffer_load_dwordx4 v[22:25], v17, s[76:79], 0 offen offset:0 nt
    v_mfma_f32_32x32x16_bf16 v[148:163], v[104:107], v[108:111], v[148:163]
    buffer_load_dwordx4 v[26:29], v17, s[76:79], 0 offen offset:1024 nt
    v_mfma_f32_32x32x16_bf16 v[164:179], v[104:107], v[112:115], v[164:179]
    buffer_load_dwordx4 v[30:33], v17, s[76:79], 0 offen offset:2048 nt
    buffer_load_dwordx4 v[34:37], v17, s[76:79], 0 offen offset:3072 nt
    s_waitcnt lgkmcnt(2)
    v_mfma_f32_32x32x16_bf16 v[116:131], v[84:87], v[92:95], v[116:131]
    ds_read_b128 v[100:103], v71 offset:0
    ds_read_b128 v[108:111], v79 offset:0
    s_mov_b32 s88, s20
    s_waitcnt lgkmcnt(3)
    v_mfma_f32_32x32x16_bf16 v[132:147], v[84:87], v[96:99], v[132:147]
    ds_read_b128 v[112:115], v79 offset:4096
    ds_read_b128 v[104:107], v71 offset:4096
    s_mov_b32 s89, s21
    s_mov_b32 s90, 2048
    s_mov_b32 s91, 131072
    s_and_b32 s3, s44, 1
    s_waitcnt lgkmcnt(4)
    v_mfma_f32_32x32x16_bf16 v[148:163], v[88:91], v[92:95], v[148:163]
    s_lshl_b32 s3, s3, 5
    s_and_b32 s3, s44, 1
    s_lshl_b32 s3, s3, 6
    v_and_b32 v52, 31, v2
    v_lshl_add_u32 v52, v52, 1, s3
    s_lshl_b32 s3, s46, 7
    buffer_load_ushort v52, v52, s[88:91], s3 offen
    v_and_b32 v53, 15, v2
    v_lshrrev_b32 v54, 4, v2
    v_mfma_f32_32x32x16_bf16 v[164:179], v[88:91], v[96:99], v[164:179]
    v_add_u32 v55, 1, v53
    v_and_b32 v56, 1, v55
    v_mul_u32_u24 v56, 4160, v56
    v_and_b32 v55, 30, v55
    v_lshl_add_u32 v56, v55, 1, v56
    v_lshl_add_u32 v56, v54, 4, v56
    s_waitcnt lgkmcnt(2)
    v_mfma_f32_32x32x16_bf16 v[116:131], v[100:103], v[108:111], v[116:131]
    ds_read_b128 v[84:87], v72 offset:0
    ds_read_b128 v[92:95], v80 offset:0
    v_add_u32 v57, s23, v56
    v_add_u32 v63, 1024, v57
    v_add_u32 v64, 2048, v57
    v_add_u32 v65, 3072, v57
    s_waitcnt lgkmcnt(3)
    v_mfma_f32_32x32x16_bf16 v[132:147], v[100:103], v[112:115], v[132:147]
    ds_read_b128 v[96:99], v80 offset:4096
    ds_read_b128 v[88:91], v72 offset:4096
    v_lshlrev_b32 v55, 1, v53
    v_sub_u32 v55, v54, v55
    v_add_u32 v55, 30, v55
    v_lshrrev_b32 v56, 2, v55
    s_waitcnt lgkmcnt(4)
    v_mfma_f32_32x32x16_bf16 v[148:163], v[104:107], v[108:111], v[148:163]
    v_lshlrev_b32 v55, 6, v55
    v_add_u32 v55, 132096, v55
    v_add_u32 v58, 63, v56
    v_and_b32 v58, 3, v58
    v_xor_b32 v58, s44, v58
    v_lshl_add_u32 v58, v58, 4, v55
    v_mfma_f32_32x32x16_bf16 v[164:179], v[104:107], v[112:115], v[164:179]
    v_add_u32 v59, 62, v56
    v_and_b32 v59, 3, v59
    v_xor_b32 v59, s44, v59
    v_lshl_add_u32 v59, v59, 4, v55
    v_add_u32 v60, 61, v56
    v_and_b32 v60, 3, v60
    s_waitcnt lgkmcnt(2)
    v_mfma_f32_32x32x16_bf16 v[116:131], v[84:87], v[92:95], v[116:131]
    ds_read_b128 v[100:103], v73 offset:0
    ds_read_b128 v[108:111], v81 offset:0
    v_xor_b32 v60, s44, v60
    v_lshl_add_u32 v60, v60, 4, v55
    v_add_u32 v61, 60, v56
    v_and_b32 v61, 3, v61
    s_waitcnt lgkmcnt(3)
    v_mfma_f32_32x32x16_bf16 v[132:147], v[84:87], v[96:99], v[132:147]
    ds_read_b128 v[112:115], v81 offset:4096
    ds_read_b128 v[104:107], v73 offset:4096
    v_xor_b32 v61, s44, v61
    v_lshl_add_u32 v61, v61, 4, v55
    v_lshlrev_b32 v55, 5, v53
    v_lshl_add_u32 v55, v54, 3, v55
    s_waitcnt lgkmcnt(4)
    v_mfma_f32_32x32x16_bf16 v[148:163], v[88:91], v[92:95], v[148:163]
    v_sub_u32 v55, 504, v55
    v_and_b32 v62, 8, v55
    v_lshrrev_b32 v55, 4, v55
    v_lshl_add_u32 v62, v55, 6, v62
    v_bfe_u32 v55, v55, 2, 2
    v_xor_b32 v55, s44, v55
    v_mfma_f32_32x32x16_bf16 v[164:179], v[88:91], v[96:99], v[164:179]
    v_lshl_add_u32 v62, v55, 4, v62
    v_add_u32 v62, 132096, v62
    v_and_b32 v55, 1, v54
    v_lshlrev_b32 v55, 9, v55
    v_lshl_add_u32 v55, v53, 5, v55
    v_lshrrev_b32 v56, 1, v54
    s_waitcnt lgkmcnt(0)
    s_waitcnt vmcnt(10)
    s_barrier
    v_mfma_f32_32x32x16_bf16 v[116:131], v[100:103], v[108:111], v[116:131]
    ds_read_b128 v[84:87], v70 offset:32768
    ds_read_b128 v[92:95], v78 offset:32768
    v_lshl_add_u32 v180, v56, 4, v55
    s_mov_b32 s6, 0
    v_readfirstlane_b32 s42, v4
    v_readfirstlane_b32 s43, v5
    s_nop 3
    s_or_b32 s3, s42, s43
    s_cmp_lg_u32 s3, 0
    s_cbranch_scc1 Lnok_gate_2
Lnretry_gate_3:
    buffer_load_dwordx2 v[4:5], v3, s[24:27], 0 offen sc0 sc1
    s_waitcnt vmcnt(0)
    v_readfirstlane_b32 s42, v4
    v_readfirstlane_b32 s43, v5
    s_add_u32 s6, s6, 1
    s_nop 3
    s_or_b32 s3, s42, s43
    s_cmp_gt_u32 s6, 20000
    s_cbranch_scc1 Lnok_gate_2
    s_cmp_eq_u32 s3, 0
    s_cbranch_scc1 Lnretry_gate_3
Lnok_gate_2:
    v_mov_b32 v82, s42
    v_mov_b32 v83, s43
    s_mov_b64 s[6:7], exec
    s_mov_b64 exec, 1
    buffer_store_dwordx2 v[82:83], v6, s[8:11], s13 offen sc0 sc1
    s_mov_b64 exec, s[6:7]
    v_mfma_f32_32x32x16_bf16 v[132:147], v[100:103], v[112:115], v[132:147]
    ds_read_b128 v[96:99], v78 offset:36864
    ds_read_b128 v[88:91], v70 offset:36864
    v_mfma_f32_32x32x16_bf16 v[148:163], v[104:107], v[108:111], v[148:163]
    v_mfma_f32_32x32x16_bf16 v[164:179], v[104:107], v[112:115], v[164:179]
    s_waitcnt lgkmcnt(2)
    v_mfma_f32_32x32x16_bf16 v[116:131], v[84:87], v[92:95], v[116:131]
    ds_read_b128 v[100:103], v71 offset:32768
    ds_read_b128 v[108:111], v79 offset:32768
    s_waitcnt lgkmcnt(3)
    v_mfma_f32_32x32x16_bf16 v[132:147], v[84:87], v[96:99], v[132:147]
    ds_read_b128 v[112:115], v79 offset:36864
    ds_read_b128 v[104:107], v71 offset:36864
    s_waitcnt lgkmcnt(4)
    v_mfma_f32_32x32x16_bf16 v[148:163], v[88:91], v[92:95], v[148:163]
    v_mfma_f32_32x32x16_bf16 v[164:179], v[88:91], v[96:99], v[164:179]
    s_waitcnt lgkmcnt(2)
    v_mfma_f32_32x32x16_bf16 v[116:131], v[100:103], v[108:111], v[116:131]
    ds_read_b128 v[84:87], v72 offset:32768
    ds_read_b128 v[92:95], v80 offset:32768
    s_waitcnt lgkmcnt(3)
    v_mfma_f32_32x32x16_bf16 v[132:147], v[100:103], v[112:115], v[132:147]
    ds_read_b128 v[96:99], v80 offset:36864
    ds_read_b128 v[88:91], v72 offset:36864
    s_waitcnt lgkmcnt(4)
    v_mfma_f32_32x32x16_bf16 v[148:163], v[104:107], v[108:111], v[148:163]
    v_mfma_f32_32x32x16_bf16 v[164:179], v[104:107], v[112:115], v[164:179]
    s_waitcnt lgkmcnt(2)
    v_mfma_f32_32x32x16_bf16 v[116:131], v[84:87], v[92:95], v[116:131]
    ds_read_b128 v[100:103], v73 offset:32768
    ds_read_b128 v[108:111], v81 offset:32768
    s_waitcnt lgkmcnt(3)
    v_mfma_f32_32x32x16_bf16 v[132:147], v[84:87], v[96:99], v[132:147]
    ds_read_b128 v[112:115], v81 offset:36864
    ds_read_b128 v[104:107], v73 offset:36864
    s_waitcnt lgkmcnt(4)
    v_mfma_f32_32x32x16_bf16 v[148:163], v[88:91], v[92:95], v[148:163]
    v_mfma_f32_32x32x16_bf16 v[164:179], v[88:91], v[96:99], v[164:179]
    s_waitcnt lgkmcnt(0)
    v_mfma_f32_32x32x16_bf16 v[116:131], v[100:103], v[108:111], v[116:131]
    v_mfma_f32_32x32x16_bf16 v[132:147], v[100:103], v[112:115], v[132:147]
    v_mfma_f32_32x32x16_bf16 v[148:163], v[104:107], v[108:111], v[148:163]
    v_mfma_f32_32x32x16_bf16 v[164:179], v[104:107], v[112:115], v[164:179]
    s_waitcnt vmcnt(7)
    v_mov_b32 v82, s42
    v_mov_b32 v83, s43
    s_mov_b64 s[6:7], exec
    s_mov_b64 exec, 1
    buffer_store_dwordx2 v[82:83], v6, s[8:11], s18 offen sc0 sc1
    s_mov_b64 exec, s[6:7]
    s_nop 2
    v_pk_fma_f32 v[10:11], v[132:133], v[230:231], v[118:119] op_sel:[0,1,0] op_sel_hi:[1,1,1] neg_lo:[0,1,0] neg_hi:[0,1,0]
    v_pk_fma_f32 v[12:13], v[116:117], v[230:231], v[134:135] op_sel:[0,1,0] op_sel_hi:[1,1,1]
    v_pk_fma_f32 v[4:5], v[116:117], v[230:231], v[10:11] op_sel:[0,0,0] op_sel_hi:[1,0,1]
    v_pk_fma_f32 v[8:9], v[132:133], v[230:231], v[12:13] op_sel:[0,0,0] op_sel_hi:[1,0,1]
    v_pk_fma_f32 v[10:11], v[8:9], v[230:231], v[120:121] op_sel:[0,1,0] op_sel_hi:[1,1,1] neg_lo:[0,1,0] neg_hi:[0,1,0]
    v_pk_fma_f32 v[12:13], v[4:5], v[230:231], v[136:137] op_sel:[0,1,0] op_sel_hi:[1,1,1]
    v_pk_fma_f32 v[4:5], v[4:5], v[230:231], v[10:11] op_sel:[0,0,0] op_sel_hi:[1,0,1]
    v_pk_fma_f32 v[8:9], v[8:9], v[230:231], v[12:13] op_sel:[0,0,0] op_sel_hi:[1,0,1]
    v_pk_fma_f32 v[10:11], v[8:9], v[230:231], v[122:123] op_sel:[0,1,0] op_sel_hi:[1,1,1] neg_lo:[0,1,0] neg_hi:[0,1,0]
    v_pk_fma_f32 v[12:13], v[4:5], v[230:231], v[138:139] op_sel:[0,1,0] op_sel_hi:[1,1,1]
    v_pk_fma_f32 v[4:5], v[4:5], v[230:231], v[10:11] op_sel:[0,0,0] op_sel_hi:[1,0,1]
    v_pk_fma_f32 v[8:9], v[8:9], v[230:231], v[12:13] op_sel:[0,0,0] op_sel_hi:[1,0,1]
    v_pk_fma_f32 v[10:11], v[8:9], v[230:231], v[124:125] op_sel:[0,1,0] op_sel_hi:[1,1,1] neg_lo:[0,1,0] neg_hi:[0,1,0]
    v_pk_fma_f32 v[12:13], v[4:5], v[230:231], v[140:141] op_sel:[0,1,0] op_sel_hi:[1,1,1]
    v_pk_fma_f32 v[4:5], v[4:5], v[230:231], v[10:11] op_sel:[0,0,0] op_sel_hi:[1,0,1]
    v_pk_fma_f32 v[8:9], v[8:9], v[230:231], v[12:13] op_sel:[0,0,0] op_sel_hi:[1,0,1]
    v_pk_fma_f32 v[10:11], v[8:9], v[230:231], v[126:127] op_sel:[0,1,0] op_sel_hi:[1,1,1] neg_lo:[0,1,0] neg_hi:[0,1,0]
    v_pk_fma_f32 v[12:13], v[4:5], v[230:231], v[142:143] op_sel:[0,1,0] op_sel_hi:[1,1,1]
    v_pk_fma_f32 v[4:5], v[4:5], v[230:231], v[10:11] op_sel:[0,0,0] op_sel_hi:[1,0,1]
    v_pk_fma_f32 v[8:9], v[8:9], v[230:231], v[12:13] op_sel:[0,0,0] op_sel_hi:[1,0,1]
    v_pk_fma_f32 v[10:11], v[8:9], v[230:231], v[128:129] op_sel:[0,1,0] op_sel_hi:[1,1,1] neg_lo:[0,1,0] neg_hi:[0,1,0]
    v_pk_fma_f32 v[12:13], v[4:5], v[230:231], v[144:145] op_sel:[0,1,0] op_sel_hi:[1,1,1]
    v_pk_fma_f32 v[4:5], v[4:5], v[230:231], v[10:11] op_sel:[0,0,0] op_sel_hi:[1,0,1]
    v_pk_fma_f32 v[8:9], v[8:9], v[230:231], v[12:13] op_sel:[0,0,0] op_sel_hi:[1,0,1]
    v_pk_fma_f32 v[10:11], v[8:9], v[230:231], v[130:131] op_sel:[0,1,0] op_sel_hi:[1,1,1] neg_lo:[0,1,0] neg_hi:[0,1,0]
    v_pk_fma_f32 v[12:13], v[4:5], v[230:231], v[146:147] op_sel:[0,1,0] op_sel_hi:[1,1,1]
    v_pk_fma_f32 v[4:5], v[4:5], v[230:231], v[10:11] op_sel:[0,0,0] op_sel_hi:[1,0,1]
    v_pk_fma_f32 v[8:9], v[8:9], v[230:231], v[12:13] op_sel:[0,0,0] op_sel_hi:[1,0,1]
    v_pk_fma_f32 v[10:11], v[8:9], v[230:231], v[148:149] op_sel:[0,1,0] op_sel_hi:[1,1,1] neg_lo:[0,1,0] neg_hi:[0,1,0]
    v_pk_fma_f32 v[12:13], v[4:5], v[230:231], v[164:165] op_sel:[0,1,0] op_sel_hi:[1,1,1]
    v_pk_fma_f32 v[4:5], v[4:5], v[230:231], v[10:11] op_sel:[0,0,0] op_sel_hi:[1,0,1]
    v_pk_fma_f32 v[8:9], v[8:9], v[230:231], v[12:13] op_sel:[0,0,0] op_sel_hi:[1,0,1]
    v_pk_fma_f32 v[10:11], v[8:9], v[230:231], v[150:151] op_sel:[0,1,0] op_sel_hi:[1,1,1] neg_lo:[0,1,0] neg_hi:[0,1,0]
    v_pk_fma_f32 v[12:13], v[4:5], v[230:231], v[166:167] op_sel:[0,1,0] op_sel_hi:[1,1,1]
    v_pk_fma_f32 v[4:5], v[4:5], v[230:231], v[10:11] op_sel:[0,0,0] op_sel_hi:[1,0,1]
    v_pk_fma_f32 v[8:9], v[8:9], v[230:231], v[12:13] op_sel:[0,0,0] op_sel_hi:[1,0,1]
    v_pk_fma_f32 v[10:11], v[8:9], v[230:231], v[152:153] op_sel:[0,1,0] op_sel_hi:[1,1,1] neg_lo:[0,1,0] neg_hi:[0,1,0]
    v_pk_fma_f32 v[12:13], v[4:5], v[230:231], v[168:169] op_sel:[0,1,0] op_sel_hi:[1,1,1]
    v_pk_fma_f32 v[4:5], v[4:5], v[230:231], v[10:11] op_sel:[0,0,0] op_sel_hi:[1,0,1]
    v_pk_fma_f32 v[8:9], v[8:9], v[230:231], v[12:13] op_sel:[0,0,0] op_sel_hi:[1,0,1]
    v_pk_fma_f32 v[10:11], v[8:9], v[230:231], v[154:155] op_sel:[0,1,0] op_sel_hi:[1,1,1] neg_lo:[0,1,0] neg_hi:[0,1,0]
    v_pk_fma_f32 v[12:13], v[4:5], v[230:231], v[170:171] op_sel:[0,1,0] op_sel_hi:[1,1,1]
    v_pk_fma_f32 v[4:5], v[4:5], v[230:231], v[10:11] op_sel:[0,0,0] op_sel_hi:[1,0,1]
    v_pk_fma_f32 v[8:9], v[8:9], v[230:231], v[12:13] op_sel:[0,0,0] op_sel_hi:[1,0,1]
    v_pk_fma_f32 v[10:11], v[8:9], v[230:231], v[156:157] op_sel:[0,1,0] op_sel_hi:[1,1,1] neg_lo:[0,1,0] neg_hi:[0,1,0]
    v_pk_fma_f32 v[12:13], v[4:5], v[230:231], v[172:173] op_sel:[0,1,0] op_sel_hi:[1,1,1]
    v_pk_fma_f32 v[4:5], v[4:5], v[230:231], v[10:11] op_sel:[0,0,0] op_sel_hi:[1,0,1]
    v_pk_fma_f32 v[8:9], v[8:9], v[230:231], v[12:13] op_sel:[0,0,0] op_sel_hi:[1,0,1]
    v_pk_fma_f32 v[10:11], v[8:9], v[230:231], v[158:159] op_sel:[0,1,0] op_sel_hi:[1,1,1] neg_lo:[0,1,0] neg_hi:[0,1,0]
    v_pk_fma_f32 v[12:13], v[4:5], v[230:231], v[174:175] op_sel:[0,1,0] op_sel_hi:[1,1,1]
    v_pk_fma_f32 v[4:5], v[4:5], v[230:231], v[10:11] op_sel:[0,0,0] op_sel_hi:[1,0,1]
    v_pk_fma_f32 v[8:9], v[8:9], v[230:231], v[12:13] op_sel:[0,0,0] op_sel_hi:[1,0,1]
    v_pk_fma_f32 v[10:11], v[8:9], v[230:231], v[160:161] op_sel:[0,1,0] op_sel_hi:[1,1,1] neg_lo:[0,1,0] neg_hi:[0,1,0]
    v_pk_fma_f32 v[12:13], v[4:5], v[230:231], v[176:177] op_sel:[0,1,0] op_sel_hi:[1,1,1]
    v_pk_fma_f32 v[4:5], v[4:5], v[230:231], v[10:11] op_sel:[0,0,0] op_sel_hi:[1,0,1]
    v_pk_fma_f32 v[8:9], v[8:9], v[230:231], v[12:13] op_sel:[0,0,0] op_sel_hi:[1,0,1]
    v_pk_fma_f32 v[10:11], v[8:9], v[230:231], v[162:163] op_sel:[0,1,0] op_sel_hi:[1,1,1] neg_lo:[0,1,0] neg_hi:[0,1,0]
    v_pk_fma_f32 v[12:13], v[4:5], v[230:231], v[178:179] op_sel:[0,1,0] op_sel_hi:[1,1,1]
    v_pk_fma_f32 v[4:5], v[4:5], v[230:231], v[10:11] op_sel:[0,0,0] op_sel_hi:[1,0,1]
    v_pk_fma_f32 v[8:9], v[8:9], v[230:231], v[12:13] op_sel:[0,0,0] op_sel_hi:[1,0,1]
    v_lshrrev_b32 v3, 5, v2
    v_lshlrev_b32 v3, 10, v3
    v_lshl_add_u32 v1, v7, 2, v3
    s_lshr_b32 s3, s44, 1
    s_lshl_b32 s3, s3, 11
    s_add_u32 s3, s3, 150528
    v_add_u32 v1, s3, v1
    ds_write2st64_b32 v1, v4, v8 offset0:12 offset1:13
    ds_write2st64_b32 v1, v5, v9 offset0:14 offset1:15
    s_waitcnt lgkmcnt(0)
    s_barrier
    ds_read2st64_b32 v[66:67], v1 offset0:0 offset1:1
    ds_read2st64_b32 v[68:69], v1 offset0:2 offset1:3
    ds_read2st64_b32 v[70:71], v1 offset0:4 offset1:5
    ds_read2st64_b32 v[72:73], v1 offset0:6 offset1:7
    ds_read2st64_b32 v[74:75], v1 offset0:8 offset1:9
    ds_read2st64_b32 v[76:77], v1 offset0:10 offset1:11
    s_waitcnt lgkmcnt(4)
    v_fma_f32 v20, -v235, v67, v68
    v_fma_f32 v21, v235, v66, v69
    v_fma_f32 v68, v234, v66, v20
    v_fma_f32 v69, v234, v67, v21
    s_waitcnt lgkmcnt(3)
    v_fma_f32 v20, -v235, v69, v70
    v_fma_f32 v21, v235, v68, v71
    v_fma_f32 v70, v234, v68, v20
    v_fma_f32 v71, v234, v69, v21
    s_waitcnt lgkmcnt(2)
    v_fma_f32 v20, -v235, v71, v72
    v_fma_f32 v21, v235, v70, v73
    v_fma_f32 v72, v234, v70, v20
    v_fma_f32 v73, v234, v71, v21
    s_waitcnt lgkmcnt(1)
    v_fma_f32 v20, -v235, v73, v74
    v_fma_f32 v21, v235, v72, v75
    v_fma_f32 v74, v234, v72, v20
    v_fma_f32 v75, v234, v73, v21
    s_waitcnt lgkmcnt(0)
    v_fma_f32 v20, -v235, v75, v76
    v_fma_f32 v21, v235, v74, v77
    v_fma_f32 v76, v234, v74, v20
    v_fma_f32 v77, v234, v75, v21
    v_fma_f32 v20, -v235, v77, v4
    v_fma_f32 v21, v235, v76, v8
    v_fma_f32 v14, v234, v76, v20
    v_fma_f32 v15, v234, v77, v21
    v_fma_f32 v20, -v235, v15, v5
    v_fma_f32 v21, v235, v14, v9
    v_fma_f32 v54, v234, v14, v20
    v_fma_f32 v55, v234, v15, v21
    v_mov_b32 v84, v76
    v_mov_b32 v85, v14
    v_mov_b32 v86, v77
    v_mov_b32 v87, v15
    s_lshl_b32 s3, s46, 14
    s_add_u32 s3, s3, 21037056
    s_add_u32 s48, s40, s3
    s_addc_u32 s49, s41, 0
    s_mov_b32 s50, 16384
    s_mov_b32 s51, 131072
    v_lshlrev_b32 v1, 4, v7
    s_lshl_b32 s4, s45, 10
    s_lshr_b32 s3, s44, 1
    s_cmp_eq_u32 s3, 0
    s_cbranch_scc1 Lnopub_gate_4
    v_mov_b32 v66, v54
    v_mov_b32 v67, v55
    v_mov_b32 v68, s42
    v_mov_b32 v69, s43
    s_mov_b64 s[6:7], exec
    s_mov_b64 exec, s[34:35]
    buffer_store_dwordx4 v[66:69], v1, s[48:51], s4 offen sc0 sc1
    s_mov_b64 exec, s[6:7]
    s_nop 1
Lnopub_gate_4:
    s_lshl_b32 s3, s46, 2
    s_add_u32 s3, s3, s44
    s_lshl_b32 s3, s3, 7
    s_add_u32 s3, s3, 21504000
    v_and_b32 v3, 15, v2
    v_lshlrev_b32 v3, 3, v3
    v_add_u32 v3, s3, v3
    v_lshrrev_b32 v9, 5, v2
    v_lshlrev_b32 v9, 10, v9
    v_sub_u32 v9, v1, v9
    s_sub_u32 s3, s4, 1024
    v_add_u32 v8, s3, v9
    v_mul_f32 v14, v237, v237
    v_fma_f32 v14, v236, v236, -v14
    v_mul_f32 v15, v236, v237
    v_add_f32 v15, v15, v15
    v_lshrrev_b32 v9, 5, v2
    v_sub_u32 v9, s45, v9
    v_add_u32 v9, 1, v9
    v_lshrrev_b32 v16, 1, v9
    s_lshl_b32 s3, s46, 2
    s_add_u32 s3, s3, s44
    s_lshl_b32 s6, s3, 16
    s_add_u32 s6, s6, 16777216
    s_lshl_b32 s7, s46, 12
    s_and_b32 s3, s46, 7
    s_lshl_b32 s3, s3, 2
    s_lshl_b32 s13, -1, s3
    s_and_b32 s13, s13, 0x01111111
    s_add_u32 s13, s13, 0x06543210
    s_bitcmp1_b32 s46, 3
    s_cselect_b32 s17, 0x08888888, 0
    s_add_u32 s13, s13, s17
    s_bitcmp1_b32 s46, 3
    s_cselect_b32 s17, 0, 0x88888888
    s_add_u32 s16, s17, 0x76543210
    s_lshl_b32 s17, s16, 28
    s_or_b32 s14, s13, s17
    s_lshr_b32 s15, s16, 4
    buffer_load_dwordx2 v[82:83], v182, s[8:11], 0 offen sc0 sc1
    v_pk_mul_f32 v[10:11], v[132:133], v[232:233] op_sel:[0,1] op_sel_hi:[1,1] neg_lo:[0,1] neg_hi:[0,1]
    v_pk_mul_f32 v[12:13], v[116:117], v[232:233] op_sel:[0,1] op_sel_hi:[1,1]
    v_pk_fma_f32 v[116:117], v[116:117], v[232:233], v[10:11] op_sel:[0,0,0] op_sel_hi:[1,0,1]
    v_pk_fma_f32 v[132:133], v[132:133], v[232:233], v[12:13] op_sel:[0,0,0] op_sel_hi:[1,0,1]
    v_pk_mul_f32 v[10:11], v[134:135], v[232:233] op_sel:[0,1] op_sel_hi:[1,1] neg_lo:[0,1] neg_hi:[0,1]
    v_pk_mul_f32 v[12:13], v[118:119], v[232:233] op_sel:[0,1] op_sel_hi:[1,1]
    v_pk_fma_f32 v[118:119], v[118:119], v[232:233], v[10:11] op_sel:[0,0,0] op_sel_hi:[1,0,1]
    v_pk_fma_f32 v[134:135], v[134:135], v[232:233], v[12:13] op_sel:[0,0,0] op_sel_hi:[1,0,1]
    v_pk_mul_f32 v[10:11], v[136:137], v[232:233] op_sel:[0,1] op_sel_hi:[1,1] neg_lo:[0,1] neg_hi:[0,1]
    v_pk_mul_f32 v[12:13], v[120:121], v[232:233] op_sel:[0,1] op_sel_hi:[1,1]
    v_pk_fma_f32 v[120:121], v[120:121], v[232:233], v[10:11] op_sel:[0,0,0] op_sel_hi:[1,0,1]
    v_pk_fma_f32 v[136:137], v[136:137], v[232:233], v[12:13] op_sel:[0,0,0] op_sel_hi:[1,0,1]
    v_pk_mul_f32 v[10:11], v[138:139], v[232:233] op_sel:[0,1] op_sel_hi:[1,1] neg_lo:[0,1] neg_hi:[0,1]
    v_pk_mul_f32 v[12:13], v[122:123], v[232:233] op_sel:[0,1] op_sel_hi:[1,1]
    v_pk_fma_f32 v[122:123], v[122:123], v[232:233], v[10:11] op_sel:[0,0,0] op_sel_hi:[1,0,1]
    v_pk_fma_f32 v[138:139], v[138:139], v[232:233], v[12:13] op_sel:[0,0,0] op_sel_hi:[1,0,1]
    v_pk_mul_f32 v[10:11], v[140:141], v[232:233] op_sel:[0,1] op_sel_hi:[1,1] neg_lo:[0,1] neg_hi:[0,1]
    v_pk_mul_f32 v[12:13], v[124:125], v[232:233] op_sel:[0,1] op_sel_hi:[1,1]
    v_pk_fma_f32 v[124:125], v[124:125], v[232:233], v[10:11] op_sel:[0,0,0] op_sel_hi:[1,0,1]
    v_pk_fma_f32 v[140:141], v[140:141], v[232:233], v[12:13] op_sel:[0,0,0] op_sel_hi:[1,0,1]
    v_pk_mul_f32 v[10:11], v[142:143], v[232:233] op_sel:[0,1] op_sel_hi:[1,1] neg_lo:[0,1] neg_hi:[0,1]
    v_pk_mul_f32 v[12:13], v[126:127], v[232:233] op_sel:[0,1] op_sel_hi:[1,1]
    v_pk_fma_f32 v[126:127], v[126:127], v[232:233], v[10:11] op_sel:[0,0,0] op_sel_hi:[1,0,1]
    v_pk_fma_f32 v[142:143], v[142:143], v[232:233], v[12:13] op_sel:[0,0,0] op_sel_hi:[1,0,1]
    v_pk_mul_f32 v[10:11], v[144:145], v[232:233] op_sel:[0,1] op_sel_hi:[1,1] neg_lo:[0,1] neg_hi:[0,1]
    v_pk_mul_f32 v[12:13], v[128:129], v[232:233] op_sel:[0,1] op_sel_hi:[1,1]
    v_pk_fma_f32 v[128:129], v[128:129], v[232:233], v[10:11] op_sel:[0,0,0] op_sel_hi:[1,0,1]
    v_pk_fma_f32 v[144:145], v[144:145], v[232:233], v[12:13] op_sel:[0,0,0] op_sel_hi:[1,0,1]
    v_pk_mul_f32 v[10:11], v[146:147], v[232:233] op_sel:[0,1] op_sel_hi:[1,1] neg_lo:[0,1] neg_hi:[0,1]
    v_pk_mul_f32 v[12:13], v[130:131], v[232:233] op_sel:[0,1] op_sel_hi:[1,1]
    v_pk_fma_f32 v[130:131], v[130:131], v[232:233], v[10:11] op_sel:[0,0,0] op_sel_hi:[1,0,1]
    v_pk_fma_f32 v[146:147], v[146:147], v[232:233], v[12:13] op_sel:[0,0,0] op_sel_hi:[1,0,1]
    v_pk_mul_f32 v[10:11], v[164:165], v[232:233] op_sel:[0,1] op_sel_hi:[1,1] neg_lo:[0,1] neg_hi:[0,1]
    v_pk_mul_f32 v[12:13], v[148:149], v[232:233] op_sel:[0,1] op_sel_hi:[1,1]
    v_pk_fma_f32 v[148:149], v[148:149], v[232:233], v[10:11] op_sel:[0,0,0] op_sel_hi:[1,0,1]
    v_pk_fma_f32 v[164:165], v[164:165], v[232:233], v[12:13] op_sel:[0,0,0] op_sel_hi:[1,0,1]
    v_pk_mul_f32 v[10:11], v[166:167], v[232:233] op_sel:[0,1] op_sel_hi:[1,1] neg_lo:[0,1] neg_hi:[0,1]
    v_pk_mul_f32 v[12:13], v[150:151], v[232:233] op_sel:[0,1] op_sel_hi:[1,1]
    v_pk_fma_f32 v[150:151], v[150:151], v[232:233], v[10:11] op_sel:[0,0,0] op_sel_hi:[1,0,1]
    v_pk_fma_f32 v[166:167], v[166:167], v[232:233], v[12:13] op_sel:[0,0,0] op_sel_hi:[1,0,1]
    v_pk_mul_f32 v[10:11], v[168:169], v[232:233] op_sel:[0,1] op_sel_hi:[1,1] neg_lo:[0,1] neg_hi:[0,1]
    v_pk_mul_f32 v[12:13], v[152:153], v[232:233] op_sel:[0,1] op_sel_hi:[1,1]
    v_pk_fma_f32 v[152:153], v[152:153], v[232:233], v[10:11] op_sel:[0,0,0] op_sel_hi:[1,0,1]
    v_pk_fma_f32 v[168:169], v[168:169], v[232:233], v[12:13] op_sel:[0,0,0] op_sel_hi:[1,0,1]
    v_pk_mul_f32 v[10:11], v[170:171], v[232:233] op_sel:[0,1] op_sel_hi:[1,1] neg_lo:[0,1] neg_hi:[0,1]
    v_pk_mul_f32 v[12:13], v[154:155], v[232:233] op_sel:[0,1] op_sel_hi:[1,1]
    v_pk_fma_f32 v[154:155], v[154:155], v[232:233], v[10:11] op_sel:[0,0,0] op_sel_hi:[1,0,1]
    v_pk_fma_f32 v[170:171], v[170:171], v[232:233], v[12:13] op_sel:[0,0,0] op_sel_hi:[1,0,1]
    v_pk_mul_f32 v[10:11], v[172:173], v[232:233] op_sel:[0,1] op_sel_hi:[1,1] neg_lo:[0,1] neg_hi:[0,1]
    v_pk_mul_f32 v[12:13], v[156:157], v[232:233] op_sel:[0,1] op_sel_hi:[1,1]
    v_pk_fma_f32 v[156:157], v[156:157], v[232:233], v[10:11] op_sel:[0,0,0] op_sel_hi:[1,0,1]
    v_pk_fma_f32 v[172:173], v[172:173], v[232:233], v[12:13] op_sel:[0,0,0] op_sel_hi:[1,0,1]
    v_pk_mul_f32 v[10:11], v[174:175], v[232:233] op_sel:[0,1] op_sel_hi:[1,1] neg_lo:[0,1] neg_hi:[0,1]
    v_pk_mul_f32 v[12:13], v[158:159], v[232:233] op_sel:[0,1] op_sel_hi:[1,1]
    v_pk_fma_f32 v[158:159], v[158:159], v[232:233], v[10:11] op_sel:[0,0,0] op_sel_hi:[1,0,1]
    v_pk_fma_f32 v[174:175], v[174:175], v[232:233], v[12:13] op_sel:[0,0,0] op_sel_hi:[1,0,1]
    v_pk_mul_f32 v[10:11], v[176:177], v[232:233] op_sel:[0,1] op_sel_hi:[1,1] neg_lo:[0,1] neg_hi:[0,1]
    v_pk_mul_f32 v[12:13], v[160:161], v[232:233] op_sel:[0,1] op_sel_hi:[1,1]
    v_pk_fma_f32 v[160:161], v[160:161], v[232:233], v[10:11] op_sel:[0,0,0] op_sel_hi:[1,0,1]
    v_pk_fma_f32 v[176:177], v[176:177], v[232:233], v[12:13] op_sel:[0,0,0] op_sel_hi:[1,0,1]
    v_pk_mul_f32 v[10:11], v[178:179], v[232:233] op_sel:[0,1] op_sel_hi:[1,1] neg_lo:[0,1] neg_hi:[0,1]
    v_pk_mul_f32 v[12:13], v[162:163], v[232:233] op_sel:[0,1] op_sel_hi:[1,1]
    v_pk_fma_f32 v[162:163], v[162:163], v[232:233], v[10:11] op_sel:[0,0,0] op_sel_hi:[1,0,1]
    v_pk_fma_f32 v[178:179], v[178:179], v[232:233], v[12:13] op_sel:[0,0,0] op_sel_hi:[1,0,1]
    s_mov_b32 s13, 0
    s_waitcnt vmcnt(0)
    v_cmp_ne_u64 vcc, s[42:43], v[82:83]
    s_nop 4
    s_cbranch_vccz Lfdone_gate_5
Lfpoll_gate_6:
    buffer_load_dwordx2 v[82:83], v182, s[8:11], 0 offen sc0 sc1
    s_waitcnt vmcnt(0)
    v_cmp_ne_u64 vcc, s[42:43], v[82:83]
    s_nop 4
    s_add_u32 s13, s13, 1
    s_cmp_gt_u32 s13, 20000
    s_cbranch_scc1 Lfdone_gate_5
    s_cbranch_vccnz Lfpoll_gate_6
Lfdone_gate_5:
    s_mov_b32 m0, s29
    s_nop 0
    buffer_load_dwordx4 v207, s[8:11], s28 offen offset:0 sc0 sc1 lds
    buffer_load_dwordx4 v207, s[8:11], s28 offen offset:1024 sc0 sc1 lds
    buffer_load_dwordx4 v207, s[8:11], s28 offen offset:2048 sc0 sc1 lds
    buffer_load_dwordx4 v207, s[8:11], s28 offen offset:3072 sc0 sc1 lds
    s_lshr_b32 s16, s44, 1
    v_lshrrev_b32 v53, 5, v2
    v_lshlrev_b32 v53, 13, v53
    v_lshl_add_u32 v9, v7, 2, v53
    s_lshl_b32 s3, s16, 14
    s_add_u32 s3, s3, 0
    v_add_u32 v9, s3, v9
    v_lshrrev_b32 v53, 4, v2
    v_lshlrev_b32 v53, 4, v53
    v_bfe_u32 v54, v2, 3, 1
    v_add_u32 v53, v53, v54
    v_and_b32 v21, 7, v2
    v_xor_b32 v54, v54, v21
    s_and_b32 s3, s44, 1
    s_lshl_b32 s3, s3, 3
    v_or_b32 v54, s3, v54
    v_lshlrev_b32 v54, 4, v54
    v_lshl_add_u32 v20, v53, 8, v54
    s_lshl_b32 s3, s16, 14
    s_add_u32 s3, s3, 0
    v_add_u32 v20, s3, v20
    v_lshlrev_b32 v21, 4, v21
    v_lshl_add_u32 v21, v53, 12, v21
    s_lshl_b32 s13, s45, 19
    s_lshl_b32 s3, s16, 18
    s_add_u32 s13, s13, s3
    s_lshl_b32 s3, s46, 8
    s_add_u32 s13, s13, s3
    s_and_b32 s3, s44, 1
    s_lshl_b32 s3, s3, 7
    s_add_u32 s13, s13, s3
    buffer_load_dwordx2 v[4:5], v3, s[8:11], 0 offen sc0 sc1
    v_mov_b32 v18, 0
    ds_write_b128 v51, v[38:41] offset:0
    v_alignbit_b32 v42, v39, v38, 16
    v_alignbit_b32 v43, v40, v39, 16
    v_mov_b32_dpp v18, v38 wave_shl:1 row_mask:0xf bank_mask:0xf
    v_alignbit_b32 v44, v41, v40, 16
    v_alignbit_b32 v45, v18, v41, 16
    ds_write_b128 v51, v[42:45] offset:4160
    v_readfirstlane_b32 s3, v26
    s_nop 1
    v_mov_b32 v19, s3
    ds_write_b128 v51, v[22:25] offset:32
    v_alignbit_b32 v46, v23, v22, 16
    v_alignbit_b32 v47, v24, v23, 16
    v_mov_b32_dpp v19, v22 wave_shl:1 row_mask:0xf bank_mask:0xf
    v_alignbit_b32 v48, v25, v24, 16
    v_alignbit_b32 v49, v19, v25, 16
    ds_write_b128 v51, v[46:49] offset:4192
    v_readfirstlane_b32 s3, v30
    s_nop 1
    v_mov_b32 v18, s3
    ds_write_b128 v51, v[26:29] offset:1056
    v_alignbit_b32 v42, v27, v26, 16
    v_alignbit_b32 v43, v28, v27, 16
    v_mov_b32_dpp v18, v26 wave_shl:1 row_mask:0xf bank_mask:0xf
    v_alignbit_b32 v44, v29, v28, 16
    v_alignbit_b32 v45, v18, v29, 16
    ds_write_b128 v51, v[42:45] offset:5216
    v_subrev_u32 v66, 0, v8
    v_min_u32 v66, 0x7fff0000, v66
    buffer_load_dwordx4 v[66:69], v66, s[48:51], 0 offen sc0 sc1
    v_subrev_u32 v70, 2048, v8
    v_min_u32 v70, 0x7fff0000, v70
    buffer_load_dwordx4 v[70:73], v70, s[48:51], 0 offen sc0 sc1
    v_subrev_u32 v74, 4096, v8
    v_min_u32 v74, 0x7fff0000, v74
    buffer_load_dwordx4 v[74:77], v74, s[48:51], 0 offen sc0 sc1
    v_subrev_u32 v78, 6144, v8
    v_min_u32 v78, 0x7fff0000, v78
    buffer_load_dwordx4 v[78:81], v78, s[48:51], 0 offen sc0 sc1
    v_subrev_u32 v88, 8192, v8
    v_min_u32 v88, 0x7fff0000, v88
    buffer_load_dwordx4 v[88:91], v88, s[48:51], 0 offen sc0 sc1
    v_subrev_u32 v92, 10240, v8
    v_min_u32 v92, 0x7fff0000, v92
    buffer_load_dwordx4 v[92:95], v92, s[48:51], 0 offen sc0 sc1
    v_subrev_u32 v96, 12288, v8
    v_min_u32 v96, 0x7fff0000, v96
    buffer_load_dwordx4 v[96:99], v96, s[48:51], 0 offen sc0 sc1
    v_subrev_u32 v100, 14336, v8
    v_min_u32 v100, 0x7fff0000, v100
    buffer_load_dwordx4 v[100:103], v100, s[48:51], 0 offen sc0 sc1
    v_readfirstlane_b32 s3, v34
    s_nop 1
    v_mov_b32 v19, s3
    ds_write_b128 v51, v[30:33] offset:2080
    v_alignbit_b32 v46, v31, v30, 16
    v_alignbit_b32 v47, v32, v31, 16
    v_mov_b32_dpp v19, v30 wave_shl:1 row_mask:0xf bank_mask:0xf
    v_alignbit_b32 v48, v33, v32, 16
    v_alignbit_b32 v49, v19, v33, 16
    ds_write_b128 v51, v[46:49] offset:6240
    v_mov_b32 v18, 0
    ds_write_b128 v51, v[34:37] offset:3104
    v_alignbit_b32 v42, v35, v34, 16
    v_alignbit_b32 v43, v36, v35, 16
    v_mov_b32_dpp v18, v34 wave_shl:1 row_mask:0xf bank_mask:0xf
    v_alignbit_b32 v44, v37, v36, 16
    v_alignbit_b32 v45, v18, v37, 16
    ds_write_b128 v51, v[42:45] offset:7264
    v_lshlrev_b32 v183, 16, v183
    s_mov_b32 s16, 0
    v_mov_b32 v18, 0
    s_waitcnt vmcnt(7)
    v_cmp_eq_u64 s[60:61], s[42:43], v[68:69]
    s_waitcnt vmcnt(6)
    v_cmp_eq_u64 s[62:63], s[42:43], v[72:73]
    s_waitcnt vmcnt(5)
    v_cmp_eq_u64 s[64:65], s[42:43], v[76:77]
    s_waitcnt vmcnt(4)
    v_cmp_eq_u64 s[66:67], s[42:43], v[80:81]
    v_addc_co_u32 v18, vcc, 0, v18, s[60:61]
    v_addc_co_u32 v18, vcc, 0, v18, s[62:63]
    v_addc_co_u32 v18, vcc, 0, v18, s[64:65]
    v_addc_co_u32 v18, vcc, 0, v18, s[66:67]
    s_waitcnt vmcnt(3)
    v_cmp_eq_u64 s[60:61], s[42:43], v[90:91]
    s_waitcnt vmcnt(2)
    v_cmp_eq_u64 s[62:63], s[42:43], v[94:95]
    s_waitcnt vmcnt(1)
    v_cmp_eq_u64 s[64:65], s[42:43], v[98:99]
    s_waitcnt vmcnt(0)
    v_cmp_eq_u64 s[66:67], s[42:43], v[102:103]
    v_addc_co_u32 v18, vcc, 0, v18, s[60:61]
    v_addc_co_u32 v18, vcc, 0, v18, s[62:63]
    v_addc_co_u32 v18, vcc, 0, v18, s[64:65]
    v_addc_co_u32 v18, vcc, 0, v18, s[66:67]
    v_cmp_ne_u32 vcc, v16, v18
    s_nop 4
    s_cbranch_vccz Lpolldone_gate_7
Lpoll_gate_8:
    v_subrev_u32 v66, 0, v8
    v_min_u32 v66, 0x7fff0000, v66
    buffer_load_dwordx4 v[66:69], v66, s[48:51], 0 offen sc0 sc1
    v_subrev_u32 v70, 2048, v8
    v_min_u32 v70, 0x7fff0000, v70
    buffer_load_dwordx4 v[70:73], v70, s[48:51], 0 offen sc0 sc1
    v_subrev_u32 v74, 4096, v8
    v_min_u32 v74, 0x7fff0000, v74
    buffer_load_dwordx4 v[74:77], v74, s[48:51], 0 offen sc0 sc1
    v_subrev_u32 v78, 6144, v8
    v_min_u32 v78, 0x7fff0000, v78
    buffer_load_dwordx4 v[78:81], v78, s[48:51], 0 offen sc0 sc1
    v_subrev_u32 v88, 8192, v8
    v_min_u32 v88, 0x7fff0000, v88
    buffer_load_dwordx4 v[88:91], v88, s[48:51], 0 offen sc0 sc1
    v_subrev_u32 v92, 10240, v8
    v_min_u32 v92, 0x7fff0000, v92
    buffer_load_dwordx4 v[92:95], v92, s[48:51], 0 offen sc0 sc1
    v_subrev_u32 v96, 12288, v8
    v_min_u32 v96, 0x7fff0000, v96
    buffer_load_dwordx4 v[96:99], v96, s[48:51], 0 offen sc0 sc1
    v_subrev_u32 v100, 14336, v8
    v_min_u32 v100, 0x7fff0000, v100
    buffer_load_dwordx4 v[100:103], v100, s[48:51], 0 offen sc0 sc1
    s_waitcnt vmcnt(0) lgkmcnt(0)
    v_mov_b32 v18, 0
    v_cmp_eq_u64 s[60:61], s[42:43], v[68:69]
    v_cmp_eq_u64 s[62:63], s[42:43], v[72:73]
    v_cmp_eq_u64 s[64:65], s[42:43], v[76:77]
    v_cmp_eq_u64 s[66:67], s[42:43], v[80:81]
    v_addc_co_u32 v18, vcc, 0, v18, s[60:61]
    v_addc_co_u32 v18, vcc, 0, v18, s[62:63]
    v_addc_co_u32 v18, vcc, 0, v18, s[64:65]
    v_addc_co_u32 v18, vcc, 0, v18, s[66:67]
    v_cmp_eq_u64 s[60:61], s[42:43], v[90:91]
    v_cmp_eq_u64 s[62:63], s[42:43], v[94:95]
    v_cmp_eq_u64 s[64:65], s[42:43], v[98:99]
    v_cmp_eq_u64 s[66:67], s[42:43], v[102:103]
    v_addc_co_u32 v18, vcc, 0, v18, s[60:61]
    v_addc_co_u32 v18, vcc, 0, v18, s[62:63]
    v_addc_co_u32 v18, vcc, 0, v18, s[64:65]
    v_addc_co_u32 v18, vcc, 0, v18, s[66:67]
    v_cmp_ne_u32 vcc, v16, v18
    s_add_u32 s16, s16, 1
    s_cmp_gt_u32 s16, 20000
    s_cbranch_scc1 Lpolldone_gate_7
    s_nop 1
    s_cbranch_vccnz Lpoll_gate_8
Lpolldone_gate_7:
    s_nop 4
    v_fma_f32 v22, -v15, v101, v96
    v_fma_f32 v23, v15, v100, v97
    v_fma_f32 v96, v14, v100, v22
    v_fma_f32 v97, v14, v101, v23
    v_fma_f32 v22, -v15, v97, v92
    v_fma_f32 v23, v15, v96, v93
    v_fma_f32 v92, v14, v96, v22
    v_fma_f32 v93, v14, v97, v23
    v_fma_f32 v22, -v15, v93, v88
    v_fma_f32 v23, v15, v92, v89
    v_fma_f32 v88, v14, v92, v22
    v_fma_f32 v89, v14, v93, v23
    v_fma_f32 v22, -v15, v89, v78
    v_fma_f32 v23, v15, v88, v79
    v_fma_f32 v78, v14, v88, v22
    v_fma_f32 v79, v14, v89, v23
    v_fma_f32 v22, -v15, v79, v74
    v_fma_f32 v23, v15, v78, v75
    v_fma_f32 v74, v14, v78, v22
    v_fma_f32 v75, v14, v79, v23
    v_fma_f32 v22, -v15, v75, v70
    v_fma_f32 v23, v15, v74, v71
    v_fma_f32 v70, v14, v74, v22
    v_fma_f32 v71, v14, v75, v23
    v_fma_f32 v22, -v15, v71, v66
    v_fma_f32 v23, v15, v70, v67
    v_fma_f32 v66, v14, v70, v22
    v_fma_f32 v67, v14, v71, v23
    v_mov_b32 v70, v66
    v_mov_b32 v71, v67
    s_nop 0
    v_permlane32_swap_b32 v66, v70
    v_permlane32_swap_b32 v67, v71
    v_fma_f32 v22, -v237, v71, v66
    v_fma_f32 v23, v237, v70, v67
    v_fma_f32 v24, v236, v70, v22
    v_fma_f32 v25, v236, v71, v23
    s_mov_b32 s4, 0
    v_cmp_ne_u64 vcc, s[42:43], v[4:5]
    s_nop 4
    s_cbranch_vccz Lfdone_gate_9
Lfpoll_gate_10:
    buffer_load_dwordx2 v[4:5], v3, s[8:11], 0 offen sc0 sc1
    s_waitcnt vmcnt(0)
    v_cmp_ne_u64 vcc, s[42:43], v[4:5]
    s_nop 4
    s_add_u32 s4, s4, 1
    s_cmp_gt_u32 s4, 20000
    s_cbranch_scc1 Lfdone_gate_9
    s_cbranch_vccnz Lfpoll_gate_10
Lfdone_gate_9:
    v_pk_fma_f32 v[10:11], v[240:241], v[24:25], v[84:85] op_sel:[0,1,0] op_sel_hi:[1,1,1] neg_lo:[0,1,0] neg_hi:[0,1,0]
    v_pk_fma_f32 v[12:13], v[238:239], v[24:25], v[86:87] op_sel:[0,1,0] op_sel_hi:[1,1,1]
    v_pk_fma_f32 v[4:5], v[238:239], v[24:25], v[10:11] op_sel:[0,0,0] op_sel_hi:[1,0,1]
    v_pk_fma_f32 v[14:15], v[240:241], v[24:25], v[12:13] op_sel:[0,0,0] op_sel_hi:[1,0,1]
    v_pk_mul_f32 v[10:11], v[14:15], v[232:233] op_sel:[0,1] op_sel_hi:[1,1] neg_lo:[0,1] neg_hi:[0,1]
    v_pk_mul_f32 v[12:13], v[4:5], v[232:233] op_sel:[0,1] op_sel_hi:[1,1]
    v_pk_fma_f32 v[4:5], v[4:5], v[232:233], v[10:11] op_sel:[0,0,0] op_sel_hi:[1,0,1]
    v_pk_fma_f32 v[14:15], v[14:15], v[232:233], v[12:13] op_sel:[0,0,0] op_sel_hi:[1,0,1]
    v_pk_fma_f32 v[10:11], v[14:15], v[230:231], v[116:117] op_sel:[0,1,0] op_sel_hi:[1,1,1] neg_lo:[0,1,0] neg_hi:[0,1,0]
    v_pk_fma_f32 v[12:13], v[4:5], v[230:231], v[132:133] op_sel:[0,1,0] op_sel_hi:[1,1,1]
    v_pk_fma_f32 v[116:117], v[4:5], v[230:231], v[10:11] op_sel:[0,0,0] op_sel_hi:[1,0,1]
    v_pk_fma_f32 v[132:133], v[14:15], v[230:231], v[12:13] op_sel:[0,0,0] op_sel_hi:[1,0,1]
    s_add_u32 s12, s6, s7
    buffer_load_dwordx4 a[0:3], v17, s[8:11], s12 offen offset:0 sc0 sc1
    v_pk_fma_f32 v[10:11], v[132:133], v[230:231], v[118:119] op_sel:[0,1,0] op_sel_hi:[1,1,1] neg_lo:[0,1,0] neg_hi:[0,1,0]
    v_pk_fma_f32 v[12:13], v[116:117], v[230:231], v[134:135] op_sel:[0,1,0] op_sel_hi:[1,1,1]
    v_pk_fma_f32 v[118:119], v[116:117], v[230:231], v[10:11] op_sel:[0,0,0] op_sel_hi:[1,0,1]
    v_pk_fma_f32 v[134:135], v[132:133], v[230:231], v[12:13] op_sel:[0,0,0] op_sel_hi:[1,0,1]
    v_cvt_pk_bf16_f32 v18, v116, -v132
    v_cvt_pk_bf16_f32 v19, v117, -v133
    ds_write2st64_b32 v9, v18, v19 offset0:0 offset1:16
    buffer_load_dwordx4 a[4:7], v17, s[8:11], s12 offen offset:1024 sc0 sc1
    v_pk_fma_f32 v[10:11], v[134:135], v[230:231], v[120:121] op_sel:[0,1,0] op_sel_hi:[1,1,1] neg_lo:[0,1,0] neg_hi:[0,1,0]
    v_pk_fma_f32 v[12:13], v[118:119], v[230:231], v[136:137] op_sel:[0,1,0] op_sel_hi:[1,1,1]
    v_pk_fma_f32 v[120:121], v[118:119], v[230:231], v[10:11] op_sel:[0,0,0] op_sel_hi:[1,0,1]
    v_pk_fma_f32 v[136:137], v[134:135], v[230:231], v[12:13] op_sel:[0,0,0] op_sel_hi:[1,0,1]
    v_xor_b32 v3, 16, v9
    v_cvt_pk_bf16_f32 v22, v118, -v134
    v_cvt_pk_bf16_f32 v23, v119, -v135
    ds_write2st64_b32 v3, v22, v23 offset0:1 offset1:17
    ds_read_b128 v[28:31], v20 offset:0
    buffer_load_dwordx4 a[8:11], v17, s[8:11], s12 offen offset:2048 sc0 sc1
    v_pk_fma_f32 v[10:11], v[136:137], v[230:231], v[122:123] op_sel:[0,1,0] op_sel_hi:[1,1,1] neg_lo:[0,1,0] neg_hi:[0,1,0]
    v_pk_fma_f32 v[12:13], v[120:121], v[230:231], v[138:139] op_sel:[0,1,0] op_sel_hi:[1,1,1]
    v_pk_fma_f32 v[122:123], v[120:121], v[230:231], v[10:11] op_sel:[0,0,0] op_sel_hi:[1,0,1]
    v_pk_fma_f32 v[138:139], v[136:137], v[230:231], v[12:13] op_sel:[0,0,0] op_sel_hi:[1,0,1]
    v_xor_b32 v1, 32, v9
    v_cvt_pk_bf16_f32 v18, v120, -v136
    v_cvt_pk_bf16_f32 v19, v121, -v137
    ds_write2st64_b32 v1, v18, v19 offset0:2 offset1:18
    s_waitcnt lgkmcnt(1)
    buffer_store_dwordx4 v[28:31], v21, s[8:11], s13 offen sc0 sc1
    buffer_load_dwordx4 a[12:15], v17, s[8:11], s12 offen offset:3072 sc0 sc1
    v_pk_fma_f32 v[10:11], v[138:139], v[230:231], v[124:125] op_sel:[0,1,0] op_sel_hi:[1,1,1] neg_lo:[0,1,0] neg_hi:[0,1,0]
    v_pk_fma_f32 v[12:13], v[122:123], v[230:231], v[140:141] op_sel:[0,1,0] op_sel_hi:[1,1,1]
    v_pk_fma_f32 v[124:125], v[122:123], v[230:231], v[10:11] op_sel:[0,0,0] op_sel_hi:[1,0,1]
    v_pk_fma_f32 v[140:141], v[138:139], v[230:231], v[12:13] op_sel:[0,0,0] op_sel_hi:[1,0,1]
    v_xor_b32 v3, 48, v9
    v_cvt_pk_bf16_f32 v22, v122, -v138
    v_cvt_pk_bf16_f32 v23, v123, -v139
    ds_write2st64_b32 v3, v22, v23 offset0:3 offset1:19
    v_xor_b32 v8, 32, v20
    ds_read_b128 v[32:35], v8 offset:512
    s_bfe_u32 s7, s14, 0x40000
    s_lshl_b32 s7, s7, 12
    s_add_u32 s12, s6, s7
    buffer_load_dwordx4 a[16:19], v17, s[8:11], s12 offen offset:0 sc0 sc1
    v_pk_fma_f32 v[10:11], v[140:141], v[230:231], v[126:127] op_sel:[0,1,0] op_sel_hi:[1,1,1] neg_lo:[0,1,0] neg_hi:[0,1,0]
    v_pk_fma_f32 v[12:13], v[124:125], v[230:231], v[142:143] op_sel:[0,1,0] op_sel_hi:[1,1,1]
    v_pk_fma_f32 v[126:127], v[124:125], v[230:231], v[10:11] op_sel:[0,0,0] op_sel_hi:[1,0,1]
    v_pk_fma_f32 v[142:143], v[140:141], v[230:231], v[12:13] op_sel:[0,0,0] op_sel_hi:[1,0,1]
    v_xor_b32 v1, 64, v9
    v_cvt_pk_bf16_f32 v18, v124, -v140
    v_cvt_pk_bf16_f32 v19, v125, -v141
    ds_write2st64_b32 v1, v18, v19 offset0:4 offset1:20
    s_add_u32 s13, s13, 8192
    s_waitcnt lgkmcnt(1)
    buffer_store_dwordx4 v[32:35], v21, s[8:11], s13 offen sc0 sc1
    buffer_load_dwordx4 a[20:23], v17, s[8:11], s12 offen offset:1024 sc0 sc1
    v_pk_fma_f32 v[10:11], v[142:143], v[230:231], v[128:129] op_sel:[0,1,0] op_sel_hi:[1,1,1] neg_lo:[0,1,0] neg_hi:[0,1,0]
    v_pk_fma_f32 v[12:13], v[126:127], v[230:231], v[144:145] op_sel:[0,1,0] op_sel_hi:[1,1,1]
    v_pk_fma_f32 v[128:129], v[126:127], v[230:231], v[10:11] op_sel:[0,0,0] op_sel_hi:[1,0,1]
    v_pk_fma_f32 v[144:145], v[142:143], v[230:231], v[12:13] op_sel:[0,0,0] op_sel_hi:[1,0,1]
    v_xor_b32 v3, 80, v9
    v_cvt_pk_bf16_f32 v22, v126, -v142
    v_cvt_pk_bf16_f32 v23, v127, -v143
    ds_write2st64_b32 v3, v22, v23 offset0:5 offset1:21
    v_xor_b32 v8, 64, v20
    ds_read_b128 v[28:31], v8 offset:1024
    buffer_load_dwordx4 a[24:27], v17, s[8:11], s12 offen offset:2048 sc0 sc1
    v_pk_fma_f32 v[10:11], v[144:145], v[230:231], v[130:131] op_sel:[0,1,0] op_sel_hi:[1,1,1] neg_lo:[0,1,0] neg_hi:[0,1,0]
    v_pk_fma_f32 v[12:13], v[128:129], v[230:231], v[146:147] op_sel:[0,1,0] op_sel_hi:[1,1,1]
    v_pk_fma_f32 v[130:131], v[128:129], v[230:231], v[10:11] op_sel:[0,0,0] op_sel_hi:[1,0,1]
    v_pk_fma_f32 v[146:147], v[144:145], v[230:231], v[12:13] op_sel:[0,0,0] op_sel_hi:[1,0,1]
    v_xor_b32 v1, 96, v9
    v_cvt_pk_bf16_f32 v18, v128, -v144
    v_cvt_pk_bf16_f32 v19, v129, -v145
    ds_write2st64_b32 v1, v18, v19 offset0:6 offset1:22
    s_add_u32 s13, s13, 8192
    s_waitcnt lgkmcnt(1)
    buffer_store_dwordx4 v[28:31], v21, s[8:11], s13 offen sc0 sc1
    buffer_load_dwordx4 a[28:31], v17, s[8:11], s12 offen offset:3072 sc0 sc1
    v_pk_fma_f32 v[10:11], v[146:147], v[230:231], v[148:149] op_sel:[0,1,0] op_sel_hi:[1,1,1] neg_lo:[0,1,0] neg_hi:[0,1,0]
    v_pk_fma_f32 v[12:13], v[130:131], v[230:231], v[164:165] op_sel:[0,1,0] op_sel_hi:[1,1,1]
    v_pk_fma_f32 v[148:149], v[130:131], v[230:231], v[10:11] op_sel:[0,0,0] op_sel_hi:[1,0,1]
    v_pk_fma_f32 v[164:165], v[146:147], v[230:231], v[12:13] op_sel:[0,0,0] op_sel_hi:[1,0,1]
    v_xor_b32 v3, 112, v9
    v_cvt_pk_bf16_f32 v22, v130, -v146
    v_cvt_pk_bf16_f32 v23, v131, -v147
    ds_write2st64_b32 v3, v22, v23 offset0:7 offset1:23
    v_xor_b32 v8, 96, v20
    ds_read_b128 v[32:35], v8 offset:1536
    v_pk_fma_f32 v[10:11], v[164:165], v[230:231], v[150:151] op_sel:[0,1,0] op_sel_hi:[1,1,1] neg_lo:[0,1,0] neg_hi:[0,1,0]
    v_pk_fma_f32 v[12:13], v[148:149], v[230:231], v[166:167] op_sel:[0,1,0] op_sel_hi:[1,1,1]
    v_pk_fma_f32 v[150:151], v[148:149], v[230:231], v[10:11] op_sel:[0,0,0] op_sel_hi:[1,0,1]
    v_pk_fma_f32 v[166:167], v[164:165], v[230:231], v[12:13] op_sel:[0,0,0] op_sel_hi:[1,0,1]
    v_xor_b32 v1, 128, v9
    v_cvt_pk_bf16_f32 v18, v148, -v164
    v_cvt_pk_bf16_f32 v19, v149, -v165
    ds_write2st64_b32 v1, v18, v19 offset0:8 offset1:24
    s_add_u32 s13, s13, 8192
    s_waitcnt lgkmcnt(1)
    buffer_store_dwordx4 v[32:35], v21, s[8:11], s13 offen sc0 sc1
    v_pk_fma_f32 v[10:11], v[166:167], v[230:231], v[152:153] op_sel:[0,1,0] op_sel_hi:[1,1,1] neg_lo:[0,1,0] neg_hi:[0,1,0]
    v_pk_fma_f32 v[12:13], v[150:151], v[230:231], v[168:169] op_sel:[0,1,0] op_sel_hi:[1,1,1]
    v_pk_fma_f32 v[152:153], v[150:151], v[230:231], v[10:11] op_sel:[0,0,0] op_sel_hi:[1,0,1]
    v_pk_fma_f32 v[168:169], v[166:167], v[230:231], v[12:13] op_sel:[0,0,0] op_sel_hi:[1,0,1]
    v_xor_b32 v3, 144, v9
    v_cvt_pk_bf16_f32 v22, v150, -v166
    v_cvt_pk_bf16_f32 v23, v151, -v167
    ds_write2st64_b32 v3, v22, v23 offset0:9 offset1:25
    v_xor_b32 v8, 128, v20
    ds_read_b128 v[28:31], v8 offset:2048
    v_pk_fma_f32 v[10:11], v[168:169], v[230:231], v[154:155] op_sel:[0,1,0] op_sel_hi:[1,1,1] neg_lo:[0,1,0] neg_hi:[0,1,0]
    v_pk_fma_f32 v[12:13], v[152:153], v[230:231], v[170:171] op_sel:[0,1,0] op_sel_hi:[1,1,1]
    v_pk_fma_f32 v[154:155], v[152:153], v[230:231], v[10:11] op_sel:[0,0,0] op_sel_hi:[1,0,1]
    v_pk_fma_f32 v[170:171], v[168:169], v[230:231], v[12:13] op_sel:[0,0,0] op_sel_hi:[1,0,1]
    v_xor_b32 v1, 160, v9
    v_cvt_pk_bf16_f32 v18, v152, -v168
    v_cvt_pk_bf16_f32 v19, v153, -v169
    ds_write2st64_b32 v1, v18, v19 offset0:10 offset1:26
    s_add_u32 s13, s13, 8192
    s_waitcnt lgkmcnt(1)
    buffer_store_dwordx4 v[28:31], v21, s[8:11], s13 offen sc0 sc1
    v_pk_fma_f32 v[10:11], v[170:171], v[230:231], v[156:157] op_sel:[0,1,0] op_sel_hi:[1,1,1] neg_lo:[0,1,0] neg_hi:[0,1,0]
    v_pk_fma_f32 v[12:13], v[154:155], v[230:231], v[172:173] op_sel:[0,1,0] op_sel_hi:[1,1,1]
    v_pk_fma_f32 v[156:157], v[154:155], v[230:231], v[10:11] op_sel:[0,0,0] op_sel_hi:[1,0,1]
    v_pk_fma_f32 v[172:173], v[170:171], v[230:231], v[12:13] op_sel:[0,0,0] op_sel_hi:[1,0,1]
    v_xor_b32 v3, 176, v9
    v_cvt_pk_bf16_f32 v22, v154, -v170
    v_cvt_pk_bf16_f32 v23, v155, -v171
    ds_write2st64_b32 v3, v22, v23 offset0:11 offset1:27
    v_xor_b32 v8, 160, v20
    ds_read_b128 v[32:35], v8 offset:2560
    v_pk_fma_f32 v[10:11], v[172:173], v[230:231], v[158:159] op_sel:[0,1,0] op_sel_hi:[1,1,1] neg_lo:[0,1,0] neg_hi:[0,1,0]
    v_pk_fma_f32 v[12:13], v[156:157], v[230:231], v[174:175] op_sel:[0,1,0] op_sel_hi:[1,1,1]
    v_pk_fma_f32 v[158:159], v[156:157], v[230:231], v[10:11] op_sel:[0,0,0] op_sel_hi:[1,0,1]
    v_pk_fma_f32 v[174:175], v[172:173], v[230:231], v[12:13] op_sel:[0,0,0] op_sel_hi:[1,0,1]
    v_xor_b32 v1, 192, v9
    v_cvt_pk_bf16_f32 v18, v156, -v172
    v_cvt_pk_bf16_f32 v19, v157, -v173
    ds_write2st64_b32 v1, v18, v19 offset0:12 offset1:28
    s_add_u32 s13, s13, 8192
    s_waitcnt lgkmcnt(1)
    buffer_store_dwordx4 v[32:35], v21, s[8:11], s13 offen sc0 sc1
    v_pk_fma_f32 v[10:11], v[174:175], v[230:231], v[160:161] op_sel:[0,1,0] op_sel_hi:[1,1,1] neg_lo:[0,1,0] neg_hi:[0,1,0]
    v_pk_fma_f32 v[12:13], v[158:159], v[230:231], v[176:177] op_sel:[0,1,0] op_sel_hi:[1,1,1]
    v_pk_fma_f32 v[160:161], v[158:159], v[230:231], v[10:11] op_sel:[0,0,0] op_sel_hi:[1,0,1]
    v_pk_fma_f32 v[176:177], v[174:175], v[230:231], v[12:13] op_sel:[0,0,0] op_sel_hi:[1,0,1]
    v_xor_b32 v3, 208, v9
    v_cvt_pk_bf16_f32 v22, v158, -v174
    v_cvt_pk_bf16_f32 v23, v159, -v175
    ds_write2st64_b32 v3, v22, v23 offset0:13 offset1:29
    v_xor_b32 v8, 192, v20
    ds_read_b128 v[28:31], v8 offset:3072
    v_pk_fma_f32 v[10:11], v[176:177], v[230:231], v[162:163] op_sel:[0,1,0] op_sel_hi:[1,1,1] neg_lo:[0,1,0] neg_hi:[0,1,0]
    v_pk_fma_f32 v[12:13], v[160:161], v[230:231], v[178:179] op_sel:[0,1,0] op_sel_hi:[1,1,1]
    v_pk_fma_f32 v[162:163], v[160:161], v[230:231], v[10:11] op_sel:[0,0,0] op_sel_hi:[1,0,1]
    v_pk_fma_f32 v[178:179], v[176:177], v[230:231], v[12:13] op_sel:[0,0,0] op_sel_hi:[1,0,1]
    v_xor_b32 v1, 224, v9
    v_cvt_pk_bf16_f32 v18, v160, -v176
    v_cvt_pk_bf16_f32 v19, v161, -v177
    ds_write2st64_b32 v1, v18, v19 offset0:14 offset1:30
    s_add_u32 s13, s13, 8192
    s_waitcnt lgkmcnt(1)
    buffer_store_dwordx4 v[28:31], v21, s[8:11], s13 offen sc0 sc1
    v_xor_b32 v3, 240, v9
    v_cvt_pk_bf16_f32 v22, v162, -v178
    v_cvt_pk_bf16_f32 v23, v163, -v179
    ds_write2st64_b32 v3, v22, v23 offset0:15 offset1:31
    v_xor_b32 v8, 224, v20
    ds_read_b128 v[32:35], v8 offset:3584
    s_add_u32 s13, s13, 8192
    s_waitcnt lgkmcnt(0)
    buffer_store_dwordx4 v[32:35], v21, s[8:11], s13 offen sc0 sc1
    s_barrier
    ds_read2_b32 v[96:97], v57 offset0:112 offset1:113
    ds_read2_b32 v[98:99], v57 offset0:114 offset1:115
    ds_read_b128 v[100:103], v58 offset:16128
    ds_read2_b32 v[104:105], v57 offset0:240 offset1:241
    ds_read2_b32 v[106:107], v57 offset0:242 offset1:243
    ds_read_b128 v[108:111], v58 offset:14080
    ds_read2_b32 v[112:113], v63 offset0:112 offset1:113
    ds_read2_b32 v[114:115], v63 offset0:114 offset1:115
    ds_read_b128 v[116:119], v58 offset:12032
    s_waitcnt lgkmcnt(1)
    v_mfma_f32_16x16x32_bf16 v[46:49], v[96:99], v[100:103], 0
    s_lshl_b32 s4, s45, 4
    s_add_u32 s4, s4, s46
    v_mfma_f32_16x16x32_bf16 v[66:69], v[104:107], v[100:103], 0
    ds_read2_b32 v[120:121], v63 offset0:240 offset1:241
    ds_read2_b32 v[122:123], v63 offset0:242 offset1:243
    v_mfma_f32_16x16x32_bf16 v[66:69], v[96:99], v[108:111], v[66:69]
    ds_read_b128 v[124:127], v58 offset:9984
    s_bfe_u32 s7, s14, 0x40004
    v_mfma_f32_16x16x32_bf16 v[70:73], v[104:107], v[108:111], 0
    s_lshl_b32 s7, s7, 12
    s_add_u32 s12, s6, s7
    v_mfma_f32_16x16x32_bf16 v[70:73], v[112:115], v[100:103], v[70:73]
    buffer_load_dwordx4 a[32:35], v17, s[8:11], s12 offen offset:0 sc0 sc1
    s_waitcnt lgkmcnt(3)
    v_mfma_f32_16x16x32_bf16 v[70:73], v[96:99], v[116:119], v[70:73]
    s_lshl_b32 s4, s4, 2
    s_add_u32 s4, s4, s44
    v_mfma_f32_16x16x32_bf16 v[74:77], v[112:115], v[108:111], 0
    s_lshl_b32 s4, s4, 3
    s_add_u32 s4, s4, 21512192
    v_mfma_f32_16x16x32_bf16 v[74:77], v[104:107], v[116:119], v[74:77]
    buffer_load_dwordx4 a[36:39], v17, s[8:11], s12 offen offset:1024 sc0 sc1
    v_mfma_f32_16x16x32_bf16 v[78:81], v[112:115], v[116:119], 0
    ds_read2_b32 v[128:129], v64 offset0:112 offset1:113
    s_waitcnt lgkmcnt(1)
    v_mfma_f32_16x16x32_bf16 v[74:77], v[120:123], v[100:103], v[74:77]
    ds_read2_b32 v[130:131], v64 offset0:114 offset1:115
    ds_read_b128 v[132:135], v58 offset:7936
    v_mfma_f32_16x16x32_bf16 v[74:77], v[96:99], v[124:127], v[74:77]
    s_lshl_b32 s3, s45, 9
    s_add_u32 s3, s3, 21512192
    v_mfma_f32_16x16x32_bf16 v[78:81], v[120:123], v[108:111], v[78:81]
    v_lshrrev_b32 v182, 1, v17
    v_add_u32 v182, s3, v182
    v_mfma_f32_16x16x32_bf16 v[78:81], v[104:107], v[124:127], v[78:81]
    buffer_load_dwordx4 a[40:43], v17, s[8:11], s12 offen offset:2048 sc0 sc1
    v_mfma_f32_16x16x32_bf16 v[84:87], v[120:123], v[116:119], 0
    v_lshrrev_b32 v1, 4, v2
    v_and_b32 v3, 15, v2
    v_mfma_f32_16x16x32_bf16 v[84:87], v[112:115], v[124:127], v[84:87]
    v_xor_b32 v3, v3, v1
    v_lshlrev_b32 v3, 4, v3
    v_mfma_f32_16x16x32_bf16 v[88:91], v[120:123], v[124:127], 0
    v_lshl_add_u32 v7, v1, 12, v3
    s_waitcnt lgkmcnt(0)
    v_mfma_f32_16x16x32_bf16 v[78:81], v[128:131], v[100:103], v[78:81]
    ds_read2_b32 v[136:137], v64 offset0:240 offset1:241
    ds_read2_b32 v[138:139], v64 offset0:242 offset1:243
    v_mfma_f32_16x16x32_bf16 v[78:81], v[96:99], v[132:135], v[78:81]
    ds_read_b128 v[140:143], v58 offset:5888
    buffer_load_dwordx4 a[44:47], v17, s[8:11], s12 offen offset:3072 sc0 sc1
    v_mfma_f32_16x16x32_bf16 v[84:87], v[128:131], v[108:111], v[84:87]
    v_xor_b32 v1, 64, v7
    v_add_u32 v8, 16384, v1
    v_mfma_f32_16x16x32_bf16 v[84:87], v[104:107], v[132:135], v[84:87]
    v_xor_b32 v1, 128, v7
    v_add_u32 v9, 32768, v1
    v_mfma_f32_16x16x32_bf16 v[88:91], v[128:131], v[116:119], v[88:91]
    v_xor_b32 v1, 192, v7
    v_add_u32 v10, 49152, v1
    v_mfma_f32_16x16x32_bf16 v[88:91], v[112:115], v[132:135], v[88:91]
    s_lshl_b32 s16, s45, 19
    s_lshl_b32 s3, s44, 17
    v_mfma_f32_16x16x32_bf16 v[92:95], v[128:131], v[124:127], 0
    ds_read2_b32 v[144:145], v65 offset0:112 offset1:113
    ds_read2_b32 v[146:147], v65 offset0:114 offset1:115
    v_mfma_f32_16x16x32_bf16 v[92:95], v[120:123], v[132:135], v[92:95]
    ds_read_b128 v[148:151], v58 offset:3840
    s_waitcnt lgkmcnt(3)
    v_mfma_f32_16x16x32_bf16 v[84:87], v[136:139], v[100:103], v[84:87]
    s_bfe_u32 s7, s14, 0x40008
    s_lshl_b32 s7, s7, 12
    v_mfma_f32_16x16x32_bf16 v[84:87], v[96:99], v[140:143], v[84:87]
    s_add_u32 s12, s6, s7
    buffer_load_dwordx4 a[48:51], v17, s[8:11], s12 offen offset:0 sc0 sc1
    v_mfma_f32_16x16x32_bf16 v[88:91], v[136:139], v[108:111], v[88:91]
    ds_read2_b32 v[128:129], v65 offset0:240 offset1:241
    ds_read2_b32 v[130:131], v65 offset0:242 offset1:243
    v_mfma_f32_16x16x32_bf16 v[88:91], v[104:107], v[140:143], v[88:91]
    ds_read_b128 v[124:127], v58 offset:1792
    buffer_load_dwordx4 a[52:55], v17, s[8:11], s12 offen offset:1024 sc0 sc1
    v_mfma_f32_16x16x32_bf16 v[92:95], v[136:139], v[116:119], v[92:95]
    ds_read2_b32 v[120:121], v57 offset0:96 offset1:97
    ds_read2_b32 v[122:123], v57 offset0:98 offset1:99
    v_mfma_f32_16x16x32_bf16 v[92:95], v[112:115], v[140:143], v[92:95]
    ds_read_b128 v[132:135], v59 offset:15872
    s_waitcnt lgkmcnt(6)
    v_mfma_f32_16x16x32_bf16 v[88:91], v[144:147], v[100:103], v[88:91]
    ds_read2_b32 v[136:137], v57 offset0:224 offset1:225
    ds_read2_b32 v[138:139], v57 offset0:226 offset1:227
    v_mfma_f32_16x16x32_bf16 v[88:91], v[96:99], v[148:151], v[88:91]
    ds_read_b128 v[116:119], v59 offset:13824
    s_add_u32 s16, s16, s3
    v_mfma_f32_16x16x32_bf16 v[92:95], v[144:147], v[108:111], v[92:95]
    ds_read2_b32 v[112:113], v63 offset0:96 offset1:97
    ds_read2_b32 v[114:115], v63 offset0:98 offset1:99
    v_mfma_f32_16x16x32_bf16 v[92:95], v[104:107], v[148:151], v[92:95]
    ds_read_b128 v[140:143], v59 offset:11776
    s_waitcnt lgkmcnt(6)
    v_mfma_f32_16x16x32_bf16 v[92:95], v[128:131], v[100:103], v[92:95]
    buffer_load_dwordx4 a[56:59], v17, s[8:11], s12 offen offset:2048 sc0 sc1
    v_mfma_f32_16x16x32_bf16 v[92:95], v[96:99], v[124:127], v[92:95]
    s_lshl_b32 s17, s46, 8
    s_lshl_b32 s18, s44, 13
    v_mfma_f32_16x16x32_bf16 v[46:49], v[120:123], v[132:135], v[46:49]
    s_lshr_b32 s28, s44, 1
    s_waitcnt lgkmcnt(1)
    v_mfma_f32_16x16x32_bf16 v[66:69], v[136:139], v[132:135], v[66:69]
    ds_read2_b32 v[144:145], v63 offset0:224 offset1:225
    ds_read2_b32 v[146:147], v63 offset0:226 offset1:227
    v_mfma_f32_16x16x32_bf16 v[66:69], v[120:123], v[116:119], v[66:69]
    ds_read_b128 v[108:111], v59 offset:9728
    buffer_load_dwordx4 a[60:63], v17, s[8:11], s12 offen offset:3072 sc0 sc1
    v_mfma_f32_16x16x32_bf16 v[70:73], v[136:139], v[116:119], v[70:73]
    v_and_b32 v26, 31, v2
    v_lshrrev_b32 v27, 5, v2
    v_mfma_f32_16x16x32_bf16 v[70:73], v[112:115], v[132:135], v[70:73]
    v_lshlrev_b32 v27, 2, v27
    s_waitcnt lgkmcnt(3)
    v_mfma_f32_16x16x32_bf16 v[70:73], v[120:123], v[140:143], v[70:73]
    s_lshl_b32 s3, s28, 3
    v_add_u32 v27, s3, v27
    v_mfma_f32_16x16x32_bf16 v[74:77], v[112:115], v[116:119], v[74:77]
    s_bfe_u32 s7, s14, 0x4000c
    s_lshl_b32 s7, s7, 12
    v_mfma_f32_16x16x32_bf16 v[74:77], v[136:139], v[140:143], v[74:77]
    s_add_u32 s12, s6, s7
    buffer_load_dwordx4 a[64:67], v17, s[8:11], s12 offen offset:0 sc0 sc1
    v_mfma_f32_16x16x32_bf16 v[78:81], v[112:115], v[140:143], v[78:81]
    ds_read2_b32 v[104:105], v64 offset0:96 offset1:97
    s_waitcnt lgkmcnt(1)
    v_mfma_f32_16x16x32_bf16 v[74:77], v[144:147], v[132:135], v[74:77]
    ds_read2_b32 v[106:107], v64 offset0:98 offset1:99
    ds_read_b128 v[148:151], v59 offset:7680
    v_mfma_f32_16x16x32_bf16 v[74:77], v[120:123], v[108:111], v[74:77]
    v_and_b32 v28, 15, v26
    v_xor_b32 v27, v27, v28
    v_mfma_f32_16x16x32_bf16 v[78:81], v[144:147], v[116:119], v[78:81]
    buffer_load_dwordx4 a[68:71], v17, s[8:11], s12 offen offset:1024 sc0 sc1
    v_mfma_f32_16x16x32_bf16 v[78:81], v[136:139], v[108:111], v[78:81]
    v_lshlrev_b32 v27, 4, v27
    v_lshl_add_u32 v27, v26, 8, v27
    v_mfma_f32_16x16x32_bf16 v[84:87], v[144:147], v[140:143], v[84:87]
    s_lshl_b32 s3, s28, 14
    v_add_u32 v27, s3, v27
    v_mfma_f32_16x16x32_bf16 v[84:87], v[112:115], v[108:111], v[84:87]
    v_xor_b32 v4, 0, v27
    v_xor_b32 v18, 0x4000, v4
    v_mfma_f32_16x16x32_bf16 v[88:91], v[144:147], v[108:111], v[88:91]
    v_add_u32 v13, 65536, v4
    s_waitcnt lgkmcnt(0)
    v_mfma_f32_16x16x32_bf16 v[78:81], v[104:107], v[132:135], v[78:81]
    ds_read2_b32 v[128:129], v64 offset0:224 offset1:225
    ds_read2_b32 v[130:131], v64 offset0:226 offset1:227
    v_mfma_f32_16x16x32_bf16 v[78:81], v[120:123], v[148:151], v[78:81]
    ds_read_b128 v[100:103], v59 offset:5632
    buffer_load_dwordx4 a[72:75], v17, s[8:11], s12 offen offset:2048 sc0 sc1
    v_mfma_f32_16x16x32_bf16 v[84:87], v[104:107], v[116:119], v[84:87]
    v_add_u32 v22, 65536, v18
    v_xor_b32 v5, 16, v27
    v_mfma_f32_16x16x32_bf16 v[84:87], v[136:139], v[148:151], v[84:87]
    v_xor_b32 v19, 0x4000, v5
    v_add_u32 v14, 65536, v5
    v_mfma_f32_16x16x32_bf16 v[88:91], v[104:107], v[140:143], v[88:91]
    v_add_u32 v23, 65536, v19
    v_xor_b32 v11, 32, v27
    v_mfma_f32_16x16x32_bf16 v[88:91], v[112:115], v[148:151], v[88:91]
    buffer_load_dwordx4 a[76:79], v17, s[8:11], s12 offen offset:3072 sc0 sc1
    v_mfma_f32_16x16x32_bf16 v[92:95], v[104:107], v[108:111], v[92:95]
    ds_read2_b32 v[96:97], v65 offset0:96 offset1:97
    ds_read2_b32 v[98:99], v65 offset0:98 offset1:99
    v_mfma_f32_16x16x32_bf16 v[92:95], v[144:147], v[148:151], v[92:95]
    ds_read_b128 v[124:127], v59 offset:3584
    s_waitcnt lgkmcnt(3)
    v_mfma_f32_16x16x32_bf16 v[84:87], v[128:131], v[132:135], v[84:87]
    v_xor_b32 v20, 0x4000, v11
    v_add_u32 v15, 65536, v11
    v_mfma_f32_16x16x32_bf16 v[84:87], v[120:123], v[100:103], v[84:87]
    v_add_u32 v24, 65536, v20
    v_xor_b32 v12, 48, v27
    v_mfma_f32_16x16x32_bf16 v[88:91], v[128:131], v[116:119], v[88:91]
    ds_read2_b32 v[104:105], v65 offset0:224 offset1:225
    ds_read2_b32 v[106:107], v65 offset0:226 offset1:227
    v_mfma_f32_16x16x32_bf16 v[88:91], v[136:139], v[100:103], v[88:91]
    ds_read_b128 v[108:111], v59 offset:1536
    s_bfe_u32 s7, s14, 0x40010
    v_mfma_f32_16x16x32_bf16 v[92:95], v[128:131], v[140:143], v[92:95]
    ds_read2_b32 v[144:145], v57 offset0:80 offset1:81
    ds_read2_b32 v[146:147], v57 offset0:82 offset1:83
    v_mfma_f32_16x16x32_bf16 v[92:95], v[112:115], v[100:103], v[92:95]
    ds_read_b128 v[148:151], v60 offset:15616
    s_waitcnt lgkmcnt(6)
    v_mfma_f32_16x16x32_bf16 v[88:91], v[96:99], v[132:135], v[88:91]
    ds_read2_b32 v[128:129], v57 offset0:208 offset1:209
    ds_read2_b32 v[130:131], v57 offset0:210 offset1:211
    v_mfma_f32_16x16x32_bf16 v[88:91], v[120:123], v[124:127], v[88:91]
    ds_read_b128 v[140:143], v60 offset:13568
    s_lshl_b32 s7, s7, 12
    v_mfma_f32_16x16x32_bf16 v[92:95], v[96:99], v[116:119], v[92:95]
    ds_read2_b32 v[112:113], v63 offset0:80 offset1:81
    ds_read2_b32 v[114:115], v63 offset0:82 offset1:83
    v_mfma_f32_16x16x32_bf16 v[92:95], v[136:139], v[124:127], v[92:95]
    ds_read_b128 v[100:103], v60 offset:11520
    s_waitcnt lgkmcnt(6)
    v_mfma_f32_16x16x32_bf16 v[92:95], v[104:107], v[132:135], v[92:95]
    s_add_u32 s12, s6, s7
    buffer_load_dwordx4 a[80:83], v17, s[8:11], s12 offen offset:0 sc0 sc1
    v_mfma_f32_16x16x32_bf16 v[92:95], v[120:123], v[108:111], v[92:95]
    buffer_load_dwordx4 a[84:87], v17, s[8:11], s12 offen offset:1024 sc0 sc1
    v_mfma_f32_16x16x32_bf16 v[46:49], v[144:147], v[148:151], v[46:49]
    s_waitcnt vmcnt(14)
    s_waitcnt lgkmcnt(1)
    v_mfma_f32_16x16x32_bf16 v[66:69], v[128:131], v[148:151], v[66:69]
    ds_read2_b32 v[96:97], v63 offset0:208 offset1:209
    ds_read2_b32 v[98:99], v63 offset0:210 offset1:211
    v_mfma_f32_16x16x32_bf16 v[66:69], v[144:147], v[140:143], v[66:69]
    ds_read_b128 v[116:119], v60 offset:9472
    v_mov_b32 v82, s42
    v_mov_b32 v83, s43
    s_mov_b64 s[48:49], exec
    s_mov_b64 exec, 1
    buffer_store_dwordx2 v[82:83], v6, s[8:11], s4 offen sc0 sc1
    s_mov_b64 exec, s[48:49]
    v_mfma_f32_16x16x32_bf16 v[70:73], v[128:131], v[140:143], v[70:73]
    buffer_load_dwordx4 a[88:91], v17, s[8:11], s12 offen offset:2048 sc0 sc1
    v_mfma_f32_16x16x32_bf16 v[70:73], v[112:115], v[148:151], v[70:73]
    v_xor_b32 v21, 0x4000, v12
    s_waitcnt lgkmcnt(3)
    v_mfma_f32_16x16x32_bf16 v[70:73], v[144:147], v[100:103], v[70:73]
    buffer_load_dwordx4 a[92:95], v17, s[8:11], s12 offen offset:3072 sc0 sc1
    v_mfma_f32_16x16x32_bf16 v[74:77], v[112:115], v[140:143], v[74:77]
    v_add_u32 v16, 65536, v12
    v_add_u32 v25, 65536, v21
    v_mfma_f32_16x16x32_bf16 v[74:77], v[128:131], v[100:103], v[74:77]
    s_lshl_b32 s13, s46, 4
    s_add_u32 s13, s13, s45
    v_mfma_f32_16x16x32_bf16 v[78:81], v[112:115], v[100:103], v[78:81]
    ds_read2_b32 v[136:137], v64 offset0:80 offset1:81
    s_waitcnt lgkmcnt(1)
    v_mfma_f32_16x16x32_bf16 v[74:77], v[96:99], v[148:151], v[74:77]
    ds_read2_b32 v[138:139], v64 offset0:82 offset1:83
    ds_read_b128 v[124:127], v60 offset:7424
    v_mfma_f32_16x16x32_bf16 v[74:77], v[144:147], v[116:119], v[74:77]
    s_bfe_u32 s7, s14, 0x40014
    s_lshl_b32 s7, s7, 12
    v_mfma_f32_16x16x32_bf16 v[78:81], v[96:99], v[140:143], v[78:81]
    s_add_u32 s12, s6, s7
    buffer_load_dwordx4 a[96:99], v17, s[8:11], s12 offen offset:0 sc0 sc1
    v_mfma_f32_16x16x32_bf16 v[78:81], v[128:131], v[116:119], v[78:81]
    s_lshl_b32 s13, s13, 2
    s_add_u32 s13, s13, s44
    v_mfma_f32_16x16x32_bf16 v[84:87], v[96:99], v[100:103], v[84:87]
    s_lshl_b32 s13, s13, 3
    s_add_u32 s13, s13, 21520384
    v_mfma_f32_16x16x32_bf16 v[84:87], v[112:115], v[116:119], v[84:87]
    s_mov_b32 s32, s36
    s_mov_b32 s33, s37
    v_mfma_f32_16x16x32_bf16 v[88:91], v[96:99], v[116:119], v[88:91]
    buffer_load_dwordx4 a[100:103], v17, s[8:11], s12 offen offset:1024 sc0 sc1
    s_waitcnt lgkmcnt(0)
    v_mfma_f32_16x16x32_bf16 v[78:81], v[136:139], v[148:151], v[78:81]
    ds_read2_b32 v[104:105], v64 offset0:208 offset1:209
    ds_read2_b32 v[106:107], v64 offset0:210 offset1:211
    v_mfma_f32_16x16x32_bf16 v[78:81], v[144:147], v[124:127], v[78:81]
    ds_read_b128 v[132:135], v60 offset:5376
    s_mov_b32 s34, 8388608
    v_mfma_f32_16x16x32_bf16 v[84:87], v[136:139], v[140:143], v[84:87]
    s_mov_b32 s35, 131072
    s_lshr_b32 s29, s44, 1
    v_mfma_f32_16x16x32_bf16 v[84:87], v[128:131], v[124:127], v[84:87]
    s_and_b32 s30, s44, 1
    v_bfe_u32 v32, v2, 4, 1
    v_mfma_f32_16x16x32_bf16 v[88:91], v[136:139], v[100:103], v[88:91]
    buffer_load_dwordx4 a[104:107], v17, s[8:11], s12 offen offset:2048 sc0 sc1
    v_mfma_f32_16x16x32_bf16 v[88:91], v[112:115], v[124:127], v[88:91]
    v_lshlrev_b32 v32, 2, v32
    v_and_b32 v33, 7, v2
    v_mfma_f32_16x16x32_bf16 v[92:95], v[136:139], v[116:119], v[92:95]
    ds_read2_b32 v[120:121], v65 offset0:80 offset1:81
    ds_read2_b32 v[122:123], v65 offset0:82 offset1:83
    v_mfma_f32_16x16x32_bf16 v[92:95], v[96:99], v[124:127], v[92:95]
    ds_read_b128 v[108:111], v60 offset:3328
    s_waitcnt lgkmcnt(3)
    v_mfma_f32_16x16x32_bf16 v[84:87], v[104:107], v[148:151], v[84:87]
    v_xor_b32 v33, v33, v32
    v_lshlrev_b32 v33, 4, v33
    v_mfma_f32_16x16x32_bf16 v[84:87], v[144:147], v[132:135], v[84:87]
    buffer_load_dwordx4 a[108:111], v17, s[8:11], s12 offen offset:3072 sc0 sc1
    v_mfma_f32_16x16x32_bf16 v[88:91], v[104:107], v[140:143], v[88:91]
    ds_read2_b32 v[136:137], v65 offset0:208 offset1:209
    ds_read2_b32 v[138:139], v65 offset0:210 offset1:211
    v_mfma_f32_16x16x32_bf16 v[88:91], v[128:131], v[132:135], v[88:91]
    ds_read_b128 v[116:119], v60 offset:1280
    v_lshrrev_b32 v32, 3, v2
    v_mfma_f32_16x16x32_bf16 v[92:95], v[104:107], v[100:103], v[92:95]
    ds_read2_b32 v[96:97], v57 offset0:64 offset1:65
    ds_read2_b32 v[98:99], v57 offset0:66 offset1:67
    v_mfma_f32_16x16x32_bf16 v[92:95], v[112:115], v[132:135], v[92:95]
    ds_read_b128 v[124:127], v61 offset:15360
    s_waitcnt lgkmcnt(6)
    v_mfma_f32_16x16x32_bf16 v[88:91], v[120:123], v[148:151], v[88:91]
    ds_read2_b32 v[104:105], v57 offset0:192 offset1:193
    ds_read2_b32 v[106:107], v57 offset0:194 offset1:195
    v_mfma_f32_16x16x32_bf16 v[88:91], v[144:147], v[108:111], v[88:91]
    ds_read_b128 v[100:103], v61 offset:13312
    s_bfe_u32 s7, s14, 0x40018
    v_mfma_f32_16x16x32_bf16 v[92:95], v[120:123], v[140:143], v[92:95]
    ds_read2_b32 v[112:113], v63 offset0:64 offset1:65
    ds_read2_b32 v[114:115], v63 offset0:66 offset1:67
    v_mfma_f32_16x16x32_bf16 v[92:95], v[128:131], v[108:111], v[92:95]
    ds_read_b128 v[132:135], v61 offset:11264
    s_waitcnt lgkmcnt(6)
    v_mfma_f32_16x16x32_bf16 v[92:95], v[136:139], v[148:151], v[92:95]
    s_lshl_b32 s7, s7, 12
    s_add_u32 s12, s6, s7
    v_mfma_f32_16x16x32_bf16 v[92:95], v[144:147], v[116:119], v[92:95]
    buffer_load_dwordx4 a[112:115], v17, s[8:11], s12 offen offset:0 sc0 sc1
    v_mfma_f32_16x16x32_bf16 v[46:49], v[96:99], v[124:127], v[46:49]
    buffer_load_dwordx4 a[116:119], v17, s[8:11], s12 offen offset:1024 sc0 sc1
    s_waitcnt lgkmcnt(1)
    v_mfma_f32_16x16x32_bf16 v[66:69], v[104:107], v[124:127], v[66:69]
    ds_read2_b32 v[120:121], v63 offset0:192 offset1:193
    ds_read2_b32 v[122:123], v63 offset0:194 offset1:195
    v_mfma_f32_16x16x32_bf16 v[66:69], v[96:99], v[100:103], v[66:69]
    ds_read_b128 v[140:143], v61 offset:9216
    v_lshl_add_u32 v35, v32, 11, v33
    v_mfma_f32_16x16x32_bf16 v[70:73], v[104:107], v[100:103], v[70:73]
    s_lshl_b32 s31, s45, 18
    s_lshl_b32 s3, s44, 16
    v_mfma_f32_16x16x32_bf16 v[70:73], v[112:115], v[124:127], v[70:73]
    buffer_load_dwordx4 a[120:123], v17, s[8:11], s12 offen offset:2048 sc0 sc1
    s_waitcnt lgkmcnt(3)
    v_mfma_f32_16x16x32_bf16 v[70:73], v[96:99], v[132:135], v[70:73]
    s_add_u32 s31, s31, s3
    s_lshl_b32 s3, s46, 7
    v_mfma_f32_16x16x32_bf16 v[74:77], v[112:115], v[100:103], v[74:77]
    s_add_u32 s31, s31, s3
    s_lshl_b32 s38, s46, 18
    v_mfma_f32_16x16x32_bf16 v[74:77], v[104:107], v[132:135], v[74:77]
    s_lshl_b32 s3, s44, 16
    s_add_u32 s38, s38, s3
    v_mfma_f32_16x16x32_bf16 v[78:81], v[112:115], v[132:135], v[78:81]
    ds_read2_b32 v[128:129], v64 offset0:64 offset1:65
    s_waitcnt lgkmcnt(1)
    v_mfma_f32_16x16x32_bf16 v[74:77], v[120:123], v[124:127], v[74:77]
    ds_read2_b32 v[130:131], v64 offset0:66 offset1:67
    ds_read_b128 v[108:111], v61 offset:7168
    v_mfma_f32_16x16x32_bf16 v[74:77], v[96:99], v[140:143], v[74:77]
    buffer_load_dwordx4 a[124:127], v17, s[8:11], s12 offen offset:3072 sc0 sc1
    v_mfma_f32_16x16x32_bf16 v[78:81], v[120:123], v[100:103], v[78:81]
    s_lshl_b32 s3, s45, 8
    s_add_u32 s38, s38, s3
    v_mfma_f32_16x16x32_bf16 v[78:81], v[104:107], v[140:143], v[78:81]
    s_add_u32 s38, s38, 12582912
    v_bfe_u32 v34, v2, 2, 2
    v_mfma_f32_16x16x32_bf16 v[84:87], v[120:123], v[132:135], v[84:87]
    v_bfe_u32 v32, v2, 4, 1
    v_lshlrev_b32 v32, 1, v32
    v_mfma_f32_16x16x32_bf16 v[84:87], v[112:115], v[140:143], v[84:87]
    s_bfe_u32 s7, s14, 0x4001c
    s_lshl_b32 s7, s7, 12
    v_mfma_f32_16x16x32_bf16 v[88:91], v[120:123], v[140:143], v[88:91]
    s_add_u32 s12, s6, s7
    s_waitcnt lgkmcnt(0)
    v_mfma_f32_16x16x32_bf16 v[78:81], v[128:131], v[124:127], v[78:81]
    ds_read2_b32 v[136:137], v64 offset0:192 offset1:193
    ds_read2_b32 v[138:139], v64 offset0:194 offset1:195
    v_mfma_f32_16x16x32_bf16 v[78:81], v[96:99], v[108:111], v[78:81]
    ds_read_b128 v[148:151], v61 offset:5120
    buffer_load_dwordx4 a[128:131], v17, s[8:11], s12 offen offset:0 sc0 sc1
    v_mfma_f32_16x16x32_bf16 v[84:87], v[128:131], v[100:103], v[84:87]
    v_bfe_u32 v33, v2, 1, 1
    v_add_u32 v32, v32, v33
    v_mfma_f32_16x16x32_bf16 v[84:87], v[104:107], v[108:111], v[84:87]
    buffer_load_dwordx4 a[132:135], v17, s[8:11], s12 offen offset:1024 sc0 sc1
    v_mfma_f32_16x16x32_bf16 v[88:91], v[128:131], v[132:135], v[88:91]
    s_lshl_b32 s3, s30, 2
    v_add_u32 v32, s3, v32
    v_mfma_f32_16x16x32_bf16 v[88:91], v[112:115], v[108:111], v[88:91]
    v_bfe_u32 v33, v2, 3, 1
    v_lshlrev_b32 v33, 2, v33
    v_mfma_f32_16x16x32_bf16 v[92:95], v[128:131], v[140:143], v[92:95]
    ds_read2_b32 v[144:145], v65 offset0:64 offset1:65
    ds_read2_b32 v[146:147], v65 offset0:66 offset1:67
    v_mfma_f32_16x16x32_bf16 v[92:95], v[120:123], v[108:111], v[92:95]
    ds_read_b128 v[116:119], v61 offset:3072
    s_waitcnt lgkmcnt(3)
    v_mfma_f32_16x16x32_bf16 v[84:87], v[136:139], v[124:127], v[84:87]
    buffer_load_dwordx4 a[136:139], v17, s[8:11], s12 offen offset:2048 sc0 sc1
    v_mfma_f32_16x16x32_bf16 v[84:87], v[96:99], v[148:151], v[84:87]
    v_xor_b32 v32, v32, v33
    v_lshlrev_b32 v32, 4, v32
    v_mfma_f32_16x16x32_bf16 v[88:91], v[136:139], v[100:103], v[88:91]
    ds_read2_b32 v[128:129], v65 offset0:192 offset1:193
    ds_read2_b32 v[130:131], v65 offset0:194 offset1:195
    v_mfma_f32_16x16x32_bf16 v[88:91], v[104:107], v[148:151], v[88:91]
    ds_read_b128 v[140:143], v61 offset:1024
    v_and_b32 v33, 1, v2
    v_mfma_f32_16x16x32_bf16 v[92:95], v[136:139], v[132:135], v[92:95]
    ds_read2_b32 v[120:121], v57 offset0:48 offset1:49
    ds_read2_b32 v[122:123], v57 offset0:50 offset1:51
    v_mfma_f32_16x16x32_bf16 v[92:95], v[112:115], v[148:151], v[92:95]
    ds_read_b128 v[108:111], v58 offset:15104
    s_waitcnt lgkmcnt(6)
    v_mfma_f32_16x16x32_bf16 v[88:91], v[144:147], v[124:127], v[88:91]
    ds_read2_b32 v[136:137], v57 offset0:176 offset1:177
    ds_read2_b32 v[138:139], v57 offset0:178 offset1:179
    v_mfma_f32_16x16x32_bf16 v[88:91], v[96:99], v[116:119], v[88:91]
    ds_read_b128 v[132:135], v58 offset:13056
    buffer_load_dwordx4 a[140:143], v17, s[8:11], s12 offen offset:3072 sc0 sc1
    v_mfma_f32_16x16x32_bf16 v[92:95], v[144:147], v[100:103], v[92:95]
    ds_read2_b32 v[112:113], v63 offset0:48 offset1:49
    ds_read2_b32 v[114:115], v63 offset0:50 offset1:51
    v_mfma_f32_16x16x32_bf16 v[92:95], v[104:107], v[116:119], v[92:95]
    ds_read_b128 v[148:151], v58 offset:11008
    s_waitcnt lgkmcnt(6)
    v_mfma_f32_16x16x32_bf16 v[92:95], v[128:131], v[124:127], v[92:95]
    s_bfe_u32 s7, s15, 0x40000
    s_lshl_b32 s7, s7, 12
    v_mfma_f32_16x16x32_bf16 v[92:95], v[96:99], v[140:143], v[92:95]
    s_add_u32 s12, s6, s7
    buffer_load_dwordx4 a[144:147], v17, s[8:11], s12 offen offset:0 sc0 sc1
    v_mfma_f32_16x16x32_bf16 v[46:49], v[120:123], v[108:111], v[46:49]
    v_lshl_add_u32 v32, v33, 3, v32
    s_waitcnt lgkmcnt(1)
    v_mfma_f32_16x16x32_bf16 v[66:69], v[136:139], v[108:111], v[66:69]
    ds_read2_b32 v[144:145], v63 offset0:176 offset1:177
    ds_read2_b32 v[146:147], v63 offset0:178 offset1:179
    v_mfma_f32_16x16x32_bf16 v[66:69], v[120:123], v[132:135], v[66:69]
    ds_read_b128 v[100:103], v58 offset:8960
    v_lshrrev_b32 v33, 5, v2
    v_mfma_f32_16x16x32_bf16 v[70:73], v[136:139], v[132:135], v[70:73]
    buffer_load_dwordx4 a[148:151], v17, s[8:11], s12 offen offset:1024 sc0 sc1
    v_mfma_f32_16x16x32_bf16 v[70:73], v[112:115], v[108:111], v[70:73]
    v_lshl_add_u32 v34, v33, 2, v34
    s_waitcnt lgkmcnt(3)
    v_mfma_f32_16x16x32_bf16 v[70:73], v[120:123], v[148:151], v[70:73]
    v_lshl_add_u32 v32, v34, 7, v32
    s_lshl_b32 s3, s29, 13
    v_mfma_f32_16x16x32_bf16 v[74:77], v[112:115], v[132:135], v[74:77]
    s_add_u32 s3, s3, 131072
    v_add_u32 v36, s3, v32
    v_mfma_f32_16x16x32_bf16 v[74:77], v[136:139], v[148:151], v[74:77]
    v_and_b32 v32, 15, v2
    s_lshl_b32 s3, s29, 3
    v_mfma_f32_16x16x32_bf16 v[78:81], v[112:115], v[148:151], v[78:81]
    ds_read2_b32 v[104:105], v64 offset0:48 offset1:49
    s_waitcnt lgkmcnt(1)
    v_mfma_f32_16x16x32_bf16 v[74:77], v[144:147], v[108:111], v[74:77]
    ds_read2_b32 v[106:107], v64 offset0:50 offset1:51
    ds_read_b128 v[116:119], v58 offset:6912
    v_mfma_f32_16x16x32_bf16 v[74:77], v[120:123], v[100:103], v[74:77]
    buffer_load_dwordx4 a[152:155], v17, s[8:11], s12 offen offset:2048 sc0 sc1
    v_mfma_f32_16x16x32_bf16 v[78:81], v[144:147], v[132:135], v[78:81]
    v_xor_b32 v32, s3, v32
    v_lshlrev_b32 v32, 4, v32
    v_mfma_f32_16x16x32_bf16 v[78:81], v[136:139], v[100:103], v[78:81]
    v_and_b32 v34, 31, v2
    v_lshl_add_u32 v32, v34, 8, v32
    v_mfma_f32_16x16x32_bf16 v[84:87], v[144:147], v[148:151], v[84:87]
    buffer_load_dwordx4 a[156:159], v17, s[8:11], s12 offen offset:3072 sc0 sc1
    v_mfma_f32_16x16x32_bf16 v[84:87], v[112:115], v[100:103], v[84:87]
    v_lshl_add_u32 v32, v33, 3, v32
    s_lshl_b32 s3, s30, 13
    v_mfma_f32_16x16x32_bf16 v[88:91], v[144:147], v[100:103], v[88:91]
    s_add_u32 s3, s3, 147456
    s_waitcnt lgkmcnt(0)
    v_mfma_f32_16x16x32_bf16 v[78:81], v[104:107], v[108:111], v[78:81]
    ds_read2_b32 v[128:129], v64 offset0:176 offset1:177
    ds_read2_b32 v[130:131], v64 offset0:178 offset1:179
    v_mfma_f32_16x16x32_bf16 v[78:81], v[120:123], v[116:119], v[78:81]
    ds_read_b128 v[124:127], v58 offset:4864
    v_add_u32 v37, s3, v32
    v_mfma_f32_16x16x32_bf16 v[84:87], v[104:107], v[132:135], v[84:87]
    s_bfe_u32 s7, s15, 0x40004
    s_lshl_b32 s7, s7, 12
    v_mfma_f32_16x16x32_bf16 v[84:87], v[136:139], v[116:119], v[84:87]
    s_add_u32 s12, s6, s7
    buffer_load_dwordx4 a[160:163], v17, s[8:11], s12 offen offset:0 sc0 sc1
    v_mfma_f32_16x16x32_bf16 v[88:91], v[104:107], v[148:151], v[88:91]
    v_and_b32 v32, 15, v2
    v_lshlrev_b32 v32, 4, v32
    v_mfma_f32_16x16x32_bf16 v[88:91], v[112:115], v[116:119], v[88:91]
    v_and_b32 v34, 16, v2
    v_lshl_add_u32 v32, v34, 9, v32
    v_mfma_f32_16x16x32_bf16 v[92:95], v[104:107], v[100:103], v[92:95]
    ds_read2_b32 v[96:97], v65 offset0:48 offset1:49
    ds_read2_b32 v[98:99], v65 offset0:50 offset1:51
    v_mfma_f32_16x16x32_bf16 v[92:95], v[144:147], v[116:119], v[92:95]
    ds_read_b128 v[140:143], v58 offset:2816
    s_waitcnt lgkmcnt(3)
    v_mfma_f32_16x16x32_bf16 v[84:87], v[128:131], v[108:111], v[84:87]
    buffer_load_dwordx4 a[164:167], v17, s[8:11], s12 offen offset:1024 sc0 sc1
    v_mfma_f32_16x16x32_bf16 v[84:87], v[120:123], v[124:127], v[84:87]
    s_lshl_b32 s3, s45, 9
    s_add_u32 s3, s3, 20971520
    v_mfma_f32_16x16x32_bf16 v[88:91], v[128:131], v[132:135], v[88:91]
    ds_read2_b32 v[104:105], v65 offset0:176 offset1:177
    ds_read2_b32 v[106:107], v65 offset0:178 offset1:179
    v_mfma_f32_16x16x32_bf16 v[88:91], v[136:139], v[124:127], v[88:91]
    ds_read_b128 v[100:103], v58 offset:768
    v_add_u32 v32, s3, v32
    v_mfma_f32_16x16x32_bf16 v[92:95], v[128:131], v[148:151], v[92:95]
    ds_read2_b32 v[144:145], v57 offset0:32 offset1:33
    ds_read2_b32 v[146:147], v57 offset0:34 offset1:35
    v_mfma_f32_16x16x32_bf16 v[92:95], v[112:115], v[124:127], v[92:95]
    ds_read_b128 v[116:119], v59 offset:14848
    s_waitcnt lgkmcnt(6)
    v_mfma_f32_16x16x32_bf16 v[88:91], v[96:99], v[108:111], v[88:91]
    ds_read2_b32 v[128:129], v57 offset0:160 offset1:161
    ds_read2_b32 v[130:131], v57 offset0:162 offset1:163
    v_mfma_f32_16x16x32_bf16 v[88:91], v[120:123], v[140:143], v[88:91]
    ds_read_b128 v[148:151], v59 offset:12800
    buffer_load_dwordx4 a[168:171], v17, s[8:11], s12 offen offset:2048 sc0 sc1
    v_mfma_f32_16x16x32_bf16 v[92:95], v[96:99], v[132:135], v[92:95]
    ds_read2_b32 v[112:113], v63 offset0:32 offset1:33
    ds_read2_b32 v[114:115], v63 offset0:34 offset1:35
    v_mfma_f32_16x16x32_bf16 v[92:95], v[136:139], v[140:143], v[92:95]
    ds_read_b128 v[124:127], v59 offset:10752
    s_waitcnt lgkmcnt(6)
    v_mfma_f32_16x16x32_bf16 v[92:95], v[104:107], v[108:111], v[92:95]
    buffer_load_dwordx4 a[172:175], v17, s[8:11], s12 offen offset:3072 sc0 sc1
    v_mfma_f32_16x16x32_bf16 v[92:95], v[120:123], v[100:103], v[92:95]
    s_lshl_b32 s3, s29, 8
    v_add_u32 v38, s3, v32
    v_mfma_f32_16x16x32_bf16 v[46:49], v[144:147], v[116:119], v[46:49]
    s_lshl_b32 s3, s44, 10
    s_waitcnt lgkmcnt(1)
    v_mfma_f32_16x16x32_bf16 v[66:69], v[128:131], v[116:119], v[66:69]
    ds_read2_b32 v[96:97], v63 offset0:160 offset1:161
    ds_read2_b32 v[98:99], v63 offset0:162 offset1:163
    v_mfma_f32_16x16x32_bf16 v[66:69], v[144:147], v[148:151], v[66:69]
    ds_read_b128 v[132:135], v59 offset:8704
    s_bfe_u32 s7, s15, 0x40008
    v_mfma_f32_16x16x32_bf16 v[70:73], v[128:131], v[148:151], v[70:73]
    s_lshl_b32 s7, s7, 12
    s_add_u32 s12, s6, s7
    v_mfma_f32_16x16x32_bf16 v[70:73], v[112:115], v[116:119], v[70:73]
    buffer_load_dwordx4 a[176:179], v17, s[8:11], s12 offen offset:0 sc0 sc1
    s_waitcnt lgkmcnt(3)
    v_mfma_f32_16x16x32_bf16 v[70:73], v[144:147], v[124:127], v[70:73]
    s_add_u32 s3, s3, 147456
    v_lshl_add_u32 v39, v33, 4, s3
    v_mfma_f32_16x16x32_bf16 v[74:77], v[112:115], v[148:151], v[74:77]
    v_and_b32 v32, 31, v2
    s_lshl_b32 s3, s30, 5
    v_mfma_f32_16x16x32_bf16 v[74:77], v[128:131], v[124:127], v[74:77]
    buffer_load_dwordx4 a[180:183], v17, s[8:11], s12 offen offset:1024 sc0 sc1
    v_mfma_f32_16x16x32_bf16 v[78:81], v[112:115], v[124:127], v[78:81]
    ds_read2_b32 v[136:137], v64 offset0:32 offset1:33
    s_waitcnt lgkmcnt(1)
    v_mfma_f32_16x16x32_bf16 v[74:77], v[96:99], v[116:119], v[74:77]
    ds_read2_b32 v[138:139], v64 offset0:34 offset1:35
    ds_read_b128 v[140:143], v59 offset:6656
    v_mfma_f32_16x16x32_bf16 v[74:77], v[144:147], v[132:135], v[74:77]
    buffer_load_dwordx2 v[82:83], v182, s[8:11], 0 offen sc0 sc1
    v_mfma_f32_16x16x32_bf16 v[78:81], v[96:99], v[148:151], v[78:81]
    v_add_u32 v32, s3, v32
    s_lshl_b32 s3, s46, 6
    v_mfma_f32_16x16x32_bf16 v[78:81], v[128:131], v[132:135], v[78:81]
    buffer_load_dwordx4 a[184:187], v17, s[8:11], s12 offen offset:2048 sc0 sc1
    v_mfma_f32_16x16x32_bf16 v[84:87], v[96:99], v[124:127], v[84:87]
    v_add_u32 v32, s3, v32
    v_lshlrev_b32 v33, 14, v33
    v_mfma_f32_16x16x32_bf16 v[84:87], v[112:115], v[132:135], v[84:87]
    v_lshl_add_u32 v40, v32, 2, v33
    v_add_u32 v41, 4096, v40
    v_mfma_f32_16x16x32_bf16 v[88:91], v[96:99], v[132:135], v[88:91]
    v_add_u32 v42, 8192, v40
    s_waitcnt lgkmcnt(0)
    v_mfma_f32_16x16x32_bf16 v[78:81], v[136:139], v[116:119], v[78:81]
    ds_read2_b32 v[104:105], v64 offset0:160 offset1:161
    ds_read2_b32 v[106:107], v64 offset0:162 offset1:163
    v_mfma_f32_16x16x32_bf16 v[78:81], v[144:147], v[140:143], v[78:81]
    ds_read_b128 v[108:111], v59 offset:4608
    buffer_load_dwordx4 a[188:191], v17, s[8:11], s12 offen offset:3072 sc0 sc1
    v_mfma_f32_16x16x32_bf16 v[84:87], v[136:139], v[148:151], v[84:87]
    v_add_u32 v43, 12288, v40
    s_lshl_b32 s39, s45, 19
    v_mfma_f32_16x16x32_bf16 v[84:87], v[128:131], v[140:143], v[84:87]
    s_lshl_b32 s3, s29, 18
    s_add_u32 s39, s39, s3
    v_mfma_f32_16x16x32_bf16 v[88:91], v[136:139], v[124:127], v[88:91]
    s_lshl_b32 s47, s44, 12
    s_lshl_b32 s3, s44, 13
    v_mfma_f32_16x16x32_bf16 v[88:91], v[112:115], v[140:143], v[88:91]
    s_add_u32 s3, s3, 0
    v_add_u32 v44, s3, v17
    v_mfma_f32_16x16x32_bf16 v[92:95], v[136:139], v[132:135], v[92:95]
    ds_read2_b32 v[120:121], v65 offset0:32 offset1:33
    ds_read2_b32 v[122:123], v65 offset0:34 offset1:35
    v_mfma_f32_16x16x32_bf16 v[92:95], v[96:99], v[140:143], v[92:95]
    ds_read_b128 v[100:103], v59 offset:2560
    s_waitcnt lgkmcnt(3)
    v_mfma_f32_16x16x32_bf16 v[84:87], v[104:107], v[116:119], v[84:87]
    s_bfe_u32 s7, s15, 0x4000c
    s_lshl_b32 s7, s7, 12
    v_mfma_f32_16x16x32_bf16 v[84:87], v[144:147], v[108:111], v[84:87]
    s_add_u32 s12, s6, s7
    buffer_load_dwordx4 a[192:195], v17, s[8:11], s12 offen offset:0 sc0 sc1
    v_mfma_f32_16x16x32_bf16 v[88:91], v[104:107], v[148:151], v[88:91]
    ds_read2_b32 v[136:137], v65 offset0:160 offset1:161
    ds_read2_b32 v[138:139], v65 offset0:162 offset1:163
    v_mfma_f32_16x16x32_bf16 v[88:91], v[128:131], v[108:111], v[88:91]
    ds_read_b128 v[132:135], v59 offset:512
    buffer_load_dwordx4 a[196:199], v17, s[8:11], s12 offen offset:1024 sc0 sc1
    v_mfma_f32_16x16x32_bf16 v[92:95], v[104:107], v[124:127], v[92:95]
    ds_read2_b32 v[96:97], v57 offset0:16 offset1:17
    ds_read2_b32 v[98:99], v57 offset0:18 offset1:19
    v_mfma_f32_16x16x32_bf16 v[92:95], v[112:115], v[108:111], v[92:95]
    ds_read_b128 v[140:143], v60 offset:14592
    s_waitcnt lgkmcnt(6)
    v_mfma_f32_16x16x32_bf16 v[88:91], v[120:123], v[116:119], v[88:91]
    ds_read2_b32 v[104:105], v57 offset0:144 offset1:145
    ds_read2_b32 v[106:107], v57 offset0:146 offset1:147
    v_mfma_f32_16x16x32_bf16 v[88:91], v[144:147], v[100:103], v[88:91]
    ds_read_b128 v[124:127], v60 offset:12544
    v_xor_b32 v45, 0x4000, v44
    v_mfma_f32_16x16x32_bf16 v[92:95], v[120:123], v[148:151], v[92:95]
    ds_read2_b32 v[112:113], v63 offset0:16 offset1:17
    ds_read2_b32 v[114:115], v63 offset0:18 offset1:19
    v_mfma_f32_16x16x32_bf16 v[92:95], v[128:131], v[100:103], v[92:95]
    ds_read_b128 v[108:111], v60 offset:10496
    s_waitcnt lgkmcnt(6)
    v_mfma_f32_16x16x32_bf16 v[92:95], v[136:139], v[116:119], v[92:95]
    buffer_load_dwordx4 a[200:203], v17, s[8:11], s12 offen offset:2048 sc0 sc1
    v_mfma_f32_16x16x32_bf16 v[92:95], v[144:147], v[132:135], v[92:95]
    s_lshl_b32 s3, s46, 9
    s_add_u32 s3, s3, 21520384
    v_mfma_f32_16x16x32_bf16 v[46:49], v[96:99], v[140:143], v[46:49]
    v_lshrrev_b32 v29, 1, v17
    s_waitcnt lgkmcnt(1)
    v_mfma_f32_16x16x32_bf16 v[66:69], v[104:107], v[140:143], v[66:69]
    ds_read2_b32 v[120:121], v63 offset0:144 offset1:145
    ds_read2_b32 v[122:123], v63 offset0:146 offset1:147
    v_mfma_f32_16x16x32_bf16 v[66:69], v[96:99], v[124:127], v[66:69]
    ds_read_b128 v[148:151], v60 offset:8448
    buffer_load_dwordx4 a[204:207], v17, s[8:11], s12 offen offset:3072 sc0 sc1
    v_mfma_f32_16x16x32_bf16 v[70:73], v[104:107], v[124:127], v[70:73]
    v_add_u32 v29, s3, v29
    v_mfma_f32_16x16x32_bf16 v[70:73], v[112:115], v[140:143], v[70:73]
    s_waitcnt lgkmcnt(3)
    v_mfma_f32_16x16x32_bf16 v[70:73], v[96:99], v[108:111], v[70:73]
    v_mfma_f32_16x16x32_bf16 v[74:77], v[112:115], v[124:127], v[74:77]
    s_bfe_u32 s7, s15, 0x40010
    s_lshl_b32 s7, s7, 12
    v_mfma_f32_16x16x32_bf16 v[74:77], v[104:107], v[108:111], v[74:77]
    s_add_u32 s12, s6, s7
    buffer_load_dwordx4 a[208:211], v17, s[8:11], s12 offen offset:0 sc0 sc1
    v_mfma_f32_16x16x32_bf16 v[78:81], v[112:115], v[108:111], v[78:81]
    ds_read2_b32 v[128:129], v64 offset0:16 offset1:17
    s_waitcnt lgkmcnt(1)
    v_mfma_f32_16x16x32_bf16 v[74:77], v[120:123], v[140:143], v[74:77]
    ds_read2_b32 v[130:131], v64 offset0:18 offset1:19
    ds_read_b128 v[100:103], v60 offset:6400
    v_mfma_f32_16x16x32_bf16 v[74:77], v[96:99], v[148:151], v[74:77]
    v_mfma_f32_16x16x32_bf16 v[78:81], v[120:123], v[124:127], v[78:81]
    buffer_load_dwordx4 a[212:215], v17, s[8:11], s12 offen offset:1024 sc0 sc1
    v_mfma_f32_16x16x32_bf16 v[78:81], v[104:107], v[148:151], v[78:81]
    v_mfma_f32_16x16x32_bf16 v[84:87], v[120:123], v[108:111], v[84:87]
    v_mfma_f32_16x16x32_bf16 v[84:87], v[112:115], v[148:151], v[84:87]
    s_mov_b32 s50, 0
    s_waitcnt vmcnt(8)
    v_cmp_ne_u64 vcc, s[42:43], v[82:83]
    s_nop 4
    s_cbranch_vccz Lfdone_gate_11
Lfpoll_gate_12:
    buffer_load_dwordx2 v[82:83], v182, s[8:11], 0 offen sc0 sc1
    s_waitcnt vmcnt(0)
    v_cmp_ne_u64 vcc, s[42:43], v[82:83]
    s_nop 4
    s_add_u32 s50, s50, 1
    s_cmp_gt_u32 s50, 20000
    s_cbranch_scc1 Lfdone_gate_11
    s_cbranch_vccnz Lfpoll_gate_12
Lfdone_gate_11:
    v_mfma_f32_16x16x32_bf16 v[88:91], v[120:123], v[148:151], v[88:91]
    s_bfe_u32 s17, s14, 0x40000
    s_waitcnt lgkmcnt(0)
    v_mfma_f32_16x16x32_bf16 v[78:81], v[128:131], v[140:143], v[78:81]
    ds_read2_b32 v[136:137], v64 offset0:144 offset1:145
    ds_read2_b32 v[138:139], v64 offset0:146 offset1:147
    v_mfma_f32_16x16x32_bf16 v[78:81], v[96:99], v[100:103], v[78:81]
    ds_read_b128 v[116:119], v60 offset:4352
    s_lshl_b32 s17, s17, 8
    v_mfma_f32_16x16x32_bf16 v[84:87], v[128:131], v[124:127], v[84:87]
    s_add_u32 s20, s16, s17
    s_add_u32 m0, s18, 32768
    v_mfma_f32_16x16x32_bf16 v[84:87], v[104:107], v[100:103], v[84:87]
    buffer_load_dwordx4 v7, s[8:11], s20 offen sc0 sc1 lds
    v_mfma_f32_16x16x32_bf16 v[88:91], v[128:131], v[108:111], v[88:91]
    buffer_load_dwordx4 a[216:219], v17, s[8:11], s12 offen offset:2048 sc0 sc1
    v_mfma_f32_16x16x32_bf16 v[88:91], v[112:115], v[100:103], v[88:91]
    s_add_u32 m0, s18, 33792
    s_nop 0
    buffer_load_dwordx4 v8, s[8:11], s20 offen sc0 sc1 lds
    v_mfma_f32_16x16x32_bf16 v[92:95], v[128:131], v[148:151], v[92:95]
    ds_read2_b32 v[144:145], v65 offset0:16 offset1:17
    ds_read2_b32 v[146:147], v65 offset0:18 offset1:19
    v_mfma_f32_16x16x32_bf16 v[92:95], v[120:123], v[100:103], v[92:95]
    ds_read_b128 v[132:135], v60 offset:2304
    s_waitcnt lgkmcnt(3)
    v_mfma_f32_16x16x32_bf16 v[84:87], v[136:139], v[140:143], v[84:87]
    buffer_load_dwordx4 a[220:223], v17, s[8:11], s12 offen offset:3072 sc0 sc1
    v_mfma_f32_16x16x32_bf16 v[84:87], v[96:99], v[116:119], v[84:87]
    s_add_u32 m0, s18, 34816
    s_nop 0
    buffer_load_dwordx4 v9, s[8:11], s20 offen sc0 sc1 lds
    v_mfma_f32_16x16x32_bf16 v[88:91], v[136:139], v[124:127], v[88:91]
    ds_read2_b32 v[128:129], v65 offset0:144 offset1:145
    ds_read2_b32 v[130:131], v65 offset0:146 offset1:147
    v_mfma_f32_16x16x32_bf16 v[88:91], v[104:107], v[116:119], v[88:91]
    ds_read_b128 v[148:151], v60 offset:256
    s_bfe_u32 s7, s15, 0x40014
    v_mfma_f32_16x16x32_bf16 v[92:95], v[136:139], v[108:111], v[92:95]
    ds_read2_b32 v[120:121], v57 offset0:0 offset1:1
    ds_read2_b32 v[122:123], v57 offset0:2 offset1:3
    v_mfma_f32_16x16x32_bf16 v[92:95], v[112:115], v[116:119], v[92:95]
    ds_read_b128 v[100:103], v61 offset:14336
    s_waitcnt lgkmcnt(6)
    v_mfma_f32_16x16x32_bf16 v[88:91], v[144:147], v[140:143], v[88:91]
    ds_read2_b32 v[136:137], v57 offset0:128 offset1:129
    ds_read2_b32 v[138:139], v57 offset0:130 offset1:131
    v_mfma_f32_16x16x32_bf16 v[88:91], v[96:99], v[132:135], v[88:91]
    ds_read_b128 v[108:111], v61 offset:12288
    s_lshl_b32 s7, s7, 12
    v_mfma_f32_16x16x32_bf16 v[92:95], v[144:147], v[124:127], v[92:95]
    ds_read2_b32 v[112:113], v63 offset0:0 offset1:1
    ds_read2_b32 v[114:115], v63 offset0:2 offset1:3
    v_mfma_f32_16x16x32_bf16 v[92:95], v[104:107], v[132:135], v[92:95]
    ds_read_b128 v[116:119], v61 offset:10240
    s_waitcnt lgkmcnt(6)
    v_mfma_f32_16x16x32_bf16 v[92:95], v[128:131], v[140:143], v[92:95]
    s_add_u32 s12, s6, s7
    buffer_load_dwordx4 a[224:227], v17, s[8:11], s12 offen offset:0 sc0 sc1
    v_mfma_f32_16x16x32_bf16 v[92:95], v[96:99], v[148:151], v[92:95]
    s_add_u32 m0, s18, 35840
    s_nop 0
    buffer_load_dwordx4 v10, s[8:11], s20 offen sc0 sc1 lds
    v_mfma_f32_16x16x32_bf16 v[46:49], v[120:123], v[100:103], v[46:49]
    buffer_load_dwordx4 a[228:231], v17, s[8:11], s12 offen offset:1024 sc0 sc1
    s_waitcnt lgkmcnt(1)
    v_mfma_f32_16x16x32_bf16 v[66:69], v[136:139], v[100:103], v[66:69]
    ds_read2_b32 v[144:145], v63 offset0:128 offset1:129
    ds_read2_b32 v[146:147], v63 offset0:130 offset1:131
    v_mfma_f32_16x16x32_bf16 v[66:69], v[120:123], v[108:111], v[66:69]
    ds_read_b128 v[124:127], v61 offset:8192
    s_add_u32 s21, s20, 65536
    v_mfma_f32_16x16x32_bf16 v[70:73], v[136:139], v[108:111], v[70:73]
    s_add_u32 m0, s18, 36864
    s_nop 0
    buffer_load_dwordx4 v7, s[8:11], s21 offen sc0 sc1 lds
    v_mfma_f32_16x16x32_bf16 v[70:73], v[112:115], v[100:103], v[70:73]
    buffer_load_dwordx4 a[232:235], v17, s[8:11], s12 offen offset:2048 sc0 sc1
    s_waitcnt lgkmcnt(3)
    v_mfma_f32_16x16x32_bf16 v[70:73], v[120:123], v[116:119], v[70:73]
    s_add_u32 m0, s18, 37888
    s_nop 0
    buffer_load_dwordx4 v8, s[8:11], s21 offen sc0 sc1 lds
    v_mfma_f32_16x16x32_bf16 v[74:77], v[112:115], v[108:111], v[74:77]
    buffer_load_dwordx4 a[236:239], v17, s[8:11], s12 offen offset:3072 sc0 sc1
    v_mfma_f32_16x16x32_bf16 v[74:77], v[136:139], v[116:119], v[74:77]
    v_mfma_f32_16x16x32_bf16 v[78:81], v[112:115], v[116:119], v[78:81]
    ds_read2_b32 v[104:105], v64 offset0:0 offset1:1
    s_waitcnt lgkmcnt(1)
    v_mfma_f32_16x16x32_bf16 v[74:77], v[144:147], v[100:103], v[74:77]
    ds_read2_b32 v[106:107], v64 offset0:2 offset1:3
    ds_read_b128 v[132:135], v61 offset:6144
    v_mfma_f32_16x16x32_bf16 v[74:77], v[120:123], v[124:127], v[74:77]
    s_add_u32 m0, s18, 38912
    s_nop 0
    buffer_load_dwordx4 v9, s[8:11], s21 offen sc0 sc1 lds
    v_mfma_f32_16x16x32_bf16 v[78:81], v[144:147], v[108:111], v[78:81]
    s_bfe_u32 s7, s15, 0x40018
    s_lshl_b32 s7, s7, 12
    v_mfma_f32_16x16x32_bf16 v[78:81], v[136:139], v[124:127], v[78:81]
    s_add_u32 s12, s6, s7
    buffer_load_dwordx4 a[240:243], v17, s[8:11], s12 offen offset:0 sc0 sc1
    v_mfma_f32_16x16x32_bf16 v[84:87], v[144:147], v[116:119], v[84:87]
    v_mfma_f32_16x16x32_bf16 v[84:87], v[112:115], v[124:127], v[84:87]
    s_add_u32 m0, s18, 39936
    s_nop 0
    buffer_load_dwordx4 v10, s[8:11], s21 offen sc0 sc1 lds
    v_mfma_f32_16x16x32_bf16 v[88:91], v[144:147], v[124:127], v[88:91]
    buffer_load_dwordx4 a[244:247], v17, s[8:11], s12 offen offset:1024 sc0 sc1
    s_waitcnt lgkmcnt(0)
    v_mfma_f32_16x16x32_bf16 v[78:81], v[104:107], v[100:103], v[78:81]
    ds_read2_b32 v[128:129], v64 offset0:128 offset1:129
    ds_read2_b32 v[130:131], v64 offset0:130 offset1:131
    v_mfma_f32_16x16x32_bf16 v[78:81], v[120:123], v[132:135], v[78:81]
    ds_read_b128 v[140:143], v61 offset:4096
    v_mfma_f32_16x16x32_bf16 v[84:87], v[104:107], v[108:111], v[84:87]
    v_mfma_f32_16x16x32_bf16 v[84:87], v[136:139], v[132:135], v[84:87]
    v_mfma_f32_16x16x32_bf16 v[88:91], v[104:107], v[116:119], v[88:91]
    buffer_load_dwordx4 a[248:251], v17, s[8:11], s12 offen offset:2048 sc0 sc1
    v_mfma_f32_16x16x32_bf16 v[88:91], v[112:115], v[132:135], v[88:91]
    v_mfma_f32_16x16x32_bf16 v[92:95], v[104:107], v[124:127], v[92:95]
    ds_read2_b32 v[96:97], v65 offset0:0 offset1:1
    ds_read2_b32 v[98:99], v65 offset0:2 offset1:3
    v_mfma_f32_16x16x32_bf16 v[92:95], v[144:147], v[132:135], v[92:95]
    ds_read_b128 v[148:151], v61 offset:2048
    s_waitcnt lgkmcnt(3)
    v_mfma_f32_16x16x32_bf16 v[84:87], v[128:131], v[100:103], v[84:87]
    v_mfma_f32_16x16x32_bf16 v[84:87], v[120:123], v[140:143], v[84:87]
    buffer_load_dwordx4 a[252:255], v17, s[8:11], s12 offen offset:3072 sc0 sc1
    v_mfma_f32_16x16x32_bf16 v[88:91], v[128:131], v[108:111], v[88:91]
    ds_read2_b32 v[104:105], v65 offset0:128 offset1:129
    ds_read2_b32 v[106:107], v65 offset0:130 offset1:131
    v_mfma_f32_16x16x32_bf16 v[88:91], v[136:139], v[140:143], v[88:91]
    ds_read_b128 v[124:127], v61 offset:0
    v_mfma_f32_16x16x32_bf16 v[92:95], v[128:131], v[116:119], v[92:95]
    v_mfma_f32_16x16x32_bf16 v[92:95], v[112:115], v[140:143], v[92:95]
    s_waitcnt lgkmcnt(3)
    v_mfma_f32_16x16x32_bf16 v[88:91], v[96:99], v[100:103], v[88:91]
    v_mfma_f32_16x16x32_bf16 v[88:91], v[120:123], v[148:151], v[88:91]
    v_mfma_f32_16x16x32_bf16 v[92:95], v[96:99], v[108:111], v[92:95]
    v_mfma_f32_16x16x32_bf16 v[92:95], v[136:139], v[148:151], v[92:95]
    s_waitcnt lgkmcnt(0)
    v_mfma_f32_16x16x32_bf16 v[92:95], v[104:107], v[100:103], v[92:95]
    v_mfma_f32_16x16x32_bf16 v[92:95], v[120:123], v[124:127], v[92:95]
    s_barrier
    ds_read_b128 v[96:99], v4 offset:0
    ds_read_b128 v[100:103], v4 offset:8192
    ds_read_b128 v[104:107], v18 offset:0
    ds_read_b128 v[108:111], v18 offset:8192
    s_bfe_u32 s17, s14, 0x40004
    s_lshl_b32 s17, s17, 8
    s_add_u32 s20, s16, s17
    s_add_u32 m0, s18, 65536
    s_waitcnt lgkmcnt(3)
    v_mfma_f32_32x32x16_bf16 v[128:143], v[96:99], a[0:3], 0
    ds_read_b128 v[112:115], v5 offset:0
    ds_read_b128 v[116:119], v5 offset:8192
    buffer_load_dwordx4 v7, s[8:11], s20 offen sc0 sc1 lds
    ds_read_b64 v[26:27], v62 offset:14336
    ds_read_b64 v[32:33], v62 offset:12288
    ds_read_b64 v[50:51], v62 offset:10240
    ds_read_b64 v[54:55], v62 offset:8192
    ds_read_b64 v[176:177], v62 offset:6144
    ds_read_b64 v[178:179], v62 offset:4096
    s_add_u32 m0, s18, 66560
    s_waitcnt lgkmcnt(10)
    v_mfma_f32_32x32x16_bf16 v[144:159], v[100:103], a[0:3], 0
    ds_read_b128 v[120:123], v19 offset:0
    ds_read_b128 v[124:127], v19 offset:8192
    buffer_load_dwordx4 v8, s[8:11], s20 offen sc0 sc1 lds
    ds_read_b64 v[200:201], v62 offset:2048
    ds_read_b64 v[202:203], v62 offset:0
    s_add_u32 s4, s22, 12582912
    s_waitcnt lgkmcnt(9)
    v_and_b32 v204, s5, v27
    v_lshlrev_b32 v205, 16, v27
    v_and_b32 v206, s5, v26
    s_add_u32 m0, s18, 67584
    v_mfma_f32_32x32x16_bf16 v[160:175], v[104:107], a[0:3], 0
    buffer_load_dwordx4 v9, s[8:11], s20 offen sc0 sc1 lds
    v_lshlrev_b32 v207, 16, v26
    v_fmac_f32 v46, v183, v204
    v_fmac_f32 v47, v183, v205
    v_fmac_f32 v48, v183, v206
    v_fmac_f32 v49, v183, v207
    v_cvt_pk_bf16_f32 v208, v46, v47
    v_cvt_pk_bf16_f32 v209, v48, v49
    s_waitcnt lgkmcnt(8)
    v_and_b32 v204, s5, v33
    s_add_u32 m0, s18, 68608
    v_mfma_f32_32x32x16_bf16 v[184:199], v[108:111], a[0:3], 0
    buffer_load_dwordx4 v10, s[8:11], s20 offen sc0 sc1 lds
    v_lshlrev_b32 v205, 16, v33
    v_and_b32 v206, s5, v32
    v_lshlrev_b32 v207, 16, v32
    v_fmac_f32 v66, v183, v204
    v_fmac_f32 v67, v183, v205
    v_fmac_f32 v68, v183, v206
    v_fmac_f32 v69, v183, v207
    v_cvt_pk_bf16_f32 v210, v66, v67
    v_cvt_pk_bf16_f32 v211, v68, v69
    s_add_u32 s21, s20, 65536
    s_add_u32 m0, s18, 69632
    v_mfma_f32_32x32x16_bf16 v[128:143], v[112:115], a[4:7], v[128:143]
    ds_read_b128 v[96:99], v11 offset:0
    ds_read_b128 v[100:103], v11 offset:8192
    buffer_load_dwordx4 v7, s[8:11], s21 offen sc0 sc1 lds
    v_permlane16_swap_b32 v208, v210
    v_permlane16_swap_b32 v209, v211
    s_waitcnt lgkmcnt(9)
    v_and_b32 v204, s5, v51
    v_lshlrev_b32 v205, 16, v51
    v_and_b32 v206, s5, v50
    v_lshlrev_b32 v207, 16, v50
    s_add_u32 m0, s18, 70656
    v_mfma_f32_32x32x16_bf16 v[144:159], v[116:119], a[4:7], v[144:159]
    ds_read_b128 v[104:107], v20 offset:0
    ds_read_b128 v[108:111], v20 offset:8192
    buffer_load_dwordx4 v8, s[8:11], s21 offen sc0 sc1 lds
    v_fmac_f32 v70, v183, v204
    v_fmac_f32 v71, v183, v205
    v_fmac_f32 v72, v183, v206
    v_fmac_f32 v73, v183, v207
    v_cvt_pk_bf16_f32 v212, v70, v71
    v_cvt_pk_bf16_f32 v213, v72, v73
    s_add_u32 m0, s18, 71680
    s_waitcnt lgkmcnt(7)
    v_mfma_f32_32x32x16_bf16 v[160:175], v[120:123], a[4:7], v[160:175]
    buffer_load_dwordx4 v9, s[8:11], s21 offen sc0 sc1 lds
    v_and_b32 v204, s5, v55
    v_lshlrev_b32 v205, 16, v55
    v_and_b32 v206, s5, v54
    v_lshlrev_b32 v207, 16, v54
    v_fmac_f32 v74, v183, v204
    v_fmac_f32 v75, v183, v205
    v_fmac_f32 v76, v183, v206
    v_fmac_f32 v77, v183, v207
    s_add_u32 m0, s18, 72704
    s_waitcnt lgkmcnt(6)
    v_mfma_f32_32x32x16_bf16 v[184:199], v[124:127], a[4:7], v[184:199]
    buffer_load_dwordx4 v10, s[8:11], s21 offen sc0 sc1 lds
    v_cvt_pk_bf16_f32 v214, v74, v75
    v_cvt_pk_bf16_f32 v215, v76, v77
    s_nop 0
    v_permlane16_swap_b32 v212, v214
    v_permlane16_swap_b32 v213, v215
    v_and_b32 v204, s5, v177
    v_lshlrev_b32 v205, 16, v177
    v_and_b32 v206, s5, v176
    v_lshlrev_b32 v207, 16, v176
    v_fmac_f32 v78, v183, v204
    s_bfe_u32 s17, s14, 0x40008
    s_lshl_b32 s17, s17, 8
    s_add_u32 s20, s16, s17
    s_add_u32 m0, s18, 98304
    s_waitcnt lgkmcnt(3)
    v_mfma_f32_32x32x16_bf16 v[128:143], v[96:99], a[8:11], v[128:143]
    ds_read_b128 v[112:115], v12 offset:0
    ds_read_b128 v[116:119], v12 offset:8192
    buffer_load_dwordx4 v7, s[8:11], s20 offen sc0 sc1 lds
    v_fmac_f32 v79, v183, v205
    v_fmac_f32 v80, v183, v206
    v_fmac_f32 v81, v183, v207
    v_cvt_pk_bf16_f32 v216, v78, v79
    v_cvt_pk_bf16_f32 v217, v80, v81
    v_and_b32 v204, s5, v179
    s_add_u32 m0, s18, 99328
    s_waitcnt lgkmcnt(4)
    v_mfma_f32_32x32x16_bf16 v[144:159], v[100:103], a[8:11], v[144:159]
    ds_read_b128 v[120:123], v21 offset:0
    ds_read_b128 v[124:127], v21 offset:8192
    buffer_load_dwordx4 v8, s[8:11], s20 offen sc0 sc1 lds
    v_lshlrev_b32 v205, 16, v179
    v_and_b32 v206, s5, v178
    v_lshlrev_b32 v207, 16, v178
    v_fmac_f32 v84, v183, v204
    v_fmac_f32 v85, v183, v205
    v_fmac_f32 v86, v183, v206
    s_add_u32 m0, s18, 100352
    s_waitcnt lgkmcnt(5)
    v_mfma_f32_32x32x16_bf16 v[160:175], v[104:107], a[8:11], v[160:175]
    buffer_load_dwordx4 v9, s[8:11], s20 offen sc0 sc1 lds
    v_fmac_f32 v87, v183, v207
    v_cvt_pk_bf16_f32 v218, v84, v85
    v_cvt_pk_bf16_f32 v219, v86, v87
    s_nop 0
    v_permlane16_swap_b32 v216, v218
    v_permlane16_swap_b32 v217, v219
    v_and_b32 v204, s5, v201
    v_lshlrev_b32 v205, 16, v201
    v_and_b32 v206, s5, v200
    s_add_u32 m0, s18, 101376
    s_waitcnt lgkmcnt(4)
    v_mfma_f32_32x32x16_bf16 v[184:199], v[108:111], a[8:11], v[184:199]
    buffer_load_dwordx4 v10, s[8:11], s20 offen sc0 sc1 lds
    v_lshlrev_b32 v207, 16, v200
    v_fmac_f32 v88, v183, v204
    v_fmac_f32 v89, v183, v205
    v_fmac_f32 v90, v183, v206
    v_fmac_f32 v91, v183, v207
    v_cvt_pk_bf16_f32 v220, v88, v89
    v_cvt_pk_bf16_f32 v221, v90, v91
    v_and_b32 v204, s5, v203
    v_lshlrev_b32 v205, 16, v203
    s_waitcnt lgkmcnt(0)
    s_waitcnt vmcnt(15)
    s_barrier
    s_add_u32 s21, s20, 65536
    s_add_u32 m0, s18, 102400
    v_mfma_f32_32x32x16_bf16 v[128:143], v[112:115], a[12:15], v[128:143]
    ds_read_b128 v[96:99], v4 offset:32768
    ds_read_b128 v[100:103], v4 offset:40960
    buffer_load_dwordx4 v7, s[8:11], s21 offen sc0 sc1 lds
    v_and_b32 v206, s5, v202
    v_lshlrev_b32 v207, 16, v202
    v_fmac_f32 v92, v183, v204
    v_fmac_f32 v93, v183, v205
    v_fmac_f32 v94, v183, v206
    v_fmac_f32 v95, v183, v207
    s_add_u32 m0, s18, 103424
    v_mfma_f32_32x32x16_bf16 v[144:159], v[116:119], a[12:15], v[144:159]
    ds_read_b128 v[104:107], v18 offset:32768
    ds_read_b128 v[108:111], v18 offset:40960
    buffer_load_dwordx4 v8, s[8:11], s21 offen sc0 sc1 lds
    v_cvt_pk_bf16_f32 v222, v92, v93
    v_cvt_pk_bf16_f32 v223, v94, v95
    s_nop 0
    v_permlane16_swap_b32 v220, v222
    v_permlane16_swap_b32 v221, v223
    s_add_u32 m0, s18, 104448
    v_mfma_f32_32x32x16_bf16 v[160:175], v[120:123], a[12:15], v[160:175]
    buffer_load_dwordx4 v9, s[8:11], s21 offen sc0 sc1 lds
    s_add_u32 m0, s18, 105472
    v_mfma_f32_32x32x16_bf16 v[184:199], v[124:127], a[12:15], v[184:199]
    buffer_load_dwordx4 v10, s[8:11], s21 offen sc0 sc1 lds
    s_waitcnt lgkmcnt(3)
    v_mfma_f32_32x32x16_bf16 v[128:143], v[96:99], a[16:19], v[128:143]
    ds_read_b128 v[112:115], v5 offset:32768
    ds_read_b128 v[116:119], v5 offset:40960
    buffer_store_dwordx4 v[208:211], v180, s[8:11], s4 offen offset:0 sc0 sc1
    buffer_store_dwordx4 v[212:215], v180, s[8:11], s4 offen offset:1024 sc0 sc1
    buffer_store_dwordx4 v[216:219], v180, s[8:11], s4 offen offset:2048 sc0 sc1
    s_waitcnt lgkmcnt(4)
    v_mfma_f32_32x32x16_bf16 v[144:159], v[100:103], a[16:19], v[144:159]
    ds_read_b128 v[120:123], v19 offset:32768
    ds_read_b128 v[124:127], v19 offset:40960
    s_bfe_u32 s17, s14, 0x4000c
    s_lshl_b32 s17, s17, 8
    s_add_u32 s20, s16, s17
    s_add_u32 m0, s18, 0
    s_waitcnt lgkmcnt(5)
    v_mfma_f32_32x32x16_bf16 v[160:175], v[104:107], a[16:19], v[160:175]
    buffer_load_dwordx4 v7, s[8:11], s20 offen sc0 sc1 lds
    buffer_store_dwordx4 v[220:223], v180, s[8:11], s4 offen offset:3072 sc0 sc1
    s_add_u32 m0, s18, 1024
    s_waitcnt lgkmcnt(4)
    v_mfma_f32_32x32x16_bf16 v[184:199], v[108:111], a[16:19], v[184:199]
    buffer_load_dwordx4 v8, s[8:11], s20 offen sc0 sc1 lds
    s_waitcnt lgkmcnt(3)
    v_mfma_f32_32x32x16_bf16 v[128:143], v[112:115], a[20:23], v[128:143]
    ds_read_b128 v[96:99], v11 offset:32768
    ds_read_b128 v[100:103], v11 offset:40960
    s_waitcnt lgkmcnt(4)
    v_mfma_f32_32x32x16_bf16 v[144:159], v[116:119], a[20:23], v[144:159]
    ds_read_b128 v[104:107], v20 offset:32768
    ds_read_b128 v[108:111], v20 offset:40960
    s_add_u32 m0, s18, 2048
    s_waitcnt lgkmcnt(5)
    v_mfma_f32_32x32x16_bf16 v[160:175], v[120:123], a[20:23], v[160:175]
    buffer_load_dwordx4 v9, s[8:11], s20 offen sc0 sc1 lds
    s_add_u32 m0, s18, 3072
    s_waitcnt lgkmcnt(4)
    v_mfma_f32_32x32x16_bf16 v[184:199], v[124:127], a[20:23], v[184:199]
    buffer_load_dwordx4 v10, s[8:11], s20 offen sc0 sc1 lds
    s_waitcnt lgkmcnt(3)
    v_mfma_f32_32x32x16_bf16 v[128:143], v[96:99], a[24:27], v[128:143]
    ds_read_b128 v[112:115], v12 offset:32768
    ds_read_b128 v[116:119], v12 offset:40960
    s_waitcnt lgkmcnt(4)
    v_mfma_f32_32x32x16_bf16 v[144:159], v[100:103], a[24:27], v[144:159]
    ds_read_b128 v[120:123], v21 offset:32768
    ds_read_b128 v[124:127], v21 offset:40960
    s_add_u32 s21, s20, 65536
    s_add_u32 m0, s18, 4096
    s_waitcnt lgkmcnt(5)
    v_mfma_f32_32x32x16_bf16 v[160:175], v[104:107], a[24:27], v[160:175]
    buffer_load_dwordx4 v7, s[8:11], s21 offen sc0 sc1 lds
    s_add_u32 m0, s18, 5120
    s_waitcnt lgkmcnt(4)
    v_mfma_f32_32x32x16_bf16 v[184:199], v[108:111], a[24:27], v[184:199]
    buffer_load_dwordx4 v8, s[8:11], s21 offen sc0 sc1 lds
    s_waitcnt lgkmcnt(0)
    s_waitcnt vmcnt(18)
    s_barrier
    v_mfma_f32_32x32x16_bf16 v[128:143], v[112:115], a[28:31], v[128:143]
    ds_read_b128 v[96:99], v13 offset:0
    ds_read_b128 v[100:103], v13 offset:8192
    v_mfma_f32_32x32x16_bf16 v[144:159], v[116:119], a[28:31], v[144:159]
    ds_read_b128 v[104:107], v22 offset:0
    ds_read_b128 v[108:111], v22 offset:8192
    s_add_u32 m0, s18, 6144
    v_mfma_f32_32x32x16_bf16 v[160:175], v[120:123], a[28:31], v[160:175]
    buffer_load_dwordx4 v9, s[8:11], s21 offen sc0 sc1 lds
    s_add_u32 m0, s18, 7168
    v_mfma_f32_32x32x16_bf16 v[184:199], v[124:127], a[28:31], v[184:199]
    buffer_load_dwordx4 v10, s[8:11], s21 offen sc0 sc1 lds
    s_waitcnt lgkmcnt(3)
    v_mfma_f32_32x32x16_bf16 v[128:143], v[96:99], a[32:35], v[128:143]
    ds_read_b128 v[112:115], v14 offset:0
    ds_read_b128 v[116:119], v14 offset:8192
    s_waitcnt lgkmcnt(4)
    v_mfma_f32_32x32x16_bf16 v[144:159], v[100:103], a[32:35], v[144:159]
    ds_read_b128 v[120:123], v23 offset:0
    ds_read_b128 v[124:127], v23 offset:8192
    s_bfe_u32 s17, s14, 0x40010
    s_lshl_b32 s17, s17, 8
    s_add_u32 s20, s16, s17
    s_add_u32 m0, s18, 32768
    s_waitcnt lgkmcnt(5)
    v_mfma_f32_32x32x16_bf16 v[160:175], v[104:107], a[32:35], v[160:175]
    buffer_load_dwordx4 v7, s[8:11], s20 offen sc0 sc1 lds
    s_add_u32 m0, s18, 33792
    s_waitcnt lgkmcnt(4)
    v_mfma_f32_32x32x16_bf16 v[184:199], v[108:111], a[32:35], v[184:199]
    buffer_load_dwordx4 v8, s[8:11], s20 offen sc0 sc1 lds
    s_waitcnt lgkmcnt(3)
    v_mfma_f32_32x32x16_bf16 v[128:143], v[112:115], a[36:39], v[128:143]
    ds_read_b128 v[96:99], v15 offset:0
    ds_read_b128 v[100:103], v15 offset:8192
    s_waitcnt lgkmcnt(4)
    v_mfma_f32_32x32x16_bf16 v[144:159], v[116:119], a[36:39], v[144:159]
    ds_read_b128 v[104:107], v24 offset:0
    ds_read_b128 v[108:111], v24 offset:8192
    s_add_u32 m0, s18, 34816
    s_waitcnt lgkmcnt(5)
    v_mfma_f32_32x32x16_bf16 v[160:175], v[120:123], a[36:39], v[160:175]
    buffer_load_dwordx4 v9, s[8:11], s20 offen sc0 sc1 lds
    s_add_u32 m0, s18, 35840
    s_waitcnt lgkmcnt(4)
    v_mfma_f32_32x32x16_bf16 v[184:199], v[124:127], a[36:39], v[184:199]
    buffer_load_dwordx4 v10, s[8:11], s20 offen sc0 sc1 lds
    s_waitcnt lgkmcnt(3)
    v_mfma_f32_32x32x16_bf16 v[128:143], v[96:99], a[40:43], v[128:143]
    ds_read_b128 v[112:115], v16 offset:0
    ds_read_b128 v[116:119], v16 offset:8192
    s_waitcnt lgkmcnt(4)
    v_mfma_f32_32x32x16_bf16 v[144:159], v[100:103], a[40:43], v[144:159]
    ds_read_b128 v[120:123], v25 offset:0
    ds_read_b128 v[124:127], v25 offset:8192
    s_add_u32 s21, s20, 65536
    s_add_u32 m0, s18, 36864
    s_waitcnt lgkmcnt(5)
    v_mfma_f32_32x32x16_bf16 v[160:175], v[104:107], a[40:43], v[160:175]
    buffer_load_dwordx4 v7, s[8:11], s21 offen sc0 sc1 lds
    s_add_u32 m0, s18, 37888
    s_waitcnt lgkmcnt(4)
    v_mfma_f32_32x32x16_bf16 v[184:199], v[108:111], a[40:43], v[184:199]
    buffer_load_dwordx4 v8, s[8:11], s21 offen sc0 sc1 lds
    s_waitcnt lgkmcnt(0)
    s_waitcnt vmcnt(18)
    s_barrier
    v_mfma_f32_32x32x16_bf16 v[128:143], v[112:115], a[44:47], v[128:143]
    ds_read_b128 v[96:99], v13 offset:32768
    ds_read_b128 v[100:103], v13 offset:40960
    v_mfma_f32_32x32x16_bf16 v[144:159], v[116:119], a[44:47], v[144:159]
    ds_read_b128 v[104:107], v22 offset:32768
    ds_read_b128 v[108:111], v22 offset:40960
    s_add_u32 m0, s18, 38912
    v_mfma_f32_32x32x16_bf16 v[160:175], v[120:123], a[44:47], v[160:175]
    buffer_load_dwordx4 v9, s[8:11], s21 offen sc0 sc1 lds
    s_add_u32 m0, s18, 39936
    v_mfma_f32_32x32x16_bf16 v[184:199], v[124:127], a[44:47], v[184:199]
    buffer_load_dwordx4 v10, s[8:11], s21 offen sc0 sc1 lds
    s_waitcnt lgkmcnt(3)
    v_mfma_f32_32x32x16_bf16 v[128:143], v[96:99], a[48:51], v[128:143]
    ds_read_b128 v[112:115], v14 offset:32768
    ds_read_b128 v[116:119], v14 offset:40960
    s_waitcnt lgkmcnt(4)
    v_mfma_f32_32x32x16_bf16 v[144:159], v[100:103], a[48:51], v[144:159]
    ds_read_b128 v[120:123], v23 offset:32768
    ds_read_b128 v[124:127], v23 offset:40960
    s_bfe_u32 s17, s14, 0x40014
    s_lshl_b32 s17, s17, 8
    s_add_u32 s20, s16, s17
    s_add_u32 m0, s18, 65536
    s_waitcnt lgkmcnt(5)
    v_mfma_f32_32x32x16_bf16 v[160:175], v[104:107], a[48:51], v[160:175]
    buffer_load_dwordx4 v7, s[8:11], s20 offen sc0 sc1 lds
    s_add_u32 m0, s18, 66560
    s_waitcnt lgkmcnt(4)
    v_mfma_f32_32x32x16_bf16 v[184:199], v[108:111], a[48:51], v[184:199]
    buffer_load_dwordx4 v8, s[8:11], s20 offen sc0 sc1 lds
    s_waitcnt lgkmcnt(3)
    v_mfma_f32_32x32x16_bf16 v[128:143], v[112:115], a[52:55], v[128:143]
    ds_read_b128 v[96:99], v15 offset:32768
    ds_read_b128 v[100:103], v15 offset:40960
    s_waitcnt lgkmcnt(4)
    v_mfma_f32_32x32x16_bf16 v[144:159], v[116:119], a[52:55], v[144:159]
    ds_read_b128 v[104:107], v24 offset:32768
    ds_read_b128 v[108:111], v24 offset:40960
    s_add_u32 m0, s18, 67584
    s_waitcnt lgkmcnt(5)
    v_mfma_f32_32x32x16_bf16 v[160:175], v[120:123], a[52:55], v[160:175]
    buffer_load_dwordx4 v9, s[8:11], s20 offen sc0 sc1 lds
    s_add_u32 m0, s18, 68608
    s_waitcnt lgkmcnt(4)
    v_mfma_f32_32x32x16_bf16 v[184:199], v[124:127], a[52:55], v[184:199]
    buffer_load_dwordx4 v10, s[8:11], s20 offen sc0 sc1 lds
    s_waitcnt lgkmcnt(3)
    v_mfma_f32_32x32x16_bf16 v[128:143], v[96:99], a[56:59], v[128:143]
    ds_read_b128 v[112:115], v16 offset:32768
    ds_read_b128 v[116:119], v16 offset:40960
    s_waitcnt lgkmcnt(4)
    v_mfma_f32_32x32x16_bf16 v[144:159], v[100:103], a[56:59], v[144:159]
    ds_read_b128 v[120:123], v25 offset:32768
    ds_read_b128 v[124:127], v25 offset:40960
    s_add_u32 s21, s20, 65536
    s_add_u32 m0, s18, 69632
    s_waitcnt lgkmcnt(5)
    v_mfma_f32_32x32x16_bf16 v[160:175], v[104:107], a[56:59], v[160:175]
    buffer_load_dwordx4 v7, s[8:11], s21 offen sc0 sc1 lds
    s_add_u32 m0, s18, 70656
    s_waitcnt lgkmcnt(4)
    v_mfma_f32_32x32x16_bf16 v[184:199], v[108:111], a[56:59], v[184:199]
    buffer_load_dwordx4 v8, s[8:11], s21 offen sc0 sc1 lds
    s_waitcnt lgkmcnt(0)
    s_waitcnt vmcnt(14)
    s_barrier
    v_mfma_f32_32x32x16_bf16 v[128:143], v[112:115], a[60:63], v[128:143]
    ds_read_b128 v[96:99], v4 offset:0
    ds_read_b128 v[100:103], v4 offset:8192
    v_mfma_f32_32x32x16_bf16 v[144:159], v[116:119], a[60:63], v[144:159]
    ds_read_b128 v[104:107], v18 offset:0
    ds_read_b128 v[108:111], v18 offset:8192
    s_add_u32 m0, s18, 71680
    v_mfma_f32_32x32x16_bf16 v[160:175], v[120:123], a[60:63], v[160:175]
    buffer_load_dwordx4 v9, s[8:11], s21 offen sc0 sc1 lds
    s_add_u32 m0, s18, 72704
    v_mfma_f32_32x32x16_bf16 v[184:199], v[124:127], a[60:63], v[184:199]
    buffer_load_dwordx4 v10, s[8:11], s21 offen sc0 sc1 lds
    s_waitcnt lgkmcnt(3)
    v_mfma_f32_32x32x16_bf16 v[128:143], v[96:99], a[64:67], v[128:143]
    ds_read_b128 v[112:115], v5 offset:0
    ds_read_b128 v[116:119], v5 offset:8192
    v_mov_b32 v82, s42
    v_mov_b32 v83, s43
    s_mov_b64 s[22:23], exec
    s_mov_b64 exec, 1
    buffer_store_dwordx2 v[82:83], v6, s[8:11], s13 offen sc0 sc1
    s_mov_b64 exec, s[22:23]
    s_waitcnt lgkmcnt(4)
    v_mfma_f32_32x32x16_bf16 v[144:159], v[100:103], a[64:67], v[144:159]
    ds_read_b128 v[120:123], v19 offset:0
    ds_read_b128 v[124:127], v19 offset:8192
    s_bfe_u32 s17, s14, 0x40018
    s_lshl_b32 s17, s17, 8
    s_add_u32 s20, s16, s17
    s_add_u32 m0, s18, 98304
    s_waitcnt lgkmcnt(5)
    v_mfma_f32_32x32x16_bf16 v[160:175], v[104:107], a[64:67], v[160:175]
    buffer_load_dwordx4 v7, s[8:11], s20 offen sc0 sc1 lds
    s_add_u32 m0, s18, 99328
    s_waitcnt lgkmcnt(4)
    v_mfma_f32_32x32x16_bf16 v[184:199], v[108:111], a[64:67], v[184:199]
    buffer_load_dwordx4 v8, s[8:11], s20 offen sc0 sc1 lds
    s_waitcnt lgkmcnt(3)
    v_mfma_f32_32x32x16_bf16 v[128:143], v[112:115], a[68:71], v[128:143]
    ds_read_b128 v[96:99], v11 offset:0
    ds_read_b128 v[100:103], v11 offset:8192
    s_waitcnt lgkmcnt(4)
    v_mfma_f32_32x32x16_bf16 v[144:159], v[116:119], a[68:71], v[144:159]
    ds_read_b128 v[104:107], v20 offset:0
    ds_read_b128 v[108:111], v20 offset:8192
    s_add_u32 m0, s18, 100352
    s_waitcnt lgkmcnt(5)
    v_mfma_f32_32x32x16_bf16 v[160:175], v[120:123], a[68:71], v[160:175]
    buffer_load_dwordx4 v9, s[8:11], s20 offen sc0 sc1 lds
    s_add_u32 m0, s18, 101376
    s_waitcnt lgkmcnt(4)
    v_mfma_f32_32x32x16_bf16 v[184:199], v[124:127], a[68:71], v[184:199]
    buffer_load_dwordx4 v10, s[8:11], s20 offen sc0 sc1 lds
    s_waitcnt lgkmcnt(3)
    v_mfma_f32_32x32x16_bf16 v[128:143], v[96:99], a[72:75], v[128:143]
    ds_read_b128 v[112:115], v12 offset:0
    ds_read_b128 v[116:119], v12 offset:8192
    s_waitcnt lgkmcnt(4)
    v_mfma_f32_32x32x16_bf16 v[144:159], v[100:103], a[72:75], v[144:159]
    ds_read_b128 v[120:123], v21 offset:0
    ds_read_b128 v[124:127], v21 offset:8192
    s_add_u32 s21, s20, 65536
    s_add_u32 m0, s18, 102400
    s_waitcnt lgkmcnt(5)
    v_mfma_f32_32x32x16_bf16 v[160:175], v[104:107], a[72:75], v[160:175]
    buffer_load_dwordx4 v7, s[8:11], s21 offen sc0 sc1 lds
    s_add_u32 m0, s18, 103424
    s_waitcnt lgkmcnt(4)
    v_mfma_f32_32x32x16_bf16 v[184:199], v[108:111], a[72:75], v[184:199]
    buffer_load_dwordx4 v8, s[8:11], s21 offen sc0 sc1 lds
    s_waitcnt lgkmcnt(0)
    s_waitcnt vmcnt(15)
    s_barrier
    v_mfma_f32_32x32x16_bf16 v[128:143], v[112:115], a[76:79], v[128:143]
    ds_read_b128 v[96:99], v4 offset:32768
    ds_read_b128 v[100:103], v4 offset:40960
    v_mfma_f32_32x32x16_bf16 v[144:159], v[116:119], a[76:79], v[144:159]
    ds_read_b128 v[104:107], v18 offset:32768
    ds_read_b128 v[108:111], v18 offset:40960
    s_add_u32 m0, s18, 104448
    v_mfma_f32_32x32x16_bf16 v[160:175], v[120:123], a[76:79], v[160:175]
    buffer_load_dwordx4 v9, s[8:11], s21 offen sc0 sc1 lds
    s_add_u32 m0, s18, 105472
    v_mfma_f32_32x32x16_bf16 v[184:199], v[124:127], a[76:79], v[184:199]
    buffer_load_dwordx4 v10, s[8:11], s21 offen sc0 sc1 lds
    s_waitcnt lgkmcnt(3)
    v_mfma_f32_32x32x16_bf16 v[128:143], v[96:99], a[80:83], v[128:143]
    ds_read_b128 v[112:115], v5 offset:32768
    ds_read_b128 v[116:119], v5 offset:40960
    s_add_u32 m0, s47, 131072
    s_nop 0
    buffer_load_dwordx4 v35, s[56:59], s31 offen lds
    s_add_u32 s31, s31, 16384
    s_add_u32 m0, s47, 132096
    s_nop 0
    buffer_load_dwordx4 v35, s[56:59], s31 offen lds
    s_waitcnt lgkmcnt(4)
    v_mfma_f32_32x32x16_bf16 v[144:159], v[100:103], a[80:83], v[144:159]
    ds_read_b128 v[120:123], v19 offset:32768
    ds_read_b128 v[124:127], v19 offset:40960
    s_bfe_u32 s17, s14, 0x4001c
    s_lshl_b32 s17, s17, 8
    s_add_u32 s20, s16, s17
    s_add_u32 m0, s18, 0
    s_waitcnt lgkmcnt(5)
    v_mfma_f32_32x32x16_bf16 v[160:175], v[104:107], a[80:83], v[160:175]
    buffer_load_dwordx4 v7, s[8:11], s20 offen sc0 sc1 lds
    s_add_u32 s31, s31, 16384
    s_add_u32 m0, s47, 133120
    s_nop 0
    buffer_load_dwordx4 v35, s[56:59], s31 offen lds
    s_add_u32 s31, s31, 16384
    s_add_u32 m0, s18, 1024
    s_waitcnt lgkmcnt(4)
    v_mfma_f32_32x32x16_bf16 v[184:199], v[108:111], a[80:83], v[184:199]
    buffer_load_dwordx4 v8, s[8:11], s20 offen sc0 sc1 lds
    s_add_u32 m0, s47, 134144
    s_nop 0
    buffer_load_dwordx4 v35, s[56:59], s31 offen lds
    s_lshr_b32 s3, s47, 2
    s_add_u32 m0, s3, 147456
    s_nop 0
    buffer_load_dwordx4 v38, s[8:11], 0 offen sc0 sc1 lds
    s_waitcnt lgkmcnt(3)
    v_mfma_f32_32x32x16_bf16 v[128:143], v[112:115], a[84:87], v[128:143]
    ds_read_b128 v[96:99], v11 offset:32768
    ds_read_b128 v[100:103], v11 offset:40960
    s_waitcnt lgkmcnt(4)
    v_mfma_f32_32x32x16_bf16 v[144:159], v[116:119], a[84:87], v[144:159]
    ds_read_b128 v[104:107], v20 offset:32768
    ds_read_b128 v[108:111], v20 offset:40960
    s_add_u32 m0, s18, 2048
    s_waitcnt lgkmcnt(5)
    v_mfma_f32_32x32x16_bf16 v[160:175], v[120:123], a[84:87], v[160:175]
    buffer_load_dwordx4 v9, s[8:11], s20 offen sc0 sc1 lds
    s_add_u32 m0, s18, 3072
    s_waitcnt lgkmcnt(4)
    v_mfma_f32_32x32x16_bf16 v[184:199], v[124:127], a[84:87], v[184:199]
    buffer_load_dwordx4 v10, s[8:11], s20 offen sc0 sc1 lds
    s_waitcnt lgkmcnt(3)
    v_mfma_f32_32x32x16_bf16 v[128:143], v[96:99], a[88:91], v[128:143]
    ds_read_b128 v[112:115], v12 offset:32768
    ds_read_b128 v[116:119], v12 offset:40960
    s_waitcnt lgkmcnt(4)
    v_mfma_f32_32x32x16_bf16 v[144:159], v[100:103], a[88:91], v[144:159]
    ds_read_b128 v[120:123], v21 offset:32768
    ds_read_b128 v[124:127], v21 offset:40960
    s_add_u32 s21, s20, 65536
    s_add_u32 m0, s18, 4096
    s_waitcnt lgkmcnt(5)
    v_mfma_f32_32x32x16_bf16 v[160:175], v[104:107], a[88:91], v[160:175]
    buffer_load_dwordx4 v7, s[8:11], s21 offen sc0 sc1 lds
    s_add_u32 m0, s18, 5120
    s_waitcnt lgkmcnt(4)
    v_mfma_f32_32x32x16_bf16 v[184:199], v[108:111], a[88:91], v[184:199]
    buffer_load_dwordx4 v8, s[8:11], s21 offen sc0 sc1 lds
    s_waitcnt lgkmcnt(0)
    s_waitcnt vmcnt(20)
    s_barrier
    v_mfma_f32_32x32x16_bf16 v[128:143], v[112:115], a[92:95], v[128:143]
    ds_read_b128 v[96:99], v13 offset:0
    ds_read_b128 v[100:103], v13 offset:8192
    v_mfma_f32_32x32x16_bf16 v[144:159], v[116:119], a[92:95], v[144:159]
    ds_read_b128 v[104:107], v22 offset:0
    ds_read_b128 v[108:111], v22 offset:8192
    s_add_u32 m0, s18, 6144
    v_mfma_f32_32x32x16_bf16 v[160:175], v[120:123], a[92:95], v[160:175]
    buffer_load_dwordx4 v9, s[8:11], s21 offen sc0 sc1 lds
    s_add_u32 m0, s18, 7168
    v_mfma_f32_32x32x16_bf16 v[184:199], v[124:127], a[92:95], v[184:199]
    buffer_load_dwordx4 v10, s[8:11], s21 offen sc0 sc1 lds
    s_waitcnt lgkmcnt(3)
    v_mfma_f32_32x32x16_bf16 v[128:143], v[96:99], a[96:99], v[128:143]
    ds_read_b128 v[112:115], v14 offset:0
    ds_read_b128 v[116:119], v14 offset:8192
    s_waitcnt lgkmcnt(4)
    v_mfma_f32_32x32x16_bf16 v[144:159], v[100:103], a[96:99], v[144:159]
    ds_read_b128 v[120:123], v23 offset:0
    ds_read_b128 v[124:127], v23 offset:8192
    s_bfe_u32 s17, s15, 0x40000
    s_lshl_b32 s17, s17, 8
    s_add_u32 s20, s16, s17
    s_add_u32 m0, s18, 32768
    s_waitcnt lgkmcnt(5)
    v_mfma_f32_32x32x16_bf16 v[160:175], v[104:107], a[96:99], v[160:175]
    buffer_load_dwordx4 v7, s[8:11], s20 offen sc0 sc1 lds
    s_add_u32 m0, s18, 33792
    s_waitcnt lgkmcnt(4)
    v_mfma_f32_32x32x16_bf16 v[184:199], v[108:111], a[96:99], v[184:199]
    buffer_load_dwordx4 v8, s[8:11], s20 offen sc0 sc1 lds
    s_waitcnt lgkmcnt(3)
    v_mfma_f32_32x32x16_bf16 v[128:143], v[112:115], a[100:103], v[128:143]
    ds_read_b128 v[96:99], v15 offset:0
    ds_read_b128 v[100:103], v15 offset:8192
    s_waitcnt lgkmcnt(4)
    v_mfma_f32_32x32x16_bf16 v[144:159], v[116:119], a[100:103], v[144:159]
    ds_read_b128 v[104:107], v24 offset:0
    ds_read_b128 v[108:111], v24 offset:8192
    s_add_u32 m0, s18, 34816
    s_waitcnt lgkmcnt(5)
    v_mfma_f32_32x32x16_bf16 v[160:175], v[120:123], a[100:103], v[160:175]
    buffer_load_dwordx4 v9, s[8:11], s20 offen sc0 sc1 lds
    s_add_u32 m0, s18, 35840
    s_waitcnt lgkmcnt(4)
    v_mfma_f32_32x32x16_bf16 v[184:199], v[124:127], a[100:103], v[184:199]
    buffer_load_dwordx4 v10, s[8:11], s20 offen sc0 sc1 lds
    s_waitcnt lgkmcnt(3)
    v_mfma_f32_32x32x16_bf16 v[128:143], v[96:99], a[104:107], v[128:143]
    ds_read_b128 v[112:115], v16 offset:0
    ds_read_b128 v[116:119], v16 offset:8192
    s_waitcnt lgkmcnt(4)
    v_mfma_f32_32x32x16_bf16 v[144:159], v[100:103], a[104:107], v[144:159]
    ds_read_b128 v[120:123], v25 offset:0
    ds_read_b128 v[124:127], v25 offset:8192
    s_add_u32 s21, s20, 65536
    s_add_u32 m0, s18, 36864
    s_waitcnt lgkmcnt(5)
    v_mfma_f32_32x32x16_bf16 v[160:175], v[104:107], a[104:107], v[160:175]
    buffer_load_dwordx4 v7, s[8:11], s21 offen sc0 sc1 lds
    s_add_u32 m0, s18, 37888
    s_waitcnt lgkmcnt(4)
    v_mfma_f32_32x32x16_bf16 v[184:199], v[108:111], a[104:107], v[184:199]
    buffer_load_dwordx4 v8, s[8:11], s21 offen sc0 sc1 lds
    s_waitcnt lgkmcnt(0)
    s_waitcnt vmcnt(19)
    s_barrier
    v_mfma_f32_32x32x16_bf16 v[128:143], v[112:115], a[108:111], v[128:143]
    ds_read_b128 v[96:99], v13 offset:32768
    ds_read_b128 v[100:103], v13 offset:40960
    v_mfma_f32_32x32x16_bf16 v[144:159], v[116:119], a[108:111], v[144:159]
    ds_read_b128 v[104:107], v22 offset:32768
    ds_read_b128 v[108:111], v22 offset:40960
    s_add_u32 m0, s18, 38912
    v_mfma_f32_32x32x16_bf16 v[160:175], v[120:123], a[108:111], v[160:175]
    buffer_load_dwordx4 v9, s[8:11], s21 offen sc0 sc1 lds
    s_add_u32 m0, s18, 39936
    v_mfma_f32_32x32x16_bf16 v[184:199], v[124:127], a[108:111], v[184:199]
    buffer_load_dwordx4 v10, s[8:11], s21 offen sc0 sc1 lds
    s_waitcnt lgkmcnt(3)
    v_mfma_f32_32x32x16_bf16 v[128:143], v[96:99], a[112:115], v[128:143]
    ds_read_b128 v[112:115], v14 offset:32768
    ds_read_b128 v[116:119], v14 offset:40960
    s_waitcnt vmcnt(14)
    ds_read_b128 v[46:49], v39 offset:0
    ds_read_b128 v[84:87], v39 offset:256
    s_waitcnt lgkmcnt(6)
    v_mfma_f32_32x32x16_bf16 v[144:159], v[100:103], a[112:115], v[144:159]
    ds_read_b128 v[120:123], v23 offset:32768
    ds_read_b128 v[124:127], v23 offset:40960
    s_bfe_u32 s17, s15, 0x40004
    s_lshl_b32 s17, s17, 8
    s_add_u32 s20, s16, s17
    s_add_u32 m0, s18, 65536
    s_waitcnt lgkmcnt(7)
    v_mfma_f32_32x32x16_bf16 v[160:175], v[104:107], a[112:115], v[160:175]
    buffer_load_dwordx4 v7, s[8:11], s20 offen sc0 sc1 lds
    ds_read_b128 v[54:57], v39 offset:32
    ds_read_b128 v[88:91], v39 offset:288
    ds_read_b128 v[58:61], v39 offset:64
    s_add_u32 m0, s18, 66560
    s_waitcnt lgkmcnt(9)
    v_mfma_f32_32x32x16_bf16 v[184:199], v[108:111], a[112:115], v[184:199]
    buffer_load_dwordx4 v8, s[8:11], s20 offen sc0 sc1 lds
    ds_read_b128 v[92:95], v39 offset:320
    ds_read_b128 v[62:65], v39 offset:96
    ds_read_b128 v[176:179], v39 offset:352
    ds_read_b128 v[66:69], v39 offset:128
    s_waitcnt lgkmcnt(12)
    v_mfma_f32_32x32x16_bf16 v[128:143], v[112:115], a[116:119], v[128:143]
    ds_read_b128 v[96:99], v15 offset:32768
    ds_read_b128 v[100:103], v15 offset:40960
    ds_read_b128 v[200:203], v39 offset:384
    ds_read_b128 v[70:73], v39 offset:160
    ds_read_b128 v[204:207], v39 offset:416
    s_waitcnt lgkmcnt(15)
    v_mfma_f32_32x32x16_bf16 v[144:159], v[116:119], a[116:119], v[144:159]
    ds_read_b128 v[104:107], v24 offset:32768
    ds_read_b128 v[108:111], v24 offset:40960
    ds_read_b128 v[74:77], v39 offset:192
    ds_read_b128 v[208:211], v39 offset:448
    s_add_u32 m0, s18, 67584
    s_waitcnt lgkmcnt(15)
    v_mfma_f32_32x32x16_bf16 v[160:175], v[120:123], a[116:119], v[160:175]
    buffer_load_dwordx4 v9, s[8:11], s20 offen sc0 sc1 lds
    ds_read_b128 v[78:81], v39 offset:224
    ds_read_b128 v[212:215], v39 offset:480
    buffer_load_dwordx2 v[30:31], v29, s[8:11], 0 offen sc0 sc1
    s_add_u32 m0, s18, 68608
    v_mfma_f32_32x32x16_bf16 v[184:199], v[124:127], a[116:119], v[184:199]
    buffer_load_dwordx4 v10, s[8:11], s20 offen sc0 sc1 lds
    s_waitcnt lgkmcnt(10)
    v_mfma_f32_32x32x16_bf16 v[128:143], v[96:99], a[120:123], v[128:143]
    ds_read_b128 v[112:115], v16 offset:32768
    ds_read_b128 v[116:119], v16 offset:40960
    s_waitcnt lgkmcnt(11)
    v_mfma_f32_32x32x16_bf16 v[144:159], v[100:103], a[120:123], v[144:159]
    ds_read_b128 v[120:123], v25 offset:32768
    ds_read_b128 v[124:127], v25 offset:40960
    s_add_u32 s21, s20, 65536
    s_add_u32 m0, s18, 69632
    s_waitcnt lgkmcnt(9)
    v_mfma_f32_32x32x16_bf16 v[160:175], v[104:107], a[120:123], v[160:175]
    buffer_load_dwordx4 v7, s[8:11], s21 offen sc0 sc1 lds
    s_add_u32 m0, s18, 70656
    s_waitcnt lgkmcnt(8)
    v_mfma_f32_32x32x16_bf16 v[184:199], v[108:111], a[120:123], v[184:199]
    buffer_load_dwordx4 v8, s[8:11], s21 offen sc0 sc1 lds
    s_waitcnt lgkmcnt(0)
    s_waitcnt vmcnt(15)
    s_barrier
    v_mfma_f32_32x32x16_bf16 v[128:143], v[112:115], a[124:127], v[128:143]
    ds_read_b128 v[96:99], v4 offset:0
    ds_read_b128 v[100:103], v4 offset:8192
    v_mfma_f32_32x32x16_bf16 v[144:159], v[116:119], a[124:127], v[144:159]
    ds_read_b128 v[104:107], v18 offset:0
    ds_read_b128 v[108:111], v18 offset:8192
    s_add_u32 m0, s18, 71680
    v_mfma_f32_32x32x16_bf16 v[160:175], v[120:123], a[124:127], v[160:175]
    buffer_load_dwordx4 v9, s[8:11], s21 offen sc0 sc1 lds
    s_add_u32 m0, s18, 72704
    v_mfma_f32_32x32x16_bf16 v[184:199], v[124:127], a[124:127], v[184:199]
    buffer_load_dwordx4 v10, s[8:11], s21 offen sc0 sc1 lds
    s_waitcnt lgkmcnt(3)
    v_mfma_f32_32x32x16_bf16 v[128:143], v[96:99], a[128:131], v[128:143]
    ds_read_b128 v[112:115], v5 offset:0
    ds_read_b128 v[116:119], v5 offset:8192
    s_waitcnt lgkmcnt(4)
    v_mfma_f32_32x32x16_bf16 v[144:159], v[100:103], a[128:131], v[144:159]
    ds_read_b128 v[120:123], v19 offset:0
    ds_read_b128 v[124:127], v19 offset:8192
    s_bfe_u32 s17, s15, 0x40008
    s_lshl_b32 s17, s17, 8
    s_add_u32 s20, s16, s17
    s_add_u32 m0, s18, 98304
    s_waitcnt lgkmcnt(5)
    v_mfma_f32_32x32x16_bf16 v[160:175], v[104:107], a[128:131], v[160:175]
    buffer_load_dwordx4 v7, s[8:11], s20 offen sc0 sc1 lds
    s_add_u32 m0, s18, 99328
    s_waitcnt lgkmcnt(4)
    v_mfma_f32_32x32x16_bf16 v[184:199], v[108:111], a[128:131], v[184:199]
    buffer_load_dwordx4 v8, s[8:11], s20 offen sc0 sc1 lds
    s_waitcnt lgkmcnt(3)
    v_mfma_f32_32x32x16_bf16 v[128:143], v[112:115], a[132:135], v[128:143]
    ds_read_b128 v[96:99], v11 offset:0
    ds_read_b128 v[100:103], v11 offset:8192
    s_waitcnt lgkmcnt(4)
    v_mfma_f32_32x32x16_bf16 v[144:159], v[116:119], a[132:135], v[144:159]
    ds_read_b128 v[104:107], v20 offset:0
    ds_read_b128 v[108:111], v20 offset:8192
    s_add_u32 m0, s18, 100352
    s_waitcnt lgkmcnt(5)
    v_mfma_f32_32x32x16_bf16 v[160:175], v[120:123], a[132:135], v[160:175]
    buffer_load_dwordx4 v9, s[8:11], s20 offen sc0 sc1 lds
    s_add_u32 m0, s18, 101376
    s_waitcnt lgkmcnt(4)
    v_mfma_f32_32x32x16_bf16 v[184:199], v[124:127], a[132:135], v[184:199]
    buffer_load_dwordx4 v10, s[8:11], s20 offen sc0 sc1 lds
    s_waitcnt lgkmcnt(3)
    v_mfma_f32_32x32x16_bf16 v[128:143], v[96:99], a[136:139], v[128:143]
    ds_read_b128 v[112:115], v12 offset:0
    ds_read_b128 v[116:119], v12 offset:8192
    s_waitcnt lgkmcnt(4)
    v_mfma_f32_32x32x16_bf16 v[144:159], v[100:103], a[136:139], v[144:159]
    ds_read_b128 v[120:123], v21 offset:0
    ds_read_b128 v[124:127], v21 offset:8192
    s_add_u32 s21, s20, 65536
    s_add_u32 m0, s18, 102400
    s_waitcnt lgkmcnt(5)
    v_mfma_f32_32x32x16_bf16 v[160:175], v[104:107], a[136:139], v[160:175]
    buffer_load_dwordx4 v7, s[8:11], s21 offen sc0 sc1 lds
    s_add_u32 m0, s18, 103424
    s_waitcnt lgkmcnt(4)
    v_mfma_f32_32x32x16_bf16 v[184:199], v[108:111], a[136:139], v[184:199]
    buffer_load_dwordx4 v8, s[8:11], s21 offen sc0 sc1 lds
    s_waitcnt lgkmcnt(0)
    s_waitcnt vmcnt(15)
    s_barrier
    v_mfma_f32_32x32x16_bf16 v[128:143], v[112:115], a[140:143], v[128:143]
    ds_read_b128 v[96:99], v4 offset:32768
    ds_read_b128 v[100:103], v4 offset:40960
    v_mfma_f32_32x32x16_bf16 v[144:159], v[116:119], a[140:143], v[144:159]
    ds_read_b128 v[104:107], v18 offset:32768
    ds_read_b128 v[108:111], v18 offset:40960
    s_add_u32 m0, s18, 104448
    v_mfma_f32_32x32x16_bf16 v[160:175], v[120:123], a[140:143], v[160:175]
    buffer_load_dwordx4 v9, s[8:11], s21 offen sc0 sc1 lds
    s_add_u32 m0, s18, 105472
    v_mfma_f32_32x32x16_bf16 v[184:199], v[124:127], a[140:143], v[184:199]
    buffer_load_dwordx4 v10, s[8:11], s21 offen sc0 sc1 lds
    s_waitcnt lgkmcnt(3)
    v_mfma_f32_32x32x16_bf16 v[128:143], v[96:99], a[144:147], v[128:143]
    ds_read_b128 v[112:115], v5 offset:32768
    ds_read_b128 v[116:119], v5 offset:40960
    s_mov_b32 s4, 0
    s_waitcnt vmcnt(13)
    v_cmp_ne_u64 vcc, s[42:43], v[30:31]
    s_nop 4
    s_cbranch_vccz Lfdone_gate_13
Lfpoll_gate_14:
    buffer_load_dwordx2 v[30:31], v29, s[8:11], 0 offen sc0 sc1
    s_waitcnt vmcnt(0)
    v_cmp_ne_u64 vcc, s[42:43], v[30:31]
    s_nop 4
    s_add_u32 s4, s4, 1
    s_cmp_gt_u32 s4, 20000
    s_cbranch_scc1 Lfdone_gate_13
    s_cbranch_vccnz Lfpoll_gate_14
Lfdone_gate_13:
    s_add_u32 m0, s47, 147456
    s_nop 0
    buffer_load_dwordx4 v7, s[8:11], s38 offen sc0 sc1 lds
    s_add_u32 m0, s47, 148480
    s_nop 0
    buffer_load_dwordx4 v8, s[8:11], s38 offen sc0 sc1 lds
    s_waitcnt lgkmcnt(4)
    v_mfma_f32_32x32x16_bf16 v[144:159], v[100:103], a[144:147], v[144:159]
    ds_read_b128 v[120:123], v19 offset:32768
    ds_read_b128 v[124:127], v19 offset:40960
    s_bfe_u32 s17, s15, 0x4000c
    s_lshl_b32 s17, s17, 8
    s_add_u32 s20, s16, s17
    s_add_u32 m0, s18, 0
    s_waitcnt lgkmcnt(5)
    v_mfma_f32_32x32x16_bf16 v[160:175], v[104:107], a[144:147], v[160:175]
    buffer_load_dwordx4 v7, s[8:11], s20 offen sc0 sc1 lds
    s_add_u32 m0, s47, 149504
    s_nop 0
    buffer_load_dwordx4 v9, s[8:11], s38 offen sc0 sc1 lds
    s_add_u32 m0, s47, 150528
    s_nop 0
    buffer_load_dwordx4 v10, s[8:11], s38 offen sc0 sc1 lds
    s_add_u32 m0, s18, 1024
    s_waitcnt lgkmcnt(4)
    v_mfma_f32_32x32x16_bf16 v[184:199], v[108:111], a[144:147], v[184:199]
    buffer_load_dwordx4 v8, s[8:11], s20 offen sc0 sc1 lds
    s_waitcnt lgkmcnt(3)
    v_mfma_f32_32x32x16_bf16 v[128:143], v[112:115], a[148:151], v[128:143]
    ds_read_b128 v[96:99], v11 offset:32768
    ds_read_b128 v[100:103], v11 offset:40960
    s_waitcnt lgkmcnt(4)
    v_mfma_f32_32x32x16_bf16 v[144:159], v[116:119], a[148:151], v[144:159]
    ds_read_b128 v[104:107], v20 offset:32768
    ds_read_b128 v[108:111], v20 offset:40960
    s_add_u32 m0, s18, 2048
    s_waitcnt lgkmcnt(5)
    v_mfma_f32_32x32x16_bf16 v[160:175], v[120:123], a[148:151], v[160:175]
    buffer_load_dwordx4 v9, s[8:11], s20 offen sc0 sc1 lds
    s_add_u32 m0, s18, 3072
    s_waitcnt lgkmcnt(4)
    v_mfma_f32_32x32x16_bf16 v[184:199], v[124:127], a[148:151], v[184:199]
    buffer_load_dwordx4 v10, s[8:11], s20 offen sc0 sc1 lds
    s_waitcnt lgkmcnt(3)
    v_mfma_f32_32x32x16_bf16 v[128:143], v[96:99], a[152:155], v[128:143]
    ds_read_b128 v[112:115], v12 offset:32768
    ds_read_b128 v[116:119], v12 offset:40960
    s_waitcnt lgkmcnt(4)
    v_mfma_f32_32x32x16_bf16 v[144:159], v[100:103], a[152:155], v[144:159]
    ds_read_b128 v[120:123], v21 offset:32768
    ds_read_b128 v[124:127], v21 offset:40960
    s_add_u32 s21, s20, 65536
    s_add_u32 m0, s18, 4096
    s_waitcnt lgkmcnt(5)
    v_mfma_f32_32x32x16_bf16 v[160:175], v[104:107], a[152:155], v[160:175]
    buffer_load_dwordx4 v7, s[8:11], s21 offen sc0 sc1 lds
    s_add_u32 m0, s18, 5120
    s_waitcnt lgkmcnt(4)
    v_mfma_f32_32x32x16_bf16 v[184:199], v[108:111], a[152:155], v[184:199]
    buffer_load_dwordx4 v8, s[8:11], s21 offen sc0 sc1 lds
    s_waitcnt lgkmcnt(0)
    s_waitcnt vmcnt(18)
    s_barrier
    v_mfma_f32_32x32x16_bf16 v[128:143], v[112:115], a[156:159], v[128:143]
    ds_read_b128 v[96:99], v13 offset:0
    ds_read_b128 v[100:103], v13 offset:8192
    v_mfma_f32_32x32x16_bf16 v[144:159], v[116:119], a[156:159], v[144:159]
    ds_read_b128 v[104:107], v22 offset:0
    ds_read_b128 v[108:111], v22 offset:8192
    s_add_u32 m0, s18, 6144
    v_mfma_f32_32x32x16_bf16 v[160:175], v[120:123], a[156:159], v[160:175]
    buffer_load_dwordx4 v9, s[8:11], s21 offen sc0 sc1 lds
    s_add_u32 m0, s18, 7168
    v_mfma_f32_32x32x16_bf16 v[184:199], v[124:127], a[156:159], v[184:199]
    buffer_load_dwordx4 v10, s[8:11], s21 offen sc0 sc1 lds
    s_waitcnt lgkmcnt(3)
    v_mfma_f32_32x32x16_bf16 v[128:143], v[96:99], a[160:163], v[128:143]
    ds_read_b128 v[112:115], v14 offset:0
    ds_read_b128 v[116:119], v14 offset:8192
    s_waitcnt lgkmcnt(4)
    v_mfma_f32_32x32x16_bf16 v[144:159], v[100:103], a[160:163], v[144:159]
    ds_read_b128 v[120:123], v23 offset:0
    ds_read_b128 v[124:127], v23 offset:8192
    s_bfe_u32 s17, s15, 0x40010
    s_lshl_b32 s17, s17, 8
    s_add_u32 s20, s16, s17
    s_add_u32 m0, s18, 32768
    s_waitcnt lgkmcnt(5)
    v_mfma_f32_32x32x16_bf16 v[160:175], v[104:107], a[160:163], v[160:175]
    buffer_load_dwordx4 v7, s[8:11], s20 offen sc0 sc1 lds
    s_add_u32 m0, s18, 33792
    s_waitcnt lgkmcnt(4)
    v_mfma_f32_32x32x16_bf16 v[184:199], v[108:111], a[160:163], v[184:199]
    buffer_load_dwordx4 v8, s[8:11], s20 offen sc0 sc1 lds
    s_waitcnt lgkmcnt(3)
    v_mfma_f32_32x32x16_bf16 v[128:143], v[112:115], a[164:167], v[128:143]
    ds_read_b128 v[96:99], v15 offset:0
    ds_read_b128 v[100:103], v15 offset:8192
    s_waitcnt lgkmcnt(4)
    v_mfma_f32_32x32x16_bf16 v[144:159], v[116:119], a[164:167], v[144:159]
    ds_read_b128 v[104:107], v24 offset:0
    ds_read_b128 v[108:111], v24 offset:8192
    s_add_u32 m0, s18, 34816
    s_waitcnt lgkmcnt(5)
    v_mfma_f32_32x32x16_bf16 v[160:175], v[120:123], a[164:167], v[160:175]
    buffer_load_dwordx4 v9, s[8:11], s20 offen sc0 sc1 lds
    s_add_u32 m0, s18, 35840
    s_waitcnt lgkmcnt(4)
    v_mfma_f32_32x32x16_bf16 v[184:199], v[124:127], a[164:167], v[184:199]
    buffer_load_dwordx4 v10, s[8:11], s20 offen sc0 sc1 lds
    s_waitcnt lgkmcnt(3)
    v_mfma_f32_32x32x16_bf16 v[128:143], v[96:99], a[168:171], v[128:143]
    ds_read_b128 v[112:115], v16 offset:0
    ds_read_b128 v[116:119], v16 offset:8192
    s_waitcnt lgkmcnt(4)
    v_mfma_f32_32x32x16_bf16 v[144:159], v[100:103], a[168:171], v[144:159]
    ds_read_b128 v[120:123], v25 offset:0
    ds_read_b128 v[124:127], v25 offset:8192
    s_add_u32 s21, s20, 65536
    s_add_u32 m0, s18, 36864
    s_waitcnt lgkmcnt(5)
    v_mfma_f32_32x32x16_bf16 v[160:175], v[104:107], a[168:171], v[160:175]
    buffer_load_dwordx4 v7, s[8:11], s21 offen sc0 sc1 lds
    s_add_u32 m0, s18, 37888
    s_waitcnt lgkmcnt(4)
    v_mfma_f32_32x32x16_bf16 v[184:199], v[108:111], a[168:171], v[184:199]
    buffer_load_dwordx4 v8, s[8:11], s21 offen sc0 sc1 lds
    s_waitcnt lgkmcnt(0)
    s_waitcnt vmcnt(18)
    s_barrier
    v_mfma_f32_32x32x16_bf16 v[128:143], v[112:115], a[172:175], v[128:143]
    ds_read_b128 v[96:99], v13 offset:32768
    ds_read_b128 v[100:103], v13 offset:40960
    v_mfma_f32_32x32x16_bf16 v[144:159], v[116:119], a[172:175], v[144:159]
    ds_read_b128 v[104:107], v22 offset:32768
    ds_read_b128 v[108:111], v22 offset:40960
    s_add_u32 m0, s18, 38912
    v_mfma_f32_32x32x16_bf16 v[160:175], v[120:123], a[172:175], v[160:175]
    buffer_load_dwordx4 v9, s[8:11], s21 offen sc0 sc1 lds
    s_add_u32 m0, s18, 39936
    v_mfma_f32_32x32x16_bf16 v[184:199], v[124:127], a[172:175], v[184:199]
    buffer_load_dwordx4 v10, s[8:11], s21 offen sc0 sc1 lds
    s_waitcnt lgkmcnt(3)
    v_mfma_f32_32x32x16_bf16 v[128:143], v[96:99], a[176:179], v[128:143]
    ds_read_b128 v[112:115], v14 offset:32768
    ds_read_b128 v[116:119], v14 offset:40960
    s_waitcnt lgkmcnt(4)
    v_mfma_f32_32x32x16_bf16 v[144:159], v[100:103], a[176:179], v[144:159]
    ds_read_b128 v[120:123], v23 offset:32768
    ds_read_b128 v[124:127], v23 offset:40960
    s_bfe_u32 s17, s15, 0x40014
    s_lshl_b32 s17, s17, 8
    s_add_u32 s20, s16, s17
    s_add_u32 m0, s18, 65536
    s_waitcnt lgkmcnt(5)
    v_mfma_f32_32x32x16_bf16 v[160:175], v[104:107], a[176:179], v[160:175]
    buffer_load_dwordx4 v7, s[8:11], s20 offen sc0 sc1 lds
    s_add_u32 m0, s18, 66560
    s_waitcnt lgkmcnt(4)
    v_mfma_f32_32x32x16_bf16 v[184:199], v[108:111], a[176:179], v[184:199]
    buffer_load_dwordx4 v8, s[8:11], s20 offen sc0 sc1 lds
    s_waitcnt lgkmcnt(3)
    v_mfma_f32_32x32x16_bf16 v[128:143], v[112:115], a[180:183], v[128:143]
    ds_read_b128 v[96:99], v15 offset:32768
    ds_read_b128 v[100:103], v15 offset:40960
    s_waitcnt lgkmcnt(4)
    v_mfma_f32_32x32x16_bf16 v[144:159], v[116:119], a[180:183], v[144:159]
    ds_read_b128 v[104:107], v24 offset:32768
    ds_read_b128 v[108:111], v24 offset:40960
    s_add_u32 m0, s18, 67584
    s_waitcnt lgkmcnt(5)
    v_mfma_f32_32x32x16_bf16 v[160:175], v[120:123], a[180:183], v[160:175]
    buffer_load_dwordx4 v9, s[8:11], s20 offen sc0 sc1 lds
    s_add_u32 m0, s18, 68608
    s_waitcnt lgkmcnt(4)
    v_mfma_f32_32x32x16_bf16 v[184:199], v[124:127], a[180:183], v[184:199]
    buffer_load_dwordx4 v10, s[8:11], s20 offen sc0 sc1 lds
    s_waitcnt lgkmcnt(3)
    v_mfma_f32_32x32x16_bf16 v[128:143], v[96:99], a[184:187], v[128:143]
    ds_read_b128 v[112:115], v16 offset:32768
    ds_read_b128 v[116:119], v16 offset:40960
    s_waitcnt lgkmcnt(4)
    v_mfma_f32_32x32x16_bf16 v[144:159], v[100:103], a[184:187], v[144:159]
    ds_read_b128 v[120:123], v25 offset:32768
    ds_read_b128 v[124:127], v25 offset:40960
    s_add_u32 s21, s20, 65536
    s_add_u32 m0, s18, 69632
    s_waitcnt lgkmcnt(5)
    v_mfma_f32_32x32x16_bf16 v[160:175], v[104:107], a[184:187], v[160:175]
    buffer_load_dwordx4 v7, s[8:11], s21 offen sc0 sc1 lds
    s_add_u32 m0, s18, 70656
    s_waitcnt lgkmcnt(4)
    v_mfma_f32_32x32x16_bf16 v[184:199], v[108:111], a[184:187], v[184:199]
    buffer_load_dwordx4 v8, s[8:11], s21 offen sc0 sc1 lds
    s_waitcnt lgkmcnt(0)
    s_waitcnt vmcnt(14)
    s_barrier
    v_mfma_f32_32x32x16_bf16 v[128:143], v[112:115], a[188:191], v[128:143]
    ds_read_b128 v[96:99], v4 offset:0
    ds_read_b128 v[100:103], v4 offset:8192
    v_mfma_f32_32x32x16_bf16 v[144:159], v[116:119], a[188:191], v[144:159]
    ds_read_b128 v[104:107], v18 offset:0
    ds_read_b128 v[108:111], v18 offset:8192
    s_add_u32 m0, s18, 71680
    v_mfma_f32_32x32x16_bf16 v[160:175], v[120:123], a[188:191], v[160:175]
    buffer_load_dwordx4 v9, s[8:11], s21 offen sc0 sc1 lds
    s_add_u32 m0, s18, 72704
    v_mfma_f32_32x32x16_bf16 v[184:199], v[124:127], a[188:191], v[184:199]
    buffer_load_dwordx4 v10, s[8:11], s21 offen sc0 sc1 lds
    s_waitcnt lgkmcnt(3)
    v_mfma_f32_32x32x16_bf16 v[128:143], v[96:99], a[192:195], v[128:143]
    ds_read_b128 v[112:115], v5 offset:0
    ds_read_b128 v[116:119], v5 offset:8192
    v_lshlrev_b32 v52, 16, v52
    ds_read_b64_tr_b16 v[26:27], v36 offset:0
    v_xor_b32 v1, 0, v37
    s_waitcnt lgkmcnt(5)
    v_mfma_f32_32x32x16_bf16 v[144:159], v[100:103], a[192:195], v[144:159]
    ds_read_b128 v[120:123], v19 offset:0
    ds_read_b128 v[124:127], v19 offset:8192
    s_bfe_u32 s17, s15, 0x40018
    s_lshl_b32 s17, s17, 8
    s_add_u32 s20, s16, s17
    s_add_u32 m0, s18, 98304
    s_waitcnt lgkmcnt(6)
    v_mfma_f32_32x32x16_bf16 v[160:175], v[104:107], a[192:195], v[160:175]
    buffer_load_dwordx4 v7, s[8:11], s20 offen sc0 sc1 lds
    ds_read_b64 v[50:51], v1
    s_waitcnt lgkmcnt(0)
    v_lshlrev_b32 v216, 16, v50
    v_lshlrev_b32 v220, 16, v26
    s_add_u32 m0, s18, 99328
    v_mfma_f32_32x32x16_bf16 v[184:199], v[108:111], a[192:195], v[184:199]
    buffer_load_dwordx4 v8, s[8:11], s20 offen sc0 sc1 lds
    v_and_b32 v217, s5, v50
    v_and_b32 v221, s5, v26
    v_lshlrev_b32 v218, 16, v51
    v_lshlrev_b32 v222, 16, v27
    v_mfma_f32_32x32x16_bf16 v[128:143], v[112:115], a[196:199], v[128:143]
    ds_read_b128 v[96:99], v11 offset:0
    ds_read_b128 v[100:103], v11 offset:8192
    v_and_b32 v219, s5, v51
    v_and_b32 v223, s5, v27
    ds_read_b64_tr_b16 v[32:33], v36 offset:1024
    v_mfma_f32_32x32x16_bf16 v[144:159], v[116:119], a[196:199], v[144:159]
    ds_read_b128 v[104:107], v20 offset:0
    ds_read_b128 v[108:111], v20 offset:8192
    v_xor_b32 v1, 16, v37
    ds_read_b64 v[180:181], v1
    s_add_u32 m0, s18, 100352
    v_mfma_f32_32x32x16_bf16 v[160:175], v[120:123], a[196:199], v[160:175]
    buffer_load_dwordx4 v9, s[8:11], s20 offen sc0 sc1 lds
    v_mul_f32 v84, v84, v216
    v_mul_f32 v85, v85, v217
    v_mul_f32 v86, v86, v218
    s_add_u32 m0, s18, 101376
    v_mfma_f32_32x32x16_bf16 v[184:199], v[124:127], a[196:199], v[184:199]
    buffer_load_dwordx4 v10, s[8:11], s20 offen sc0 sc1 lds
    v_mul_f32 v87, v87, v219
    v_fmac_f32 v84, v46, v52
    v_fmac_f32 v85, v47, v52
    v_fmac_f32 v86, v48, v52
    s_waitcnt lgkmcnt(5)
    v_mfma_f32_32x32x16_bf16 v[128:143], v[96:99], a[200:203], v[128:143]
    ds_read_b128 v[112:115], v12 offset:0
    ds_read_b128 v[116:119], v12 offset:8192
    v_fmac_f32 v87, v49, v52
    v_mul_f32 v84, v84, v220
    v_mul_f32 v85, v85, v221
    s_waitcnt lgkmcnt(6)
    v_mfma_f32_32x32x16_bf16 v[144:159], v[100:103], a[200:203], v[144:159]
    ds_read_b128 v[120:123], v21 offset:0
    ds_read_b128 v[124:127], v21 offset:8192
    v_mul_f32 v86, v86, v222
    s_add_u32 s21, s20, 65536
    s_add_u32 m0, s18, 102400
    s_waitcnt lgkmcnt(6)
    v_mfma_f32_32x32x16_bf16 v[160:175], v[104:107], a[200:203], v[160:175]
    buffer_load_dwordx4 v7, s[8:11], s21 offen sc0 sc1 lds
    v_mul_f32 v87, v87, v223
    s_waitcnt lgkmcnt(4)
    v_lshlrev_b32 v216, 16, v180
    v_lshlrev_b32 v220, 16, v32
    s_add_u32 m0, s18, 103424
    v_mfma_f32_32x32x16_bf16 v[184:199], v[108:111], a[200:203], v[184:199]
    buffer_load_dwordx4 v8, s[8:11], s21 offen sc0 sc1 lds
    v_and_b32 v217, s5, v180
    v_and_b32 v221, s5, v32
    v_lshlrev_b32 v218, 16, v181
    v_lshlrev_b32 v222, 16, v33
    s_waitcnt lgkmcnt(0)
    s_waitcnt vmcnt(14)
    s_barrier
    v_mfma_f32_32x32x16_bf16 v[128:143], v[112:115], a[204:207], v[128:143]
    ds_read_b128 v[96:99], v4 offset:32768
    ds_read_b128 v[100:103], v4 offset:40960
    v_and_b32 v219, s5, v181
    v_and_b32 v223, s5, v33
    ds_read_b64_tr_b16 v[26:27], v36 offset:2048
    v_mfma_f32_32x32x16_bf16 v[144:159], v[116:119], a[204:207], v[144:159]
    ds_read_b128 v[104:107], v18 offset:32768
    ds_read_b128 v[108:111], v18 offset:40960
    v_xor_b32 v1, 32, v37
    ds_read_b64 v[50:51], v1
    s_add_u32 m0, s18, 104448
    v_mfma_f32_32x32x16_bf16 v[160:175], v[120:123], a[204:207], v[160:175]
    buffer_load_dwordx4 v9, s[8:11], s21 offen sc0 sc1 lds
    v_mul_f32 v88, v88, v216
    v_mul_f32 v89, v89, v217
    v_mul_f32 v90, v90, v218
    s_add_u32 m0, s18, 105472
    v_mfma_f32_32x32x16_bf16 v[184:199], v[124:127], a[204:207], v[184:199]
    buffer_load_dwordx4 v10, s[8:11], s21 offen sc0 sc1 lds
    v_mul_f32 v91, v91, v219
    v_fmac_f32 v88, v54, v52
    v_fmac_f32 v89, v55, v52
    v_fmac_f32 v90, v56, v52
    s_waitcnt lgkmcnt(5)
    v_mfma_f32_32x32x16_bf16 v[128:143], v[96:99], a[208:211], v[128:143]
    ds_read_b128 v[112:115], v5 offset:32768
    ds_read_b128 v[116:119], v5 offset:40960
    v_fmac_f32 v91, v57, v52
    v_mul_f32 v88, v88, v220
    v_mul_f32 v89, v89, v221
    s_waitcnt lgkmcnt(6)
    v_mfma_f32_32x32x16_bf16 v[144:159], v[100:103], a[208:211], v[144:159]
    ds_read_b128 v[120:123], v19 offset:32768
    ds_read_b128 v[124:127], v19 offset:40960
    v_mul_f32 v90, v90, v222
    v_mul_f32 v91, v91, v223
    s_waitcnt lgkmcnt(4)
    v_lshlrev_b32 v216, 16, v50
    v_mfma_f32_32x32x16_bf16 v[160:175], v[104:107], a[208:211], v[160:175]
    v_lshlrev_b32 v220, 16, v26
    v_and_b32 v217, s5, v50
    v_and_b32 v221, s5, v26
    v_lshlrev_b32 v218, 16, v51
    v_lshlrev_b32 v222, 16, v27
    v_mfma_f32_32x32x16_bf16 v[184:199], v[108:111], a[208:211], v[184:199]
    v_and_b32 v219, s5, v51
    v_and_b32 v223, s5, v27
    ds_read_b64_tr_b16 v[32:33], v36 offset:3072
    v_xor_b32 v1, 48, v37
    ds_read_b64 v[180:181], v1
    s_waitcnt lgkmcnt(5)
    v_mfma_f32_32x32x16_bf16 v[128:143], v[112:115], a[212:215], v[128:143]
    ds_read_b128 v[96:99], v11 offset:32768
    ds_read_b128 v[100:103], v11 offset:40960
    v_mul_f32 v92, v92, v216
    v_mul_f32 v93, v93, v217
    v_mul_f32 v94, v94, v218
    s_waitcnt lgkmcnt(6)
    v_mfma_f32_32x32x16_bf16 v[144:159], v[116:119], a[212:215], v[144:159]
    ds_read_b128 v[104:107], v20 offset:32768
    ds_read_b128 v[108:111], v20 offset:40960
    v_mul_f32 v95, v95, v219
    v_fmac_f32 v92, v58, v52
    v_fmac_f32 v93, v59, v52
    s_waitcnt lgkmcnt(7)
    v_mfma_f32_32x32x16_bf16 v[160:175], v[120:123], a[212:215], v[160:175]
    v_fmac_f32 v94, v60, v52
    v_fmac_f32 v95, v61, v52
    v_mul_f32 v92, v92, v220
    v_mul_f32 v93, v93, v221
    v_mul_f32 v94, v94, v222
    s_waitcnt lgkmcnt(6)
    v_mfma_f32_32x32x16_bf16 v[184:199], v[124:127], a[212:215], v[184:199]
    v_mul_f32 v95, v95, v223
    s_waitcnt lgkmcnt(4)
    v_lshlrev_b32 v216, 16, v180
    v_lshlrev_b32 v220, 16, v32
    v_and_b32 v217, s5, v180
    v_and_b32 v221, s5, v32
    s_waitcnt lgkmcnt(3)
    v_mfma_f32_32x32x16_bf16 v[128:143], v[96:99], a[216:219], v[128:143]
    ds_read_b128 v[112:115], v12 offset:32768
    ds_read_b128 v[116:119], v12 offset:40960
    v_lshlrev_b32 v218, 16, v181
    v_lshlrev_b32 v222, 16, v33
    v_and_b32 v219, s5, v181
    s_waitcnt lgkmcnt(4)
    v_mfma_f32_32x32x16_bf16 v[144:159], v[100:103], a[216:219], v[144:159]
    ds_read_b128 v[120:123], v21 offset:32768
    ds_read_b128 v[124:127], v21 offset:40960
    v_and_b32 v223, s5, v33
    ds_read_b64_tr_b16 v[26:27], v36 offset:4096
    v_xor_b32 v1, 64, v37
    s_waitcnt lgkmcnt(6)
    v_mfma_f32_32x32x16_bf16 v[160:175], v[104:107], a[216:219], v[160:175]
    ds_read_b64 v[50:51], v1
    v_mul_f32 v176, v176, v216
    v_mul_f32 v177, v177, v217
    v_mul_f32 v178, v178, v218
    v_mul_f32 v179, v179, v219
    s_waitcnt lgkmcnt(6)
    v_mfma_f32_32x32x16_bf16 v[184:199], v[108:111], a[216:219], v[184:199]
    v_fmac_f32 v176, v62, v52
    v_fmac_f32 v177, v63, v52
    v_fmac_f32 v178, v64, v52
    v_fmac_f32 v179, v65, v52
    v_mul_f32 v176, v176, v220
    s_waitcnt lgkmcnt(2)
    s_waitcnt vmcnt(8)
    s_waitcnt vmcnt(0)
    s_barrier
    v_mfma_f32_32x32x16_bf16 v[128:143], v[112:115], a[220:223], v[128:143]
    ds_read_b128 v[96:99], v22 offset:0
    ds_read_b128 v[100:103], v23 offset:0
    v_mul_f32 v177, v177, v221
    v_mul_f32 v178, v178, v222
    v_mul_f32 v179, v179, v223
    v_mfma_f32_32x32x16_bf16 v[144:159], v[116:119], a[220:223], v[144:159]
    ds_read_b128 v[104:107], v24 offset:0
    ds_read_b128 v[108:111], v25 offset:0
    s_waitcnt lgkmcnt(4)
    v_lshlrev_b32 v216, 16, v50
    v_lshlrev_b32 v220, 16, v26
    v_and_b32 v217, s5, v50
    v_mfma_f32_32x32x16_bf16 v[160:175], v[120:123], a[220:223], v[160:175]
    v_and_b32 v221, s5, v26
    v_lshlrev_b32 v218, 16, v51
    v_lshlrev_b32 v222, 16, v27
    v_and_b32 v219, s5, v51
    v_and_b32 v223, s5, v27
    v_mfma_f32_32x32x16_bf16 v[184:199], v[124:127], a[220:223], v[184:199]
    ds_read_b64_tr_b16 v[32:33], v36 offset:5120
    v_xor_b32 v1, 80, v37
    ds_read_b64 v[180:181], v1
    v_mul_f32 v200, v200, v216
    v_mul_f32 v201, v201, v217
    s_waitcnt lgkmcnt(5)
    v_mfma_f32_32x32x16_bf16 v[160:175], v[96:99], a[224:227], v[160:175]
    ds_read_b128 v[112:115], v22 offset:32768
    ds_read_b128 v[116:119], v23 offset:32768
    v_mul_f32 v202, v202, v218
    v_mul_f32 v203, v203, v219
    v_fmac_f32 v200, v66, v52
    s_waitcnt lgkmcnt(6)
    v_mfma_f32_32x32x16_bf16 v[160:175], v[100:103], a[228:231], v[160:175]
    ds_read_b128 v[120:123], v24 offset:32768
    ds_read_b128 v[124:127], v25 offset:32768
    v_fmac_f32 v201, v67, v52
    v_fmac_f32 v202, v68, v52
    v_fmac_f32 v203, v69, v52
    s_waitcnt lgkmcnt(7)
    v_mfma_f32_32x32x16_bf16 v[160:175], v[104:107], a[232:235], v[160:175]
    v_mul_f32 v200, v200, v220
    v_mul_f32 v201, v201, v221
    v_mul_f32 v202, v202, v222
    v_mul_f32 v203, v203, v223
    s_waitcnt lgkmcnt(4)
    v_lshlrev_b32 v216, 16, v180
    v_mfma_f32_32x32x16_bf16 v[160:175], v[108:111], a[236:239], v[160:175]
    v_lshlrev_b32 v220, 16, v32
    v_and_b32 v217, s5, v180
    v_and_b32 v221, s5, v32
    v_lshlrev_b32 v218, 16, v181
    v_lshlrev_b32 v222, 16, v33
    s_waitcnt lgkmcnt(3)
    v_mfma_f32_32x32x16_bf16 v[160:175], v[112:115], a[240:243], v[160:175]
    ds_read_b128 v[96:99], v13 offset:0
    ds_read_b128 v[100:103], v14 offset:0
    v_and_b32 v219, s5, v181
    v_and_b32 v223, s5, v33
    ds_read_b64_tr_b16 v[26:27], v36 offset:6144
    s_waitcnt lgkmcnt(5)
    v_mfma_f32_32x32x16_bf16 v[160:175], v[116:119], a[244:247], v[160:175]
    ds_read_b128 v[104:107], v15 offset:0
    ds_read_b128 v[108:111], v16 offset:0
    v_xor_b32 v1, 96, v37
    ds_read_b64 v[50:51], v1
    v_mul_f32 v204, v204, v216
    s_waitcnt lgkmcnt(7)
    v_mfma_f32_32x32x16_bf16 v[160:175], v[120:123], a[248:251], v[160:175]
    v_mul_f32 v205, v205, v217
    v_mul_f32 v206, v206, v218
    v_mul_f32 v207, v207, v219
    v_fmac_f32 v204, v70, v52
    v_fmac_f32 v205, v71, v52
    s_waitcnt lgkmcnt(6)
    v_mfma_f32_32x32x16_bf16 v[160:175], v[124:127], a[252:255], v[160:175]
    v_fmac_f32 v206, v72, v52
    v_fmac_f32 v207, v73, v52
    v_mul_f32 v204, v204, v220
    v_mul_f32 v205, v205, v221
    v_mul_f32 v206, v206, v222
    s_waitcnt lgkmcnt(5)
    v_mfma_f32_32x32x16_bf16 v[128:143], v[96:99], a[224:227], v[128:143]
    ds_read_b128 v[112:115], v13 offset:32768
    ds_read_b128 v[116:119], v14 offset:32768
    v_mul_f32 v207, v207, v223
    s_waitcnt lgkmcnt(2)
    v_lshlrev_b32 v216, 16, v50
    v_lshlrev_b32 v220, 16, v26
    v_mfma_f32_32x32x16_bf16 v[128:143], v[100:103], a[228:231], v[128:143]
    ds_read_b128 v[120:123], v15 offset:32768
    ds_read_b128 v[124:127], v16 offset:32768
    ds_write_b128 v44, v[160:163] offset:0
    v_and_b32 v217, s5, v50
    v_and_b32 v221, s5, v26
    v_mfma_f32_32x32x16_bf16 v[128:143], v[104:107], a[232:235], v[128:143]
    ds_write_b128 v44, v[164:167] offset:1024
    ds_write_b128 v44, v[168:171] offset:2048
    v_lshlrev_b32 v218, 16, v51
    v_lshlrev_b32 v222, 16, v27
    v_and_b32 v219, s5, v51
    v_mfma_f32_32x32x16_bf16 v[128:143], v[108:111], a[236:239], v[128:143]
    ds_write_b128 v44, v[172:175] offset:3072
    v_and_b32 v223, s5, v27
    ds_read_b64_tr_b16 v[32:33], v36 offset:7168
    v_xor_b32 v1, 112, v37
    ds_read_b64 v[180:181], v1
    v_mul_f32 v208, v208, v216
    v_mul_f32 v209, v209, v217
    v_mul_f32 v210, v210, v218
    v_mul_f32 v211, v211, v219
    v_fmac_f32 v208, v74, v52
    v_fmac_f32 v209, v75, v52
    v_fmac_f32 v210, v76, v52
    v_fmac_f32 v211, v77, v52
    v_mul_f32 v208, v208, v220
    v_mul_f32 v209, v209, v221
    v_mul_f32 v210, v210, v222
    v_mul_f32 v211, v211, v223
    s_waitcnt lgkmcnt(0)
    v_lshlrev_b32 v216, 16, v180
    v_lshlrev_b32 v220, 16, v32
    v_and_b32 v217, s5, v180
    v_and_b32 v221, s5, v32
    v_lshlrev_b32 v218, 16, v181
    v_lshlrev_b32 v222, 16, v33
    v_and_b32 v219, s5, v181
    v_and_b32 v223, s5, v33
    v_mul_f32 v212, v212, v216
    v_mul_f32 v213, v213, v217
    v_mul_f32 v214, v214, v218
    v_mul_f32 v215, v215, v219
    v_fmac_f32 v212, v78, v52
    v_fmac_f32 v213, v79, v52
    v_fmac_f32 v214, v80, v52
    v_fmac_f32 v215, v81, v52
    v_mul_f32 v212, v212, v220
    v_mul_f32 v213, v213, v221
    v_mul_f32 v214, v214, v222
    v_mul_f32 v215, v215, v223
    v_mfma_f32_32x32x16_bf16 v[128:143], v[112:115], a[240:243], v[128:143]
    ds_read_b128 v[96:99], v22 offset:8192
    ds_read_b128 v[100:103], v23 offset:8192
    v_mfma_f32_32x32x16_bf16 v[128:143], v[116:119], a[244:247], v[128:143]
    ds_read_b128 v[104:107], v24 offset:8192
    ds_read_b128 v[108:111], v25 offset:8192
    v_mfma_f32_32x32x16_bf16 v[128:143], v[120:123], a[248:251], v[128:143]
    s_barrier
    ds_read_b128 v[224:227], v45 offset:0
    ds_read_b128 v[228:231], v45 offset:1024
    v_mfma_f32_32x32x16_bf16 v[128:143], v[124:127], a[252:255], v[128:143]
    ds_read_b128 v[232:235], v45 offset:2048
    ds_read_b128 v[236:239], v45 offset:3072
    s_waitcnt lgkmcnt(7)
    v_mfma_f32_32x32x16_bf16 v[184:199], v[96:99], a[224:227], v[184:199]
    ds_read_b128 v[112:115], v22 offset:40960
    ds_read_b128 v[116:119], v23 offset:40960
    s_waitcnt lgkmcnt(8)
    v_mfma_f32_32x32x16_bf16 v[184:199], v[100:103], a[228:231], v[184:199]
    ds_read_b128 v[120:123], v24 offset:40960
    ds_read_b128 v[124:127], v25 offset:40960
    s_waitcnt lgkmcnt(7)
    s_nop 0
    v_add_f32 v128, v128, v224
    v_add_f32 v129, v129, v225
    v_add_f32 v130, v130, v226
    v_mfma_f32_32x32x16_bf16 v[184:199], v[104:107], a[232:235], v[184:199]
    v_add_f32 v131, v131, v227
    v_fma_f32 v128, v46, v128, v84
    v_fma_f32 v129, v47, v129, v85
    v_fma_f32 v130, v48, v130, v86
    v_fma_f32 v131, v49, v131, v87
    v_mfma_f32_32x32x16_bf16 v[184:199], v[108:111], a[236:239], v[184:199]
    buffer_store_dword v128, v40, s[32:35], s39 offen nt
    buffer_store_dword v129, v41, s[32:35], s39 offen nt
    buffer_store_dword v130, v42, s[32:35], s39 offen nt
    buffer_store_dword v131, v43, s[32:35], s39 offen nt
    s_waitcnt lgkmcnt(6)
    v_add_f32 v132, v132, v228
    s_waitcnt lgkmcnt(3)
    v_mfma_f32_32x32x16_bf16 v[184:199], v[112:115], a[240:243], v[184:199]
    ds_read_b128 v[96:99], v13 offset:8192
    ds_read_b128 v[100:103], v14 offset:8192
    v_add_f32 v133, v133, v229
    v_add_f32 v134, v134, v230
    v_add_f32 v135, v135, v231
    s_waitcnt lgkmcnt(4)
    v_mfma_f32_32x32x16_bf16 v[184:199], v[116:119], a[244:247], v[184:199]
    ds_read_b128 v[104:107], v15 offset:8192
    ds_read_b128 v[108:111], v16 offset:8192
    v_fma_f32 v132, v54, v132, v88
    v_fma_f32 v133, v55, v133, v89
    v_fma_f32 v134, v56, v134, v90
    s_waitcnt lgkmcnt(5)
    v_mfma_f32_32x32x16_bf16 v[184:199], v[120:123], a[248:251], v[184:199]
    v_fma_f32 v135, v57, v135, v91
    s_add_u32 s39, s39, 32768
    buffer_store_dword v132, v40, s[32:35], s39 offen nt
    buffer_store_dword v133, v41, s[32:35], s39 offen nt
    buffer_store_dword v134, v42, s[32:35], s39 offen nt
    s_waitcnt lgkmcnt(4)
    v_mfma_f32_32x32x16_bf16 v[184:199], v[124:127], a[252:255], v[184:199]
    buffer_store_dword v135, v43, s[32:35], s39 offen nt
    v_add_f32 v136, v136, v232
    v_add_f32 v137, v137, v233
    v_add_f32 v138, v138, v234
    v_add_f32 v139, v139, v235
    s_waitcnt lgkmcnt(3)
    v_mfma_f32_32x32x16_bf16 v[144:159], v[96:99], a[224:227], v[144:159]
    ds_read_b128 v[112:115], v13 offset:40960
    ds_read_b128 v[116:119], v14 offset:40960
    v_fma_f32 v136, v58, v136, v92
    v_fma_f32 v137, v59, v137, v93
    v_fma_f32 v138, v60, v138, v94
    s_waitcnt lgkmcnt(4)
    v_mfma_f32_32x32x16_bf16 v[144:159], v[100:103], a[228:231], v[144:159]
    ds_read_b128 v[120:123], v15 offset:40960
    ds_read_b128 v[124:127], v16 offset:40960
    ds_write_b128 v44, v[184:187] offset:4096
    v_fma_f32 v139, v61, v139, v95
    s_add_u32 s39, s39, 32768
    s_waitcnt lgkmcnt(6)
    v_mfma_f32_32x32x16_bf16 v[144:159], v[104:107], a[232:235], v[144:159]
    ds_write_b128 v44, v[188:191] offset:5120
    ds_write_b128 v44, v[192:195] offset:6144
    buffer_store_dword v136, v40, s[32:35], s39 offen nt
    buffer_store_dword v137, v41, s[32:35], s39 offen nt
    buffer_store_dword v138, v42, s[32:35], s39 offen nt
    s_waitcnt lgkmcnt(7)
    v_mfma_f32_32x32x16_bf16 v[144:159], v[108:111], a[236:239], v[144:159]
    ds_write_b128 v44, v[196:199] offset:7168
    buffer_store_dword v139, v43, s[32:35], s39 offen nt
    v_add_f32 v140, v140, v236
    v_add_f32 v141, v141, v237
    v_add_f32 v142, v142, v238
    s_waitcnt lgkmcnt(7)
    v_mfma_f32_32x32x16_bf16 v[144:159], v[112:115], a[240:243], v[144:159]
    v_add_f32 v143, v143, v239
    v_fma_f32 v140, v62, v140, v176
    v_fma_f32 v141, v63, v141, v177
    v_fma_f32 v142, v64, v142, v178
    v_fma_f32 v143, v65, v143, v179
    s_waitcnt lgkmcnt(6)
    v_mfma_f32_32x32x16_bf16 v[144:159], v[116:119], a[244:247], v[144:159]
    s_add_u32 s39, s39, 32768
    buffer_store_dword v140, v40, s[32:35], s39 offen nt
    buffer_store_dword v141, v41, s[32:35], s39 offen nt
    buffer_store_dword v142, v42, s[32:35], s39 offen nt
    buffer_store_dword v143, v43, s[32:35], s39 offen nt
    s_waitcnt lgkmcnt(5)
    v_mfma_f32_32x32x16_bf16 v[144:159], v[120:123], a[248:251], v[144:159]
    s_waitcnt lgkmcnt(0)
    s_barrier
    ds_read_b128 v[96:99], v45 offset:4096
    ds_read_b128 v[100:103], v45 offset:5120
    v_mfma_f32_32x32x16_bf16 v[144:159], v[124:127], a[252:255], v[144:159]
    ds_read_b128 v[104:107], v45 offset:6144
    ds_read_b128 v[108:111], v45 offset:7168
    s_waitcnt lgkmcnt(3)
    s_nop 8
    v_add_f32 v144, v144, v96
    v_add_f32 v145, v145, v97
    v_add_f32 v146, v146, v98
    v_add_f32 v147, v147, v99
    v_fma_f32 v144, v66, v144, v200
    v_fma_f32 v145, v67, v145, v201
    v_fma_f32 v146, v68, v146, v202
    v_fma_f32 v147, v69, v147, v203
    s_add_u32 s39, s39, 32768
    buffer_store_dword v144, v40, s[32:35], s39 offen nt
    buffer_store_dword v145, v41, s[32:35], s39 offen nt
    buffer_store_dword v146, v42, s[32:35], s39 offen nt
    buffer_store_dword v147, v43, s[32:35], s39 offen nt
    s_waitcnt lgkmcnt(2)
    v_add_f32 v148, v148, v100
    v_add_f32 v149, v149, v101
    v_add_f32 v150, v150, v102
    v_add_f32 v151, v151, v103
    v_fma_f32 v148, v70, v148, v204
    v_fma_f32 v149, v71, v149, v205
    v_fma_f32 v150, v72, v150, v206
    v_fma_f32 v151, v73, v151, v207
    s_add_u32 s39, s39, 32768
    buffer_store_dword v148, v40, s[32:35], s39 offen nt
    buffer_store_dword v149, v41, s[32:35], s39 offen nt
    buffer_store_dword v150, v42, s[32:35], s39 offen nt
    buffer_store_dword v151, v43, s[32:35], s39 offen nt
    s_waitcnt lgkmcnt(1)
    v_add_f32 v152, v152, v104
    v_add_f32 v153, v153, v105
    v_add_f32 v154, v154, v106
    v_add_f32 v155, v155, v107
    v_fma_f32 v152, v74, v152, v208
    v_fma_f32 v153, v75, v153, v209
    v_fma_f32 v154, v76, v154, v210
    v_fma_f32 v155, v77, v155, v211
    s_add_u32 s39, s39, 32768
    buffer_store_dword v152, v40, s[32:35], s39 offen nt
    buffer_store_dword v153, v41, s[32:35], s39 offen nt
    buffer_store_dword v154, v42, s[32:35], s39 offen nt
    buffer_store_dword v155, v43, s[32:35], s39 offen nt
    s_waitcnt lgkmcnt(0)
    v_add_f32 v156, v156, v108
    v_add_f32 v157, v157, v109
    v_add_f32 v158, v158, v110
    v_add_f32 v159, v159, v111
    v_fma_f32 v156, v78, v156, v212
    v_fma_f32 v157, v79, v157, v213
    v_fma_f32 v158, v80, v158, v214
    v_fma_f32 v159, v81, v159, v215
    s_add_u32 s39, s39, 32768
    buffer_store_dword v156, v40, s[32:35], s39 offen nt
    buffer_store_dword v157, v41, s[32:35], s39 offen nt
    buffer_store_dword v158, v42, s[32:35], s39 offen nt
    buffer_store_dword v159, v43, s[32:35], s39 offen nt
Lend_gated_mix__ssm_conv_s5__ssm_conv_h3__prompt_kernel:
Lcode_last:
    s_endpgm

.section .rodata,"a"
.p2align 6
.amdhsa_kernel gated_mix__ssm_conv_s5__ssm_conv_h3__prompt_kernel
  .amdhsa_next_free_vgpr 504
  .amdhsa_next_free_sgpr 92
  .amdhsa_accum_offset 248
  .amdhsa_group_segment_fixed_size 0
  .amdhsa_kernarg_size 152
  .amdhsa_user_sgpr_count 2
  .amdhsa_user_sgpr_kernarg_segment_ptr 1
  .amdhsa_system_sgpr_workgroup_id_x 1
  .amdhsa_float_denorm_mode_32 3
.end_amdhsa_kernel
```

```asm
; @launch grid=(256,1,1) block=(256,1,1) lds=163840
.amdgcn_target "amdgcn-amd-amdhsa--gfx950"
.text
.globl gated_mix__ssm_conv_s5__ssm_conv_h3__prompt_kernel
.p2align 8
.type gated_mix__ssm_conv_s5__ssm_conv_h3__prompt_kernel,@function
gated_mix__ssm_conv_s5__ssm_conv_h3__prompt_kernel:
    s_cmp_ge_u32 s2, 256
    s_cbranch_scc1 Lend_gated_mix__ssm_conv_s5__ssm_conv_h3__prompt_kernel
    s_load_dwordx16 s[4:19], s[0:1], 0
    s_load_dwordx16 s[20:35], s[0:1], 64
    s_load_dwordx4 s[36:39], s[0:1], 128
    s_load_dwordx2 s[40:41], s[0:1], 144
    s_getpc_b64 s[42:43]
Lcpf_pc:
    s_bfe_u32 s3, s2, 0x10003
    s_lshl_b32 s3, s3, 15
    v_lshlrev_b32 v1, 7, v0
    v_add_u32 v1, s3, v1
    v_min_u32 v1, Lcode_last-Lcpf_pc, v1
    v_mov_b32 v3, s43
    v_add_co_u32 v2, vcc, s42, v1
    s_nop 1
    v_addc_co_u32 v3, vcc, 0, v3, vcc
    global_load_dword v1, v[2:3], off
    s_memrealtime s[42:43]
    v_lshrrev_b32 v2, 6, v0
    s_nop 0
    v_readfirstlane_b32 s44, v2
    v_and_b32 v2, 63, v0
    s_and_b32 s47, s2, 7
    s_lshr_b32 s45, s47, 1
    s_lshl_b32 s45, s45, 2
    s_and_b32 s46, s47, 1
    s_lshl_b32 s46, s46, 3
    s_lshr_b32 s47, s2, 3
    s_and_b32 s3, s47, 3
    s_add_u32 s45, s45, s3
    s_lshr_b32 s47, s47, 2
    s_add_u32 s46, s46, s47
    v_mov_b32 v4, 0
    v_mov_b32 v5, 0
    v_mov_b32 v6, 0
    v_mov_b32 v7, 0
    v_lshlrev_b32 v3, 4, v0
    v_add_u32 v3, 148480, v3
    ds_write_b128 v3, v[4:7]
    v_lshlrev_b32 v3, 2, v0
    v_add_u32 v3, 152576, v3
    ds_write_b32 v3, v4
    v_lshrrev_b32 v16, 4, v2
    v_and_b32 v17, 7, v2
    v_xor_b32 v17, v17, v16
    v_lshlrev_b32 v17, 4, v17
    v_lshrrev_b32 v16, 3, v2
    v_lshl_add_u32 v12, v16, 11, v17
    v_and_b32 v16, 32, v2
    v_lshl_add_u32 v8, v16, 11, v17
    v_and_b32 v16, 8, v2
    v_lshl_add_u32 v8, v16, 12, v8
    v_and_b32 v16, 16, v2
    v_lshl_add_u32 v8, v16, 7, v8
    v_xor_b32 v16, 64, v8
    v_xor_b32 v17, 64, v12
    v_add_u32 v9, 4096, v16
    v_add_u32 v10, 8192, v8
    v_add_u32 v11, 12288, v16
    v_add_u32 v13, 16384, v17
    v_add_u32 v14, 32768, v12
    v_add_u32 v15, 49152, v17
    s_lshr_b32 s50, s44, 1
    s_lshl_b32 s47, s45, 7
    s_lshl_b32 s3, s50, 6
    s_add_u32 s47, s47, s3
    s_and_b32 s3, s44, 1
    s_lshl_b32 s3, s3, 3
    s_add_u32 s47, s47, s3
    s_lshl_b32 s47, s47, 11
    s_lshl_b32 s48, s46, 6
    s_lshl_b32 s3, s50, 5
    s_add_u32 s48, s48, s3
    s_lshl_b32 s48, s48, 11
    s_lshl_b32 s49, s44, 12
    s_and_b32 s3, s2, 7
    s_lshl_b32 s51, s3, 8
    v_bfe_u32 v17, v2, 3, 2
    v_lshrrev_b32 v18, 5, v2
    v_lshlrev_b32 v18, 2, v18
    v_lshl_add_u32 v17, v17, 3, v18
    v_and_b32 v18, 7, v2
    v_lshlrev_b32 v18, 4, v18
    v_lshl_add_u32 v16, v17, 11, v18
    s_lshl_b32 s50, s45, 7
    s_lshl_b32 s3, s44, 5
    s_add_u32 s50, s50, s3
    s_lshl_b32 s50, s50, 11
    s_lshl_b32 s3, s46, 7
    s_add_u32 s50, s50, s3
    v_add_u32 v16, s50, v16
    v_subrev_u32 v18, 6144, v16
    v_min_u32 v18, 0x7fff0000, v18
    v_subrev_u32 v22, 4096, v16
    v_min_u32 v22, 0x7fff0000, v22
    v_subrev_u32 v26, 2048, v16
    v_min_u32 v26, 0x7fff0000, v26
    s_mov_b32 s50, 4096
    s_lshl_b32 s54, s46, 9
    v_lshlrev_b32 v17, 4, v2
    s_waitcnt lgkmcnt(0)
    s_mov_b32 s56, s4
    s_mov_b32 s57, s5
    s_mov_b32 s58, 4194304
    s_mov_b32 s59, 131072
    s_and_b32 s3, s44, 1
    s_cmp_eq_u32 s3, 0
    s_cselect_b32 s60, s10, s12
    s_cselect_b32 s61, s11, s13
    s_mov_b32 s62, 2097152
    s_mov_b32 s63, 131072
    s_add_u32 s52, s47, s51
    s_add_u32 m0, s49, 0
    s_nop 0
    buffer_load_dwordx4 v8, s[56:59], s52 offen  lds
    s_add_u32 m0, s49, 1024
    s_nop 0
    buffer_load_dwordx4 v9, s[56:59], s52 offen  lds
    s_add_u32 m0, s49, 2048
    s_nop 0
    buffer_load_dwordx4 v10, s[56:59], s52 offen  lds
    s_add_u32 m0, s49, 3072
    s_nop 0
    buffer_load_dwordx4 v11, s[56:59], s52 offen  lds
    s_add_u32 s53, s48, s51
    s_add_u32 m0, s49, 16384
    s_nop 0
    buffer_load_dwordx4 v12, s[60:63], s53 offen  lds
    s_add_u32 m0, s49, 17408
    s_nop 0
    buffer_load_dwordx4 v13, s[60:63], s53 offen  lds
    s_add_u32 m0, s49, 18432
    s_nop 0
    buffer_load_dwordx4 v14, s[60:63], s53 offen  lds
    s_add_u32 m0, s49, 19456
    s_nop 0
    buffer_load_dwordx4 v15, s[60:63], s53 offen  lds
    s_add_u32 s51, s51, 128
    s_and_b32 s51, s51, 0x7ff
    s_add_u32 s52, s47, s51
    s_add_u32 m0, s49, 32768
    s_nop 0
    buffer_load_dwordx4 v8, s[56:59], s52 offen  lds
    s_add_u32 m0, s49, 33792
    s_nop 0
    buffer_load_dwordx4 v9, s[56:59], s52 offen  lds
    s_add_u32 m0, s49, 34816
    s_nop 0
    buffer_load_dwordx4 v10, s[56:59], s52 offen  lds
    s_add_u32 m0, s49, 35840
    s_nop 0
    buffer_load_dwordx4 v11, s[56:59], s52 offen  lds
    s_add_u32 s53, s48, s51
    s_add_u32 m0, s49, 49152
    s_nop 0
    buffer_load_dwordx4 v12, s[60:63], s53 offen  lds
    s_add_u32 m0, s49, 50176
    s_nop 0
    buffer_load_dwordx4 v13, s[60:63], s53 offen  lds
    s_add_u32 m0, s49, 51200
    s_nop 0
    buffer_load_dwordx4 v14, s[60:63], s53 offen  lds
    s_add_u32 m0, s49, 52224
    s_nop 0
    buffer_load_dwordx4 v15, s[60:63], s53 offen  lds
    s_mov_b32 s64, s28
    s_mov_b32 s65, s29
    s_mov_b32 s66, 8192
    s_mov_b32 s67, 131072
    s_mov_b32 s68, s24
    s_mov_b32 s69, s25
    s_mov_b32 s70, 4194304
    s_mov_b32 s71, 131072
    s_mov_b32 s72, s26
    s_mov_b32 s73, s27
    s_mov_b32 s74, 4194304
    s_mov_b32 s75, 131072
    s_lshl_b32 s3, s44, 10
    s_add_u32 s4, s3, 157696
    s_mov_b32 s24, s38
    s_mov_b32 s25, s39
    s_mov_b32 s26, 256
    s_mov_b32 s27, 131072
    s_or_b32 s3, s2, s44
    s_cmp_lg_u32 s3, 0
    s_cbranch_scc1 Lnonce_gate_1
    v_mov_b32 v4, s42
    v_mov_b32 v5, s43
    v_mov_b32 v3, 0
    buffer_store_dwordx2 v[4:5], v3, s[24:27], 0 offen sc0 sc1
    s_nop 1
Lnonce_gate_1:
    s_mov_b32 s5, 0xffff0000
    v_mov_b32 v6, 0
    s_and_b32 s3, s44, 1
    s_lshl_b32 s3, s3, 5
    v_and_b32 v7, 31, v2
    v_add_u32 v7, s3, v7
    s_lshl_b32 s3, s46, 6
    v_add_u32 v62, s3, v7
    v_lshlrev_b32 v62, 1, v62
    s_mov_b32 s76, s6
    s_mov_b32 s77, s7
    s_mov_b32 s78, 2048
    s_mov_b32 s79, 131072
    buffer_load_ushort v63, v62, s[76:79], 0 offen
    s_mov_b32 s76, s8
    s_mov_b32 s77, s9
    s_mov_b32 s78, 2048
    s_mov_b32 s79, 131072
    buffer_load_ushort v64, v62, s[76:79], 0 offen
    s_mov_b32 s8, s18
    s_mov_b32 s9, s19
    s_mov_b32 s10, 2048
    s_mov_b32 s11, 131072
    buffer_load_ushort v65, v62, s[8:11], 0 offen
    v_and_b32 v82, 31, v2
    v_bfe_u32 v83, v82, 1, 3
    v_lshrrev_b32 v84, 5, v2
    v_xor_b32 v83, v83, v84
    v_lshlrev_b32 v83, 4, v83
    v_lshl_add_u32 v83, v82, 7, v83
    s_lshr_b32 s6, s44, 1
    s_lshl_b32 s6, s6, 13
    s_and_b32 s7, s44, 1
    s_lshl_b32 s7, s7, 13
    s_add_u32 s7, s7, 16384
    v_xor_b32 v84, 0, v83
    v_add_u32 v66, s6, v84
    v_add_u32 v74, s7, v84
    v_add_u32 v70, 0x10000, v66
    v_add_u32 v78, 0x10000, v74
    v_xor_b32 v84, 32, v83
    v_add_u32 v67, s6, v84
    v_add_u32 v75, s7, v84
    v_add_u32 v71, 0x10000, v67
    v_add_u32 v79, 0x10000, v75
    v_xor_b32 v84, 64, v83
    v_add_u32 v68, s6, v84
    v_add_u32 v76, s7, v84
    v_add_u32 v72, 0x10000, v68
    v_add_u32 v80, 0x10000, v76
    v_xor_b32 v84, 96, v83
    v_add_u32 v69, s6, v84
    v_add_u32 v77, s7, v84
    v_add_u32 v73, 0x10000, v69
    v_add_u32 v81, 0x10000, v77
    s_mov_b32 s8, s40
    s_mov_b32 s9, s41
    s_mov_b32 s10, 33554432
    s_mov_b32 s11, 131072
    v_and_b32 v82, 7, v2
    s_lshl_b32 s3, s44, 10
    s_add_u32 s3, s3, 157696
    v_lshl_add_u32 v180, v82, 6, s3
    v_bfe_u32 v82, v2, 2, 1
    v_lshlrev_b32 v82, 3, v82
    v_lshrrev_b32 v83, 5, v2
    v_add_u32 v82, v82, v83
    v_lshlrev_b32 v181, 14, v82
    v_bfe_u32 v82, v2, 3, 2
    v_sub_u32 v82, 3, v82
    v_lshl_add_u32 v181, v82, 6, v181
    v_and_b32 v82, 3, v2
    v_lshl_add_u32 v181, v82, 4, v181
    s_lshl_b32 s6, s46, 18
    s_add_u32 s6, s6, 8404736
    s_lshl_b32 s3, s45, 10
    s_sub_u32 s6, s6, s3
    s_lshl_b32 s3, s44, 8
    s_sub_u32 s6, s6, s3
    s_lshl_b32 s13, s46, 4
    s_add_u32 s13, s13, s45
    s_lshl_b32 s13, s13, 2
    s_add_u32 s13, s13, s44
    s_lshl_b32 s13, s13, 3
    s_add_u32 s13, s13, 21495808
    s_lshl_b32 s18, s46, 2
    s_add_u32 s18, s18, s44
    s_lshl_b32 s18, s18, 4
    s_add_u32 s18, s18, s45
    s_lshl_b32 s18, s18, 3
    s_add_u32 s18, s18, 21504000
    s_lshl_b32 s3, s46, 9
    s_add_u32 s3, s3, 21495808
    v_lshrrev_b32 v182, 1, v17
    v_add_u32 v182, s3, v182
    s_lshl_b32 s19, s46, 6
    s_lshr_b32 s3, s45, 3
    s_lshl_b32 s3, s3, 5
    s_add_u32 s19, s19, s3
    s_lshl_b32 s3, s44, 3
    s_add_u32 s19, s19, s3
    s_and_b32 s3, s45, 7
    s_add_u32 s19, s19, s3
    s_lshl_b32 s22, s19, 12
    s_add_u32 s76, s30, s22
    s_addc_u32 s77, s31, 0
    s_mov_b32 s78, 4096
    s_mov_b32 s79, 131072
    s_mov_b32 s80, s32
    s_mov_b32 s81, s33
    s_mov_b32 s82, 2048
    s_mov_b32 s83, 131072
    s_lshl_b32 s3, s19, 1
    v_mov_b32 v183, s3
    buffer_load_ushort v183, v183, s[80:83], 0 offen
    s_mul_i32 s23, s44, 8320
    s_add_u32 s23, s23, 65536
    v_lshrrev_b32 v224, 4, v2
    v_and_b32 v225, 3, v2
    v_xor_b32 v225, v225, v224
    v_lshlrev_b32 v225, 4, v225
    v_lshrrev_b32 v224, 2, v2
    v_lshl_add_u32 v207, v224, 6, v225
    s_lshl_b32 s28, s46, 4
    s_add_u32 s28, s28, s45
    s_lshl_b32 s28, s28, 14
    s_lshl_b32 s29, s44, 12
    s_add_u32 s28, s28, s29
    s_add_u32 s28, s28, 8388608
    s_add_u32 s29, s29, 132096
    s_mov_b32 s80, s14
    s_mov_b32 s81, s15
    s_mov_b32 s82, 2097152
    s_mov_b32 s83, 131072
    s_mov_b32 s84, s16
    s_mov_b32 s85, s17
    s_mov_b32 s86, 2097152
    s_mov_b32 s87, 131072
    v_lshrrev_b32 v225, 2, v2
    v_lshrrev_b32 v226, 4, v2
    v_xor_b32 v226, v226, v2
    v_and_b32 v226, 3, v226
    v_lshlrev_b32 v226, 4, v226
    v_lshl_add_u32 v224, v225, 11, v226
    s_lshl_b32 s14, s46, 17
    s_and_b32 s3, s44, 1
    s_lshl_b32 s3, s3, 16
    s_add_u32 s14, s14, s3
    s_lshl_b32 s3, s45, 7
    s_add_u32 s14, s14, s3
    s_lshr_b32 s3, s44, 1
    s_lshl_b32 s3, s3, 6
    s_add_u32 s14, s14, s3
    s_add_u32 s15, s14, 32768
    s_lshl_b32 s16, s44, 12
    s_add_u32 s16, s16, 132096
    s_mov_b32 s88, s34
    s_mov_b32 s89, s35
    s_mov_b32 s90, 2048
    s_mov_b32 s91, 131072
    s_lshl_b32 s17, s45, 7
    s_lshl_b32 s3, s46, 3
    s_add_u32 s17, s17, s3
    s_lshl_b32 s3, s44, 1
    s_add_u32 s17, s17, s3
    s_lshl_b32 s3, s17, 2
    s_add_u32 s3, s3, 20971520
    v_mov_b32 v225, s3
    s_lshl_b32 s17, s17, 11
    s_mov_b32 s32, 8192
    buffer_load_dwordx4 v[208:211], v17, s[88:91], 0 offen offset:0
    buffer_load_dwordx4 v[212:215], v17, s[88:91], 0 offen offset:1024
    buffer_load_dwordx4 v[46:49], v17, s[56:59], s17 offen offset:0
    buffer_load_dwordx4 v[50:53], v17, s[56:59], s17 offen offset:1024
    buffer_load_dwordx4 v[54:57], v17, s[56:59], s17 offen offset:2048
    buffer_load_dwordx4 v[58:61], v17, s[56:59], s17 offen offset:3072
    s_waitcnt vmcnt(18)
    s_barrier
    ds_read_b128 v[84:87], v66 offset:0
    ds_read_b128 v[92:95], v74 offset:0
    ds_read_b128 v[96:99], v74 offset:4096
    ds_read_b128 v[88:91], v66 offset:4096
    s_add_u32 s51, s51, 128
    s_and_b32 s51, s51, 0x7ff
    s_add_u32 s52, s47, s51
    s_add_u32 m0, s49, 65536
    s_waitcnt lgkmcnt(2)
    v_mfma_f32_32x32x16_bf16 v[116:131], v[84:87], v[92:95], 0
    ds_read_b128 v[100:103], v67 offset:0
    ds_read_b128 v[108:111], v75 offset:0
    buffer_load_dwordx4 v8, s[56:59], s52 offen  lds
    s_add_u32 m0, s49, 66560
    s_waitcnt lgkmcnt(3)
    v_mfma_f32_32x32x16_bf16 v[132:147], v[84:87], v[96:99], 0
    ds_read_b128 v[112:115], v75 offset:4096
    ds_read_b128 v[104:107], v67 offset:4096
    buffer_load_dwordx4 v9, s[56:59], s52 offen  lds
    s_add_u32 m0, s49, 67584
    s_waitcnt lgkmcnt(4)
    v_mfma_f32_32x32x16_bf16 v[148:163], v[88:91], v[92:95], 0
    buffer_load_dwordx4 v10, s[56:59], s52 offen  lds
    s_add_u32 m0, s49, 68608
    v_mfma_f32_32x32x16_bf16 v[164:179], v[88:91], v[96:99], 0
    buffer_load_dwordx4 v11, s[56:59], s52 offen  lds
    s_add_u32 s53, s48, s51
    s_add_u32 m0, s49, 81920
    s_waitcnt lgkmcnt(2)
    v_mfma_f32_32x32x16_bf16 v[116:131], v[100:103], v[108:111], v[116:131]
    ds_read_b128 v[84:87], v68 offset:0
    ds_read_b128 v[92:95], v76 offset:0
    buffer_load_dwordx4 v12, s[60:63], s53 offen  lds
    s_add_u32 m0, s49, 82944
    s_waitcnt lgkmcnt(3)
    v_mfma_f32_32x32x16_bf16 v[132:147], v[100:103], v[112:115], v[132:147]
    ds_read_b128 v[96:99], v76 offset:4096
    ds_read_b128 v[88:91], v68 offset:4096
    buffer_load_dwordx4 v13, s[60:63], s53 offen  lds
    s_add_u32 m0, s49, 83968
    s_waitcnt lgkmcnt(4)
    v_mfma_f32_32x32x16_bf16 v[148:163], v[104:107], v[108:111], v[148:163]
    buffer_load_dwordx4 v14, s[60:63], s53 offen  lds
    s_add_u32 m0, s49, 84992
    v_mfma_f32_32x32x16_bf16 v[164:179], v[104:107], v[112:115], v[164:179]
    buffer_load_dwordx4 v15, s[60:63], s53 offen  lds
    s_add_u32 s51, s51, 128
    s_and_b32 s51, s51, 0x7ff
    s_add_u32 s52, s47, s51
    s_add_u32 m0, s49, 98304
    s_waitcnt lgkmcnt(2)
    v_mfma_f32_32x32x16_bf16 v[116:131], v[84:87], v[92:95], v[116:131]
    ds_read_b128 v[100:103], v69 offset:0
    ds_read_b128 v[108:111], v77 offset:0
    buffer_load_dwordx4 v8, s[56:59], s52 offen  lds
    s_add_u32 m0, s49, 99328
    s_waitcnt lgkmcnt(3)
    v_mfma_f32_32x32x16_bf16 v[132:147], v[84:87], v[96:99], v[132:147]
    ds_read_b128 v[112:115], v77 offset:4096
    ds_read_b128 v[104:107], v69 offset:4096
    buffer_load_dwordx4 v9, s[56:59], s52 offen  lds
    s_add_u32 m0, s49, 100352
    s_waitcnt lgkmcnt(4)
    v_mfma_f32_32x32x16_bf16 v[148:163], v[88:91], v[92:95], v[148:163]
    buffer_load_dwordx4 v10, s[56:59], s52 offen  lds
    s_add_u32 m0, s49, 101376
    v_mfma_f32_32x32x16_bf16 v[164:179], v[88:91], v[96:99], v[164:179]
    buffer_load_dwordx4 v11, s[56:59], s52 offen  lds
    s_waitcnt lgkmcnt(0)
    s_waitcnt vmcnt(22)
    s_barrier
    s_add_u32 s53, s48, s51
    s_add_u32 m0, s49, 114688
    v_mfma_f32_32x32x16_bf16 v[116:131], v[100:103], v[108:111], v[116:131]
    ds_read_b128 v[84:87], v66 offset:32768
    ds_read_b128 v[92:95], v74 offset:32768
    buffer_load_dwordx4 v12, s[60:63], s53 offen  lds
    s_waitcnt vmcnt(22)
    v_lshlrev_b32 v63, 16, v63
    s_waitcnt vmcnt(21)
    v_lshlrev_b32 v64, 16, v64
    s_waitcnt vmcnt(20)
    v_lshlrev_b32 v65, 16, v65
    v_mul_f32 v242, 1069066811, v65
    s_add_u32 m0, s49, 115712
    v_mfma_f32_32x32x16_bf16 v[132:147], v[100:103], v[112:115], v[132:147]
    ds_read_b128 v[96:99], v74 offset:36864
    ds_read_b128 v[88:91], v66 offset:36864
    buffer_load_dwordx4 v13, s[60:63], s53 offen  lds
    v_exp_f32 v242, v242
    s_nop 0
    v_cvt_pk_bf16_f32 v242, v242, v242
    v_lshlrev_b32 v242, 16, v242
    v_mul_f32 v243, v242, v63
    s_add_u32 m0, s49, 116736
    v_mfma_f32_32x32x16_bf16 v[148:163], v[104:107], v[108:111], v[148:163]
    buffer_load_dwordx4 v14, s[60:63], s53 offen  lds
    v_mul_f32 v244, v242, v64
    v_mul_f32 v243, 1069066811, v243
    v_exp_f32 v243, v243
    v_mul_f32 v244, 1042479491, v244
    v_fract_f32 v244, v244
    v_cos_f32 v245, v244
    s_add_u32 m0, s49, 117760
    v_mfma_f32_32x32x16_bf16 v[164:179], v[104:107], v[112:115], v[164:179]
    buffer_load_dwordx4 v15, s[60:63], s53 offen  lds
    v_sin_f32 v246, v244
    v_mul_f32 v230, v243, v245
    v_mul_f32 v231, v243, v246
    v_add_f32 v242, -1.0, v230
    v_mul_f32 v243, v63, v63
    v_fmac_f32 v243, v64, v64
    v_rcp_f32 v243, v243
    s_add_u32 s51, s51, 128
    s_and_b32 s51, s51, 0x7ff
    s_add_u32 s52, s47, s51
    s_add_u32 m0, s49, 0
    s_waitcnt lgkmcnt(2)
    v_mfma_f32_32x32x16_bf16 v[116:131], v[84:87], v[92:95], v[116:131]
    ds_read_b128 v[100:103], v67 offset:32768
    ds_read_b128 v[108:111], v75 offset:32768
    buffer_load_dwordx4 v8, s[56:59], s52 offen  lds
    v_add_f32 v243, v243, v243
    v_mul_f32 v244, v242, v63
    v_fmac_f32 v244, v231, v64
    v_mul_f32 v245, v231, v63
    s_add_u32 m0, s49, 1024
    s_waitcnt lgkmcnt(3)
    v_mfma_f32_32x32x16_bf16 v[132:147], v[84:87], v[96:99], v[132:147]
    ds_read_b128 v[112:115], v75 offset:36864
    ds_read_b128 v[104:107], v67 offset:36864
    buffer_load_dwordx4 v9, s[56:59], s52 offen  lds
    v_fma_f32 v245, -v242, v64, v245
    v_mul_f32 v232, v244, v243
    v_mul_f32 v233, v245, v243
    v_mul_f32 v242, v231, v231
    s_add_u32 m0, s49, 2048
    s_waitcnt lgkmcnt(4)
    v_mfma_f32_32x32x16_bf16 v[148:163], v[88:91], v[92:95], v[148:163]
    buffer_load_dwordx4 v10, s[56:59], s52 offen  lds
    v_fma_f32 v242, v230, v230, -v242
    v_mul_f32 v243, v230, v231
    v_add_f32 v243, v243, v243
    v_mul_f32 v244, v243, v243
    v_fma_f32 v244, v242, v242, -v244
    v_mul_f32 v245, v242, v243
    s_add_u32 m0, s49, 3072
    v_mfma_f32_32x32x16_bf16 v[164:179], v[88:91], v[96:99], v[164:179]
    buffer_load_dwordx4 v11, s[56:59], s52 offen  lds
    v_add_f32 v245, v245, v245
    v_mul_f32 v242, v245, v245
    v_fma_f32 v242, v244, v244, -v242
    v_mul_f32 v243, v244, v245
    v_add_f32 v243, v243, v243
    v_mul_f32 v234, v243, v243
    v_fma_f32 v234, v242, v242, -v234
    s_add_u32 s53, s48, s51
    s_add_u32 m0, s49, 16384
    s_waitcnt lgkmcnt(2)
    v_mfma_f32_32x32x16_bf16 v[116:131], v[100:103], v[108:111], v[116:131]
    ds_read_b128 v[84:87], v68 offset:32768
    ds_read_b128 v[92:95], v76 offset:32768
    buffer_load_dwordx4 v12, s[60:63], s53 offen  lds
    v_mul_f32 v235, v242, v243
    v_add_f32 v235, v235, v235
    v_mul_f32 v242, v235, v235
    v_fma_f32 v242, v234, v234, -v242
    s_add_u32 m0, s49, 17408
    s_waitcnt lgkmcnt(3)
    v_mfma_f32_32x32x16_bf16 v[132:147], v[100:103], v[112:115], v[132:147]
    ds_read_b128 v[96:99], v76 offset:36864
    ds_read_b128 v[88:91], v68 offset:36864
    buffer_load_dwordx4 v13, s[60:63], s53 offen  lds
    v_mul_f32 v243, v234, v235
    v_add_f32 v243, v243, v243
    v_mul_f32 v244, v243, v243
    v_fma_f32 v244, v242, v242, -v244
    s_add_u32 m0, s49, 18432
    s_waitcnt lgkmcnt(4)
    v_mfma_f32_32x32x16_bf16 v[148:163], v[104:107], v[108:111], v[148:163]
    buffer_load_dwordx4 v14, s[60:63], s53 offen  lds
    v_mul_f32 v245, v242, v243
    v_add_f32 v245, v245, v245
    v_mul_f32 v236, v245, v245
    v_fma_f32 v236, v244, v244, -v236
    v_mul_f32 v237, v244, v245
    v_add_f32 v237, v237, v237
    s_add_u32 m0, s49, 19456
    v_mfma_f32_32x32x16_bf16 v[164:179], v[104:107], v[112:115], v[164:179]
    buffer_load_dwordx4 v15, s[60:63], s53 offen  lds
    s_mov_b32 s34, 0
    s_mov_b32 s35, -1
    s_lshr_b32 s3, s44, 1
    s_cmp_eq_u32 s3, 1
    s_cselect_b32 s38, -1, 0
    s_cselect_b32 s39, -1, 0
    v_cndmask_b32 v242, 1.0, v242, s[34:35]
    v_cndmask_b32 v243, 0, v243, s[34:35]
    v_cndmask_b32 v244, 1.0, v244, s[38:39]
    s_waitcnt lgkmcnt(2)
    v_mfma_f32_32x32x16_bf16 v[116:131], v[84:87], v[92:95], v[116:131]
    ds_read_b128 v[100:103], v69 offset:32768
    ds_read_b128 v[108:111], v77 offset:32768
    v_cndmask_b32 v245, 0, v245, s[38:39]
    v_mul_f32 v246, v243, v245
    v_fma_f32 v246, v242, v244, -v246
    v_mul_f32 v247, v242, v245
    v_fmac_f32 v247, v243, v244
    v_mul_f32 v242, v247, v235
    s_waitcnt lgkmcnt(3)
    v_mfma_f32_32x32x16_bf16 v[132:147], v[84:87], v[96:99], v[132:147]
    ds_read_b128 v[112:115], v77 offset:36864
    ds_read_b128 v[104:107], v69 offset:36864
    v_fma_f32 v242, v246, v234, -v242
    v_mul_f32 v243, v246, v235
    v_fmac_f32 v243, v247, v234
    v_mov_b32 v238, v246
    v_mov_b32 v239, v242
    v_mov_b32 v240, v247
    s_waitcnt lgkmcnt(4)
    v_mfma_f32_32x32x16_bf16 v[148:163], v[88:91], v[92:95], v[148:163]
    v_mov_b32 v241, v243
    v_mfma_f32_32x32x16_bf16 v[164:179], v[88:91], v[96:99], v[164:179]
    s_waitcnt lgkmcnt(0)
    s_waitcnt vmcnt(16)
    s_barrier
    s_add_u32 s51, s51, 128
    s_and_b32 s51, s51, 0x7ff
    s_add_u32 s52, s47, s51
    s_add_u32 m0, s49, 32768
    v_mfma_f32_32x32x16_bf16 v[116:131], v[100:103], v[108:111], v[116:131]
    ds_read_b128 v[84:87], v70 offset:0
    ds_read_b128 v[92:95], v78 offset:0
    buffer_load_dwordx4 v8, s[56:59], s52 offen  lds
    v_lshlrev_b32 v203, 16, v208
    v_and_b32 v204, s5, v208
    v_lshlrev_b32 v205, 16, v46
    v_and_b32 v206, s5, v46
    s_add_u32 m0, s49, 33792
    v_mfma_f32_32x32x16_bf16 v[132:147], v[100:103], v[112:115], v[132:147]
    ds_read_b128 v[96:99], v78 offset:4096
    ds_read_b128 v[88:91], v70 offset:4096
    buffer_load_dwordx4 v9, s[56:59], s52 offen  lds
    v_mul_f32 v226, v203, v205
    v_fmac_f32 v226, v204, v206
    v_lshlrev_b32 v205, 16, v54
    v_and_b32 v206, s5, v54
    s_add_u32 m0, s49, 34816
    v_mfma_f32_32x32x16_bf16 v[148:163], v[104:107], v[108:111], v[148:163]
    buffer_load_dwordx4 v10, s[56:59], s52 offen  lds
    v_mul_f32 v227, v203, v205
    v_fmac_f32 v227, v204, v206
    v_lshlrev_b32 v203, 16, v209
    v_and_b32 v204, s5, v209
    v_lshlrev_b32 v205, 16, v47
    v_and_b32 v206, s5, v47
    s_add_u32 m0, s49, 35840
    v_mfma_f32_32x32x16_bf16 v[164:179], v[104:107], v[112:115], v[164:179]
    buffer_load_dwordx4 v11, s[56:59], s52 offen  lds
    v_fmac_f32 v226, v203, v205
    v_fmac_f32 v226, v204, v206
    v_lshlrev_b32 v205, 16, v55
    v_and_b32 v206, s5, v55
    v_fmac_f32 v227, v203, v205
    v_fmac_f32 v227, v204, v206
    v_lshlrev_b32 v203, 16, v210
    s_add_u32 s53, s48, s51
    s_add_u32 m0, s49, 49152
    s_waitcnt lgkmcnt(2)
    v_mfma_f32_32x32x16_bf16 v[116:131], v[84:87], v[92:95], v[116:131]
    ds_read_b128 v[100:103], v71 offset:0
    ds_read_b128 v[108:111], v79 offset:0
    buffer_load_dwordx4 v12, s[60:63], s53 offen  lds
    v_and_b32 v204, s5, v210
    v_lshlrev_b32 v205, 16, v48
    v_and_b32 v206, s5, v48
    v_fmac_f32 v226, v203, v205
    s_add_u32 m0, s49, 50176
    s_waitcnt lgkmcnt(3)
    v_mfma_f32_32x32x16_bf16 v[132:147], v[84:87], v[96:99], v[132:147]
    ds_read_b128 v[112:115], v79 offset:4096
    ds_read_b128 v[104:107], v71 offset:4096
    buffer_load_dwordx4 v13, s[60:63], s53 offen  lds
    v_fmac_f32 v226, v204, v206
    v_lshlrev_b32 v205, 16, v56
    v_and_b32 v206, s5, v56
    v_fmac_f32 v227, v203, v205
    s_add_u32 m0, s49, 51200
    s_waitcnt lgkmcnt(4)
    v_mfma_f32_32x32x16_bf16 v[148:163], v[88:91], v[92:95], v[148:163]
    buffer_load_dwordx4 v14, s[60:63], s53 offen  lds
    v_fmac_f32 v227, v204, v206
    v_lshlrev_b32 v203, 16, v211
    v_and_b32 v204, s5, v211
    v_lshlrev_b32 v205, 16, v49
    v_and_b32 v206, s5, v49
    v_fmac_f32 v226, v203, v205
    s_add_u32 m0, s49, 52224
    v_mfma_f32_32x32x16_bf16 v[164:179], v[88:91], v[96:99], v[164:179]
    buffer_load_dwordx4 v15, s[60:63], s53 offen  lds
    v_fmac_f32 v226, v204, v206
    v_lshlrev_b32 v205, 16, v57
    v_and_b32 v206, s5, v57
    v_fmac_f32 v227, v203, v205
    v_fmac_f32 v227, v204, v206
    v_lshlrev_b32 v203, 16, v212
    v_and_b32 v204, s5, v212
    s_waitcnt lgkmcnt(2)
    v_mfma_f32_32x32x16_bf16 v[116:131], v[100:103], v[108:111], v[116:131]
    ds_read_b128 v[84:87], v72 offset:0
    ds_read_b128 v[92:95], v80 offset:0
    v_lshlrev_b32 v205, 16, v50
    v_and_b32 v206, s5, v50
    v_fmac_f32 v226, v203, v205
    v_fmac_f32 v226, v204, v206
    v_lshlrev_b32 v205, 16, v58
    v_and_b32 v206, s5, v58
    s_waitcnt lgkmcnt(3)
    v_mfma_f32_32x32x16_bf16 v[132:147], v[100:103], v[112:115], v[132:147]
    ds_read_b128 v[96:99], v80 offset:4096
    ds_read_b128 v[88:91], v72 offset:4096
    v_fmac_f32 v227, v203, v205
    v_fmac_f32 v227, v204, v206
    v_lshlrev_b32 v203, 16, v213
    v_and_b32 v204, s5, v213
    v_lshlrev_b32 v205, 16, v51
    v_and_b32 v206, s5, v51
    s_waitcnt lgkmcnt(4)
    v_mfma_f32_32x32x16_bf16 v[148:163], v[104:107], v[108:111], v[148:163]
    v_fmac_f32 v226, v203, v205
    v_fmac_f32 v226, v204, v206
    v_lshlrev_b32 v205, 16, v59
    v_and_b32 v206, s5, v59
    v_fmac_f32 v227, v203, v205
    v_fmac_f32 v227, v204, v206
    v_lshlrev_b32 v203, 16, v214
    v_and_b32 v204, s5, v214
    v_mfma_f32_32x32x16_bf16 v[164:179], v[104:107], v[112:115], v[164:179]
    v_lshlrev_b32 v205, 16, v52
    v_and_b32 v206, s5, v52
    v_fmac_f32 v226, v203, v205
    v_fmac_f32 v226, v204, v206
    v_lshlrev_b32 v205, 16, v60
    v_and_b32 v206, s5, v60
    v_fmac_f32 v227, v203, v205
    v_fmac_f32 v227, v204, v206
    s_waitcnt lgkmcnt(2)
    v_mfma_f32_32x32x16_bf16 v[116:131], v[84:87], v[92:95], v[116:131]
    ds_read_b128 v[100:103], v73 offset:0
    ds_read_b128 v[108:111], v81 offset:0
    v_lshlrev_b32 v203, 16, v215
    v_and_b32 v204, s5, v215
    v_lshlrev_b32 v205, 16, v53
    v_and_b32 v206, s5, v53
    v_fmac_f32 v226, v203, v205
    v_fmac_f32 v226, v204, v206
    s_waitcnt lgkmcnt(3)
    v_mfma_f32_32x32x16_bf16 v[132:147], v[84:87], v[96:99], v[132:147]
    ds_read_b128 v[112:115], v81 offset:4096
    ds_read_b128 v[104:107], v73 offset:4096
    v_lshlrev_b32 v205, 16, v61
    v_and_b32 v206, s5, v61
    v_fmac_f32 v227, v203, v205
    v_fmac_f32 v227, v204, v206
    v_add_f32_dpp v226, v226, v226 row_shr:1 row_mask:0xf bank_mask:0xf bound_ctrl:0
    s_nop 0
    v_add_f32_dpp v227, v227, v227 row_shr:1 row_mask:0xf bank_mask:0xf bound_ctrl:0
    s_waitcnt lgkmcnt(4)
    v_mfma_f32_32x32x16_bf16 v[148:163], v[88:91], v[92:95], v[148:163]
    v_add_f32_dpp v226, v226, v226 row_shr:2 row_mask:0xf bank_mask:0xf bound_ctrl:0
    v_add_f32_dpp v227, v227, v227 row_shr:2 row_mask:0xf bank_mask:0xf bound_ctrl:0
    s_nop 0
    v_add_f32_dpp v226, v226, v226 row_shr:4 row_mask:0xf bank_mask:0xf bound_ctrl:0
    v_add_f32_dpp v227, v227, v227 row_shr:4 row_mask:0xf bank_mask:0xf bound_ctrl:0
    s_nop 0
    v_add_f32_dpp v226, v226, v226 row_shr:8 row_mask:0xf bank_mask:0xf bound_ctrl:0
    v_add_f32_dpp v227, v227, v227 row_shr:8 row_mask:0xf bank_mask:0xf bound_ctrl:0
    s_nop 0
    v_add_f32_dpp v226, v226, v226 row_bcast:15 row_mask:0xa bank_mask:0xf
    v_add_f32_dpp v227, v227, v227 row_bcast:15 row_mask:0xa bank_mask:0xf
    v_mfma_f32_32x32x16_bf16 v[164:179], v[88:91], v[96:99], v[164:179]
    v_add_f32_dpp v226, v226, v226 row_bcast:31 row_mask:0xc bank_mask:0xf
    v_add_f32_dpp v227, v227, v227 row_bcast:31 row_mask:0xc bank_mask:0xf
    v_cvt_pk_bf16_f32 v203, v226, v227
    v_lshlrev_b32 v226, 16, v203
    v_and_b32 v227, s5, v203
    v_mul_f32 v226, 0xbfb8aa3b, v226
    v_mul_f32 v227, 0xbfb8aa3b, v227
    v_exp_f32 v226, v226
    s_waitcnt lgkmcnt(0)
    s_waitcnt vmcnt(16)
    s_barrier
    s_add_u32 s51, s51, 128
    s_and_b32 s51, s51, 0x7ff
    s_add_u32 s52, s47, s51
    s_add_u32 m0, s49, 65536
    v_mfma_f32_32x32x16_bf16 v[116:131], v[100:103], v[108:111], v[116:131]
    ds_read_b128 v[84:87], v70 offset:32768
    ds_read_b128 v[92:95], v78 offset:32768
    buffer_load_dwordx4 v8, s[56:59], s52 offen  lds
    v_exp_f32 v227, v227
    v_add_f32 v226, 1.0, v226
    v_add_f32 v227, 1.0, v227
    v_rcp_f32 v226, v226
    s_add_u32 m0, s49, 66560
    v_mfma_f32_32x32x16_bf16 v[132:147], v[100:103], v[112:115], v[132:147]
    ds_read_b128 v[96:99], v78 offset:36864
    ds_read_b128 v[88:91], v70 offset:36864
    buffer_load_dwordx4 v9, s[56:59], s52 offen  lds
    v_rcp_f32 v227, v227
    s_nop 0
    v_cvt_pk_bf16_f32 v203, v226, v227
    v_lshlrev_b32 v226, 16, v203
    v_and_b32 v227, s5, v203
    s_add_u32 m0, s49, 67584
    v_mfma_f32_32x32x16_bf16 v[148:163], v[104:107], v[108:111], v[148:163]
    buffer_load_dwordx4 v10, s[56:59], s52 offen  lds
    v_sub_f32 v228, 1.0, v226
    v_sub_f32 v229, 1.0, v227
    v_cvt_pk_bf16_f32 v203, v228, v229
    v_lshlrev_b32 v228, 16, v203
    v_and_b32 v229, s5, v203
    s_add_u32 m0, s49, 68608
    v_mfma_f32_32x32x16_bf16 v[164:179], v[104:107], v[112:115], v[164:179]
    buffer_load_dwordx4 v11, s[56:59], s52 offen  lds
    s_add_u32 s53, s48, s51
    s_add_u32 m0, s49, 81920
    s_waitcnt lgkmcnt(2)
    v_mfma_f32_32x32x16_bf16 v[116:131], v[84:87], v[92:95], v[116:131]
    ds_read_b128 v[100:103], v71 offset:32768
    ds_read_b128 v[108:111], v79 offset:32768
    buffer_load_dwordx4 v12, s[60:63], s53 offen  lds
    s_add_u32 m0, s49, 82944
    s_waitcnt lgkmcnt(3)
    v_mfma_f32_32x32x16_bf16 v[132:147], v[84:87], v[96:99], v[132:147]
    ds_read_b128 v[112:115], v79 offset:36864
    ds_read_b128 v[104:107], v71 offset:36864
    buffer_load_dwordx4 v13, s[60:63], s53 offen  lds
    s_add_u32 m0, s49, 83968
    s_waitcnt lgkmcnt(4)
    v_mfma_f32_32x32x16_bf16 v[148:163], v[88:91], v[92:95], v[148:163]
    buffer_load_dwordx4 v14, s[60:63], s53 offen  lds
    s_add_u32 m0, s49, 84992
    v_mfma_f32_32x32x16_bf16 v[164:179], v[88:91], v[96:99], v[164:179]
    buffer_load_dwordx4 v15, s[60:63], s53 offen  lds
    s_mov_b32 m0, s4
    s_waitcnt lgkmcnt(2)
    v_mfma_f32_32x32x16_bf16 v[116:131], v[100:103], v[108:111], v[116:131]
    ds_read_b128 v[84:87], v72 offset:32768
    ds_read_b128 v[92:95], v80 offset:32768
    buffer_load_dwordx4 v17, s[64:67], s54 offen lds
    s_waitcnt lgkmcnt(3)
    v_mfma_f32_32x32x16_bf16 v[132:147], v[100:103], v[112:115], v[132:147]
    ds_read_b128 v[96:99], v80 offset:36864
    ds_read_b128 v[88:91], v72 offset:36864
    buffer_load_dwordx4 v[18:21], v18, s[68:71], 0 offen
    s_waitcnt lgkmcnt(4)
    v_mfma_f32_32x32x16_bf16 v[148:163], v[104:107], v[108:111], v[148:163]
    buffer_load_dwordx4 v[22:25], v22, s[68:71], 0 offen
    v_mfma_f32_32x32x16_bf16 v[164:179], v[104:107], v[112:115], v[164:179]
    buffer_load_dwordx4 v[26:29], v26, s[68:71], 0 offen
    s_waitcnt lgkmcnt(2)
    v_mfma_f32_32x32x16_bf16 v[116:131], v[84:87], v[92:95], v[116:131]
    ds_read_b128 v[100:103], v73 offset:32768
    ds_read_b128 v[108:111], v81 offset:32768
    buffer_load_dwordx4 v[30:33], v16, s[68:71], 0 offen offset:0
    s_waitcnt lgkmcnt(3)
    v_mfma_f32_32x32x16_bf16 v[132:147], v[84:87], v[96:99], v[132:147]
    ds_read_b128 v[112:115], v81 offset:36864
    ds_read_b128 v[104:107], v73 offset:36864
    buffer_load_dwordx4 v[34:37], v16, s[68:71], 0 offen offset:2048
    s_waitcnt lgkmcnt(4)
    v_mfma_f32_32x32x16_bf16 v[148:163], v[88:91], v[92:95], v[148:163]
    buffer_load_dwordx4 v[38:41], v16, s[68:71], s50 offen offset:0
    v_mfma_f32_32x32x16_bf16 v[164:179], v[88:91], v[96:99], v[164:179]
    buffer_load_dwordx4 v[42:45], v16, s[68:71], s50 offen offset:2048
    s_waitcnt lgkmcnt(0)
    s_waitcnt vmcnt(24)
    s_barrier
    v_mfma_f32_32x32x16_bf16 v[116:131], v[100:103], v[108:111], v[116:131]
    ds_read_b128 v[84:87], v66 offset:0
    ds_read_b128 v[92:95], v74 offset:0
    buffer_load_dwordx4 v[46:49], v16, s[72:75], 0 offen offset:0
    v_mfma_f32_32x32x16_bf16 v[132:147], v[100:103], v[112:115], v[132:147]
    ds_read_b128 v[96:99], v74 offset:4096
    ds_read_b128 v[88:91], v66 offset:4096
    buffer_load_dwordx4 v[50:53], v16, s[72:75], 0 offen offset:2048
    v_mfma_f32_32x32x16_bf16 v[148:163], v[104:107], v[108:111], v[148:163]
    buffer_load_dwordx4 v[54:57], v16, s[72:75], s50 offen offset:0
    v_mfma_f32_32x32x16_bf16 v[164:179], v[104:107], v[112:115], v[164:179]
    buffer_load_dwordx4 v[58:61], v16, s[72:75], s50 offen offset:2048
    s_add_u32 s51, s51, 128
    s_and_b32 s51, s51, 0x7ff
    s_add_u32 s52, s47, s51
    s_add_u32 m0, s49, 98304
    s_waitcnt lgkmcnt(2)
    v_mfma_f32_32x32x16_bf16 v[116:131], v[84:87], v[92:95], v[116:131]
    ds_read_b128 v[100:103], v67 offset:0
    ds_read_b128 v[108:111], v75 offset:0
    buffer_load_dwordx4 v8, s[56:59], s52 offen  lds
    s_add_u32 m0, s49, 99328
    s_waitcnt lgkmcnt(3)
    v_mfma_f32_32x32x16_bf16 v[132:147], v[84:87], v[96:99], v[132:147]
    ds_read_b128 v[112:115], v75 offset:4096
    ds_read_b128 v[104:107], v67 offset:4096
    buffer_load_dwordx4 v9, s[56:59], s52 offen  lds
    s_add_u32 m0, s49, 100352
    s_waitcnt lgkmcnt(4)
    v_mfma_f32_32x32x16_bf16 v[148:163], v[88:91], v[92:95], v[148:163]
    buffer_load_dwordx4 v10, s[56:59], s52 offen  lds
    s_add_u32 m0, s49, 101376
    v_mfma_f32_32x32x16_bf16 v[164:179], v[88:91], v[96:99], v[164:179]
    buffer_load_dwordx4 v11, s[56:59], s52 offen  lds
    s_add_u32 s53, s48, s51
    s_add_u32 m0, s49, 114688
    s_waitcnt lgkmcnt(2)
    v_mfma_f32_32x32x16_bf16 v[116:131], v[100:103], v[108:111], v[116:131]
    ds_read_b128 v[84:87], v68 offset:0
    ds_read_b128 v[92:95], v76 offset:0
    buffer_load_dwordx4 v12, s[60:63], s53 offen  lds
    s_add_u32 m0, s49, 115712
    s_waitcnt lgkmcnt(3)
    v_mfma_f32_32x32x16_bf16 v[132:147], v[100:103], v[112:115], v[132:147]
    ds_read_b128 v[96:99], v76 offset:4096
    ds_read_b128 v[88:91], v68 offset:4096
    buffer_load_dwordx4 v13, s[60:63], s53 offen  lds
    s_add_u32 m0, s49, 116736
    s_waitcnt lgkmcnt(4)
    v_mfma_f32_32x32x16_bf16 v[148:163], v[104:107], v[108:111], v[148:163]
    buffer_load_dwordx4 v14, s[60:63], s53 offen  lds
    s_add_u32 m0, s49, 117760
    v_mfma_f32_32x32x16_bf16 v[164:179], v[104:107], v[112:115], v[164:179]
    buffer_load_dwordx4 v15, s[60:63], s53 offen  lds
    s_waitcnt lgkmcnt(2)
    v_mfma_f32_32x32x16_bf16 v[116:131], v[84:87], v[92:95], v[116:131]
    ds_read_b128 v[100:103], v69 offset:0
    ds_read_b128 v[108:111], v77 offset:0
    s_waitcnt lgkmcnt(3)
    v_mfma_f32_32x32x16_bf16 v[132:147], v[84:87], v[96:99], v[132:147]
    ds_read_b128 v[112:115], v77 offset:4096
    ds_read_b128 v[104:107], v69 offset:4096
    s_waitcnt lgkmcnt(4)
    v_mfma_f32_32x32x16_bf16 v[148:163], v[88:91], v[92:95], v[148:163]
    v_mfma_f32_32x32x16_bf16 v[164:179], v[88:91], v[96:99], v[164:179]
    s_waitcnt lgkmcnt(0)
    s_waitcnt vmcnt(28)
    s_barrier
    s_add_u32 s51, s51, 128
    s_and_b32 s51, s51, 0x7ff
    s_add_u32 s52, s47, s51
    s_add_u32 m0, s49, 0
    v_mfma_f32_32x32x16_bf16 v[116:131], v[100:103], v[108:111], v[116:131]
    ds_read_b128 v[84:87], v66 offset:32768
    ds_read_b128 v[92:95], v74 offset:32768
    buffer_load_dwordx4 v8, s[56:59], s52 offen  lds
    s_add_u32 m0, s49, 1024
    v_mfma_f32_32x32x16_bf16 v[132:147], v[100:103], v[112:115], v[132:147]
    ds_read_b128 v[96:99], v74 offset:36864
    ds_read_b128 v[88:91], v66 offset:36864
    buffer_load_dwordx4 v9, s[56:59], s52 offen  lds
    s_add_u32 m0, s49, 2048
    v_mfma_f32_32x32x16_bf16 v[148:163], v[104:107], v[108:111], v[148:163]
    buffer_load_dwordx4 v10, s[56:59], s52 offen  lds
    s_add_u32 m0, s49, 3072
    v_mfma_f32_32x32x16_bf16 v[164:179], v[104:107], v[112:115], v[164:179]
    buffer_load_dwordx4 v11, s[56:59], s52 offen  lds
    s_waitcnt lgkmcnt(2)
    v_mfma_f32_32x32x16_bf16 v[116:131], v[84:87], v[92:95], v[116:131]
    ds_read_b128 v[100:103], v67 offset:32768
    ds_read_b128 v[108:111], v75 offset:32768
    s_mov_b32 s7, 0x05040100
    s_mov_b32 s12, 0x07060302
    s_waitcnt vmcnt(23)
    s_waitcnt lgkmcnt(3)
    v_mfma_f32_32x32x16_bf16 v[132:147], v[84:87], v[96:99], v[132:147]
    ds_read_b128 v[112:115], v75 offset:36864
    ds_read_b128 v[104:107], v67 offset:36864
    ds_read_b128 v[184:187], v180 offset:0
    s_add_u32 s53, s48, s51
    s_add_u32 m0, s49, 16384
    s_waitcnt lgkmcnt(5)
    v_mfma_f32_32x32x16_bf16 v[148:163], v[88:91], v[92:95], v[148:163]
    buffer_load_dwordx4 v12, s[60:63], s53 offen  lds
    ds_read_b128 v[188:191], v180 offset:16
    s_waitcnt vmcnt(22)
    v_perm_b32 v196, v18, v22, s7
    s_waitcnt vmcnt(21)
    v_perm_b32 v197, v22, v26, s7
    s_add_u32 m0, s49, 17408
    v_mfma_f32_32x32x16_bf16 v[164:179], v[88:91], v[96:99], v[164:179]
    buffer_load_dwordx4 v13, s[60:63], s53 offen  lds
    s_waitcnt vmcnt(21)
    v_perm_b32 v198, v26, v30, s7
    s_waitcnt vmcnt(20)
    v_perm_b32 v199, v30, v34, s7
    s_waitcnt vmcnt(19)
    v_perm_b32 v200, v34, v38, s7
    s_waitcnt vmcnt(18)
    v_perm_b32 v201, v38, v42, s7
    s_waitcnt lgkmcnt(4)
    v_mfma_f32_32x32x16_bf16 v[116:131], v[100:103], v[108:111], v[116:131]
    ds_read_b128 v[84:87], v68 offset:32768
    ds_read_b128 v[92:95], v76 offset:32768
    s_waitcnt vmcnt(17)
    v_lshlrev_b32 v192, 16, v46
    s_waitcnt vmcnt(16)
    v_lshlrev_b32 v193, 16, v50
    s_waitcnt vmcnt(15)
    v_lshlrev_b32 v194, 16, v54
    s_waitcnt lgkmcnt(5)
    v_mfma_f32_32x32x16_bf16 v[132:147], v[100:103], v[112:115], v[132:147]
    ds_read_b128 v[96:99], v76 offset:36864
    ds_read_b128 v[88:91], v68 offset:36864
    s_waitcnt vmcnt(14)
    v_lshlrev_b32 v195, 16, v58
    s_waitcnt lgkmcnt(5)
    v_dot2_f32_bf16 v203, v196, v185, 0
    s_add_u32 m0, s49, 18432
    v_mfma_f32_32x32x16_bf16 v[148:163], v[104:107], v[108:111], v[148:163]
    buffer_load_dwordx4 v14, s[60:63], s53 offen  lds
    v_dot2_f32_bf16 v204, v197, v185, 0
    v_dot2_f32_bf16 v205, v198, v185, 0
    v_dot2_f32_bf16 v206, v199, v185, 0
    s_add_u32 m0, s49, 19456
    v_mfma_f32_32x32x16_bf16 v[164:179], v[104:107], v[112:115], v[164:179]
    buffer_load_dwordx4 v15, s[60:63], s53 offen  lds
    v_dot2c_f32_bf16 v203, v198, v184
    v_dot2c_f32_bf16 v204, v199, v184
    v_dot2c_f32_bf16 v205, v200, v184
    v_dot2c_f32_bf16 v206, v201, v184
    s_waitcnt lgkmcnt(2)
    v_mfma_f32_32x32x16_bf16 v[116:131], v[84:87], v[92:95], v[116:131]
    ds_read_b128 v[100:103], v69 offset:32768
    ds_read_b128 v[108:111], v77 offset:32768
    v_mul_f32 v203, v203, v192
    v_mul_f32 v204, v204, v193
    v_mul_f32 v205, v205, v194
    s_waitcnt lgkmcnt(3)
    v_mfma_f32_32x32x16_bf16 v[132:147], v[84:87], v[96:99], v[132:147]
    ds_read_b128 v[112:115], v77 offset:36864
    ds_read_b128 v[104:107], v69 offset:36864
    v_mul_f32 v206, v206, v195
    v_cvt_pk_bf16_f32 v210, v206, v205
    v_cvt_pk_bf16_f32 v211, v204, v203
    s_waitcnt lgkmcnt(4)
    v_mfma_f32_32x32x16_bf16 v[148:163], v[88:91], v[92:95], v[148:163]
    v_perm_b32 v196, v18, v22, s12
    v_perm_b32 v197, v22, v26, s12
    v_perm_b32 v198, v26, v30, s12
    v_perm_b32 v199, v30, v34, s12
    v_perm_b32 v200, v34, v38, s12
    v_mfma_f32_32x32x16_bf16 v[164:179], v[88:91], v[96:99], v[164:179]
    v_perm_b32 v201, v38, v42, s12
    v_and_b32 v192, s5, v46
    v_and_b32 v193, s5, v50
    v_and_b32 v194, s5, v54
    v_and_b32 v195, s5, v58
    s_waitcnt lgkmcnt(0)
    s_barrier
    v_mfma_f32_32x32x16_bf16 v[116:131], v[100:103], v[108:111], v[116:131]
    ds_read_b128 v[84:87], v70 offset:0
    ds_read_b128 v[92:95], v78 offset:0
    v_dot2_f32_bf16 v203, v196, v187, 0
    v_dot2_f32_bf16 v204, v197, v187, 0
    v_dot2_f32_bf16 v205, v198, v187, 0
    v_mfma_f32_32x32x16_bf16 v[132:147], v[100:103], v[112:115], v[132:147]
    ds_read_b128 v[96:99], v78 offset:4096
    ds_read_b128 v[88:91], v70 offset:4096
    s_add_u32 s51, s51, 128
    s_and_b32 s51, s51, 0x7ff
    s_add_u32 s52, s47, s51
    s_add_u32 m0, s49, 32768
    v_mfma_f32_32x32x16_bf16 v[148:163], v[104:107], v[108:111], v[148:163]
    buffer_load_dwordx4 v8, s[56:59], s52 offen  lds
    v_dot2_f32_bf16 v206, v199, v187, 0
    v_dot2c_f32_bf16 v203, v198, v186
    v_dot2c_f32_bf16 v204, v199, v186
    s_add_u32 m0, s49, 33792
    v_mfma_f32_32x32x16_bf16 v[164:179], v[104:107], v[112:115], v[164:179]
    buffer_load_dwordx4 v9, s[56:59], s52 offen  lds
    v_dot2c_f32_bf16 v205, v200, v186
    v_dot2c_f32_bf16 v206, v201, v186
    v_mul_f32 v203, v203, v192
    v_mul_f32 v204, v204, v193
    s_waitcnt lgkmcnt(2)
    v_mfma_f32_32x32x16_bf16 v[116:131], v[84:87], v[92:95], v[116:131]
    ds_read_b128 v[100:103], v71 offset:0
    ds_read_b128 v[108:111], v79 offset:0
    v_mul_f32 v205, v205, v194
    v_mul_f32 v206, v206, v195
    v_cvt_pk_bf16_f32 v208, v206, v205
    s_waitcnt lgkmcnt(3)
    v_mfma_f32_32x32x16_bf16 v[132:147], v[84:87], v[96:99], v[132:147]
    ds_read_b128 v[112:115], v79 offset:4096
    ds_read_b128 v[104:107], v71 offset:4096
    v_cvt_pk_bf16_f32 v209, v204, v203
    ds_read_b128 v[184:187], v180 offset:32
    s_add_u32 m0, s49, 34816
    s_waitcnt lgkmcnt(5)
    v_mfma_f32_32x32x16_bf16 v[148:163], v[88:91], v[92:95], v[148:163]
    buffer_load_dwordx4 v10, s[56:59], s52 offen  lds
    v_perm_b32 v196, v19, v23, s7
    v_perm_b32 v197, v23, v27, s7
    v_permlane32_swap_b32 v210, v208
    s_add_u32 m0, s49, 35840
    v_mfma_f32_32x32x16_bf16 v[164:179], v[88:91], v[96:99], v[164:179]
    buffer_load_dwordx4 v11, s[56:59], s52 offen  lds
    v_permlane32_swap_b32 v211, v209
    v_perm_b32 v198, v27, v31, s7
    v_perm_b32 v199, v31, v35, s7
    v_perm_b32 v200, v35, v39, s7
    s_waitcnt lgkmcnt(3)
    v_mfma_f32_32x32x16_bf16 v[116:131], v[100:103], v[108:111], v[116:131]
    ds_read_b128 v[84:87], v72 offset:0
    ds_read_b128 v[92:95], v80 offset:0
    v_perm_b32 v201, v39, v43, s7
    v_lshlrev_b32 v192, 16, v47
    v_lshlrev_b32 v193, 16, v51
    s_waitcnt lgkmcnt(4)
    v_mfma_f32_32x32x16_bf16 v[132:147], v[100:103], v[112:115], v[132:147]
    ds_read_b128 v[96:99], v80 offset:4096
    ds_read_b128 v[88:91], v72 offset:4096
    v_lshlrev_b32 v194, 16, v55
    s_add_u32 s53, s48, s51
    s_add_u32 m0, s49, 49152
    s_waitcnt lgkmcnt(5)
    v_mfma_f32_32x32x16_bf16 v[148:163], v[104:107], v[108:111], v[148:163]
    buffer_load_dwordx4 v12, s[60:63], s53 offen  lds
    v_lshlrev_b32 v195, 16, v59
    v_dot2_f32_bf16 v203, v196, v189, 0
    v_dot2_f32_bf16 v204, v197, v189, 0
    s_add_u32 m0, s49, 50176
    v_mfma_f32_32x32x16_bf16 v[164:179], v[104:107], v[112:115], v[164:179]
    buffer_load_dwordx4 v13, s[60:63], s53 offen  lds
    v_dot2_f32_bf16 v205, v198, v189, 0
    v_dot2_f32_bf16 v206, v199, v189, 0
    v_dot2c_f32_bf16 v203, v198, v188
    v_dot2c_f32_bf16 v204, v199, v188
    s_waitcnt lgkmcnt(2)
    v_mfma_f32_32x32x16_bf16 v[116:131], v[84:87], v[92:95], v[116:131]
    ds_read_b128 v[100:103], v73 offset:0
    ds_read_b128 v[108:111], v81 offset:0
    v_dot2c_f32_bf16 v205, v200, v188
    v_dot2c_f32_bf16 v206, v201, v188
    v_mul_f32 v203, v203, v192
    s_waitcnt lgkmcnt(3)
    v_mfma_f32_32x32x16_bf16 v[132:147], v[84:87], v[96:99], v[132:147]
    ds_read_b128 v[112:115], v81 offset:4096
    ds_read_b128 v[104:107], v73 offset:4096
    v_mul_f32 v204, v204, v193
    v_mul_f32 v205, v205, v194
    s_add_u32 m0, s49, 51200
    s_waitcnt lgkmcnt(4)
    v_mfma_f32_32x32x16_bf16 v[148:163], v[88:91], v[92:95], v[148:163]
    buffer_load_dwordx4 v14, s[60:63], s53 offen  lds
    v_mul_f32 v206, v206, v195
    v_cvt_pk_bf16_f32 v214, v206, v205
    v_cvt_pk_bf16_f32 v215, v204, v203
    s_add_u32 m0, s49, 52224
    v_mfma_f32_32x32x16_bf16 v[164:179], v[88:91], v[96:99], v[164:179]
    buffer_load_dwordx4 v15, s[60:63], s53 offen  lds
    v_perm_b32 v196, v19, v23, s12
    v_perm_b32 v197, v23, v27, s12
    v_perm_b32 v198, v27, v31, s12
    v_perm_b32 v199, v31, v35, s12
    s_waitcnt lgkmcnt(0)
    s_waitcnt vmcnt(16)
    s_barrier
    v_mfma_f32_32x32x16_bf16 v[116:131], v[100:103], v[108:111], v[116:131]
    ds_read_b128 v[84:87], v70 offset:32768
    ds_read_b128 v[92:95], v78 offset:32768
    v_perm_b32 v200, v35, v39, s12
    v_perm_b32 v201, v39, v43, s12
    v_and_b32 v192, s5, v47
    v_mfma_f32_32x32x16_bf16 v[132:147], v[100:103], v[112:115], v[132:147]
    ds_read_b128 v[96:99], v78 offset:36864
    ds_read_b128 v[88:91], v70 offset:36864
    s_add_u32 s51, s51, 128
    s_and_b32 s51, s51, 0x7ff
    s_add_u32 s52, s47, s51
    s_add_u32 m0, s49, 65536
    v_mfma_f32_32x32x16_bf16 v[148:163], v[104:107], v[108:111], v[148:163]
    buffer_load_dwordx4 v8, s[56:59], s52 offen  lds
    v_and_b32 v193, s5, v51
    v_and_b32 v194, s5, v55
    v_and_b32 v195, s5, v59
    s_add_u32 m0, s49, 66560
    v_mfma_f32_32x32x16_bf16 v[164:179], v[104:107], v[112:115], v[164:179]
    buffer_load_dwordx4 v9, s[56:59], s52 offen  lds
    v_dot2_f32_bf16 v203, v196, v191, 0
    v_dot2_f32_bf16 v204, v197, v191, 0
    v_dot2_f32_bf16 v205, v198, v191, 0
    v_dot2_f32_bf16 v206, v199, v191, 0
    s_waitcnt lgkmcnt(2)
    v_mfma_f32_32x32x16_bf16 v[116:131], v[84:87], v[92:95], v[116:131]
    ds_read_b128 v[100:103], v71 offset:32768
    ds_read_b128 v[108:111], v79 offset:32768
    v_dot2c_f32_bf16 v203, v198, v190
    v_dot2c_f32_bf16 v204, v199, v190
    s_add_u32 m0, s49, 67584
    s_waitcnt lgkmcnt(3)
    v_mfma_f32_32x32x16_bf16 v[132:147], v[84:87], v[96:99], v[132:147]
    ds_read_b128 v[112:115], v79 offset:36864
    ds_read_b128 v[104:107], v71 offset:36864
    buffer_load_dwordx4 v10, s[56:59], s52 offen  lds
    v_dot2c_f32_bf16 v205, v200, v190
    s_add_u32 m0, s49, 68608
    s_waitcnt lgkmcnt(4)
    v_mfma_f32_32x32x16_bf16 v[148:163], v[88:91], v[92:95], v[148:163]
    buffer_load_dwordx4 v11, s[56:59], s52 offen  lds
    v_dot2c_f32_bf16 v206, v201, v190
    v_mul_f32 v203, v203, v192
    s_add_u32 s53, s48, s51
    s_add_u32 m0, s49, 81920
    v_mfma_f32_32x32x16_bf16 v[164:179], v[88:91], v[96:99], v[164:179]
    buffer_load_dwordx4 v12, s[60:63], s53 offen  lds
    v_mul_f32 v204, v204, v193
    v_mul_f32 v205, v205, v194
    v_mul_f32 v206, v206, v195
    v_cvt_pk_bf16_f32 v212, v206, v205
    s_waitcnt lgkmcnt(2)
    v_mfma_f32_32x32x16_bf16 v[116:131], v[100:103], v[108:111], v[116:131]
    ds_read_b128 v[84:87], v72 offset:32768
    ds_read_b128 v[92:95], v80 offset:32768
    v_cvt_pk_bf16_f32 v213, v204, v203
    ds_read_b128 v[188:191], v180 offset:48
    s_add_u32 m0, s49, 82944
    s_waitcnt lgkmcnt(4)
    v_mfma_f32_32x32x16_bf16 v[132:147], v[100:103], v[112:115], v[132:147]
    ds_read_b128 v[96:99], v80 offset:36864
    ds_read_b128 v[88:91], v72 offset:36864
    buffer_load_dwordx4 v13, s[60:63], s53 offen  lds
    v_perm_b32 v196, v20, v24, s7
    s_add_u32 m0, s49, 83968
    s_waitcnt lgkmcnt(5)
    v_mfma_f32_32x32x16_bf16 v[148:163], v[104:107], v[108:111], v[148:163]
    buffer_load_dwordx4 v14, s[60:63], s53 offen  lds
    v_perm_b32 v197, v24, v28, s7
    v_permlane32_swap_b32 v214, v212
    v_permlane32_swap_b32 v215, v213
    s_add_u32 m0, s49, 84992
    v_mfma_f32_32x32x16_bf16 v[164:179], v[104:107], v[112:115], v[164:179]
    buffer_load_dwordx4 v15, s[60:63], s53 offen  lds
    v_perm_b32 v198, v28, v32, s7
    v_perm_b32 v199, v32, v36, s7
    v_perm_b32 v200, v36, v40, s7
    v_perm_b32 v201, v40, v44, s7
    s_waitcnt lgkmcnt(3)
    v_mfma_f32_32x32x16_bf16 v[116:131], v[84:87], v[92:95], v[116:131]
    ds_read_b128 v[100:103], v73 offset:32768
    ds_read_b128 v[108:111], v81 offset:32768
    v_lshlrev_b32 v192, 16, v48
    v_lshlrev_b32 v193, 16, v52
    s_add_u32 m0, s16, 0
    s_waitcnt lgkmcnt(3)
    v_mfma_f32_32x32x16_bf16 v[132:147], v[84:87], v[96:99], v[132:147]
    ds_read_b128 v[112:115], v81 offset:36864
    ds_read_b128 v[104:107], v73 offset:36864
    buffer_load_dwordx4 v224, s[80:83], s14 offen  lds
    v_lshlrev_b32 v194, 16, v56
    s_add_u32 m0, s16, 1024
    s_waitcnt lgkmcnt(4)
    v_mfma_f32_32x32x16_bf16 v[148:163], v[88:91], v[92:95], v[148:163]
    buffer_load_dwordx4 v224, s[80:83], s15 offen  lds
    v_lshlrev_b32 v195, 16, v60
    v_dot2_f32_bf16 v203, v196, v185, 0
    v_dot2_f32_bf16 v204, v197, v185, 0
    s_add_u32 m0, s16, 2048
    v_mfma_f32_32x32x16_bf16 v[164:179], v[88:91], v[96:99], v[164:179]
    buffer_load_dwordx4 v224, s[84:87], s14 offen  lds
    v_dot2_f32_bf16 v205, v198, v185, 0
    v_dot2_f32_bf16 v206, v199, v185, 0
    v_dot2c_f32_bf16 v203, v198, v184
    v_dot2c_f32_bf16 v204, v199, v184
    s_waitcnt lgkmcnt(0)
    s_waitcnt vmcnt(19)
    s_barrier
    v_mfma_f32_32x32x16_bf16 v[116:131], v[100:103], v[108:111], v[116:131]
    ds_read_b128 v[84:87], v66 offset:0
    ds_read_b128 v[92:95], v74 offset:0
    v_dot2c_f32_bf16 v205, v200, v184
    v_dot2c_f32_bf16 v206, v201, v184
    s_add_u32 m0, s16, 3072
    v_mfma_f32_32x32x16_bf16 v[132:147], v[100:103], v[112:115], v[132:147]
    ds_read_b128 v[96:99], v74 offset:4096
    ds_read_b128 v[88:91], v66 offset:4096
    buffer_load_dwordx4 v224, s[84:87], s15 offen  lds
    s_add_u32 s51, s51, 128
    s_and_b32 s51, s51, 0x7ff
    s_add_u32 s52, s47, s51
    s_add_u32 m0, s49, 98304
    v_mfma_f32_32x32x16_bf16 v[148:163], v[104:107], v[108:111], v[148:163]
    buffer_load_dwordx4 v8, s[56:59], s52 offen  lds
    v_mul_f32 v203, v203, v192
    v_mul_f32 v204, v204, v193
    v_mul_f32 v205, v205, v194
    s_add_u32 m0, s49, 99328
    v_mfma_f32_32x32x16_bf16 v[164:179], v[104:107], v[112:115], v[164:179]
    buffer_load_dwordx4 v9, s[56:59], s52 offen  lds
    v_mul_f32 v206, v206, v195
    v_cvt_pk_bf16_f32 v218, v206, v205
    v_cvt_pk_bf16_f32 v219, v204, v203
    v_perm_b32 v196, v20, v24, s12
    s_waitcnt lgkmcnt(2)
    v_mfma_f32_32x32x16_bf16 v[116:131], v[84:87], v[92:95], v[116:131]
    ds_read_b128 v[100:103], v67 offset:0
    ds_read_b128 v[108:111], v75 offset:0
    v_perm_b32 v197, v24, v28, s12
    v_perm_b32 v198, v28, v32, s12
    v_perm_b32 v199, v32, v36, s12
    s_waitcnt lgkmcnt(3)
    v_mfma_f32_32x32x16_bf16 v[132:147], v[84:87], v[96:99], v[132:147]
    ds_read_b128 v[112:115], v75 offset:4096
    ds_read_b128 v[104:107], v67 offset:4096
    v_perm_b32 v200, v36, v40, s12
    v_perm_b32 v201, v40, v44, s12
    s_add_u32 m0, s49, 100352
    s_waitcnt lgkmcnt(4)
    v_mfma_f32_32x32x16_bf16 v[148:163], v[88:91], v[92:95], v[148:163]
    buffer_load_dwordx4 v10, s[56:59], s52 offen  lds
    v_and_b32 v192, s5, v48
    v_and_b32 v193, s5, v52
    v_and_b32 v194, s5, v56
    s_add_u32 m0, s49, 101376
    v_mfma_f32_32x32x16_bf16 v[164:179], v[88:91], v[96:99], v[164:179]
    buffer_load_dwordx4 v11, s[56:59], s52 offen  lds
    v_and_b32 v195, s5, v60
    v_dot2_f32_bf16 v203, v196, v187, 0
    v_dot2_f32_bf16 v204, v197, v187, 0
    v_dot2_f32_bf16 v205, v198, v187, 0
    s_waitcnt lgkmcnt(2)
    v_mfma_f32_32x32x16_bf16 v[116:131], v[100:103], v[108:111], v[116:131]
    ds_read_b128 v[84:87], v68 offset:0
    ds_read_b128 v[92:95], v76 offset:0
    v_dot2_f32_bf16 v206, v199, v187, 0
    v_dot2c_f32_bf16 v203, v198, v186
    v_dot2c_f32_bf16 v204, v199, v186
    s_waitcnt lgkmcnt(3)
    v_mfma_f32_32x32x16_bf16 v[132:147], v[100:103], v[112:115], v[132:147]
    ds_read_b128 v[96:99], v76 offset:4096
    ds_read_b128 v[88:91], v68 offset:4096
    v_dot2c_f32_bf16 v205, v200, v186
    s_add_u32 s53, s48, s51
    s_add_u32 m0, s49, 114688
    s_waitcnt lgkmcnt(4)
    v_mfma_f32_32x32x16_bf16 v[148:163], v[104:107], v[108:111], v[148:163]
    buffer_load_dwordx4 v12, s[60:63], s53 offen  lds
    v_dot2c_f32_bf16 v206, v201, v186
    v_mul_f32 v203, v203, v192
    v_mul_f32 v204, v204, v193
    s_add_u32 m0, s49, 115712
    v_mfma_f32_32x32x16_bf16 v[164:179], v[104:107], v[112:115], v[164:179]
    buffer_load_dwordx4 v13, s[60:63], s53 offen  lds
    v_mul_f32 v205, v205, v194
    v_mul_f32 v206, v206, v195
    v_cvt_pk_bf16_f32 v216, v206, v205
    v_cvt_pk_bf16_f32 v217, v204, v203
    s_waitcnt lgkmcnt(2)
    v_mfma_f32_32x32x16_bf16 v[116:131], v[84:87], v[92:95], v[116:131]
    ds_read_b128 v[100:103], v69 offset:0
    ds_read_b128 v[108:111], v77 offset:0
    v_perm_b32 v196, v21, v25, s7
    v_perm_b32 v197, v25, v29, s7
    v_permlane32_swap_b32 v218, v216
    s_waitcnt lgkmcnt(3)
    v_mfma_f32_32x32x16_bf16 v[132:147], v[84:87], v[96:99], v[132:147]
    ds_read_b128 v[112:115], v77 offset:4096
    ds_read_b128 v[104:107], v69 offset:4096
    v_permlane32_swap_b32 v219, v217
    v_perm_b32 v198, v29, v33, s7
    s_add_u32 m0, s49, 116736
    s_waitcnt lgkmcnt(4)
    v_mfma_f32_32x32x16_bf16 v[148:163], v[88:91], v[92:95], v[148:163]
    buffer_load_dwordx4 v14, s[60:63], s53 offen  lds
    v_perm_b32 v199, v33, v37, s7
    v_perm_b32 v200, v37, v41, s7
    v_perm_b32 v201, v41, v45, s7
    s_add_u32 m0, s49, 117760
    v_mfma_f32_32x32x16_bf16 v[164:179], v[88:91], v[96:99], v[164:179]
    buffer_load_dwordx4 v15, s[60:63], s53 offen  lds
    v_lshlrev_b32 v192, 16, v49
    v_lshlrev_b32 v193, 16, v53
    v_lshlrev_b32 v194, 16, v57
    v_lshlrev_b32 v195, 16, v61
    s_waitcnt lgkmcnt(0)
    s_waitcnt vmcnt(20)
    s_barrier
    v_mfma_f32_32x32x16_bf16 v[116:131], v[100:103], v[108:111], v[116:131]
    ds_read_b128 v[84:87], v66 offset:32768
    ds_read_b128 v[92:95], v74 offset:32768
    v_dot2_f32_bf16 v203, v196, v189, 0
    v_dot2_f32_bf16 v204, v197, v189, 0
    v_dot2_f32_bf16 v205, v198, v189, 0
    v_mfma_f32_32x32x16_bf16 v[132:147], v[100:103], v[112:115], v[132:147]
    ds_read_b128 v[96:99], v74 offset:36864
    ds_read_b128 v[88:91], v66 offset:36864
    s_add_u32 s51, s51, 128
    s_and_b32 s51, s51, 0x7ff
    s_add_u32 s52, s47, s51
    s_add_u32 m0, s49, 0
    v_mfma_f32_32x32x16_bf16 v[148:163], v[104:107], v[108:111], v[148:163]
    buffer_load_dwordx4 v8, s[56:59], s52 offen  lds
    v_dot2_f32_bf16 v206, v199, v189, 0
    v_dot2c_f32_bf16 v203, v198, v188
    v_dot2c_f32_bf16 v204, v199, v188
    s_add_u32 m0, s49, 1024
    v_mfma_f32_32x32x16_bf16 v[164:179], v[104:107], v[112:115], v[164:179]
    buffer_load_dwordx4 v9, s[56:59], s52 offen  lds
    v_dot2c_f32_bf16 v205, v200, v188
    v_dot2c_f32_bf16 v206, v201, v188
    v_mul_f32 v203, v203, v192
    v_mul_f32 v204, v204, v193
    s_waitcnt lgkmcnt(2)
    v_mfma_f32_32x32x16_bf16 v[116:131], v[84:87], v[92:95], v[116:131]
    ds_read_b128 v[100:103], v67 offset:32768
    ds_read_b128 v[108:111], v75 offset:32768
    v_mul_f32 v205, v205, v194
    v_mul_f32 v206, v206, v195
    v_cvt_pk_bf16_f32 v222, v206, v205
    s_waitcnt lgkmcnt(3)
    v_mfma_f32_32x32x16_bf16 v[132:147], v[84:87], v[96:99], v[132:147]
    ds_read_b128 v[112:115], v75 offset:36864
    ds_read_b128 v[104:107], v67 offset:36864
    v_cvt_pk_bf16_f32 v223, v204, v203
    v_perm_b32 v196, v21, v25, s12
    s_add_u32 m0, s49, 2048
    s_waitcnt lgkmcnt(4)
    v_mfma_f32_32x32x16_bf16 v[148:163], v[88:91], v[92:95], v[148:163]
    buffer_load_dwordx4 v10, s[56:59], s52 offen  lds
    v_perm_b32 v197, v25, v29, s12
    v_perm_b32 v198, v29, v33, s12
    v_perm_b32 v199, v33, v37, s12
    s_add_u32 m0, s49, 3072
    v_mfma_f32_32x32x16_bf16 v[164:179], v[88:91], v[96:99], v[164:179]
    buffer_load_dwordx4 v11, s[56:59], s52 offen  lds
    v_perm_b32 v200, v37, v41, s12
    v_perm_b32 v201, v41, v45, s12
    v_and_b32 v192, s5, v49
    v_and_b32 v193, s5, v53
    s_waitcnt lgkmcnt(2)
    v_mfma_f32_32x32x16_bf16 v[116:131], v[100:103], v[108:111], v[116:131]
    ds_read_b128 v[84:87], v68 offset:32768
    ds_read_b128 v[92:95], v76 offset:32768
    v_and_b32 v194, s5, v57
    v_and_b32 v195, s5, v61
    v_dot2_f32_bf16 v203, v196, v191, 0
    s_waitcnt lgkmcnt(3)
    v_mfma_f32_32x32x16_bf16 v[132:147], v[100:103], v[112:115], v[132:147]
    ds_read_b128 v[96:99], v76 offset:36864
    ds_read_b128 v[88:91], v68 offset:36864
    v_dot2_f32_bf16 v204, v197, v191, 0
    s_add_u32 s53, s48, s51
    s_add_u32 m0, s49, 16384
    s_waitcnt lgkmcnt(4)
    v_mfma_f32_32x32x16_bf16 v[148:163], v[104:107], v[108:111], v[148:163]
    buffer_load_dwordx4 v12, s[60:63], s53 offen  lds
    v_dot2_f32_bf16 v205, v198, v191, 0
    v_dot2_f32_bf16 v206, v199, v191, 0
    v_dot2c_f32_bf16 v203, v198, v190
    s_add_u32 m0, s49, 17408
    v_mfma_f32_32x32x16_bf16 v[164:179], v[104:107], v[112:115], v[164:179]
    buffer_load_dwordx4 v13, s[60:63], s53 offen  lds
    v_dot2c_f32_bf16 v204, v199, v190
    v_dot2c_f32_bf16 v205, v200, v190
    v_dot2c_f32_bf16 v206, v201, v190
    v_mul_f32 v203, v203, v192
    s_waitcnt lgkmcnt(2)
    v_mfma_f32_32x32x16_bf16 v[116:131], v[84:87], v[92:95], v[116:131]
    ds_read_b128 v[100:103], v69 offset:32768
    ds_read_b128 v[108:111], v77 offset:32768
    v_mul_f32 v204, v204, v193
    v_mul_f32 v205, v205, v194
    v_mul_f32 v206, v206, v195
    s_waitcnt lgkmcnt(3)
    v_mfma_f32_32x32x16_bf16 v[132:147], v[84:87], v[96:99], v[132:147]
    ds_read_b128 v[112:115], v77 offset:36864
    ds_read_b128 v[104:107], v69 offset:36864
    v_cvt_pk_bf16_f32 v220, v206, v205
    v_cvt_pk_bf16_f32 v221, v204, v203
    s_add_u32 m0, s49, 18432
    s_waitcnt lgkmcnt(4)
    v_mfma_f32_32x32x16_bf16 v[148:163], v[88:91], v[92:95], v[148:163]
    buffer_load_dwordx4 v14, s[60:63], s53 offen  lds
    v_permlane32_swap_b32 v222, v220
    v_permlane32_swap_b32 v223, v221
    s_add_u32 m0, s49, 19456
    v_mfma_f32_32x32x16_bf16 v[164:179], v[88:91], v[96:99], v[164:179]
    buffer_load_dwordx4 v15, s[60:63], s53 offen  lds
    s_waitcnt lgkmcnt(0)
    s_waitcnt vmcnt(20)
    s_barrier
    v_mfma_f32_32x32x16_bf16 v[116:131], v[100:103], v[108:111], v[116:131]
    ds_read_b128 v[84:87], v70 offset:0
    ds_read_b128 v[92:95], v78 offset:0
    v_mfma_f32_32x32x16_bf16 v[132:147], v[100:103], v[112:115], v[132:147]
    ds_read_b128 v[96:99], v78 offset:4096
    ds_read_b128 v[88:91], v70 offset:4096
    s_add_u32 s51, s51, 128
    s_and_b32 s51, s51, 0x7ff
    s_add_u32 s52, s47, s51
    s_add_u32 m0, s49, 32768
    v_mfma_f32_32x32x16_bf16 v[148:163], v[104:107], v[108:111], v[148:163]
    buffer_load_dwordx4 v8, s[56:59], s52 offen  lds
    s_add_u32 m0, s49, 33792
    v_mfma_f32_32x32x16_bf16 v[164:179], v[104:107], v[112:115], v[164:179]
    buffer_load_dwordx4 v9, s[56:59], s52 offen  lds
    s_waitcnt lgkmcnt(2)
    v_mfma_f32_32x32x16_bf16 v[116:131], v[84:87], v[92:95], v[116:131]
    ds_read_b128 v[100:103], v71 offset:0
    ds_read_b128 v[108:111], v79 offset:0
    s_waitcnt lgkmcnt(3)
    v_mfma_f32_32x32x16_bf16 v[132:147], v[84:87], v[96:99], v[132:147]
    ds_read_b128 v[112:115], v79 offset:4096
    ds_read_b128 v[104:107], v71 offset:4096
    s_add_u32 m0, s49, 34816
    s_waitcnt lgkmcnt(4)
    v_mfma_f32_32x32x16_bf16 v[148:163], v[88:91], v[92:95], v[148:163]
    buffer_load_dwordx4 v10, s[56:59], s52 offen  lds
    s_add_u32 m0, s49, 35840
    v_mfma_f32_32x32x16_bf16 v[164:179], v[88:91], v[96:99], v[164:179]
    buffer_load_dwordx4 v11, s[56:59], s52 offen  lds
    s_waitcnt lgkmcnt(2)
    v_mfma_f32_32x32x16_bf16 v[116:131], v[100:103], v[108:111], v[116:131]
    ds_read_b128 v[84:87], v72 offset:0
    ds_read_b128 v[92:95], v80 offset:0
    s_waitcnt lgkmcnt(3)
    v_mfma_f32_32x32x16_bf16 v[132:147], v[100:103], v[112:115], v[132:147]
    ds_read_b128 v[96:99], v80 offset:4096
    ds_read_b128 v[88:91], v72 offset:4096
    s_add_u32 s53, s48, s51
    s_add_u32 m0, s49, 49152
    s_waitcnt lgkmcnt(4)
    v_mfma_f32_32x32x16_bf16 v[148:163], v[104:107], v[108:111], v[148:163]
    buffer_load_dwordx4 v12, s[60:63], s53 offen  lds
    s_add_u32 m0, s49, 50176
    v_mfma_f32_32x32x16_bf16 v[164:179], v[104:107], v[112:115], v[164:179]
    buffer_load_dwordx4 v13, s[60:63], s53 offen  lds
    s_waitcnt lgkmcnt(2)
    v_mfma_f32_32x32x16_bf16 v[116:131], v[84:87], v[92:95], v[116:131]
    ds_read_b128 v[100:103], v73 offset:0
    ds_read_b128 v[108:111], v81 offset:0
    s_waitcnt lgkmcnt(3)
    v_mfma_f32_32x32x16_bf16 v[132:147], v[84:87], v[96:99], v[132:147]
    ds_read_b128 v[112:115], v81 offset:4096
    ds_read_b128 v[104:107], v73 offset:4096
    s_add_u32 m0, s49, 51200
    s_waitcnt lgkmcnt(4)
    v_mfma_f32_32x32x16_bf16 v[148:163], v[88:91], v[92:95], v[148:163]
    buffer_load_dwordx4 v14, s[60:63], s53 offen  lds
    s_add_u32 m0, s49, 52224
    v_mfma_f32_32x32x16_bf16 v[164:179], v[88:91], v[96:99], v[164:179]
    buffer_load_dwordx4 v15, s[60:63], s53 offen  lds
    s_waitcnt lgkmcnt(0)
    s_waitcnt vmcnt(16)
    s_barrier
    v_mfma_f32_32x32x16_bf16 v[116:131], v[100:103], v[108:111], v[116:131]
    ds_read_b128 v[84:87], v70 offset:32768
    ds_read_b128 v[92:95], v78 offset:32768
    v_mov_b32 v3, 0
    buffer_load_dwordx2 v[4:5], v3, s[24:27], 0 offen sc0 sc1
    v_mfma_f32_32x32x16_bf16 v[132:147], v[100:103], v[112:115], v[132:147]
    ds_read_b128 v[96:99], v78 offset:36864
    ds_read_b128 v[88:91], v70 offset:36864
    s_add_u32 s51, s51, 128
    s_and_b32 s51, s51, 0x7ff
    s_add_u32 s52, s47, s51
    s_add_u32 m0, s49, 65536
    v_mfma_f32_32x32x16_bf16 v[148:163], v[104:107], v[108:111], v[148:163]
    buffer_load_dwordx4 v8, s[56:59], s52 offen  lds
    buffer_store_dwordx4 v[208:211], v181, s[8:11], s6 offen sc0 sc1
    s_add_u32 m0, s49, 66560
    v_mfma_f32_32x32x16_bf16 v[164:179], v[104:107], v[112:115], v[164:179]
    buffer_load_dwordx4 v9, s[56:59], s52 offen  lds
    s_add_u32 s6, s6, 32768
    buffer_store_dwordx4 v[212:215], v181, s[8:11], s6 offen sc0 sc1
    s_waitcnt lgkmcnt(2)
    v_mfma_f32_32x32x16_bf16 v[116:131], v[84:87], v[92:95], v[116:131]
    ds_read_b128 v[100:103], v71 offset:32768
    ds_read_b128 v[108:111], v79 offset:32768
    s_add_u32 s6, s6, 32768
    buffer_store_dwordx4 v[216:219], v181, s[8:11], s6 offen sc0 sc1
    s_waitcnt lgkmcnt(3)
    v_mfma_f32_32x32x16_bf16 v[132:147], v[84:87], v[96:99], v[132:147]
    ds_read_b128 v[112:115], v79 offset:36864
    ds_read_b128 v[104:107], v71 offset:36864
    s_add_u32 s6, s6, 32768
    s_add_u32 m0, s49, 67584
    s_waitcnt lgkmcnt(4)
    v_mfma_f32_32x32x16_bf16 v[148:163], v[88:91], v[92:95], v[148:163]
    buffer_load_dwordx4 v10, s[56:59], s52 offen  lds
    buffer_store_dwordx4 v[220:223], v181, s[8:11], s6 offen sc0 sc1
    s_add_u32 m0, s49, 68608
    v_mfma_f32_32x32x16_bf16 v[164:179], v[88:91], v[96:99], v[164:179]
    buffer_load_dwordx4 v11, s[56:59], s52 offen  lds
    s_mov_b64 s[30:31], exec
    s_mov_b32 exec_lo, 0
    s_mov_b32 exec_hi, 0x80000000
    buffer_store_dwordx2 v[226:227], v225, s[8:11], 0 offen sc0 sc1
    buffer_store_dwordx2 v[228:229], v225, s[8:11], s32 offen sc0 sc1
    s_mov_b64 exec, s[30:31]
    s_waitcnt lgkmcnt(2)
    v_mfma_f32_32x32x16_bf16 v[116:131], v[100:103], v[108:111], v[116:131]
    ds_read_b128 v[84:87], v72 offset:32768
    ds_read_b128 v[92:95], v80 offset:32768
    s_waitcnt lgkmcnt(3)
    v_mfma_f32_32x32x16_bf16 v[132:147], v[100:103], v[112:115], v[132:147]
    ds_read_b128 v[96:99], v80 offset:36864
    ds_read_b128 v[88:91], v72 offset:36864
    s_add_u32 s53, s48, s51
    s_add_u32 m0, s49, 81920
    s_waitcnt lgkmcnt(4)
    v_mfma_f32_32x32x16_bf16 v[148:163], v[104:107], v[108:111], v[148:163]
    buffer_load_dwordx4 v12, s[60:63], s53 offen  lds
    s_add_u32 m0, s49, 82944
    v_mfma_f32_32x32x16_bf16 v[164:179], v[104:107], v[112:115], v[164:179]
    buffer_load_dwordx4 v13, s[60:63], s53 offen  lds
    s_waitcnt lgkmcnt(2)
    v_mfma_f32_32x32x16_bf16 v[116:131], v[84:87], v[92:95], v[116:131]
    ds_read_b128 v[100:103], v73 offset:32768
    ds_read_b128 v[108:111], v81 offset:32768
    s_waitcnt lgkmcnt(3)
    v_mfma_f32_32x32x16_bf16 v[132:147], v[84:87], v[96:99], v[132:147]
    ds_read_b128 v[112:115], v81 offset:36864
    ds_read_b128 v[104:107], v73 offset:36864
    s_add_u32 m0, s49, 83968
    s_waitcnt lgkmcnt(4)
    v_mfma_f32_32x32x16_bf16 v[148:163], v[88:91], v[92:95], v[148:163]
    buffer_load_dwordx4 v14, s[60:63], s53 offen  lds
    s_add_u32 m0, s49, 84992
    v_mfma_f32_32x32x16_bf16 v[164:179], v[88:91], v[96:99], v[164:179]
    buffer_load_dwordx4 v15, s[60:63], s53 offen  lds
    s_waitcnt lgkmcnt(0)
    s_waitcnt vmcnt(23)
    s_barrier
    v_mfma_f32_32x32x16_bf16 v[116:131], v[100:103], v[108:111], v[116:131]
    ds_read_b128 v[84:87], v66 offset:0
    ds_read_b128 v[92:95], v74 offset:0
    v_mfma_f32_32x32x16_bf16 v[132:147], v[100:103], v[112:115], v[132:147]
    ds_read_b128 v[96:99], v74 offset:4096
    ds_read_b128 v[88:91], v66 offset:4096
    s_add_u32 s51, s51, 128
    s_and_b32 s51, s51, 0x7ff
    s_add_u32 s52, s47, s51
    s_add_u32 m0, s49, 98304
    v_mfma_f32_32x32x16_bf16 v[148:163], v[104:107], v[108:111], v[148:163]
    buffer_load_dwordx4 v8, s[56:59], s52 offen  lds
    s_add_u32 m0, s49, 99328
    v_mfma_f32_32x32x16_bf16 v[164:179], v[104:107], v[112:115], v[164:179]
    buffer_load_dwordx4 v9, s[56:59], s52 offen  lds
    s_waitcnt lgkmcnt(2)
    v_mfma_f32_32x32x16_bf16 v[116:131], v[84:87], v[92:95], v[116:131]
    ds_read_b128 v[100:103], v67 offset:0
    ds_read_b128 v[108:111], v75 offset:0
    s_waitcnt lgkmcnt(3)
    v_mfma_f32_32x32x16_bf16 v[132:147], v[84:87], v[96:99], v[132:147]
    ds_read_b128 v[112:115], v75 offset:4096
    ds_read_b128 v[104:107], v67 offset:4096
    s_add_u32 m0, s49, 100352
    s_waitcnt lgkmcnt(4)
    v_mfma_f32_32x32x16_bf16 v[148:163], v[88:91], v[92:95], v[148:163]
    buffer_load_dwordx4 v10, s[56:59], s52 offen  lds
    s_add_u32 m0, s49, 101376
    v_mfma_f32_32x32x16_bf16 v[164:179], v[88:91], v[96:99], v[164:179]
    buffer_load_dwordx4 v11, s[56:59], s52 offen  lds
    s_waitcnt lgkmcnt(2)
    v_mfma_f32_32x32x16_bf16 v[116:131], v[100:103], v[108:111], v[116:131]
    ds_read_b128 v[84:87], v68 offset:0
    ds_read_b128 v[92:95], v76 offset:0
    s_waitcnt lgkmcnt(3)
    v_mfma_f32_32x32x16_bf16 v[132:147], v[100:103], v[112:115], v[132:147]
    ds_read_b128 v[96:99], v76 offset:4096
    ds_read_b128 v[88:91], v68 offset:4096
    s_add_u32 s53, s48, s51
    s_add_u32 m0, s49, 114688
    s_waitcnt lgkmcnt(4)
    v_mfma_f32_32x32x16_bf16 v[148:163], v[104:107], v[108:111], v[148:163]
    buffer_load_dwordx4 v12, s[60:63], s53 offen  lds
    s_add_u32 m0, s49, 115712
    v_mfma_f32_32x32x16_bf16 v[164:179], v[104:107], v[112:115], v[164:179]
    buffer_load_dwordx4 v13, s[60:63], s53 offen  lds
    s_waitcnt lgkmcnt(2)
    v_mfma_f32_32x32x16_bf16 v[116:131], v[84:87], v[92:95], v[116:131]
    ds_read_b128 v[100:103], v69 offset:0
    ds_read_b128 v[108:111], v77 offset:0
    s_waitcnt lgkmcnt(3)
    v_mfma_f32_32x32x16_bf16 v[132:147], v[84:87], v[96:99], v[132:147]
    ds_read_b128 v[112:115], v77 offset:4096
    ds_read_b128 v[104:107], v69 offset:4096
    s_add_u32 m0, s49, 116736
    s_waitcnt lgkmcnt(4)
    v_mfma_f32_32x32x16_bf16 v[148:163], v[88:91], v[92:95], v[148:163]
    buffer_load_dwordx4 v14, s[60:63], s53 offen  lds
    s_add_u32 m0, s49, 117760
    v_mfma_f32_32x32x16_bf16 v[164:179], v[88:91], v[96:99], v[164:179]
    buffer_load_dwordx4 v15, s[60:63], s53 offen  lds
    s_waitcnt lgkmcnt(0)
    s_waitcnt vmcnt(23)
    s_barrier
    v_mfma_f32_32x32x16_bf16 v[116:131], v[100:103], v[108:111], v[116:131]
    ds_read_b128 v[84:87], v66 offset:32768
    ds_read_b128 v[92:95], v74 offset:32768
    s_lshl_b32 s6, s46, 2
    s_add_u32 s6, s6, s44
    s_lshl_b32 s6, s6, 16
    s_lshl_b32 s3, s45, 12
    v_mfma_f32_32x32x16_bf16 v[132:147], v[100:103], v[112:115], v[132:147]
    ds_read_b128 v[96:99], v74 offset:36864
    ds_read_b128 v[88:91], v66 offset:36864
    s_add_u32 s6, s6, s3
    s_add_u32 s6, s6, 16777216
    s_mov_b32 s7, 0x05040100
    s_mov_b32 s12, 0x07060302
    v_mfma_f32_32x32x16_bf16 v[148:163], v[104:107], v[108:111], v[148:163]
    v_and_b32 v20, 31, v2
    v_lshlrev_b32 v18, 6, v20
    v_bfe_u32 v20, v2, 2, 2
    v_lshrrev_b32 v21, 5, v2
    v_lshlrev_b32 v21, 1, v21
    v_xor_b32 v20, v20, v21
    v_mfma_f32_32x32x16_bf16 v[164:179], v[104:107], v[112:115], v[164:179]
    v_lshl_add_u32 v18, v20, 4, v18
    v_add_u32 v18, s16, v18
    v_xor_b32 v19, 16, v18
    ds_read_b128 v[22:25], v18 offset:0
    ds_read_b128 v[26:29], v19 offset:0
    s_waitcnt lgkmcnt(4)
    v_mfma_f32_32x32x16_bf16 v[116:131], v[84:87], v[92:95], v[116:131]
    ds_read_b128 v[100:103], v67 offset:32768
    ds_read_b128 v[108:111], v75 offset:32768
    ds_read_b128 v[30:33], v18 offset:2048
    ds_read_b128 v[34:37], v19 offset:2048
    s_waitcnt lgkmcnt(1)
    v_perm_b32 v38, v30, v22, s7
    v_perm_b32 v39, v30, v22, s12
    v_mfma_f32_32x32x16_bf16 v[132:147], v[84:87], v[96:99], v[132:147]
    ds_read_b128 v[112:115], v75 offset:36864
    ds_read_b128 v[104:107], v67 offset:36864
    v_perm_b32 v40, v31, v23, s7
    v_perm_b32 v41, v31, v23, s12
    buffer_store_dwordx4 v[38:41], v17, s[8:11], s6 offen offset:0 sc0 sc1
    v_perm_b32 v42, v32, v24, s7
    v_mfma_f32_32x32x16_bf16 v[148:163], v[88:91], v[92:95], v[148:163]
    v_perm_b32 v43, v32, v24, s12
    v_perm_b32 v44, v33, v25, s7
    v_perm_b32 v45, v33, v25, s12
    buffer_store_dwordx4 v[42:45], v17, s[8:11], s6 offen offset:1024 sc0 sc1
    s_waitcnt lgkmcnt(2)
    v_perm_b32 v38, v34, v26, s7
    v_perm_b32 v39, v34, v26, s12
    v_mfma_f32_32x32x16_bf16 v[164:179], v[88:91], v[96:99], v[164:179]
    v_perm_b32 v40, v35, v27, s7
    v_perm_b32 v41, v35, v27, s12
    buffer_store_dwordx4 v[38:41], v17, s[8:11], s6 offen offset:2048 sc0 sc1
    v_perm_b32 v42, v36, v28, s7
    v_perm_b32 v43, v36, v28, s12
    v_perm_b32 v44, v37, v29, s7
    v_mfma_f32_32x32x16_bf16 v[116:131], v[100:103], v[108:111], v[116:131]
    ds_read_b128 v[84:87], v68 offset:32768
    ds_read_b128 v[92:95], v76 offset:32768
    v_perm_b32 v45, v37, v29, s12
    buffer_store_dwordx4 v[42:45], v17, s[8:11], s6 offen offset:3072 sc0 sc1
    s_waitcnt lgkmcnt(3)
    v_mfma_f32_32x32x16_bf16 v[132:147], v[100:103], v[112:115], v[132:147]
    ds_read_b128 v[96:99], v76 offset:36864
    ds_read_b128 v[88:91], v68 offset:36864
    s_waitcnt lgkmcnt(4)
    v_mfma_f32_32x32x16_bf16 v[148:163], v[104:107], v[108:111], v[148:163]
    v_mfma_f32_32x32x16_bf16 v[164:179], v[104:107], v[112:115], v[164:179]
    s_waitcnt lgkmcnt(2)
    v_mfma_f32_32x32x16_bf16 v[116:131], v[84:87], v[92:95], v[116:131]
    ds_read_b128 v[100:103], v69 offset:32768
    ds_read_b128 v[108:111], v77 offset:32768
    s_waitcnt lgkmcnt(3)
    v_mfma_f32_32x32x16_bf16 v[132:147], v[84:87], v[96:99], v[132:147]
    ds_read_b128 v[112:115], v77 offset:36864
    ds_read_b128 v[104:107], v69 offset:36864
    s_waitcnt lgkmcnt(4)
    v_mfma_f32_32x32x16_bf16 v[148:163], v[88:91], v[92:95], v[148:163]
    v_mfma_f32_32x32x16_bf16 v[164:179], v[88:91], v[96:99], v[164:179]
    s_waitcnt lgkmcnt(0)
    s_waitcnt vmcnt(12)
    s_barrier
    v_mfma_f32_32x32x16_bf16 v[116:131], v[100:103], v[108:111], v[116:131]
    ds_read_b128 v[84:87], v70 offset:0
    ds_read_b128 v[92:95], v78 offset:0
    v_subrev_u32 v50, 32, v17
    v_min_u32 v50, 0x7fff0000, v50
    v_add_u32 v51, s23, v17
    buffer_load_dwordx4 v[38:41], v50, s[76:79], 0 offen nt
    v_mfma_f32_32x32x16_bf16 v[132:147], v[100:103], v[112:115], v[132:147]
    ds_read_b128 v[96:99], v78 offset:4096
    ds_read_b128 v[88:91], v70 offset:4096
    buffer_load_dwordx4 v[22:25], v17, s[76:79], 0 offen offset:0 nt
    v_mfma_f32_32x32x16_bf16 v[148:163], v[104:107], v[108:111], v[148:163]
    buffer_load_dwordx4 v[26:29], v17, s[76:79], 0 offen offset:1024 nt
    v_mfma_f32_32x32x16_bf16 v[164:179], v[104:107], v[112:115], v[164:179]
    buffer_load_dwordx4 v[30:33], v17, s[76:79], 0 offen offset:2048 nt
    buffer_load_dwordx4 v[34:37], v17, s[76:79], 0 offen offset:3072 nt
    s_waitcnt lgkmcnt(2)
    v_mfma_f32_32x32x16_bf16 v[116:131], v[84:87], v[92:95], v[116:131]
    ds_read_b128 v[100:103], v71 offset:0
    ds_read_b128 v[108:111], v79 offset:0
    s_mov_b32 s88, s20
    s_waitcnt lgkmcnt(3)
    v_mfma_f32_32x32x16_bf16 v[132:147], v[84:87], v[96:99], v[132:147]
    ds_read_b128 v[112:115], v79 offset:4096
    ds_read_b128 v[104:107], v71 offset:4096
    s_mov_b32 s89, s21
    s_mov_b32 s90, 2048
    s_mov_b32 s91, 131072
    s_and_b32 s3, s44, 1
    s_waitcnt lgkmcnt(4)
    v_mfma_f32_32x32x16_bf16 v[148:163], v[88:91], v[92:95], v[148:163]
    s_lshl_b32 s3, s3, 5
    s_and_b32 s3, s44, 1
    s_lshl_b32 s3, s3, 6
    v_and_b32 v52, 31, v2
    v_lshl_add_u32 v52, v52, 1, s3
    s_lshl_b32 s3, s46, 7
    buffer_load_ushort v52, v52, s[88:91], s3 offen
    v_and_b32 v53, 15, v2
    v_lshrrev_b32 v54, 4, v2
    v_mfma_f32_32x32x16_bf16 v[164:179], v[88:91], v[96:99], v[164:179]
    v_add_u32 v55, 1, v53
    v_and_b32 v56, 1, v55
    v_mul_u32_u24 v56, 4160, v56
    v_and_b32 v55, 30, v55
    v_lshl_add_u32 v56, v55, 1, v56
    v_lshl_add_u32 v56, v54, 4, v56
    s_waitcnt lgkmcnt(2)
    v_mfma_f32_32x32x16_bf16 v[116:131], v[100:103], v[108:111], v[116:131]
    ds_read_b128 v[84:87], v72 offset:0
    ds_read_b128 v[92:95], v80 offset:0
    v_add_u32 v57, s23, v56
    v_add_u32 v63, 1024, v57
    v_add_u32 v64, 2048, v57
    v_add_u32 v65, 3072, v57
    s_waitcnt lgkmcnt(3)
    v_mfma_f32_32x32x16_bf16 v[132:147], v[100:103], v[112:115], v[132:147]
    ds_read_b128 v[96:99], v80 offset:4096
    ds_read_b128 v[88:91], v72 offset:4096
    v_lshlrev_b32 v55, 1, v53
    v_sub_u32 v55, v54, v55
    v_add_u32 v55, 30, v55
    v_lshrrev_b32 v56, 2, v55
    s_waitcnt lgkmcnt(4)
    v_mfma_f32_32x32x16_bf16 v[148:163], v[104:107], v[108:111], v[148:163]
    v_lshlrev_b32 v55, 6, v55
    v_add_u32 v55, 132096, v55
    v_add_u32 v58, 63, v56
    v_and_b32 v58, 3, v58
    v_xor_b32 v58, s44, v58
    v_lshl_add_u32 v58, v58, 4, v55
    v_mfma_f32_32x32x16_bf16 v[164:179], v[104:107], v[112:115], v[164:179]
    v_add_u32 v59, 62, v56
    v_and_b32 v59, 3, v59
    v_xor_b32 v59, s44, v59
    v_lshl_add_u32 v59, v59, 4, v55
    v_add_u32 v60, 61, v56
    v_and_b32 v60, 3, v60
    s_waitcnt lgkmcnt(2)
    v_mfma_f32_32x32x16_bf16 v[116:131], v[84:87], v[92:95], v[116:131]
    ds_read_b128 v[100:103], v73 offset:0
    ds_read_b128 v[108:111], v81 offset:0
    v_xor_b32 v60, s44, v60
    v_lshl_add_u32 v60, v60, 4, v55
    v_add_u32 v61, 60, v56
    v_and_b32 v61, 3, v61
    s_waitcnt lgkmcnt(3)
    v_mfma_f32_32x32x16_bf16 v[132:147], v[84:87], v[96:99], v[132:147]
    ds_read_b128 v[112:115], v81 offset:4096
    ds_read_b128 v[104:107], v73 offset:4096
    v_xor_b32 v61, s44, v61
    v_lshl_add_u32 v61, v61, 4, v55
    v_lshlrev_b32 v55, 5, v53
    v_lshl_add_u32 v55, v54, 3, v55
    s_waitcnt lgkmcnt(4)
    v_mfma_f32_32x32x16_bf16 v[148:163], v[88:91], v[92:95], v[148:163]
    v_sub_u32 v55, 504, v55
    v_and_b32 v62, 8, v55
    v_lshrrev_b32 v55, 4, v55
    v_lshl_add_u32 v62, v55, 6, v62
    v_bfe_u32 v55, v55, 2, 2
    v_xor_b32 v55, s44, v55
    v_mfma_f32_32x32x16_bf16 v[164:179], v[88:91], v[96:99], v[164:179]
    v_lshl_add_u32 v62, v55, 4, v62
    v_add_u32 v62, 132096, v62
    v_and_b32 v55, 1, v54
    v_lshlrev_b32 v55, 9, v55
    v_lshl_add_u32 v55, v53, 5, v55
    v_lshrrev_b32 v56, 1, v54
    s_waitcnt lgkmcnt(0)
    s_waitcnt vmcnt(10)
    s_barrier
    v_mfma_f32_32x32x16_bf16 v[116:131], v[100:103], v[108:111], v[116:131]
    ds_read_b128 v[84:87], v70 offset:32768
    ds_read_b128 v[92:95], v78 offset:32768
    v_lshl_add_u32 v180, v56, 4, v55
    s_mov_b32 s6, 0
    v_readfirstlane_b32 s42, v4
    v_readfirstlane_b32 s43, v5
    s_nop 3
    s_or_b32 s3, s42, s43
    s_cmp_lg_u32 s3, 0
    s_cbranch_scc1 Lnok_gate_2
Lnretry_gate_3:
    buffer_load_dwordx2 v[4:5], v3, s[24:27], 0 offen sc0 sc1
    s_waitcnt vmcnt(0)
    v_readfirstlane_b32 s42, v4
    v_readfirstlane_b32 s43, v5
    s_add_u32 s6, s6, 1
    s_nop 3
    s_or_b32 s3, s42, s43
    s_cmp_gt_u32 s6, 20000
    s_cbranch_scc1 Lnok_gate_2
    s_cmp_eq_u32 s3, 0
    s_cbranch_scc1 Lnretry_gate_3
Lnok_gate_2:
    v_mov_b32 v82, s42
    v_mov_b32 v83, s43
    s_mov_b64 s[6:7], exec
    s_mov_b64 exec, 1
    buffer_store_dwordx2 v[82:83], v6, s[8:11], s13 offen sc0 sc1
    s_mov_b64 exec, s[6:7]
    v_mfma_f32_32x32x16_bf16 v[132:147], v[100:103], v[112:115], v[132:147]
    ds_read_b128 v[96:99], v78 offset:36864
    ds_read_b128 v[88:91], v70 offset:36864
    v_mfma_f32_32x32x16_bf16 v[148:163], v[104:107], v[108:111], v[148:163]
    v_mfma_f32_32x32x16_bf16 v[164:179], v[104:107], v[112:115], v[164:179]
    s_waitcnt lgkmcnt(2)
    v_mfma_f32_32x32x16_bf16 v[116:131], v[84:87], v[92:95], v[116:131]
    ds_read_b128 v[100:103], v71 offset:32768
    ds_read_b128 v[108:111], v79 offset:32768
    s_waitcnt lgkmcnt(3)
    v_mfma_f32_32x32x16_bf16 v[132:147], v[84:87], v[96:99], v[132:147]
    ds_read_b128 v[112:115], v79 offset:36864
    ds_read_b128 v[104:107], v71 offset:36864
    s_waitcnt lgkmcnt(4)
    v_mfma_f32_32x32x16_bf16 v[148:163], v[88:91], v[92:95], v[148:163]
    v_mfma_f32_32x32x16_bf16 v[164:179], v[88:91], v[96:99], v[164:179]
    s_waitcnt lgkmcnt(2)
    v_mfma_f32_32x32x16_bf16 v[116:131], v[100:103], v[108:111], v[116:131]
    ds_read_b128 v[84:87], v72 offset:32768
    ds_read_b128 v[92:95], v80 offset:32768
    s_waitcnt lgkmcnt(3)
    v_mfma_f32_32x32x16_bf16 v[132:147], v[100:103], v[112:115], v[132:147]
    ds_read_b128 v[96:99], v80 offset:36864
    ds_read_b128 v[88:91], v72 offset:36864
    s_waitcnt lgkmcnt(4)
    v_mfma_f32_32x32x16_bf16 v[148:163], v[104:107], v[108:111], v[148:163]
    v_mfma_f32_32x32x16_bf16 v[164:179], v[104:107], v[112:115], v[164:179]
    s_waitcnt lgkmcnt(2)
    v_mfma_f32_32x32x16_bf16 v[116:131], v[84:87], v[92:95], v[116:131]
    ds_read_b128 v[100:103], v73 offset:32768
    ds_read_b128 v[108:111], v81 offset:32768
    s_waitcnt lgkmcnt(3)
    v_mfma_f32_32x32x16_bf16 v[132:147], v[84:87], v[96:99], v[132:147]
    ds_read_b128 v[112:115], v81 offset:36864
    ds_read_b128 v[104:107], v73 offset:36864
    s_waitcnt lgkmcnt(4)
    v_mfma_f32_32x32x16_bf16 v[148:163], v[88:91], v[92:95], v[148:163]
    v_mfma_f32_32x32x16_bf16 v[164:179], v[88:91], v[96:99], v[164:179]
    s_waitcnt lgkmcnt(0)
    v_mfma_f32_32x32x16_bf16 v[116:131], v[100:103], v[108:111], v[116:131]
    v_mfma_f32_32x32x16_bf16 v[132:147], v[100:103], v[112:115], v[132:147]
    v_mfma_f32_32x32x16_bf16 v[148:163], v[104:107], v[108:111], v[148:163]
    v_mfma_f32_32x32x16_bf16 v[164:179], v[104:107], v[112:115], v[164:179]
    s_waitcnt vmcnt(7)
    v_mov_b32 v82, s42
    v_mov_b32 v83, s43
    s_mov_b64 s[6:7], exec
    s_mov_b64 exec, 1
    buffer_store_dwordx2 v[82:83], v6, s[8:11], s18 offen sc0 sc1
    s_mov_b64 exec, s[6:7]
    s_nop 2
    v_pk_fma_f32 v[10:11], v[132:133], v[230:231], v[118:119] op_sel:[0,1,0] op_sel_hi:[1,1,1] neg_lo:[0,1,0] neg_hi:[0,1,0]
    v_pk_fma_f32 v[12:13], v[116:117], v[230:231], v[134:135] op_sel:[0,1,0] op_sel_hi:[1,1,1]
    v_pk_fma_f32 v[4:5], v[116:117], v[230:231], v[10:11] op_sel:[0,0,0] op_sel_hi:[1,0,1]
    v_pk_fma_f32 v[8:9], v[132:133], v[230:231], v[12:13] op_sel:[0,0,0] op_sel_hi:[1,0,1]
    v_pk_fma_f32 v[10:11], v[8:9], v[230:231], v[120:121] op_sel:[0,1,0] op_sel_hi:[1,1,1] neg_lo:[0,1,0] neg_hi:[0,1,0]
    v_pk_fma_f32 v[12:13], v[4:5], v[230:231], v[136:137] op_sel:[0,1,0] op_sel_hi:[1,1,1]
    v_pk_fma_f32 v[4:5], v[4:5], v[230:231], v[10:11] op_sel:[0,0,0] op_sel_hi:[1,0,1]
    v_pk_fma_f32 v[8:9], v[8:9], v[230:231], v[12:13] op_sel:[0,0,0] op_sel_hi:[1,0,1]
    v_pk_fma_f32 v[10:11], v[8:9], v[230:231], v[122:123] op_sel:[0,1,0] op_sel_hi:[1,1,1] neg_lo:[0,1,0] neg_hi:[0,1,0]
    v_pk_fma_f32 v[12:13], v[4:5], v[230:231], v[138:139] op_sel:[0,1,0] op_sel_hi:[1,1,1]
    v_pk_fma_f32 v[4:5], v[4:5], v[230:231], v[10:11] op_sel:[0,0,0] op_sel_hi:[1,0,1]
    v_pk_fma_f32 v[8:9], v[8:9], v[230:231], v[12:13] op_sel:[0,0,0] op_sel_hi:[1,0,1]
    v_pk_fma_f32 v[10:11], v[8:9], v[230:231], v[124:125] op_sel:[0,1,0] op_sel_hi:[1,1,1] neg_lo:[0,1,0] neg_hi:[0,1,0]
    v_pk_fma_f32 v[12:13], v[4:5], v[230:231], v[140:141] op_sel:[0,1,0] op_sel_hi:[1,1,1]
    v_pk_fma_f32 v[4:5], v[4:5], v[230:231], v[10:11] op_sel:[0,0,0] op_sel_hi:[1,0,1]
    v_pk_fma_f32 v[8:9], v[8:9], v[230:231], v[12:13] op_sel:[0,0,0] op_sel_hi:[1,0,1]
    v_pk_fma_f32 v[10:11], v[8:9], v[230:231], v[126:127] op_sel:[0,1,0] op_sel_hi:[1,1,1] neg_lo:[0,1,0] neg_hi:[0,1,0]
    v_pk_fma_f32 v[12:13], v[4:5], v[230:231], v[142:143] op_sel:[0,1,0] op_sel_hi:[1,1,1]
    v_pk_fma_f32 v[4:5], v[4:5], v[230:231], v[10:11] op_sel:[0,0,0] op_sel_hi:[1,0,1]
    v_pk_fma_f32 v[8:9], v[8:9], v[230:231], v[12:13] op_sel:[0,0,0] op_sel_hi:[1,0,1]
    v_pk_fma_f32 v[10:11], v[8:9], v[230:231], v[128:129] op_sel:[0,1,0] op_sel_hi:[1,1,1] neg_lo:[0,1,0] neg_hi:[0,1,0]
    v_pk_fma_f32 v[12:13], v[4:5], v[230:231], v[144:145] op_sel:[0,1,0] op_sel_hi:[1,1,1]
    v_pk_fma_f32 v[4:5], v[4:5], v[230:231], v[10:11] op_sel:[0,0,0] op_sel_hi:[1,0,1]
    v_pk_fma_f32 v[8:9], v[8:9], v[230:231], v[12:13] op_sel:[0,0,0] op_sel_hi:[1,0,1]
    v_pk_fma_f32 v[10:11], v[8:9], v[230:231], v[130:131] op_sel:[0,1,0] op_sel_hi:[1,1,1] neg_lo:[0,1,0] neg_hi:[0,1,0]
    v_pk_fma_f32 v[12:13], v[4:5], v[230:231], v[146:147] op_sel:[0,1,0] op_sel_hi:[1,1,1]
    v_pk_fma_f32 v[4:5], v[4:5], v[230:231], v[10:11] op_sel:[0,0,0] op_sel_hi:[1,0,1]
    v_pk_fma_f32 v[8:9], v[8:9], v[230:231], v[12:13] op_sel:[0,0,0] op_sel_hi:[1,0,1]
    v_pk_fma_f32 v[10:11], v[8:9], v[230:231], v[148:149] op_sel:[0,1,0] op_sel_hi:[1,1,1] neg_lo:[0,1,0] neg_hi:[0,1,0]
    v_pk_fma_f32 v[12:13], v[4:5], v[230:231], v[164:165] op_sel:[0,1,0] op_sel_hi:[1,1,1]
    v_pk_fma_f32 v[4:5], v[4:5], v[230:231], v[10:11] op_sel:[0,0,0] op_sel_hi:[1,0,1]
    v_pk_fma_f32 v[8:9], v[8:9], v[230:231], v[12:13] op_sel:[0,0,0] op_sel_hi:[1,0,1]
    v_pk_fma_f32 v[10:11], v[8:9], v[230:231], v[150:151] op_sel:[0,1,0] op_sel_hi:[1,1,1] neg_lo:[0,1,0] neg_hi:[0,1,0]
    v_pk_fma_f32 v[12:13], v[4:5], v[230:231], v[166:167] op_sel:[0,1,0] op_sel_hi:[1,1,1]
    v_pk_fma_f32 v[4:5], v[4:5], v[230:231], v[10:11] op_sel:[0,0,0] op_sel_hi:[1,0,1]
    v_pk_fma_f32 v[8:9], v[8:9], v[230:231], v[12:13] op_sel:[0,0,0] op_sel_hi:[1,0,1]
    v_pk_fma_f32 v[10:11], v[8:9], v[230:231], v[152:153] op_sel:[0,1,0] op_sel_hi:[1,1,1] neg_lo:[0,1,0] neg_hi:[0,1,0]
    v_pk_fma_f32 v[12:13], v[4:5], v[230:231], v[168:169] op_sel:[0,1,0] op_sel_hi:[1,1,1]
    v_pk_fma_f32 v[4:5], v[4:5], v[230:231], v[10:11] op_sel:[0,0,0] op_sel_hi:[1,0,1]
    v_pk_fma_f32 v[8:9], v[8:9], v[230:231], v[12:13] op_sel:[0,0,0] op_sel_hi:[1,0,1]
    v_pk_fma_f32 v[10:11], v[8:9], v[230:231], v[154:155] op_sel:[0,1,0] op_sel_hi:[1,1,1] neg_lo:[0,1,0] neg_hi:[0,1,0]
    v_pk_fma_f32 v[12:13], v[4:5], v[230:231], v[170:171] op_sel:[0,1,0] op_sel_hi:[1,1,1]
    v_pk_fma_f32 v[4:5], v[4:5], v[230:231], v[10:11] op_sel:[0,0,0] op_sel_hi:[1,0,1]
    v_pk_fma_f32 v[8:9], v[8:9], v[230:231], v[12:13] op_sel:[0,0,0] op_sel_hi:[1,0,1]
    v_pk_fma_f32 v[10:11], v[8:9], v[230:231], v[156:157] op_sel:[0,1,0] op_sel_hi:[1,1,1] neg_lo:[0,1,0] neg_hi:[0,1,0]
    v_pk_fma_f32 v[12:13], v[4:5], v[230:231], v[172:173] op_sel:[0,1,0] op_sel_hi:[1,1,1]
    v_pk_fma_f32 v[4:5], v[4:5], v[230:231], v[10:11] op_sel:[0,0,0] op_sel_hi:[1,0,1]
    v_pk_fma_f32 v[8:9], v[8:9], v[230:231], v[12:13] op_sel:[0,0,0] op_sel_hi:[1,0,1]
    v_pk_fma_f32 v[10:11], v[8:9], v[230:231], v[158:159] op_sel:[0,1,0] op_sel_hi:[1,1,1] neg_lo:[0,1,0] neg_hi:[0,1,0]
    v_pk_fma_f32 v[12:13], v[4:5], v[230:231], v[174:175] op_sel:[0,1,0] op_sel_hi:[1,1,1]
    v_pk_fma_f32 v[4:5], v[4:5], v[230:231], v[10:11] op_sel:[0,0,0] op_sel_hi:[1,0,1]
    v_pk_fma_f32 v[8:9], v[8:9], v[230:231], v[12:13] op_sel:[0,0,0] op_sel_hi:[1,0,1]
    v_pk_fma_f32 v[10:11], v[8:9], v[230:231], v[160:161] op_sel:[0,1,0] op_sel_hi:[1,1,1] neg_lo:[0,1,0] neg_hi:[0,1,0]
    v_pk_fma_f32 v[12:13], v[4:5], v[230:231], v[176:177] op_sel:[0,1,0] op_sel_hi:[1,1,1]
    v_pk_fma_f32 v[4:5], v[4:5], v[230:231], v[10:11] op_sel:[0,0,0] op_sel_hi:[1,0,1]
    v_pk_fma_f32 v[8:9], v[8:9], v[230:231], v[12:13] op_sel:[0,0,0] op_sel_hi:[1,0,1]
    v_pk_fma_f32 v[10:11], v[8:9], v[230:231], v[162:163] op_sel:[0,1,0] op_sel_hi:[1,1,1] neg_lo:[0,1,0] neg_hi:[0,1,0]
    v_pk_fma_f32 v[12:13], v[4:5], v[230:231], v[178:179] op_sel:[0,1,0] op_sel_hi:[1,1,1]
    v_pk_fma_f32 v[4:5], v[4:5], v[230:231], v[10:11] op_sel:[0,0,0] op_sel_hi:[1,0,1]
    v_pk_fma_f32 v[8:9], v[8:9], v[230:231], v[12:13] op_sel:[0,0,0] op_sel_hi:[1,0,1]
    v_lshrrev_b32 v3, 5, v2
    v_lshlrev_b32 v3, 10, v3
    v_lshl_add_u32 v1, v7, 2, v3
    s_lshr_b32 s3, s44, 1
    s_lshl_b32 s3, s3, 11
    s_add_u32 s3, s3, 150528
    v_add_u32 v1, s3, v1
    ds_write2st64_b32 v1, v4, v8 offset0:12 offset1:13
    ds_write2st64_b32 v1, v5, v9 offset0:14 offset1:15
    s_waitcnt lgkmcnt(0)
    s_barrier
    ds_read2st64_b32 v[66:67], v1 offset0:0 offset1:1
    ds_read2st64_b32 v[68:69], v1 offset0:2 offset1:3
    ds_read2st64_b32 v[70:71], v1 offset0:4 offset1:5
    ds_read2st64_b32 v[72:73], v1 offset0:6 offset1:7
    ds_read2st64_b32 v[74:75], v1 offset0:8 offset1:9
    ds_read2st64_b32 v[76:77], v1 offset0:10 offset1:11
    s_waitcnt lgkmcnt(4)
    v_fma_f32 v20, -v235, v67, v68
    v_fma_f32 v21, v235, v66, v69
    v_fma_f32 v68, v234, v66, v20
    v_fma_f32 v69, v234, v67, v21
    s_waitcnt lgkmcnt(3)
    v_fma_f32 v20, -v235, v69, v70
    v_fma_f32 v21, v235, v68, v71
    v_fma_f32 v70, v234, v68, v20
    v_fma_f32 v71, v234, v69, v21
    s_waitcnt lgkmcnt(2)
    v_fma_f32 v20, -v235, v71, v72
    v_fma_f32 v21, v235, v70, v73
    v_fma_f32 v72, v234, v70, v20
    v_fma_f32 v73, v234, v71, v21
    s_waitcnt lgkmcnt(1)
    v_fma_f32 v20, -v235, v73, v74
    v_fma_f32 v21, v235, v72, v75
    v_fma_f32 v74, v234, v72, v20
    v_fma_f32 v75, v234, v73, v21
    s_waitcnt lgkmcnt(0)
    v_fma_f32 v20, -v235, v75, v76
    v_fma_f32 v21, v235, v74, v77
    v_fma_f32 v76, v234, v74, v20
    v_fma_f32 v77, v234, v75, v21
    v_fma_f32 v20, -v235, v77, v4
    v_fma_f32 v21, v235, v76, v8
    v_fma_f32 v14, v234, v76, v20
    v_fma_f32 v15, v234, v77, v21
    v_fma_f32 v20, -v235, v15, v5
    v_fma_f32 v21, v235, v14, v9
    v_fma_f32 v54, v234, v14, v20
    v_fma_f32 v55, v234, v15, v21
    v_mov_b32 v84, v76
    v_mov_b32 v85, v14
    v_mov_b32 v86, v77
    v_mov_b32 v87, v15
    s_lshl_b32 s3, s46, 14
    s_add_u32 s3, s3, 21037056
    s_add_u32 s48, s40, s3
    s_addc_u32 s49, s41, 0
    s_mov_b32 s50, 16384
    s_mov_b32 s51, 131072
    v_lshlrev_b32 v1, 4, v7
    s_lshl_b32 s4, s45, 10
    s_lshr_b32 s3, s44, 1
    s_cmp_eq_u32 s3, 0
    s_cbranch_scc1 Lnopub_gate_4
    v_mov_b32 v66, v54
    v_mov_b32 v67, v55
    v_mov_b32 v68, s42
    v_mov_b32 v69, s43
    s_mov_b64 s[6:7], exec
    s_mov_b64 exec, s[34:35]
    buffer_store_dwordx4 v[66:69], v1, s[48:51], s4 offen sc0 sc1
    s_mov_b64 exec, s[6:7]
    s_nop 1
Lnopub_gate_4:
    s_lshl_b32 s3, s46, 2
    s_add_u32 s3, s3, s44
    s_lshl_b32 s3, s3, 7
    s_add_u32 s3, s3, 21504000
    v_and_b32 v3, 15, v2
    v_lshlrev_b32 v3, 3, v3
    v_add_u32 v3, s3, v3
    v_lshrrev_b32 v9, 5, v2
    v_lshlrev_b32 v9, 10, v9
    v_sub_u32 v9, v1, v9
    s_sub_u32 s3, s4, 1024
    v_add_u32 v8, s3, v9
    v_mul_f32 v14, v237, v237
    v_fma_f32 v14, v236, v236, -v14
    v_mul_f32 v15, v236, v237
    v_add_f32 v15, v15, v15
    v_lshrrev_b32 v9, 5, v2
    v_sub_u32 v9, s45, v9
    v_add_u32 v9, 1, v9
    v_lshrrev_b32 v16, 1, v9
    s_lshl_b32 s3, s46, 2
    s_add_u32 s3, s3, s44
    s_lshl_b32 s6, s3, 16
    s_add_u32 s6, s6, 16777216
    s_lshl_b32 s7, s46, 12
    s_and_b32 s3, s46, 7
    s_lshl_b32 s3, s3, 2
    s_lshl_b32 s13, -1, s3
    s_and_b32 s13, s13, 0x01111111
    s_add_u32 s13, s13, 0x06543210
    s_bitcmp1_b32 s46, 3
    s_cselect_b32 s17, 0x08888888, 0
    s_add_u32 s13, s13, s17
    s_bitcmp1_b32 s46, 3
    s_cselect_b32 s17, 0, 0x88888888
    s_add_u32 s16, s17, 0x76543210
    s_lshl_b32 s17, s16, 28
    s_or_b32 s14, s13, s17
    s_lshr_b32 s15, s16, 4
    buffer_load_dwordx2 v[82:83], v182, s[8:11], 0 offen sc0 sc1
    v_pk_mul_f32 v[10:11], v[132:133], v[232:233] op_sel:[0,1] op_sel_hi:[1,1] neg_lo:[0,1] neg_hi:[0,1]
    v_pk_mul_f32 v[12:13], v[116:117], v[232:233] op_sel:[0,1] op_sel_hi:[1,1]
    v_pk_fma_f32 v[116:117], v[116:117], v[232:233], v[10:11] op_sel:[0,0,0] op_sel_hi:[1,0,1]
    v_pk_fma_f32 v[132:133], v[132:133], v[232:233], v[12:13] op_sel:[0,0,0] op_sel_hi:[1,0,1]
    v_pk_mul_f32 v[10:11], v[134:135], v[232:233] op_sel:[0,1] op_sel_hi:[1,1] neg_lo:[0,1] neg_hi:[0,1]
    v_pk_mul_f32 v[12:13], v[118:119], v[232:233] op_sel:[0,1] op_sel_hi:[1,1]
    v_pk_fma_f32 v[118:119], v[118:119], v[232:233], v[10:11] op_sel:[0,0,0] op_sel_hi:[1,0,1]
    v_pk_fma_f32 v[134:135], v[134:135], v[232:233], v[12:13] op_sel:[0,0,0] op_sel_hi:[1,0,1]
    v_pk_mul_f32 v[10:11], v[136:137], v[232:233] op_sel:[0,1] op_sel_hi:[1,1] neg_lo:[0,1] neg_hi:[0,1]
    v_pk_mul_f32 v[12:13], v[120:121], v[232:233] op_sel:[0,1] op_sel_hi:[1,1]
    v_pk_fma_f32 v[120:121], v[120:121], v[232:233], v[10:11] op_sel:[0,0,0] op_sel_hi:[1,0,1]
    v_pk_fma_f32 v[136:137], v[136:137], v[232:233], v[12:13] op_sel:[0,0,0] op_sel_hi:[1,0,1]
    v_pk_mul_f32 v[10:11], v[138:139], v[232:233] op_sel:[0,1] op_sel_hi:[1,1] neg_lo:[0,1] neg_hi:[0,1]
    v_pk_mul_f32 v[12:13], v[122:123], v[232:233] op_sel:[0,1] op_sel_hi:[1,1]
    v_pk_fma_f32 v[122:123], v[122:123], v[232:233], v[10:11] op_sel:[0,0,0] op_sel_hi:[1,0,1]
    v_pk_fma_f32 v[138:139], v[138:139], v[232:233], v[12:13] op_sel:[0,0,0] op_sel_hi:[1,0,1]
    v_pk_mul_f32 v[10:11], v[140:141], v[232:233] op_sel:[0,1] op_sel_hi:[1,1] neg_lo:[0,1] neg_hi:[0,1]
    v_pk_mul_f32 v[12:13], v[124:125], v[232:233] op_sel:[0,1] op_sel_hi:[1,1]
    v_pk_fma_f32 v[124:125], v[124:125], v[232:233], v[10:11] op_sel:[0,0,0] op_sel_hi:[1,0,1]
    v_pk_fma_f32 v[140:141], v[140:141], v[232:233], v[12:13] op_sel:[0,0,0] op_sel_hi:[1,0,1]
    v_pk_mul_f32 v[10:11], v[142:143], v[232:233] op_sel:[0,1] op_sel_hi:[1,1] neg_lo:[0,1] neg_hi:[0,1]
    v_pk_mul_f32 v[12:13], v[126:127], v[232:233] op_sel:[0,1] op_sel_hi:[1,1]
    v_pk_fma_f32 v[126:127], v[126:127], v[232:233], v[10:11] op_sel:[0,0,0] op_sel_hi:[1,0,1]
    v_pk_fma_f32 v[142:143], v[142:143], v[232:233], v[12:13] op_sel:[0,0,0] op_sel_hi:[1,0,1]
    v_pk_mul_f32 v[10:11], v[144:145], v[232:233] op_sel:[0,1] op_sel_hi:[1,1] neg_lo:[0,1] neg_hi:[0,1]
    v_pk_mul_f32 v[12:13], v[128:129], v[232:233] op_sel:[0,1] op_sel_hi:[1,1]
    v_pk_fma_f32 v[128:129], v[128:129], v[232:233], v[10:11] op_sel:[0,0,0] op_sel_hi:[1,0,1]
    v_pk_fma_f32 v[144:145], v[144:145], v[232:233], v[12:13] op_sel:[0,0,0] op_sel_hi:[1,0,1]
    v_pk_mul_f32 v[10:11], v[146:147], v[232:233] op_sel:[0,1] op_sel_hi:[1,1] neg_lo:[0,1] neg_hi:[0,1]
    v_pk_mul_f32 v[12:13], v[130:131], v[232:233] op_sel:[0,1] op_sel_hi:[1,1]
    v_pk_fma_f32 v[130:131], v[130:131], v[232:233], v[10:11] op_sel:[0,0,0] op_sel_hi:[1,0,1]
    v_pk_fma_f32 v[146:147], v[146:147], v[232:233], v[12:13] op_sel:[0,0,0] op_sel_hi:[1,0,1]
    v_pk_mul_f32 v[10:11], v[164:165], v[232:233] op_sel:[0,1] op_sel_hi:[1,1] neg_lo:[0,1] neg_hi:[0,1]
    v_pk_mul_f32 v[12:13], v[148:149], v[232:233] op_sel:[0,1] op_sel_hi:[1,1]
    v_pk_fma_f32 v[148:149], v[148:149], v[232:233], v[10:11] op_sel:[0,0,0] op_sel_hi:[1,0,1]
    v_pk_fma_f32 v[164:165], v[164:165], v[232:233], v[12:13] op_sel:[0,0,0] op_sel_hi:[1,0,1]
    v_pk_mul_f32 v[10:11], v[166:167], v[232:233] op_sel:[0,1] op_sel_hi:[1,1] neg_lo:[0,1] neg_hi:[0,1]
    v_pk_mul_f32 v[12:13], v[150:151], v[232:233] op_sel:[0,1] op_sel_hi:[1,1]
    v_pk_fma_f32 v[150:151], v[150:151], v[232:233], v[10:11] op_sel:[0,0,0] op_sel_hi:[1,0,1]
    v_pk_fma_f32 v[166:167], v[166:167], v[232:233], v[12:13] op_sel:[0,0,0] op_sel_hi:[1,0,1]
    v_pk_mul_f32 v[10:11], v[168:169], v[232:233] op_sel:[0,1] op_sel_hi:[1,1] neg_lo:[0,1] neg_hi:[0,1]
    v_pk_mul_f32 v[12:13], v[152:153], v[232:233] op_sel:[0,1] op_sel_hi:[1,1]
    v_pk_fma_f32 v[152:153], v[152:153], v[232:233], v[10:11] op_sel:[0,0,0] op_sel_hi:[1,0,1]
    v_pk_fma_f32 v[168:169], v[168:169], v[232:233], v[12:13] op_sel:[0,0,0] op_sel_hi:[1,0,1]
    v_pk_mul_f32 v[10:11], v[170:171], v[232:233] op_sel:[0,1] op_sel_hi:[1,1] neg_lo:[0,1] neg_hi:[0,1]
    v_pk_mul_f32 v[12:13], v[154:155], v[232:233] op_sel:[0,1] op_sel_hi:[1,1]
    v_pk_fma_f32 v[154:155], v[154:155], v[232:233], v[10:11] op_sel:[0,0,0] op_sel_hi:[1,0,1]
    v_pk_fma_f32 v[170:171], v[170:171], v[232:233], v[12:13] op_sel:[0,0,0] op_sel_hi:[1,0,1]
    v_pk_mul_f32 v[10:11], v[172:173], v[232:233] op_sel:[0,1] op_sel_hi:[1,1] neg_lo:[0,1] neg_hi:[0,1]
    v_pk_mul_f32 v[12:13], v[156:157], v[232:233] op_sel:[0,1] op_sel_hi:[1,1]
    v_pk_fma_f32 v[156:157], v[156:157], v[232:233], v[10:11] op_sel:[0,0,0] op_sel_hi:[1,0,1]
    v_pk_fma_f32 v[172:173], v[172:173], v[232:233], v[12:13] op_sel:[0,0,0] op_sel_hi:[1,0,1]
    v_pk_mul_f32 v[10:11], v[174:175], v[232:233] op_sel:[0,1] op_sel_hi:[1,1] neg_lo:[0,1] neg_hi:[0,1]
    v_pk_mul_f32 v[12:13], v[158:159], v[232:233] op_sel:[0,1] op_sel_hi:[1,1]
    v_pk_fma_f32 v[158:159], v[158:159], v[232:233], v[10:11] op_sel:[0,0,0] op_sel_hi:[1,0,1]
    v_pk_fma_f32 v[174:175], v[174:175], v[232:233], v[12:13] op_sel:[0,0,0] op_sel_hi:[1,0,1]
    v_pk_mul_f32 v[10:11], v[176:177], v[232:233] op_sel:[0,1] op_sel_hi:[1,1] neg_lo:[0,1] neg_hi:[0,1]
    v_pk_mul_f32 v[12:13], v[160:161], v[232:233] op_sel:[0,1] op_sel_hi:[1,1]
    v_pk_fma_f32 v[160:161], v[160:161], v[232:233], v[10:11] op_sel:[0,0,0] op_sel_hi:[1,0,1]
    v_pk_fma_f32 v[176:177], v[176:177], v[232:233], v[12:13] op_sel:[0,0,0] op_sel_hi:[1,0,1]
    v_pk_mul_f32 v[10:11], v[178:179], v[232:233] op_sel:[0,1] op_sel_hi:[1,1] neg_lo:[0,1] neg_hi:[0,1]
    v_pk_mul_f32 v[12:13], v[162:163], v[232:233] op_sel:[0,1] op_sel_hi:[1,1]
    v_pk_fma_f32 v[162:163], v[162:163], v[232:233], v[10:11] op_sel:[0,0,0] op_sel_hi:[1,0,1]
    v_pk_fma_f32 v[178:179], v[178:179], v[232:233], v[12:13] op_sel:[0,0,0] op_sel_hi:[1,0,1]
    s_mov_b32 s13, 0
    s_waitcnt vmcnt(0)
    v_cmp_ne_u64 vcc, s[42:43], v[82:83]
    s_nop 4
    s_cbranch_vccz Lfdone_gate_5
Lfpoll_gate_6:
    buffer_load_dwordx2 v[82:83], v182, s[8:11], 0 offen sc0 sc1
    s_waitcnt vmcnt(0)
    v_cmp_ne_u64 vcc, s[42:43], v[82:83]
    s_nop 4
    s_add_u32 s13, s13, 1
    s_cmp_gt_u32 s13, 20000
    s_cbranch_scc1 Lfdone_gate_5
    s_cbranch_vccnz Lfpoll_gate_6
Lfdone_gate_5:
    s_mov_b32 m0, s29
    s_nop 0
    buffer_load_dwordx4 v207, s[8:11], s28 offen offset:0 sc0 sc1 lds
    buffer_load_dwordx4 v207, s[8:11], s28 offen offset:1024 sc0 sc1 lds
    buffer_load_dwordx4 v207, s[8:11], s28 offen offset:2048 sc0 sc1 lds
    buffer_load_dwordx4 v207, s[8:11], s28 offen offset:3072 sc0 sc1 lds
    s_lshr_b32 s16, s44, 1
    v_lshrrev_b32 v53, 5, v2
    v_lshlrev_b32 v53, 13, v53
    v_lshl_add_u32 v9, v7, 2, v53
    s_lshl_b32 s3, s16, 14
    s_add_u32 s3, s3, 0
    v_add_u32 v9, s3, v9
    v_lshrrev_b32 v53, 4, v2
    v_lshlrev_b32 v53, 4, v53
    v_bfe_u32 v54, v2, 3, 1
    v_add_u32 v53, v53, v54
    v_and_b32 v21, 7, v2
    v_xor_b32 v54, v54, v21
    s_and_b32 s3, s44, 1
    s_lshl_b32 s3, s3, 3
    v_or_b32 v54, s3, v54
    v_lshlrev_b32 v54, 4, v54
    v_lshl_add_u32 v20, v53, 8, v54
    s_lshl_b32 s3, s16, 14
    s_add_u32 s3, s3, 0
    v_add_u32 v20, s3, v20
    v_lshlrev_b32 v21, 4, v21
    v_lshl_add_u32 v21, v53, 12, v21
    s_lshl_b32 s13, s45, 19
    s_lshl_b32 s3, s16, 18
    s_add_u32 s13, s13, s3
    s_lshl_b32 s3, s46, 8
    s_add_u32 s13, s13, s3
    s_and_b32 s3, s44, 1
    s_lshl_b32 s3, s3, 7
    s_add_u32 s13, s13, s3
    buffer_load_dwordx2 v[4:5], v3, s[8:11], 0 offen sc0 sc1
    v_mov_b32 v18, 0
    ds_write_b128 v51, v[38:41] offset:0
    v_alignbit_b32 v42, v39, v38, 16
    v_alignbit_b32 v43, v40, v39, 16
    v_mov_b32_dpp v18, v38 wave_shl:1 row_mask:0xf bank_mask:0xf
    v_alignbit_b32 v44, v41, v40, 16
    v_alignbit_b32 v45, v18, v41, 16
    ds_write_b128 v51, v[42:45] offset:4160
    v_readfirstlane_b32 s3, v26
    s_nop 1
    v_mov_b32 v19, s3
    ds_write_b128 v51, v[22:25] offset:32
    v_alignbit_b32 v46, v23, v22, 16
    v_alignbit_b32 v47, v24, v23, 16
    v_mov_b32_dpp v19, v22 wave_shl:1 row_mask:0xf bank_mask:0xf
    v_alignbit_b32 v48, v25, v24, 16
    v_alignbit_b32 v49, v19, v25, 16
    ds_write_b128 v51, v[46:49] offset:4192
    v_readfirstlane_b32 s3, v30
    s_nop 1
    v_mov_b32 v18, s3
    ds_write_b128 v51, v[26:29] offset:1056
    v_alignbit_b32 v42, v27, v26, 16
    v_alignbit_b32 v43, v28, v27, 16
    v_mov_b32_dpp v18, v26 wave_shl:1 row_mask:0xf bank_mask:0xf
    v_alignbit_b32 v44, v29, v28, 16
    v_alignbit_b32 v45, v18, v29, 16
    ds_write_b128 v51, v[42:45] offset:5216
    v_subrev_u32 v66, 0, v8
    v_min_u32 v66, 0x7fff0000, v66
    buffer_load_dwordx4 v[66:69], v66, s[48:51], 0 offen sc0 sc1
    v_subrev_u32 v70, 2048, v8
    v_min_u32 v70, 0x7fff0000, v70
    buffer_load_dwordx4 v[70:73], v70, s[48:51], 0 offen sc0 sc1
    v_subrev_u32 v74, 4096, v8
    v_min_u32 v74, 0x7fff0000, v74
    buffer_load_dwordx4 v[74:77], v74, s[48:51], 0 offen sc0 sc1
    v_subrev_u32 v78, 6144, v8
    v_min_u32 v78, 0x7fff0000, v78
    buffer_load_dwordx4 v[78:81], v78, s[48:51], 0 offen sc0 sc1
    v_subrev_u32 v88, 8192, v8
    v_min_u32 v88, 0x7fff0000, v88
    buffer_load_dwordx4 v[88:91], v88, s[48:51], 0 offen sc0 sc1
    v_subrev_u32 v92, 10240, v8
    v_min_u32 v92, 0x7fff0000, v92
    buffer_load_dwordx4 v[92:95], v92, s[48:51], 0 offen sc0 sc1
    v_subrev_u32 v96, 12288, v8
    v_min_u32 v96, 0x7fff0000, v96
    buffer_load_dwordx4 v[96:99], v96, s[48:51], 0 offen sc0 sc1
    v_subrev_u32 v100, 14336, v8
    v_min_u32 v100, 0x7fff0000, v100
    buffer_load_dwordx4 v[100:103], v100, s[48:51], 0 offen sc0 sc1
    v_readfirstlane_b32 s3, v34
    s_nop 1
    v_mov_b32 v19, s3
    ds_write_b128 v51, v[30:33] offset:2080
    v_alignbit_b32 v46, v31, v30, 16
    v_alignbit_b32 v47, v32, v31, 16
    v_mov_b32_dpp v19, v30 wave_shl:1 row_mask:0xf bank_mask:0xf
    v_alignbit_b32 v48, v33, v32, 16
    v_alignbit_b32 v49, v19, v33, 16
    ds_write_b128 v51, v[46:49] offset:6240
    v_mov_b32 v18, 0
    ds_write_b128 v51, v[34:37] offset:3104
    v_alignbit_b32 v42, v35, v34, 16
    v_alignbit_b32 v43, v36, v35, 16
    v_mov_b32_dpp v18, v34 wave_shl:1 row_mask:0xf bank_mask:0xf
    v_alignbit_b32 v44, v37, v36, 16
    v_alignbit_b32 v45, v18, v37, 16
    ds_write_b128 v51, v[42:45] offset:7264
    v_lshlrev_b32 v183, 16, v183
    s_mov_b32 s16, 0
    v_mov_b32 v18, 0
    s_waitcnt vmcnt(7)
    v_cmp_eq_u64 s[60:61], s[42:43], v[68:69]
    s_waitcnt vmcnt(6)
    v_cmp_eq_u64 s[62:63], s[42:43], v[72:73]
    s_waitcnt vmcnt(5)
    v_cmp_eq_u64 s[64:65], s[42:43], v[76:77]
    s_waitcnt vmcnt(4)
    v_cmp_eq_u64 s[66:67], s[42:43], v[80:81]
    v_addc_co_u32 v18, vcc, 0, v18, s[60:61]
    v_addc_co_u32 v18, vcc, 0, v18, s[62:63]
    v_addc_co_u32 v18, vcc, 0, v18, s[64:65]
    v_addc_co_u32 v18, vcc, 0, v18, s[66:67]
    s_waitcnt vmcnt(3)
    v_cmp_eq_u64 s[60:61], s[42:43], v[90:91]
    s_waitcnt vmcnt(2)
    v_cmp_eq_u64 s[62:63], s[42:43], v[94:95]
    s_waitcnt vmcnt(1)
    v_cmp_eq_u64 s[64:65], s[42:43], v[98:99]
    s_waitcnt vmcnt(0)
    v_cmp_eq_u64 s[66:67], s[42:43], v[102:103]
    v_addc_co_u32 v18, vcc, 0, v18, s[60:61]
    v_addc_co_u32 v18, vcc, 0, v18, s[62:63]
    v_addc_co_u32 v18, vcc, 0, v18, s[64:65]
    v_addc_co_u32 v18, vcc, 0, v18, s[66:67]
    v_cmp_ne_u32 vcc, v16, v18
    s_nop 4
    s_cbranch_vccz Lpolldone_gate_7
Lpoll_gate_8:
    v_subrev_u32 v66, 0, v8
    v_min_u32 v66, 0x7fff0000, v66
    buffer_load_dwordx4 v[66:69], v66, s[48:51], 0 offen sc0 sc1
    v_subrev_u32 v70, 2048, v8
    v_min_u32 v70, 0x7fff0000, v70
    buffer_load_dwordx4 v[70:73], v70, s[48:51], 0 offen sc0 sc1
    v_subrev_u32 v74, 4096, v8
    v_min_u32 v74, 0x7fff0000, v74
    buffer_load_dwordx4 v[74:77], v74, s[48:51], 0 offen sc0 sc1
    v_subrev_u32 v78, 6144, v8
    v_min_u32 v78, 0x7fff0000, v78
    buffer_load_dwordx4 v[78:81], v78, s[48:51], 0 offen sc0 sc1
    v_subrev_u32 v88, 8192, v8
    v_min_u32 v88, 0x7fff0000, v88
    buffer_load_dwordx4 v[88:91], v88, s[48:51], 0 offen sc0 sc1
    v_subrev_u32 v92, 10240, v8
    v_min_u32 v92, 0x7fff0000, v92
    buffer_load_dwordx4 v[92:95], v92, s[48:51], 0 offen sc0 sc1
    v_subrev_u32 v96, 12288, v8
    v_min_u32 v96, 0x7fff0000, v96
    buffer_load_dwordx4 v[96:99], v96, s[48:51], 0 offen sc0 sc1
    v_subrev_u32 v100, 14336, v8
    v_min_u32 v100, 0x7fff0000, v100
    buffer_load_dwordx4 v[100:103], v100, s[48:51], 0 offen sc0 sc1
    s_waitcnt vmcnt(0) lgkmcnt(0)
    v_mov_b32 v18, 0
    v_cmp_eq_u64 s[60:61], s[42:43], v[68:69]
    v_cmp_eq_u64 s[62:63], s[42:43], v[72:73]
    v_cmp_eq_u64 s[64:65], s[42:43], v[76:77]
    v_cmp_eq_u64 s[66:67], s[42:43], v[80:81]
    v_addc_co_u32 v18, vcc, 0, v18, s[60:61]
    v_addc_co_u32 v18, vcc, 0, v18, s[62:63]
    v_addc_co_u32 v18, vcc, 0, v18, s[64:65]
    v_addc_co_u32 v18, vcc, 0, v18, s[66:67]
    v_cmp_eq_u64 s[60:61], s[42:43], v[90:91]
    v_cmp_eq_u64 s[62:63], s[42:43], v[94:95]
    v_cmp_eq_u64 s[64:65], s[42:43], v[98:99]
    v_cmp_eq_u64 s[66:67], s[42:43], v[102:103]
    v_addc_co_u32 v18, vcc, 0, v18, s[60:61]
    v_addc_co_u32 v18, vcc, 0, v18, s[62:63]
    v_addc_co_u32 v18, vcc, 0, v18, s[64:65]
    v_addc_co_u32 v18, vcc, 0, v18, s[66:67]
    v_cmp_ne_u32 vcc, v16, v18
    s_add_u32 s16, s16, 1
    s_cmp_gt_u32 s16, 20000
    s_cbranch_scc1 Lpolldone_gate_7
    s_nop 1
    s_cbranch_vccnz Lpoll_gate_8
Lpolldone_gate_7:
    s_nop 4
    v_fma_f32 v22, -v15, v101, v96
    v_fma_f32 v23, v15, v100, v97
    v_fma_f32 v96, v14, v100, v22
    v_fma_f32 v97, v14, v101, v23
    v_fma_f32 v22, -v15, v97, v92
    v_fma_f32 v23, v15, v96, v93
    v_fma_f32 v92, v14, v96, v22
    v_fma_f32 v93, v14, v97, v23
    v_fma_f32 v22, -v15, v93, v88
    v_fma_f32 v23, v15, v92, v89
    v_fma_f32 v88, v14, v92, v22
    v_fma_f32 v89, v14, v93, v23
    v_fma_f32 v22, -v15, v89, v78
    v_fma_f32 v23, v15, v88, v79
    v_fma_f32 v78, v14, v88, v22
    v_fma_f32 v79, v14, v89, v23
    v_fma_f32 v22, -v15, v79, v74
    v_fma_f32 v23, v15, v78, v75
    v_fma_f32 v74, v14, v78, v22
    v_fma_f32 v75, v14, v79, v23
    v_fma_f32 v22, -v15, v75, v70
    v_fma_f32 v23, v15, v74, v71
    v_fma_f32 v70, v14, v74, v22
    v_fma_f32 v71, v14, v75, v23
    v_fma_f32 v22, -v15, v71, v66
    v_fma_f32 v23, v15, v70, v67
    v_fma_f32 v66, v14, v70, v22
    v_fma_f32 v67, v14, v71, v23
    v_mov_b32 v70, v66
    v_mov_b32 v71, v67
    s_nop 0
    v_permlane32_swap_b32 v66, v70
    v_permlane32_swap_b32 v67, v71
    v_fma_f32 v22, -v237, v71, v66
    v_fma_f32 v23, v237, v70, v67
    v_fma_f32 v24, v236, v70, v22
    v_fma_f32 v25, v236, v71, v23
    s_mov_b32 s4, 0
    v_cmp_ne_u64 vcc, s[42:43], v[4:5]
    s_nop 4
    s_cbranch_vccz Lfdone_gate_9
Lfpoll_gate_10:
    buffer_load_dwordx2 v[4:5], v3, s[8:11], 0 offen sc0 sc1
    s_waitcnt vmcnt(0)
    v_cmp_ne_u64 vcc, s[42:43], v[4:5]
    s_nop 4
    s_add_u32 s4, s4, 1
    s_cmp_gt_u32 s4, 20000
    s_cbranch_scc1 Lfdone_gate_9
    s_cbranch_vccnz Lfpoll_gate_10
Lfdone_gate_9:
    v_pk_fma_f32 v[10:11], v[240:241], v[24:25], v[84:85] op_sel:[0,1,0] op_sel_hi:[1,1,1] neg_lo:[0,1,0] neg_hi:[0,1,0]
    v_pk_fma_f32 v[12:13], v[238:239], v[24:25], v[86:87] op_sel:[0,1,0] op_sel_hi:[1,1,1]
    v_pk_fma_f32 v[4:5], v[238:239], v[24:25], v[10:11] op_sel:[0,0,0] op_sel_hi:[1,0,1]
    v_pk_fma_f32 v[14:15], v[240:241], v[24:25], v[12:13] op_sel:[0,0,0] op_sel_hi:[1,0,1]
    v_pk_mul_f32 v[10:11], v[14:15], v[232:233] op_sel:[0,1] op_sel_hi:[1,1] neg_lo:[0,1] neg_hi:[0,1]
    v_pk_mul_f32 v[12:13], v[4:5], v[232:233] op_sel:[0,1] op_sel_hi:[1,1]
    v_pk_fma_f32 v[4:5], v[4:5], v[232:233], v[10:11] op_sel:[0,0,0] op_sel_hi:[1,0,1]
    v_pk_fma_f32 v[14:15], v[14:15], v[232:233], v[12:13] op_sel:[0,0,0] op_sel_hi:[1,0,1]
    v_pk_fma_f32 v[10:11], v[14:15], v[230:231], v[116:117] op_sel:[0,1,0] op_sel_hi:[1,1,1] neg_lo:[0,1,0] neg_hi:[0,1,0]
    v_pk_fma_f32 v[12:13], v[4:5], v[230:231], v[132:133] op_sel:[0,1,0] op_sel_hi:[1,1,1]
    v_pk_fma_f32 v[116:117], v[4:5], v[230:231], v[10:11] op_sel:[0,0,0] op_sel_hi:[1,0,1]
    v_pk_fma_f32 v[132:133], v[14:15], v[230:231], v[12:13] op_sel:[0,0,0] op_sel_hi:[1,0,1]
    s_add_u32 s12, s6, s7
    buffer_load_dwordx4 a[0:3], v17, s[8:11], s12 offen offset:0 sc0 sc1
    v_pk_fma_f32 v[10:11], v[132:133], v[230:231], v[118:119] op_sel:[0,1,0] op_sel_hi:[1,1,1] neg_lo:[0,1,0] neg_hi:[0,1,0]
    v_pk_fma_f32 v[12:13], v[116:117], v[230:231], v[134:135] op_sel:[0,1,0] op_sel_hi:[1,1,1]
    v_pk_fma_f32 v[118:119], v[116:117], v[230:231], v[10:11] op_sel:[0,0,0] op_sel_hi:[1,0,1]
    v_pk_fma_f32 v[134:135], v[132:133], v[230:231], v[12:13] op_sel:[0,0,0] op_sel_hi:[1,0,1]
    v_cvt_pk_bf16_f32 v18, v116, -v132
    v_cvt_pk_bf16_f32 v19, v117, -v133
    ds_write2st64_b32 v9, v18, v19 offset0:0 offset1:16
    buffer_load_dwordx4 a[4:7], v17, s[8:11], s12 offen offset:1024 sc0 sc1
    v_pk_fma_f32 v[10:11], v[134:135], v[230:231], v[120:121] op_sel:[0,1,0] op_sel_hi:[1,1,1] neg_lo:[0,1,0] neg_hi:[0,1,0]
    v_pk_fma_f32 v[12:13], v[118:119], v[230:231], v[136:137] op_sel:[0,1,0] op_sel_hi:[1,1,1]
    v_pk_fma_f32 v[120:121], v[118:119], v[230:231], v[10:11] op_sel:[0,0,0] op_sel_hi:[1,0,1]
    v_pk_fma_f32 v[136:137], v[134:135], v[230:231], v[12:13] op_sel:[0,0,0] op_sel_hi:[1,0,1]
    v_xor_b32 v3, 16, v9
    v_cvt_pk_bf16_f32 v22, v118, -v134
    v_cvt_pk_bf16_f32 v23, v119, -v135
    ds_write2st64_b32 v3, v22, v23 offset0:1 offset1:17
    ds_read_b128 v[28:31], v20 offset:0
    buffer_load_dwordx4 a[8:11], v17, s[8:11], s12 offen offset:2048 sc0 sc1
    v_pk_fma_f32 v[10:11], v[136:137], v[230:231], v[122:123] op_sel:[0,1,0] op_sel_hi:[1,1,1] neg_lo:[0,1,0] neg_hi:[0,1,0]
    v_pk_fma_f32 v[12:13], v[120:121], v[230:231], v[138:139] op_sel:[0,1,0] op_sel_hi:[1,1,1]
    v_pk_fma_f32 v[122:123], v[120:121], v[230:231], v[10:11] op_sel:[0,0,0] op_sel_hi:[1,0,1]
    v_pk_fma_f32 v[138:139], v[136:137], v[230:231], v[12:13] op_sel:[0,0,0] op_sel_hi:[1,0,1]
    v_xor_b32 v1, 32, v9
    v_cvt_pk_bf16_f32 v18, v120, -v136
    v_cvt_pk_bf16_f32 v19, v121, -v137
    ds_write2st64_b32 v1, v18, v19 offset0:2 offset1:18
    s_waitcnt lgkmcnt(1)
    buffer_store_dwordx4 v[28:31], v21, s[8:11], s13 offen sc0 sc1
    buffer_load_dwordx4 a[12:15], v17, s[8:11], s12 offen offset:3072 sc0 sc1
    v_pk_fma_f32 v[10:11], v[138:139], v[230:231], v[124:125] op_sel:[0,1,0] op_sel_hi:[1,1,1] neg_lo:[0,1,0] neg_hi:[0,1,0]
    v_pk_fma_f32 v[12:13], v[122:123], v[230:231], v[140:141] op_sel:[0,1,0] op_sel_hi:[1,1,1]
    v_pk_fma_f32 v[124:125], v[122:123], v[230:231], v[10:11] op_sel:[0,0,0] op_sel_hi:[1,0,1]
    v_pk_fma_f32 v[140:141], v[138:139], v[230:231], v[12:13] op_sel:[0,0,0] op_sel_hi:[1,0,1]
    v_xor_b32 v3, 48, v9
    v_cvt_pk_bf16_f32 v22, v122, -v138
    v_cvt_pk_bf16_f32 v23, v123, -v139
    ds_write2st64_b32 v3, v22, v23 offset0:3 offset1:19
    v_xor_b32 v8, 32, v20
    ds_read_b128 v[32:35], v8 offset:512
    s_bfe_u32 s7, s14, 0x40000
    s_lshl_b32 s7, s7, 12
    s_add_u32 s12, s6, s7
    buffer_load_dwordx4 a[16:19], v17, s[8:11], s12 offen offset:0 sc0 sc1
    v_pk_fma_f32 v[10:11], v[140:141], v[230:231], v[126:127] op_sel:[0,1,0] op_sel_hi:[1,1,1] neg_lo:[0,1,0] neg_hi:[0,1,0]
    v_pk_fma_f32 v[12:13], v[124:125], v[230:231], v[142:143] op_sel:[0,1,0] op_sel_hi:[1,1,1]
    v_pk_fma_f32 v[126:127], v[124:125], v[230:231], v[10:11] op_sel:[0,0,0] op_sel_hi:[1,0,1]
    v_pk_fma_f32 v[142:143], v[140:141], v[230:231], v[12:13] op_sel:[0,0,0] op_sel_hi:[1,0,1]
    v_xor_b32 v1, 64, v9
    v_cvt_pk_bf16_f32 v18, v124, -v140
    v_cvt_pk_bf16_f32 v19, v125, -v141
    ds_write2st64_b32 v1, v18, v19 offset0:4 offset1:20
    s_add_u32 s13, s13, 8192
    s_waitcnt lgkmcnt(1)
    buffer_store_dwordx4 v[32:35], v21, s[8:11], s13 offen sc0 sc1
    buffer_load_dwordx4 a[20:23], v17, s[8:11], s12 offen offset:1024 sc0 sc1
    v_pk_fma_f32 v[10:11], v[142:143], v[230:231], v[128:129] op_sel:[0,1,0] op_sel_hi:[1,1,1] neg_lo:[0,1,0] neg_hi:[0,1,0]
    v_pk_fma_f32 v[12:13], v[126:127], v[230:231], v[144:145] op_sel:[0,1,0] op_sel_hi:[1,1,1]
    v_pk_fma_f32 v[128:129], v[126:127], v[230:231], v[10:11] op_sel:[0,0,0] op_sel_hi:[1,0,1]
    v_pk_fma_f32 v[144:145], v[142:143], v[230:231], v[12:13] op_sel:[0,0,0] op_sel_hi:[1,0,1]
    v_xor_b32 v3, 80, v9
    v_cvt_pk_bf16_f32 v22, v126, -v142
    v_cvt_pk_bf16_f32 v23, v127, -v143
    ds_write2st64_b32 v3, v22, v23 offset0:5 offset1:21
    v_xor_b32 v8, 64, v20
    ds_read_b128 v[28:31], v8 offset:1024
    buffer_load_dwordx4 a[24:27], v17, s[8:11], s12 offen offset:2048 sc0 sc1
    v_pk_fma_f32 v[10:11], v[144:145], v[230:231], v[130:131] op_sel:[0,1,0] op_sel_hi:[1,1,1] neg_lo:[0,1,0] neg_hi:[0,1,0]
    v_pk_fma_f32 v[12:13], v[128:129], v[230:231], v[146:147] op_sel:[0,1,0] op_sel_hi:[1,1,1]
    v_pk_fma_f32 v[130:131], v[128:129], v[230:231], v[10:11] op_sel:[0,0,0] op_sel_hi:[1,0,1]
    v_pk_fma_f32 v[146:147], v[144:145], v[230:231], v[12:13] op_sel:[0,0,0] op_sel_hi:[1,0,1]
    v_xor_b32 v1, 96, v9
    v_cvt_pk_bf16_f32 v18, v128, -v144
    v_cvt_pk_bf16_f32 v19, v129, -v145
    ds_write2st64_b32 v1, v18, v19 offset0:6 offset1:22
    s_add_u32 s13, s13, 8192
    s_waitcnt lgkmcnt(1)
    buffer_store_dwordx4 v[28:31], v21, s[8:11], s13 offen sc0 sc1
    buffer_load_dwordx4 a[28:31], v17, s[8:11], s12 offen offset:3072 sc0 sc1
    v_pk_fma_f32 v[10:11], v[146:147], v[230:231], v[148:149] op_sel:[0,1,0] op_sel_hi:[1,1,1] neg_lo:[0,1,0] neg_hi:[0,1,0]
    v_pk_fma_f32 v[12:13], v[130:131], v[230:231], v[164:165] op_sel:[0,1,0] op_sel_hi:[1,1,1]
    v_pk_fma_f32 v[148:149], v[130:131], v[230:231], v[10:11] op_sel:[0,0,0] op_sel_hi:[1,0,1]
    v_pk_fma_f32 v[164:165], v[146:147], v[230:231], v[12:13] op_sel:[0,0,0] op_sel_hi:[1,0,1]
    v_xor_b32 v3, 112, v9
    v_cvt_pk_bf16_f32 v22, v130, -v146
    v_cvt_pk_bf16_f32 v23, v131, -v147
    ds_write2st64_b32 v3, v22, v23 offset0:7 offset1:23
    v_xor_b32 v8, 96, v20
    ds_read_b128 v[32:35], v8 offset:1536
    s_bfe_u32 s7, s14, 0x40004
    s_lshl_b32 s7, s7, 12
    s_add_u32 s12, s6, s7
    buffer_load_dwordx4 a[32:35], v17, s[8:11], s12 offen offset:0 sc0 sc1
    v_pk_fma_f32 v[10:11], v[164:165], v[230:231], v[150:151] op_sel:[0,1,0] op_sel_hi:[1,1,1] neg_lo:[0,1,0] neg_hi:[0,1,0]
    v_pk_fma_f32 v[12:13], v[148:149], v[230:231], v[166:167] op_sel:[0,1,0] op_sel_hi:[1,1,1]
    v_pk_fma_f32 v[150:151], v[148:149], v[230:231], v[10:11] op_sel:[0,0,0] op_sel_hi:[1,0,1]
    v_pk_fma_f32 v[166:167], v[164:165], v[230:231], v[12:13] op_sel:[0,0,0] op_sel_hi:[1,0,1]
    v_xor_b32 v1, 128, v9
    v_cvt_pk_bf16_f32 v18, v148, -v164
    v_cvt_pk_bf16_f32 v19, v149, -v165
    ds_write2st64_b32 v1, v18, v19 offset0:8 offset1:24
    s_add_u32 s13, s13, 8192
    s_waitcnt lgkmcnt(1)
    buffer_store_dwordx4 v[32:35], v21, s[8:11], s13 offen sc0 sc1
    buffer_load_dwordx4 a[36:39], v17, s[8:11], s12 offen offset:1024 sc0 sc1
    v_pk_fma_f32 v[10:11], v[166:167], v[230:231], v[152:153] op_sel:[0,1,0] op_sel_hi:[1,1,1] neg_lo:[0,1,0] neg_hi:[0,1,0]
    v_pk_fma_f32 v[12:13], v[150:151], v[230:231], v[168:169] op_sel:[0,1,0] op_sel_hi:[1,1,1]
    v_pk_fma_f32 v[152:153], v[150:151], v[230:231], v[10:11] op_sel:[0,0,0] op_sel_hi:[1,0,1]
    v_pk_fma_f32 v[168:169], v[166:167], v[230:231], v[12:13] op_sel:[0,0,0] op_sel_hi:[1,0,1]
    v_xor_b32 v3, 144, v9
    v_cvt_pk_bf16_f32 v22, v150, -v166
    v_cvt_pk_bf16_f32 v23, v151, -v167
    ds_write2st64_b32 v3, v22, v23 offset0:9 offset1:25
    v_xor_b32 v8, 128, v20
    ds_read_b128 v[28:31], v8 offset:2048
    buffer_load_dwordx4 a[40:43], v17, s[8:11], s12 offen offset:2048 sc0 sc1
    v_pk_fma_f32 v[10:11], v[168:169], v[230:231], v[154:155] op_sel:[0,1,0] op_sel_hi:[1,1,1] neg_lo:[0,1,0] neg_hi:[0,1,0]
    v_pk_fma_f32 v[12:13], v[152:153], v[230:231], v[170:171] op_sel:[0,1,0] op_sel_hi:[1,1,1]
    v_pk_fma_f32 v[154:155], v[152:153], v[230:231], v[10:11] op_sel:[0,0,0] op_sel_hi:[1,0,1]
    v_pk_fma_f32 v[170:171], v[168:169], v[230:231], v[12:13] op_sel:[0,0,0] op_sel_hi:[1,0,1]
    v_xor_b32 v1, 160, v9
    v_cvt_pk_bf16_f32 v18, v152, -v168
    v_cvt_pk_bf16_f32 v19, v153, -v169
    ds_write2st64_b32 v1, v18, v19 offset0:10 offset1:26
    s_add_u32 s13, s13, 8192
    s_waitcnt lgkmcnt(1)
    buffer_store_dwordx4 v[28:31], v21, s[8:11], s13 offen sc0 sc1
    buffer_load_dwordx4 a[44:47], v17, s[8:11], s12 offen offset:3072 sc0 sc1
    v_pk_fma_f32 v[10:11], v[170:171], v[230:231], v[156:157] op_sel:[0,1,0] op_sel_hi:[1,1,1] neg_lo:[0,1,0] neg_hi:[0,1,0]
    v_pk_fma_f32 v[12:13], v[154:155], v[230:231], v[172:173] op_sel:[0,1,0] op_sel_hi:[1,1,1]
    v_pk_fma_f32 v[156:157], v[154:155], v[230:231], v[10:11] op_sel:[0,0,0] op_sel_hi:[1,0,1]
    v_pk_fma_f32 v[172:173], v[170:171], v[230:231], v[12:13] op_sel:[0,0,0] op_sel_hi:[1,0,1]
    v_xor_b32 v3, 176, v9
    v_cvt_pk_bf16_f32 v22, v154, -v170
    v_cvt_pk_bf16_f32 v23, v155, -v171
    ds_write2st64_b32 v3, v22, v23 offset0:11 offset1:27
    v_xor_b32 v8, 160, v20
    ds_read_b128 v[32:35], v8 offset:2560
    v_pk_fma_f32 v[10:11], v[172:173], v[230:231], v[158:159] op_sel:[0,1,0] op_sel_hi:[1,1,1] neg_lo:[0,1,0] neg_hi:[0,1,0]
    v_pk_fma_f32 v[12:13], v[156:157], v[230:231], v[174:175] op_sel:[0,1,0] op_sel_hi:[1,1,1]
    v_pk_fma_f32 v[158:159], v[156:157], v[230:231], v[10:11] op_sel:[0,0,0] op_sel_hi:[1,0,1]
    v_pk_fma_f32 v[174:175], v[172:173], v[230:231], v[12:13] op_sel:[0,0,0] op_sel_hi:[1,0,1]
    v_xor_b32 v1, 192, v9
    v_cvt_pk_bf16_f32 v18, v156, -v172
    v_cvt_pk_bf16_f32 v19, v157, -v173
    ds_write2st64_b32 v1, v18, v19 offset0:12 offset1:28
    s_add_u32 s13, s13, 8192
    s_waitcnt lgkmcnt(1)
    buffer_store_dwordx4 v[32:35], v21, s[8:11], s13 offen sc0 sc1
    v_pk_fma_f32 v[10:11], v[174:175], v[230:231], v[160:161] op_sel:[0,1,0] op_sel_hi:[1,1,1] neg_lo:[0,1,0] neg_hi:[0,1,0]
    v_pk_fma_f32 v[12:13], v[158:159], v[230:231], v[176:177] op_sel:[0,1,0] op_sel_hi:[1,1,1]
    v_pk_fma_f32 v[160:161], v[158:159], v[230:231], v[10:11] op_sel:[0,0,0] op_sel_hi:[1,0,1]
    v_pk_fma_f32 v[176:177], v[174:175], v[230:231], v[12:13] op_sel:[0,0,0] op_sel_hi:[1,0,1]
    v_xor_b32 v3, 208, v9
    v_cvt_pk_bf16_f32 v22, v158, -v174
    v_cvt_pk_bf16_f32 v23, v159, -v175
    ds_write2st64_b32 v3, v22, v23 offset0:13 offset1:29
    v_xor_b32 v8, 192, v20
    ds_read_b128 v[28:31], v8 offset:3072
    v_pk_fma_f32 v[10:11], v[176:177], v[230:231], v[162:163] op_sel:[0,1,0] op_sel_hi:[1,1,1] neg_lo:[0,1,0] neg_hi:[0,1,0]
    v_pk_fma_f32 v[12:13], v[160:161], v[230:231], v[178:179] op_sel:[0,1,0] op_sel_hi:[1,1,1]
    v_pk_fma_f32 v[162:163], v[160:161], v[230:231], v[10:11] op_sel:[0,0,0] op_sel_hi:[1,0,1]
    v_pk_fma_f32 v[178:179], v[176:177], v[230:231], v[12:13] op_sel:[0,0,0] op_sel_hi:[1,0,1]
    v_xor_b32 v1, 224, v9
    v_cvt_pk_bf16_f32 v18, v160, -v176
    v_cvt_pk_bf16_f32 v19, v161, -v177
    ds_write2st64_b32 v1, v18, v19 offset0:14 offset1:30
    s_add_u32 s13, s13, 8192
    s_waitcnt lgkmcnt(1)
    buffer_store_dwordx4 v[28:31], v21, s[8:11], s13 offen sc0 sc1
    v_xor_b32 v3, 240, v9
    v_cvt_pk_bf16_f32 v22, v162, -v178
    v_cvt_pk_bf16_f32 v23, v163, -v179
    ds_write2st64_b32 v3, v22, v23 offset0:15 offset1:31
    v_xor_b32 v8, 224, v20
    ds_read_b128 v[32:35], v8 offset:3584
    s_add_u32 s13, s13, 8192
    s_waitcnt lgkmcnt(0)
    buffer_store_dwordx4 v[32:35], v21, s[8:11], s13 offen sc0 sc1
    s_barrier
    ds_read2_b32 v[96:97], v57 offset0:112 offset1:113
    ds_read2_b32 v[98:99], v57 offset0:114 offset1:115
    ds_read_b128 v[100:103], v58 offset:16128
    ds_read2_b32 v[104:105], v57 offset0:240 offset1:241
    ds_read2_b32 v[106:107], v57 offset0:242 offset1:243
    ds_read_b128 v[108:111], v58 offset:14080
    ds_read2_b32 v[112:113], v63 offset0:112 offset1:113
    ds_read2_b32 v[114:115], v63 offset0:114 offset1:115
    ds_read_b128 v[116:119], v58 offset:12032
    s_waitcnt lgkmcnt(1)
    v_mfma_f32_16x16x32_bf16 v[46:49], v[96:99], v[100:103], 0
    s_lshl_b32 s4, s45, 4
    s_add_u32 s4, s4, s46
    v_mfma_f32_16x16x32_bf16 v[66:69], v[104:107], v[100:103], 0
    ds_read2_b32 v[120:121], v63 offset0:240 offset1:241
    ds_read2_b32 v[122:123], v63 offset0:242 offset1:243
    v_mfma_f32_16x16x32_bf16 v[66:69], v[96:99], v[108:111], v[66:69]
    ds_read_b128 v[124:127], v58 offset:9984
    s_bfe_u32 s7, s14, 0x40008
    v_mfma_f32_16x16x32_bf16 v[70:73], v[104:107], v[108:111], 0
    s_lshl_b32 s7, s7, 12
    s_add_u32 s12, s6, s7
    v_mfma_f32_16x16x32_bf16 v[70:73], v[112:115], v[100:103], v[70:73]
    buffer_load_dwordx4 a[48:51], v17, s[8:11], s12 offen offset:0 sc0 sc1
    s_waitcnt lgkmcnt(3)
    v_mfma_f32_16x16x32_bf16 v[70:73], v[96:99], v[116:119], v[70:73]
    s_lshl_b32 s4, s4, 2
    s_add_u32 s4, s4, s44
    v_mfma_f32_16x16x32_bf16 v[74:77], v[112:115], v[108:111], 0
    s_lshl_b32 s4, s4, 3
    s_add_u32 s4, s4, 21512192
    v_mfma_f32_16x16x32_bf16 v[74:77], v[104:107], v[116:119], v[74:77]
    buffer_load_dwordx4 a[52:55], v17, s[8:11], s12 offen offset:1024 sc0 sc1
    v_mfma_f32_16x16x32_bf16 v[78:81], v[112:115], v[116:119], 0
    ds_read2_b32 v[128:129], v64 offset0:112 offset1:113
    s_waitcnt lgkmcnt(1)
    v_mfma_f32_16x16x32_bf16 v[74:77], v[120:123], v[100:103], v[74:77]
    ds_read2_b32 v[130:131], v64 offset0:114 offset1:115
    ds_read_b128 v[132:135], v58 offset:7936
    v_mfma_f32_16x16x32_bf16 v[74:77], v[96:99], v[124:127], v[74:77]
    s_lshl_b32 s3, s45, 9
    s_add_u32 s3, s3, 21512192
    v_mfma_f32_16x16x32_bf16 v[78:81], v[120:123], v[108:111], v[78:81]
    v_lshrrev_b32 v182, 1, v17
    v_add_u32 v182, s3, v182
    v_mfma_f32_16x16x32_bf16 v[78:81], v[104:107], v[124:127], v[78:81]
    buffer_load_dwordx4 a[56:59], v17, s[8:11], s12 offen offset:2048 sc0 sc1
    v_mfma_f32_16x16x32_bf16 v[84:87], v[120:123], v[116:119], 0
    v_lshrrev_b32 v1, 4, v2
    v_and_b32 v3, 15, v2
    v_mfma_f32_16x16x32_bf16 v[84:87], v[112:115], v[124:127], v[84:87]
    v_xor_b32 v3, v3, v1
    v_lshlrev_b32 v3, 4, v3
    v_mfma_f32_16x16x32_bf16 v[88:91], v[120:123], v[124:127], 0
    v_lshl_add_u32 v7, v1, 12, v3
    s_waitcnt lgkmcnt(0)
    v_mfma_f32_16x16x32_bf16 v[78:81], v[128:131], v[100:103], v[78:81]
    ds_read2_b32 v[136:137], v64 offset0:240 offset1:241
    ds_read2_b32 v[138:139], v64 offset0:242 offset1:243
    v_mfma_f32_16x16x32_bf16 v[78:81], v[96:99], v[132:135], v[78:81]
    ds_read_b128 v[140:143], v58 offset:5888
    buffer_load_dwordx4 a[60:63], v17, s[8:11], s12 offen offset:3072 sc0 sc1
    v_mfma_f32_16x16x32_bf16 v[84:87], v[128:131], v[108:111], v[84:87]
    v_xor_b32 v1, 64, v7
    v_add_u32 v8, 16384, v1
    v_mfma_f32_16x16x32_bf16 v[84:87], v[104:107], v[132:135], v[84:87]
    v_xor_b32 v1, 128, v7
    v_add_u32 v9, 32768, v1
    v_mfma_f32_16x16x32_bf16 v[88:91], v[128:131], v[116:119], v[88:91]
    v_xor_b32 v1, 192, v7
    v_add_u32 v10, 49152, v1
    v_mfma_f32_16x16x32_bf16 v[88:91], v[112:115], v[132:135], v[88:91]
    s_lshl_b32 s16, s45, 19
    s_lshl_b32 s3, s44, 17
    v_mfma_f32_16x16x32_bf16 v[92:95], v[128:131], v[124:127], 0
    ds_read2_b32 v[144:145], v65 offset0:112 offset1:113
    ds_read2_b32 v[146:147], v65 offset0:114 offset1:115
    v_mfma_f32_16x16x32_bf16 v[92:95], v[120:123], v[132:135], v[92:95]
    ds_read_b128 v[148:151], v58 offset:3840
    s_waitcnt lgkmcnt(3)
    v_mfma_f32_16x16x32_bf16 v[84:87], v[136:139], v[100:103], v[84:87]
    s_bfe_u32 s7, s14, 0x4000c
    s_lshl_b32 s7, s7, 12
    v_mfma_f32_16x16x32_bf16 v[84:87], v[96:99], v[140:143], v[84:87]
    s_add_u32 s12, s6, s7
    buffer_load_dwordx4 a[64:67], v17, s[8:11], s12 offen offset:0 sc0 sc1
    v_mfma_f32_16x16x32_bf16 v[88:91], v[136:139], v[108:111], v[88:91]
    ds_read2_b32 v[128:129], v65 offset0:240 offset1:241
    ds_read2_b32 v[130:131], v65 offset0:242 offset1:243
    v_mfma_f32_16x16x32_bf16 v[88:91], v[104:107], v[140:143], v[88:91]
    ds_read_b128 v[124:127], v58 offset:1792
    s_add_u32 s16, s16, s3
    v_mfma_f32_16x16x32_bf16 v[92:95], v[136:139], v[116:119], v[92:95]
    ds_read2_b32 v[120:121], v57 offset0:96 offset1:97
    ds_read2_b32 v[122:123], v57 offset0:98 offset1:99
    v_mfma_f32_16x16x32_bf16 v[92:95], v[112:115], v[140:143], v[92:95]
    ds_read_b128 v[132:135], v59 offset:15872
    s_waitcnt lgkmcnt(6)
    v_mfma_f32_16x16x32_bf16 v[88:91], v[144:147], v[100:103], v[88:91]
    ds_read2_b32 v[136:137], v57 offset0:224 offset1:225
    ds_read2_b32 v[138:139], v57 offset0:226 offset1:227
    v_mfma_f32_16x16x32_bf16 v[88:91], v[96:99], v[148:151], v[88:91]
    ds_read_b128 v[116:119], v59 offset:13824
    buffer_load_dwordx4 a[68:71], v17, s[8:11], s12 offen offset:1024 sc0 sc1
    v_mfma_f32_16x16x32_bf16 v[92:95], v[144:147], v[108:111], v[92:95]
    ds_read2_b32 v[112:113], v63 offset0:96 offset1:97
    ds_read2_b32 v[114:115], v63 offset0:98 offset1:99
    v_mfma_f32_16x16x32_bf16 v[92:95], v[104:107], v[148:151], v[92:95]
    ds_read_b128 v[140:143], v59 offset:11776
    s_waitcnt lgkmcnt(6)
    v_mfma_f32_16x16x32_bf16 v[92:95], v[128:131], v[100:103], v[92:95]
    buffer_load_dwordx4 a[72:75], v17, s[8:11], s12 offen offset:2048 sc0 sc1
    v_mfma_f32_16x16x32_bf16 v[92:95], v[96:99], v[124:127], v[92:95]
    s_lshl_b32 s17, s46, 8
    s_lshl_b32 s18, s44, 13
    v_mfma_f32_16x16x32_bf16 v[46:49], v[120:123], v[132:135], v[46:49]
    s_lshr_b32 s28, s44, 1
    s_waitcnt lgkmcnt(1)
    v_mfma_f32_16x16x32_bf16 v[66:69], v[136:139], v[132:135], v[66:69]
    ds_read2_b32 v[144:145], v63 offset0:224 offset1:225
    ds_read2_b32 v[146:147], v63 offset0:226 offset1:227
    v_mfma_f32_16x16x32_bf16 v[66:69], v[120:123], v[116:119], v[66:69]
    ds_read_b128 v[108:111], v59 offset:9728
    v_and_b32 v26, 31, v2
    v_mfma_f32_16x16x32_bf16 v[70:73], v[136:139], v[116:119], v[70:73]
    buffer_load_dwordx4 a[76:79], v17, s[8:11], s12 offen offset:3072 sc0 sc1
    v_mfma_f32_16x16x32_bf16 v[70:73], v[112:115], v[132:135], v[70:73]
    v_lshrrev_b32 v27, 5, v2
    s_waitcnt lgkmcnt(3)
    v_mfma_f32_16x16x32_bf16 v[70:73], v[120:123], v[140:143], v[70:73]
    v_lshlrev_b32 v27, 2, v27
    s_lshl_b32 s3, s28, 3
    v_mfma_f32_16x16x32_bf16 v[74:77], v[112:115], v[116:119], v[74:77]
    v_add_u32 v27, s3, v27
    v_and_b32 v28, 15, v26
    v_mfma_f32_16x16x32_bf16 v[74:77], v[136:139], v[140:143], v[74:77]
    v_xor_b32 v27, v27, v28
    v_lshlrev_b32 v27, 4, v27
    v_mfma_f32_16x16x32_bf16 v[78:81], v[112:115], v[140:143], v[78:81]
    ds_read2_b32 v[104:105], v64 offset0:96 offset1:97
    s_waitcnt lgkmcnt(1)
    v_mfma_f32_16x16x32_bf16 v[74:77], v[144:147], v[132:135], v[74:77]
    ds_read2_b32 v[106:107], v64 offset0:98 offset1:99
    ds_read_b128 v[148:151], v59 offset:7680
    v_mfma_f32_16x16x32_bf16 v[74:77], v[120:123], v[108:111], v[74:77]
    s_bfe_u32 s7, s14, 0x40010
    s_lshl_b32 s7, s7, 12
    v_mfma_f32_16x16x32_bf16 v[78:81], v[144:147], v[116:119], v[78:81]
    s_add_u32 s12, s6, s7
    buffer_load_dwordx4 a[80:83], v17, s[8:11], s12 offen offset:0 sc0 sc1
    v_mfma_f32_16x16x32_bf16 v[78:81], v[136:139], v[108:111], v[78:81]
    v_lshl_add_u32 v27, v26, 8, v27
    s_lshl_b32 s3, s28, 14
    v_mfma_f32_16x16x32_bf16 v[84:87], v[144:147], v[140:143], v[84:87]
    buffer_load_dwordx4 a[84:87], v17, s[8:11], s12 offen offset:1024 sc0 sc1
    v_mfma_f32_16x16x32_bf16 v[84:87], v[112:115], v[108:111], v[84:87]
    v_add_u32 v27, s3, v27
    v_xor_b32 v4, 0, v27
    v_mfma_f32_16x16x32_bf16 v[88:91], v[144:147], v[108:111], v[88:91]
    v_xor_b32 v18, 0x4000, v4
    s_waitcnt lgkmcnt(0)
    v_mfma_f32_16x16x32_bf16 v[78:81], v[104:107], v[132:135], v[78:81]
    ds_read2_b32 v[128:129], v64 offset0:224 offset1:225
    ds_read2_b32 v[130:131], v64 offset0:226 offset1:227
    v_mfma_f32_16x16x32_bf16 v[78:81], v[120:123], v[148:151], v[78:81]
    ds_read_b128 v[100:103], v59 offset:5632
    v_add_u32 v13, 65536, v4
    v_mfma_f32_16x16x32_bf16 v[84:87], v[104:107], v[116:119], v[84:87]
    v_add_u32 v22, 65536, v18
    v_xor_b32 v5, 16, v27
    v_mfma_f32_16x16x32_bf16 v[84:87], v[136:139], v[148:151], v[84:87]
    buffer_load_dwordx4 a[88:91], v17, s[8:11], s12 offen offset:2048 sc0 sc1
    v_mfma_f32_16x16x32_bf16 v[88:91], v[104:107], v[140:143], v[88:91]
    v_xor_b32 v19, 0x4000, v5
    v_add_u32 v14, 65536, v5
    v_mfma_f32_16x16x32_bf16 v[88:91], v[112:115], v[148:151], v[88:91]
    v_add_u32 v23, 65536, v19
    v_xor_b32 v11, 32, v27
    v_mfma_f32_16x16x32_bf16 v[92:95], v[104:107], v[108:111], v[92:95]
    ds_read2_b32 v[96:97], v65 offset0:96 offset1:97
    ds_read2_b32 v[98:99], v65 offset0:98 offset1:99
    v_mfma_f32_16x16x32_bf16 v[92:95], v[144:147], v[148:151], v[92:95]
    ds_read_b128 v[124:127], v59 offset:3584
    s_waitcnt lgkmcnt(3)
    v_mfma_f32_16x16x32_bf16 v[84:87], v[128:131], v[132:135], v[84:87]
    buffer_load_dwordx4 a[92:95], v17, s[8:11], s12 offen offset:3072 sc0 sc1
    v_mfma_f32_16x16x32_bf16 v[84:87], v[120:123], v[100:103], v[84:87]
    s_waitcnt vmcnt(12)
    v_mov_b32 v82, s42
    v_mov_b32 v83, s43
    s_mov_b64 s[48:49], exec
    s_mov_b64 exec, 1
    buffer_store_dwordx2 v[82:83], v6, s[8:11], s4 offen sc0 sc1
    s_mov_b64 exec, s[48:49]
    v_mfma_f32_16x16x32_bf16 v[88:91], v[128:131], v[116:119], v[88:91]
    ds_read2_b32 v[104:105], v65 offset0:224 offset1:225
    ds_read2_b32 v[106:107], v65 offset0:226 offset1:227
    v_mfma_f32_16x16x32_bf16 v[88:91], v[136:139], v[100:103], v[88:91]
    ds_read_b128 v[108:111], v59 offset:1536
    v_xor_b32 v20, 0x4000, v11
    v_mfma_f32_16x16x32_bf16 v[92:95], v[128:131], v[140:143], v[92:95]
    ds_read2_b32 v[144:145], v57 offset0:80 offset1:81
    ds_read2_b32 v[146:147], v57 offset0:82 offset1:83
    v_mfma_f32_16x16x32_bf16 v[92:95], v[112:115], v[100:103], v[92:95]
    ds_read_b128 v[148:151], v60 offset:15616
    s_waitcnt lgkmcnt(6)
    v_mfma_f32_16x16x32_bf16 v[88:91], v[96:99], v[132:135], v[88:91]
    ds_read2_b32 v[128:129], v57 offset0:208 offset1:209
    ds_read2_b32 v[130:131], v57 offset0:210 offset1:211
    v_mfma_f32_16x16x32_bf16 v[88:91], v[120:123], v[124:127], v[88:91]
    ds_read_b128 v[140:143], v60 offset:13568
    s_bfe_u32 s7, s14, 0x40014
    v_mfma_f32_16x16x32_bf16 v[92:95], v[96:99], v[116:119], v[92:95]
    ds_read2_b32 v[112:113], v63 offset0:80 offset1:81
    ds_read2_b32 v[114:115], v63 offset0:82 offset1:83
    v_mfma_f32_16x16x32_bf16 v[92:95], v[136:139], v[124:127], v[92:95]
    ds_read_b128 v[100:103], v60 offset:11520
    s_waitcnt lgkmcnt(6)
    v_mfma_f32_16x16x32_bf16 v[92:95], v[104:107], v[132:135], v[92:95]
    s_lshl_b32 s7, s7, 12
    s_add_u32 s12, s6, s7
    v_mfma_f32_16x16x32_bf16 v[92:95], v[120:123], v[108:111], v[92:95]
    buffer_load_dwordx4 a[96:99], v17, s[8:11], s12 offen offset:0 sc0 sc1
    v_mfma_f32_16x16x32_bf16 v[46:49], v[144:147], v[148:151], v[46:49]
    buffer_load_dwordx4 a[100:103], v17, s[8:11], s12 offen offset:1024 sc0 sc1
    s_waitcnt lgkmcnt(1)
    v_mfma_f32_16x16x32_bf16 v[66:69], v[128:131], v[148:151], v[66:69]
    ds_read2_b32 v[96:97], v63 offset0:208 offset1:209
    ds_read2_b32 v[98:99], v63 offset0:210 offset1:211
    v_mfma_f32_16x16x32_bf16 v[66:69], v[144:147], v[140:143], v[66:69]
    ds_read_b128 v[116:119], v60 offset:9472
    v_add_u32 v15, 65536, v11
    v_mfma_f32_16x16x32_bf16 v[70:73], v[128:131], v[140:143], v[70:73]
    v_add_u32 v24, 65536, v20
    v_xor_b32 v12, 48, v27
    v_mfma_f32_16x16x32_bf16 v[70:73], v[112:115], v[148:151], v[70:73]
    buffer_load_dwordx4 a[104:107], v17, s[8:11], s12 offen offset:2048 sc0 sc1
    s_waitcnt lgkmcnt(3)
    v_mfma_f32_16x16x32_bf16 v[70:73], v[144:147], v[100:103], v[70:73]
    v_xor_b32 v21, 0x4000, v12
    v_add_u32 v16, 65536, v12
    v_mfma_f32_16x16x32_bf16 v[74:77], v[112:115], v[140:143], v[74:77]
    v_add_u32 v25, 65536, v21
    s_lshl_b32 s13, s46, 4
    v_mfma_f32_16x16x32_bf16 v[74:77], v[128:131], v[100:103], v[74:77]
    s_add_u32 s13, s13, s45
    s_lshl_b32 s13, s13, 2
    v_mfma_f32_16x16x32_bf16 v[78:81], v[112:115], v[100:103], v[78:81]
    ds_read2_b32 v[136:137], v64 offset0:80 offset1:81
    s_waitcnt lgkmcnt(1)
    v_mfma_f32_16x16x32_bf16 v[74:77], v[96:99], v[148:151], v[74:77]
    ds_read2_b32 v[138:139], v64 offset0:82 offset1:83
    ds_read_b128 v[124:127], v60 offset:7424
    v_mfma_f32_16x16x32_bf16 v[74:77], v[144:147], v[116:119], v[74:77]
    buffer_load_dwordx4 a[108:111], v17, s[8:11], s12 offen offset:3072 sc0 sc1
    v_mfma_f32_16x16x32_bf16 v[78:81], v[96:99], v[140:143], v[78:81]
    s_add_u32 s13, s13, s44
    s_lshl_b32 s13, s13, 3
    v_mfma_f32_16x16x32_bf16 v[78:81], v[128:131], v[116:119], v[78:81]
    s_add_u32 s13, s13, 21520384
    s_mov_b32 s32, s36
    v_mfma_f32_16x16x32_bf16 v[84:87], v[96:99], v[100:103], v[84:87]
    s_mov_b32 s33, s37
    s_mov_b32 s34, 8388608
    v_mfma_f32_16x16x32_bf16 v[84:87], v[112:115], v[116:119], v[84:87]
    s_bfe_u32 s7, s14, 0x40018
    s_lshl_b32 s7, s7, 12
    v_mfma_f32_16x16x32_bf16 v[88:91], v[96:99], v[116:119], v[88:91]
    s_add_u32 s12, s6, s7
    s_waitcnt lgkmcnt(0)
    v_mfma_f32_16x16x32_bf16 v[78:81], v[136:139], v[148:151], v[78:81]
    ds_read2_b32 v[104:105], v64 offset0:208 offset1:209
    ds_read2_b32 v[106:107], v64 offset0:210 offset1:211
    v_mfma_f32_16x16x32_bf16 v[78:81], v[144:147], v[124:127], v[78:81]
    ds_read_b128 v[132:135], v60 offset:5376
    buffer_load_dwordx4 a[112:115], v17, s[8:11], s12 offen offset:0 sc0 sc1
    v_mfma_f32_16x16x32_bf16 v[84:87], v[136:139], v[140:143], v[84:87]
    s_mov_b32 s35, 131072
    s_lshr_b32 s29, s44, 1
    v_mfma_f32_16x16x32_bf16 v[84:87], v[128:131], v[124:127], v[84:87]
    s_and_b32 s30, s44, 1
    v_bfe_u32 v32, v2, 4, 1
    v_mfma_f32_16x16x32_bf16 v[88:91], v[136:139], v[100:103], v[88:91]
    buffer_load_dwordx4 a[116:119], v17, s[8:11], s12 offen offset:1024 sc0 sc1
    v_mfma_f32_16x16x32_bf16 v[88:91], v[112:115], v[124:127], v[88:91]
    v_lshlrev_b32 v32, 2, v32
    v_and_b32 v33, 7, v2
    v_mfma_f32_16x16x32_bf16 v[92:95], v[136:139], v[116:119], v[92:95]
    ds_read2_b32 v[120:121], v65 offset0:80 offset1:81
    ds_read2_b32 v[122:123], v65 offset0:82 offset1:83
    v_mfma_f32_16x16x32_bf16 v[92:95], v[96:99], v[124:127], v[92:95]
    ds_read_b128 v[108:111], v60 offset:3328
    s_waitcnt lgkmcnt(3)
    v_mfma_f32_16x16x32_bf16 v[84:87], v[104:107], v[148:151], v[84:87]
    v_xor_b32 v33, v33, v32
    v_lshlrev_b32 v33, 4, v33
    v_mfma_f32_16x16x32_bf16 v[84:87], v[144:147], v[132:135], v[84:87]
    buffer_load_dwordx4 a[120:123], v17, s[8:11], s12 offen offset:2048 sc0 sc1
    v_mfma_f32_16x16x32_bf16 v[88:91], v[104:107], v[140:143], v[88:91]
    ds_read2_b32 v[136:137], v65 offset0:208 offset1:209
    ds_read2_b32 v[138:139], v65 offset0:210 offset1:211
    v_mfma_f32_16x16x32_bf16 v[88:91], v[128:131], v[132:135], v[88:91]
    ds_read_b128 v[116:119], v60 offset:1280
    v_lshrrev_b32 v32, 3, v2
    v_mfma_f32_16x16x32_bf16 v[92:95], v[104:107], v[100:103], v[92:95]
    ds_read2_b32 v[96:97], v57 offset0:64 offset1:65
    ds_read2_b32 v[98:99], v57 offset0:66 offset1:67
    v_mfma_f32_16x16x32_bf16 v[92:95], v[112:115], v[132:135], v[92:95]
    ds_read_b128 v[124:127], v61 offset:15360
    s_waitcnt lgkmcnt(6)
    v_mfma_f32_16x16x32_bf16 v[88:91], v[120:123], v[148:151], v[88:91]
    ds_read2_b32 v[104:105], v57 offset0:192 offset1:193
    ds_read2_b32 v[106:107], v57 offset0:194 offset1:195
    v_mfma_f32_16x16x32_bf16 v[88:91], v[144:147], v[108:111], v[88:91]
    ds_read_b128 v[100:103], v61 offset:13312
    buffer_load_dwordx4 a[124:127], v17, s[8:11], s12 offen offset:3072 sc0 sc1
    v_mfma_f32_16x16x32_bf16 v[92:95], v[120:123], v[140:143], v[92:95]
    ds_read2_b32 v[112:113], v63 offset0:64 offset1:65
    ds_read2_b32 v[114:115], v63 offset0:66 offset1:67
    v_mfma_f32_16x16x32_bf16 v[92:95], v[128:131], v[108:111], v[92:95]
    ds_read_b128 v[132:135], v61 offset:11264
    s_waitcnt lgkmcnt(6)
    v_mfma_f32_16x16x32_bf16 v[92:95], v[136:139], v[148:151], v[92:95]
    v_lshl_add_u32 v35, v32, 11, v33
    s_lshl_b32 s31, s45, 18
    v_mfma_f32_16x16x32_bf16 v[92:95], v[144:147], v[116:119], v[92:95]
    s_lshl_b32 s3, s44, 16
    s_add_u32 s31, s31, s3
    v_mfma_f32_16x16x32_bf16 v[46:49], v[96:99], v[124:127], v[46:49]
    s_bfe_u32 s7, s14, 0x4001c
    s_waitcnt lgkmcnt(1)
    v_mfma_f32_16x16x32_bf16 v[66:69], v[104:107], v[124:127], v[66:69]
    ds_read2_b32 v[120:121], v63 offset0:192 offset1:193
    ds_read2_b32 v[122:123], v63 offset0:194 offset1:195
    v_mfma_f32_16x16x32_bf16 v[66:69], v[96:99], v[100:103], v[66:69]
    ds_read_b128 v[140:143], v61 offset:9216
    s_lshl_b32 s7, s7, 12
    v_mfma_f32_16x16x32_bf16 v[70:73], v[104:107], v[100:103], v[70:73]
    s_add_u32 s12, s6, s7
    buffer_load_dwordx4 a[128:131], v17, s[8:11], s12 offen offset:0 sc0 sc1
    v_mfma_f32_16x16x32_bf16 v[70:73], v[112:115], v[124:127], v[70:73]
    s_lshl_b32 s3, s46, 7
    s_waitcnt lgkmcnt(3)
    v_mfma_f32_16x16x32_bf16 v[70:73], v[96:99], v[132:135], v[70:73]
    buffer_load_dwordx4 a[132:135], v17, s[8:11], s12 offen offset:1024 sc0 sc1
    v_mfma_f32_16x16x32_bf16 v[74:77], v[112:115], v[100:103], v[74:77]
    s_add_u32 s31, s31, s3
    s_lshl_b32 s38, s46, 18
    v_mfma_f32_16x16x32_bf16 v[74:77], v[104:107], v[132:135], v[74:77]
    s_lshl_b32 s3, s44, 16
    s_add_u32 s38, s38, s3
    v_mfma_f32_16x16x32_bf16 v[78:81], v[112:115], v[132:135], v[78:81]
    ds_read2_b32 v[128:129], v64 offset0:64 offset1:65
    s_waitcnt lgkmcnt(1)
    v_mfma_f32_16x16x32_bf16 v[74:77], v[120:123], v[124:127], v[74:77]
    ds_read2_b32 v[130:131], v64 offset0:66 offset1:67
    ds_read_b128 v[108:111], v61 offset:7168
    v_mfma_f32_16x16x32_bf16 v[74:77], v[96:99], v[140:143], v[74:77]
    buffer_load_dwordx4 a[136:139], v17, s[8:11], s12 offen offset:2048 sc0 sc1
    v_mfma_f32_16x16x32_bf16 v[78:81], v[120:123], v[100:103], v[78:81]
    s_lshl_b32 s3, s45, 8
    s_add_u32 s38, s38, s3
    v_mfma_f32_16x16x32_bf16 v[78:81], v[104:107], v[140:143], v[78:81]
    s_add_u32 s38, s38, 12582912
    v_bfe_u32 v34, v2, 2, 2
    v_mfma_f32_16x16x32_bf16 v[84:87], v[120:123], v[132:135], v[84:87]
    v_bfe_u32 v32, v2, 4, 1
    v_lshlrev_b32 v32, 1, v32
    v_mfma_f32_16x16x32_bf16 v[84:87], v[112:115], v[140:143], v[84:87]
    v_bfe_u32 v33, v2, 1, 1
    v_add_u32 v32, v32, v33
    v_mfma_f32_16x16x32_bf16 v[88:91], v[120:123], v[140:143], v[88:91]
    buffer_load_dwordx4 a[140:143], v17, s[8:11], s12 offen offset:3072 sc0 sc1
    s_waitcnt lgkmcnt(0)
    v_mfma_f32_16x16x32_bf16 v[78:81], v[128:131], v[124:127], v[78:81]
    ds_read2_b32 v[136:137], v64 offset0:192 offset1:193
    ds_read2_b32 v[138:139], v64 offset0:194 offset1:195
    v_mfma_f32_16x16x32_bf16 v[78:81], v[96:99], v[108:111], v[78:81]
    ds_read_b128 v[148:151], v61 offset:5120
    s_lshl_b32 s3, s30, 2
    v_mfma_f32_16x16x32_bf16 v[84:87], v[128:131], v[100:103], v[84:87]
    v_add_u32 v32, s3, v32
    v_bfe_u32 v33, v2, 3, 1
    v_mfma_f32_16x16x32_bf16 v[84:87], v[104:107], v[108:111], v[84:87]
    v_lshlrev_b32 v33, 2, v33
    v_xor_b32 v32, v32, v33
    v_mfma_f32_16x16x32_bf16 v[88:91], v[128:131], v[132:135], v[88:91]
    v_lshlrev_b32 v32, 4, v32
    v_and_b32 v33, 1, v2
    v_mfma_f32_16x16x32_bf16 v[88:91], v[112:115], v[108:111], v[88:91]
    s_bfe_u32 s7, s15, 0x40000
    s_lshl_b32 s7, s7, 12
    v_mfma_f32_16x16x32_bf16 v[92:95], v[128:131], v[140:143], v[92:95]
    ds_read2_b32 v[144:145], v65 offset0:64 offset1:65
    ds_read2_b32 v[146:147], v65 offset0:66 offset1:67
    v_mfma_f32_16x16x32_bf16 v[92:95], v[120:123], v[108:111], v[92:95]
    ds_read_b128 v[116:119], v61 offset:3072
    s_waitcnt lgkmcnt(3)
    v_mfma_f32_16x16x32_bf16 v[84:87], v[136:139], v[124:127], v[84:87]
    s_add_u32 s12, s6, s7
    buffer_load_dwordx4 a[144:147], v17, s[8:11], s12 offen offset:0 sc0 sc1
    v_mfma_f32_16x16x32_bf16 v[84:87], v[96:99], v[148:151], v[84:87]
    v_lshl_add_u32 v32, v33, 3, v32
    v_lshrrev_b32 v33, 5, v2
    v_mfma_f32_16x16x32_bf16 v[88:91], v[136:139], v[100:103], v[88:91]
    ds_read2_b32 v[128:129], v65 offset0:192 offset1:193
    ds_read2_b32 v[130:131], v65 offset0:194 offset1:195
    v_mfma_f32_16x16x32_bf16 v[88:91], v[104:107], v[148:151], v[88:91]
    ds_read_b128 v[140:143], v61 offset:1024
    buffer_load_dwordx4 a[148:151], v17, s[8:11], s12 offen offset:1024 sc0 sc1
    v_mfma_f32_16x16x32_bf16 v[92:95], v[136:139], v[132:135], v[92:95]
    ds_read2_b32 v[120:121], v57 offset0:48 offset1:49
    ds_read2_b32 v[122:123], v57 offset0:50 offset1:51
    v_mfma_f32_16x16x32_bf16 v[92:95], v[112:115], v[148:151], v[92:95]
    ds_read_b128 v[108:111], v58 offset:15104
    s_waitcnt lgkmcnt(6)
    v_mfma_f32_16x16x32_bf16 v[88:91], v[144:147], v[124:127], v[88:91]
    ds_read2_b32 v[136:137], v57 offset0:176 offset1:177
    ds_read2_b32 v[138:139], v57 offset0:178 offset1:179
    v_mfma_f32_16x16x32_bf16 v[88:91], v[96:99], v[116:119], v[88:91]
    ds_read_b128 v[132:135], v58 offset:13056
    buffer_load_dwordx4 a[152:155], v17, s[8:11], s12 offen offset:2048 sc0 sc1
    v_mfma_f32_16x16x32_bf16 v[92:95], v[144:147], v[100:103], v[92:95]
    ds_read2_b32 v[112:113], v63 offset0:48 offset1:49
    ds_read2_b32 v[114:115], v63 offset0:50 offset1:51
    v_mfma_f32_16x16x32_bf16 v[92:95], v[104:107], v[116:119], v[92:95]
    ds_read_b128 v[148:151], v58 offset:11008
    s_waitcnt lgkmcnt(6)
    v_mfma_f32_16x16x32_bf16 v[92:95], v[128:131], v[124:127], v[92:95]
    v_lshl_add_u32 v34, v33, 2, v34
    v_lshl_add_u32 v32, v34, 7, v32
    v_mfma_f32_16x16x32_bf16 v[92:95], v[96:99], v[140:143], v[92:95]
    s_lshl_b32 s3, s29, 13
    s_add_u32 s3, s3, 131072
    v_mfma_f32_16x16x32_bf16 v[46:49], v[120:123], v[108:111], v[46:49]
    v_add_u32 v36, s3, v32
    s_waitcnt lgkmcnt(1)
    v_mfma_f32_16x16x32_bf16 v[66:69], v[136:139], v[108:111], v[66:69]
    ds_read2_b32 v[144:145], v63 offset0:176 offset1:177
    ds_read2_b32 v[146:147], v63 offset0:178 offset1:179
    v_mfma_f32_16x16x32_bf16 v[66:69], v[120:123], v[132:135], v[66:69]
    ds_read_b128 v[100:103], v58 offset:8960
    buffer_load_dwordx4 a[156:159], v17, s[8:11], s12 offen offset:3072 sc0 sc1
    v_mfma_f32_16x16x32_bf16 v[70:73], v[136:139], v[132:135], v[70:73]
    v_and_b32 v32, 15, v2
    s_lshl_b32 s3, s29, 3
    v_mfma_f32_16x16x32_bf16 v[70:73], v[112:115], v[108:111], v[70:73]
    v_xor_b32 v32, s3, v32
    s_waitcnt lgkmcnt(3)
    v_mfma_f32_16x16x32_bf16 v[70:73], v[120:123], v[148:151], v[70:73]
    v_lshlrev_b32 v32, 4, v32
    v_and_b32 v34, 31, v2
    v_mfma_f32_16x16x32_bf16 v[74:77], v[112:115], v[132:135], v[74:77]
    s_bfe_u32 s7, s15, 0x40004
    s_lshl_b32 s7, s7, 12
    v_mfma_f32_16x16x32_bf16 v[74:77], v[136:139], v[148:151], v[74:77]
    s_add_u32 s12, s6, s7
    buffer_load_dwordx4 a[160:163], v17, s[8:11], s12 offen offset:0 sc0 sc1
    v_mfma_f32_16x16x32_bf16 v[78:81], v[112:115], v[148:151], v[78:81]
    ds_read2_b32 v[104:105], v64 offset0:48 offset1:49
    s_waitcnt lgkmcnt(1)
    v_mfma_f32_16x16x32_bf16 v[74:77], v[144:147], v[108:111], v[74:77]
    ds_read2_b32 v[106:107], v64 offset0:50 offset1:51
    ds_read_b128 v[116:119], v58 offset:6912
    v_mfma_f32_16x16x32_bf16 v[74:77], v[120:123], v[100:103], v[74:77]
    v_lshl_add_u32 v32, v34, 8, v32
    v_lshl_add_u32 v32, v33, 3, v32
    v_mfma_f32_16x16x32_bf16 v[78:81], v[144:147], v[132:135], v[78:81]
    buffer_load_dwordx4 a[164:167], v17, s[8:11], s12 offen offset:1024 sc0 sc1
    v_mfma_f32_16x16x32_bf16 v[78:81], v[136:139], v[100:103], v[78:81]
    s_lshl_b32 s3, s30, 13
    s_add_u32 s3, s3, 147456
    v_mfma_f32_16x16x32_bf16 v[84:87], v[144:147], v[148:151], v[84:87]
    v_add_u32 v37, s3, v32
    v_and_b32 v32, 15, v2
    v_mfma_f32_16x16x32_bf16 v[84:87], v[112:115], v[100:103], v[84:87]
    v_lshlrev_b32 v32, 4, v32
    v_and_b32 v34, 16, v2
    v_mfma_f32_16x16x32_bf16 v[88:91], v[144:147], v[100:103], v[88:91]
    v_lshl_add_u32 v32, v34, 9, v32
    s_waitcnt lgkmcnt(0)
    v_mfma_f32_16x16x32_bf16 v[78:81], v[104:107], v[108:111], v[78:81]
    ds_read2_b32 v[128:129], v64 offset0:176 offset1:177
    ds_read2_b32 v[130:131], v64 offset0:178 offset1:179
    v_mfma_f32_16x16x32_bf16 v[78:81], v[120:123], v[116:119], v[78:81]
    ds_read_b128 v[124:127], v58 offset:4864
    buffer_load_dwordx4 a[168:171], v17, s[8:11], s12 offen offset:2048 sc0 sc1
    v_mfma_f32_16x16x32_bf16 v[84:87], v[104:107], v[132:135], v[84:87]
    s_lshl_b32 s3, s45, 9
    s_add_u32 s3, s3, 20971520
    v_mfma_f32_16x16x32_bf16 v[84:87], v[136:139], v[116:119], v[84:87]
    v_add_u32 v32, s3, v32
    s_lshl_b32 s3, s29, 8
    v_mfma_f32_16x16x32_bf16 v[88:91], v[104:107], v[148:151], v[88:91]
    v_add_u32 v38, s3, v32
    s_lshl_b32 s3, s44, 10
    v_mfma_f32_16x16x32_bf16 v[88:91], v[112:115], v[116:119], v[88:91]
    s_add_u32 s3, s3, 147456
    v_lshl_add_u32 v39, v33, 4, s3
    v_mfma_f32_16x16x32_bf16 v[92:95], v[104:107], v[100:103], v[92:95]
    ds_read2_b32 v[96:97], v65 offset0:48 offset1:49
    ds_read2_b32 v[98:99], v65 offset0:50 offset1:51
    v_mfma_f32_16x16x32_bf16 v[92:95], v[144:147], v[116:119], v[92:95]
    ds_read_b128 v[140:143], v58 offset:2816
    s_waitcnt lgkmcnt(3)
    v_mfma_f32_16x16x32_bf16 v[84:87], v[128:131], v[108:111], v[84:87]
    buffer_load_dwordx4 a[172:175], v17, s[8:11], s12 offen offset:3072 sc0 sc1
    v_mfma_f32_16x16x32_bf16 v[84:87], v[120:123], v[124:127], v[84:87]
    v_and_b32 v32, 31, v2
    s_lshl_b32 s3, s30, 5
    v_mfma_f32_16x16x32_bf16 v[88:91], v[128:131], v[132:135], v[88:91]
    ds_read2_b32 v[104:105], v65 offset0:176 offset1:177
    ds_read2_b32 v[106:107], v65 offset0:178 offset1:179
    v_mfma_f32_16x16x32_bf16 v[88:91], v[136:139], v[124:127], v[88:91]
    ds_read_b128 v[100:103], v58 offset:768
    s_bfe_u32 s7, s15, 0x40008
    v_mfma_f32_16x16x32_bf16 v[92:95], v[128:131], v[148:151], v[92:95]
    ds_read2_b32 v[144:145], v57 offset0:32 offset1:33
    ds_read2_b32 v[146:147], v57 offset0:34 offset1:35
    v_mfma_f32_16x16x32_bf16 v[92:95], v[112:115], v[124:127], v[92:95]
    ds_read_b128 v[116:119], v59 offset:14848
    s_waitcnt lgkmcnt(6)
    v_mfma_f32_16x16x32_bf16 v[88:91], v[96:99], v[108:111], v[88:91]
    ds_read2_b32 v[128:129], v57 offset0:160 offset1:161
    ds_read2_b32 v[130:131], v57 offset0:162 offset1:163
    v_mfma_f32_16x16x32_bf16 v[88:91], v[120:123], v[140:143], v[88:91]
    ds_read_b128 v[148:151], v59 offset:12800
    s_lshl_b32 s7, s7, 12
    v_mfma_f32_16x16x32_bf16 v[92:95], v[96:99], v[132:135], v[92:95]
    ds_read2_b32 v[112:113], v63 offset0:32 offset1:33
    ds_read2_b32 v[114:115], v63 offset0:34 offset1:35
    v_mfma_f32_16x16x32_bf16 v[92:95], v[136:139], v[140:143], v[92:95]
    ds_read_b128 v[124:127], v59 offset:10752
    s_waitcnt lgkmcnt(6)
    v_mfma_f32_16x16x32_bf16 v[92:95], v[104:107], v[108:111], v[92:95]
    s_add_u32 s12, s6, s7
    buffer_load_dwordx4 a[176:179], v17, s[8:11], s12 offen offset:0 sc0 sc1
    v_mfma_f32_16x16x32_bf16 v[92:95], v[120:123], v[100:103], v[92:95]
    buffer_load_dwordx4 a[180:183], v17, s[8:11], s12 offen offset:1024 sc0 sc1
    v_mfma_f32_16x16x32_bf16 v[46:49], v[144:147], v[116:119], v[46:49]
    v_add_u32 v32, s3, v32
    s_waitcnt lgkmcnt(1)
    v_mfma_f32_16x16x32_bf16 v[66:69], v[128:131], v[116:119], v[66:69]
    ds_read2_b32 v[96:97], v63 offset0:160 offset1:161
    ds_read2_b32 v[98:99], v63 offset0:162 offset1:163
    v_mfma_f32_16x16x32_bf16 v[66:69], v[144:147], v[148:151], v[66:69]
    ds_read_b128 v[132:135], v59 offset:8704
    buffer_load_dwordx4 a[184:187], v17, s[8:11], s12 offen offset:2048 sc0 sc1
    v_mfma_f32_16x16x32_bf16 v[70:73], v[128:131], v[148:151], v[70:73]
    s_lshl_b32 s3, s46, 6
    v_add_u32 v32, s3, v32
    v_mfma_f32_16x16x32_bf16 v[70:73], v[112:115], v[116:119], v[70:73]
    v_lshlrev_b32 v33, 14, v33
    s_waitcnt lgkmcnt(3)
    v_mfma_f32_16x16x32_bf16 v[70:73], v[144:147], v[124:127], v[70:73]
    v_lshl_add_u32 v40, v32, 2, v33
    v_add_u32 v41, 4096, v40
    v_mfma_f32_16x16x32_bf16 v[74:77], v[112:115], v[148:151], v[74:77]
    v_add_u32 v42, 8192, v40
    v_add_u32 v43, 12288, v40
    v_mfma_f32_16x16x32_bf16 v[74:77], v[128:131], v[124:127], v[74:77]
    buffer_load_dwordx4 a[188:191], v17, s[8:11], s12 offen offset:3072 sc0 sc1
    v_mfma_f32_16x16x32_bf16 v[78:81], v[112:115], v[124:127], v[78:81]
    ds_read2_b32 v[136:137], v64 offset0:32 offset1:33
    s_waitcnt lgkmcnt(1)
    v_mfma_f32_16x16x32_bf16 v[74:77], v[96:99], v[116:119], v[74:77]
    ds_read2_b32 v[138:139], v64 offset0:34 offset1:35
    ds_read_b128 v[140:143], v59 offset:6656
    v_mfma_f32_16x16x32_bf16 v[74:77], v[144:147], v[132:135], v[74:77]
    buffer_load_dwordx2 v[82:83], v182, s[8:11], 0 offen sc0 sc1
    v_mfma_f32_16x16x32_bf16 v[78:81], v[96:99], v[148:151], v[78:81]
    s_lshl_b32 s39, s45, 19
    s_lshl_b32 s3, s29, 18
    v_mfma_f32_16x16x32_bf16 v[78:81], v[128:131], v[132:135], v[78:81]
    s_bfe_u32 s7, s15, 0x4000c
    s_lshl_b32 s7, s7, 12
    v_mfma_f32_16x16x32_bf16 v[84:87], v[96:99], v[124:127], v[84:87]
    s_add_u32 s12, s6, s7
    buffer_load_dwordx4 a[192:195], v17, s[8:11], s12 offen offset:0 sc0 sc1
    v_mfma_f32_16x16x32_bf16 v[84:87], v[112:115], v[132:135], v[84:87]
    s_add_u32 s39, s39, s3
    s_lshl_b32 s47, s44, 12
    v_mfma_f32_16x16x32_bf16 v[88:91], v[96:99], v[132:135], v[88:91]
    s_lshl_b32 s3, s44, 13
    s_waitcnt lgkmcnt(0)
    v_mfma_f32_16x16x32_bf16 v[78:81], v[136:139], v[116:119], v[78:81]
    ds_read2_b32 v[104:105], v64 offset0:160 offset1:161
    ds_read2_b32 v[106:107], v64 offset0:162 offset1:163
    v_mfma_f32_16x16x32_bf16 v[78:81], v[144:147], v[140:143], v[78:81]
    ds_read_b128 v[108:111], v59 offset:4608
    s_add_u32 s3, s3, 0
    v_mfma_f32_16x16x32_bf16 v[84:87], v[136:139], v[148:151], v[84:87]
    buffer_load_dwordx4 a[196:199], v17, s[8:11], s12 offen offset:1024 sc0 sc1
    v_mfma_f32_16x16x32_bf16 v[84:87], v[128:131], v[140:143], v[84:87]
    v_add_u32 v44, s3, v17
    v_xor_b32 v45, 0x4000, v44
    v_mfma_f32_16x16x32_bf16 v[88:91], v[136:139], v[124:127], v[88:91]
    s_lshl_b32 s3, s46, 9
    s_add_u32 s3, s3, 21520384
    v_mfma_f32_16x16x32_bf16 v[88:91], v[112:115], v[140:143], v[88:91]
    v_lshrrev_b32 v29, 1, v17
    v_add_u32 v29, s3, v29
    v_mfma_f32_16x16x32_bf16 v[92:95], v[136:139], v[132:135], v[92:95]
    ds_read2_b32 v[120:121], v65 offset0:32 offset1:33
    ds_read2_b32 v[122:123], v65 offset0:34 offset1:35
    v_mfma_f32_16x16x32_bf16 v[92:95], v[96:99], v[140:143], v[92:95]
    ds_read_b128 v[100:103], v59 offset:2560
    s_waitcnt lgkmcnt(3)
    v_mfma_f32_16x16x32_bf16 v[84:87], v[104:107], v[116:119], v[84:87]
    buffer_load_dwordx4 a[200:203], v17, s[8:11], s12 offen offset:2048 sc0 sc1
    v_mfma_f32_16x16x32_bf16 v[84:87], v[144:147], v[108:111], v[84:87]
    v_mfma_f32_16x16x32_bf16 v[88:91], v[104:107], v[148:151], v[88:91]
    ds_read2_b32 v[136:137], v65 offset0:160 offset1:161
    ds_read2_b32 v[138:139], v65 offset0:162 offset1:163
    v_mfma_f32_16x16x32_bf16 v[88:91], v[128:131], v[108:111], v[88:91]
    ds_read_b128 v[132:135], v59 offset:512
    v_mfma_f32_16x16x32_bf16 v[92:95], v[104:107], v[124:127], v[92:95]
    ds_read2_b32 v[96:97], v57 offset0:16 offset1:17
    ds_read2_b32 v[98:99], v57 offset0:18 offset1:19
    v_mfma_f32_16x16x32_bf16 v[92:95], v[112:115], v[108:111], v[92:95]
    ds_read_b128 v[140:143], v60 offset:14592
    s_waitcnt lgkmcnt(6)
    v_mfma_f32_16x16x32_bf16 v[88:91], v[120:123], v[116:119], v[88:91]
    ds_read2_b32 v[104:105], v57 offset0:144 offset1:145
    ds_read2_b32 v[106:107], v57 offset0:146 offset1:147
    v_mfma_f32_16x16x32_bf16 v[88:91], v[144:147], v[100:103], v[88:91]
    ds_read_b128 v[124:127], v60 offset:12544
    buffer_load_dwordx4 a[204:207], v17, s[8:11], s12 offen offset:3072 sc0 sc1
    v_mfma_f32_16x16x32_bf16 v[92:95], v[120:123], v[148:151], v[92:95]
    ds_read2_b32 v[112:113], v63 offset0:16 offset1:17
    ds_read2_b32 v[114:115], v63 offset0:18 offset1:19
    v_mfma_f32_16x16x32_bf16 v[92:95], v[128:131], v[100:103], v[92:95]
    ds_read_b128 v[108:111], v60 offset:10496
    s_waitcnt lgkmcnt(6)
    v_mfma_f32_16x16x32_bf16 v[92:95], v[136:139], v[116:119], v[92:95]
    s_bfe_u32 s7, s15, 0x40010
    s_lshl_b32 s7, s7, 12
    v_mfma_f32_16x16x32_bf16 v[92:95], v[144:147], v[132:135], v[92:95]
    s_add_u32 s12, s6, s7
    buffer_load_dwordx4 a[208:211], v17, s[8:11], s12 offen offset:0 sc0 sc1
    v_mfma_f32_16x16x32_bf16 v[46:49], v[96:99], v[140:143], v[46:49]
    s_waitcnt lgkmcnt(1)
    v_mfma_f32_16x16x32_bf16 v[66:69], v[104:107], v[140:143], v[66:69]
    ds_read2_b32 v[120:121], v63 offset0:144 offset1:145
    ds_read2_b32 v[122:123], v63 offset0:146 offset1:147
    v_mfma_f32_16x16x32_bf16 v[66:69], v[96:99], v[124:127], v[66:69]
    ds_read_b128 v[148:151], v60 offset:8448
    v_mfma_f32_16x16x32_bf16 v[70:73], v[104:107], v[124:127], v[70:73]
    buffer_load_dwordx4 a[212:215], v17, s[8:11], s12 offen offset:1024 sc0 sc1
    v_mfma_f32_16x16x32_bf16 v[70:73], v[112:115], v[140:143], v[70:73]
    s_waitcnt lgkmcnt(3)
    v_mfma_f32_16x16x32_bf16 v[70:73], v[96:99], v[108:111], v[70:73]
    v_mfma_f32_16x16x32_bf16 v[74:77], v[112:115], v[124:127], v[74:77]
    v_mfma_f32_16x16x32_bf16 v[74:77], v[104:107], v[108:111], v[74:77]
    v_mfma_f32_16x16x32_bf16 v[78:81], v[112:115], v[108:111], v[78:81]
    ds_read2_b32 v[128:129], v64 offset0:16 offset1:17
    s_waitcnt lgkmcnt(1)
    v_mfma_f32_16x16x32_bf16 v[74:77], v[120:123], v[140:143], v[74:77]
    ds_read2_b32 v[130:131], v64 offset0:18 offset1:19
    ds_read_b128 v[100:103], v60 offset:6400
    v_mfma_f32_16x16x32_bf16 v[74:77], v[96:99], v[148:151], v[74:77]
    buffer_load_dwordx4 a[216:219], v17, s[8:11], s12 offen offset:2048 sc0 sc1
    v_mfma_f32_16x16x32_bf16 v[78:81], v[120:123], v[124:127], v[78:81]
    v_mfma_f32_16x16x32_bf16 v[78:81], v[104:107], v[148:151], v[78:81]
    v_mfma_f32_16x16x32_bf16 v[84:87], v[120:123], v[108:111], v[84:87]
    buffer_load_dwordx4 a[220:223], v17, s[8:11], s12 offen offset:3072 sc0 sc1
    v_mfma_f32_16x16x32_bf16 v[84:87], v[112:115], v[148:151], v[84:87]
    s_mov_b32 s50, 0
    s_waitcnt vmcnt(8)
    v_cmp_ne_u64 vcc, s[42:43], v[82:83]
    s_nop 4
    s_cbranch_vccz Lfdone_gate_11
Lfpoll_gate_12:
    buffer_load_dwordx2 v[82:83], v182, s[8:11], 0 offen sc0 sc1
    s_waitcnt vmcnt(0)
    v_cmp_ne_u64 vcc, s[42:43], v[82:83]
    s_nop 4
    s_add_u32 s50, s50, 1
    s_cmp_gt_u32 s50, 20000
    s_cbranch_scc1 Lfdone_gate_11
    s_cbranch_vccnz Lfpoll_gate_12
Lfdone_gate_11:
    v_mfma_f32_16x16x32_bf16 v[88:91], v[120:123], v[148:151], v[88:91]
    s_bfe_u32 s17, s14, 0x40000
    s_waitcnt lgkmcnt(0)
    v_mfma_f32_16x16x32_bf16 v[78:81], v[128:131], v[140:143], v[78:81]
    ds_read2_b32 v[136:137], v64 offset0:144 offset1:145
    ds_read2_b32 v[138:139], v64 offset0:146 offset1:147
    v_mfma_f32_16x16x32_bf16 v[78:81], v[96:99], v[100:103], v[78:81]
    ds_read_b128 v[116:119], v60 offset:4352
    s_lshl_b32 s17, s17, 8
    v_mfma_f32_16x16x32_bf16 v[84:87], v[128:131], v[124:127], v[84:87]
    s_add_u32 s20, s16, s17
    s_add_u32 m0, s18, 32768
    v_mfma_f32_16x16x32_bf16 v[84:87], v[104:107], v[100:103], v[84:87]
    buffer_load_dwordx4 v7, s[8:11], s20 offen sc0 sc1 lds
    v_mfma_f32_16x16x32_bf16 v[88:91], v[128:131], v[108:111], v[88:91]
    s_bfe_u32 s7, s15, 0x40014
    s_lshl_b32 s7, s7, 12
    v_mfma_f32_16x16x32_bf16 v[88:91], v[112:115], v[100:103], v[88:91]
    s_add_u32 s12, s6, s7
    buffer_load_dwordx4 a[224:227], v17, s[8:11], s12 offen offset:0 sc0 sc1
    v_mfma_f32_16x16x32_bf16 v[92:95], v[128:131], v[148:151], v[92:95]
    ds_read2_b32 v[144:145], v65 offset0:16 offset1:17
    ds_read2_b32 v[146:147], v65 offset0:18 offset1:19
    v_mfma_f32_16x16x32_bf16 v[92:95], v[120:123], v[100:103], v[92:95]
    ds_read_b128 v[132:135], v60 offset:2304
    s_waitcnt lgkmcnt(3)
    v_mfma_f32_16x16x32_bf16 v[84:87], v[136:139], v[140:143], v[84:87]
    s_add_u32 m0, s18, 33792
    s_nop 0
    buffer_load_dwordx4 v8, s[8:11], s20 offen sc0 sc1 lds
    v_mfma_f32_16x16x32_bf16 v[84:87], v[96:99], v[116:119], v[84:87]
    buffer_load_dwordx4 a[228:231], v17, s[8:11], s12 offen offset:1024 sc0 sc1
    v_mfma_f32_16x16x32_bf16 v[88:91], v[136:139], v[124:127], v[88:91]
    ds_read2_b32 v[128:129], v65 offset0:144 offset1:145
    ds_read2_b32 v[130:131], v65 offset0:146 offset1:147
    v_mfma_f32_16x16x32_bf16 v[88:91], v[104:107], v[116:119], v[88:91]
    ds_read_b128 v[148:151], v60 offset:256
    s_add_u32 m0, s18, 34816
    v_mfma_f32_16x16x32_bf16 v[92:95], v[136:139], v[108:111], v[92:95]
    ds_read2_b32 v[120:121], v57 offset0:0 offset1:1
    ds_read2_b32 v[122:123], v57 offset0:2 offset1:3
    v_mfma_f32_16x16x32_bf16 v[92:95], v[112:115], v[116:119], v[92:95]
    ds_read_b128 v[100:103], v61 offset:14336
    s_waitcnt lgkmcnt(6)
    v_mfma_f32_16x16x32_bf16 v[88:91], v[144:147], v[140:143], v[88:91]
    ds_read2_b32 v[136:137], v57 offset0:128 offset1:129
    ds_read2_b32 v[138:139], v57 offset0:130 offset1:131
    v_mfma_f32_16x16x32_bf16 v[88:91], v[96:99], v[132:135], v[88:91]
    ds_read_b128 v[108:111], v61 offset:12288
    buffer_load_dwordx4 v9, s[8:11], s20 offen sc0 sc1 lds
    v_mfma_f32_16x16x32_bf16 v[92:95], v[144:147], v[124:127], v[92:95]
    ds_read2_b32 v[112:113], v63 offset0:0 offset1:1
    ds_read2_b32 v[114:115], v63 offset0:2 offset1:3
    v_mfma_f32_16x16x32_bf16 v[92:95], v[104:107], v[132:135], v[92:95]
    ds_read_b128 v[116:119], v61 offset:10240
    s_waitcnt lgkmcnt(6)
    v_mfma_f32_16x16x32_bf16 v[92:95], v[128:131], v[140:143], v[92:95]
    buffer_load_dwordx4 a[232:235], v17, s[8:11], s12 offen offset:2048 sc0 sc1
    v_mfma_f32_16x16x32_bf16 v[92:95], v[96:99], v[148:151], v[92:95]
    s_add_u32 m0, s18, 35840
    s_nop 0
    buffer_load_dwordx4 v10, s[8:11], s20 offen sc0 sc1 lds
    v_mfma_f32_16x16x32_bf16 v[46:49], v[120:123], v[100:103], v[46:49]
    buffer_load_dwordx4 a[236:239], v17, s[8:11], s12 offen offset:3072 sc0 sc1
    s_waitcnt lgkmcnt(1)
    v_mfma_f32_16x16x32_bf16 v[66:69], v[136:139], v[100:103], v[66:69]
    ds_read2_b32 v[144:145], v63 offset0:128 offset1:129
    ds_read2_b32 v[146:147], v63 offset0:130 offset1:131
    v_mfma_f32_16x16x32_bf16 v[66:69], v[120:123], v[108:111], v[66:69]
    ds_read_b128 v[124:127], v61 offset:8192
    s_add_u32 s21, s20, 65536
    v_mfma_f32_16x16x32_bf16 v[70:73], v[136:139], v[108:111], v[70:73]
    s_add_u32 m0, s18, 36864
    s_nop 0
    buffer_load_dwordx4 v7, s[8:11], s21 offen sc0 sc1 lds
    v_mfma_f32_16x16x32_bf16 v[70:73], v[112:115], v[100:103], v[70:73]
    s_bfe_u32 s7, s15, 0x40018
    s_waitcnt lgkmcnt(3)
    v_mfma_f32_16x16x32_bf16 v[70:73], v[120:123], v[116:119], v[70:73]
    s_lshl_b32 s7, s7, 12
    s_add_u32 s12, s6, s7
    v_mfma_f32_16x16x32_bf16 v[74:77], v[112:115], v[108:111], v[74:77]
    buffer_load_dwordx4 a[240:243], v17, s[8:11], s12 offen offset:0 sc0 sc1
    v_mfma_f32_16x16x32_bf16 v[74:77], v[136:139], v[116:119], v[74:77]
    s_add_u32 m0, s18, 37888
    s_nop 0
    buffer_load_dwordx4 v8, s[8:11], s21 offen sc0 sc1 lds
    v_mfma_f32_16x16x32_bf16 v[78:81], v[112:115], v[116:119], v[78:81]
    ds_read2_b32 v[104:105], v64 offset0:0 offset1:1
    s_waitcnt lgkmcnt(1)
    v_mfma_f32_16x16x32_bf16 v[74:77], v[144:147], v[100:103], v[74:77]
    ds_read2_b32 v[106:107], v64 offset0:2 offset1:3
    ds_read_b128 v[132:135], v61 offset:6144
    v_mfma_f32_16x16x32_bf16 v[74:77], v[120:123], v[124:127], v[74:77]
    buffer_load_dwordx4 a[244:247], v17, s[8:11], s12 offen offset:1024 sc0 sc1
    v_mfma_f32_16x16x32_bf16 v[78:81], v[144:147], v[108:111], v[78:81]
    s_add_u32 m0, s18, 38912
    s_nop 0
    buffer_load_dwordx4 v9, s[8:11], s21 offen sc0 sc1 lds
    v_mfma_f32_16x16x32_bf16 v[78:81], v[136:139], v[124:127], v[78:81]
    v_mfma_f32_16x16x32_bf16 v[84:87], v[144:147], v[116:119], v[84:87]
    v_mfma_f32_16x16x32_bf16 v[84:87], v[112:115], v[124:127], v[84:87]
    s_add_u32 m0, s18, 39936
    s_nop 0
    buffer_load_dwordx4 v10, s[8:11], s21 offen sc0 sc1 lds
    v_mfma_f32_16x16x32_bf16 v[88:91], v[144:147], v[124:127], v[88:91]
    buffer_load_dwordx4 a[248:251], v17, s[8:11], s12 offen offset:2048 sc0 sc1
    s_waitcnt lgkmcnt(0)
    v_mfma_f32_16x16x32_bf16 v[78:81], v[104:107], v[100:103], v[78:81]
    ds_read2_b32 v[128:129], v64 offset0:128 offset1:129
    ds_read2_b32 v[130:131], v64 offset0:130 offset1:131
    v_mfma_f32_16x16x32_bf16 v[78:81], v[120:123], v[132:135], v[78:81]
    ds_read_b128 v[140:143], v61 offset:4096
    v_mfma_f32_16x16x32_bf16 v[84:87], v[104:107], v[108:111], v[84:87]
    v_mfma_f32_16x16x32_bf16 v[84:87], v[136:139], v[132:135], v[84:87]
    v_mfma_f32_16x16x32_bf16 v[88:91], v[104:107], v[116:119], v[88:91]
    buffer_load_dwordx4 a[252:255], v17, s[8:11], s12 offen offset:3072 sc0 sc1
    v_mfma_f32_16x16x32_bf16 v[88:91], v[112:115], v[132:135], v[88:91]
    v_mfma_f32_16x16x32_bf16 v[92:95], v[104:107], v[124:127], v[92:95]
    ds_read2_b32 v[96:97], v65 offset0:0 offset1:1
    ds_read2_b32 v[98:99], v65 offset0:2 offset1:3
    v_mfma_f32_16x16x32_bf16 v[92:95], v[144:147], v[132:135], v[92:95]
    ds_read_b128 v[148:151], v61 offset:2048
    s_waitcnt lgkmcnt(3)
    v_mfma_f32_16x16x32_bf16 v[84:87], v[128:131], v[100:103], v[84:87]
    v_mfma_f32_16x16x32_bf16 v[84:87], v[120:123], v[140:143], v[84:87]
    v_mfma_f32_16x16x32_bf16 v[88:91], v[128:131], v[108:111], v[88:91]
    ds_read2_b32 v[104:105], v65 offset0:128 offset1:129
    ds_read2_b32 v[106:107], v65 offset0:130 offset1:131
    v_mfma_f32_16x16x32_bf16 v[88:91], v[136:139], v[140:143], v[88:91]
    ds_read_b128 v[124:127], v61 offset:0
    v_mfma_f32_16x16x32_bf16 v[92:95], v[128:131], v[116:119], v[92:95]
    v_mfma_f32_16x16x32_bf16 v[92:95], v[112:115], v[140:143], v[92:95]
    s_waitcnt lgkmcnt(3)
    v_mfma_f32_16x16x32_bf16 v[88:91], v[96:99], v[100:103], v[88:91]
    v_mfma_f32_16x16x32_bf16 v[88:91], v[120:123], v[148:151], v[88:91]
    v_mfma_f32_16x16x32_bf16 v[92:95], v[96:99], v[108:111], v[92:95]
    v_mfma_f32_16x16x32_bf16 v[92:95], v[136:139], v[148:151], v[92:95]
    s_waitcnt lgkmcnt(0)
    v_mfma_f32_16x16x32_bf16 v[92:95], v[104:107], v[100:103], v[92:95]
    v_mfma_f32_16x16x32_bf16 v[92:95], v[120:123], v[124:127], v[92:95]
    s_barrier
    ds_read_b128 v[96:99], v4 offset:0
    ds_read_b128 v[100:103], v4 offset:8192
    ds_read_b128 v[104:107], v18 offset:0
    ds_read_b128 v[108:111], v18 offset:8192
    s_bfe_u32 s17, s14, 0x40004
    s_lshl_b32 s17, s17, 8
    s_add_u32 s20, s16, s17
    s_add_u32 m0, s18, 65536
    s_waitcnt lgkmcnt(3)
    v_mfma_f32_32x32x16_bf16 v[128:143], v[96:99], a[0:3], 0
    ds_read_b128 v[112:115], v5 offset:0
    ds_read_b128 v[116:119], v5 offset:8192
    buffer_load_dwordx4 v7, s[8:11], s20 offen sc0 sc1 lds
    ds_read_b64 v[26:27], v62 offset:14336
    ds_read_b64 v[32:33], v62 offset:12288
    ds_read_b64 v[50:51], v62 offset:10240
    ds_read_b64 v[54:55], v62 offset:8192
    ds_read_b64 v[176:177], v62 offset:6144
    ds_read_b64 v[178:179], v62 offset:4096
    s_add_u32 m0, s18, 66560
    s_waitcnt lgkmcnt(10)
    v_mfma_f32_32x32x16_bf16 v[144:159], v[100:103], a[0:3], 0
    ds_read_b128 v[120:123], v19 offset:0
    ds_read_b128 v[124:127], v19 offset:8192
    buffer_load_dwordx4 v8, s[8:11], s20 offen sc0 sc1 lds
    ds_read_b64 v[200:201], v62 offset:2048
    ds_read_b64 v[202:203], v62 offset:0
    s_add_u32 s4, s22, 12582912
    s_waitcnt lgkmcnt(9)
    v_and_b32 v204, s5, v27
    v_lshlrev_b32 v205, 16, v27
    v_and_b32 v206, s5, v26
    s_add_u32 m0, s18, 67584
    v_mfma_f32_32x32x16_bf16 v[160:175], v[104:107], a[0:3], 0
    buffer_load_dwordx4 v9, s[8:11], s20 offen sc0 sc1 lds
    v_lshlrev_b32 v207, 16, v26
    v_fmac_f32 v46, v183, v204
    v_fmac_f32 v47, v183, v205
    v_fmac_f32 v48, v183, v206
    v_fmac_f32 v49, v183, v207
    v_cvt_pk_bf16_f32 v208, v46, v47
    v_cvt_pk_bf16_f32 v209, v48, v49
    s_waitcnt lgkmcnt(8)
    v_and_b32 v204, s5, v33
    s_add_u32 m0, s18, 68608
    v_mfma_f32_32x32x16_bf16 v[184:199], v[108:111], a[0:3], 0
    buffer_load_dwordx4 v10, s[8:11], s20 offen sc0 sc1 lds
    v_lshlrev_b32 v205, 16, v33
    v_and_b32 v206, s5, v32
    v_lshlrev_b32 v207, 16, v32
    v_fmac_f32 v66, v183, v204
    v_fmac_f32 v67, v183, v205
    v_fmac_f32 v68, v183, v206
    v_fmac_f32 v69, v183, v207
    v_cvt_pk_bf16_f32 v210, v66, v67
    v_cvt_pk_bf16_f32 v211, v68, v69
    s_add_u32 s21, s20, 65536
    s_add_u32 m0, s18, 69632
    v_mfma_f32_32x32x16_bf16 v[128:143], v[112:115], a[4:7], v[128:143]
    ds_read_b128 v[96:99], v11 offset:0
    ds_read_b128 v[100:103], v11 offset:8192
    buffer_load_dwordx4 v7, s[8:11], s21 offen sc0 sc1 lds
    v_permlane16_swap_b32 v208, v210
    v_permlane16_swap_b32 v209, v211
    s_waitcnt lgkmcnt(9)
    v_and_b32 v204, s5, v51
    v_lshlrev_b32 v205, 16, v51
    v_and_b32 v206, s5, v50
    v_lshlrev_b32 v207, 16, v50
    s_add_u32 m0, s18, 70656
    v_mfma_f32_32x32x16_bf16 v[144:159], v[116:119], a[4:7], v[144:159]
    ds_read_b128 v[104:107], v20 offset:0
    ds_read_b128 v[108:111], v20 offset:8192
    buffer_load_dwordx4 v8, s[8:11], s21 offen sc0 sc1 lds
    v_fmac_f32 v70, v183, v204
    v_fmac_f32 v71, v183, v205
    v_fmac_f32 v72, v183, v206
    v_fmac_f32 v73, v183, v207
    v_cvt_pk_bf16_f32 v212, v70, v71
    v_cvt_pk_bf16_f32 v213, v72, v73
    s_add_u32 m0, s18, 71680
    s_waitcnt lgkmcnt(7)
    v_mfma_f32_32x32x16_bf16 v[160:175], v[120:123], a[4:7], v[160:175]
    buffer_load_dwordx4 v9, s[8:11], s21 offen sc0 sc1 lds
    v_and_b32 v204, s5, v55
    v_lshlrev_b32 v205, 16, v55
    v_and_b32 v206, s5, v54
    v_lshlrev_b32 v207, 16, v54
    v_fmac_f32 v74, v183, v204
    v_fmac_f32 v75, v183, v205
    v_fmac_f32 v76, v183, v206
    v_fmac_f32 v77, v183, v207
    s_add_u32 m0, s18, 72704
    s_waitcnt lgkmcnt(6)
    v_mfma_f32_32x32x16_bf16 v[184:199], v[124:127], a[4:7], v[184:199]
    buffer_load_dwordx4 v10, s[8:11], s21 offen sc0 sc1 lds
    v_cvt_pk_bf16_f32 v214, v74, v75
    v_cvt_pk_bf16_f32 v215, v76, v77
    s_nop 0
    v_permlane16_swap_b32 v212, v214
    v_permlane16_swap_b32 v213, v215
    v_and_b32 v204, s5, v177
    v_lshlrev_b32 v205, 16, v177
    v_and_b32 v206, s5, v176
    v_lshlrev_b32 v207, 16, v176
    v_fmac_f32 v78, v183, v204
    s_bfe_u32 s17, s14, 0x40008
    s_lshl_b32 s17, s17, 8
    s_add_u32 s20, s16, s17
    s_add_u32 m0, s18, 98304
    s_waitcnt lgkmcnt(3)
    v_mfma_f32_32x32x16_bf16 v[128:143], v[96:99], a[8:11], v[128:143]
    ds_read_b128 v[112:115], v12 offset:0
    ds_read_b128 v[116:119], v12 offset:8192
    buffer_load_dwordx4 v7, s[8:11], s20 offen sc0 sc1 lds
    v_fmac_f32 v79, v183, v205
    v_fmac_f32 v80, v183, v206
    v_fmac_f32 v81, v183, v207
    v_cvt_pk_bf16_f32 v216, v78, v79
    v_cvt_pk_bf16_f32 v217, v80, v81
    v_and_b32 v204, s5, v179
    s_add_u32 m0, s18, 99328
    s_waitcnt lgkmcnt(4)
    v_mfma_f32_32x32x16_bf16 v[144:159], v[100:103], a[8:11], v[144:159]
    ds_read_b128 v[120:123], v21 offset:0
    ds_read_b128 v[124:127], v21 offset:8192
    buffer_load_dwordx4 v8, s[8:11], s20 offen sc0 sc1 lds
    v_lshlrev_b32 v205, 16, v179
    v_and_b32 v206, s5, v178
    v_lshlrev_b32 v207, 16, v178
    v_fmac_f32 v84, v183, v204
    v_fmac_f32 v85, v183, v205
    v_fmac_f32 v86, v183, v206
    s_add_u32 m0, s18, 100352
    s_waitcnt lgkmcnt(5)
    v_mfma_f32_32x32x16_bf16 v[160:175], v[104:107], a[8:11], v[160:175]
    buffer_load_dwordx4 v9, s[8:11], s20 offen sc0 sc1 lds
    v_fmac_f32 v87, v183, v207
    v_cvt_pk_bf16_f32 v218, v84, v85
    v_cvt_pk_bf16_f32 v219, v86, v87
    s_nop 0
    v_permlane16_swap_b32 v216, v218
    v_permlane16_swap_b32 v217, v219
    v_and_b32 v204, s5, v201
    v_lshlrev_b32 v205, 16, v201
    v_and_b32 v206, s5, v200
    s_add_u32 m0, s18, 101376
    s_waitcnt lgkmcnt(4)
    v_mfma_f32_32x32x16_bf16 v[184:199], v[108:111], a[8:11], v[184:199]
    buffer_load_dwordx4 v10, s[8:11], s20 offen sc0 sc1 lds
    v_lshlrev_b32 v207, 16, v200
    v_fmac_f32 v88, v183, v204
    v_fmac_f32 v89, v183, v205
    v_fmac_f32 v90, v183, v206
    v_fmac_f32 v91, v183, v207
    v_cvt_pk_bf16_f32 v220, v88, v89
    v_cvt_pk_bf16_f32 v221, v90, v91
    v_and_b32 v204, s5, v203
    v_lshlrev_b32 v205, 16, v203
    s_waitcnt lgkmcnt(0)
    s_waitcnt vmcnt(14)
    s_barrier
    s_add_u32 s21, s20, 65536
    s_add_u32 m0, s18, 102400
    v_mfma_f32_32x32x16_bf16 v[128:143], v[112:115], a[12:15], v[128:143]
    ds_read_b128 v[96:99], v4 offset:32768
    ds_read_b128 v[100:103], v4 offset:40960
    buffer_load_dwordx4 v7, s[8:11], s21 offen sc0 sc1 lds
    v_and_b32 v206, s5, v202
    v_lshlrev_b32 v207, 16, v202
    v_fmac_f32 v92, v183, v204
    v_fmac_f32 v93, v183, v205
    v_fmac_f32 v94, v183, v206
    v_fmac_f32 v95, v183, v207
    s_add_u32 m0, s18, 103424
    v_mfma_f32_32x32x16_bf16 v[144:159], v[116:119], a[12:15], v[144:159]
    ds_read_b128 v[104:107], v18 offset:32768
    ds_read_b128 v[108:111], v18 offset:40960
    buffer_load_dwordx4 v8, s[8:11], s21 offen sc0 sc1 lds
    v_cvt_pk_bf16_f32 v222, v92, v93
    v_cvt_pk_bf16_f32 v223, v94, v95
    s_nop 0
    v_permlane16_swap_b32 v220, v222
    v_permlane16_swap_b32 v221, v223
    s_add_u32 m0, s18, 104448
    v_mfma_f32_32x32x16_bf16 v[160:175], v[120:123], a[12:15], v[160:175]
    buffer_load_dwordx4 v9, s[8:11], s21 offen sc0 sc1 lds
    s_add_u32 m0, s18, 105472
    v_mfma_f32_32x32x16_bf16 v[184:199], v[124:127], a[12:15], v[184:199]
    buffer_load_dwordx4 v10, s[8:11], s21 offen sc0 sc1 lds
    s_waitcnt lgkmcnt(3)
    v_mfma_f32_32x32x16_bf16 v[128:143], v[96:99], a[16:19], v[128:143]
    ds_read_b128 v[112:115], v5 offset:32768
    ds_read_b128 v[116:119], v5 offset:40960
    buffer_store_dwordx4 v[208:211], v180, s[8:11], s4 offen offset:0 sc0 sc1
    buffer_store_dwordx4 v[212:215], v180, s[8:11], s4 offen offset:1024 sc0 sc1
    buffer_store_dwordx4 v[216:219], v180, s[8:11], s4 offen offset:2048 sc0 sc1
    s_waitcnt lgkmcnt(4)
    v_mfma_f32_32x32x16_bf16 v[144:159], v[100:103], a[16:19], v[144:159]
    ds_read_b128 v[120:123], v19 offset:32768
    ds_read_b128 v[124:127], v19 offset:40960
    s_bfe_u32 s17, s14, 0x4000c
    s_lshl_b32 s17, s17, 8
    s_add_u32 s20, s16, s17
    s_add_u32 m0, s18, 0
    s_waitcnt lgkmcnt(5)
    v_mfma_f32_32x32x16_bf16 v[160:175], v[104:107], a[16:19], v[160:175]
    buffer_load_dwordx4 v7, s[8:11], s20 offen sc0 sc1 lds
    buffer_store_dwordx4 v[220:223], v180, s[8:11], s4 offen offset:3072 sc0 sc1
    s_add_u32 m0, s18, 1024
    s_waitcnt lgkmcnt(4)
    v_mfma_f32_32x32x16_bf16 v[184:199], v[108:111], a[16:19], v[184:199]
    buffer_load_dwordx4 v8, s[8:11], s20 offen sc0 sc1 lds
    s_waitcnt lgkmcnt(3)
    v_mfma_f32_32x32x16_bf16 v[128:143], v[112:115], a[20:23], v[128:143]
    ds_read_b128 v[96:99], v11 offset:32768
    ds_read_b128 v[100:103], v11 offset:40960
    s_waitcnt lgkmcnt(4)
    v_mfma_f32_32x32x16_bf16 v[144:159], v[116:119], a[20:23], v[144:159]
    ds_read_b128 v[104:107], v20 offset:32768
    ds_read_b128 v[108:111], v20 offset:40960
    s_add_u32 m0, s18, 2048
    s_waitcnt lgkmcnt(5)
    v_mfma_f32_32x32x16_bf16 v[160:175], v[120:123], a[20:23], v[160:175]
    buffer_load_dwordx4 v9, s[8:11], s20 offen sc0 sc1 lds
    s_add_u32 m0, s18, 3072
    s_waitcnt lgkmcnt(4)
    v_mfma_f32_32x32x16_bf16 v[184:199], v[124:127], a[20:23], v[184:199]
    buffer_load_dwordx4 v10, s[8:11], s20 offen sc0 sc1 lds
    s_waitcnt lgkmcnt(3)
    v_mfma_f32_32x32x16_bf16 v[128:143], v[96:99], a[24:27], v[128:143]
    ds_read_b128 v[112:115], v12 offset:32768
    ds_read_b128 v[116:119], v12 offset:40960
    s_waitcnt lgkmcnt(4)
    v_mfma_f32_32x32x16_bf16 v[144:159], v[100:103], a[24:27], v[144:159]
    ds_read_b128 v[120:123], v21 offset:32768
    ds_read_b128 v[124:127], v21 offset:40960
    s_add_u32 s21, s20, 65536
    s_add_u32 m0, s18, 4096
    s_waitcnt lgkmcnt(5)
    v_mfma_f32_32x32x16_bf16 v[160:175], v[104:107], a[24:27], v[160:175]
    buffer_load_dwordx4 v7, s[8:11], s21 offen sc0 sc1 lds
    s_add_u32 m0, s18, 5120
    s_waitcnt lgkmcnt(4)
    v_mfma_f32_32x32x16_bf16 v[184:199], v[108:111], a[24:27], v[184:199]
    buffer_load_dwordx4 v8, s[8:11], s21 offen sc0 sc1 lds
    s_waitcnt lgkmcnt(0)
    s_waitcnt vmcnt(18)
    s_barrier
    v_mfma_f32_32x32x16_bf16 v[128:143], v[112:115], a[28:31], v[128:143]
    ds_read_b128 v[96:99], v13 offset:0
    ds_read_b128 v[100:103], v13 offset:8192
    v_mfma_f32_32x32x16_bf16 v[144:159], v[116:119], a[28:31], v[144:159]
    ds_read_b128 v[104:107], v22 offset:0
    ds_read_b128 v[108:111], v22 offset:8192
    s_add_u32 m0, s18, 6144
    v_mfma_f32_32x32x16_bf16 v[160:175], v[120:123], a[28:31], v[160:175]
    buffer_load_dwordx4 v9, s[8:11], s21 offen sc0 sc1 lds
    s_add_u32 m0, s18, 7168
    v_mfma_f32_32x32x16_bf16 v[184:199], v[124:127], a[28:31], v[184:199]
    buffer_load_dwordx4 v10, s[8:11], s21 offen sc0 sc1 lds
    s_waitcnt lgkmcnt(3)
    v_mfma_f32_32x32x16_bf16 v[128:143], v[96:99], a[32:35], v[128:143]
    ds_read_b128 v[112:115], v14 offset:0
    ds_read_b128 v[116:119], v14 offset:8192
    s_waitcnt lgkmcnt(4)
    v_mfma_f32_32x32x16_bf16 v[144:159], v[100:103], a[32:35], v[144:159]
    ds_read_b128 v[120:123], v23 offset:0
    ds_read_b128 v[124:127], v23 offset:8192
    s_bfe_u32 s17, s14, 0x40010
    s_lshl_b32 s17, s17, 8
    s_add_u32 s20, s16, s17
    s_add_u32 m0, s18, 32768
    s_waitcnt lgkmcnt(5)
    v_mfma_f32_32x32x16_bf16 v[160:175], v[104:107], a[32:35], v[160:175]
    buffer_load_dwordx4 v7, s[8:11], s20 offen sc0 sc1 lds
    s_add_u32 m0, s18, 33792
    s_waitcnt lgkmcnt(4)
    v_mfma_f32_32x32x16_bf16 v[184:199], v[108:111], a[32:35], v[184:199]
    buffer_load_dwordx4 v8, s[8:11], s20 offen sc0 sc1 lds
    s_waitcnt lgkmcnt(3)
    v_mfma_f32_32x32x16_bf16 v[128:143], v[112:115], a[36:39], v[128:143]
    ds_read_b128 v[96:99], v15 offset:0
    ds_read_b128 v[100:103], v15 offset:8192
    s_waitcnt lgkmcnt(4)
    v_mfma_f32_32x32x16_bf16 v[144:159], v[116:119], a[36:39], v[144:159]
    ds_read_b128 v[104:107], v24 offset:0
    ds_read_b128 v[108:111], v24 offset:8192
    s_add_u32 m0, s18, 34816
    s_waitcnt lgkmcnt(5)
    v_mfma_f32_32x32x16_bf16 v[160:175], v[120:123], a[36:39], v[160:175]
    buffer_load_dwordx4 v9, s[8:11], s20 offen sc0 sc1 lds
    s_add_u32 m0, s18, 35840
    s_waitcnt lgkmcnt(4)
    v_mfma_f32_32x32x16_bf16 v[184:199], v[124:127], a[36:39], v[184:199]
    buffer_load_dwordx4 v10, s[8:11], s20 offen sc0 sc1 lds
    s_waitcnt lgkmcnt(3)
    v_mfma_f32_32x32x16_bf16 v[128:143], v[96:99], a[40:43], v[128:143]
    ds_read_b128 v[112:115], v16 offset:0
    ds_read_b128 v[116:119], v16 offset:8192
    s_waitcnt lgkmcnt(4)
    v_mfma_f32_32x32x16_bf16 v[144:159], v[100:103], a[40:43], v[144:159]
    ds_read_b128 v[120:123], v25 offset:0
    ds_read_b128 v[124:127], v25 offset:8192
    s_add_u32 s21, s20, 65536
    s_add_u32 m0, s18, 36864
    s_waitcnt lgkmcnt(5)
    v_mfma_f32_32x32x16_bf16 v[160:175], v[104:107], a[40:43], v[160:175]
    buffer_load_dwordx4 v7, s[8:11], s21 offen sc0 sc1 lds
    s_add_u32 m0, s18, 37888
    s_waitcnt lgkmcnt(4)
    v_mfma_f32_32x32x16_bf16 v[184:199], v[108:111], a[40:43], v[184:199]
    buffer_load_dwordx4 v8, s[8:11], s21 offen sc0 sc1 lds
    s_waitcnt lgkmcnt(0)
    s_waitcnt vmcnt(18)
    s_barrier
    v_mfma_f32_32x32x16_bf16 v[128:143], v[112:115], a[44:47], v[128:143]
    ds_read_b128 v[96:99], v13 offset:32768
    ds_read_b128 v[100:103], v13 offset:40960
    v_mfma_f32_32x32x16_bf16 v[144:159], v[116:119], a[44:47], v[144:159]
    ds_read_b128 v[104:107], v22 offset:32768
    ds_read_b128 v[108:111], v22 offset:40960
    s_add_u32 m0, s18, 38912
    v_mfma_f32_32x32x16_bf16 v[160:175], v[120:123], a[44:47], v[160:175]
    buffer_load_dwordx4 v9, s[8:11], s21 offen sc0 sc1 lds
    s_add_u32 m0, s18, 39936
    v_mfma_f32_32x32x16_bf16 v[184:199], v[124:127], a[44:47], v[184:199]
    buffer_load_dwordx4 v10, s[8:11], s21 offen sc0 sc1 lds
    s_waitcnt lgkmcnt(3)
    v_mfma_f32_32x32x16_bf16 v[128:143], v[96:99], a[48:51], v[128:143]
    ds_read_b128 v[112:115], v14 offset:32768
    ds_read_b128 v[116:119], v14 offset:40960
    s_waitcnt lgkmcnt(4)
    v_mfma_f32_32x32x16_bf16 v[144:159], v[100:103], a[48:51], v[144:159]
    ds_read_b128 v[120:123], v23 offset:32768
    ds_read_b128 v[124:127], v23 offset:40960
    s_bfe_u32 s17, s14, 0x40014
    s_lshl_b32 s17, s17, 8
    s_add_u32 s20, s16, s17
    s_add_u32 m0, s18, 65536
    s_waitcnt lgkmcnt(5)
    v_mfma_f32_32x32x16_bf16 v[160:175], v[104:107], a[48:51], v[160:175]
    buffer_load_dwordx4 v7, s[8:11], s20 offen sc0 sc1 lds
    s_add_u32 m0, s18, 66560
    s_waitcnt lgkmcnt(4)
    v_mfma_f32_32x32x16_bf16 v[184:199], v[108:111], a[48:51], v[184:199]
    buffer_load_dwordx4 v8, s[8:11], s20 offen sc0 sc1 lds
    s_waitcnt lgkmcnt(3)
    v_mfma_f32_32x32x16_bf16 v[128:143], v[112:115], a[52:55], v[128:143]
    ds_read_b128 v[96:99], v15 offset:32768
    ds_read_b128 v[100:103], v15 offset:40960
    s_waitcnt lgkmcnt(4)
    v_mfma_f32_32x32x16_bf16 v[144:159], v[116:119], a[52:55], v[144:159]
    ds_read_b128 v[104:107], v24 offset:32768
    ds_read_b128 v[108:111], v24 offset:40960
    s_add_u32 m0, s18, 67584
    s_waitcnt lgkmcnt(5)
    v_mfma_f32_32x32x16_bf16 v[160:175], v[120:123], a[52:55], v[160:175]
    buffer_load_dwordx4 v9, s[8:11], s20 offen sc0 sc1 lds
    s_add_u32 m0, s18, 68608
    s_waitcnt lgkmcnt(4)
    v_mfma_f32_32x32x16_bf16 v[184:199], v[124:127], a[52:55], v[184:199]
    buffer_load_dwordx4 v10, s[8:11], s20 offen sc0 sc1 lds
    s_waitcnt lgkmcnt(3)
    v_mfma_f32_32x32x16_bf16 v[128:143], v[96:99], a[56:59], v[128:143]
    ds_read_b128 v[112:115], v16 offset:32768
    ds_read_b128 v[116:119], v16 offset:40960
    s_waitcnt lgkmcnt(4)
    v_mfma_f32_32x32x16_bf16 v[144:159], v[100:103], a[56:59], v[144:159]
    ds_read_b128 v[120:123], v25 offset:32768
    ds_read_b128 v[124:127], v25 offset:40960
    s_add_u32 s21, s20, 65536
    s_add_u32 m0, s18, 69632
    s_waitcnt lgkmcnt(5)
    v_mfma_f32_32x32x16_bf16 v[160:175], v[104:107], a[56:59], v[160:175]
    buffer_load_dwordx4 v7, s[8:11], s21 offen sc0 sc1 lds
    s_add_u32 m0, s18, 70656
    s_waitcnt lgkmcnt(4)
    v_mfma_f32_32x32x16_bf16 v[184:199], v[108:111], a[56:59], v[184:199]
    buffer_load_dwordx4 v8, s[8:11], s21 offen sc0 sc1 lds
    s_waitcnt lgkmcnt(0)
    s_waitcnt vmcnt(14)
    s_barrier
    v_mfma_f32_32x32x16_bf16 v[128:143], v[112:115], a[60:63], v[128:143]
    ds_read_b128 v[96:99], v4 offset:0
    ds_read_b128 v[100:103], v4 offset:8192
    v_mfma_f32_32x32x16_bf16 v[144:159], v[116:119], a[60:63], v[144:159]
    ds_read_b128 v[104:107], v18 offset:0
    ds_read_b128 v[108:111], v18 offset:8192
    s_add_u32 m0, s18, 71680
    v_mfma_f32_32x32x16_bf16 v[160:175], v[120:123], a[60:63], v[160:175]
    buffer_load_dwordx4 v9, s[8:11], s21 offen sc0 sc1 lds
    s_add_u32 m0, s18, 72704
    v_mfma_f32_32x32x16_bf16 v[184:199], v[124:127], a[60:63], v[184:199]
    buffer_load_dwordx4 v10, s[8:11], s21 offen sc0 sc1 lds
    s_waitcnt lgkmcnt(3)
    v_mfma_f32_32x32x16_bf16 v[128:143], v[96:99], a[64:67], v[128:143]
    ds_read_b128 v[112:115], v5 offset:0
    ds_read_b128 v[116:119], v5 offset:8192
    v_mov_b32 v82, s42
    v_mov_b32 v83, s43
    s_mov_b64 s[22:23], exec
    s_mov_b64 exec, 1
    buffer_store_dwordx2 v[82:83], v6, s[8:11], s13 offen sc0 sc1
    s_mov_b64 exec, s[22:23]
    s_waitcnt lgkmcnt(4)
    v_mfma_f32_32x32x16_bf16 v[144:159], v[100:103], a[64:67], v[144:159]
    ds_read_b128 v[120:123], v19 offset:0
    ds_read_b128 v[124:127], v19 offset:8192
    s_bfe_u32 s17, s14, 0x40018
    s_lshl_b32 s17, s17, 8
    s_add_u32 s20, s16, s17
    s_add_u32 m0, s18, 98304
    s_waitcnt lgkmcnt(5)
    v_mfma_f32_32x32x16_bf16 v[160:175], v[104:107], a[64:67], v[160:175]
    buffer_load_dwordx4 v7, s[8:11], s20 offen sc0 sc1 lds
    s_add_u32 m0, s18, 99328
    s_waitcnt lgkmcnt(4)
    v_mfma_f32_32x32x16_bf16 v[184:199], v[108:111], a[64:67], v[184:199]
    buffer_load_dwordx4 v8, s[8:11], s20 offen sc0 sc1 lds
    s_waitcnt lgkmcnt(3)
    v_mfma_f32_32x32x16_bf16 v[128:143], v[112:115], a[68:71], v[128:143]
    ds_read_b128 v[96:99], v11 offset:0
    ds_read_b128 v[100:103], v11 offset:8192
    s_waitcnt lgkmcnt(4)
    v_mfma_f32_32x32x16_bf16 v[144:159], v[116:119], a[68:71], v[144:159]
    ds_read_b128 v[104:107], v20 offset:0
    ds_read_b128 v[108:111], v20 offset:8192
    s_add_u32 m0, s18, 100352
    s_waitcnt lgkmcnt(5)
    v_mfma_f32_32x32x16_bf16 v[160:175], v[120:123], a[68:71], v[160:175]
    buffer_load_dwordx4 v9, s[8:11], s20 offen sc0 sc1 lds
    s_add_u32 m0, s18, 101376
    s_waitcnt lgkmcnt(4)
    v_mfma_f32_32x32x16_bf16 v[184:199], v[124:127], a[68:71], v[184:199]
    buffer_load_dwordx4 v10, s[8:11], s20 offen sc0 sc1 lds
    s_waitcnt lgkmcnt(3)
    v_mfma_f32_32x32x16_bf16 v[128:143], v[96:99], a[72:75], v[128:143]
    ds_read_b128 v[112:115], v12 offset:0
    ds_read_b128 v[116:119], v12 offset:8192
    s_waitcnt lgkmcnt(4)
    v_mfma_f32_32x32x16_bf16 v[144:159], v[100:103], a[72:75], v[144:159]
    ds_read_b128 v[120:123], v21 offset:0
    ds_read_b128 v[124:127], v21 offset:8192
    s_add_u32 s21, s20, 65536
    s_add_u32 m0, s18, 102400
    s_waitcnt lgkmcnt(5)
    v_mfma_f32_32x32x16_bf16 v[160:175], v[104:107], a[72:75], v[160:175]
    buffer_load_dwordx4 v7, s[8:11], s21 offen sc0 sc1 lds
    s_add_u32 m0, s18, 103424
    s_waitcnt lgkmcnt(4)
    v_mfma_f32_32x32x16_bf16 v[184:199], v[108:111], a[72:75], v[184:199]
    buffer_load_dwordx4 v8, s[8:11], s21 offen sc0 sc1 lds
    s_waitcnt lgkmcnt(0)
    s_waitcnt vmcnt(15)
    s_barrier
    v_mfma_f32_32x32x16_bf16 v[128:143], v[112:115], a[76:79], v[128:143]
    ds_read_b128 v[96:99], v4 offset:32768
    ds_read_b128 v[100:103], v4 offset:40960
    v_mfma_f32_32x32x16_bf16 v[144:159], v[116:119], a[76:79], v[144:159]
    ds_read_b128 v[104:107], v18 offset:32768
    ds_read_b128 v[108:111], v18 offset:40960
    s_add_u32 m0, s18, 104448
    v_mfma_f32_32x32x16_bf16 v[160:175], v[120:123], a[76:79], v[160:175]
    buffer_load_dwordx4 v9, s[8:11], s21 offen sc0 sc1 lds
    s_add_u32 m0, s18, 105472
    v_mfma_f32_32x32x16_bf16 v[184:199], v[124:127], a[76:79], v[184:199]
    buffer_load_dwordx4 v10, s[8:11], s21 offen sc0 sc1 lds
    s_waitcnt lgkmcnt(3)
    v_mfma_f32_32x32x16_bf16 v[128:143], v[96:99], a[80:83], v[128:143]
    ds_read_b128 v[112:115], v5 offset:32768
    ds_read_b128 v[116:119], v5 offset:40960
    s_add_u32 m0, s47, 131072
    s_nop 0
    buffer_load_dwordx4 v35, s[56:59], s31 offen lds
    s_add_u32 s31, s31, 16384
    s_add_u32 m0, s47, 132096
    s_nop 0
    buffer_load_dwordx4 v35, s[56:59], s31 offen lds
    s_waitcnt lgkmcnt(4)
    v_mfma_f32_32x32x16_bf16 v[144:159], v[100:103], a[80:83], v[144:159]
    ds_read_b128 v[120:123], v19 offset:32768
    ds_read_b128 v[124:127], v19 offset:40960
    s_bfe_u32 s17, s14, 0x4001c
    s_lshl_b32 s17, s17, 8
    s_add_u32 s20, s16, s17
    s_add_u32 m0, s18, 0
    s_waitcnt lgkmcnt(5)
    v_mfma_f32_32x32x16_bf16 v[160:175], v[104:107], a[80:83], v[160:175]
    buffer_load_dwordx4 v7, s[8:11], s20 offen sc0 sc1 lds
    s_add_u32 s31, s31, 16384
    s_add_u32 m0, s47, 133120
    s_nop 0
    buffer_load_dwordx4 v35, s[56:59], s31 offen lds
    s_add_u32 s31, s31, 16384
    s_add_u32 m0, s18, 1024
    s_waitcnt lgkmcnt(4)
    v_mfma_f32_32x32x16_bf16 v[184:199], v[108:111], a[80:83], v[184:199]
    buffer_load_dwordx4 v8, s[8:11], s20 offen sc0 sc1 lds
    s_add_u32 m0, s47, 134144
    s_nop 0
    buffer_load_dwordx4 v35, s[56:59], s31 offen lds
    s_lshr_b32 s3, s47, 2
    s_add_u32 m0, s3, 147456
    s_nop 0
    buffer_load_dwordx4 v38, s[8:11], 0 offen sc0 sc1 lds
    s_waitcnt lgkmcnt(3)
    v_mfma_f32_32x32x16_bf16 v[128:143], v[112:115], a[84:87], v[128:143]
    ds_read_b128 v[96:99], v11 offset:32768
    ds_read_b128 v[100:103], v11 offset:40960
    s_waitcnt lgkmcnt(4)
    v_mfma_f32_32x32x16_bf16 v[144:159], v[116:119], a[84:87], v[144:159]
    ds_read_b128 v[104:107], v20 offset:32768
    ds_read_b128 v[108:111], v20 offset:40960
    s_add_u32 m0, s18, 2048
    s_waitcnt lgkmcnt(5)
    v_mfma_f32_32x32x16_bf16 v[160:175], v[120:123], a[84:87], v[160:175]
    buffer_load_dwordx4 v9, s[8:11], s20 offen sc0 sc1 lds
    s_add_u32 m0, s18, 3072
    s_waitcnt lgkmcnt(4)
    v_mfma_f32_32x32x16_bf16 v[184:199], v[124:127], a[84:87], v[184:199]
    buffer_load_dwordx4 v10, s[8:11], s20 offen sc0 sc1 lds
    s_waitcnt lgkmcnt(3)
    v_mfma_f32_32x32x16_bf16 v[128:143], v[96:99], a[88:91], v[128:143]
    ds_read_b128 v[112:115], v12 offset:32768
    ds_read_b128 v[116:119], v12 offset:40960
    s_waitcnt lgkmcnt(4)
    v_mfma_f32_32x32x16_bf16 v[144:159], v[100:103], a[88:91], v[144:159]
    ds_read_b128 v[120:123], v21 offset:32768
    ds_read_b128 v[124:127], v21 offset:40960
    s_add_u32 s21, s20, 65536
    s_add_u32 m0, s18, 4096
    s_waitcnt lgkmcnt(5)
    v_mfma_f32_32x32x16_bf16 v[160:175], v[104:107], a[88:91], v[160:175]
    buffer_load_dwordx4 v7, s[8:11], s21 offen sc0 sc1 lds
    s_add_u32 m0, s18, 5120
    s_waitcnt lgkmcnt(4)
    v_mfma_f32_32x32x16_bf16 v[184:199], v[108:111], a[88:91], v[184:199]
    buffer_load_dwordx4 v8, s[8:11], s21 offen sc0 sc1 lds
    s_waitcnt lgkmcnt(0)
    s_waitcnt vmcnt(20)
    s_barrier
    v_mfma_f32_32x32x16_bf16 v[128:143], v[112:115], a[92:95], v[128:143]
    ds_read_b128 v[96:99], v13 offset:0
    ds_read_b128 v[100:103], v13 offset:8192
    v_mfma_f32_32x32x16_bf16 v[144:159], v[116:119], a[92:95], v[144:159]
    ds_read_b128 v[104:107], v22 offset:0
    ds_read_b128 v[108:111], v22 offset:8192
    s_add_u32 m0, s18, 6144
    v_mfma_f32_32x32x16_bf16 v[160:175], v[120:123], a[92:95], v[160:175]
    buffer_load_dwordx4 v9, s[8:11], s21 offen sc0 sc1 lds
    s_add_u32 m0, s18, 7168
    v_mfma_f32_32x32x16_bf16 v[184:199], v[124:127], a[92:95], v[184:199]
    buffer_load_dwordx4 v10, s[8:11], s21 offen sc0 sc1 lds
    s_waitcnt lgkmcnt(3)
    v_mfma_f32_32x32x16_bf16 v[128:143], v[96:99], a[96:99], v[128:143]
    ds_read_b128 v[112:115], v14 offset:0
    ds_read_b128 v[116:119], v14 offset:8192
    s_waitcnt lgkmcnt(4)
    v_mfma_f32_32x32x16_bf16 v[144:159], v[100:103], a[96:99], v[144:159]
    ds_read_b128 v[120:123], v23 offset:0
    ds_read_b128 v[124:127], v23 offset:8192
    s_bfe_u32 s17, s15, 0x40000
    s_lshl_b32 s17, s17, 8
    s_add_u32 s20, s16, s17
    s_add_u32 m0, s18, 32768
    s_waitcnt lgkmcnt(5)
    v_mfma_f32_32x32x16_bf16 v[160:175], v[104:107], a[96:99], v[160:175]
    buffer_load_dwordx4 v7, s[8:11], s20 offen sc0 sc1 lds
    s_add_u32 m0, s18, 33792
    s_waitcnt lgkmcnt(4)
    v_mfma_f32_32x32x16_bf16 v[184:199], v[108:111], a[96:99], v[184:199]
    buffer_load_dwordx4 v8, s[8:11], s20 offen sc0 sc1 lds
    s_waitcnt lgkmcnt(3)
    v_mfma_f32_32x32x16_bf16 v[128:143], v[112:115], a[100:103], v[128:143]
    ds_read_b128 v[96:99], v15 offset:0
    ds_read_b128 v[100:103], v15 offset:8192
    s_waitcnt lgkmcnt(4)
    v_mfma_f32_32x32x16_bf16 v[144:159], v[116:119], a[100:103], v[144:159]
    ds_read_b128 v[104:107], v24 offset:0
    ds_read_b128 v[108:111], v24 offset:8192
    s_add_u32 m0, s18, 34816
    s_waitcnt lgkmcnt(5)
    v_mfma_f32_32x32x16_bf16 v[160:175], v[120:123], a[100:103], v[160:175]
    buffer_load_dwordx4 v9, s[8:11], s20 offen sc0 sc1 lds
    s_add_u32 m0, s18, 35840
    s_waitcnt lgkmcnt(4)
    v_mfma_f32_32x32x16_bf16 v[184:199], v[124:127], a[100:103], v[184:199]
    buffer_load_dwordx4 v10, s[8:11], s20 offen sc0 sc1 lds
    s_waitcnt lgkmcnt(3)
    v_mfma_f32_32x32x16_bf16 v[128:143], v[96:99], a[104:107], v[128:143]
    ds_read_b128 v[112:115], v16 offset:0
    ds_read_b128 v[116:119], v16 offset:8192
    s_waitcnt lgkmcnt(4)
    v_mfma_f32_32x32x16_bf16 v[144:159], v[100:103], a[104:107], v[144:159]
    ds_read_b128 v[120:123], v25 offset:0
    ds_read_b128 v[124:127], v25 offset:8192
    s_add_u32 s21, s20, 65536
    s_add_u32 m0, s18, 36864
    s_waitcnt lgkmcnt(5)
    v_mfma_f32_32x32x16_bf16 v[160:175], v[104:107], a[104:107], v[160:175]
    buffer_load_dwordx4 v7, s[8:11], s21 offen sc0 sc1 lds
    s_add_u32 m0, s18, 37888
    s_waitcnt lgkmcnt(4)
    v_mfma_f32_32x32x16_bf16 v[184:199], v[108:111], a[104:107], v[184:199]
    buffer_load_dwordx4 v8, s[8:11], s21 offen sc0 sc1 lds
    s_waitcnt lgkmcnt(0)
    s_waitcnt vmcnt(19)
    s_barrier
    v_mfma_f32_32x32x16_bf16 v[128:143], v[112:115], a[108:111], v[128:143]
    ds_read_b128 v[96:99], v13 offset:32768
    ds_read_b128 v[100:103], v13 offset:40960
    v_mfma_f32_32x32x16_bf16 v[144:159], v[116:119], a[108:111], v[144:159]
    ds_read_b128 v[104:107], v22 offset:32768
    ds_read_b128 v[108:111], v22 offset:40960
    s_add_u32 m0, s18, 38912
    v_mfma_f32_32x32x16_bf16 v[160:175], v[120:123], a[108:111], v[160:175]
    buffer_load_dwordx4 v9, s[8:11], s21 offen sc0 sc1 lds
    s_add_u32 m0, s18, 39936
    v_mfma_f32_32x32x16_bf16 v[184:199], v[124:127], a[108:111], v[184:199]
    buffer_load_dwordx4 v10, s[8:11], s21 offen sc0 sc1 lds
    s_waitcnt lgkmcnt(3)
    v_mfma_f32_32x32x16_bf16 v[128:143], v[96:99], a[112:115], v[128:143]
    ds_read_b128 v[112:115], v14 offset:32768
    ds_read_b128 v[116:119], v14 offset:40960
    s_waitcnt vmcnt(14)
    ds_read_b128 v[46:49], v39 offset:0
    ds_read_b128 v[84:87], v39 offset:256
    s_waitcnt lgkmcnt(6)
    v_mfma_f32_32x32x16_bf16 v[144:159], v[100:103], a[112:115], v[144:159]
    ds_read_b128 v[120:123], v23 offset:32768
    ds_read_b128 v[124:127], v23 offset:40960
    s_bfe_u32 s17, s15, 0x40004
    s_lshl_b32 s17, s17, 8
    s_add_u32 s20, s16, s17
    s_add_u32 m0, s18, 65536
    s_waitcnt lgkmcnt(7)
    v_mfma_f32_32x32x16_bf16 v[160:175], v[104:107], a[112:115], v[160:175]
    buffer_load_dwordx4 v7, s[8:11], s20 offen sc0 sc1 lds
    ds_read_b128 v[54:57], v39 offset:32
    ds_read_b128 v[88:91], v39 offset:288
    ds_read_b128 v[58:61], v39 offset:64
    s_add_u32 m0, s18, 66560
    s_waitcnt lgkmcnt(9)
    v_mfma_f32_32x32x16_bf16 v[184:199], v[108:111], a[112:115], v[184:199]
    buffer_load_dwordx4 v8, s[8:11], s20 offen sc0 sc1 lds
    ds_read_b128 v[92:95], v39 offset:320
    ds_read_b128 v[62:65], v39 offset:96
    ds_read_b128 v[176:179], v39 offset:352
    ds_read_b128 v[66:69], v39 offset:128
    s_waitcnt lgkmcnt(12)
    v_mfma_f32_32x32x16_bf16 v[128:143], v[112:115], a[116:119], v[128:143]
    ds_read_b128 v[96:99], v15 offset:32768
    ds_read_b128 v[100:103], v15 offset:40960
    ds_read_b128 v[200:203], v39 offset:384
    ds_read_b128 v[70:73], v39 offset:160
    ds_read_b128 v[204:207], v39 offset:416
    s_waitcnt lgkmcnt(15)
    v_mfma_f32_32x32x16_bf16 v[144:159], v[116:119], a[116:119], v[144:159]
    ds_read_b128 v[104:107], v24 offset:32768
    ds_read_b128 v[108:111], v24 offset:40960
    ds_read_b128 v[74:77], v39 offset:192
    ds_read_b128 v[208:211], v39 offset:448
    s_add_u32 m0, s18, 67584
    s_waitcnt lgkmcnt(15)
    v_mfma_f32_32x32x16_bf16 v[160:175], v[120:123], a[116:119], v[160:175]
    buffer_load_dwordx4 v9, s[8:11], s20 offen sc0 sc1 lds
    ds_read_b128 v[78:81], v39 offset:224
    ds_read_b128 v[212:215], v39 offset:480
    buffer_load_dwordx2 v[30:31], v29, s[8:11], 0 offen sc0 sc1
    s_add_u32 m0, s18, 68608
    v_mfma_f32_32x32x16_bf16 v[184:199], v[124:127], a[116:119], v[184:199]
    buffer_load_dwordx4 v10, s[8:11], s20 offen sc0 sc1 lds
    s_waitcnt lgkmcnt(10)
    v_mfma_f32_32x32x16_bf16 v[128:143], v[96:99], a[120:123], v[128:143]
    ds_read_b128 v[112:115], v16 offset:32768
    ds_read_b128 v[116:119], v16 offset:40960
    s_waitcnt lgkmcnt(11)
    v_mfma_f32_32x32x16_bf16 v[144:159], v[100:103], a[120:123], v[144:159]
    ds_read_b128 v[120:123], v25 offset:32768
    ds_read_b128 v[124:127], v25 offset:40960
    s_add_u32 s21, s20, 65536
    s_add_u32 m0, s18, 69632
    s_waitcnt lgkmcnt(9)
    v_mfma_f32_32x32x16_bf16 v[160:175], v[104:107], a[120:123], v[160:175]
    buffer_load_dwordx4 v7, s[8:11], s21 offen sc0 sc1 lds
    s_add_u32 m0, s18, 70656
    s_waitcnt lgkmcnt(8)
    v_mfma_f32_32x32x16_bf16 v[184:199], v[108:111], a[120:123], v[184:199]
    buffer_load_dwordx4 v8, s[8:11], s21 offen sc0 sc1 lds
    s_waitcnt lgkmcnt(0)
    s_waitcnt vmcnt(15)
    s_barrier
    v_mfma_f32_32x32x16_bf16 v[128:143], v[112:115], a[124:127], v[128:143]
    ds_read_b128 v[96:99], v4 offset:0
    ds_read_b128 v[100:103], v4 offset:8192
    v_mfma_f32_32x32x16_bf16 v[144:159], v[116:119], a[124:127], v[144:159]
    ds_read_b128 v[104:107], v18 offset:0
    ds_read_b128 v[108:111], v18 offset:8192
    s_add_u32 m0, s18, 71680
    v_mfma_f32_32x32x16_bf16 v[160:175], v[120:123], a[124:127], v[160:175]
    buffer_load_dwordx4 v9, s[8:11], s21 offen sc0 sc1 lds
    s_add_u32 m0, s18, 72704
    v_mfma_f32_32x32x16_bf16 v[184:199], v[124:127], a[124:127], v[184:199]
    buffer_load_dwordx4 v10, s[8:11], s21 offen sc0 sc1 lds
    s_waitcnt lgkmcnt(3)
    v_mfma_f32_32x32x16_bf16 v[128:143], v[96:99], a[128:131], v[128:143]
    ds_read_b128 v[112:115], v5 offset:0
    ds_read_b128 v[116:119], v5 offset:8192
    s_waitcnt lgkmcnt(4)
    v_mfma_f32_32x32x16_bf16 v[144:159], v[100:103], a[128:131], v[144:159]
    ds_read_b128 v[120:123], v19 offset:0
    ds_read_b128 v[124:127], v19 offset:8192
    s_bfe_u32 s17, s15, 0x40008
    s_lshl_b32 s17, s17, 8
    s_add_u32 s20, s16, s17
    s_add_u32 m0, s18, 98304
    s_waitcnt lgkmcnt(5)
    v_mfma_f32_32x32x16_bf16 v[160:175], v[104:107], a[128:131], v[160:175]
    buffer_load_dwordx4 v7, s[8:11], s20 offen sc0 sc1 lds
    s_add_u32 m0, s18, 99328
    s_waitcnt lgkmcnt(4)
    v_mfma_f32_32x32x16_bf16 v[184:199], v[108:111], a[128:131], v[184:199]
    buffer_load_dwordx4 v8, s[8:11], s20 offen sc0 sc1 lds
    s_waitcnt lgkmcnt(3)
    v_mfma_f32_32x32x16_bf16 v[128:143], v[112:115], a[132:135], v[128:143]
    ds_read_b128 v[96:99], v11 offset:0
    ds_read_b128 v[100:103], v11 offset:8192
    s_waitcnt lgkmcnt(4)
    v_mfma_f32_32x32x16_bf16 v[144:159], v[116:119], a[132:135], v[144:159]
    ds_read_b128 v[104:107], v20 offset:0
    ds_read_b128 v[108:111], v20 offset:8192
    s_add_u32 m0, s18, 100352
    s_waitcnt lgkmcnt(5)
    v_mfma_f32_32x32x16_bf16 v[160:175], v[120:123], a[132:135], v[160:175]
    buffer_load_dwordx4 v9, s[8:11], s20 offen sc0 sc1 lds
    s_add_u32 m0, s18, 101376
    s_waitcnt lgkmcnt(4)
    v_mfma_f32_32x32x16_bf16 v[184:199], v[124:127], a[132:135], v[184:199]
    buffer_load_dwordx4 v10, s[8:11], s20 offen sc0 sc1 lds
    s_waitcnt lgkmcnt(3)
    v_mfma_f32_32x32x16_bf16 v[128:143], v[96:99], a[136:139], v[128:143]
    ds_read_b128 v[112:115], v12 offset:0
    ds_read_b128 v[116:119], v12 offset:8192
    s_waitcnt lgkmcnt(4)
    v_mfma_f32_32x32x16_bf16 v[144:159], v[100:103], a[136:139], v[144:159]
    ds_read_b128 v[120:123], v21 offset:0
    ds_read_b128 v[124:127], v21 offset:8192
    s_add_u32 s21, s20, 65536
    s_add_u32 m0, s18, 102400
    s_waitcnt lgkmcnt(5)
    v_mfma_f32_32x32x16_bf16 v[160:175], v[104:107], a[136:139], v[160:175]
    buffer_load_dwordx4 v7, s[8:11], s21 offen sc0 sc1 lds
    s_add_u32 m0, s18, 103424
    s_waitcnt lgkmcnt(4)
    v_mfma_f32_32x32x16_bf16 v[184:199], v[108:111], a[136:139], v[184:199]
    buffer_load_dwordx4 v8, s[8:11], s21 offen sc0 sc1 lds
    s_waitcnt lgkmcnt(0)
    s_waitcnt vmcnt(15)
    s_barrier
    v_mfma_f32_32x32x16_bf16 v[128:143], v[112:115], a[140:143], v[128:143]
    ds_read_b128 v[96:99], v4 offset:32768
    ds_read_b128 v[100:103], v4 offset:40960
    v_mfma_f32_32x32x16_bf16 v[144:159], v[116:119], a[140:143], v[144:159]
    ds_read_b128 v[104:107], v18 offset:32768
    ds_read_b128 v[108:111], v18 offset:40960
    s_add_u32 m0, s18, 104448
    v_mfma_f32_32x32x16_bf16 v[160:175], v[120:123], a[140:143], v[160:175]
    buffer_load_dwordx4 v9, s[8:11], s21 offen sc0 sc1 lds
    s_add_u32 m0, s18, 105472
    v_mfma_f32_32x32x16_bf16 v[184:199], v[124:127], a[140:143], v[184:199]
    buffer_load_dwordx4 v10, s[8:11], s21 offen sc0 sc1 lds
    s_waitcnt lgkmcnt(3)
    v_mfma_f32_32x32x16_bf16 v[128:143], v[96:99], a[144:147], v[128:143]
    ds_read_b128 v[112:115], v5 offset:32768
    ds_read_b128 v[116:119], v5 offset:40960
    s_mov_b32 s4, 0
    s_waitcnt vmcnt(13)
    v_cmp_ne_u64 vcc, s[42:43], v[30:31]
    s_nop 4
    s_cbranch_vccz Lfdone_gate_13
Lfpoll_gate_14:
    buffer_load_dwordx2 v[30:31], v29, s[8:11], 0 offen sc0 sc1
    s_waitcnt vmcnt(0)
    v_cmp_ne_u64 vcc, s[42:43], v[30:31]
    s_nop 4
    s_add_u32 s4, s4, 1
    s_cmp_gt_u32 s4, 20000
    s_cbranch_scc1 Lfdone_gate_13
    s_cbranch_vccnz Lfpoll_gate_14
Lfdone_gate_13:
    s_add_u32 m0, s47, 147456
    s_nop 0
    buffer_load_dwordx4 v7, s[8:11], s38 offen sc0 sc1 lds
    s_add_u32 m0, s47, 148480
    s_nop 0
    buffer_load_dwordx4 v8, s[8:11], s38 offen sc0 sc1 lds
    s_waitcnt lgkmcnt(4)
    v_mfma_f32_32x32x16_bf16 v[144:159], v[100:103], a[144:147], v[144:159]
    ds_read_b128 v[120:123], v19 offset:32768
    ds_read_b128 v[124:127], v19 offset:40960
    s_bfe_u32 s17, s15, 0x4000c
    s_lshl_b32 s17, s17, 8
    s_add_u32 s20, s16, s17
    s_add_u32 m0, s18, 0
    s_waitcnt lgkmcnt(5)
    v_mfma_f32_32x32x16_bf16 v[160:175], v[104:107], a[144:147], v[160:175]
    buffer_load_dwordx4 v7, s[8:11], s20 offen sc0 sc1 lds
    s_add_u32 m0, s47, 149504
    s_nop 0
    buffer_load_dwordx4 v9, s[8:11], s38 offen sc0 sc1 lds
    s_add_u32 m0, s47, 150528
    s_nop 0
    buffer_load_dwordx4 v10, s[8:11], s38 offen sc0 sc1 lds
    s_add_u32 m0, s18, 1024
    s_waitcnt lgkmcnt(4)
    v_mfma_f32_32x32x16_bf16 v[184:199], v[108:111], a[144:147], v[184:199]
    buffer_load_dwordx4 v8, s[8:11], s20 offen sc0 sc1 lds
    s_waitcnt lgkmcnt(3)
    v_mfma_f32_32x32x16_bf16 v[128:143], v[112:115], a[148:151], v[128:143]
    ds_read_b128 v[96:99], v11 offset:32768
    ds_read_b128 v[100:103], v11 offset:40960
    s_waitcnt lgkmcnt(4)
    v_mfma_f32_32x32x16_bf16 v[144:159], v[116:119], a[148:151], v[144:159]
    ds_read_b128 v[104:107], v20 offset:32768
    ds_read_b128 v[108:111], v20 offset:40960
    s_add_u32 m0, s18, 2048
    s_waitcnt lgkmcnt(5)
    v_mfma_f32_32x32x16_bf16 v[160:175], v[120:123], a[148:151], v[160:175]
    buffer_load_dwordx4 v9, s[8:11], s20 offen sc0 sc1 lds
    s_add_u32 m0, s18, 3072
    s_waitcnt lgkmcnt(4)
    v_mfma_f32_32x32x16_bf16 v[184:199], v[124:127], a[148:151], v[184:199]
    buffer_load_dwordx4 v10, s[8:11], s20 offen sc0 sc1 lds
    s_waitcnt lgkmcnt(3)
    v_mfma_f32_32x32x16_bf16 v[128:143], v[96:99], a[152:155], v[128:143]
    ds_read_b128 v[112:115], v12 offset:32768
    ds_read_b128 v[116:119], v12 offset:40960
    s_waitcnt lgkmcnt(4)
    v_mfma_f32_32x32x16_bf16 v[144:159], v[100:103], a[152:155], v[144:159]
    ds_read_b128 v[120:123], v21 offset:32768
    ds_read_b128 v[124:127], v21 offset:40960
    s_add_u32 s21, s20, 65536
    s_add_u32 m0, s18, 4096
    s_waitcnt lgkmcnt(5)
    v_mfma_f32_32x32x16_bf16 v[160:175], v[104:107], a[152:155], v[160:175]
    buffer_load_dwordx4 v7, s[8:11], s21 offen sc0 sc1 lds
    s_add_u32 m0, s18, 5120
    s_waitcnt lgkmcnt(4)
    v_mfma_f32_32x32x16_bf16 v[184:199], v[108:111], a[152:155], v[184:199]
    buffer_load_dwordx4 v8, s[8:11], s21 offen sc0 sc1 lds
    s_waitcnt lgkmcnt(0)
    s_waitcnt vmcnt(18)
    s_barrier
    v_mfma_f32_32x32x16_bf16 v[128:143], v[112:115], a[156:159], v[128:143]
    ds_read_b128 v[96:99], v13 offset:0
    ds_read_b128 v[100:103], v13 offset:8192
    v_mfma_f32_32x32x16_bf16 v[144:159], v[116:119], a[156:159], v[144:159]
    ds_read_b128 v[104:107], v22 offset:0
    ds_read_b128 v[108:111], v22 offset:8192
    s_add_u32 m0, s18, 6144
    v_mfma_f32_32x32x16_bf16 v[160:175], v[120:123], a[156:159], v[160:175]
    buffer_load_dwordx4 v9, s[8:11], s21 offen sc0 sc1 lds
    s_add_u32 m0, s18, 7168
    v_mfma_f32_32x32x16_bf16 v[184:199], v[124:127], a[156:159], v[184:199]
    buffer_load_dwordx4 v10, s[8:11], s21 offen sc0 sc1 lds
    s_waitcnt lgkmcnt(3)
    v_mfma_f32_32x32x16_bf16 v[128:143], v[96:99], a[160:163], v[128:143]
    ds_read_b128 v[112:115], v14 offset:0
    ds_read_b128 v[116:119], v14 offset:8192
    s_waitcnt lgkmcnt(4)
    v_mfma_f32_32x32x16_bf16 v[144:159], v[100:103], a[160:163], v[144:159]
    ds_read_b128 v[120:123], v23 offset:0
    ds_read_b128 v[124:127], v23 offset:8192
    s_bfe_u32 s17, s15, 0x40010
    s_lshl_b32 s17, s17, 8
    s_add_u32 s20, s16, s17
    s_add_u32 m0, s18, 32768
    s_waitcnt lgkmcnt(5)
    v_mfma_f32_32x32x16_bf16 v[160:175], v[104:107], a[160:163], v[160:175]
    buffer_load_dwordx4 v7, s[8:11], s20 offen sc0 sc1 lds
    s_add_u32 m0, s18, 33792
    s_waitcnt lgkmcnt(4)
    v_mfma_f32_32x32x16_bf16 v[184:199], v[108:111], a[160:163], v[184:199]
    buffer_load_dwordx4 v8, s[8:11], s20 offen sc0 sc1 lds
    s_waitcnt lgkmcnt(3)
    v_mfma_f32_32x32x16_bf16 v[128:143], v[112:115], a[164:167], v[128:143]
    ds_read_b128 v[96:99], v15 offset:0
    ds_read_b128 v[100:103], v15 offset:8192
    s_waitcnt lgkmcnt(4)
    v_mfma_f32_32x32x16_bf16 v[144:159], v[116:119], a[164:167], v[144:159]
    ds_read_b128 v[104:107], v24 offset:0
    ds_read_b128 v[108:111], v24 offset:8192
    s_add_u32 m0, s18, 34816
    s_waitcnt lgkmcnt(5)
    v_mfma_f32_32x32x16_bf16 v[160:175], v[120:123], a[164:167], v[160:175]
    buffer_load_dwordx4 v9, s[8:11], s20 offen sc0 sc1 lds
    s_add_u32 m0, s18, 35840
    s_waitcnt lgkmcnt(4)
    v_mfma_f32_32x32x16_bf16 v[184:199], v[124:127], a[164:167], v[184:199]
    buffer_load_dwordx4 v10, s[8:11], s20 offen sc0 sc1 lds
    s_waitcnt lgkmcnt(3)
    v_mfma_f32_32x32x16_bf16 v[128:143], v[96:99], a[168:171], v[128:143]
    ds_read_b128 v[112:115], v16 offset:0
    ds_read_b128 v[116:119], v16 offset:8192
    s_waitcnt lgkmcnt(4)
    v_mfma_f32_32x32x16_bf16 v[144:159], v[100:103], a[168:171], v[144:159]
    ds_read_b128 v[120:123], v25 offset:0
    ds_read_b128 v[124:127], v25 offset:8192
    s_add_u32 s21, s20, 65536
    s_add_u32 m0, s18, 36864
    s_waitcnt lgkmcnt(5)
    v_mfma_f32_32x32x16_bf16 v[160:175], v[104:107], a[168:171], v[160:175]
    buffer_load_dwordx4 v7, s[8:11], s21 offen sc0 sc1 lds
    s_add_u32 m0, s18, 37888
    s_waitcnt lgkmcnt(4)
    v_mfma_f32_32x32x16_bf16 v[184:199], v[108:111], a[168:171], v[184:199]
    buffer_load_dwordx4 v8, s[8:11], s21 offen sc0 sc1 lds
    s_waitcnt lgkmcnt(0)
    s_waitcnt vmcnt(18)
    s_barrier
    v_mfma_f32_32x32x16_bf16 v[128:143], v[112:115], a[172:175], v[128:143]
    ds_read_b128 v[96:99], v13 offset:32768
    ds_read_b128 v[100:103], v13 offset:40960
    v_mfma_f32_32x32x16_bf16 v[144:159], v[116:119], a[172:175], v[144:159]
    ds_read_b128 v[104:107], v22 offset:32768
    ds_read_b128 v[108:111], v22 offset:40960
    s_add_u32 m0, s18, 38912
    v_mfma_f32_32x32x16_bf16 v[160:175], v[120:123], a[172:175], v[160:175]
    buffer_load_dwordx4 v9, s[8:11], s21 offen sc0 sc1 lds
    s_add_u32 m0, s18, 39936
    v_mfma_f32_32x32x16_bf16 v[184:199], v[124:127], a[172:175], v[184:199]
    buffer_load_dwordx4 v10, s[8:11], s21 offen sc0 sc1 lds
    s_waitcnt lgkmcnt(3)
    v_mfma_f32_32x32x16_bf16 v[128:143], v[96:99], a[176:179], v[128:143]
    ds_read_b128 v[112:115], v14 offset:32768
    ds_read_b128 v[116:119], v14 offset:40960
    s_waitcnt lgkmcnt(4)
    v_mfma_f32_32x32x16_bf16 v[144:159], v[100:103], a[176:179], v[144:159]
    ds_read_b128 v[120:123], v23 offset:32768
    ds_read_b128 v[124:127], v23 offset:40960
    s_bfe_u32 s17, s15, 0x40014
    s_lshl_b32 s17, s17, 8
    s_add_u32 s20, s16, s17
    s_add_u32 m0, s18, 65536
    s_waitcnt lgkmcnt(5)
    v_mfma_f32_32x32x16_bf16 v[160:175], v[104:107], a[176:179], v[160:175]
    buffer_load_dwordx4 v7, s[8:11], s20 offen sc0 sc1 lds
    s_add_u32 m0, s18, 66560
    s_waitcnt lgkmcnt(4)
    v_mfma_f32_32x32x16_bf16 v[184:199], v[108:111], a[176:179], v[184:199]
    buffer_load_dwordx4 v8, s[8:11], s20 offen sc0 sc1 lds
    s_waitcnt lgkmcnt(3)
    v_mfma_f32_32x32x16_bf16 v[128:143], v[112:115], a[180:183], v[128:143]
    ds_read_b128 v[96:99], v15 offset:32768
    ds_read_b128 v[100:103], v15 offset:40960
    s_waitcnt lgkmcnt(4)
    v_mfma_f32_32x32x16_bf16 v[144:159], v[116:119], a[180:183], v[144:159]
    ds_read_b128 v[104:107], v24 offset:32768
    ds_read_b128 v[108:111], v24 offset:40960
    s_add_u32 m0, s18, 67584
    s_waitcnt lgkmcnt(5)
    v_mfma_f32_32x32x16_bf16 v[160:175], v[120:123], a[180:183], v[160:175]
    buffer_load_dwordx4 v9, s[8:11], s20 offen sc0 sc1 lds
    s_add_u32 m0, s18, 68608
    s_waitcnt lgkmcnt(4)
    v_mfma_f32_32x32x16_bf16 v[184:199], v[124:127], a[180:183], v[184:199]
    buffer_load_dwordx4 v10, s[8:11], s20 offen sc0 sc1 lds
    s_waitcnt lgkmcnt(3)
    v_mfma_f32_32x32x16_bf16 v[128:143], v[96:99], a[184:187], v[128:143]
    ds_read_b128 v[112:115], v16 offset:32768
    ds_read_b128 v[116:119], v16 offset:40960
    s_waitcnt lgkmcnt(4)
    v_mfma_f32_32x32x16_bf16 v[144:159], v[100:103], a[184:187], v[144:159]
    ds_read_b128 v[120:123], v25 offset:32768
    ds_read_b128 v[124:127], v25 offset:40960
    s_add_u32 s21, s20, 65536
    s_add_u32 m0, s18, 69632
    s_waitcnt lgkmcnt(5)
    v_mfma_f32_32x32x16_bf16 v[160:175], v[104:107], a[184:187], v[160:175]
    buffer_load_dwordx4 v7, s[8:11], s21 offen sc0 sc1 lds
    s_add_u32 m0, s18, 70656
    s_waitcnt lgkmcnt(4)
    v_mfma_f32_32x32x16_bf16 v[184:199], v[108:111], a[184:187], v[184:199]
    buffer_load_dwordx4 v8, s[8:11], s21 offen sc0 sc1 lds
    s_waitcnt lgkmcnt(0)
    s_waitcnt vmcnt(14)
    s_barrier
    v_mfma_f32_32x32x16_bf16 v[128:143], v[112:115], a[188:191], v[128:143]
    ds_read_b128 v[96:99], v4 offset:0
    ds_read_b128 v[100:103], v4 offset:8192
    v_mfma_f32_32x32x16_bf16 v[144:159], v[116:119], a[188:191], v[144:159]
    ds_read_b128 v[104:107], v18 offset:0
    ds_read_b128 v[108:111], v18 offset:8192
    s_add_u32 m0, s18, 71680
    v_mfma_f32_32x32x16_bf16 v[160:175], v[120:123], a[188:191], v[160:175]
    buffer_load_dwordx4 v9, s[8:11], s21 offen sc0 sc1 lds
    s_add_u32 m0, s18, 72704
    v_mfma_f32_32x32x16_bf16 v[184:199], v[124:127], a[188:191], v[184:199]
    buffer_load_dwordx4 v10, s[8:11], s21 offen sc0 sc1 lds
    s_waitcnt lgkmcnt(3)
    v_mfma_f32_32x32x16_bf16 v[128:143], v[96:99], a[192:195], v[128:143]
    ds_read_b128 v[112:115], v5 offset:0
    ds_read_b128 v[116:119], v5 offset:8192
    v_lshlrev_b32 v52, 16, v52
    ds_read_b64_tr_b16 v[26:27], v36 offset:0
    v_xor_b32 v1, 0, v37
    s_waitcnt lgkmcnt(5)
    v_mfma_f32_32x32x16_bf16 v[144:159], v[100:103], a[192:195], v[144:159]
    ds_read_b128 v[120:123], v19 offset:0
    ds_read_b128 v[124:127], v19 offset:8192
    s_bfe_u32 s17, s15, 0x40018
    s_lshl_b32 s17, s17, 8
    s_add_u32 s20, s16, s17
    s_add_u32 m0, s18, 98304
    s_waitcnt lgkmcnt(6)
    v_mfma_f32_32x32x16_bf16 v[160:175], v[104:107], a[192:195], v[160:175]
    buffer_load_dwordx4 v7, s[8:11], s20 offen sc0 sc1 lds
    ds_read_b64 v[50:51], v1
    s_waitcnt lgkmcnt(0)
    v_lshlrev_b32 v216, 16, v50
    v_lshlrev_b32 v220, 16, v26
    s_add_u32 m0, s18, 99328
    v_mfma_f32_32x32x16_bf16 v[184:199], v[108:111], a[192:195], v[184:199]
    buffer_load_dwordx4 v8, s[8:11], s20 offen sc0 sc1 lds
    v_and_b32 v217, s5, v50
    v_and_b32 v221, s5, v26
    v_lshlrev_b32 v218, 16, v51
    v_lshlrev_b32 v222, 16, v27
    v_mfma_f32_32x32x16_bf16 v[128:143], v[112:115], a[196:199], v[128:143]
    ds_read_b128 v[96:99], v11 offset:0
    ds_read_b128 v[100:103], v11 offset:8192
    v_and_b32 v219, s5, v51
    v_and_b32 v223, s5, v27
    ds_read_b64_tr_b16 v[32:33], v36 offset:1024
    v_mfma_f32_32x32x16_bf16 v[144:159], v[116:119], a[196:199], v[144:159]
    ds_read_b128 v[104:107], v20 offset:0
    ds_read_b128 v[108:111], v20 offset:8192
    v_xor_b32 v1, 16, v37
    ds_read_b64 v[180:181], v1
    s_add_u32 m0, s18, 100352
    v_mfma_f32_32x32x16_bf16 v[160:175], v[120:123], a[196:199], v[160:175]
    buffer_load_dwordx4 v9, s[8:11], s20 offen sc0 sc1 lds
    v_mul_f32 v84, v84, v216
    v_mul_f32 v85, v85, v217
    v_mul_f32 v86, v86, v218
    s_add_u32 m0, s18, 101376
    v_mfma_f32_32x32x16_bf16 v[184:199], v[124:127], a[196:199], v[184:199]
    buffer_load_dwordx4 v10, s[8:11], s20 offen sc0 sc1 lds
    v_mul_f32 v87, v87, v219
    v_fmac_f32 v84, v46, v52
    v_fmac_f32 v85, v47, v52
    v_fmac_f32 v86, v48, v52
    s_waitcnt lgkmcnt(5)
    v_mfma_f32_32x32x16_bf16 v[128:143], v[96:99], a[200:203], v[128:143]
    ds_read_b128 v[112:115], v12 offset:0
    ds_read_b128 v[116:119], v12 offset:8192
    v_fmac_f32 v87, v49, v52
    v_mul_f32 v84, v84, v220
    v_mul_f32 v85, v85, v221
    s_waitcnt lgkmcnt(6)
    v_mfma_f32_32x32x16_bf16 v[144:159], v[100:103], a[200:203], v[144:159]
    ds_read_b128 v[120:123], v21 offset:0
    ds_read_b128 v[124:127], v21 offset:8192
    v_mul_f32 v86, v86, v222
    s_add_u32 s21, s20, 65536
    s_add_u32 m0, s18, 102400
    s_waitcnt lgkmcnt(6)
    v_mfma_f32_32x32x16_bf16 v[160:175], v[104:107], a[200:203], v[160:175]
    buffer_load_dwordx4 v7, s[8:11], s21 offen sc0 sc1 lds
    v_mul_f32 v87, v87, v223
    s_waitcnt lgkmcnt(4)
    v_lshlrev_b32 v216, 16, v180
    v_lshlrev_b32 v220, 16, v32
    s_add_u32 m0, s18, 103424
    v_mfma_f32_32x32x16_bf16 v[184:199], v[108:111], a[200:203], v[184:199]
    buffer_load_dwordx4 v8, s[8:11], s21 offen sc0 sc1 lds
    v_and_b32 v217, s5, v180
    v_and_b32 v221, s5, v32
    v_lshlrev_b32 v218, 16, v181
    v_lshlrev_b32 v222, 16, v33
    s_waitcnt lgkmcnt(0)
    s_waitcnt vmcnt(14)
    s_barrier
    v_mfma_f32_32x32x16_bf16 v[128:143], v[112:115], a[204:207], v[128:143]
    ds_read_b128 v[96:99], v4 offset:32768
    ds_read_b128 v[100:103], v4 offset:40960
    v_and_b32 v219, s5, v181
    v_and_b32 v223, s5, v33
    ds_read_b64_tr_b16 v[26:27], v36 offset:2048
    v_mfma_f32_32x32x16_bf16 v[144:159], v[116:119], a[204:207], v[144:159]
    ds_read_b128 v[104:107], v18 offset:32768
    ds_read_b128 v[108:111], v18 offset:40960
    v_xor_b32 v1, 32, v37
    ds_read_b64 v[50:51], v1
    s_add_u32 m0, s18, 104448
    v_mfma_f32_32x32x16_bf16 v[160:175], v[120:123], a[204:207], v[160:175]
    buffer_load_dwordx4 v9, s[8:11], s21 offen sc0 sc1 lds
    v_mul_f32 v88, v88, v216
    v_mul_f32 v89, v89, v217
    v_mul_f32 v90, v90, v218
    s_add_u32 m0, s18, 105472
    v_mfma_f32_32x32x16_bf16 v[184:199], v[124:127], a[204:207], v[184:199]
    buffer_load_dwordx4 v10, s[8:11], s21 offen sc0 sc1 lds
    v_mul_f32 v91, v91, v219
    v_fmac_f32 v88, v54, v52
    v_fmac_f32 v89, v55, v52
    v_fmac_f32 v90, v56, v52
    s_waitcnt lgkmcnt(5)
    v_mfma_f32_32x32x16_bf16 v[128:143], v[96:99], a[208:211], v[128:143]
    ds_read_b128 v[112:115], v5 offset:32768
    ds_read_b128 v[116:119], v5 offset:40960
    v_fmac_f32 v91, v57, v52
    v_mul_f32 v88, v88, v220
    v_mul_f32 v89, v89, v221
    s_waitcnt lgkmcnt(6)
    v_mfma_f32_32x32x16_bf16 v[144:159], v[100:103], a[208:211], v[144:159]
    ds_read_b128 v[120:123], v19 offset:32768
    ds_read_b128 v[124:127], v19 offset:40960
    v_mul_f32 v90, v90, v222
    v_mul_f32 v91, v91, v223
    s_waitcnt lgkmcnt(4)
    v_lshlrev_b32 v216, 16, v50
    v_mfma_f32_32x32x16_bf16 v[160:175], v[104:107], a[208:211], v[160:175]
    v_lshlrev_b32 v220, 16, v26
    v_and_b32 v217, s5, v50
    v_and_b32 v221, s5, v26
    v_lshlrev_b32 v218, 16, v51
    v_lshlrev_b32 v222, 16, v27
    v_mfma_f32_32x32x16_bf16 v[184:199], v[108:111], a[208:211], v[184:199]
    v_and_b32 v219, s5, v51
    v_and_b32 v223, s5, v27
    ds_read_b64_tr_b16 v[32:33], v36 offset:3072
    v_xor_b32 v1, 48, v37
    ds_read_b64 v[180:181], v1
    s_waitcnt lgkmcnt(5)
    v_mfma_f32_32x32x16_bf16 v[128:143], v[112:115], a[212:215], v[128:143]
    ds_read_b128 v[96:99], v11 offset:32768
    ds_read_b128 v[100:103], v11 offset:40960
    v_mul_f32 v92, v92, v216
    v_mul_f32 v93, v93, v217
    v_mul_f32 v94, v94, v218
    s_waitcnt lgkmcnt(6)
    v_mfma_f32_32x32x16_bf16 v[144:159], v[116:119], a[212:215], v[144:159]
    ds_read_b128 v[104:107], v20 offset:32768
    ds_read_b128 v[108:111], v20 offset:40960
    v_mul_f32 v95, v95, v219
    v_fmac_f32 v92, v58, v52
    v_fmac_f32 v93, v59, v52
    s_waitcnt lgkmcnt(7)
    v_mfma_f32_32x32x16_bf16 v[160:175], v[120:123], a[212:215], v[160:175]
    v_fmac_f32 v94, v60, v52
    v_fmac_f32 v95, v61, v52
    v_mul_f32 v92, v92, v220
    v_mul_f32 v93, v93, v221
    v_mul_f32 v94, v94, v222
    s_waitcnt lgkmcnt(6)
    v_mfma_f32_32x32x16_bf16 v[184:199], v[124:127], a[212:215], v[184:199]
    v_mul_f32 v95, v95, v223
    s_waitcnt lgkmcnt(4)
    v_lshlrev_b32 v216, 16, v180
    v_lshlrev_b32 v220, 16, v32
    v_and_b32 v217, s5, v180
    v_and_b32 v221, s5, v32
    s_waitcnt lgkmcnt(3)
    v_mfma_f32_32x32x16_bf16 v[128:143], v[96:99], a[216:219], v[128:143]
    ds_read_b128 v[112:115], v12 offset:32768
    ds_read_b128 v[116:119], v12 offset:40960
    v_lshlrev_b32 v218, 16, v181
    v_lshlrev_b32 v222, 16, v33
    v_and_b32 v219, s5, v181
    s_waitcnt lgkmcnt(4)
    v_mfma_f32_32x32x16_bf16 v[144:159], v[100:103], a[216:219], v[144:159]
    ds_read_b128 v[120:123], v21 offset:32768
    ds_read_b128 v[124:127], v21 offset:40960
    v_and_b32 v223, s5, v33
    ds_read_b64_tr_b16 v[26:27], v36 offset:4096
    v_xor_b32 v1, 64, v37
    s_waitcnt lgkmcnt(6)
    v_mfma_f32_32x32x16_bf16 v[160:175], v[104:107], a[216:219], v[160:175]
    ds_read_b64 v[50:51], v1
    v_mul_f32 v176, v176, v216
    v_mul_f32 v177, v177, v217
    v_mul_f32 v178, v178, v218
    v_mul_f32 v179, v179, v219
    s_waitcnt lgkmcnt(6)
    v_mfma_f32_32x32x16_bf16 v[184:199], v[108:111], a[216:219], v[184:199]
    v_fmac_f32 v176, v62, v52
    v_fmac_f32 v177, v63, v52
    v_fmac_f32 v178, v64, v52
    v_fmac_f32 v179, v65, v52
    v_mul_f32 v176, v176, v220
    s_waitcnt lgkmcnt(2)
    s_waitcnt vmcnt(8)
    s_waitcnt vmcnt(0)
    s_barrier
    v_mfma_f32_32x32x16_bf16 v[128:143], v[112:115], a[220:223], v[128:143]
    ds_read_b128 v[96:99], v22 offset:0
    ds_read_b128 v[100:103], v23 offset:0
    v_mul_f32 v177, v177, v221
    v_mul_f32 v178, v178, v222
    v_mul_f32 v179, v179, v223
    v_mfma_f32_32x32x16_bf16 v[144:159], v[116:119], a[220:223], v[144:159]
    ds_read_b128 v[104:107], v24 offset:0
    ds_read_b128 v[108:111], v25 offset:0
    s_waitcnt lgkmcnt(4)
    v_lshlrev_b32 v216, 16, v50
    v_lshlrev_b32 v220, 16, v26
    v_and_b32 v217, s5, v50
    v_mfma_f32_32x32x16_bf16 v[160:175], v[120:123], a[220:223], v[160:175]
    v_and_b32 v221, s5, v26
    v_lshlrev_b32 v218, 16, v51
    v_lshlrev_b32 v222, 16, v27
    v_and_b32 v219, s5, v51
    v_and_b32 v223, s5, v27
    v_mfma_f32_32x32x16_bf16 v[184:199], v[124:127], a[220:223], v[184:199]
    ds_read_b64_tr_b16 v[32:33], v36 offset:5120
    v_xor_b32 v1, 80, v37
    ds_read_b64 v[180:181], v1
    v_mul_f32 v200, v200, v216
    v_mul_f32 v201, v201, v217
    s_waitcnt lgkmcnt(5)
    v_mfma_f32_32x32x16_bf16 v[160:175], v[96:99], a[224:227], v[160:175]
    ds_read_b128 v[112:115], v22 offset:32768
    ds_read_b128 v[116:119], v23 offset:32768
    v_mul_f32 v202, v202, v218
    v_mul_f32 v203, v203, v219
    v_fmac_f32 v200, v66, v52
    s_waitcnt lgkmcnt(6)
    v_mfma_f32_32x32x16_bf16 v[160:175], v[100:103], a[228:231], v[160:175]
    ds_read_b128 v[120:123], v24 offset:32768
    ds_read_b128 v[124:127], v25 offset:32768
    v_fmac_f32 v201, v67, v52
    v_fmac_f32 v202, v68, v52
    v_fmac_f32 v203, v69, v52
    s_waitcnt lgkmcnt(7)
    v_mfma_f32_32x32x16_bf16 v[160:175], v[104:107], a[232:235], v[160:175]
    v_mul_f32 v200, v200, v220
    v_mul_f32 v201, v201, v221
    v_mul_f32 v202, v202, v222
    v_mul_f32 v203, v203, v223
    s_waitcnt lgkmcnt(4)
    v_lshlrev_b32 v216, 16, v180
    v_mfma_f32_32x32x16_bf16 v[160:175], v[108:111], a[236:239], v[160:175]
    v_lshlrev_b32 v220, 16, v32
    v_and_b32 v217, s5, v180
    v_and_b32 v221, s5, v32
    v_lshlrev_b32 v218, 16, v181
    v_lshlrev_b32 v222, 16, v33
    s_waitcnt lgkmcnt(3)
    v_mfma_f32_32x32x16_bf16 v[160:175], v[112:115], a[240:243], v[160:175]
    ds_read_b128 v[96:99], v13 offset:0
    ds_read_b128 v[100:103], v14 offset:0
    v_and_b32 v219, s5, v181
    v_and_b32 v223, s5, v33
    ds_read_b64_tr_b16 v[26:27], v36 offset:6144
    s_waitcnt lgkmcnt(5)
    v_mfma_f32_32x32x16_bf16 v[160:175], v[116:119], a[244:247], v[160:175]
    ds_read_b128 v[104:107], v15 offset:0
    ds_read_b128 v[108:111], v16 offset:0
    v_xor_b32 v1, 96, v37
    ds_read_b64 v[50:51], v1
    v_mul_f32 v204, v204, v216
    s_waitcnt lgkmcnt(7)
    v_mfma_f32_32x32x16_bf16 v[160:175], v[120:123], a[248:251], v[160:175]
    v_mul_f32 v205, v205, v217
    v_mul_f32 v206, v206, v218
    v_mul_f32 v207, v207, v219
    v_fmac_f32 v204, v70, v52
    v_fmac_f32 v205, v71, v52
    s_waitcnt lgkmcnt(6)
    v_mfma_f32_32x32x16_bf16 v[160:175], v[124:127], a[252:255], v[160:175]
    v_fmac_f32 v206, v72, v52
    v_fmac_f32 v207, v73, v52
    v_mul_f32 v204, v204, v220
    v_mul_f32 v205, v205, v221
    v_mul_f32 v206, v206, v222
    s_waitcnt lgkmcnt(5)
    v_mfma_f32_32x32x16_bf16 v[128:143], v[96:99], a[224:227], v[128:143]
    ds_read_b128 v[112:115], v13 offset:32768
    ds_read_b128 v[116:119], v14 offset:32768
    v_mul_f32 v207, v207, v223
    s_waitcnt lgkmcnt(2)
    v_lshlrev_b32 v216, 16, v50
    v_lshlrev_b32 v220, 16, v26
    v_mfma_f32_32x32x16_bf16 v[128:143], v[100:103], a[228:231], v[128:143]
    ds_read_b128 v[120:123], v15 offset:32768
    ds_read_b128 v[124:127], v16 offset:32768
    ds_write_b128 v44, v[160:163] offset:0
    v_and_b32 v217, s5, v50
    v_and_b32 v221, s5, v26
    v_mfma_f32_32x32x16_bf16 v[128:143], v[104:107], a[232:235], v[128:143]
    ds_write_b128 v44, v[164:167] offset:1024
    ds_write_b128 v44, v[168:171] offset:2048
    v_lshlrev_b32 v218, 16, v51
    v_lshlrev_b32 v222, 16, v27
    v_and_b32 v219, s5, v51
    v_mfma_f32_32x32x16_bf16 v[128:143], v[108:111], a[236:239], v[128:143]
    ds_write_b128 v44, v[172:175] offset:3072
    v_and_b32 v223, s5, v27
    ds_read_b64_tr_b16 v[32:33], v36 offset:7168
    v_xor_b32 v1, 112, v37
    ds_read_b64 v[180:181], v1
    v_mul_f32 v208, v208, v216
    v_mul_f32 v209, v209, v217
    v_mul_f32 v210, v210, v218
    v_mul_f32 v211, v211, v219
    v_fmac_f32 v208, v74, v52
    v_fmac_f32 v209, v75, v52
    v_fmac_f32 v210, v76, v52
    v_fmac_f32 v211, v77, v52
    v_mul_f32 v208, v208, v220
    v_mul_f32 v209, v209, v221
    v_mul_f32 v210, v210, v222
    v_mul_f32 v211, v211, v223
    s_waitcnt lgkmcnt(0)
    v_lshlrev_b32 v216, 16, v180
    v_lshlrev_b32 v220, 16, v32
    v_and_b32 v217, s5, v180
    v_and_b32 v221, s5, v32
    v_lshlrev_b32 v218, 16, v181
    v_lshlrev_b32 v222, 16, v33
    v_and_b32 v219, s5, v181
    v_and_b32 v223, s5, v33
    v_mul_f32 v212, v212, v216
    v_mul_f32 v213, v213, v217
    v_mul_f32 v214, v214, v218
    v_mul_f32 v215, v215, v219
    v_fmac_f32 v212, v78, v52
    v_fmac_f32 v213, v79, v52
    v_fmac_f32 v214, v80, v52
    v_fmac_f32 v215, v81, v52
    v_mul_f32 v212, v212, v220
    v_mul_f32 v213, v213, v221
    v_mul_f32 v214, v214, v222
    v_mul_f32 v215, v215, v223
    v_mfma_f32_32x32x16_bf16 v[128:143], v[112:115], a[240:243], v[128:143]
    ds_read_b128 v[96:99], v22 offset:8192
    ds_read_b128 v[100:103], v23 offset:8192
    v_mfma_f32_32x32x16_bf16 v[128:143], v[116:119], a[244:247], v[128:143]
    ds_read_b128 v[104:107], v24 offset:8192
    ds_read_b128 v[108:111], v25 offset:8192
    v_mfma_f32_32x32x16_bf16 v[128:143], v[120:123], a[248:251], v[128:143]
    s_barrier
    ds_read_b128 v[224:227], v45 offset:0
    ds_read_b128 v[228:231], v45 offset:1024
    v_mfma_f32_32x32x16_bf16 v[128:143], v[124:127], a[252:255], v[128:143]
    ds_read_b128 v[232:235], v45 offset:2048
    ds_read_b128 v[236:239], v45 offset:3072
    s_waitcnt lgkmcnt(7)
    v_mfma_f32_32x32x16_bf16 v[184:199], v[96:99], a[224:227], v[184:199]
    ds_read_b128 v[112:115], v22 offset:40960
    ds_read_b128 v[116:119], v23 offset:40960
    s_waitcnt lgkmcnt(8)
    v_mfma_f32_32x32x16_bf16 v[184:199], v[100:103], a[228:231], v[184:199]
    ds_read_b128 v[120:123], v24 offset:40960
    ds_read_b128 v[124:127], v25 offset:40960
    s_waitcnt lgkmcnt(7)
    s_nop 0
    v_add_f32 v128, v128, v224
    v_add_f32 v129, v129, v225
    v_add_f32 v130, v130, v226
    v_mfma_f32_32x32x16_bf16 v[184:199], v[104:107], a[232:235], v[184:199]
    v_add_f32 v131, v131, v227
    v_fma_f32 v128, v46, v128, v84
    v_fma_f32 v129, v47, v129, v85
    v_fma_f32 v130, v48, v130, v86
    v_fma_f32 v131, v49, v131, v87
    v_mfma_f32_32x32x16_bf16 v[184:199], v[108:111], a[236:239], v[184:199]
    buffer_store_dword v128, v40, s[32:35], s39 offen nt
    buffer_store_dword v129, v41, s[32:35], s39 offen nt
    buffer_store_dword v130, v42, s[32:35], s39 offen nt
    buffer_store_dword v131, v43, s[32:35], s39 offen nt
    s_waitcnt lgkmcnt(6)
    v_add_f32 v132, v132, v228
    s_waitcnt lgkmcnt(3)
    v_mfma_f32_32x32x16_bf16 v[184:199], v[112:115], a[240:243], v[184:199]
    ds_read_b128 v[96:99], v13 offset:8192
    ds_read_b128 v[100:103], v14 offset:8192
    v_add_f32 v133, v133, v229
    v_add_f32 v134, v134, v230
    v_add_f32 v135, v135, v231
    s_waitcnt lgkmcnt(4)
    v_mfma_f32_32x32x16_bf16 v[184:199], v[116:119], a[244:247], v[184:199]
    ds_read_b128 v[104:107], v15 offset:8192
    ds_read_b128 v[108:111], v16 offset:8192
    v_fma_f32 v132, v54, v132, v88
    v_fma_f32 v133, v55, v133, v89
    v_fma_f32 v134, v56, v134, v90
    s_waitcnt lgkmcnt(5)
    v_mfma_f32_32x32x16_bf16 v[184:199], v[120:123], a[248:251], v[184:199]
    v_fma_f32 v135, v57, v135, v91
    s_add_u32 s39, s39, 32768
    buffer_store_dword v132, v40, s[32:35], s39 offen nt
    buffer_store_dword v133, v41, s[32:35], s39 offen nt
    buffer_store_dword v134, v42, s[32:35], s39 offen nt
    s_waitcnt lgkmcnt(4)
    v_mfma_f32_32x32x16_bf16 v[184:199], v[124:127], a[252:255], v[184:199]
    buffer_store_dword v135, v43, s[32:35], s39 offen nt
    v_add_f32 v136, v136, v232
    v_add_f32 v137, v137, v233
    v_add_f32 v138, v138, v234
    v_add_f32 v139, v139, v235
    s_waitcnt lgkmcnt(3)
    v_mfma_f32_32x32x16_bf16 v[144:159], v[96:99], a[224:227], v[144:159]
    ds_read_b128 v[112:115], v13 offset:40960
    ds_read_b128 v[116:119], v14 offset:40960
    v_fma_f32 v136, v58, v136, v92
    v_fma_f32 v137, v59, v137, v93
    v_fma_f32 v138, v60, v138, v94
    s_waitcnt lgkmcnt(4)
    v_mfma_f32_32x32x16_bf16 v[144:159], v[100:103], a[228:231], v[144:159]
    ds_read_b128 v[120:123], v15 offset:40960
    ds_read_b128 v[124:127], v16 offset:40960
    ds_write_b128 v44, v[184:187] offset:4096
    v_fma_f32 v139, v61, v139, v95
    s_add_u32 s39, s39, 32768
    s_waitcnt lgkmcnt(6)
    v_mfma_f32_32x32x16_bf16 v[144:159], v[104:107], a[232:235], v[144:159]
    ds_write_b128 v44, v[188:191] offset:5120
    ds_write_b128 v44, v[192:195] offset:6144
    buffer_store_dword v136, v40, s[32:35], s39 offen nt
    buffer_store_dword v137, v41, s[32:35], s39 offen nt
    buffer_store_dword v138, v42, s[32:35], s39 offen nt
    s_waitcnt lgkmcnt(7)
    v_mfma_f32_32x32x16_bf16 v[144:159], v[108:111], a[236:239], v[144:159]
    ds_write_b128 v44, v[196:199] offset:7168
    buffer_store_dword v139, v43, s[32:35], s39 offen nt
    v_add_f32 v140, v140, v236
    v_add_f32 v141, v141, v237
    v_add_f32 v142, v142, v238
    s_waitcnt lgkmcnt(7)
    v_mfma_f32_32x32x16_bf16 v[144:159], v[112:115], a[240:243], v[144:159]
    v_add_f32 v143, v143, v239
    v_fma_f32 v140, v62, v140, v176
    v_fma_f32 v141, v63, v141, v177
    v_fma_f32 v142, v64, v142, v178
    v_fma_f32 v143, v65, v143, v179
    s_waitcnt lgkmcnt(6)
    v_mfma_f32_32x32x16_bf16 v[144:159], v[116:119], a[244:247], v[144:159]
    s_add_u32 s39, s39, 32768
    buffer_store_dword v140, v40, s[32:35], s39 offen nt
    buffer_store_dword v141, v41, s[32:35], s39 offen nt
    buffer_store_dword v142, v42, s[32:35], s39 offen nt
    buffer_store_dword v143, v43, s[32:35], s39 offen nt
    s_waitcnt lgkmcnt(5)
    v_mfma_f32_32x32x16_bf16 v[144:159], v[120:123], a[248:251], v[144:159]
    s_waitcnt lgkmcnt(0)
    s_barrier
    ds_read_b128 v[96:99], v45 offset:4096
    ds_read_b128 v[100:103], v45 offset:5120
    v_mfma_f32_32x32x16_bf16 v[144:159], v[124:127], a[252:255], v[144:159]
    ds_read_b128 v[104:107], v45 offset:6144
    ds_read_b128 v[108:111], v45 offset:7168
    s_waitcnt lgkmcnt(3)
    s_nop 8
    v_add_f32 v144, v144, v96
    v_add_f32 v145, v145, v97
    v_add_f32 v146, v146, v98
    v_add_f32 v147, v147, v99
    v_fma_f32 v144, v66, v144, v200
    v_fma_f32 v145, v67, v145, v201
    v_fma_f32 v146, v68, v146, v202
    v_fma_f32 v147, v69, v147, v203
    s_add_u32 s39, s39, 32768
    buffer_store_dword v144, v40, s[32:35], s39 offen nt
    buffer_store_dword v145, v41, s[32:35], s39 offen nt
    buffer_store_dword v146, v42, s[32:35], s39 offen nt
    buffer_store_dword v147, v43, s[32:35], s39 offen nt
    s_waitcnt lgkmcnt(2)
    v_add_f32 v148, v148, v100
    v_add_f32 v149, v149, v101
    v_add_f32 v150, v150, v102
    v_add_f32 v151, v151, v103
    v_fma_f32 v148, v70, v148, v204
    v_fma_f32 v149, v71, v149, v205
    v_fma_f32 v150, v72, v150, v206
    v_fma_f32 v151, v73, v151, v207
    s_add_u32 s39, s39, 32768
    buffer_store_dword v148, v40, s[32:35], s39 offen nt
    buffer_store_dword v149, v41, s[32:35], s39 offen nt
    buffer_store_dword v150, v42, s[32:35], s39 offen nt
    buffer_store_dword v151, v43, s[32:35], s39 offen nt
    s_waitcnt lgkmcnt(1)
    v_add_f32 v152, v152, v104
    v_add_f32 v153, v153, v105
    v_add_f32 v154, v154, v106
    v_add_f32 v155, v155, v107
    v_fma_f32 v152, v74, v152, v208
    v_fma_f32 v153, v75, v153, v209
    v_fma_f32 v154, v76, v154, v210
    v_fma_f32 v155, v77, v155, v211
    s_add_u32 s39, s39, 32768
    buffer_store_dword v152, v40, s[32:35], s39 offen nt
    buffer_store_dword v153, v41, s[32:35], s39 offen nt
    buffer_store_dword v154, v42, s[32:35], s39 offen nt
    buffer_store_dword v155, v43, s[32:35], s39 offen nt
    s_waitcnt lgkmcnt(0)
    v_add_f32 v156, v156, v108
    v_add_f32 v157, v157, v109
    v_add_f32 v158, v158, v110
    v_add_f32 v159, v159, v111
    v_fma_f32 v156, v78, v156, v212
    v_fma_f32 v157, v79, v157, v213
    v_fma_f32 v158, v80, v158, v214
    v_fma_f32 v159, v81, v159, v215
    s_add_u32 s39, s39, 32768
    buffer_store_dword v156, v40, s[32:35], s39 offen nt
    buffer_store_dword v157, v41, s[32:35], s39 offen nt
    buffer_store_dword v158, v42, s[32:35], s39 offen nt
    buffer_store_dword v159, v43, s[32:35], s39 offen nt
Lend_gated_mix__ssm_conv_s5__ssm_conv_h3__prompt_kernel:
Lcode_last:
    s_endpgm

.section .rodata,"a"
.p2align 6
.amdhsa_kernel gated_mix__ssm_conv_s5__ssm_conv_h3__prompt_kernel
  .amdhsa_next_free_vgpr 504
  .amdhsa_next_free_sgpr 92
  .amdhsa_accum_offset 248
  .amdhsa_group_segment_fixed_size 0
  .amdhsa_kernarg_size 152
  .amdhsa_user_sgpr_count 2
  .amdhsa_user_sgpr_kernarg_segment_ptr 1
  .amdhsa_system_sgpr_workgroup_id_x 1
  .amdhsa_float_denorm_mode_32 3
.end_amdhsa_kernel
```

```asm
; @launch grid=(256,1,1) block=(256,1,1) lds=163840
.amdgcn_target "amdgcn-amd-amdhsa--gfx950"
.text
.globl gated_mix__ssm_conv_s5__ssm_conv_h3__prompt_kernel
.p2align 8
.type gated_mix__ssm_conv_s5__ssm_conv_h3__prompt_kernel,@function
gated_mix__ssm_conv_s5__ssm_conv_h3__prompt_kernel:
    s_cmp_ge_u32 s2, 256
    s_cbranch_scc1 Lend_gated_mix__ssm_conv_s5__ssm_conv_h3__prompt_kernel
    s_load_dwordx16 s[4:19], s[0:1], 0
    s_load_dwordx16 s[20:35], s[0:1], 64
    s_load_dwordx4 s[36:39], s[0:1], 128
    s_load_dwordx2 s[40:41], s[0:1], 144
    s_getpc_b64 s[42:43]
Lcpf_pc:
    s_bfe_u32 s3, s2, 0x10003
    s_lshl_b32 s3, s3, 15
    v_lshlrev_b32 v1, 7, v0
    v_add_u32 v1, s3, v1
    v_min_u32 v1, Lcode_last-Lcpf_pc, v1
    v_mov_b32 v3, s43
    v_add_co_u32 v2, vcc, s42, v1
    s_nop 1
    v_addc_co_u32 v3, vcc, 0, v3, vcc
    global_load_dword v1, v[2:3], off
    s_memrealtime s[42:43]
    v_lshrrev_b32 v2, 6, v0
    s_nop 0
    v_readfirstlane_b32 s44, v2
    v_and_b32 v2, 63, v0
    s_and_b32 s47, s2, 7
    s_lshr_b32 s45, s47, 1
    s_lshl_b32 s45, s45, 2
    s_and_b32 s46, s47, 1
    s_lshl_b32 s46, s46, 3
    s_lshr_b32 s47, s2, 3
    s_and_b32 s3, s47, 3
    s_add_u32 s45, s45, s3
    s_lshr_b32 s47, s47, 2
    s_add_u32 s46, s46, s47
    v_mov_b32 v4, 0
    v_mov_b32 v5, 0
    v_mov_b32 v6, 0
    v_mov_b32 v7, 0
    v_lshlrev_b32 v3, 4, v0
    v_add_u32 v3, 148480, v3
    ds_write_b128 v3, v[4:7]
    v_lshlrev_b32 v3, 2, v0
    v_add_u32 v3, 152576, v3
    ds_write_b32 v3, v4
    v_lshrrev_b32 v16, 4, v2
    v_and_b32 v17, 7, v2
    v_xor_b32 v17, v17, v16
    v_lshlrev_b32 v17, 4, v17
    v_lshrrev_b32 v16, 3, v2
    v_lshl_add_u32 v12, v16, 11, v17
    v_and_b32 v16, 32, v2
    v_lshl_add_u32 v8, v16, 11, v17
    v_and_b32 v16, 8, v2
    v_lshl_add_u32 v8, v16, 12, v8
    v_and_b32 v16, 16, v2
    v_lshl_add_u32 v8, v16, 7, v8
    v_xor_b32 v16, 64, v8
    v_xor_b32 v17, 64, v12
    v_add_u32 v9, 4096, v16
    v_add_u32 v10, 8192, v8
    v_add_u32 v11, 12288, v16
    v_add_u32 v13, 16384, v17
    v_add_u32 v14, 32768, v12
    v_add_u32 v15, 49152, v17
    s_lshr_b32 s50, s44, 1
    s_lshl_b32 s47, s45, 7
    s_lshl_b32 s3, s50, 6
    s_add_u32 s47, s47, s3
    s_and_b32 s3, s44, 1
    s_lshl_b32 s3, s3, 3
    s_add_u32 s47, s47, s3
    s_lshl_b32 s47, s47, 11
    s_lshl_b32 s48, s46, 6
    s_lshl_b32 s3, s50, 5
    s_add_u32 s48, s48, s3
    s_lshl_b32 s48, s48, 11
    s_lshl_b32 s49, s44, 12
    s_and_b32 s3, s2, 7
    s_lshl_b32 s51, s3, 8
    v_bfe_u32 v17, v2, 3, 2
    v_lshrrev_b32 v18, 5, v2
    v_lshlrev_b32 v18, 2, v18
    v_lshl_add_u32 v17, v17, 3, v18
    v_and_b32 v18, 7, v2
    v_lshlrev_b32 v18, 4, v18
    v_lshl_add_u32 v16, v17, 11, v18
    s_lshl_b32 s50, s45, 7
    s_lshl_b32 s3, s44, 5
    s_add_u32 s50, s50, s3
    s_lshl_b32 s50, s50, 11
    s_lshl_b32 s3, s46, 7
    s_add_u32 s50, s50, s3
    v_add_u32 v16, s50, v16
    v_subrev_u32 v18, 6144, v16
    v_min_u32 v18, 0x7fff0000, v18
    v_subrev_u32 v22, 4096, v16
    v_min_u32 v22, 0x7fff0000, v22
    v_subrev_u32 v26, 2048, v16
    v_min_u32 v26, 0x7fff0000, v26
    s_mov_b32 s50, 4096
    s_lshl_b32 s54, s46, 9
    v_lshlrev_b32 v17, 4, v2
    s_waitcnt lgkmcnt(0)
    s_mov_b32 s56, s4
    s_mov_b32 s57, s5
    s_mov_b32 s58, 4194304
    s_mov_b32 s59, 131072
    s_and_b32 s3, s44, 1
    s_cmp_eq_u32 s3, 0
    s_cselect_b32 s60, s10, s12
    s_cselect_b32 s61, s11, s13
    s_mov_b32 s62, 2097152
    s_mov_b32 s63, 131072
    s_add_u32 s52, s47, s51
    s_add_u32 m0, s49, 0
    s_nop 0
    buffer_load_dwordx4 v8, s[56:59], s52 offen  lds
    s_add_u32 m0, s49, 1024
    s_nop 0
    buffer_load_dwordx4 v9, s[56:59], s52 offen  lds
    s_add_u32 m0, s49, 2048
    s_nop 0
    buffer_load_dwordx4 v10, s[56:59], s52 offen  lds
    s_add_u32 m0, s49, 3072
    s_nop 0
    buffer_load_dwordx4 v11, s[56:59], s52 offen  lds
    s_add_u32 s53, s48, s51
    s_add_u32 m0, s49, 16384
    s_nop 0
    buffer_load_dwordx4 v12, s[60:63], s53 offen  lds
    s_add_u32 m0, s49, 17408
    s_nop 0
    buffer_load_dwordx4 v13, s[60:63], s53 offen  lds
    s_add_u32 m0, s49, 18432
    s_nop 0
    buffer_load_dwordx4 v14, s[60:63], s53 offen  lds
    s_add_u32 m0, s49, 19456
    s_nop 0
    buffer_load_dwordx4 v15, s[60:63], s53 offen  lds
    s_add_u32 s51, s51, 128
    s_and_b32 s51, s51, 0x7ff
    s_add_u32 s52, s47, s51
    s_add_u32 m0, s49, 32768
    s_nop 0
    buffer_load_dwordx4 v8, s[56:59], s52 offen  lds
    s_add_u32 m0, s49, 33792
    s_nop 0
    buffer_load_dwordx4 v9, s[56:59], s52 offen  lds
    s_add_u32 m0, s49, 34816
    s_nop 0
    buffer_load_dwordx4 v10, s[56:59], s52 offen  lds
    s_add_u32 m0, s49, 35840
    s_nop 0
    buffer_load_dwordx4 v11, s[56:59], s52 offen  lds
    s_add_u32 s53, s48, s51
    s_add_u32 m0, s49, 49152
    s_nop 0
    buffer_load_dwordx4 v12, s[60:63], s53 offen  lds
    s_add_u32 m0, s49, 50176
    s_nop 0
    buffer_load_dwordx4 v13, s[60:63], s53 offen  lds
    s_add_u32 m0, s49, 51200
    s_nop 0
    buffer_load_dwordx4 v14, s[60:63], s53 offen  lds
    s_add_u32 m0, s49, 52224
    s_nop 0
    buffer_load_dwordx4 v15, s[60:63], s53 offen  lds
    s_mov_b32 s64, s28
    s_mov_b32 s65, s29
    s_mov_b32 s66, 8192
    s_mov_b32 s67, 131072
    s_mov_b32 s68, s24
    s_mov_b32 s69, s25
    s_mov_b32 s70, 4194304
    s_mov_b32 s71, 131072
    s_mov_b32 s72, s26
    s_mov_b32 s73, s27
    s_mov_b32 s74, 4194304
    s_mov_b32 s75, 131072
    s_lshl_b32 s3, s44, 10
    s_add_u32 s4, s3, 157696
    s_mov_b32 s24, s38
    s_mov_b32 s25, s39
    s_mov_b32 s26, 256
    s_mov_b32 s27, 131072
    s_or_b32 s3, s2, s44
    s_cmp_lg_u32 s3, 0
    s_cbranch_scc1 Lnonce_gate_1
    v_mov_b32 v4, s42
    v_mov_b32 v5, s43
    v_mov_b32 v3, 0
    buffer_store_dwordx2 v[4:5], v3, s[24:27], 0 offen sc0 sc1
    s_nop 1
Lnonce_gate_1:
    s_mov_b32 s5, 0xffff0000
    v_mov_b32 v6, 0
    s_and_b32 s3, s44, 1
    s_lshl_b32 s3, s3, 5
    v_and_b32 v7, 31, v2
    v_add_u32 v7, s3, v7
    s_lshl_b32 s3, s46, 6
    v_add_u32 v62, s3, v7
    v_lshlrev_b32 v62, 1, v62
    s_mov_b32 s76, s6
    s_mov_b32 s77, s7
    s_mov_b32 s78, 2048
    s_mov_b32 s79, 131072
    buffer_load_ushort v63, v62, s[76:79], 0 offen
    s_mov_b32 s76, s8
    s_mov_b32 s77, s9
    s_mov_b32 s78, 2048
    s_mov_b32 s79, 131072
    buffer_load_ushort v64, v62, s[76:79], 0 offen
    s_mov_b32 s8, s18
    s_mov_b32 s9, s19
    s_mov_b32 s10, 2048
    s_mov_b32 s11, 131072
    buffer_load_ushort v65, v62, s[8:11], 0 offen
    v_and_b32 v82, 31, v2
    v_bfe_u32 v83, v82, 1, 3
    v_lshrrev_b32 v84, 5, v2
    v_xor_b32 v83, v83, v84
    v_lshlrev_b32 v83, 4, v83
    v_lshl_add_u32 v83, v82, 7, v83
    s_lshr_b32 s6, s44, 1
    s_lshl_b32 s6, s6, 13
    s_and_b32 s7, s44, 1
    s_lshl_b32 s7, s7, 13
    s_add_u32 s7, s7, 16384
    v_xor_b32 v84, 0, v83
    v_add_u32 v66, s6, v84
    v_add_u32 v74, s7, v84
    v_add_u32 v70, 0x10000, v66
    v_add_u32 v78, 0x10000, v74
    v_xor_b32 v84, 32, v83
    v_add_u32 v67, s6, v84
    v_add_u32 v75, s7, v84
    v_add_u32 v71, 0x10000, v67
    v_add_u32 v79, 0x10000, v75
    v_xor_b32 v84, 64, v83
    v_add_u32 v68, s6, v84
    v_add_u32 v76, s7, v84
    v_add_u32 v72, 0x10000, v68
    v_add_u32 v80, 0x10000, v76
    v_xor_b32 v84, 96, v83
    v_add_u32 v69, s6, v84
    v_add_u32 v77, s7, v84
    v_add_u32 v73, 0x10000, v69
    v_add_u32 v81, 0x10000, v77
    s_mov_b32 s8, s40
    s_mov_b32 s9, s41
    s_mov_b32 s10, 33554432
    s_mov_b32 s11, 131072
    v_and_b32 v82, 7, v2
    s_lshl_b32 s3, s44, 10
    s_add_u32 s3, s3, 157696
    v_lshl_add_u32 v180, v82, 6, s3
    v_bfe_u32 v82, v2, 2, 1
    v_lshlrev_b32 v82, 3, v82
    v_lshrrev_b32 v83, 5, v2
    v_add_u32 v82, v82, v83
    v_lshlrev_b32 v181, 14, v82
    v_bfe_u32 v82, v2, 3, 2
    v_sub_u32 v82, 3, v82
    v_lshl_add_u32 v181, v82, 6, v181
    v_and_b32 v82, 3, v2
    v_lshl_add_u32 v181, v82, 4, v181
    s_lshl_b32 s6, s46, 18
    s_add_u32 s6, s6, 8404736
    s_lshl_b32 s3, s45, 10
    s_sub_u32 s6, s6, s3
    s_lshl_b32 s3, s44, 8
    s_sub_u32 s6, s6, s3
    s_lshl_b32 s13, s46, 4
    s_add_u32 s13, s13, s45
    s_lshl_b32 s13, s13, 2
    s_add_u32 s13, s13, s44
    s_lshl_b32 s13, s13, 3
    s_add_u32 s13, s13, 21495808
    s_lshl_b32 s18, s46, 2
    s_add_u32 s18, s18, s44
    s_lshl_b32 s18, s18, 4
    s_add_u32 s18, s18, s45
    s_lshl_b32 s18, s18, 3
    s_add_u32 s18, s18, 21504000
    s_lshl_b32 s3, s46, 9
    s_add_u32 s3, s3, 21495808
    v_lshrrev_b32 v182, 1, v17
    v_add_u32 v182, s3, v182
    s_lshl_b32 s19, s46, 6
    s_lshr_b32 s3, s45, 3
    s_lshl_b32 s3, s3, 5
    s_add_u32 s19, s19, s3
    s_lshl_b32 s3, s44, 3
    s_add_u32 s19, s19, s3
    s_and_b32 s3, s45, 7
    s_add_u32 s19, s19, s3
    s_lshl_b32 s22, s19, 12
    s_add_u32 s76, s30, s22
    s_addc_u32 s77, s31, 0
    s_mov_b32 s78, 4096
    s_mov_b32 s79, 131072
    s_mov_b32 s80, s32
    s_mov_b32 s81, s33
    s_mov_b32 s82, 2048
    s_mov_b32 s83, 131072
    s_lshl_b32 s3, s19, 1
    v_mov_b32 v183, s3
    buffer_load_ushort v183, v183, s[80:83], 0 offen
    s_mul_i32 s23, s44, 8320
    s_add_u32 s23, s23, 65536
    v_lshrrev_b32 v224, 4, v2
    v_and_b32 v225, 3, v2
    v_xor_b32 v225, v225, v224
    v_lshlrev_b32 v225, 4, v225
    v_lshrrev_b32 v224, 2, v2
    v_lshl_add_u32 v207, v224, 6, v225
    s_lshl_b32 s28, s46, 4
    s_add_u32 s28, s28, s45
    s_lshl_b32 s28, s28, 14
    s_lshl_b32 s29, s44, 12
    s_add_u32 s28, s28, s29
    s_add_u32 s28, s28, 8388608
    s_add_u32 s29, s29, 132096
    s_mov_b32 s80, s14
    s_mov_b32 s81, s15
    s_mov_b32 s82, 2097152
    s_mov_b32 s83, 131072
    s_mov_b32 s84, s16
    s_mov_b32 s85, s17
    s_mov_b32 s86, 2097152
    s_mov_b32 s87, 131072
    v_lshrrev_b32 v225, 2, v2
    v_lshrrev_b32 v226, 4, v2
    v_xor_b32 v226, v226, v2
    v_and_b32 v226, 3, v226
    v_lshlrev_b32 v226, 4, v226
    v_lshl_add_u32 v224, v225, 11, v226
    s_lshl_b32 s14, s46, 17
    s_and_b32 s3, s44, 1
    s_lshl_b32 s3, s3, 16
    s_add_u32 s14, s14, s3
    s_lshl_b32 s3, s45, 7
    s_add_u32 s14, s14, s3
    s_lshr_b32 s3, s44, 1
    s_lshl_b32 s3, s3, 6
    s_add_u32 s14, s14, s3
    s_add_u32 s15, s14, 32768
    s_lshl_b32 s16, s44, 12
    s_add_u32 s16, s16, 132096
    s_mov_b32 s88, s34
    s_mov_b32 s89, s35
    s_mov_b32 s90, 2048
    s_mov_b32 s91, 131072
    s_lshl_b32 s17, s45, 7
    s_lshl_b32 s3, s46, 3
    s_add_u32 s17, s17, s3
    s_lshl_b32 s3, s44, 1
    s_add_u32 s17, s17, s3
    s_lshl_b32 s3, s17, 2
    s_add_u32 s3, s3, 20971520
    v_mov_b32 v225, s3
    s_lshl_b32 s17, s17, 11
    s_mov_b32 s32, 8192
    buffer_load_dwordx4 v[208:211], v17, s[88:91], 0 offen offset:0
    buffer_load_dwordx4 v[212:215], v17, s[88:91], 0 offen offset:1024
    buffer_load_dwordx4 v[46:49], v17, s[56:59], s17 offen offset:0
    buffer_load_dwordx4 v[50:53], v17, s[56:59], s17 offen offset:1024
    buffer_load_dwordx4 v[54:57], v17, s[56:59], s17 offen offset:2048
    buffer_load_dwordx4 v[58:61], v17, s[56:59], s17 offen offset:3072
    s_waitcnt vmcnt(18)
    s_barrier
    ds_read_b128 v[84:87], v66 offset:0
    ds_read_b128 v[92:95], v74 offset:0
    ds_read_b128 v[96:99], v74 offset:4096
    ds_read_b128 v[88:91], v66 offset:4096
    s_add_u32 s51, s51, 128
    s_and_b32 s51, s51, 0x7ff
    s_add_u32 s52, s47, s51
    s_add_u32 m0, s49, 65536
    s_waitcnt lgkmcnt(2)
    v_mfma_f32_32x32x16_bf16 v[116:131], v[84:87], v[92:95], 0
    ds_read_b128 v[100:103], v67 offset:0
    ds_read_b128 v[108:111], v75 offset:0
    buffer_load_dwordx4 v8, s[56:59], s52 offen  lds
    s_add_u32 m0, s49, 66560
    s_waitcnt lgkmcnt(3)
    v_mfma_f32_32x32x16_bf16 v[132:147], v[84:87], v[96:99], 0
    ds_read_b128 v[112:115], v75 offset:4096
    ds_read_b128 v[104:107], v67 offset:4096
    buffer_load_dwordx4 v9, s[56:59], s52 offen  lds
    s_add_u32 m0, s49, 67584
    s_waitcnt lgkmcnt(4)
    v_mfma_f32_32x32x16_bf16 v[148:163], v[88:91], v[92:95], 0
    buffer_load_dwordx4 v10, s[56:59], s52 offen  lds
    s_add_u32 m0, s49, 68608
    v_mfma_f32_32x32x16_bf16 v[164:179], v[88:91], v[96:99], 0
    buffer_load_dwordx4 v11, s[56:59], s52 offen  lds
    s_add_u32 s53, s48, s51
    s_add_u32 m0, s49, 81920
    s_waitcnt lgkmcnt(2)
    v_mfma_f32_32x32x16_bf16 v[116:131], v[100:103], v[108:111], v[116:131]
    ds_read_b128 v[84:87], v68 offset:0
    ds_read_b128 v[92:95], v76 offset:0
    buffer_load_dwordx4 v12, s[60:63], s53 offen  lds
    s_add_u32 m0, s49, 82944
    s_waitcnt lgkmcnt(3)
    v_mfma_f32_32x32x16_bf16 v[132:147], v[100:103], v[112:115], v[132:147]
    ds_read_b128 v[96:99], v76 offset:4096
    ds_read_b128 v[88:91], v68 offset:4096
    buffer_load_dwordx4 v13, s[60:63], s53 offen  lds
    s_add_u32 m0, s49, 83968
    s_waitcnt lgkmcnt(4)
    v_mfma_f32_32x32x16_bf16 v[148:163], v[104:107], v[108:111], v[148:163]
    buffer_load_dwordx4 v14, s[60:63], s53 offen  lds
    s_add_u32 m0, s49, 84992
    v_mfma_f32_32x32x16_bf16 v[164:179], v[104:107], v[112:115], v[164:179]
    buffer_load_dwordx4 v15, s[60:63], s53 offen  lds
    s_add_u32 s51, s51, 128
    s_and_b32 s51, s51, 0x7ff
    s_add_u32 s52, s47, s51
    s_add_u32 m0, s49, 98304
    s_waitcnt lgkmcnt(2)
    v_mfma_f32_32x32x16_bf16 v[116:131], v[84:87], v[92:95], v[116:131]
    ds_read_b128 v[100:103], v69 offset:0
    ds_read_b128 v[108:111], v77 offset:0
    buffer_load_dwordx4 v8, s[56:59], s52 offen  lds
    s_add_u32 m0, s49, 99328
    s_waitcnt lgkmcnt(3)
    v_mfma_f32_32x32x16_bf16 v[132:147], v[84:87], v[96:99], v[132:147]
    ds_read_b128 v[112:115], v77 offset:4096
    ds_read_b128 v[104:107], v69 offset:4096
    buffer_load_dwordx4 v9, s[56:59], s52 offen  lds
    s_add_u32 m0, s49, 100352
    s_waitcnt lgkmcnt(4)
    v_mfma_f32_32x32x16_bf16 v[148:163], v[88:91], v[92:95], v[148:163]
    buffer_load_dwordx4 v10, s[56:59], s52 offen  lds
    s_add_u32 m0, s49, 101376
    v_mfma_f32_32x32x16_bf16 v[164:179], v[88:91], v[96:99], v[164:179]
    buffer_load_dwordx4 v11, s[56:59], s52 offen  lds
    s_waitcnt lgkmcnt(0)
    s_waitcnt vmcnt(22)
    s_barrier
    s_add_u32 s53, s48, s51
    s_add_u32 m0, s49, 114688
    v_mfma_f32_32x32x16_bf16 v[116:131], v[100:103], v[108:111], v[116:131]
    ds_read_b128 v[84:87], v66 offset:32768
    ds_read_b128 v[92:95], v74 offset:32768
    buffer_load_dwordx4 v12, s[60:63], s53 offen  lds
    s_waitcnt vmcnt(22)
    v_lshlrev_b32 v63, 16, v63
    s_waitcnt vmcnt(21)
    v_lshlrev_b32 v64, 16, v64
    s_waitcnt vmcnt(20)
    v_lshlrev_b32 v65, 16, v65
    v_mul_f32 v242, 1069066811, v65
    s_add_u32 m0, s49, 115712
    v_mfma_f32_32x32x16_bf16 v[132:147], v[100:103], v[112:115], v[132:147]
    ds_read_b128 v[96:99], v74 offset:36864
    ds_read_b128 v[88:91], v66 offset:36864
    buffer_load_dwordx4 v13, s[60:63], s53 offen  lds
    v_exp_f32 v242, v242
    s_nop 0
    v_cvt_pk_bf16_f32 v242, v242, v242
    v_lshlrev_b32 v242, 16, v242
    v_mul_f32 v243, v242, v63
    s_add_u32 m0, s49, 116736
    v_mfma_f32_32x32x16_bf16 v[148:163], v[104:107], v[108:111], v[148:163]
    buffer_load_dwordx4 v14, s[60:63], s53 offen  lds
    v_mul_f32 v244, v242, v64
    v_mul_f32 v243, 1069066811, v243
    v_exp_f32 v243, v243
    v_mul_f32 v244, 1042479491, v244
    v_fract_f32 v244, v244
    v_cos_f32 v245, v244
    s_add_u32 m0, s49, 117760
    v_mfma_f32_32x32x16_bf16 v[164:179], v[104:107], v[112:115], v[164:179]
    buffer_load_dwordx4 v15, s[60:63], s53 offen  lds
    v_sin_f32 v246, v244
    v_mul_f32 v230, v243, v245
    v_mul_f32 v231, v243, v246
    v_add_f32 v242, -1.0, v230
    v_mul_f32 v243, v63, v63
    v_fmac_f32 v243, v64, v64
    v_rcp_f32 v243, v243
    s_add_u32 s51, s51, 128
    s_and_b32 s51, s51, 0x7ff
    s_add_u32 s52, s47, s51
    s_add_u32 m0, s49, 0
    s_waitcnt lgkmcnt(2)
    v_mfma_f32_32x32x16_bf16 v[116:131], v[84:87], v[92:95], v[116:131]
    ds_read_b128 v[100:103], v67 offset:32768
    ds_read_b128 v[108:111], v75 offset:32768
    buffer_load_dwordx4 v8, s[56:59], s52 offen  lds
    v_add_f32 v243, v243, v243
    v_mul_f32 v244, v242, v63
    v_fmac_f32 v244, v231, v64
    v_mul_f32 v245, v231, v63
    s_add_u32 m0, s49, 1024
    s_waitcnt lgkmcnt(3)
    v_mfma_f32_32x32x16_bf16 v[132:147], v[84:87], v[96:99], v[132:147]
    ds_read_b128 v[112:115], v75 offset:36864
    ds_read_b128 v[104:107], v67 offset:36864
    buffer_load_dwordx4 v9, s[56:59], s52 offen  lds
    v_fma_f32 v245, -v242, v64, v245
    v_mul_f32 v232, v244, v243
    v_mul_f32 v233, v245, v243
    v_mul_f32 v242, v231, v231
    s_add_u32 m0, s49, 2048
    s_waitcnt lgkmcnt(4)
    v_mfma_f32_32x32x16_bf16 v[148:163], v[88:91], v[92:95], v[148:163]
    buffer_load_dwordx4 v10, s[56:59], s52 offen  lds
    v_fma_f32 v242, v230, v230, -v242
    v_mul_f32 v243, v230, v231
    v_add_f32 v243, v243, v243
    v_mul_f32 v244, v243, v243
    v_fma_f32 v244, v242, v242, -v244
    v_mul_f32 v245, v242, v243
    s_add_u32 m0, s49, 3072
    v_mfma_f32_32x32x16_bf16 v[164:179], v[88:91], v[96:99], v[164:179]
    buffer_load_dwordx4 v11, s[56:59], s52 offen  lds
    v_add_f32 v245, v245, v245
    v_mul_f32 v242, v245, v245
    v_fma_f32 v242, v244, v244, -v242
    v_mul_f32 v243, v244, v245
    v_add_f32 v243, v243, v243
    v_mul_f32 v234, v243, v243
    v_fma_f32 v234, v242, v242, -v234
    s_add_u32 s53, s48, s51
    s_add_u32 m0, s49, 16384
    s_waitcnt lgkmcnt(2)
    v_mfma_f32_32x32x16_bf16 v[116:131], v[100:103], v[108:111], v[116:131]
    ds_read_b128 v[84:87], v68 offset:32768
    ds_read_b128 v[92:95], v76 offset:32768
    buffer_load_dwordx4 v12, s[60:63], s53 offen  lds
    v_mul_f32 v235, v242, v243
    v_add_f32 v235, v235, v235
    v_mul_f32 v242, v235, v235
    v_fma_f32 v242, v234, v234, -v242
    s_add_u32 m0, s49, 17408
    s_waitcnt lgkmcnt(3)
    v_mfma_f32_32x32x16_bf16 v[132:147], v[100:103], v[112:115], v[132:147]
    ds_read_b128 v[96:99], v76 offset:36864
    ds_read_b128 v[88:91], v68 offset:36864
    buffer_load_dwordx4 v13, s[60:63], s53 offen  lds
    v_mul_f32 v243, v234, v235
    v_add_f32 v243, v243, v243
    v_mul_f32 v244, v243, v243
    v_fma_f32 v244, v242, v242, -v244
    s_add_u32 m0, s49, 18432
    s_waitcnt lgkmcnt(4)
    v_mfma_f32_32x32x16_bf16 v[148:163], v[104:107], v[108:111], v[148:163]
    buffer_load_dwordx4 v14, s[60:63], s53 offen  lds
    v_mul_f32 v245, v242, v243
    v_add_f32 v245, v245, v245
    v_mul_f32 v236, v245, v245
    v_fma_f32 v236, v244, v244, -v236
    v_mul_f32 v237, v244, v245
    v_add_f32 v237, v237, v237
    s_add_u32 m0, s49, 19456
    v_mfma_f32_32x32x16_bf16 v[164:179], v[104:107], v[112:115], v[164:179]
    buffer_load_dwordx4 v15, s[60:63], s53 offen  lds
    s_mov_b32 s34, 0
    s_mov_b32 s35, -1
    s_lshr_b32 s3, s44, 1
    s_cmp_eq_u32 s3, 1
    s_cselect_b32 s38, -1, 0
    s_cselect_b32 s39, -1, 0
    v_cndmask_b32 v242, 1.0, v242, s[34:35]
    v_cndmask_b32 v243, 0, v243, s[34:35]
    v_cndmask_b32 v244, 1.0, v244, s[38:39]
    s_waitcnt lgkmcnt(2)
    v_mfma_f32_32x32x16_bf16 v[116:131], v[84:87], v[92:95], v[116:131]
    ds_read_b128 v[100:103], v69 offset:32768
    ds_read_b128 v[108:111], v77 offset:32768
    v_cndmask_b32 v245, 0, v245, s[38:39]
    v_mul_f32 v246, v243, v245
    v_fma_f32 v246, v242, v244, -v246
    v_mul_f32 v247, v242, v245
    v_fmac_f32 v247, v243, v244
    v_mul_f32 v242, v247, v235
    s_waitcnt lgkmcnt(3)
    v_mfma_f32_32x32x16_bf16 v[132:147], v[84:87], v[96:99], v[132:147]
    ds_read_b128 v[112:115], v77 offset:36864
    ds_read_b128 v[104:107], v69 offset:36864
    v_fma_f32 v242, v246, v234, -v242
    v_mul_f32 v243, v246, v235
    v_fmac_f32 v243, v247, v234
    v_mov_b32 v238, v246
    v_mov_b32 v239, v242
    v_mov_b32 v240, v247
    s_waitcnt lgkmcnt(4)
    v_mfma_f32_32x32x16_bf16 v[148:163], v[88:91], v[92:95], v[148:163]
    v_mov_b32 v241, v243
    v_mfma_f32_32x32x16_bf16 v[164:179], v[88:91], v[96:99], v[164:179]
    s_waitcnt lgkmcnt(0)
    s_waitcnt vmcnt(16)
    s_barrier
    s_add_u32 s51, s51, 128
    s_and_b32 s51, s51, 0x7ff
    s_add_u32 s52, s47, s51
    s_add_u32 m0, s49, 32768
    v_mfma_f32_32x32x16_bf16 v[116:131], v[100:103], v[108:111], v[116:131]
    ds_read_b128 v[84:87], v70 offset:0
    ds_read_b128 v[92:95], v78 offset:0
    buffer_load_dwordx4 v8, s[56:59], s52 offen  lds
    v_lshlrev_b32 v203, 16, v208
    v_and_b32 v204, s5, v208
    v_lshlrev_b32 v205, 16, v46
    v_and_b32 v206, s5, v46
    s_add_u32 m0, s49, 33792
    v_mfma_f32_32x32x16_bf16 v[132:147], v[100:103], v[112:115], v[132:147]
    ds_read_b128 v[96:99], v78 offset:4096
    ds_read_b128 v[88:91], v70 offset:4096
    buffer_load_dwordx4 v9, s[56:59], s52 offen  lds
    v_mul_f32 v226, v203, v205
    v_fmac_f32 v226, v204, v206
    v_lshlrev_b32 v205, 16, v54
    v_and_b32 v206, s5, v54
    s_add_u32 m0, s49, 34816
    v_mfma_f32_32x32x16_bf16 v[148:163], v[104:107], v[108:111], v[148:163]
    buffer_load_dwordx4 v10, s[56:59], s52 offen  lds
    v_mul_f32 v227, v203, v205
    v_fmac_f32 v227, v204, v206
    v_lshlrev_b32 v203, 16, v209
    v_and_b32 v204, s5, v209
    v_lshlrev_b32 v205, 16, v47
    v_and_b32 v206, s5, v47
    s_add_u32 m0, s49, 35840
    v_mfma_f32_32x32x16_bf16 v[164:179], v[104:107], v[112:115], v[164:179]
    buffer_load_dwordx4 v11, s[56:59], s52 offen  lds
    v_fmac_f32 v226, v203, v205
    v_fmac_f32 v226, v204, v206
    v_lshlrev_b32 v205, 16, v55
    v_and_b32 v206, s5, v55
    v_fmac_f32 v227, v203, v205
    v_fmac_f32 v227, v204, v206
    v_lshlrev_b32 v203, 16, v210
    s_add_u32 s53, s48, s51
    s_add_u32 m0, s49, 49152
    s_waitcnt lgkmcnt(2)
    v_mfma_f32_32x32x16_bf16 v[116:131], v[84:87], v[92:95], v[116:131]
    ds_read_b128 v[100:103], v71 offset:0
    ds_read_b128 v[108:111], v79 offset:0
    buffer_load_dwordx4 v12, s[60:63], s53 offen  lds
    v_and_b32 v204, s5, v210
    v_lshlrev_b32 v205, 16, v48
    v_and_b32 v206, s5, v48
    v_fmac_f32 v226, v203, v205
    s_add_u32 m0, s49, 50176
    s_waitcnt lgkmcnt(3)
    v_mfma_f32_32x32x16_bf16 v[132:147], v[84:87], v[96:99], v[132:147]
    ds_read_b128 v[112:115], v79 offset:4096
    ds_read_b128 v[104:107], v71 offset:4096
    buffer_load_dwordx4 v13, s[60:63], s53 offen  lds
    v_fmac_f32 v226, v204, v206
    v_lshlrev_b32 v205, 16, v56
    v_and_b32 v206, s5, v56
    v_fmac_f32 v227, v203, v205
    s_add_u32 m0, s49, 51200
    s_waitcnt lgkmcnt(4)
    v_mfma_f32_32x32x16_bf16 v[148:163], v[88:91], v[92:95], v[148:163]
    buffer_load_dwordx4 v14, s[60:63], s53 offen  lds
    v_fmac_f32 v227, v204, v206
    v_lshlrev_b32 v203, 16, v211
    v_and_b32 v204, s5, v211
    v_lshlrev_b32 v205, 16, v49
    v_and_b32 v206, s5, v49
    v_fmac_f32 v226, v203, v205
    s_add_u32 m0, s49, 52224
    v_mfma_f32_32x32x16_bf16 v[164:179], v[88:91], v[96:99], v[164:179]
    buffer_load_dwordx4 v15, s[60:63], s53 offen  lds
    v_fmac_f32 v226, v204, v206
    v_lshlrev_b32 v205, 16, v57
    v_and_b32 v206, s5, v57
    v_fmac_f32 v227, v203, v205
    v_fmac_f32 v227, v204, v206
    v_lshlrev_b32 v203, 16, v212
    v_and_b32 v204, s5, v212
    s_waitcnt lgkmcnt(2)
    v_mfma_f32_32x32x16_bf16 v[116:131], v[100:103], v[108:111], v[116:131]
    ds_read_b128 v[84:87], v72 offset:0
    ds_read_b128 v[92:95], v80 offset:0
    v_lshlrev_b32 v205, 16, v50
    v_and_b32 v206, s5, v50
    v_fmac_f32 v226, v203, v205
    v_fmac_f32 v226, v204, v206
    v_lshlrev_b32 v205, 16, v58
    v_and_b32 v206, s5, v58
    s_waitcnt lgkmcnt(3)
    v_mfma_f32_32x32x16_bf16 v[132:147], v[100:103], v[112:115], v[132:147]
    ds_read_b128 v[96:99], v80 offset:4096
    ds_read_b128 v[88:91], v72 offset:4096
    v_fmac_f32 v227, v203, v205
    v_fmac_f32 v227, v204, v206
    v_lshlrev_b32 v203, 16, v213
    v_and_b32 v204, s5, v213
    v_lshlrev_b32 v205, 16, v51
    v_and_b32 v206, s5, v51
    s_waitcnt lgkmcnt(4)
    v_mfma_f32_32x32x16_bf16 v[148:163], v[104:107], v[108:111], v[148:163]
    v_fmac_f32 v226, v203, v205
    v_fmac_f32 v226, v204, v206
    v_lshlrev_b32 v205, 16, v59
    v_and_b32 v206, s5, v59
    v_fmac_f32 v227, v203, v205
    v_fmac_f32 v227, v204, v206
    v_lshlrev_b32 v203, 16, v214
    v_and_b32 v204, s5, v214
    v_mfma_f32_32x32x16_bf16 v[164:179], v[104:107], v[112:115], v[164:179]
    v_lshlrev_b32 v205, 16, v52
    v_and_b32 v206, s5, v52
    v_fmac_f32 v226, v203, v205
    v_fmac_f32 v226, v204, v206
    v_lshlrev_b32 v205, 16, v60
    v_and_b32 v206, s5, v60
    v_fmac_f32 v227, v203, v205
    v_fmac_f32 v227, v204, v206
    s_waitcnt lgkmcnt(2)
    v_mfma_f32_32x32x16_bf16 v[116:131], v[84:87], v[92:95], v[116:131]
    ds_read_b128 v[100:103], v73 offset:0
    ds_read_b128 v[108:111], v81 offset:0
    v_lshlrev_b32 v203, 16, v215
    v_and_b32 v204, s5, v215
    v_lshlrev_b32 v205, 16, v53
    v_and_b32 v206, s5, v53
    v_fmac_f32 v226, v203, v205
    v_fmac_f32 v226, v204, v206
    s_waitcnt lgkmcnt(3)
    v_mfma_f32_32x32x16_bf16 v[132:147], v[84:87], v[96:99], v[132:147]
    ds_read_b128 v[112:115], v81 offset:4096
    ds_read_b128 v[104:107], v73 offset:4096
    v_lshlrev_b32 v205, 16, v61
    v_and_b32 v206, s5, v61
    v_fmac_f32 v227, v203, v205
    v_fmac_f32 v227, v204, v206
    v_add_f32_dpp v226, v226, v226 row_shr:1 row_mask:0xf bank_mask:0xf bound_ctrl:0
    s_nop 0
    v_add_f32_dpp v227, v227, v227 row_shr:1 row_mask:0xf bank_mask:0xf bound_ctrl:0
    s_waitcnt lgkmcnt(4)
    v_mfma_f32_32x32x16_bf16 v[148:163], v[88:91], v[92:95], v[148:163]
    v_add_f32_dpp v226, v226, v226 row_shr:2 row_mask:0xf bank_mask:0xf bound_ctrl:0
    v_add_f32_dpp v227, v227, v227 row_shr:2 row_mask:0xf bank_mask:0xf bound_ctrl:0
    s_nop 0
    v_add_f32_dpp v226, v226, v226 row_shr:4 row_mask:0xf bank_mask:0xf bound_ctrl:0
    v_add_f32_dpp v227, v227, v227 row_shr:4 row_mask:0xf bank_mask:0xf bound_ctrl:0
    s_nop 0
    v_add_f32_dpp v226, v226, v226 row_shr:8 row_mask:0xf bank_mask:0xf bound_ctrl:0
    v_add_f32_dpp v227, v227, v227 row_shr:8 row_mask:0xf bank_mask:0xf bound_ctrl:0
    s_nop 0
    v_add_f32_dpp v226, v226, v226 row_bcast:15 row_mask:0xa bank_mask:0xf
    v_add_f32_dpp v227, v227, v227 row_bcast:15 row_mask:0xa bank_mask:0xf
    v_mfma_f32_32x32x16_bf16 v[164:179], v[88:91], v[96:99], v[164:179]
    v_add_f32_dpp v226, v226, v226 row_bcast:31 row_mask:0xc bank_mask:0xf
    v_add_f32_dpp v227, v227, v227 row_bcast:31 row_mask:0xc bank_mask:0xf
    v_cvt_pk_bf16_f32 v203, v226, v227
    v_lshlrev_b32 v226, 16, v203
    v_and_b32 v227, s5, v203
    v_mul_f32 v226, 0xbfb8aa3b, v226
    v_mul_f32 v227, 0xbfb8aa3b, v227
    v_exp_f32 v226, v226
    s_waitcnt lgkmcnt(0)
    s_waitcnt vmcnt(16)
    s_barrier
    s_add_u32 s51, s51, 128
    s_and_b32 s51, s51, 0x7ff
    s_add_u32 s52, s47, s51
    s_add_u32 m0, s49, 65536
    v_mfma_f32_32x32x16_bf16 v[116:131], v[100:103], v[108:111], v[116:131]
    ds_read_b128 v[84:87], v70 offset:32768
    ds_read_b128 v[92:95], v78 offset:32768
    buffer_load_dwordx4 v8, s[56:59], s52 offen  lds
    v_exp_f32 v227, v227
    v_add_f32 v226, 1.0, v226
    v_add_f32 v227, 1.0, v227
    v_rcp_f32 v226, v226
    s_add_u32 m0, s49, 66560
    v_mfma_f32_32x32x16_bf16 v[132:147], v[100:103], v[112:115], v[132:147]
    ds_read_b128 v[96:99], v78 offset:36864
    ds_read_b128 v[88:91], v70 offset:36864
    buffer_load_dwordx4 v9, s[56:59], s52 offen  lds
    v_rcp_f32 v227, v227
    s_nop 0
    v_cvt_pk_bf16_f32 v203, v226, v227
    v_lshlrev_b32 v226, 16, v203
    v_and_b32 v227, s5, v203
    s_add_u32 m0, s49, 67584
    v_mfma_f32_32x32x16_bf16 v[148:163], v[104:107], v[108:111], v[148:163]
    buffer_load_dwordx4 v10, s[56:59], s52 offen  lds
    v_sub_f32 v228, 1.0, v226
    v_sub_f32 v229, 1.0, v227
    v_cvt_pk_bf16_f32 v203, v228, v229
    v_lshlrev_b32 v228, 16, v203
    v_and_b32 v229, s5, v203
    s_add_u32 m0, s49, 68608
    v_mfma_f32_32x32x16_bf16 v[164:179], v[104:107], v[112:115], v[164:179]
    buffer_load_dwordx4 v11, s[56:59], s52 offen  lds
    s_add_u32 s53, s48, s51
    s_add_u32 m0, s49, 81920
    s_waitcnt lgkmcnt(2)
    v_mfma_f32_32x32x16_bf16 v[116:131], v[84:87], v[92:95], v[116:131]
    ds_read_b128 v[100:103], v71 offset:32768
    ds_read_b128 v[108:111], v79 offset:32768
    buffer_load_dwordx4 v12, s[60:63], s53 offen  lds
    s_add_u32 m0, s49, 82944
    s_waitcnt lgkmcnt(3)
    v_mfma_f32_32x32x16_bf16 v[132:147], v[84:87], v[96:99], v[132:147]
    ds_read_b128 v[112:115], v79 offset:36864
    ds_read_b128 v[104:107], v71 offset:36864
    buffer_load_dwordx4 v13, s[60:63], s53 offen  lds
    s_add_u32 m0, s49, 83968
    s_waitcnt lgkmcnt(4)
    v_mfma_f32_32x32x16_bf16 v[148:163], v[88:91], v[92:95], v[148:163]
    buffer_load_dwordx4 v14, s[60:63], s53 offen  lds
    s_add_u32 m0, s49, 84992
    v_mfma_f32_32x32x16_bf16 v[164:179], v[88:91], v[96:99], v[164:179]
    buffer_load_dwordx4 v15, s[60:63], s53 offen  lds
    s_mov_b32 m0, s4
    s_waitcnt lgkmcnt(2)
    v_mfma_f32_32x32x16_bf16 v[116:131], v[100:103], v[108:111], v[116:131]
    ds_read_b128 v[84:87], v72 offset:32768
    ds_read_b128 v[92:95], v80 offset:32768
    buffer_load_dwordx4 v17, s[64:67], s54 offen lds
    s_waitcnt lgkmcnt(3)
    v_mfma_f32_32x32x16_bf16 v[132:147], v[100:103], v[112:115], v[132:147]
    ds_read_b128 v[96:99], v80 offset:36864
    ds_read_b128 v[88:91], v72 offset:36864
    buffer_load_dwordx4 v[18:21], v18, s[68:71], 0 offen
    s_waitcnt lgkmcnt(4)
    v_mfma_f32_32x32x16_bf16 v[148:163], v[104:107], v[108:111], v[148:163]
    buffer_load_dwordx4 v[22:25], v22, s[68:71], 0 offen
    v_mfma_f32_32x32x16_bf16 v[164:179], v[104:107], v[112:115], v[164:179]
    buffer_load_dwordx4 v[26:29], v26, s[68:71], 0 offen
    s_waitcnt lgkmcnt(2)
    v_mfma_f32_32x32x16_bf16 v[116:131], v[84:87], v[92:95], v[116:131]
    ds_read_b128 v[100:103], v73 offset:32768
    ds_read_b128 v[108:111], v81 offset:32768
    buffer_load_dwordx4 v[30:33], v16, s[68:71], 0 offen offset:0
    s_waitcnt lgkmcnt(3)
    v_mfma_f32_32x32x16_bf16 v[132:147], v[84:87], v[96:99], v[132:147]
    ds_read_b128 v[112:115], v81 offset:36864
    ds_read_b128 v[104:107], v73 offset:36864
    buffer_load_dwordx4 v[34:37], v16, s[68:71], 0 offen offset:2048
    s_waitcnt lgkmcnt(4)
    v_mfma_f32_32x32x16_bf16 v[148:163], v[88:91], v[92:95], v[148:163]
    buffer_load_dwordx4 v[38:41], v16, s[68:71], s50 offen offset:0
    v_mfma_f32_32x32x16_bf16 v[164:179], v[88:91], v[96:99], v[164:179]
    buffer_load_dwordx4 v[42:45], v16, s[68:71], s50 offen offset:2048
    s_waitcnt lgkmcnt(0)
    s_waitcnt vmcnt(24)
    s_barrier
    v_mfma_f32_32x32x16_bf16 v[116:131], v[100:103], v[108:111], v[116:131]
    ds_read_b128 v[84:87], v66 offset:0
    ds_read_b128 v[92:95], v74 offset:0
    buffer_load_dwordx4 v[46:49], v16, s[72:75], 0 offen offset:0
    v_mfma_f32_32x32x16_bf16 v[132:147], v[100:103], v[112:115], v[132:147]
    ds_read_b128 v[96:99], v74 offset:4096
    ds_read_b128 v[88:91], v66 offset:4096
    buffer_load_dwordx4 v[50:53], v16, s[72:75], 0 offen offset:2048
    v_mfma_f32_32x32x16_bf16 v[148:163], v[104:107], v[108:111], v[148:163]
    buffer_load_dwordx4 v[54:57], v16, s[72:75], s50 offen offset:0
    v_mfma_f32_32x32x16_bf16 v[164:179], v[104:107], v[112:115], v[164:179]
    buffer_load_dwordx4 v[58:61], v16, s[72:75], s50 offen offset:2048
    s_add_u32 s51, s51, 128
    s_and_b32 s51, s51, 0x7ff
    s_add_u32 s52, s47, s51
    s_add_u32 m0, s49, 98304
    s_waitcnt lgkmcnt(2)
    v_mfma_f32_32x32x16_bf16 v[116:131], v[84:87], v[92:95], v[116:131]
    ds_read_b128 v[100:103], v67 offset:0
    ds_read_b128 v[108:111], v75 offset:0
    buffer_load_dwordx4 v8, s[56:59], s52 offen  lds
    s_add_u32 m0, s49, 99328
    s_waitcnt lgkmcnt(3)
    v_mfma_f32_32x32x16_bf16 v[132:147], v[84:87], v[96:99], v[132:147]
    ds_read_b128 v[112:115], v75 offset:4096
    ds_read_b128 v[104:107], v67 offset:4096
    buffer_load_dwordx4 v9, s[56:59], s52 offen  lds
    s_add_u32 m0, s49, 100352
    s_waitcnt lgkmcnt(4)
    v_mfma_f32_32x32x16_bf16 v[148:163], v[88:91], v[92:95], v[148:163]
    buffer_load_dwordx4 v10, s[56:59], s52 offen  lds
    s_add_u32 m0, s49, 101376
    v_mfma_f32_32x32x16_bf16 v[164:179], v[88:91], v[96:99], v[164:179]
    buffer_load_dwordx4 v11, s[56:59], s52 offen  lds
    s_add_u32 s53, s48, s51
    s_add_u32 m0, s49, 114688
    s_waitcnt lgkmcnt(2)
    v_mfma_f32_32x32x16_bf16 v[116:131], v[100:103], v[108:111], v[116:131]
    ds_read_b128 v[84:87], v68 offset:0
    ds_read_b128 v[92:95], v76 offset:0
    buffer_load_dwordx4 v12, s[60:63], s53 offen  lds
    s_add_u32 m0, s49, 115712
    s_waitcnt lgkmcnt(3)
    v_mfma_f32_32x32x16_bf16 v[132:147], v[100:103], v[112:115], v[132:147]
    ds_read_b128 v[96:99], v76 offset:4096
    ds_read_b128 v[88:91], v68 offset:4096
    buffer_load_dwordx4 v13, s[60:63], s53 offen  lds
    s_add_u32 m0, s49, 116736
    s_waitcnt lgkmcnt(4)
    v_mfma_f32_32x32x16_bf16 v[148:163], v[104:107], v[108:111], v[148:163]
    buffer_load_dwordx4 v14, s[60:63], s53 offen  lds
    s_add_u32 m0, s49, 117760
    v_mfma_f32_32x32x16_bf16 v[164:179], v[104:107], v[112:115], v[164:179]
    buffer_load_dwordx4 v15, s[60:63], s53 offen  lds
    s_waitcnt lgkmcnt(2)
    v_mfma_f32_32x32x16_bf16 v[116:131], v[84:87], v[92:95], v[116:131]
    ds_read_b128 v[100:103], v69 offset:0
    ds_read_b128 v[108:111], v77 offset:0
    s_waitcnt lgkmcnt(3)
    v_mfma_f32_32x32x16_bf16 v[132:147], v[84:87], v[96:99], v[132:147]
    ds_read_b128 v[112:115], v77 offset:4096
    ds_read_b128 v[104:107], v69 offset:4096
    s_waitcnt lgkmcnt(4)
    v_mfma_f32_32x32x16_bf16 v[148:163], v[88:91], v[92:95], v[148:163]
    v_mfma_f32_32x32x16_bf16 v[164:179], v[88:91], v[96:99], v[164:179]
    s_waitcnt lgkmcnt(0)
    s_waitcnt vmcnt(28)
    s_barrier
    s_add_u32 s51, s51, 128
    s_and_b32 s51, s51, 0x7ff
    s_add_u32 s52, s47, s51
    s_add_u32 m0, s49, 0
    v_mfma_f32_32x32x16_bf16 v[116:131], v[100:103], v[108:111], v[116:131]
    ds_read_b128 v[84:87], v66 offset:32768
    ds_read_b128 v[92:95], v74 offset:32768
    buffer_load_dwordx4 v8, s[56:59], s52 offen  lds
    s_add_u32 m0, s49, 1024
    v_mfma_f32_32x32x16_bf16 v[132:147], v[100:103], v[112:115], v[132:147]
    ds_read_b128 v[96:99], v74 offset:36864
    ds_read_b128 v[88:91], v66 offset:36864
    buffer_load_dwordx4 v9, s[56:59], s52 offen  lds
    s_add_u32 m0, s49, 2048
    v_mfma_f32_32x32x16_bf16 v[148:163], v[104:107], v[108:111], v[148:163]
    buffer_load_dwordx4 v10, s[56:59], s52 offen  lds
    s_add_u32 m0, s49, 3072
    v_mfma_f32_32x32x16_bf16 v[164:179], v[104:107], v[112:115], v[164:179]
    buffer_load_dwordx4 v11, s[56:59], s52 offen  lds
    s_waitcnt lgkmcnt(2)
    v_mfma_f32_32x32x16_bf16 v[116:131], v[84:87], v[92:95], v[116:131]
    ds_read_b128 v[100:103], v67 offset:32768
    ds_read_b128 v[108:111], v75 offset:32768
    s_mov_b32 s7, 0x05040100
    s_mov_b32 s12, 0x07060302
    s_waitcnt vmcnt(23)
    s_waitcnt lgkmcnt(3)
    v_mfma_f32_32x32x16_bf16 v[132:147], v[84:87], v[96:99], v[132:147]
    ds_read_b128 v[112:115], v75 offset:36864
    ds_read_b128 v[104:107], v67 offset:36864
    ds_read_b128 v[184:187], v180 offset:0
    s_add_u32 s53, s48, s51
    s_add_u32 m0, s49, 16384
    s_waitcnt lgkmcnt(5)
    v_mfma_f32_32x32x16_bf16 v[148:163], v[88:91], v[92:95], v[148:163]
    buffer_load_dwordx4 v12, s[60:63], s53 offen  lds
    ds_read_b128 v[188:191], v180 offset:16
    s_waitcnt vmcnt(22)
    v_perm_b32 v196, v18, v22, s7
    s_waitcnt vmcnt(21)
    v_perm_b32 v197, v22, v26, s7
    s_add_u32 m0, s49, 17408
    v_mfma_f32_32x32x16_bf16 v[164:179], v[88:91], v[96:99], v[164:179]
    buffer_load_dwordx4 v13, s[60:63], s53 offen  lds
    s_waitcnt vmcnt(21)
    v_perm_b32 v198, v26, v30, s7
    s_waitcnt vmcnt(20)
    v_perm_b32 v199, v30, v34, s7
    s_waitcnt vmcnt(19)
    v_perm_b32 v200, v34, v38, s7
    s_waitcnt vmcnt(18)
    v_perm_b32 v201, v38, v42, s7
    s_waitcnt lgkmcnt(4)
    v_mfma_f32_32x32x16_bf16 v[116:131], v[100:103], v[108:111], v[116:131]
    ds_read_b128 v[84:87], v68 offset:32768
    ds_read_b128 v[92:95], v76 offset:32768
    s_waitcnt vmcnt(17)
    v_lshlrev_b32 v192, 16, v46
    s_waitcnt vmcnt(16)
    v_lshlrev_b32 v193, 16, v50
    s_waitcnt vmcnt(15)
    v_lshlrev_b32 v194, 16, v54
    s_waitcnt lgkmcnt(5)
    v_mfma_f32_32x32x16_bf16 v[132:147], v[100:103], v[112:115], v[132:147]
    ds_read_b128 v[96:99], v76 offset:36864
    ds_read_b128 v[88:91], v68 offset:36864
    s_waitcnt vmcnt(14)
    v_lshlrev_b32 v195, 16, v58
    s_waitcnt lgkmcnt(5)
    v_dot2_f32_bf16 v203, v196, v185, 0
    s_add_u32 m0, s49, 18432
    v_mfma_f32_32x32x16_bf16 v[148:163], v[104:107], v[108:111], v[148:163]
    buffer_load_dwordx4 v14, s[60:63], s53 offen  lds
    v_dot2_f32_bf16 v204, v197, v185, 0
    v_dot2_f32_bf16 v205, v198, v185, 0
    v_dot2_f32_bf16 v206, v199, v185, 0
    s_add_u32 m0, s49, 19456
    v_mfma_f32_32x32x16_bf16 v[164:179], v[104:107], v[112:115], v[164:179]
    buffer_load_dwordx4 v15, s[60:63], s53 offen  lds
    v_dot2c_f32_bf16 v203, v198, v184
    v_dot2c_f32_bf16 v204, v199, v184
    v_dot2c_f32_bf16 v205, v200, v184
    v_dot2c_f32_bf16 v206, v201, v184
    s_waitcnt lgkmcnt(2)
    v_mfma_f32_32x32x16_bf16 v[116:131], v[84:87], v[92:95], v[116:131]
    ds_read_b128 v[100:103], v69 offset:32768
    ds_read_b128 v[108:111], v77 offset:32768
    v_mul_f32 v203, v203, v192
    v_mul_f32 v204, v204, v193
    v_mul_f32 v205, v205, v194
    s_waitcnt lgkmcnt(3)
    v_mfma_f32_32x32x16_bf16 v[132:147], v[84:87], v[96:99], v[132:147]
    ds_read_b128 v[112:115], v77 offset:36864
    ds_read_b128 v[104:107], v69 offset:36864
    v_mul_f32 v206, v206, v195
    v_cvt_pk_bf16_f32 v210, v206, v205
    v_cvt_pk_bf16_f32 v211, v204, v203
    s_waitcnt lgkmcnt(4)
    v_mfma_f32_32x32x16_bf16 v[148:163], v[88:91], v[92:95], v[148:163]
    v_perm_b32 v196, v18, v22, s12
    v_perm_b32 v197, v22, v26, s12
    v_perm_b32 v198, v26, v30, s12
    v_perm_b32 v199, v30, v34, s12
    v_perm_b32 v200, v34, v38, s12
    v_mfma_f32_32x32x16_bf16 v[164:179], v[88:91], v[96:99], v[164:179]
    v_perm_b32 v201, v38, v42, s12
    v_and_b32 v192, s5, v46
    v_and_b32 v193, s5, v50
    v_and_b32 v194, s5, v54
    v_and_b32 v195, s5, v58
    s_waitcnt lgkmcnt(0)
    s_barrier
    v_mfma_f32_32x32x16_bf16 v[116:131], v[100:103], v[108:111], v[116:131]
    ds_read_b128 v[84:87], v70 offset:0
    ds_read_b128 v[92:95], v78 offset:0
    v_dot2_f32_bf16 v203, v196, v187, 0
    v_dot2_f32_bf16 v204, v197, v187, 0
    v_dot2_f32_bf16 v205, v198, v187, 0
    v_mfma_f32_32x32x16_bf16 v[132:147], v[100:103], v[112:115], v[132:147]
    ds_read_b128 v[96:99], v78 offset:4096
    ds_read_b128 v[88:91], v70 offset:4096
    s_add_u32 s51, s51, 128
    s_and_b32 s51, s51, 0x7ff
    s_add_u32 s52, s47, s51
    s_add_u32 m0, s49, 32768
    v_mfma_f32_32x32x16_bf16 v[148:163], v[104:107], v[108:111], v[148:163]
    buffer_load_dwordx4 v8, s[56:59], s52 offen  lds
    v_dot2_f32_bf16 v206, v199, v187, 0
    v_dot2c_f32_bf16 v203, v198, v186
    v_dot2c_f32_bf16 v204, v199, v186
    s_add_u32 m0, s49, 33792
    v_mfma_f32_32x32x16_bf16 v[164:179], v[104:107], v[112:115], v[164:179]
    buffer_load_dwordx4 v9, s[56:59], s52 offen  lds
    v_dot2c_f32_bf16 v205, v200, v186
    v_dot2c_f32_bf16 v206, v201, v186
    v_mul_f32 v203, v203, v192
    v_mul_f32 v204, v204, v193
    s_waitcnt lgkmcnt(2)
    v_mfma_f32_32x32x16_bf16 v[116:131], v[84:87], v[92:95], v[116:131]
    ds_read_b128 v[100:103], v71 offset:0
    ds_read_b128 v[108:111], v79 offset:0
    v_mul_f32 v205, v205, v194
    v_mul_f32 v206, v206, v195
    v_cvt_pk_bf16_f32 v208, v206, v205
    s_waitcnt lgkmcnt(3)
    v_mfma_f32_32x32x16_bf16 v[132:147], v[84:87], v[96:99], v[132:147]
    ds_read_b128 v[112:115], v79 offset:4096
    ds_read_b128 v[104:107], v71 offset:4096
    v_cvt_pk_bf16_f32 v209, v204, v203
    ds_read_b128 v[184:187], v180 offset:32
    s_add_u32 m0, s49, 34816
    s_waitcnt lgkmcnt(5)
    v_mfma_f32_32x32x16_bf16 v[148:163], v[88:91], v[92:95], v[148:163]
    buffer_load_dwordx4 v10, s[56:59], s52 offen  lds
    v_perm_b32 v196, v19, v23, s7
    v_perm_b32 v197, v23, v27, s7
    v_permlane32_swap_b32 v210, v208
    s_add_u32 m0, s49, 35840
    v_mfma_f32_32x32x16_bf16 v[164:179], v[88:91], v[96:99], v[164:179]
    buffer_load_dwordx4 v11, s[56:59], s52 offen  lds
    v_permlane32_swap_b32 v211, v209
    v_perm_b32 v198, v27, v31, s7
    v_perm_b32 v199, v31, v35, s7
    v_perm_b32 v200, v35, v39, s7
    s_waitcnt lgkmcnt(3)
    v_mfma_f32_32x32x16_bf16 v[116:131], v[100:103], v[108:111], v[116:131]
    ds_read_b128 v[84:87], v72 offset:0
    ds_read_b128 v[92:95], v80 offset:0
    v_perm_b32 v201, v39, v43, s7
    v_lshlrev_b32 v192, 16, v47
    v_lshlrev_b32 v193, 16, v51
    s_waitcnt lgkmcnt(4)
    v_mfma_f32_32x32x16_bf16 v[132:147], v[100:103], v[112:115], v[132:147]
    ds_read_b128 v[96:99], v80 offset:4096
    ds_read_b128 v[88:91], v72 offset:4096
    v_lshlrev_b32 v194, 16, v55
    s_add_u32 s53, s48, s51
    s_add_u32 m0, s49, 49152
    s_waitcnt lgkmcnt(5)
    v_mfma_f32_32x32x16_bf16 v[148:163], v[104:107], v[108:111], v[148:163]
    buffer_load_dwordx4 v12, s[60:63], s53 offen  lds
    v_lshlrev_b32 v195, 16, v59
    v_dot2_f32_bf16 v203, v196, v189, 0
    v_dot2_f32_bf16 v204, v197, v189, 0
    s_add_u32 m0, s49, 50176
    v_mfma_f32_32x32x16_bf16 v[164:179], v[104:107], v[112:115], v[164:179]
    buffer_load_dwordx4 v13, s[60:63], s53 offen  lds
    v_dot2_f32_bf16 v205, v198, v189, 0
    v_dot2_f32_bf16 v206, v199, v189, 0
    v_dot2c_f32_bf16 v203, v198, v188
    v_dot2c_f32_bf16 v204, v199, v188
    s_waitcnt lgkmcnt(2)
    v_mfma_f32_32x32x16_bf16 v[116:131], v[84:87], v[92:95], v[116:131]
    ds_read_b128 v[100:103], v73 offset:0
    ds_read_b128 v[108:111], v81 offset:0
    v_dot2c_f32_bf16 v205, v200, v188
    v_dot2c_f32_bf16 v206, v201, v188
    v_mul_f32 v203, v203, v192
    s_waitcnt lgkmcnt(3)
    v_mfma_f32_32x32x16_bf16 v[132:147], v[84:87], v[96:99], v[132:147]
    ds_read_b128 v[112:115], v81 offset:4096
    ds_read_b128 v[104:107], v73 offset:4096
    v_mul_f32 v204, v204, v193
    v_mul_f32 v205, v205, v194
    s_add_u32 m0, s49, 51200
    s_waitcnt lgkmcnt(4)
    v_mfma_f32_32x32x16_bf16 v[148:163], v[88:91], v[92:95], v[148:163]
    buffer_load_dwordx4 v14, s[60:63], s53 offen  lds
    v_mul_f32 v206, v206, v195
    v_cvt_pk_bf16_f32 v214, v206, v205
    v_cvt_pk_bf16_f32 v215, v204, v203
    s_add_u32 m0, s49, 52224
    v_mfma_f32_32x32x16_bf16 v[164:179], v[88:91], v[96:99], v[164:179]
    buffer_load_dwordx4 v15, s[60:63], s53 offen  lds
    v_perm_b32 v196, v19, v23, s12
    v_perm_b32 v197, v23, v27, s12
    v_perm_b32 v198, v27, v31, s12
    v_perm_b32 v199, v31, v35, s12
    s_waitcnt lgkmcnt(0)
    s_waitcnt vmcnt(16)
    s_barrier
    v_mfma_f32_32x32x16_bf16 v[116:131], v[100:103], v[108:111], v[116:131]
    ds_read_b128 v[84:87], v70 offset:32768
    ds_read_b128 v[92:95], v78 offset:32768
    v_perm_b32 v200, v35, v39, s12
    v_perm_b32 v201, v39, v43, s12
    v_and_b32 v192, s5, v47
    v_mfma_f32_32x32x16_bf16 v[132:147], v[100:103], v[112:115], v[132:147]
    ds_read_b128 v[96:99], v78 offset:36864
    ds_read_b128 v[88:91], v70 offset:36864
    s_add_u32 s51, s51, 128
    s_and_b32 s51, s51, 0x7ff
    s_add_u32 s52, s47, s51
    s_add_u32 m0, s49, 65536
    v_mfma_f32_32x32x16_bf16 v[148:163], v[104:107], v[108:111], v[148:163]
    buffer_load_dwordx4 v8, s[56:59], s52 offen  lds
    v_and_b32 v193, s5, v51
    v_and_b32 v194, s5, v55
    v_and_b32 v195, s5, v59
    s_add_u32 m0, s49, 66560
    v_mfma_f32_32x32x16_bf16 v[164:179], v[104:107], v[112:115], v[164:179]
    buffer_load_dwordx4 v9, s[56:59], s52 offen  lds
    v_dot2_f32_bf16 v203, v196, v191, 0
    v_dot2_f32_bf16 v204, v197, v191, 0
    v_dot2_f32_bf16 v205, v198, v191, 0
    v_dot2_f32_bf16 v206, v199, v191, 0
    s_waitcnt lgkmcnt(2)
    v_mfma_f32_32x32x16_bf16 v[116:131], v[84:87], v[92:95], v[116:131]
    ds_read_b128 v[100:103], v71 offset:32768
    ds_read_b128 v[108:111], v79 offset:32768
    v_dot2c_f32_bf16 v203, v198, v190
    v_dot2c_f32_bf16 v204, v199, v190
    s_add_u32 m0, s49, 67584
    s_waitcnt lgkmcnt(3)
    v_mfma_f32_32x32x16_bf16 v[132:147], v[84:87], v[96:99], v[132:147]
    ds_read_b128 v[112:115], v79 offset:36864
    ds_read_b128 v[104:107], v71 offset:36864
    buffer_load_dwordx4 v10, s[56:59], s52 offen  lds
    v_dot2c_f32_bf16 v205, v200, v190
    s_add_u32 m0, s49, 68608
    s_waitcnt lgkmcnt(4)
    v_mfma_f32_32x32x16_bf16 v[148:163], v[88:91], v[92:95], v[148:163]
    buffer_load_dwordx4 v11, s[56:59], s52 offen  lds
    v_dot2c_f32_bf16 v206, v201, v190
    v_mul_f32 v203, v203, v192
    s_add_u32 s53, s48, s51
    s_add_u32 m0, s49, 81920
    v_mfma_f32_32x32x16_bf16 v[164:179], v[88:91], v[96:99], v[164:179]
    buffer_load_dwordx4 v12, s[60:63], s53 offen  lds
    v_mul_f32 v204, v204, v193
    v_mul_f32 v205, v205, v194
    v_mul_f32 v206, v206, v195
    v_cvt_pk_bf16_f32 v212, v206, v205
    s_waitcnt lgkmcnt(2)
    v_mfma_f32_32x32x16_bf16 v[116:131], v[100:103], v[108:111], v[116:131]
    ds_read_b128 v[84:87], v72 offset:32768
    ds_read_b128 v[92:95], v80 offset:32768
    v_cvt_pk_bf16_f32 v213, v204, v203
    ds_read_b128 v[188:191], v180 offset:48
    s_add_u32 m0, s49, 82944
    s_waitcnt lgkmcnt(4)
    v_mfma_f32_32x32x16_bf16 v[132:147], v[100:103], v[112:115], v[132:147]
    ds_read_b128 v[96:99], v80 offset:36864
    ds_read_b128 v[88:91], v72 offset:36864
    buffer_load_dwordx4 v13, s[60:63], s53 offen  lds
    v_perm_b32 v196, v20, v24, s7
    s_add_u32 m0, s49, 83968
    s_waitcnt lgkmcnt(5)
    v_mfma_f32_32x32x16_bf16 v[148:163], v[104:107], v[108:111], v[148:163]
    buffer_load_dwordx4 v14, s[60:63], s53 offen  lds
    v_perm_b32 v197, v24, v28, s7
    v_permlane32_swap_b32 v214, v212
    v_permlane32_swap_b32 v215, v213
    s_add_u32 m0, s49, 84992
    v_mfma_f32_32x32x16_bf16 v[164:179], v[104:107], v[112:115], v[164:179]
    buffer_load_dwordx4 v15, s[60:63], s53 offen  lds
    v_perm_b32 v198, v28, v32, s7
    v_perm_b32 v199, v32, v36, s7
    v_perm_b32 v200, v36, v40, s7
    v_perm_b32 v201, v40, v44, s7
    s_waitcnt lgkmcnt(3)
    v_mfma_f32_32x32x16_bf16 v[116:131], v[84:87], v[92:95], v[116:131]
    ds_read_b128 v[100:103], v73 offset:32768
    ds_read_b128 v[108:111], v81 offset:32768
    v_lshlrev_b32 v192, 16, v48
    v_lshlrev_b32 v193, 16, v52
    s_add_u32 m0, s16, 0
    s_waitcnt lgkmcnt(3)
    v_mfma_f32_32x32x16_bf16 v[132:147], v[84:87], v[96:99], v[132:147]
    ds_read_b128 v[112:115], v81 offset:36864
    ds_read_b128 v[104:107], v73 offset:36864
    buffer_load_dwordx4 v224, s[80:83], s14 offen  lds
    v_lshlrev_b32 v194, 16, v56
    s_add_u32 m0, s16, 1024
    s_waitcnt lgkmcnt(4)
    v_mfma_f32_32x32x16_bf16 v[148:163], v[88:91], v[92:95], v[148:163]
    buffer_load_dwordx4 v224, s[80:83], s15 offen  lds
    v_lshlrev_b32 v195, 16, v60
    v_dot2_f32_bf16 v203, v196, v185, 0
    v_dot2_f32_bf16 v204, v197, v185, 0
    s_add_u32 m0, s16, 2048
    v_mfma_f32_32x32x16_bf16 v[164:179], v[88:91], v[96:99], v[164:179]
    buffer_load_dwordx4 v224, s[84:87], s14 offen  lds
    v_dot2_f32_bf16 v205, v198, v185, 0
    v_dot2_f32_bf16 v206, v199, v185, 0
    v_dot2c_f32_bf16 v203, v198, v184
    v_dot2c_f32_bf16 v204, v199, v184
    s_waitcnt lgkmcnt(0)
    s_waitcnt vmcnt(19)
    s_barrier
    v_mfma_f32_32x32x16_bf16 v[116:131], v[100:103], v[108:111], v[116:131]
    ds_read_b128 v[84:87], v66 offset:0
    ds_read_b128 v[92:95], v74 offset:0
    v_dot2c_f32_bf16 v205, v200, v184
    v_dot2c_f32_bf16 v206, v201, v184
    s_add_u32 m0, s16, 3072
    v_mfma_f32_32x32x16_bf16 v[132:147], v[100:103], v[112:115], v[132:147]
    ds_read_b128 v[96:99], v74 offset:4096
    ds_read_b128 v[88:91], v66 offset:4096
    buffer_load_dwordx4 v224, s[84:87], s15 offen  lds
    s_add_u32 s51, s51, 128
    s_and_b32 s51, s51, 0x7ff
    s_add_u32 s52, s47, s51
    s_add_u32 m0, s49, 98304
    v_mfma_f32_32x32x16_bf16 v[148:163], v[104:107], v[108:111], v[148:163]
    buffer_load_dwordx4 v8, s[56:59], s52 offen  lds
    v_mul_f32 v203, v203, v192
    v_mul_f32 v204, v204, v193
    v_mul_f32 v205, v205, v194
    s_add_u32 m0, s49, 99328
    v_mfma_f32_32x32x16_bf16 v[164:179], v[104:107], v[112:115], v[164:179]
    buffer_load_dwordx4 v9, s[56:59], s52 offen  lds
    v_mul_f32 v206, v206, v195
    v_cvt_pk_bf16_f32 v218, v206, v205
    v_cvt_pk_bf16_f32 v219, v204, v203
    v_perm_b32 v196, v20, v24, s12
    s_waitcnt lgkmcnt(2)
    v_mfma_f32_32x32x16_bf16 v[116:131], v[84:87], v[92:95], v[116:131]
    ds_read_b128 v[100:103], v67 offset:0
    ds_read_b128 v[108:111], v75 offset:0
    v_perm_b32 v197, v24, v28, s12
    v_perm_b32 v198, v28, v32, s12
    v_perm_b32 v199, v32, v36, s12
    s_waitcnt lgkmcnt(3)
    v_mfma_f32_32x32x16_bf16 v[132:147], v[84:87], v[96:99], v[132:147]
    ds_read_b128 v[112:115], v75 offset:4096
    ds_read_b128 v[104:107], v67 offset:4096
    v_perm_b32 v200, v36, v40, s12
    v_perm_b32 v201, v40, v44, s12
    s_add_u32 m0, s49, 100352
    s_waitcnt lgkmcnt(4)
    v_mfma_f32_32x32x16_bf16 v[148:163], v[88:91], v[92:95], v[148:163]
    buffer_load_dwordx4 v10, s[56:59], s52 offen  lds
    v_and_b32 v192, s5, v48
    v_and_b32 v193, s5, v52
    v_and_b32 v194, s5, v56
    s_add_u32 m0, s49, 101376
    v_mfma_f32_32x32x16_bf16 v[164:179], v[88:91], v[96:99], v[164:179]
    buffer_load_dwordx4 v11, s[56:59], s52 offen  lds
    v_and_b32 v195, s5, v60
    v_dot2_f32_bf16 v203, v196, v187, 0
    v_dot2_f32_bf16 v204, v197, v187, 0
    v_dot2_f32_bf16 v205, v198, v187, 0
    s_waitcnt lgkmcnt(2)
    v_mfma_f32_32x32x16_bf16 v[116:131], v[100:103], v[108:111], v[116:131]
    ds_read_b128 v[84:87], v68 offset:0
    ds_read_b128 v[92:95], v76 offset:0
    v_dot2_f32_bf16 v206, v199, v187, 0
    v_dot2c_f32_bf16 v203, v198, v186
    v_dot2c_f32_bf16 v204, v199, v186
    s_waitcnt lgkmcnt(3)
    v_mfma_f32_32x32x16_bf16 v[132:147], v[100:103], v[112:115], v[132:147]
    ds_read_b128 v[96:99], v76 offset:4096
    ds_read_b128 v[88:91], v68 offset:4096
    v_dot2c_f32_bf16 v205, v200, v186
    s_add_u32 s53, s48, s51
    s_add_u32 m0, s49, 114688
    s_waitcnt lgkmcnt(4)
    v_mfma_f32_32x32x16_bf16 v[148:163], v[104:107], v[108:111], v[148:163]
    buffer_load_dwordx4 v12, s[60:63], s53 offen  lds
    v_dot2c_f32_bf16 v206, v201, v186
    v_mul_f32 v203, v203, v192
    v_mul_f32 v204, v204, v193
    s_add_u32 m0, s49, 115712
    v_mfma_f32_32x32x16_bf16 v[164:179], v[104:107], v[112:115], v[164:179]
    buffer_load_dwordx4 v13, s[60:63], s53 offen  lds
    v_mul_f32 v205, v205, v194
    v_mul_f32 v206, v206, v195
    v_cvt_pk_bf16_f32 v216, v206, v205
    v_cvt_pk_bf16_f32 v217, v204, v203
    s_waitcnt lgkmcnt(2)
    v_mfma_f32_32x32x16_bf16 v[116:131], v[84:87], v[92:95], v[116:131]
    ds_read_b128 v[100:103], v69 offset:0
    ds_read_b128 v[108:111], v77 offset:0
    v_perm_b32 v196, v21, v25, s7
    v_perm_b32 v197, v25, v29, s7
    v_permlane32_swap_b32 v218, v216
    s_waitcnt lgkmcnt(3)
    v_mfma_f32_32x32x16_bf16 v[132:147], v[84:87], v[96:99], v[132:147]
    ds_read_b128 v[112:115], v77 offset:4096
    ds_read_b128 v[104:107], v69 offset:4096
    v_permlane32_swap_b32 v219, v217
    v_perm_b32 v198, v29, v33, s7
    s_add_u32 m0, s49, 116736
    s_waitcnt lgkmcnt(4)
    v_mfma_f32_32x32x16_bf16 v[148:163], v[88:91], v[92:95], v[148:163]
    buffer_load_dwordx4 v14, s[60:63], s53 offen  lds
    v_perm_b32 v199, v33, v37, s7
    v_perm_b32 v200, v37, v41, s7
    v_perm_b32 v201, v41, v45, s7
    s_add_u32 m0, s49, 117760
    v_mfma_f32_32x32x16_bf16 v[164:179], v[88:91], v[96:99], v[164:179]
    buffer_load_dwordx4 v15, s[60:63], s53 offen  lds
    v_lshlrev_b32 v192, 16, v49
    v_lshlrev_b32 v193, 16, v53
    v_lshlrev_b32 v194, 16, v57
    v_lshlrev_b32 v195, 16, v61
    s_waitcnt lgkmcnt(0)
    s_waitcnt vmcnt(20)
    s_barrier
    v_mfma_f32_32x32x16_bf16 v[116:131], v[100:103], v[108:111], v[116:131]
    ds_read_b128 v[84:87], v66 offset:32768
    ds_read_b128 v[92:95], v74 offset:32768
    v_dot2_f32_bf16 v203, v196, v189, 0
    v_dot2_f32_bf16 v204, v197, v189, 0
    v_dot2_f32_bf16 v205, v198, v189, 0
    v_mfma_f32_32x32x16_bf16 v[132:147], v[100:103], v[112:115], v[132:147]
    ds_read_b128 v[96:99], v74 offset:36864
    ds_read_b128 v[88:91], v66 offset:36864
    s_add_u32 s51, s51, 128
    s_and_b32 s51, s51, 0x7ff
    s_add_u32 s52, s47, s51
    s_add_u32 m0, s49, 0
    v_mfma_f32_32x32x16_bf16 v[148:163], v[104:107], v[108:111], v[148:163]
    buffer_load_dwordx4 v8, s[56:59], s52 offen  lds
    v_dot2_f32_bf16 v206, v199, v189, 0
    v_dot2c_f32_bf16 v203, v198, v188
    v_dot2c_f32_bf16 v204, v199, v188
    s_add_u32 m0, s49, 1024
    v_mfma_f32_32x32x16_bf16 v[164:179], v[104:107], v[112:115], v[164:179]
    buffer_load_dwordx4 v9, s[56:59], s52 offen  lds
    v_dot2c_f32_bf16 v205, v200, v188
    v_dot2c_f32_bf16 v206, v201, v188
    v_mul_f32 v203, v203, v192
    v_mul_f32 v204, v204, v193
    s_waitcnt lgkmcnt(2)
    v_mfma_f32_32x32x16_bf16 v[116:131], v[84:87], v[92:95], v[116:131]
    ds_read_b128 v[100:103], v67 offset:32768
    ds_read_b128 v[108:111], v75 offset:32768
    v_mul_f32 v205, v205, v194
    v_mul_f32 v206, v206, v195
    v_cvt_pk_bf16_f32 v222, v206, v205
    s_waitcnt lgkmcnt(3)
    v_mfma_f32_32x32x16_bf16 v[132:147], v[84:87], v[96:99], v[132:147]
    ds_read_b128 v[112:115], v75 offset:36864
    ds_read_b128 v[104:107], v67 offset:36864
    v_cvt_pk_bf16_f32 v223, v204, v203
    v_perm_b32 v196, v21, v25, s12
    s_add_u32 m0, s49, 2048
    s_waitcnt lgkmcnt(4)
    v_mfma_f32_32x32x16_bf16 v[148:163], v[88:91], v[92:95], v[148:163]
    buffer_load_dwordx4 v10, s[56:59], s52 offen  lds
    v_perm_b32 v197, v25, v29, s12
    v_perm_b32 v198, v29, v33, s12
    v_perm_b32 v199, v33, v37, s12
    s_add_u32 m0, s49, 3072
    v_mfma_f32_32x32x16_bf16 v[164:179], v[88:91], v[96:99], v[164:179]
    buffer_load_dwordx4 v11, s[56:59], s52 offen  lds
    v_perm_b32 v200, v37, v41, s12
    v_perm_b32 v201, v41, v45, s12
    v_and_b32 v192, s5, v49
    v_and_b32 v193, s5, v53
    s_waitcnt lgkmcnt(2)
    v_mfma_f32_32x32x16_bf16 v[116:131], v[100:103], v[108:111], v[116:131]
    ds_read_b128 v[84:87], v68 offset:32768
    ds_read_b128 v[92:95], v76 offset:32768
    v_and_b32 v194, s5, v57
    v_and_b32 v195, s5, v61
    v_dot2_f32_bf16 v203, v196, v191, 0
    s_waitcnt lgkmcnt(3)
    v_mfma_f32_32x32x16_bf16 v[132:147], v[100:103], v[112:115], v[132:147]
    ds_read_b128 v[96:99], v76 offset:36864
    ds_read_b128 v[88:91], v68 offset:36864
    v_dot2_f32_bf16 v204, v197, v191, 0
    s_add_u32 s53, s48, s51
    s_add_u32 m0, s49, 16384
    s_waitcnt lgkmcnt(4)
    v_mfma_f32_32x32x16_bf16 v[148:163], v[104:107], v[108:111], v[148:163]
    buffer_load_dwordx4 v12, s[60:63], s53 offen  lds
    v_dot2_f32_bf16 v205, v198, v191, 0
    v_dot2_f32_bf16 v206, v199, v191, 0
    v_dot2c_f32_bf16 v203, v198, v190
    s_add_u32 m0, s49, 17408
    v_mfma_f32_32x32x16_bf16 v[164:179], v[104:107], v[112:115], v[164:179]
    buffer_load_dwordx4 v13, s[60:63], s53 offen  lds
    v_dot2c_f32_bf16 v204, v199, v190
    v_dot2c_f32_bf16 v205, v200, v190
    v_dot2c_f32_bf16 v206, v201, v190
    v_mul_f32 v203, v203, v192
    s_waitcnt lgkmcnt(2)
    v_mfma_f32_32x32x16_bf16 v[116:131], v[84:87], v[92:95], v[116:131]
    ds_read_b128 v[100:103], v69 offset:32768
    ds_read_b128 v[108:111], v77 offset:32768
    v_mul_f32 v204, v204, v193
    v_mul_f32 v205, v205, v194
    v_mul_f32 v206, v206, v195
    s_waitcnt lgkmcnt(3)
    v_mfma_f32_32x32x16_bf16 v[132:147], v[84:87], v[96:99], v[132:147]
    ds_read_b128 v[112:115], v77 offset:36864
    ds_read_b128 v[104:107], v69 offset:36864
    v_cvt_pk_bf16_f32 v220, v206, v205
    v_cvt_pk_bf16_f32 v221, v204, v203
    s_add_u32 m0, s49, 18432
    s_waitcnt lgkmcnt(4)
    v_mfma_f32_32x32x16_bf16 v[148:163], v[88:91], v[92:95], v[148:163]
    buffer_load_dwordx4 v14, s[60:63], s53 offen  lds
    v_permlane32_swap_b32 v222, v220
    v_permlane32_swap_b32 v223, v221
    s_add_u32 m0, s49, 19456
    v_mfma_f32_32x32x16_bf16 v[164:179], v[88:91], v[96:99], v[164:179]
    buffer_load_dwordx4 v15, s[60:63], s53 offen  lds
    s_waitcnt lgkmcnt(0)
    s_waitcnt vmcnt(20)
    s_barrier
    v_mfma_f32_32x32x16_bf16 v[116:131], v[100:103], v[108:111], v[116:131]
    ds_read_b128 v[84:87], v70 offset:0
    ds_read_b128 v[92:95], v78 offset:0
    v_mfma_f32_32x32x16_bf16 v[132:147], v[100:103], v[112:115], v[132:147]
    ds_read_b128 v[96:99], v78 offset:4096
    ds_read_b128 v[88:91], v70 offset:4096
    s_add_u32 s51, s51, 128
    s_and_b32 s51, s51, 0x7ff
    s_add_u32 s52, s47, s51
    s_add_u32 m0, s49, 32768
    v_mfma_f32_32x32x16_bf16 v[148:163], v[104:107], v[108:111], v[148:163]
    buffer_load_dwordx4 v8, s[56:59], s52 offen  lds
    s_add_u32 m0, s49, 33792
    v_mfma_f32_32x32x16_bf16 v[164:179], v[104:107], v[112:115], v[164:179]
    buffer_load_dwordx4 v9, s[56:59], s52 offen  lds
    s_waitcnt lgkmcnt(2)
    v_mfma_f32_32x32x16_bf16 v[116:131], v[84:87], v[92:95], v[116:131]
    ds_read_b128 v[100:103], v71 offset:0
    ds_read_b128 v[108:111], v79 offset:0
    s_waitcnt lgkmcnt(3)
    v_mfma_f32_32x32x16_bf16 v[132:147], v[84:87], v[96:99], v[132:147]
    ds_read_b128 v[112:115], v79 offset:4096
    ds_read_b128 v[104:107], v71 offset:4096
    s_add_u32 m0, s49, 34816
    s_waitcnt lgkmcnt(4)
    v_mfma_f32_32x32x16_bf16 v[148:163], v[88:91], v[92:95], v[148:163]
    buffer_load_dwordx4 v10, s[56:59], s52 offen  lds
    s_add_u32 m0, s49, 35840
    v_mfma_f32_32x32x16_bf16 v[164:179], v[88:91], v[96:99], v[164:179]
    buffer_load_dwordx4 v11, s[56:59], s52 offen  lds
    s_waitcnt lgkmcnt(2)
    v_mfma_f32_32x32x16_bf16 v[116:131], v[100:103], v[108:111], v[116:131]
    ds_read_b128 v[84:87], v72 offset:0
    ds_read_b128 v[92:95], v80 offset:0
    s_waitcnt lgkmcnt(3)
    v_mfma_f32_32x32x16_bf16 v[132:147], v[100:103], v[112:115], v[132:147]
    ds_read_b128 v[96:99], v80 offset:4096
    ds_read_b128 v[88:91], v72 offset:4096
    s_add_u32 s53, s48, s51
    s_add_u32 m0, s49, 49152
    s_waitcnt lgkmcnt(4)
    v_mfma_f32_32x32x16_bf16 v[148:163], v[104:107], v[108:111], v[148:163]
    buffer_load_dwordx4 v12, s[60:63], s53 offen  lds
    s_add_u32 m0, s49, 50176
    v_mfma_f32_32x32x16_bf16 v[164:179], v[104:107], v[112:115], v[164:179]
    buffer_load_dwordx4 v13, s[60:63], s53 offen  lds
    s_waitcnt lgkmcnt(2)
    v_mfma_f32_32x32x16_bf16 v[116:131], v[84:87], v[92:95], v[116:131]
    ds_read_b128 v[100:103], v73 offset:0
    ds_read_b128 v[108:111], v81 offset:0
    s_waitcnt lgkmcnt(3)
    v_mfma_f32_32x32x16_bf16 v[132:147], v[84:87], v[96:99], v[132:147]
    ds_read_b128 v[112:115], v81 offset:4096
    ds_read_b128 v[104:107], v73 offset:4096
    s_add_u32 m0, s49, 51200
    s_waitcnt lgkmcnt(4)
    v_mfma_f32_32x32x16_bf16 v[148:163], v[88:91], v[92:95], v[148:163]
    buffer_load_dwordx4 v14, s[60:63], s53 offen  lds
    s_add_u32 m0, s49, 52224
    v_mfma_f32_32x32x16_bf16 v[164:179], v[88:91], v[96:99], v[164:179]
    buffer_load_dwordx4 v15, s[60:63], s53 offen  lds
    s_waitcnt lgkmcnt(0)
    s_waitcnt vmcnt(16)
    s_barrier
    v_mfma_f32_32x32x16_bf16 v[116:131], v[100:103], v[108:111], v[116:131]
    ds_read_b128 v[84:87], v70 offset:32768
    ds_read_b128 v[92:95], v78 offset:32768
    v_mov_b32 v3, 0
    buffer_load_dwordx2 v[4:5], v3, s[24:27], 0 offen sc0 sc1
    v_mfma_f32_32x32x16_bf16 v[132:147], v[100:103], v[112:115], v[132:147]
    ds_read_b128 v[96:99], v78 offset:36864
    ds_read_b128 v[88:91], v70 offset:36864
    s_add_u32 s51, s51, 128
    s_and_b32 s51, s51, 0x7ff
    s_add_u32 s52, s47, s51
    s_add_u32 m0, s49, 65536
    v_mfma_f32_32x32x16_bf16 v[148:163], v[104:107], v[108:111], v[148:163]
    buffer_load_dwordx4 v8, s[56:59], s52 offen  lds
    buffer_store_dwordx4 v[208:211], v181, s[8:11], s6 offen sc0 sc1
    s_add_u32 m0, s49, 66560
    v_mfma_f32_32x32x16_bf16 v[164:179], v[104:107], v[112:115], v[164:179]
    buffer_load_dwordx4 v9, s[56:59], s52 offen  lds
    s_add_u32 s6, s6, 32768
    buffer_store_dwordx4 v[212:215], v181, s[8:11], s6 offen sc0 sc1
    s_waitcnt lgkmcnt(2)
    v_mfma_f32_32x32x16_bf16 v[116:131], v[84:87], v[92:95], v[116:131]
    ds_read_b128 v[100:103], v71 offset:32768
    ds_read_b128 v[108:111], v79 offset:32768
    s_add_u32 s6, s6, 32768
    buffer_store_dwordx4 v[216:219], v181, s[8:11], s6 offen sc0 sc1
    s_waitcnt lgkmcnt(3)
    v_mfma_f32_32x32x16_bf16 v[132:147], v[84:87], v[96:99], v[132:147]
    ds_read_b128 v[112:115], v79 offset:36864
    ds_read_b128 v[104:107], v71 offset:36864
    s_add_u32 s6, s6, 32768
    s_add_u32 m0, s49, 67584
    s_waitcnt lgkmcnt(4)
    v_mfma_f32_32x32x16_bf16 v[148:163], v[88:91], v[92:95], v[148:163]
    buffer_load_dwordx4 v10, s[56:59], s52 offen  lds
    buffer_store_dwordx4 v[220:223], v181, s[8:11], s6 offen sc0 sc1
    s_add_u32 m0, s49, 68608
    v_mfma_f32_32x32x16_bf16 v[164:179], v[88:91], v[96:99], v[164:179]
    buffer_load_dwordx4 v11, s[56:59], s52 offen  lds
    s_mov_b64 s[30:31], exec
    s_mov_b32 exec_lo, 0
    s_mov_b32 exec_hi, 0x80000000
    buffer_store_dwordx2 v[226:227], v225, s[8:11], 0 offen sc0 sc1
    buffer_store_dwordx2 v[228:229], v225, s[8:11], s32 offen sc0 sc1
    s_mov_b64 exec, s[30:31]
    s_waitcnt lgkmcnt(2)
    v_mfma_f32_32x32x16_bf16 v[116:131], v[100:103], v[108:111], v[116:131]
    ds_read_b128 v[84:87], v72 offset:32768
    ds_read_b128 v[92:95], v80 offset:32768
    s_waitcnt lgkmcnt(3)
    v_mfma_f32_32x32x16_bf16 v[132:147], v[100:103], v[112:115], v[132:147]
    ds_read_b128 v[96:99], v80 offset:36864
    ds_read_b128 v[88:91], v72 offset:36864
    s_add_u32 s53, s48, s51
    s_add_u32 m0, s49, 81920
    s_waitcnt lgkmcnt(4)
    v_mfma_f32_32x32x16_bf16 v[148:163], v[104:107], v[108:111], v[148:163]
    buffer_load_dwordx4 v12, s[60:63], s53 offen  lds
    s_add_u32 m0, s49, 82944
    v_mfma_f32_32x32x16_bf16 v[164:179], v[104:107], v[112:115], v[164:179]
    buffer_load_dwordx4 v13, s[60:63], s53 offen  lds
    s_waitcnt lgkmcnt(2)
    v_mfma_f32_32x32x16_bf16 v[116:131], v[84:87], v[92:95], v[116:131]
    ds_read_b128 v[100:103], v73 offset:32768
    ds_read_b128 v[108:111], v81 offset:32768
    s_waitcnt lgkmcnt(3)
    v_mfma_f32_32x32x16_bf16 v[132:147], v[84:87], v[96:99], v[132:147]
    ds_read_b128 v[112:115], v81 offset:36864
    ds_read_b128 v[104:107], v73 offset:36864
    s_add_u32 m0, s49, 83968
    s_waitcnt lgkmcnt(4)
    v_mfma_f32_32x32x16_bf16 v[148:163], v[88:91], v[92:95], v[148:163]
    buffer_load_dwordx4 v14, s[60:63], s53 offen  lds
    s_add_u32 m0, s49, 84992
    v_mfma_f32_32x32x16_bf16 v[164:179], v[88:91], v[96:99], v[164:179]
    buffer_load_dwordx4 v15, s[60:63], s53 offen  lds
    s_waitcnt lgkmcnt(0)
    s_waitcnt vmcnt(23)
    s_barrier
    v_mfma_f32_32x32x16_bf16 v[116:131], v[100:103], v[108:111], v[116:131]
    ds_read_b128 v[84:87], v66 offset:0
    ds_read_b128 v[92:95], v74 offset:0
    v_mfma_f32_32x32x16_bf16 v[132:147], v[100:103], v[112:115], v[132:147]
    ds_read_b128 v[96:99], v74 offset:4096
    ds_read_b128 v[88:91], v66 offset:4096
    s_add_u32 s51, s51, 128
    s_and_b32 s51, s51, 0x7ff
    s_add_u32 s52, s47, s51
    s_add_u32 m0, s49, 98304
    v_mfma_f32_32x32x16_bf16 v[148:163], v[104:107], v[108:111], v[148:163]
    buffer_load_dwordx4 v8, s[56:59], s52 offen  lds
    s_add_u32 m0, s49, 99328
    v_mfma_f32_32x32x16_bf16 v[164:179], v[104:107], v[112:115], v[164:179]
    buffer_load_dwordx4 v9, s[56:59], s52 offen  lds
    s_waitcnt lgkmcnt(2)
    v_mfma_f32_32x32x16_bf16 v[116:131], v[84:87], v[92:95], v[116:131]
    ds_read_b128 v[100:103], v67 offset:0
    ds_read_b128 v[108:111], v75 offset:0
    s_waitcnt lgkmcnt(3)
    v_mfma_f32_32x32x16_bf16 v[132:147], v[84:87], v[96:99], v[132:147]
    ds_read_b128 v[112:115], v75 offset:4096
    ds_read_b128 v[104:107], v67 offset:4096
    s_add_u32 m0, s49, 100352
    s_waitcnt lgkmcnt(4)
    v_mfma_f32_32x32x16_bf16 v[148:163], v[88:91], v[92:95], v[148:163]
    buffer_load_dwordx4 v10, s[56:59], s52 offen  lds
    s_add_u32 m0, s49, 101376
    v_mfma_f32_32x32x16_bf16 v[164:179], v[88:91], v[96:99], v[164:179]
    buffer_load_dwordx4 v11, s[56:59], s52 offen  lds
    s_waitcnt lgkmcnt(2)
    v_mfma_f32_32x32x16_bf16 v[116:131], v[100:103], v[108:111], v[116:131]
    ds_read_b128 v[84:87], v68 offset:0
    ds_read_b128 v[92:95], v76 offset:0
    s_waitcnt lgkmcnt(3)
    v_mfma_f32_32x32x16_bf16 v[132:147], v[100:103], v[112:115], v[132:147]
    ds_read_b128 v[96:99], v76 offset:4096
    ds_read_b128 v[88:91], v68 offset:4096
    s_add_u32 s53, s48, s51
    s_add_u32 m0, s49, 114688
    s_waitcnt lgkmcnt(4)
    v_mfma_f32_32x32x16_bf16 v[148:163], v[104:107], v[108:111], v[148:163]
    buffer_load_dwordx4 v12, s[60:63], s53 offen  lds
    s_add_u32 m0, s49, 115712
    v_mfma_f32_32x32x16_bf16 v[164:179], v[104:107], v[112:115], v[164:179]
    buffer_load_dwordx4 v13, s[60:63], s53 offen  lds
    s_waitcnt lgkmcnt(2)
    v_mfma_f32_32x32x16_bf16 v[116:131], v[84:87], v[92:95], v[116:131]
    ds_read_b128 v[100:103], v69 offset:0
    ds_read_b128 v[108:111], v77 offset:0
    s_waitcnt lgkmcnt(3)
    v_mfma_f32_32x32x16_bf16 v[132:147], v[84:87], v[96:99], v[132:147]
    ds_read_b128 v[112:115], v77 offset:4096
    ds_read_b128 v[104:107], v69 offset:4096
    s_add_u32 m0, s49, 116736
    s_waitcnt lgkmcnt(4)
    v_mfma_f32_32x32x16_bf16 v[148:163], v[88:91], v[92:95], v[148:163]
    buffer_load_dwordx4 v14, s[60:63], s53 offen  lds
    s_add_u32 m0, s49, 117760
    v_mfma_f32_32x32x16_bf16 v[164:179], v[88:91], v[96:99], v[164:179]
    buffer_load_dwordx4 v15, s[60:63], s53 offen  lds
    s_waitcnt lgkmcnt(0)
    s_waitcnt vmcnt(23)
    s_barrier
    v_mfma_f32_32x32x16_bf16 v[116:131], v[100:103], v[108:111], v[116:131]
    ds_read_b128 v[84:87], v66 offset:32768
    ds_read_b128 v[92:95], v74 offset:32768
    s_lshl_b32 s6, s46, 2
    s_add_u32 s6, s6, s44
    s_lshl_b32 s6, s6, 16
    s_lshl_b32 s3, s45, 12
    v_mfma_f32_32x32x16_bf16 v[132:147], v[100:103], v[112:115], v[132:147]
    ds_read_b128 v[96:99], v74 offset:36864
    ds_read_b128 v[88:91], v66 offset:36864
    s_add_u32 s6, s6, s3
    s_add_u32 s6, s6, 16777216
    s_mov_b32 s7, 0x05040100
    s_mov_b32 s12, 0x07060302
    v_mfma_f32_32x32x16_bf16 v[148:163], v[104:107], v[108:111], v[148:163]
    v_and_b32 v20, 31, v2
    v_lshlrev_b32 v18, 6, v20
    v_bfe_u32 v20, v2, 2, 2
    v_lshrrev_b32 v21, 5, v2
    v_lshlrev_b32 v21, 1, v21
    v_xor_b32 v20, v20, v21
    v_mfma_f32_32x32x16_bf16 v[164:179], v[104:107], v[112:115], v[164:179]
    v_lshl_add_u32 v18, v20, 4, v18
    v_add_u32 v18, s16, v18
    v_xor_b32 v19, 16, v18
    ds_read_b128 v[22:25], v18 offset:0
    ds_read_b128 v[26:29], v19 offset:0
    s_waitcnt lgkmcnt(4)
    v_mfma_f32_32x32x16_bf16 v[116:131], v[84:87], v[92:95], v[116:131]
    ds_read_b128 v[100:103], v67 offset:32768
    ds_read_b128 v[108:111], v75 offset:32768
    ds_read_b128 v[30:33], v18 offset:2048
    ds_read_b128 v[34:37], v19 offset:2048
    s_waitcnt lgkmcnt(1)
    v_perm_b32 v38, v30, v22, s7
    v_perm_b32 v39, v30, v22, s12
    v_mfma_f32_32x32x16_bf16 v[132:147], v[84:87], v[96:99], v[132:147]
    ds_read_b128 v[112:115], v75 offset:36864
    ds_read_b128 v[104:107], v67 offset:36864
    v_perm_b32 v40, v31, v23, s7
    v_perm_b32 v41, v31, v23, s12
    buffer_store_dwordx4 v[38:41], v17, s[8:11], s6 offen offset:0 sc0 sc1
    v_perm_b32 v42, v32, v24, s7
    v_mfma_f32_32x32x16_bf16 v[148:163], v[88:91], v[92:95], v[148:163]
    v_perm_b32 v43, v32, v24, s12
    v_perm_b32 v44, v33, v25, s7
    v_perm_b32 v45, v33, v25, s12
    buffer_store_dwordx4 v[42:45], v17, s[8:11], s6 offen offset:1024 sc0 sc1
    s_waitcnt lgkmcnt(2)
    v_perm_b32 v38, v34, v26, s7
    v_perm_b32 v39, v34, v26, s12
    v_mfma_f32_32x32x16_bf16 v[164:179], v[88:91], v[96:99], v[164:179]
    v_perm_b32 v40, v35, v27, s7
    v_perm_b32 v41, v35, v27, s12
    buffer_store_dwordx4 v[38:41], v17, s[8:11], s6 offen offset:2048 sc0 sc1
    v_perm_b32 v42, v36, v28, s7
    v_perm_b32 v43, v36, v28, s12
    v_perm_b32 v44, v37, v29, s7
    v_mfma_f32_32x32x16_bf16 v[116:131], v[100:103], v[108:111], v[116:131]
    ds_read_b128 v[84:87], v68 offset:32768
    ds_read_b128 v[92:95], v76 offset:32768
    v_perm_b32 v45, v37, v29, s12
    buffer_store_dwordx4 v[42:45], v17, s[8:11], s6 offen offset:3072 sc0 sc1
    s_waitcnt lgkmcnt(3)
    v_mfma_f32_32x32x16_bf16 v[132:147], v[100:103], v[112:115], v[132:147]
    ds_read_b128 v[96:99], v76 offset:36864
    ds_read_b128 v[88:91], v68 offset:36864
    s_waitcnt lgkmcnt(4)
    v_mfma_f32_32x32x16_bf16 v[148:163], v[104:107], v[108:111], v[148:163]
    v_mfma_f32_32x32x16_bf16 v[164:179], v[104:107], v[112:115], v[164:179]
    s_waitcnt lgkmcnt(2)
    v_mfma_f32_32x32x16_bf16 v[116:131], v[84:87], v[92:95], v[116:131]
    ds_read_b128 v[100:103], v69 offset:32768
    ds_read_b128 v[108:111], v77 offset:32768
    s_waitcnt lgkmcnt(3)
    v_mfma_f32_32x32x16_bf16 v[132:147], v[84:87], v[96:99], v[132:147]
    ds_read_b128 v[112:115], v77 offset:36864
    ds_read_b128 v[104:107], v69 offset:36864
    s_waitcnt lgkmcnt(4)
    v_mfma_f32_32x32x16_bf16 v[148:163], v[88:91], v[92:95], v[148:163]
    v_mfma_f32_32x32x16_bf16 v[164:179], v[88:91], v[96:99], v[164:179]
    s_waitcnt lgkmcnt(0)
    s_waitcnt vmcnt(12)
    s_barrier
    v_mfma_f32_32x32x16_bf16 v[116:131], v[100:103], v[108:111], v[116:131]
    ds_read_b128 v[84:87], v70 offset:0
    ds_read_b128 v[92:95], v78 offset:0
    v_subrev_u32 v50, 32, v17
    v_min_u32 v50, 0x7fff0000, v50
    v_add_u32 v51, s23, v17
    buffer_load_dwordx4 v[38:41], v50, s[76:79], 0 offen nt
    v_mfma_f32_32x32x16_bf16 v[132:147], v[100:103], v[112:115], v[132:147]
    ds_read_b128 v[96:99], v78 offset:4096
    ds_read_b128 v[88:91], v70 offset:4096
    buffer_load_dwordx4 v[22:25], v17, s[76:79], 0 offen offset:0 nt
    v_mfma_f32_32x32x16_bf16 v[148:163], v[104:107], v[108:111], v[148:163]
    buffer_load_dwordx4 v[26:29], v17, s[76:79], 0 offen offset:1024 nt
    v_mfma_f32_32x32x16_bf16 v[164:179], v[104:107], v[112:115], v[164:179]
    buffer_load_dwordx4 v[30:33], v17, s[76:79], 0 offen offset:2048 nt
    buffer_load_dwordx4 v[34:37], v17, s[76:79], 0 offen offset:3072 nt
    s_waitcnt lgkmcnt(2)
    v_mfma_f32_32x32x16_bf16 v[116:131], v[84:87], v[92:95], v[116:131]
    ds_read_b128 v[100:103], v71 offset:0
    ds_read_b128 v[108:111], v79 offset:0
    s_mov_b32 s88, s20
    s_waitcnt lgkmcnt(3)
    v_mfma_f32_32x32x16_bf16 v[132:147], v[84:87], v[96:99], v[132:147]
    ds_read_b128 v[112:115], v79 offset:4096
    ds_read_b128 v[104:107], v71 offset:4096
    s_mov_b32 s89, s21
    s_mov_b32 s90, 2048
    s_mov_b32 s91, 131072
    s_and_b32 s3, s44, 1
    s_waitcnt lgkmcnt(4)
    v_mfma_f32_32x32x16_bf16 v[148:163], v[88:91], v[92:95], v[148:163]
    s_lshl_b32 s3, s3, 5
    s_and_b32 s3, s44, 1
    s_lshl_b32 s3, s3, 6
    v_and_b32 v52, 31, v2
    v_lshl_add_u32 v52, v52, 1, s3
    s_lshl_b32 s3, s46, 7
    buffer_load_ushort v52, v52, s[88:91], s3 offen
    v_and_b32 v53, 15, v2
    v_lshrrev_b32 v54, 4, v2
    v_mfma_f32_32x32x16_bf16 v[164:179], v[88:91], v[96:99], v[164:179]
    v_add_u32 v55, 1, v53
    v_and_b32 v56, 1, v55
    v_mul_u32_u24 v56, 4160, v56
    v_and_b32 v55, 30, v55
    v_lshl_add_u32 v56, v55, 1, v56
    v_lshl_add_u32 v56, v54, 4, v56
    s_waitcnt lgkmcnt(2)
    v_mfma_f32_32x32x16_bf16 v[116:131], v[100:103], v[108:111], v[116:131]
    ds_read_b128 v[84:87], v72 offset:0
    ds_read_b128 v[92:95], v80 offset:0
    v_add_u32 v57, s23, v56
    v_add_u32 v63, 1024, v57
    v_add_u32 v64, 2048, v57
    v_add_u32 v65, 3072, v57
    s_waitcnt lgkmcnt(3)
    v_mfma_f32_32x32x16_bf16 v[132:147], v[100:103], v[112:115], v[132:147]
    ds_read_b128 v[96:99], v80 offset:4096
    ds_read_b128 v[88:91], v72 offset:4096
    v_lshlrev_b32 v55, 1, v53
    v_sub_u32 v55, v54, v55
    v_add_u32 v55, 30, v55
    v_lshrrev_b32 v56, 2, v55
    s_waitcnt lgkmcnt(4)
    v_mfma_f32_32x32x16_bf16 v[148:163], v[104:107], v[108:111], v[148:163]
    v_lshlrev_b32 v55, 6, v55
    v_add_u32 v55, 132096, v55
    v_add_u32 v58, 63, v56
    v_and_b32 v58, 3, v58
    v_xor_b32 v58, s44, v58
    v_lshl_add_u32 v58, v58, 4, v55
    v_mfma_f32_32x32x16_bf16 v[164:179], v[104:107], v[112:115], v[164:179]
    v_add_u32 v59, 62, v56
    v_and_b32 v59, 3, v59
    v_xor_b32 v59, s44, v59
    v_lshl_add_u32 v59, v59, 4, v55
    v_add_u32 v60, 61, v56
    v_and_b32 v60, 3, v60
    s_waitcnt lgkmcnt(2)
    v_mfma_f32_32x32x16_bf16 v[116:131], v[84:87], v[92:95], v[116:131]
    ds_read_b128 v[100:103], v73 offset:0
    ds_read_b128 v[108:111], v81 offset:0
    v_xor_b32 v60, s44, v60
    v_lshl_add_u32 v60, v60, 4, v55
    v_add_u32 v61, 60, v56
    v_and_b32 v61, 3, v61
    s_waitcnt lgkmcnt(3)
    v_mfma_f32_32x32x16_bf16 v[132:147], v[84:87], v[96:99], v[132:147]
    ds_read_b128 v[112:115], v81 offset:4096
    ds_read_b128 v[104:107], v73 offset:4096
    v_xor_b32 v61, s44, v61
    v_lshl_add_u32 v61, v61, 4, v55
    v_lshlrev_b32 v55, 5, v53
    v_lshl_add_u32 v55, v54, 3, v55
    s_waitcnt lgkmcnt(4)
    v_mfma_f32_32x32x16_bf16 v[148:163], v[88:91], v[92:95], v[148:163]
    v_sub_u32 v55, 504, v55
    v_and_b32 v62, 8, v55
    v_lshrrev_b32 v55, 4, v55
    v_lshl_add_u32 v62, v55, 6, v62
    v_bfe_u32 v55, v55, 2, 2
    v_xor_b32 v55, s44, v55
    v_mfma_f32_32x32x16_bf16 v[164:179], v[88:91], v[96:99], v[164:179]
    v_lshl_add_u32 v62, v55, 4, v62
    v_add_u32 v62, 132096, v62
    v_and_b32 v55, 1, v54
    v_lshlrev_b32 v55, 9, v55
    v_lshl_add_u32 v55, v53, 5, v55
    v_lshrrev_b32 v56, 1, v54
    s_waitcnt lgkmcnt(0)
    s_waitcnt vmcnt(10)
    s_barrier
    v_mfma_f32_32x32x16_bf16 v[116:131], v[100:103], v[108:111], v[116:131]
    ds_read_b128 v[84:87], v70 offset:32768
    ds_read_b128 v[92:95], v78 offset:32768
    v_lshl_add_u32 v180, v56, 4, v55
    s_mov_b32 s6, 0
    v_readfirstlane_b32 s42, v4
    v_readfirstlane_b32 s43, v5
    s_nop 3
    s_or_b32 s3, s42, s43
    s_cmp_lg_u32 s3, 0
    s_cbranch_scc1 Lnok_gate_2
Lnretry_gate_3:
    buffer_load_dwordx2 v[4:5], v3, s[24:27], 0 offen sc0 sc1
    s_waitcnt vmcnt(0)
    v_readfirstlane_b32 s42, v4
    v_readfirstlane_b32 s43, v5
    s_add_u32 s6, s6, 1
    s_nop 3
    s_or_b32 s3, s42, s43
    s_cmp_gt_u32 s6, 20000
    s_cbranch_scc1 Lnok_gate_2
    s_cmp_eq_u32 s3, 0
    s_cbranch_scc1 Lnretry_gate_3
Lnok_gate_2:
    v_mov_b32 v82, s42
    v_mov_b32 v83, s43
    s_mov_b64 s[6:7], exec
    s_mov_b64 exec, 1
    buffer_store_dwordx2 v[82:83], v6, s[8:11], s13 offen sc0 sc1
    s_mov_b64 exec, s[6:7]
    v_mfma_f32_32x32x16_bf16 v[132:147], v[100:103], v[112:115], v[132:147]
    ds_read_b128 v[96:99], v78 offset:36864
    ds_read_b128 v[88:91], v70 offset:36864
    v_mfma_f32_32x32x16_bf16 v[148:163], v[104:107], v[108:111], v[148:163]
    v_mfma_f32_32x32x16_bf16 v[164:179], v[104:107], v[112:115], v[164:179]
    s_waitcnt lgkmcnt(2)
    v_mfma_f32_32x32x16_bf16 v[116:131], v[84:87], v[92:95], v[116:131]
    ds_read_b128 v[100:103], v71 offset:32768
    ds_read_b128 v[108:111], v79 offset:32768
    s_waitcnt lgkmcnt(3)
    v_mfma_f32_32x32x16_bf16 v[132:147], v[84:87], v[96:99], v[132:147]
    ds_read_b128 v[112:115], v79 offset:36864
    ds_read_b128 v[104:107], v71 offset:36864
    s_waitcnt lgkmcnt(4)
    v_mfma_f32_32x32x16_bf16 v[148:163], v[88:91], v[92:95], v[148:163]
    v_mfma_f32_32x32x16_bf16 v[164:179], v[88:91], v[96:99], v[164:179]
    s_waitcnt lgkmcnt(2)
    v_mfma_f32_32x32x16_bf16 v[116:131], v[100:103], v[108:111], v[116:131]
    ds_read_b128 v[84:87], v72 offset:32768
    ds_read_b128 v[92:95], v80 offset:32768
    s_waitcnt lgkmcnt(3)
    v_mfma_f32_32x32x16_bf16 v[132:147], v[100:103], v[112:115], v[132:147]
    ds_read_b128 v[96:99], v80 offset:36864
    ds_read_b128 v[88:91], v72 offset:36864
    s_waitcnt lgkmcnt(4)
    v_mfma_f32_32x32x16_bf16 v[148:163], v[104:107], v[108:111], v[148:163]
    v_mfma_f32_32x32x16_bf16 v[164:179], v[104:107], v[112:115], v[164:179]
    s_waitcnt lgkmcnt(2)
    v_mfma_f32_32x32x16_bf16 v[116:131], v[84:87], v[92:95], v[116:131]
    ds_read_b128 v[100:103], v73 offset:32768
    ds_read_b128 v[108:111], v81 offset:32768
    s_waitcnt lgkmcnt(3)
    v_mfma_f32_32x32x16_bf16 v[132:147], v[84:87], v[96:99], v[132:147]
    ds_read_b128 v[112:115], v81 offset:36864
    ds_read_b128 v[104:107], v73 offset:36864
    s_waitcnt lgkmcnt(4)
    v_mfma_f32_32x32x16_bf16 v[148:163], v[88:91], v[92:95], v[148:163]
    v_mfma_f32_32x32x16_bf16 v[164:179], v[88:91], v[96:99], v[164:179]
    s_waitcnt lgkmcnt(0)
    v_mfma_f32_32x32x16_bf16 v[116:131], v[100:103], v[108:111], v[116:131]
    v_mfma_f32_32x32x16_bf16 v[132:147], v[100:103], v[112:115], v[132:147]
    v_mfma_f32_32x32x16_bf16 v[148:163], v[104:107], v[108:111], v[148:163]
    v_mfma_f32_32x32x16_bf16 v[164:179], v[104:107], v[112:115], v[164:179]
    s_waitcnt vmcnt(7)
    v_mov_b32 v82, s42
    v_mov_b32 v83, s43
    s_mov_b64 s[6:7], exec
    s_mov_b64 exec, 1
    buffer_store_dwordx2 v[82:83], v6, s[8:11], s18 offen sc0 sc1
    s_mov_b64 exec, s[6:7]
    s_nop 2
    v_pk_fma_f32 v[10:11], v[132:133], v[230:231], v[118:119] op_sel:[0,1,0] op_sel_hi:[1,1,1] neg_lo:[0,1,0] neg_hi:[0,1,0]
    v_pk_fma_f32 v[12:13], v[116:117], v[230:231], v[134:135] op_sel:[0,1,0] op_sel_hi:[1,1,1]
    v_pk_fma_f32 v[4:5], v[116:117], v[230:231], v[10:11] op_sel:[0,0,0] op_sel_hi:[1,0,1]
    v_pk_fma_f32 v[8:9], v[132:133], v[230:231], v[12:13] op_sel:[0,0,0] op_sel_hi:[1,0,1]
    v_pk_fma_f32 v[10:11], v[8:9], v[230:231], v[120:121] op_sel:[0,1,0] op_sel_hi:[1,1,1] neg_lo:[0,1,0] neg_hi:[0,1,0]
    v_pk_fma_f32 v[12:13], v[4:5], v[230:231], v[136:137] op_sel:[0,1,0] op_sel_hi:[1,1,1]
    v_pk_fma_f32 v[4:5], v[4:5], v[230:231], v[10:11] op_sel:[0,0,0] op_sel_hi:[1,0,1]
    v_pk_fma_f32 v[8:9], v[8:9], v[230:231], v[12:13] op_sel:[0,0,0] op_sel_hi:[1,0,1]
    v_pk_fma_f32 v[10:11], v[8:9], v[230:231], v[122:123] op_sel:[0,1,0] op_sel_hi:[1,1,1] neg_lo:[0,1,0] neg_hi:[0,1,0]
    v_pk_fma_f32 v[12:13], v[4:5], v[230:231], v[138:139] op_sel:[0,1,0] op_sel_hi:[1,1,1]
    v_pk_fma_f32 v[4:5], v[4:5], v[230:231], v[10:11] op_sel:[0,0,0] op_sel_hi:[1,0,1]
    v_pk_fma_f32 v[8:9], v[8:9], v[230:231], v[12:13] op_sel:[0,0,0] op_sel_hi:[1,0,1]
    v_pk_fma_f32 v[10:11], v[8:9], v[230:231], v[124:125] op_sel:[0,1,0] op_sel_hi:[1,1,1] neg_lo:[0,1,0] neg_hi:[0,1,0]
    v_pk_fma_f32 v[12:13], v[4:5], v[230:231], v[140:141] op_sel:[0,1,0] op_sel_hi:[1,1,1]
    v_pk_fma_f32 v[4:5], v[4:5], v[230:231], v[10:11] op_sel:[0,0,0] op_sel_hi:[1,0,1]
    v_pk_fma_f32 v[8:9], v[8:9], v[230:231], v[12:13] op_sel:[0,0,0] op_sel_hi:[1,0,1]
    v_pk_fma_f32 v[10:11], v[8:9], v[230:231], v[126:127] op_sel:[0,1,0] op_sel_hi:[1,1,1] neg_lo:[0,1,0] neg_hi:[0,1,0]
    v_pk_fma_f32 v[12:13], v[4:5], v[230:231], v[142:143] op_sel:[0,1,0] op_sel_hi:[1,1,1]
    v_pk_fma_f32 v[4:5], v[4:5], v[230:231], v[10:11] op_sel:[0,0,0] op_sel_hi:[1,0,1]
    v_pk_fma_f32 v[8:9], v[8:9], v[230:231], v[12:13] op_sel:[0,0,0] op_sel_hi:[1,0,1]
    v_pk_fma_f32 v[10:11], v[8:9], v[230:231], v[128:129] op_sel:[0,1,0] op_sel_hi:[1,1,1] neg_lo:[0,1,0] neg_hi:[0,1,0]
    v_pk_fma_f32 v[12:13], v[4:5], v[230:231], v[144:145] op_sel:[0,1,0] op_sel_hi:[1,1,1]
    v_pk_fma_f32 v[4:5], v[4:5], v[230:231], v[10:11] op_sel:[0,0,0] op_sel_hi:[1,0,1]
    v_pk_fma_f32 v[8:9], v[8:9], v[230:231], v[12:13] op_sel:[0,0,0] op_sel_hi:[1,0,1]
    v_pk_fma_f32 v[10:11], v[8:9], v[230:231], v[130:131] op_sel:[0,1,0] op_sel_hi:[1,1,1] neg_lo:[0,1,0] neg_hi:[0,1,0]
    v_pk_fma_f32 v[12:13], v[4:5], v[230:231], v[146:147] op_sel:[0,1,0] op_sel_hi:[1,1,1]
    v_pk_fma_f32 v[4:5], v[4:5], v[230:231], v[10:11] op_sel:[0,0,0] op_sel_hi:[1,0,1]
    v_pk_fma_f32 v[8:9], v[8:9], v[230:231], v[12:13] op_sel:[0,0,0] op_sel_hi:[1,0,1]
    v_pk_fma_f32 v[10:11], v[8:9], v[230:231], v[148:149] op_sel:[0,1,0] op_sel_hi:[1,1,1] neg_lo:[0,1,0] neg_hi:[0,1,0]
    v_pk_fma_f32 v[12:13], v[4:5], v[230:231], v[164:165] op_sel:[0,1,0] op_sel_hi:[1,1,1]
    v_pk_fma_f32 v[4:5], v[4:5], v[230:231], v[10:11] op_sel:[0,0,0] op_sel_hi:[1,0,1]
    v_pk_fma_f32 v[8:9], v[8:9], v[230:231], v[12:13] op_sel:[0,0,0] op_sel_hi:[1,0,1]
    v_pk_fma_f32 v[10:11], v[8:9], v[230:231], v[150:151] op_sel:[0,1,0] op_sel_hi:[1,1,1] neg_lo:[0,1,0] neg_hi:[0,1,0]
    v_pk_fma_f32 v[12:13], v[4:5], v[230:231], v[166:167] op_sel:[0,1,0] op_sel_hi:[1,1,1]
    v_pk_fma_f32 v[4:5], v[4:5], v[230:231], v[10:11] op_sel:[0,0,0] op_sel_hi:[1,0,1]
    v_pk_fma_f32 v[8:9], v[8:9], v[230:231], v[12:13] op_sel:[0,0,0] op_sel_hi:[1,0,1]
    v_pk_fma_f32 v[10:11], v[8:9], v[230:231], v[152:153] op_sel:[0,1,0] op_sel_hi:[1,1,1] neg_lo:[0,1,0] neg_hi:[0,1,0]
    v_pk_fma_f32 v[12:13], v[4:5], v[230:231], v[168:169] op_sel:[0,1,0] op_sel_hi:[1,1,1]
    v_pk_fma_f32 v[4:5], v[4:5], v[230:231], v[10:11] op_sel:[0,0,0] op_sel_hi:[1,0,1]
    v_pk_fma_f32 v[8:9], v[8:9], v[230:231], v[12:13] op_sel:[0,0,0] op_sel_hi:[1,0,1]
    v_pk_fma_f32 v[10:11], v[8:9], v[230:231], v[154:155] op_sel:[0,1,0] op_sel_hi:[1,1,1] neg_lo:[0,1,0] neg_hi:[0,1,0]
    v_pk_fma_f32 v[12:13], v[4:5], v[230:231], v[170:171] op_sel:[0,1,0] op_sel_hi:[1,1,1]
    v_pk_fma_f32 v[4:5], v[4:5], v[230:231], v[10:11] op_sel:[0,0,0] op_sel_hi:[1,0,1]
    v_pk_fma_f32 v[8:9], v[8:9], v[230:231], v[12:13] op_sel:[0,0,0] op_sel_hi:[1,0,1]
    v_pk_fma_f32 v[10:11], v[8:9], v[230:231], v[156:157] op_sel:[0,1,0] op_sel_hi:[1,1,1] neg_lo:[0,1,0] neg_hi:[0,1,0]
    v_pk_fma_f32 v[12:13], v[4:5], v[230:231], v[172:173] op_sel:[0,1,0] op_sel_hi:[1,1,1]
    v_pk_fma_f32 v[4:5], v[4:5], v[230:231], v[10:11] op_sel:[0,0,0] op_sel_hi:[1,0,1]
    v_pk_fma_f32 v[8:9], v[8:9], v[230:231], v[12:13] op_sel:[0,0,0] op_sel_hi:[1,0,1]
    v_pk_fma_f32 v[10:11], v[8:9], v[230:231], v[158:159] op_sel:[0,1,0] op_sel_hi:[1,1,1] neg_lo:[0,1,0] neg_hi:[0,1,0]
    v_pk_fma_f32 v[12:13], v[4:5], v[230:231], v[174:175] op_sel:[0,1,0] op_sel_hi:[1,1,1]
    v_pk_fma_f32 v[4:5], v[4:5], v[230:231], v[10:11] op_sel:[0,0,0] op_sel_hi:[1,0,1]
    v_pk_fma_f32 v[8:9], v[8:9], v[230:231], v[12:13] op_sel:[0,0,0] op_sel_hi:[1,0,1]
    v_pk_fma_f32 v[10:11], v[8:9], v[230:231], v[160:161] op_sel:[0,1,0] op_sel_hi:[1,1,1] neg_lo:[0,1,0] neg_hi:[0,1,0]
    v_pk_fma_f32 v[12:13], v[4:5], v[230:231], v[176:177] op_sel:[0,1,0] op_sel_hi:[1,1,1]
    v_pk_fma_f32 v[4:5], v[4:5], v[230:231], v[10:11] op_sel:[0,0,0] op_sel_hi:[1,0,1]
    v_pk_fma_f32 v[8:9], v[8:9], v[230:231], v[12:13] op_sel:[0,0,0] op_sel_hi:[1,0,1]
    v_pk_fma_f32 v[10:11], v[8:9], v[230:231], v[162:163] op_sel:[0,1,0] op_sel_hi:[1,1,1] neg_lo:[0,1,0] neg_hi:[0,1,0]
    v_pk_fma_f32 v[12:13], v[4:5], v[230:231], v[178:179] op_sel:[0,1,0] op_sel_hi:[1,1,1]
    v_pk_fma_f32 v[4:5], v[4:5], v[230:231], v[10:11] op_sel:[0,0,0] op_sel_hi:[1,0,1]
    v_pk_fma_f32 v[8:9], v[8:9], v[230:231], v[12:13] op_sel:[0,0,0] op_sel_hi:[1,0,1]
    v_lshrrev_b32 v3, 5, v2
    v_lshlrev_b32 v3, 10, v3
    v_lshl_add_u32 v1, v7, 2, v3
    s_lshr_b32 s3, s44, 1
    s_lshl_b32 s3, s3, 11
    s_add_u32 s3, s3, 150528
    v_add_u32 v1, s3, v1
    ds_write2st64_b32 v1, v4, v8 offset0:12 offset1:13
    ds_write2st64_b32 v1, v5, v9 offset0:14 offset1:15
    s_waitcnt lgkmcnt(0)
    s_barrier
    ds_read2st64_b32 v[66:67], v1 offset0:0 offset1:1
    ds_read2st64_b32 v[68:69], v1 offset0:2 offset1:3
    ds_read2st64_b32 v[70:71], v1 offset0:4 offset1:5
    ds_read2st64_b32 v[72:73], v1 offset0:6 offset1:7
    ds_read2st64_b32 v[74:75], v1 offset0:8 offset1:9
    ds_read2st64_b32 v[76:77], v1 offset0:10 offset1:11
    s_waitcnt lgkmcnt(4)
    v_fma_f32 v20, -v235, v67, v68
    v_fma_f32 v21, v235, v66, v69
    v_fma_f32 v68, v234, v66, v20
    v_fma_f32 v69, v234, v67, v21
    s_waitcnt lgkmcnt(3)
    v_fma_f32 v20, -v235, v69, v70
    v_fma_f32 v21, v235, v68, v71
    v_fma_f32 v70, v234, v68, v20
    v_fma_f32 v71, v234, v69, v21
    s_waitcnt lgkmcnt(2)
    v_fma_f32 v20, -v235, v71, v72
    v_fma_f32 v21, v235, v70, v73
    v_fma_f32 v72, v234, v70, v20
    v_fma_f32 v73, v234, v71, v21
    s_waitcnt lgkmcnt(1)
    v_fma_f32 v20, -v235, v73, v74
    v_fma_f32 v21, v235, v72, v75
    v_fma_f32 v74, v234, v72, v20
    v_fma_f32 v75, v234, v73, v21
    s_waitcnt lgkmcnt(0)
    v_fma_f32 v20, -v235, v75, v76
    v_fma_f32 v21, v235, v74, v77
    v_fma_f32 v76, v234, v74, v20
    v_fma_f32 v77, v234, v75, v21
    v_fma_f32 v20, -v235, v77, v4
    v_fma_f32 v21, v235, v76, v8
    v_fma_f32 v14, v234, v76, v20
    v_fma_f32 v15, v234, v77, v21
    v_fma_f32 v20, -v235, v15, v5
    v_fma_f32 v21, v235, v14, v9
    v_fma_f32 v54, v234, v14, v20
    v_fma_f32 v55, v234, v15, v21
    v_mov_b32 v84, v76
    v_mov_b32 v85, v14
    v_mov_b32 v86, v77
    v_mov_b32 v87, v15
    s_lshl_b32 s3, s46, 14
    s_add_u32 s3, s3, 21037056
    s_add_u32 s48, s40, s3
    s_addc_u32 s49, s41, 0
    s_mov_b32 s50, 16384
    s_mov_b32 s51, 131072
    v_lshlrev_b32 v1, 4, v7
    s_lshl_b32 s4, s45, 10
    s_lshr_b32 s3, s44, 1
    s_cmp_eq_u32 s3, 0
    s_cbranch_scc1 Lnopub_gate_4
    v_mov_b32 v66, v54
    v_mov_b32 v67, v55
    v_mov_b32 v68, s42
    v_mov_b32 v69, s43
    s_mov_b64 s[6:7], exec
    s_mov_b64 exec, s[34:35]
    buffer_store_dwordx4 v[66:69], v1, s[48:51], s4 offen sc0 sc1
    s_mov_b64 exec, s[6:7]
    s_nop 1
Lnopub_gate_4:
    s_lshl_b32 s3, s46, 2
    s_add_u32 s3, s3, s44
    s_lshl_b32 s3, s3, 7
    s_add_u32 s3, s3, 21504000
    v_and_b32 v3, 15, v2
    v_lshlrev_b32 v3, 3, v3
    v_add_u32 v3, s3, v3
    v_lshrrev_b32 v9, 5, v2
    v_lshlrev_b32 v9, 10, v9
    v_sub_u32 v9, v1, v9
    s_sub_u32 s3, s4, 1024
    v_add_u32 v8, s3, v9
    v_mul_f32 v14, v237, v237
    v_fma_f32 v14, v236, v236, -v14
    v_mul_f32 v15, v236, v237
    v_add_f32 v15, v15, v15
    v_lshrrev_b32 v9, 5, v2
    v_sub_u32 v9, s45, v9
    v_add_u32 v9, 1, v9
    v_lshrrev_b32 v16, 1, v9
    s_lshl_b32 s3, s46, 2
    s_add_u32 s3, s3, s44
    s_lshl_b32 s6, s3, 16
    s_add_u32 s6, s6, 16777216
    s_lshl_b32 s7, s46, 12
    s_and_b32 s3, s46, 7
    s_lshl_b32 s3, s3, 2
    s_lshl_b32 s13, -1, s3
    s_and_b32 s13, s13, 0x01111111
    s_add_u32 s13, s13, 0x06543210
    s_bitcmp1_b32 s46, 3
    s_cselect_b32 s17, 0x08888888, 0
    s_add_u32 s13, s13, s17
    s_bitcmp1_b32 s46, 3
    s_cselect_b32 s17, 0, 0x88888888
    s_add_u32 s16, s17, 0x76543210
    s_lshl_b32 s17, s16, 28
    s_or_b32 s14, s13, s17
    s_lshr_b32 s15, s16, 4
    buffer_load_dwordx2 v[82:83], v182, s[8:11], 0 offen sc0 sc1
    v_pk_mul_f32 v[10:11], v[132:133], v[232:233] op_sel:[0,1] op_sel_hi:[1,1] neg_lo:[0,1] neg_hi:[0,1]
    v_pk_mul_f32 v[12:13], v[116:117], v[232:233] op_sel:[0,1] op_sel_hi:[1,1]
    v_pk_fma_f32 v[116:117], v[116:117], v[232:233], v[10:11] op_sel:[0,0,0] op_sel_hi:[1,0,1]
    v_pk_fma_f32 v[132:133], v[132:133], v[232:233], v[12:13] op_sel:[0,0,0] op_sel_hi:[1,0,1]
    v_pk_mul_f32 v[10:11], v[134:135], v[232:233] op_sel:[0,1] op_sel_hi:[1,1] neg_lo:[0,1] neg_hi:[0,1]
    v_pk_mul_f32 v[12:13], v[118:119], v[232:233] op_sel:[0,1] op_sel_hi:[1,1]
    v_pk_fma_f32 v[118:119], v[118:119], v[232:233], v[10:11] op_sel:[0,0,0] op_sel_hi:[1,0,1]
    v_pk_fma_f32 v[134:135], v[134:135], v[232:233], v[12:13] op_sel:[0,0,0] op_sel_hi:[1,0,1]
    v_pk_mul_f32 v[10:11], v[136:137], v[232:233] op_sel:[0,1] op_sel_hi:[1,1] neg_lo:[0,1] neg_hi:[0,1]
    v_pk_mul_f32 v[12:13], v[120:121], v[232:233] op_sel:[0,1] op_sel_hi:[1,1]
    v_pk_fma_f32 v[120:121], v[120:121], v[232:233], v[10:11] op_sel:[0,0,0] op_sel_hi:[1,0,1]
    v_pk_fma_f32 v[136:137], v[136:137], v[232:233], v[12:13] op_sel:[0,0,0] op_sel_hi:[1,0,1]
    v_pk_mul_f32 v[10:11], v[138:139], v[232:233] op_sel:[0,1] op_sel_hi:[1,1] neg_lo:[0,1] neg_hi:[0,1]
    v_pk_mul_f32 v[12:13], v[122:123], v[232:233] op_sel:[0,1] op_sel_hi:[1,1]
    v_pk_fma_f32 v[122:123], v[122:123], v[232:233], v[10:11] op_sel:[0,0,0] op_sel_hi:[1,0,1]
    v_pk_fma_f32 v[138:139], v[138:139], v[232:233], v[12:13] op_sel:[0,0,0] op_sel_hi:[1,0,1]
    v_pk_mul_f32 v[10:11], v[140:141], v[232:233] op_sel:[0,1] op_sel_hi:[1,1] neg_lo:[0,1] neg_hi:[0,1]
    v_pk_mul_f32 v[12:13], v[124:125], v[232:233] op_sel:[0,1] op_sel_hi:[1,1]
    v_pk_fma_f32 v[124:125], v[124:125], v[232:233], v[10:11] op_sel:[0,0,0] op_sel_hi:[1,0,1]
    v_pk_fma_f32 v[140:141], v[140:141], v[232:233], v[12:13] op_sel:[0,0,0] op_sel_hi:[1,0,1]
    v_pk_mul_f32 v[10:11], v[142:143], v[232:233] op_sel:[0,1] op_sel_hi:[1,1] neg_lo:[0,1] neg_hi:[0,1]
    v_pk_mul_f32 v[12:13], v[126:127], v[232:233] op_sel:[0,1] op_sel_hi:[1,1]
    v_pk_fma_f32 v[126:127], v[126:127], v[232:233], v[10:11] op_sel:[0,0,0] op_sel_hi:[1,0,1]
    v_pk_fma_f32 v[142:143], v[142:143], v[232:233], v[12:13] op_sel:[0,0,0] op_sel_hi:[1,0,1]
    v_pk_mul_f32 v[10:11], v[144:145], v[232:233] op_sel:[0,1] op_sel_hi:[1,1] neg_lo:[0,1] neg_hi:[0,1]
    v_pk_mul_f32 v[12:13], v[128:129], v[232:233] op_sel:[0,1] op_sel_hi:[1,1]
    v_pk_fma_f32 v[128:129], v[128:129], v[232:233], v[10:11] op_sel:[0,0,0] op_sel_hi:[1,0,1]
    v_pk_fma_f32 v[144:145], v[144:145], v[232:233], v[12:13] op_sel:[0,0,0] op_sel_hi:[1,0,1]
    v_pk_mul_f32 v[10:11], v[146:147], v[232:233] op_sel:[0,1] op_sel_hi:[1,1] neg_lo:[0,1] neg_hi:[0,1]
    v_pk_mul_f32 v[12:13], v[130:131], v[232:233] op_sel:[0,1] op_sel_hi:[1,1]
    v_pk_fma_f32 v[130:131], v[130:131], v[232:233], v[10:11] op_sel:[0,0,0] op_sel_hi:[1,0,1]
    v_pk_fma_f32 v[146:147], v[146:147], v[232:233], v[12:13] op_sel:[0,0,0] op_sel_hi:[1,0,1]
    v_pk_mul_f32 v[10:11], v[164:165], v[232:233] op_sel:[0,1] op_sel_hi:[1,1] neg_lo:[0,1] neg_hi:[0,1]
    v_pk_mul_f32 v[12:13], v[148:149], v[232:233] op_sel:[0,1] op_sel_hi:[1,1]
    v_pk_fma_f32 v[148:149], v[148:149], v[232:233], v[10:11] op_sel:[0,0,0] op_sel_hi:[1,0,1]
    v_pk_fma_f32 v[164:165], v[164:165], v[232:233], v[12:13] op_sel:[0,0,0] op_sel_hi:[1,0,1]
    v_pk_mul_f32 v[10:11], v[166:167], v[232:233] op_sel:[0,1] op_sel_hi:[1,1] neg_lo:[0,1] neg_hi:[0,1]
    v_pk_mul_f32 v[12:13], v[150:151], v[232:233] op_sel:[0,1] op_sel_hi:[1,1]
    v_pk_fma_f32 v[150:151], v[150:151], v[232:233], v[10:11] op_sel:[0,0,0] op_sel_hi:[1,0,1]
    v_pk_fma_f32 v[166:167], v[166:167], v[232:233], v[12:13] op_sel:[0,0,0] op_sel_hi:[1,0,1]
    v_pk_mul_f32 v[10:11], v[168:169], v[232:233] op_sel:[0,1] op_sel_hi:[1,1] neg_lo:[0,1] neg_hi:[0,1]
    v_pk_mul_f32 v[12:13], v[152:153], v[232:233] op_sel:[0,1] op_sel_hi:[1,1]
    v_pk_fma_f32 v[152:153], v[152:153], v[232:233], v[10:11] op_sel:[0,0,0] op_sel_hi:[1,0,1]
    v_pk_fma_f32 v[168:169], v[168:169], v[232:233], v[12:13] op_sel:[0,0,0] op_sel_hi:[1,0,1]
    v_pk_mul_f32 v[10:11], v[170:171], v[232:233] op_sel:[0,1] op_sel_hi:[1,1] neg_lo:[0,1] neg_hi:[0,1]
    v_pk_mul_f32 v[12:13], v[154:155], v[232:233] op_sel:[0,1] op_sel_hi:[1,1]
    v_pk_fma_f32 v[154:155], v[154:155], v[232:233], v[10:11] op_sel:[0,0,0] op_sel_hi:[1,0,1]
    v_pk_fma_f32 v[170:171], v[170:171], v[232:233], v[12:13] op_sel:[0,0,0] op_sel_hi:[1,0,1]
    v_pk_mul_f32 v[10:11], v[172:173], v[232:233] op_sel:[0,1] op_sel_hi:[1,1] neg_lo:[0,1] neg_hi:[0,1]
    v_pk_mul_f32 v[12:13], v[156:157], v[232:233] op_sel:[0,1] op_sel_hi:[1,1]
    v_pk_fma_f32 v[156:157], v[156:157], v[232:233], v[10:11] op_sel:[0,0,0] op_sel_hi:[1,0,1]
    v_pk_fma_f32 v[172:173], v[172:173], v[232:233], v[12:13] op_sel:[0,0,0] op_sel_hi:[1,0,1]
    v_pk_mul_f32 v[10:11], v[174:175], v[232:233] op_sel:[0,1] op_sel_hi:[1,1] neg_lo:[0,1] neg_hi:[0,1]
    v_pk_mul_f32 v[12:13], v[158:159], v[232:233] op_sel:[0,1] op_sel_hi:[1,1]
    v_pk_fma_f32 v[158:159], v[158:159], v[232:233], v[10:11] op_sel:[0,0,0] op_sel_hi:[1,0,1]
    v_pk_fma_f32 v[174:175], v[174:175], v[232:233], v[12:13] op_sel:[0,0,0] op_sel_hi:[1,0,1]
    v_pk_mul_f32 v[10:11], v[176:177], v[232:233] op_sel:[0,1] op_sel_hi:[1,1] neg_lo:[0,1] neg_hi:[0,1]
    v_pk_mul_f32 v[12:13], v[160:161], v[232:233] op_sel:[0,1] op_sel_hi:[1,1]
    v_pk_fma_f32 v[160:161], v[160:161], v[232:233], v[10:11] op_sel:[0,0,0] op_sel_hi:[1,0,1]
    v_pk_fma_f32 v[176:177], v[176:177], v[232:233], v[12:13] op_sel:[0,0,0] op_sel_hi:[1,0,1]
    v_pk_mul_f32 v[10:11], v[178:179], v[232:233] op_sel:[0,1] op_sel_hi:[1,1] neg_lo:[0,1] neg_hi:[0,1]
    v_pk_mul_f32 v[12:13], v[162:163], v[232:233] op_sel:[0,1] op_sel_hi:[1,1]
    v_pk_fma_f32 v[162:163], v[162:163], v[232:233], v[10:11] op_sel:[0,0,0] op_sel_hi:[1,0,1]
    v_pk_fma_f32 v[178:179], v[178:179], v[232:233], v[12:13] op_sel:[0,0,0] op_sel_hi:[1,0,1]
    s_mov_b32 s13, 0
    s_waitcnt vmcnt(0)
    v_cmp_ne_u64 vcc, s[42:43], v[82:83]
    s_nop 4
    s_cbranch_vccz Lfdone_gate_5
Lfpoll_gate_6:
    buffer_load_dwordx2 v[82:83], v182, s[8:11], 0 offen sc0 sc1
    s_waitcnt vmcnt(0)
    v_cmp_ne_u64 vcc, s[42:43], v[82:83]
    s_nop 4
    s_add_u32 s13, s13, 1
    s_cmp_gt_u32 s13, 20000
    s_cbranch_scc1 Lfdone_gate_5
    s_cbranch_vccnz Lfpoll_gate_6
Lfdone_gate_5:
    s_mov_b32 m0, s29
    s_nop 0
    buffer_load_dwordx4 v207, s[8:11], s28 offen offset:0 sc0 sc1 lds
    buffer_load_dwordx4 v207, s[8:11], s28 offen offset:1024 sc0 sc1 lds
    buffer_load_dwordx4 v207, s[8:11], s28 offen offset:2048 sc0 sc1 lds
    buffer_load_dwordx4 v207, s[8:11], s28 offen offset:3072 sc0 sc1 lds
    s_lshr_b32 s16, s44, 1
    v_lshrrev_b32 v53, 5, v2
    v_lshlrev_b32 v53, 13, v53
    v_lshl_add_u32 v9, v7, 2, v53
    s_lshl_b32 s3, s16, 14
    s_add_u32 s3, s3, 0
    v_add_u32 v9, s3, v9
    v_lshrrev_b32 v53, 4, v2
    v_lshlrev_b32 v53, 4, v53
    v_bfe_u32 v54, v2, 3, 1
    v_add_u32 v53, v53, v54
    v_and_b32 v21, 7, v2
    v_xor_b32 v54, v54, v21
    s_and_b32 s3, s44, 1
    s_lshl_b32 s3, s3, 3
    v_or_b32 v54, s3, v54
    v_lshlrev_b32 v54, 4, v54
    v_lshl_add_u32 v20, v53, 8, v54
    s_lshl_b32 s3, s16, 14
    s_add_u32 s3, s3, 0
    v_add_u32 v20, s3, v20
    v_lshlrev_b32 v21, 4, v21
    v_lshl_add_u32 v21, v53, 12, v21
    s_lshl_b32 s13, s45, 19
    s_lshl_b32 s3, s16, 18
    s_add_u32 s13, s13, s3
    s_lshl_b32 s3, s46, 8
    s_add_u32 s13, s13, s3
    s_and_b32 s3, s44, 1
    s_lshl_b32 s3, s3, 7
    s_add_u32 s13, s13, s3
    buffer_load_dwordx2 v[4:5], v3, s[8:11], 0 offen sc0 sc1
    v_mov_b32 v18, 0
    ds_write_b128 v51, v[38:41] offset:0
    v_alignbit_b32 v42, v39, v38, 16
    v_alignbit_b32 v43, v40, v39, 16
    v_mov_b32_dpp v18, v38 wave_shl:1 row_mask:0xf bank_mask:0xf
    v_alignbit_b32 v44, v41, v40, 16
    v_alignbit_b32 v45, v18, v41, 16
    ds_write_b128 v51, v[42:45] offset:4160
    v_readfirstlane_b32 s3, v26
    s_nop 1
    v_mov_b32 v19, s3
    ds_write_b128 v51, v[22:25] offset:32
    v_alignbit_b32 v46, v23, v22, 16
    v_alignbit_b32 v47, v24, v23, 16
    v_mov_b32_dpp v19, v22 wave_shl:1 row_mask:0xf bank_mask:0xf
    v_alignbit_b32 v48, v25, v24, 16
    v_alignbit_b32 v49, v19, v25, 16
    ds_write_b128 v51, v[46:49] offset:4192
    v_readfirstlane_b32 s3, v30
    s_nop 1
    v_mov_b32 v18, s3
    ds_write_b128 v51, v[26:29] offset:1056
    v_alignbit_b32 v42, v27, v26, 16
    v_alignbit_b32 v43, v28, v27, 16
    v_mov_b32_dpp v18, v26 wave_shl:1 row_mask:0xf bank_mask:0xf
    v_alignbit_b32 v44, v29, v28, 16
    v_alignbit_b32 v45, v18, v29, 16
    ds_write_b128 v51, v[42:45] offset:5216
    v_subrev_u32 v66, 0, v8
    v_min_u32 v66, 0x7fff0000, v66
    buffer_load_dwordx4 v[66:69], v66, s[48:51], 0 offen sc0 sc1
    v_subrev_u32 v70, 2048, v8
    v_min_u32 v70, 0x7fff0000, v70
    buffer_load_dwordx4 v[70:73], v70, s[48:51], 0 offen sc0 sc1
    v_subrev_u32 v74, 4096, v8
    v_min_u32 v74, 0x7fff0000, v74
    buffer_load_dwordx4 v[74:77], v74, s[48:51], 0 offen sc0 sc1
    v_subrev_u32 v78, 6144, v8
    v_min_u32 v78, 0x7fff0000, v78
    buffer_load_dwordx4 v[78:81], v78, s[48:51], 0 offen sc0 sc1
    v_subrev_u32 v88, 8192, v8
    v_min_u32 v88, 0x7fff0000, v88
    buffer_load_dwordx4 v[88:91], v88, s[48:51], 0 offen sc0 sc1
    v_subrev_u32 v92, 10240, v8
    v_min_u32 v92, 0x7fff0000, v92
    buffer_load_dwordx4 v[92:95], v92, s[48:51], 0 offen sc0 sc1
    v_subrev_u32 v96, 12288, v8
    v_min_u32 v96, 0x7fff0000, v96
    buffer_load_dwordx4 v[96:99], v96, s[48:51], 0 offen sc0 sc1
    v_subrev_u32 v100, 14336, v8
    v_min_u32 v100, 0x7fff0000, v100
    buffer_load_dwordx4 v[100:103], v100, s[48:51], 0 offen sc0 sc1
    v_readfirstlane_b32 s3, v34
    s_nop 1
    v_mov_b32 v19, s3
    ds_write_b128 v51, v[30:33] offset:2080
    v_alignbit_b32 v46, v31, v30, 16
    v_alignbit_b32 v47, v32, v31, 16
    v_mov_b32_dpp v19, v30 wave_shl:1 row_mask:0xf bank_mask:0xf
    v_alignbit_b32 v48, v33, v32, 16
    v_alignbit_b32 v49, v19, v33, 16
    ds_write_b128 v51, v[46:49] offset:6240
    v_mov_b32 v18, 0
    ds_write_b128 v51, v[34:37] offset:3104
    v_alignbit_b32 v42, v35, v34, 16
    v_alignbit_b32 v43, v36, v35, 16
    v_mov_b32_dpp v18, v34 wave_shl:1 row_mask:0xf bank_mask:0xf
    v_alignbit_b32 v44, v37, v36, 16
    v_alignbit_b32 v45, v18, v37, 16
    ds_write_b128 v51, v[42:45] offset:7264
    v_lshlrev_b32 v183, 16, v183
    s_mov_b32 s16, 0
    v_mov_b32 v18, 0
    s_waitcnt vmcnt(7)
    v_cmp_eq_u64 s[60:61], s[42:43], v[68:69]
    s_waitcnt vmcnt(6)
    v_cmp_eq_u64 s[62:63], s[42:43], v[72:73]
    s_waitcnt vmcnt(5)
    v_cmp_eq_u64 s[64:65], s[42:43], v[76:77]
    s_waitcnt vmcnt(4)
    v_cmp_eq_u64 s[66:67], s[42:43], v[80:81]
    v_addc_co_u32 v18, vcc, 0, v18, s[60:61]
    v_addc_co_u32 v18, vcc, 0, v18, s[62:63]
    v_addc_co_u32 v18, vcc, 0, v18, s[64:65]
    v_addc_co_u32 v18, vcc, 0, v18, s[66:67]
    s_waitcnt vmcnt(3)
    v_cmp_eq_u64 s[60:61], s[42:43], v[90:91]
    s_waitcnt vmcnt(2)
    v_cmp_eq_u64 s[62:63], s[42:43], v[94:95]
    s_waitcnt vmcnt(1)
    v_cmp_eq_u64 s[64:65], s[42:43], v[98:99]
    s_waitcnt vmcnt(0)
    v_cmp_eq_u64 s[66:67], s[42:43], v[102:103]
    v_addc_co_u32 v18, vcc, 0, v18, s[60:61]
    v_addc_co_u32 v18, vcc, 0, v18, s[62:63]
    v_addc_co_u32 v18, vcc, 0, v18, s[64:65]
    v_addc_co_u32 v18, vcc, 0, v18, s[66:67]
    v_cmp_ne_u32 vcc, v16, v18
    s_nop 4
    s_cbranch_vccz Lpolldone_gate_7
Lpoll_gate_8:
    v_subrev_u32 v66, 0, v8
    v_min_u32 v66, 0x7fff0000, v66
    buffer_load_dwordx4 v[66:69], v66, s[48:51], 0 offen sc0 sc1
    v_subrev_u32 v70, 2048, v8
    v_min_u32 v70, 0x7fff0000, v70
    buffer_load_dwordx4 v[70:73], v70, s[48:51], 0 offen sc0 sc1
    v_subrev_u32 v74, 4096, v8
    v_min_u32 v74, 0x7fff0000, v74
    buffer_load_dwordx4 v[74:77], v74, s[48:51], 0 offen sc0 sc1
    v_subrev_u32 v78, 6144, v8
    v_min_u32 v78, 0x7fff0000, v78
    buffer_load_dwordx4 v[78:81], v78, s[48:51], 0 offen sc0 sc1
    v_subrev_u32 v88, 8192, v8
    v_min_u32 v88, 0x7fff0000, v88
    buffer_load_dwordx4 v[88:91], v88, s[48:51], 0 offen sc0 sc1
    v_subrev_u32 v92, 10240, v8
    v_min_u32 v92, 0x7fff0000, v92
    buffer_load_dwordx4 v[92:95], v92, s[48:51], 0 offen sc0 sc1
    v_subrev_u32 v96, 12288, v8
    v_min_u32 v96, 0x7fff0000, v96
    buffer_load_dwordx4 v[96:99], v96, s[48:51], 0 offen sc0 sc1
    v_subrev_u32 v100, 14336, v8
    v_min_u32 v100, 0x7fff0000, v100
    buffer_load_dwordx4 v[100:103], v100, s[48:51], 0 offen sc0 sc1
    s_waitcnt vmcnt(0) lgkmcnt(0)
    v_mov_b32 v18, 0
    v_cmp_eq_u64 s[60:61], s[42:43], v[68:69]
    v_cmp_eq_u64 s[62:63], s[42:43], v[72:73]
    v_cmp_eq_u64 s[64:65], s[42:43], v[76:77]
    v_cmp_eq_u64 s[66:67], s[42:43], v[80:81]
    v_addc_co_u32 v18, vcc, 0, v18, s[60:61]
    v_addc_co_u32 v18, vcc, 0, v18, s[62:63]
    v_addc_co_u32 v18, vcc, 0, v18, s[64:65]
    v_addc_co_u32 v18, vcc, 0, v18, s[66:67]
    v_cmp_eq_u64 s[60:61], s[42:43], v[90:91]
    v_cmp_eq_u64 s[62:63], s[42:43], v[94:95]
    v_cmp_eq_u64 s[64:65], s[42:43], v[98:99]
    v_cmp_eq_u64 s[66:67], s[42:43], v[102:103]
    v_addc_co_u32 v18, vcc, 0, v18, s[60:61]
    v_addc_co_u32 v18, vcc, 0, v18, s[62:63]
    v_addc_co_u32 v18, vcc, 0, v18, s[64:65]
    v_addc_co_u32 v18, vcc, 0, v18, s[66:67]
    v_cmp_ne_u32 vcc, v16, v18
    s_add_u32 s16, s16, 1
    s_cmp_gt_u32 s16, 20000
    s_cbranch_scc1 Lpolldone_gate_7
    s_nop 1
    s_cbranch_vccnz Lpoll_gate_8
Lpolldone_gate_7:
    s_nop 4
    v_fma_f32 v22, -v15, v101, v96
    v_fma_f32 v23, v15, v100, v97
    v_fma_f32 v96, v14, v100, v22
    v_fma_f32 v97, v14, v101, v23
    v_fma_f32 v22, -v15, v97, v92
    v_fma_f32 v23, v15, v96, v93
    v_fma_f32 v92, v14, v96, v22
    v_fma_f32 v93, v14, v97, v23
    v_fma_f32 v22, -v15, v93, v88
    v_fma_f32 v23, v15, v92, v89
    v_fma_f32 v88, v14, v92, v22
    v_fma_f32 v89, v14, v93, v23
    v_fma_f32 v22, -v15, v89, v78
    v_fma_f32 v23, v15, v88, v79
    v_fma_f32 v78, v14, v88, v22
    v_fma_f32 v79, v14, v89, v23
    v_fma_f32 v22, -v15, v79, v74
    v_fma_f32 v23, v15, v78, v75
    v_fma_f32 v74, v14, v78, v22
    v_fma_f32 v75, v14, v79, v23
    v_fma_f32 v22, -v15, v75, v70
    v_fma_f32 v23, v15, v74, v71
    v_fma_f32 v70, v14, v74, v22
    v_fma_f32 v71, v14, v75, v23
    v_fma_f32 v22, -v15, v71, v66
    v_fma_f32 v23, v15, v70, v67
    v_fma_f32 v66, v14, v70, v22
    v_fma_f32 v67, v14, v71, v23
    v_mov_b32 v70, v66
    v_mov_b32 v71, v67
    s_nop 0
    v_permlane32_swap_b32 v66, v70
    v_permlane32_swap_b32 v67, v71
    v_fma_f32 v22, -v237, v71, v66
    v_fma_f32 v23, v237, v70, v67
    v_fma_f32 v24, v236, v70, v22
    v_fma_f32 v25, v236, v71, v23
    s_mov_b32 s4, 0
    v_cmp_ne_u64 vcc, s[42:43], v[4:5]
    s_nop 4
    s_cbranch_vccz Lfdone_gate_9
Lfpoll_gate_10:
    buffer_load_dwordx2 v[4:5], v3, s[8:11], 0 offen sc0 sc1
    s_waitcnt vmcnt(0)
    v_cmp_ne_u64 vcc, s[42:43], v[4:5]
    s_nop 4
    s_add_u32 s4, s4, 1
    s_cmp_gt_u32 s4, 20000
    s_cbranch_scc1 Lfdone_gate_9
    s_cbranch_vccnz Lfpoll_gate_10
Lfdone_gate_9:
    v_pk_fma_f32 v[10:11], v[240:241], v[24:25], v[84:85] op_sel:[0,1,0] op_sel_hi:[1,1,1] neg_lo:[0,1,0] neg_hi:[0,1,0]
    v_pk_fma_f32 v[12:13], v[238:239], v[24:25], v[86:87] op_sel:[0,1,0] op_sel_hi:[1,1,1]
    v_pk_fma_f32 v[4:5], v[238:239], v[24:25], v[10:11] op_sel:[0,0,0] op_sel_hi:[1,0,1]
    v_pk_fma_f32 v[14:15], v[240:241], v[24:25], v[12:13] op_sel:[0,0,0] op_sel_hi:[1,0,1]
    v_pk_mul_f32 v[10:11], v[14:15], v[232:233] op_sel:[0,1] op_sel_hi:[1,1] neg_lo:[0,1] neg_hi:[0,1]
    v_pk_mul_f32 v[12:13], v[4:5], v[232:233] op_sel:[0,1] op_sel_hi:[1,1]
    v_pk_fma_f32 v[4:5], v[4:5], v[232:233], v[10:11] op_sel:[0,0,0] op_sel_hi:[1,0,1]
    v_pk_fma_f32 v[14:15], v[14:15], v[232:233], v[12:13] op_sel:[0,0,0] op_sel_hi:[1,0,1]
    v_pk_fma_f32 v[10:11], v[14:15], v[230:231], v[116:117] op_sel:[0,1,0] op_sel_hi:[1,1,1] neg_lo:[0,1,0] neg_hi:[0,1,0]
    v_pk_fma_f32 v[12:13], v[4:5], v[230:231], v[132:133] op_sel:[0,1,0] op_sel_hi:[1,1,1]
    v_pk_fma_f32 v[116:117], v[4:5], v[230:231], v[10:11] op_sel:[0,0,0] op_sel_hi:[1,0,1]
    v_pk_fma_f32 v[132:133], v[14:15], v[230:231], v[12:13] op_sel:[0,0,0] op_sel_hi:[1,0,1]
    s_add_u32 s12, s6, s7
    buffer_load_dwordx4 a[0:3], v17, s[8:11], s12 offen offset:0 sc0 sc1
    v_pk_fma_f32 v[10:11], v[132:133], v[230:231], v[118:119] op_sel:[0,1,0] op_sel_hi:[1,1,1] neg_lo:[0,1,0] neg_hi:[0,1,0]
    v_pk_fma_f32 v[12:13], v[116:117], v[230:231], v[134:135] op_sel:[0,1,0] op_sel_hi:[1,1,1]
    v_pk_fma_f32 v[118:119], v[116:117], v[230:231], v[10:11] op_sel:[0,0,0] op_sel_hi:[1,0,1]
    v_pk_fma_f32 v[134:135], v[132:133], v[230:231], v[12:13] op_sel:[0,0,0] op_sel_hi:[1,0,1]
    v_cvt_pk_bf16_f32 v18, v116, -v132
    v_cvt_pk_bf16_f32 v19, v117, -v133
    ds_write2st64_b32 v9, v18, v19 offset0:0 offset1:16
    buffer_load_dwordx4 a[4:7], v17, s[8:11], s12 offen offset:1024 sc0 sc1
    v_pk_fma_f32 v[10:11], v[134:135], v[230:231], v[120:121] op_sel:[0,1,0] op_sel_hi:[1,1,1] neg_lo:[0,1,0] neg_hi:[0,1,0]
    v_pk_fma_f32 v[12:13], v[118:119], v[230:231], v[136:137] op_sel:[0,1,0] op_sel_hi:[1,1,1]
    v_pk_fma_f32 v[120:121], v[118:119], v[230:231], v[10:11] op_sel:[0,0,0] op_sel_hi:[1,0,1]
    v_pk_fma_f32 v[136:137], v[134:135], v[230:231], v[12:13] op_sel:[0,0,0] op_sel_hi:[1,0,1]
    v_xor_b32 v3, 16, v9
    v_cvt_pk_bf16_f32 v22, v118, -v134
    v_cvt_pk_bf16_f32 v23, v119, -v135
    ds_write2st64_b32 v3, v22, v23 offset0:1 offset1:17
    ds_read_b128 v[28:31], v20 offset:0
    buffer_load_dwordx4 a[8:11], v17, s[8:11], s12 offen offset:2048 sc0 sc1
    v_pk_fma_f32 v[10:11], v[136:137], v[230:231], v[122:123] op_sel:[0,1,0] op_sel_hi:[1,1,1] neg_lo:[0,1,0] neg_hi:[0,1,0]
    v_pk_fma_f32 v[12:13], v[120:121], v[230:231], v[138:139] op_sel:[0,1,0] op_sel_hi:[1,1,1]
    v_pk_fma_f32 v[122:123], v[120:121], v[230:231], v[10:11] op_sel:[0,0,0] op_sel_hi:[1,0,1]
    v_pk_fma_f32 v[138:139], v[136:137], v[230:231], v[12:13] op_sel:[0,0,0] op_sel_hi:[1,0,1]
    v_xor_b32 v1, 32, v9
    v_cvt_pk_bf16_f32 v18, v120, -v136
    v_cvt_pk_bf16_f32 v19, v121, -v137
    ds_write2st64_b32 v1, v18, v19 offset0:2 offset1:18
    s_waitcnt lgkmcnt(1)
    buffer_store_dwordx4 v[28:31], v21, s[8:11], s13 offen sc0 sc1
    buffer_load_dwordx4 a[12:15], v17, s[8:11], s12 offen offset:3072 sc0 sc1
    v_pk_fma_f32 v[10:11], v[138:139], v[230:231], v[124:125] op_sel:[0,1,0] op_sel_hi:[1,1,1] neg_lo:[0,1,0] neg_hi:[0,1,0]
    v_pk_fma_f32 v[12:13], v[122:123], v[230:231], v[140:141] op_sel:[0,1,0] op_sel_hi:[1,1,1]
    v_pk_fma_f32 v[124:125], v[122:123], v[230:231], v[10:11] op_sel:[0,0,0] op_sel_hi:[1,0,1]
    v_pk_fma_f32 v[140:141], v[138:139], v[230:231], v[12:13] op_sel:[0,0,0] op_sel_hi:[1,0,1]
    v_xor_b32 v3, 48, v9
    v_cvt_pk_bf16_f32 v22, v122, -v138
    v_cvt_pk_bf16_f32 v23, v123, -v139
    ds_write2st64_b32 v3, v22, v23 offset0:3 offset1:19
    v_xor_b32 v8, 32, v20
    ds_read_b128 v[32:35], v8 offset:512
    s_bfe_u32 s7, s14, 0x40000
    s_lshl_b32 s7, s7, 12
    s_add_u32 s12, s6, s7
    buffer_load_dwordx4 a[16:19], v17, s[8:11], s12 offen offset:0 sc0 sc1
    v_pk_fma_f32 v[10:11], v[140:141], v[230:231], v[126:127] op_sel:[0,1,0] op_sel_hi:[1,1,1] neg_lo:[0,1,0] neg_hi:[0,1,0]
    v_pk_fma_f32 v[12:13], v[124:125], v[230:231], v[142:143] op_sel:[0,1,0] op_sel_hi:[1,1,1]
    v_pk_fma_f32 v[126:127], v[124:125], v[230:231], v[10:11] op_sel:[0,0,0] op_sel_hi:[1,0,1]
    v_pk_fma_f32 v[142:143], v[140:141], v[230:231], v[12:13] op_sel:[0,0,0] op_sel_hi:[1,0,1]
    v_xor_b32 v1, 64, v9
    v_cvt_pk_bf16_f32 v18, v124, -v140
    v_cvt_pk_bf16_f32 v19, v125, -v141
    ds_write2st64_b32 v1, v18, v19 offset0:4 offset1:20
    s_add_u32 s13, s13, 8192
    s_waitcnt lgkmcnt(1)
    buffer_store_dwordx4 v[32:35], v21, s[8:11], s13 offen sc0 sc1
    buffer_load_dwordx4 a[20:23], v17, s[8:11], s12 offen offset:1024 sc0 sc1
    v_pk_fma_f32 v[10:11], v[142:143], v[230:231], v[128:129] op_sel:[0,1,0] op_sel_hi:[1,1,1] neg_lo:[0,1,0] neg_hi:[0,1,0]
    v_pk_fma_f32 v[12:13], v[126:127], v[230:231], v[144:145] op_sel:[0,1,0] op_sel_hi:[1,1,1]
    v_pk_fma_f32 v[128:129], v[126:127], v[230:231], v[10:11] op_sel:[0,0,0] op_sel_hi:[1,0,1]
    v_pk_fma_f32 v[144:145], v[142:143], v[230:231], v[12:13] op_sel:[0,0,0] op_sel_hi:[1,0,1]
    v_xor_b32 v3, 80, v9
    v_cvt_pk_bf16_f32 v22, v126, -v142
    v_cvt_pk_bf16_f32 v23, v127, -v143
    ds_write2st64_b32 v3, v22, v23 offset0:5 offset1:21
    v_xor_b32 v8, 64, v20
    ds_read_b128 v[28:31], v8 offset:1024
    buffer_load_dwordx4 a[24:27], v17, s[8:11], s12 offen offset:2048 sc0 sc1
    v_pk_fma_f32 v[10:11], v[144:145], v[230:231], v[130:131] op_sel:[0,1,0] op_sel_hi:[1,1,1] neg_lo:[0,1,0] neg_hi:[0,1,0]
    v_pk_fma_f32 v[12:13], v[128:129], v[230:231], v[146:147] op_sel:[0,1,0] op_sel_hi:[1,1,1]
    v_pk_fma_f32 v[130:131], v[128:129], v[230:231], v[10:11] op_sel:[0,0,0] op_sel_hi:[1,0,1]
    v_pk_fma_f32 v[146:147], v[144:145], v[230:231], v[12:13] op_sel:[0,0,0] op_sel_hi:[1,0,1]
    v_xor_b32 v1, 96, v9
    v_cvt_pk_bf16_f32 v18, v128, -v144
    v_cvt_pk_bf16_f32 v19, v129, -v145
    ds_write2st64_b32 v1, v18, v19 offset0:6 offset1:22
    s_add_u32 s13, s13, 8192
    s_waitcnt lgkmcnt(1)
    buffer_store_dwordx4 v[28:31], v21, s[8:11], s13 offen sc0 sc1
    buffer_load_dwordx4 a[28:31], v17, s[8:11], s12 offen offset:3072 sc0 sc1
    v_pk_fma_f32 v[10:11], v[146:147], v[230:231], v[148:149] op_sel:[0,1,0] op_sel_hi:[1,1,1] neg_lo:[0,1,0] neg_hi:[0,1,0]
    v_pk_fma_f32 v[12:13], v[130:131], v[230:231], v[164:165] op_sel:[0,1,0] op_sel_hi:[1,1,1]
    v_pk_fma_f32 v[148:149], v[130:131], v[230:231], v[10:11] op_sel:[0,0,0] op_sel_hi:[1,0,1]
    v_pk_fma_f32 v[164:165], v[146:147], v[230:231], v[12:13] op_sel:[0,0,0] op_sel_hi:[1,0,1]
    v_xor_b32 v3, 112, v9
    v_cvt_pk_bf16_f32 v22, v130, -v146
    v_cvt_pk_bf16_f32 v23, v131, -v147
    ds_write2st64_b32 v3, v22, v23 offset0:7 offset1:23
    v_xor_b32 v8, 96, v20
    ds_read_b128 v[32:35], v8 offset:1536
    s_bfe_u32 s7, s14, 0x40004
    s_lshl_b32 s7, s7, 12
    s_add_u32 s12, s6, s7
    buffer_load_dwordx4 a[32:35], v17, s[8:11], s12 offen offset:0 sc0 sc1
    v_pk_fma_f32 v[10:11], v[164:165], v[230:231], v[150:151] op_sel:[0,1,0] op_sel_hi:[1,1,1] neg_lo:[0,1,0] neg_hi:[0,1,0]
    v_pk_fma_f32 v[12:13], v[148:149], v[230:231], v[166:167] op_sel:[0,1,0] op_sel_hi:[1,1,1]
    v_pk_fma_f32 v[150:151], v[148:149], v[230:231], v[10:11] op_sel:[0,0,0] op_sel_hi:[1,0,1]
    v_pk_fma_f32 v[166:167], v[164:165], v[230:231], v[12:13] op_sel:[0,0,0] op_sel_hi:[1,0,1]
    v_xor_b32 v1, 128, v9
    v_cvt_pk_bf16_f32 v18, v148, -v164
    v_cvt_pk_bf16_f32 v19, v149, -v165
    ds_write2st64_b32 v1, v18, v19 offset0:8 offset1:24
    s_add_u32 s13, s13, 8192
    s_waitcnt lgkmcnt(1)
    buffer_store_dwordx4 v[32:35], v21, s[8:11], s13 offen sc0 sc1
    buffer_load_dwordx4 a[36:39], v17, s[8:11], s12 offen offset:1024 sc0 sc1
    v_pk_fma_f32 v[10:11], v[166:167], v[230:231], v[152:153] op_sel:[0,1,0] op_sel_hi:[1,1,1] neg_lo:[0,1,0] neg_hi:[0,1,0]
    v_pk_fma_f32 v[12:13], v[150:151], v[230:231], v[168:169] op_sel:[0,1,0] op_sel_hi:[1,1,1]
    v_pk_fma_f32 v[152:153], v[150:151], v[230:231], v[10:11] op_sel:[0,0,0] op_sel_hi:[1,0,1]
    v_pk_fma_f32 v[168:169], v[166:167], v[230:231], v[12:13] op_sel:[0,0,0] op_sel_hi:[1,0,1]
    v_xor_b32 v3, 144, v9
    v_cvt_pk_bf16_f32 v22, v150, -v166
    v_cvt_pk_bf16_f32 v23, v151, -v167
    ds_write2st64_b32 v3, v22, v23 offset0:9 offset1:25
    v_xor_b32 v8, 128, v20
    ds_read_b128 v[28:31], v8 offset:2048
    buffer_load_dwordx4 a[40:43], v17, s[8:11], s12 offen offset:2048 sc0 sc1
    v_pk_fma_f32 v[10:11], v[168:169], v[230:231], v[154:155] op_sel:[0,1,0] op_sel_hi:[1,1,1] neg_lo:[0,1,0] neg_hi:[0,1,0]
    v_pk_fma_f32 v[12:13], v[152:153], v[230:231], v[170:171] op_sel:[0,1,0] op_sel_hi:[1,1,1]
    v_pk_fma_f32 v[154:155], v[152:153], v[230:231], v[10:11] op_sel:[0,0,0] op_sel_hi:[1,0,1]
    v_pk_fma_f32 v[170:171], v[168:169], v[230:231], v[12:13] op_sel:[0,0,0] op_sel_hi:[1,0,1]
    v_xor_b32 v1, 160, v9
    v_cvt_pk_bf16_f32 v18, v152, -v168
    v_cvt_pk_bf16_f32 v19, v153, -v169
    ds_write2st64_b32 v1, v18, v19 offset0:10 offset1:26
    s_add_u32 s13, s13, 8192
    s_waitcnt lgkmcnt(1)
    buffer_store_dwordx4 v[28:31], v21, s[8:11], s13 offen sc0 sc1
    buffer_load_dwordx4 a[44:47], v17, s[8:11], s12 offen offset:3072 sc0 sc1
    v_pk_fma_f32 v[10:11], v[170:171], v[230:231], v[156:157] op_sel:[0,1,0] op_sel_hi:[1,1,1] neg_lo:[0,1,0] neg_hi:[0,1,0]
    v_pk_fma_f32 v[12:13], v[154:155], v[230:231], v[172:173] op_sel:[0,1,0] op_sel_hi:[1,1,1]
    v_pk_fma_f32 v[156:157], v[154:155], v[230:231], v[10:11] op_sel:[0,0,0] op_sel_hi:[1,0,1]
    v_pk_fma_f32 v[172:173], v[170:171], v[230:231], v[12:13] op_sel:[0,0,0] op_sel_hi:[1,0,1]
    v_xor_b32 v3, 176, v9
    v_cvt_pk_bf16_f32 v22, v154, -v170
    v_cvt_pk_bf16_f32 v23, v155, -v171
    ds_write2st64_b32 v3, v22, v23 offset0:11 offset1:27
    v_xor_b32 v8, 160, v20
    ds_read_b128 v[32:35], v8 offset:2560
    v_pk_fma_f32 v[10:11], v[172:173], v[230:231], v[158:159] op_sel:[0,1,0] op_sel_hi:[1,1,1] neg_lo:[0,1,0] neg_hi:[0,1,0]
    v_pk_fma_f32 v[12:13], v[156:157], v[230:231], v[174:175] op_sel:[0,1,0] op_sel_hi:[1,1,1]
    v_pk_fma_f32 v[158:159], v[156:157], v[230:231], v[10:11] op_sel:[0,0,0] op_sel_hi:[1,0,1]
    v_pk_fma_f32 v[174:175], v[172:173], v[230:231], v[12:13] op_sel:[0,0,0] op_sel_hi:[1,0,1]
    v_xor_b32 v1, 192, v9
    v_cvt_pk_bf16_f32 v18, v156, -v172
    v_cvt_pk_bf16_f32 v19, v157, -v173
    ds_write2st64_b32 v1, v18, v19 offset0:12 offset1:28
    s_add_u32 s13, s13, 8192
    s_waitcnt lgkmcnt(1)
    buffer_store_dwordx4 v[32:35], v21, s[8:11], s13 offen sc0 sc1
    v_pk_fma_f32 v[10:11], v[174:175], v[230:231], v[160:161] op_sel:[0,1,0] op_sel_hi:[1,1,1] neg_lo:[0,1,0] neg_hi:[0,1,0]
    v_pk_fma_f32 v[12:13], v[158:159], v[230:231], v[176:177] op_sel:[0,1,0] op_sel_hi:[1,1,1]
    v_pk_fma_f32 v[160:161], v[158:159], v[230:231], v[10:11] op_sel:[0,0,0] op_sel_hi:[1,0,1]
    v_pk_fma_f32 v[176:177], v[174:175], v[230:231], v[12:13] op_sel:[0,0,0] op_sel_hi:[1,0,1]
    v_xor_b32 v3, 208, v9
    v_cvt_pk_bf16_f32 v22, v158, -v174
    v_cvt_pk_bf16_f32 v23, v159, -v175
    ds_write2st64_b32 v3, v22, v23 offset0:13 offset1:29
    v_xor_b32 v8, 192, v20
    ds_read_b128 v[28:31], v8 offset:3072
    v_pk_fma_f32 v[10:11], v[176:177], v[230:231], v[162:163] op_sel:[0,1,0] op_sel_hi:[1,1,1] neg_lo:[0,1,0] neg_hi:[0,1,0]
    v_pk_fma_f32 v[12:13], v[160:161], v[230:231], v[178:179] op_sel:[0,1,0] op_sel_hi:[1,1,1]
    v_pk_fma_f32 v[162:163], v[160:161], v[230:231], v[10:11] op_sel:[0,0,0] op_sel_hi:[1,0,1]
    v_pk_fma_f32 v[178:179], v[176:177], v[230:231], v[12:13] op_sel:[0,0,0] op_sel_hi:[1,0,1]
    v_xor_b32 v1, 224, v9
    v_cvt_pk_bf16_f32 v18, v160, -v176
    v_cvt_pk_bf16_f32 v19, v161, -v177
    ds_write2st64_b32 v1, v18, v19 offset0:14 offset1:30
    s_add_u32 s13, s13, 8192
    s_waitcnt lgkmcnt(1)
    buffer_store_dwordx4 v[28:31], v21, s[8:11], s13 offen sc0 sc1
    v_xor_b32 v3, 240, v9
    v_cvt_pk_bf16_f32 v22, v162, -v178
    v_cvt_pk_bf16_f32 v23, v163, -v179
    ds_write2st64_b32 v3, v22, v23 offset0:15 offset1:31
    v_xor_b32 v8, 224, v20
    ds_read_b128 v[32:35], v8 offset:3584
    s_add_u32 s13, s13, 8192
    s_waitcnt lgkmcnt(0)
    buffer_store_dwordx4 v[32:35], v21, s[8:11], s13 offen sc0 sc1
    s_barrier
    ds_read2_b32 v[96:97], v57 offset0:112 offset1:113
    ds_read2_b32 v[98:99], v57 offset0:114 offset1:115
    ds_read_b128 v[100:103], v58 offset:16128
    ds_read2_b32 v[104:105], v57 offset0:240 offset1:241
    ds_read2_b32 v[106:107], v57 offset0:242 offset1:243
    ds_read_b128 v[108:111], v58 offset:14080
    ds_read2_b32 v[112:113], v63 offset0:112 offset1:113
    ds_read2_b32 v[114:115], v63 offset0:114 offset1:115
    ds_read_b128 v[116:119], v58 offset:12032
    s_waitcnt lgkmcnt(1)
    v_mfma_f32_16x16x32_bf16 v[46:49], v[96:99], v[100:103], 0
    s_lshl_b32 s4, s45, 4
    s_add_u32 s4, s4, s46
    v_mfma_f32_16x16x32_bf16 v[66:69], v[104:107], v[100:103], 0
    ds_read2_b32 v[120:121], v63 offset0:240 offset1:241
    ds_read2_b32 v[122:123], v63 offset0:242 offset1:243
    v_mfma_f32_16x16x32_bf16 v[66:69], v[96:99], v[108:111], v[66:69]
    ds_read_b128 v[124:127], v58 offset:9984
    s_bfe_u32 s7, s14, 0x40008
    v_mfma_f32_16x16x32_bf16 v[70:73], v[104:107], v[108:111], 0
    s_lshl_b32 s7, s7, 12
    s_add_u32 s12, s6, s7
    v_mfma_f32_16x16x32_bf16 v[70:73], v[112:115], v[100:103], v[70:73]
    buffer_load_dwordx4 a[48:51], v17, s[8:11], s12 offen offset:0 sc0 sc1
    s_waitcnt lgkmcnt(3)
    v_mfma_f32_16x16x32_bf16 v[70:73], v[96:99], v[116:119], v[70:73]
    s_lshl_b32 s4, s4, 2
    s_add_u32 s4, s4, s44
    v_mfma_f32_16x16x32_bf16 v[74:77], v[112:115], v[108:111], 0
    s_lshl_b32 s4, s4, 3
    s_add_u32 s4, s4, 21512192
    v_mfma_f32_16x16x32_bf16 v[74:77], v[104:107], v[116:119], v[74:77]
    buffer_load_dwordx4 a[52:55], v17, s[8:11], s12 offen offset:1024 sc0 sc1
    v_mfma_f32_16x16x32_bf16 v[78:81], v[112:115], v[116:119], 0
    ds_read2_b32 v[128:129], v64 offset0:112 offset1:113
    s_waitcnt lgkmcnt(1)
    v_mfma_f32_16x16x32_bf16 v[74:77], v[120:123], v[100:103], v[74:77]
    ds_read2_b32 v[130:131], v64 offset0:114 offset1:115
    ds_read_b128 v[132:135], v58 offset:7936
    v_mfma_f32_16x16x32_bf16 v[74:77], v[96:99], v[124:127], v[74:77]
    s_lshl_b32 s3, s45, 9
    s_add_u32 s3, s3, 21512192
    v_mfma_f32_16x16x32_bf16 v[78:81], v[120:123], v[108:111], v[78:81]
    v_lshrrev_b32 v182, 1, v17
    v_add_u32 v182, s3, v182
    v_mfma_f32_16x16x32_bf16 v[78:81], v[104:107], v[124:127], v[78:81]
    buffer_load_dwordx4 a[56:59], v17, s[8:11], s12 offen offset:2048 sc0 sc1
    v_mfma_f32_16x16x32_bf16 v[84:87], v[120:123], v[116:119], 0
    v_lshrrev_b32 v1, 4, v2
    v_and_b32 v3, 15, v2
    v_mfma_f32_16x16x32_bf16 v[84:87], v[112:115], v[124:127], v[84:87]
    v_xor_b32 v3, v3, v1
    v_lshlrev_b32 v3, 4, v3
    v_mfma_f32_16x16x32_bf16 v[88:91], v[120:123], v[124:127], 0
    v_lshl_add_u32 v7, v1, 12, v3
    s_waitcnt lgkmcnt(0)
    v_mfma_f32_16x16x32_bf16 v[78:81], v[128:131], v[100:103], v[78:81]
    ds_read2_b32 v[136:137], v64 offset0:240 offset1:241
    ds_read2_b32 v[138:139], v64 offset0:242 offset1:243
    v_mfma_f32_16x16x32_bf16 v[78:81], v[96:99], v[132:135], v[78:81]
    ds_read_b128 v[140:143], v58 offset:5888
    buffer_load_dwordx4 a[60:63], v17, s[8:11], s12 offen offset:3072 sc0 sc1
    v_mfma_f32_16x16x32_bf16 v[84:87], v[128:131], v[108:111], v[84:87]
    v_xor_b32 v1, 64, v7
    v_add_u32 v8, 16384, v1
    v_mfma_f32_16x16x32_bf16 v[84:87], v[104:107], v[132:135], v[84:87]
    v_xor_b32 v1, 128, v7
    v_add_u32 v9, 32768, v1
    v_mfma_f32_16x16x32_bf16 v[88:91], v[128:131], v[116:119], v[88:91]
    v_xor_b32 v1, 192, v7
    v_add_u32 v10, 49152, v1
    v_mfma_f32_16x16x32_bf16 v[88:91], v[112:115], v[132:135], v[88:91]
    s_lshl_b32 s16, s45, 19
    s_lshl_b32 s3, s44, 17
    v_mfma_f32_16x16x32_bf16 v[92:95], v[128:131], v[124:127], 0
    ds_read2_b32 v[144:145], v65 offset0:112 offset1:113
    ds_read2_b32 v[146:147], v65 offset0:114 offset1:115
    v_mfma_f32_16x16x32_bf16 v[92:95], v[120:123], v[132:135], v[92:95]
    ds_read_b128 v[148:151], v58 offset:3840
    s_waitcnt lgkmcnt(3)
    v_mfma_f32_16x16x32_bf16 v[84:87], v[136:139], v[100:103], v[84:87]
    s_bfe_u32 s7, s14, 0x4000c
    s_lshl_b32 s7, s7, 12
    v_mfma_f32_16x16x32_bf16 v[84:87], v[96:99], v[140:143], v[84:87]
    s_add_u32 s12, s6, s7
    buffer_load_dwordx4 a[64:67], v17, s[8:11], s12 offen offset:0 sc0 sc1
    v_mfma_f32_16x16x32_bf16 v[88:91], v[136:139], v[108:111], v[88:91]
    ds_read2_b32 v[128:129], v65 offset0:240 offset1:241
    ds_read2_b32 v[130:131], v65 offset0:242 offset1:243
    v_mfma_f32_16x16x32_bf16 v[88:91], v[104:107], v[140:143], v[88:91]
    ds_read_b128 v[124:127], v58 offset:1792
    s_add_u32 s16, s16, s3
    v_mfma_f32_16x16x32_bf16 v[92:95], v[136:139], v[116:119], v[92:95]
    ds_read2_b32 v[120:121], v57 offset0:96 offset1:97
    ds_read2_b32 v[122:123], v57 offset0:98 offset1:99
    v_mfma_f32_16x16x32_bf16 v[92:95], v[112:115], v[140:143], v[92:95]
    ds_read_b128 v[132:135], v59 offset:15872
    s_waitcnt lgkmcnt(6)
    v_mfma_f32_16x16x32_bf16 v[88:91], v[144:147], v[100:103], v[88:91]
    ds_read2_b32 v[136:137], v57 offset0:224 offset1:225
    ds_read2_b32 v[138:139], v57 offset0:226 offset1:227
    v_mfma_f32_16x16x32_bf16 v[88:91], v[96:99], v[148:151], v[88:91]
    ds_read_b128 v[116:119], v59 offset:13824
    buffer_load_dwordx4 a[68:71], v17, s[8:11], s12 offen offset:1024 sc0 sc1
    v_mfma_f32_16x16x32_bf16 v[92:95], v[144:147], v[108:111], v[92:95]
    ds_read2_b32 v[112:113], v63 offset0:96 offset1:97
    ds_read2_b32 v[114:115], v63 offset0:98 offset1:99
    v_mfma_f32_16x16x32_bf16 v[92:95], v[104:107], v[148:151], v[92:95]
    ds_read_b128 v[140:143], v59 offset:11776
    s_waitcnt lgkmcnt(6)
    v_mfma_f32_16x16x32_bf16 v[92:95], v[128:131], v[100:103], v[92:95]
    buffer_load_dwordx4 a[72:75], v17, s[8:11], s12 offen offset:2048 sc0 sc1
    v_mfma_f32_16x16x32_bf16 v[92:95], v[96:99], v[124:127], v[92:95]
    s_lshl_b32 s17, s46, 8
    s_lshl_b32 s18, s44, 13
    v_mfma_f32_16x16x32_bf16 v[46:49], v[120:123], v[132:135], v[46:49]
    s_lshr_b32 s28, s44, 1
    s_waitcnt lgkmcnt(1)
    v_mfma_f32_16x16x32_bf16 v[66:69], v[136:139], v[132:135], v[66:69]
    ds_read2_b32 v[144:145], v63 offset0:224 offset1:225
    ds_read2_b32 v[146:147], v63 offset0:226 offset1:227
    v_mfma_f32_16x16x32_bf16 v[66:69], v[120:123], v[116:119], v[66:69]
    ds_read_b128 v[108:111], v59 offset:9728
    v_and_b32 v26, 31, v2
    v_mfma_f32_16x16x32_bf16 v[70:73], v[136:139], v[116:119], v[70:73]
    buffer_load_dwordx4 a[76:79], v17, s[8:11], s12 offen offset:3072 sc0 sc1
    v_mfma_f32_16x16x32_bf16 v[70:73], v[112:115], v[132:135], v[70:73]
    v_lshrrev_b32 v27, 5, v2
    s_waitcnt lgkmcnt(3)
    v_mfma_f32_16x16x32_bf16 v[70:73], v[120:123], v[140:143], v[70:73]
    v_lshlrev_b32 v27, 2, v27
    s_lshl_b32 s3, s28, 3
    v_mfma_f32_16x16x32_bf16 v[74:77], v[112:115], v[116:119], v[74:77]
    v_add_u32 v27, s3, v27
    v_and_b32 v28, 15, v26
    v_mfma_f32_16x16x32_bf16 v[74:77], v[136:139], v[140:143], v[74:77]
    v_xor_b32 v27, v27, v28
    v_lshlrev_b32 v27, 4, v27
    v_mfma_f32_16x16x32_bf16 v[78:81], v[112:115], v[140:143], v[78:81]
    ds_read2_b32 v[104:105], v64 offset0:96 offset1:97
    s_waitcnt lgkmcnt(1)
    v_mfma_f32_16x16x32_bf16 v[74:77], v[144:147], v[132:135], v[74:77]
    ds_read2_b32 v[106:107], v64 offset0:98 offset1:99
    ds_read_b128 v[148:151], v59 offset:7680
    v_mfma_f32_16x16x32_bf16 v[74:77], v[120:123], v[108:111], v[74:77]
    s_bfe_u32 s7, s14, 0x40010
    s_lshl_b32 s7, s7, 12
    v_mfma_f32_16x16x32_bf16 v[78:81], v[144:147], v[116:119], v[78:81]
    s_add_u32 s12, s6, s7
    buffer_load_dwordx4 a[80:83], v17, s[8:11], s12 offen offset:0 sc0 sc1
    v_mfma_f32_16x16x32_bf16 v[78:81], v[136:139], v[108:111], v[78:81]
    v_lshl_add_u32 v27, v26, 8, v27
    s_lshl_b32 s3, s28, 14
    v_mfma_f32_16x16x32_bf16 v[84:87], v[144:147], v[140:143], v[84:87]
    buffer_load_dwordx4 a[84:87], v17, s[8:11], s12 offen offset:1024 sc0 sc1
    v_mfma_f32_16x16x32_bf16 v[84:87], v[112:115], v[108:111], v[84:87]
    v_add_u32 v27, s3, v27
    v_xor_b32 v4, 0, v27
    v_mfma_f32_16x16x32_bf16 v[88:91], v[144:147], v[108:111], v[88:91]
    v_xor_b32 v18, 0x4000, v4
    s_waitcnt lgkmcnt(0)
    v_mfma_f32_16x16x32_bf16 v[78:81], v[104:107], v[132:135], v[78:81]
    ds_read2_b32 v[128:129], v64 offset0:224 offset1:225
    ds_read2_b32 v[130:131], v64 offset0:226 offset1:227
    v_mfma_f32_16x16x32_bf16 v[78:81], v[120:123], v[148:151], v[78:81]
    ds_read_b128 v[100:103], v59 offset:5632
    v_add_u32 v13, 65536, v4
    v_mfma_f32_16x16x32_bf16 v[84:87], v[104:107], v[116:119], v[84:87]
    v_add_u32 v22, 65536, v18
    v_xor_b32 v5, 16, v27
    v_mfma_f32_16x16x32_bf16 v[84:87], v[136:139], v[148:151], v[84:87]
    buffer_load_dwordx4 a[88:91], v17, s[8:11], s12 offen offset:2048 sc0 sc1
    v_mfma_f32_16x16x32_bf16 v[88:91], v[104:107], v[140:143], v[88:91]
    v_xor_b32 v19, 0x4000, v5
    v_add_u32 v14, 65536, v5
    v_mfma_f32_16x16x32_bf16 v[88:91], v[112:115], v[148:151], v[88:91]
    v_add_u32 v23, 65536, v19
    v_xor_b32 v11, 32, v27
    v_mfma_f32_16x16x32_bf16 v[92:95], v[104:107], v[108:111], v[92:95]
    ds_read2_b32 v[96:97], v65 offset0:96 offset1:97
    ds_read2_b32 v[98:99], v65 offset0:98 offset1:99
    v_mfma_f32_16x16x32_bf16 v[92:95], v[144:147], v[148:151], v[92:95]
    ds_read_b128 v[124:127], v59 offset:3584
    s_waitcnt lgkmcnt(3)
    v_mfma_f32_16x16x32_bf16 v[84:87], v[128:131], v[132:135], v[84:87]
    buffer_load_dwordx4 a[92:95], v17, s[8:11], s12 offen offset:3072 sc0 sc1
    v_mfma_f32_16x16x32_bf16 v[84:87], v[120:123], v[100:103], v[84:87]
    s_waitcnt vmcnt(12)
    v_mov_b32 v82, s42
    v_mov_b32 v83, s43
    s_mov_b64 s[48:49], exec
    s_mov_b64 exec, 1
    buffer_store_dwordx2 v[82:83], v6, s[8:11], s4 offen sc0 sc1
    s_mov_b64 exec, s[48:49]
    v_mfma_f32_16x16x32_bf16 v[88:91], v[128:131], v[116:119], v[88:91]
    ds_read2_b32 v[104:105], v65 offset0:224 offset1:225
    ds_read2_b32 v[106:107], v65 offset0:226 offset1:227
    v_mfma_f32_16x16x32_bf16 v[88:91], v[136:139], v[100:103], v[88:91]
    ds_read_b128 v[108:111], v59 offset:1536
    v_xor_b32 v20, 0x4000, v11
    v_mfma_f32_16x16x32_bf16 v[92:95], v[128:131], v[140:143], v[92:95]
    ds_read2_b32 v[144:145], v57 offset0:80 offset1:81
    ds_read2_b32 v[146:147], v57 offset0:82 offset1:83
    v_mfma_f32_16x16x32_bf16 v[92:95], v[112:115], v[100:103], v[92:95]
    ds_read_b128 v[148:151], v60 offset:15616
    s_waitcnt lgkmcnt(6)
    v_mfma_f32_16x16x32_bf16 v[88:91], v[96:99], v[132:135], v[88:91]
    ds_read2_b32 v[128:129], v57 offset0:208 offset1:209
    ds_read2_b32 v[130:131], v57 offset0:210 offset1:211
    v_mfma_f32_16x16x32_bf16 v[88:91], v[120:123], v[124:127], v[88:91]
    ds_read_b128 v[140:143], v60 offset:13568
    s_bfe_u32 s7, s14, 0x40014
    v_mfma_f32_16x16x32_bf16 v[92:95], v[96:99], v[116:119], v[92:95]
    ds_read2_b32 v[112:113], v63 offset0:80 offset1:81
    ds_read2_b32 v[114:115], v63 offset0:82 offset1:83
    v_mfma_f32_16x16x32_bf16 v[92:95], v[136:139], v[124:127], v[92:95]
    ds_read_b128 v[100:103], v60 offset:11520
    s_waitcnt lgkmcnt(6)
    v_mfma_f32_16x16x32_bf16 v[92:95], v[104:107], v[132:135], v[92:95]
    s_lshl_b32 s7, s7, 12
    s_add_u32 s12, s6, s7
    v_mfma_f32_16x16x32_bf16 v[92:95], v[120:123], v[108:111], v[92:95]
    buffer_load_dwordx4 a[96:99], v17, s[8:11], s12 offen offset:0 sc0 sc1
    v_mfma_f32_16x16x32_bf16 v[46:49], v[144:147], v[148:151], v[46:49]
    buffer_load_dwordx4 a[100:103], v17, s[8:11], s12 offen offset:1024 sc0 sc1
    s_waitcnt lgkmcnt(1)
    v_mfma_f32_16x16x32_bf16 v[66:69], v[128:131], v[148:151], v[66:69]
    ds_read2_b32 v[96:97], v63 offset0:208 offset1:209
    ds_read2_b32 v[98:99], v63 offset0:210 offset1:211
    v_mfma_f32_16x16x32_bf16 v[66:69], v[144:147], v[140:143], v[66:69]
    ds_read_b128 v[116:119], v60 offset:9472
    v_add_u32 v15, 65536, v11
    v_mfma_f32_16x16x32_bf16 v[70:73], v[128:131], v[140:143], v[70:73]
    v_add_u32 v24, 65536, v20
    v_xor_b32 v12, 48, v27
    v_mfma_f32_16x16x32_bf16 v[70:73], v[112:115], v[148:151], v[70:73]
    buffer_load_dwordx4 a[104:107], v17, s[8:11], s12 offen offset:2048 sc0 sc1
    s_waitcnt lgkmcnt(3)
    v_mfma_f32_16x16x32_bf16 v[70:73], v[144:147], v[100:103], v[70:73]
    v_xor_b32 v21, 0x4000, v12
    v_add_u32 v16, 65536, v12
    v_mfma_f32_16x16x32_bf16 v[74:77], v[112:115], v[140:143], v[74:77]
    v_add_u32 v25, 65536, v21
    s_lshl_b32 s13, s46, 4
    v_mfma_f32_16x16x32_bf16 v[74:77], v[128:131], v[100:103], v[74:77]
    s_add_u32 s13, s13, s45
    s_lshl_b32 s13, s13, 2
    v_mfma_f32_16x16x32_bf16 v[78:81], v[112:115], v[100:103], v[78:81]
    ds_read2_b32 v[136:137], v64 offset0:80 offset1:81
    s_waitcnt lgkmcnt(1)
    v_mfma_f32_16x16x32_bf16 v[74:77], v[96:99], v[148:151], v[74:77]
    ds_read2_b32 v[138:139], v64 offset0:82 offset1:83
    ds_read_b128 v[124:127], v60 offset:7424
    v_mfma_f32_16x16x32_bf16 v[74:77], v[144:147], v[116:119], v[74:77]
    buffer_load_dwordx4 a[108:111], v17, s[8:11], s12 offen offset:3072 sc0 sc1
    v_mfma_f32_16x16x32_bf16 v[78:81], v[96:99], v[140:143], v[78:81]
    s_add_u32 s13, s13, s44
    s_lshl_b32 s13, s13, 3
    v_mfma_f32_16x16x32_bf16 v[78:81], v[128:131], v[116:119], v[78:81]
    s_add_u32 s13, s13, 21520384
    s_mov_b32 s32, s36
    v_mfma_f32_16x16x32_bf16 v[84:87], v[96:99], v[100:103], v[84:87]
    s_mov_b32 s33, s37
    s_mov_b32 s34, 8388608
    v_mfma_f32_16x16x32_bf16 v[84:87], v[112:115], v[116:119], v[84:87]
    s_bfe_u32 s7, s14, 0x40018
    s_lshl_b32 s7, s7, 12
    v_mfma_f32_16x16x32_bf16 v[88:91], v[96:99], v[116:119], v[88:91]
    s_add_u32 s12, s6, s7
    s_waitcnt lgkmcnt(0)
    v_mfma_f32_16x16x32_bf16 v[78:81], v[136:139], v[148:151], v[78:81]
    ds_read2_b32 v[104:105], v64 offset0:208 offset1:209
    ds_read2_b32 v[106:107], v64 offset0:210 offset1:211
    v_mfma_f32_16x16x32_bf16 v[78:81], v[144:147], v[124:127], v[78:81]
    ds_read_b128 v[132:135], v60 offset:5376
    buffer_load_dwordx4 a[112:115], v17, s[8:11], s12 offen offset:0 sc0 sc1
    v_mfma_f32_16x16x32_bf16 v[84:87], v[136:139], v[140:143], v[84:87]
    s_mov_b32 s35, 131072
    s_lshr_b32 s29, s44, 1
    v_mfma_f32_16x16x32_bf16 v[84:87], v[128:131], v[124:127], v[84:87]
    s_and_b32 s30, s44, 1
    v_bfe_u32 v32, v2, 4, 1
    v_mfma_f32_16x16x32_bf16 v[88:91], v[136:139], v[100:103], v[88:91]
    buffer_load_dwordx4 a[116:119], v17, s[8:11], s12 offen offset:1024 sc0 sc1
    v_mfma_f32_16x16x32_bf16 v[88:91], v[112:115], v[124:127], v[88:91]
    v_lshlrev_b32 v32, 2, v32
    v_and_b32 v33, 7, v2
    v_mfma_f32_16x16x32_bf16 v[92:95], v[136:139], v[116:119], v[92:95]
    ds_read2_b32 v[120:121], v65 offset0:80 offset1:81
    ds_read2_b32 v[122:123], v65 offset0:82 offset1:83
    v_mfma_f32_16x16x32_bf16 v[92:95], v[96:99], v[124:127], v[92:95]
    ds_read_b128 v[108:111], v60 offset:3328
    s_waitcnt lgkmcnt(3)
    v_mfma_f32_16x16x32_bf16 v[84:87], v[104:107], v[148:151], v[84:87]
    v_xor_b32 v33, v33, v32
    v_lshlrev_b32 v33, 4, v33
    v_mfma_f32_16x16x32_bf16 v[84:87], v[144:147], v[132:135], v[84:87]
    buffer_load_dwordx4 a[120:123], v17, s[8:11], s12 offen offset:2048 sc0 sc1
    v_mfma_f32_16x16x32_bf16 v[88:91], v[104:107], v[140:143], v[88:91]
    ds_read2_b32 v[136:137], v65 offset0:208 offset1:209
    ds_read2_b32 v[138:139], v65 offset0:210 offset1:211
    v_mfma_f32_16x16x32_bf16 v[88:91], v[128:131], v[132:135], v[88:91]
    ds_read_b128 v[116:119], v60 offset:1280
    v_lshrrev_b32 v32, 3, v2
    v_mfma_f32_16x16x32_bf16 v[92:95], v[104:107], v[100:103], v[92:95]
    ds_read2_b32 v[96:97], v57 offset0:64 offset1:65
    ds_read2_b32 v[98:99], v57 offset0:66 offset1:67
    v_mfma_f32_16x16x32_bf16 v[92:95], v[112:115], v[132:135], v[92:95]
    ds_read_b128 v[124:127], v61 offset:15360
    s_waitcnt lgkmcnt(6)
    v_mfma_f32_16x16x32_bf16 v[88:91], v[120:123], v[148:151], v[88:91]
    ds_read2_b32 v[104:105], v57 offset0:192 offset1:193
    ds_read2_b32 v[106:107], v57 offset0:194 offset1:195
    v_mfma_f32_16x16x32_bf16 v[88:91], v[144:147], v[108:111], v[88:91]
    ds_read_b128 v[100:103], v61 offset:13312
    buffer_load_dwordx4 a[124:127], v17, s[8:11], s12 offen offset:3072 sc0 sc1
    v_mfma_f32_16x16x32_bf16 v[92:95], v[120:123], v[140:143], v[92:95]
    ds_read2_b32 v[112:113], v63 offset0:64 offset1:65
    ds_read2_b32 v[114:115], v63 offset0:66 offset1:67
    v_mfma_f32_16x16x32_bf16 v[92:95], v[128:131], v[108:111], v[92:95]
    ds_read_b128 v[132:135], v61 offset:11264
    s_waitcnt lgkmcnt(6)
    v_mfma_f32_16x16x32_bf16 v[92:95], v[136:139], v[148:151], v[92:95]
    v_lshl_add_u32 v35, v32, 11, v33
    s_lshl_b32 s31, s45, 18
    v_mfma_f32_16x16x32_bf16 v[92:95], v[144:147], v[116:119], v[92:95]
    s_lshl_b32 s3, s44, 16
    s_add_u32 s31, s31, s3
    v_mfma_f32_16x16x32_bf16 v[46:49], v[96:99], v[124:127], v[46:49]
    s_bfe_u32 s7, s14, 0x4001c
    s_waitcnt lgkmcnt(1)
    v_mfma_f32_16x16x32_bf16 v[66:69], v[104:107], v[124:127], v[66:69]
    ds_read2_b32 v[120:121], v63 offset0:192 offset1:193
    ds_read2_b32 v[122:123], v63 offset0:194 offset1:195
    v_mfma_f32_16x16x32_bf16 v[66:69], v[96:99], v[100:103], v[66:69]
    ds_read_b128 v[140:143], v61 offset:9216
    s_lshl_b32 s7, s7, 12
    v_mfma_f32_16x16x32_bf16 v[70:73], v[104:107], v[100:103], v[70:73]
    s_add_u32 s12, s6, s7
    buffer_load_dwordx4 a[128:131], v17, s[8:11], s12 offen offset:0 sc0 sc1
    v_mfma_f32_16x16x32_bf16 v[70:73], v[112:115], v[124:127], v[70:73]
    s_lshl_b32 s3, s46, 7
    s_waitcnt lgkmcnt(3)
    v_mfma_f32_16x16x32_bf16 v[70:73], v[96:99], v[132:135], v[70:73]
    buffer_load_dwordx4 a[132:135], v17, s[8:11], s12 offen offset:1024 sc0 sc1
    v_mfma_f32_16x16x32_bf16 v[74:77], v[112:115], v[100:103], v[74:77]
    s_add_u32 s31, s31, s3
    s_lshl_b32 s38, s46, 18
    v_mfma_f32_16x16x32_bf16 v[74:77], v[104:107], v[132:135], v[74:77]
    s_lshl_b32 s3, s44, 16
    s_add_u32 s38, s38, s3
    v_mfma_f32_16x16x32_bf16 v[78:81], v[112:115], v[132:135], v[78:81]
    ds_read2_b32 v[128:129], v64 offset0:64 offset1:65
    s_waitcnt lgkmcnt(1)
    v_mfma_f32_16x16x32_bf16 v[74:77], v[120:123], v[124:127], v[74:77]
    ds_read2_b32 v[130:131], v64 offset0:66 offset1:67
    ds_read_b128 v[108:111], v61 offset:7168
    v_mfma_f32_16x16x32_bf16 v[74:77], v[96:99], v[140:143], v[74:77]
    buffer_load_dwordx4 a[136:139], v17, s[8:11], s12 offen offset:2048 sc0 sc1
    v_mfma_f32_16x16x32_bf16 v[78:81], v[120:123], v[100:103], v[78:81]
    s_lshl_b32 s3, s45, 8
    s_add_u32 s38, s38, s3
    v_mfma_f32_16x16x32_bf16 v[78:81], v[104:107], v[140:143], v[78:81]
    s_add_u32 s38, s38, 12582912
    v_bfe_u32 v34, v2, 2, 2
    v_mfma_f32_16x16x32_bf16 v[84:87], v[120:123], v[132:135], v[84:87]
    v_bfe_u32 v32, v2, 4, 1
    v_lshlrev_b32 v32, 1, v32
    v_mfma_f32_16x16x32_bf16 v[84:87], v[112:115], v[140:143], v[84:87]
    v_bfe_u32 v33, v2, 1, 1
    v_add_u32 v32, v32, v33
    v_mfma_f32_16x16x32_bf16 v[88:91], v[120:123], v[140:143], v[88:91]
    buffer_load_dwordx4 a[140:143], v17, s[8:11], s12 offen offset:3072 sc0 sc1
    s_waitcnt lgkmcnt(0)
    v_mfma_f32_16x16x32_bf16 v[78:81], v[128:131], v[124:127], v[78:81]
    ds_read2_b32 v[136:137], v64 offset0:192 offset1:193
    ds_read2_b32 v[138:139], v64 offset0:194 offset1:195
    v_mfma_f32_16x16x32_bf16 v[78:81], v[96:99], v[108:111], v[78:81]
    ds_read_b128 v[148:151], v61 offset:5120
    s_lshl_b32 s3, s30, 2
    v_mfma_f32_16x16x32_bf16 v[84:87], v[128:131], v[100:103], v[84:87]
    v_add_u32 v32, s3, v32
    v_bfe_u32 v33, v2, 3, 1
    v_mfma_f32_16x16x32_bf16 v[84:87], v[104:107], v[108:111], v[84:87]
    v_lshlrev_b32 v33, 2, v33
    v_xor_b32 v32, v32, v33
    v_mfma_f32_16x16x32_bf16 v[88:91], v[128:131], v[132:135], v[88:91]
    v_lshlrev_b32 v32, 4, v32
    v_and_b32 v33, 1, v2
    v_mfma_f32_16x16x32_bf16 v[88:91], v[112:115], v[108:111], v[88:91]
    s_bfe_u32 s7, s15, 0x40000
    s_lshl_b32 s7, s7, 12
    v_mfma_f32_16x16x32_bf16 v[92:95], v[128:131], v[140:143], v[92:95]
    ds_read2_b32 v[144:145], v65 offset0:64 offset1:65
    ds_read2_b32 v[146:147], v65 offset0:66 offset1:67
    v_mfma_f32_16x16x32_bf16 v[92:95], v[120:123], v[108:111], v[92:95]
    ds_read_b128 v[116:119], v61 offset:3072
    s_waitcnt lgkmcnt(3)
    v_mfma_f32_16x16x32_bf16 v[84:87], v[136:139], v[124:127], v[84:87]
    s_add_u32 s12, s6, s7
    buffer_load_dwordx4 a[144:147], v17, s[8:11], s12 offen offset:0 sc0 sc1
    v_mfma_f32_16x16x32_bf16 v[84:87], v[96:99], v[148:151], v[84:87]
    v_lshl_add_u32 v32, v33, 3, v32
    v_lshrrev_b32 v33, 5, v2
    v_mfma_f32_16x16x32_bf16 v[88:91], v[136:139], v[100:103], v[88:91]
    ds_read2_b32 v[128:129], v65 offset0:192 offset1:193
    ds_read2_b32 v[130:131], v65 offset0:194 offset1:195
    v_mfma_f32_16x16x32_bf16 v[88:91], v[104:107], v[148:151], v[88:91]
    ds_read_b128 v[140:143], v61 offset:1024
    buffer_load_dwordx4 a[148:151], v17, s[8:11], s12 offen offset:1024 sc0 sc1
    v_mfma_f32_16x16x32_bf16 v[92:95], v[136:139], v[132:135], v[92:95]
    ds_read2_b32 v[120:121], v57 offset0:48 offset1:49
    ds_read2_b32 v[122:123], v57 offset0:50 offset1:51
    v_mfma_f32_16x16x32_bf16 v[92:95], v[112:115], v[148:151], v[92:95]
    ds_read_b128 v[108:111], v58 offset:15104
    s_waitcnt lgkmcnt(6)
    v_mfma_f32_16x16x32_bf16 v[88:91], v[144:147], v[124:127], v[88:91]
    ds_read2_b32 v[136:137], v57 offset0:176 offset1:177
    ds_read2_b32 v[138:139], v57 offset0:178 offset1:179
    v_mfma_f32_16x16x32_bf16 v[88:91], v[96:99], v[116:119], v[88:91]
    ds_read_b128 v[132:135], v58 offset:13056
    buffer_load_dwordx4 a[152:155], v17, s[8:11], s12 offen offset:2048 sc0 sc1
    v_mfma_f32_16x16x32_bf16 v[92:95], v[144:147], v[100:103], v[92:95]
    ds_read2_b32 v[112:113], v63 offset0:48 offset1:49
    ds_read2_b32 v[114:115], v63 offset0:50 offset1:51
    v_mfma_f32_16x16x32_bf16 v[92:95], v[104:107], v[116:119], v[92:95]
    ds_read_b128 v[148:151], v58 offset:11008
    s_waitcnt lgkmcnt(6)
    v_mfma_f32_16x16x32_bf16 v[92:95], v[128:131], v[124:127], v[92:95]
    v_lshl_add_u32 v34, v33, 2, v34
    v_lshl_add_u32 v32, v34, 7, v32
    v_mfma_f32_16x16x32_bf16 v[92:95], v[96:99], v[140:143], v[92:95]
    s_lshl_b32 s3, s29, 13
    s_add_u32 s3, s3, 131072
    v_mfma_f32_16x16x32_bf16 v[46:49], v[120:123], v[108:111], v[46:49]
    v_add_u32 v36, s3, v32
    s_waitcnt lgkmcnt(1)
    v_mfma_f32_16x16x32_bf16 v[66:69], v[136:139], v[108:111], v[66:69]
    ds_read2_b32 v[144:145], v63 offset0:176 offset1:177
    ds_read2_b32 v[146:147], v63 offset0:178 offset1:179
    v_mfma_f32_16x16x32_bf16 v[66:69], v[120:123], v[132:135], v[66:69]
    ds_read_b128 v[100:103], v58 offset:8960
    buffer_load_dwordx4 a[156:159], v17, s[8:11], s12 offen offset:3072 sc0 sc1
    v_mfma_f32_16x16x32_bf16 v[70:73], v[136:139], v[132:135], v[70:73]
    v_and_b32 v32, 15, v2
    s_lshl_b32 s3, s29, 3
    v_mfma_f32_16x16x32_bf16 v[70:73], v[112:115], v[108:111], v[70:73]
    v_xor_b32 v32, s3, v32
    s_waitcnt lgkmcnt(3)
    v_mfma_f32_16x16x32_bf16 v[70:73], v[120:123], v[148:151], v[70:73]
    v_lshlrev_b32 v32, 4, v32
    v_and_b32 v34, 31, v2
    v_mfma_f32_16x16x32_bf16 v[74:77], v[112:115], v[132:135], v[74:77]
    s_bfe_u32 s7, s15, 0x40004
    s_lshl_b32 s7, s7, 12
    v_mfma_f32_16x16x32_bf16 v[74:77], v[136:139], v[148:151], v[74:77]
    s_add_u32 s12, s6, s7
    buffer_load_dwordx4 a[160:163], v17, s[8:11], s12 offen offset:0 sc0 sc1
    v_mfma_f32_16x16x32_bf16 v[78:81], v[112:115], v[148:151], v[78:81]
    ds_read2_b32 v[104:105], v64 offset0:48 offset1:49
    s_waitcnt lgkmcnt(1)
    v_mfma_f32_16x16x32_bf16 v[74:77], v[144:147], v[108:111], v[74:77]
    ds_read2_b32 v[106:107], v64 offset0:50 offset1:51
    ds_read_b128 v[116:119], v58 offset:6912
    v_mfma_f32_16x16x32_bf16 v[74:77], v[120:123], v[100:103], v[74:77]
    v_lshl_add_u32 v32, v34, 8, v32
    v_lshl_add_u32 v32, v33, 3, v32
    v_mfma_f32_16x16x32_bf16 v[78:81], v[144:147], v[132:135], v[78:81]
    buffer_load_dwordx4 a[164:167], v17, s[8:11], s12 offen offset:1024 sc0 sc1
    v_mfma_f32_16x16x32_bf16 v[78:81], v[136:139], v[100:103], v[78:81]
    s_lshl_b32 s3, s30, 13
    s_add_u32 s3, s3, 147456
    v_mfma_f32_16x16x32_bf16 v[84:87], v[144:147], v[148:151], v[84:87]
    v_add_u32 v37, s3, v32
    v_and_b32 v32, 15, v2
    v_mfma_f32_16x16x32_bf16 v[84:87], v[112:115], v[100:103], v[84:87]
    v_lshlrev_b32 v32, 4, v32
    v_and_b32 v34, 16, v2
    v_mfma_f32_16x16x32_bf16 v[88:91], v[144:147], v[100:103], v[88:91]
    v_lshl_add_u32 v32, v34, 9, v32
    s_waitcnt lgkmcnt(0)
    v_mfma_f32_16x16x32_bf16 v[78:81], v[104:107], v[108:111], v[78:81]
    ds_read2_b32 v[128:129], v64 offset0:176 offset1:177
    ds_read2_b32 v[130:131], v64 offset0:178 offset1:179
    v_mfma_f32_16x16x32_bf16 v[78:81], v[120:123], v[116:119], v[78:81]
    ds_read_b128 v[124:127], v58 offset:4864
    buffer_load_dwordx4 a[168:171], v17, s[8:11], s12 offen offset:2048 sc0 sc1
    v_mfma_f32_16x16x32_bf16 v[84:87], v[104:107], v[132:135], v[84:87]
    s_lshl_b32 s3, s45, 9
    s_add_u32 s3, s3, 20971520
    v_mfma_f32_16x16x32_bf16 v[84:87], v[136:139], v[116:119], v[84:87]
    v_add_u32 v32, s3, v32
    s_lshl_b32 s3, s29, 8
    v_mfma_f32_16x16x32_bf16 v[88:91], v[104:107], v[148:151], v[88:91]
    v_add_u32 v38, s3, v32
    s_lshl_b32 s3, s44, 10
    v_mfma_f32_16x16x32_bf16 v[88:91], v[112:115], v[116:119], v[88:91]
    s_add_u32 s3, s3, 147456
    v_lshl_add_u32 v39, v33, 4, s3
    v_mfma_f32_16x16x32_bf16 v[92:95], v[104:107], v[100:103], v[92:95]
    ds_read2_b32 v[96:97], v65 offset0:48 offset1:49
    ds_read2_b32 v[98:99], v65 offset0:50 offset1:51
    v_mfma_f32_16x16x32_bf16 v[92:95], v[144:147], v[116:119], v[92:95]
    ds_read_b128 v[140:143], v58 offset:2816
    s_waitcnt lgkmcnt(3)
    v_mfma_f32_16x16x32_bf16 v[84:87], v[128:131], v[108:111], v[84:87]
    buffer_load_dwordx4 a[172:175], v17, s[8:11], s12 offen offset:3072 sc0 sc1
    v_mfma_f32_16x16x32_bf16 v[84:87], v[120:123], v[124:127], v[84:87]
    v_and_b32 v32, 31, v2
    s_lshl_b32 s3, s30, 5
    v_mfma_f32_16x16x32_bf16 v[88:91], v[128:131], v[132:135], v[88:91]
    ds_read2_b32 v[104:105], v65 offset0:176 offset1:177
    ds_read2_b32 v[106:107], v65 offset0:178 offset1:179
    v_mfma_f32_16x16x32_bf16 v[88:91], v[136:139], v[124:127], v[88:91]
    ds_read_b128 v[100:103], v58 offset:768
    s_bfe_u32 s7, s15, 0x40008
    v_mfma_f32_16x16x32_bf16 v[92:95], v[128:131], v[148:151], v[92:95]
    ds_read2_b32 v[144:145], v57 offset0:32 offset1:33
    ds_read2_b32 v[146:147], v57 offset0:34 offset1:35
    v_mfma_f32_16x16x32_bf16 v[92:95], v[112:115], v[124:127], v[92:95]
    ds_read_b128 v[116:119], v59 offset:14848
    s_waitcnt lgkmcnt(6)
    v_mfma_f32_16x16x32_bf16 v[88:91], v[96:99], v[108:111], v[88:91]
    ds_read2_b32 v[128:129], v57 offset0:160 offset1:161
    ds_read2_b32 v[130:131], v57 offset0:162 offset1:163
    v_mfma_f32_16x16x32_bf16 v[88:91], v[120:123], v[140:143], v[88:91]
    ds_read_b128 v[148:151], v59 offset:12800
    s_lshl_b32 s7, s7, 12
    v_mfma_f32_16x16x32_bf16 v[92:95], v[96:99], v[132:135], v[92:95]
    ds_read2_b32 v[112:113], v63 offset0:32 offset1:33
    ds_read2_b32 v[114:115], v63 offset0:34 offset1:35
    v_mfma_f32_16x16x32_bf16 v[92:95], v[136:139], v[140:143], v[92:95]
    ds_read_b128 v[124:127], v59 offset:10752
    s_waitcnt lgkmcnt(6)
    v_mfma_f32_16x16x32_bf16 v[92:95], v[104:107], v[108:111], v[92:95]
    s_add_u32 s12, s6, s7
    buffer_load_dwordx4 a[176:179], v17, s[8:11], s12 offen offset:0 sc0 sc1
    v_mfma_f32_16x16x32_bf16 v[92:95], v[120:123], v[100:103], v[92:95]
    buffer_load_dwordx4 a[180:183], v17, s[8:11], s12 offen offset:1024 sc0 sc1
    v_mfma_f32_16x16x32_bf16 v[46:49], v[144:147], v[116:119], v[46:49]
    v_add_u32 v32, s3, v32
    s_waitcnt lgkmcnt(1)
    v_mfma_f32_16x16x32_bf16 v[66:69], v[128:131], v[116:119], v[66:69]
    ds_read2_b32 v[96:97], v63 offset0:160 offset1:161
    ds_read2_b32 v[98:99], v63 offset0:162 offset1:163
    v_mfma_f32_16x16x32_bf16 v[66:69], v[144:147], v[148:151], v[66:69]
    ds_read_b128 v[132:135], v59 offset:8704
    buffer_load_dwordx4 a[184:187], v17, s[8:11], s12 offen offset:2048 sc0 sc1
    v_mfma_f32_16x16x32_bf16 v[70:73], v[128:131], v[148:151], v[70:73]
    s_lshl_b32 s3, s46, 6
    v_add_u32 v32, s3, v32
    v_mfma_f32_16x16x32_bf16 v[70:73], v[112:115], v[116:119], v[70:73]
    v_lshlrev_b32 v33, 14, v33
    s_waitcnt lgkmcnt(3)
    v_mfma_f32_16x16x32_bf16 v[70:73], v[144:147], v[124:127], v[70:73]
    v_lshl_add_u32 v40, v32, 2, v33
    v_add_u32 v41, 4096, v40
    v_mfma_f32_16x16x32_bf16 v[74:77], v[112:115], v[148:151], v[74:77]
    v_add_u32 v42, 8192, v40
    v_add_u32 v43, 12288, v40
    v_mfma_f32_16x16x32_bf16 v[74:77], v[128:131], v[124:127], v[74:77]
    buffer_load_dwordx4 a[188:191], v17, s[8:11], s12 offen offset:3072 sc0 sc1
    v_mfma_f32_16x16x32_bf16 v[78:81], v[112:115], v[124:127], v[78:81]
    ds_read2_b32 v[136:137], v64 offset0:32 offset1:33
    s_waitcnt lgkmcnt(1)
    v_mfma_f32_16x16x32_bf16 v[74:77], v[96:99], v[116:119], v[74:77]
    ds_read2_b32 v[138:139], v64 offset0:34 offset1:35
    ds_read_b128 v[140:143], v59 offset:6656
    v_mfma_f32_16x16x32_bf16 v[74:77], v[144:147], v[132:135], v[74:77]
    buffer_load_dwordx2 v[82:83], v182, s[8:11], 0 offen sc0 sc1
    v_mfma_f32_16x16x32_bf16 v[78:81], v[96:99], v[148:151], v[78:81]
    s_lshl_b32 s39, s45, 19
    s_lshl_b32 s3, s29, 18
    v_mfma_f32_16x16x32_bf16 v[78:81], v[128:131], v[132:135], v[78:81]
    s_bfe_u32 s7, s15, 0x4000c
    s_lshl_b32 s7, s7, 12
    v_mfma_f32_16x16x32_bf16 v[84:87], v[96:99], v[124:127], v[84:87]
    s_add_u32 s12, s6, s7
    buffer_load_dwordx4 a[192:195], v17, s[8:11], s12 offen offset:0 sc0 sc1
    v_mfma_f32_16x16x32_bf16 v[84:87], v[112:115], v[132:135], v[84:87]
    s_add_u32 s39, s39, s3
    s_lshl_b32 s47, s44, 12
    v_mfma_f32_16x16x32_bf16 v[88:91], v[96:99], v[132:135], v[88:91]
    s_lshl_b32 s3, s44, 13
    s_waitcnt lgkmcnt(0)
    v_mfma_f32_16x16x32_bf16 v[78:81], v[136:139], v[116:119], v[78:81]
    ds_read2_b32 v[104:105], v64 offset0:160 offset1:161
    ds_read2_b32 v[106:107], v64 offset0:162 offset1:163
    v_mfma_f32_16x16x32_bf16 v[78:81], v[144:147], v[140:143], v[78:81]
    ds_read_b128 v[108:111], v59 offset:4608
    s_add_u32 s3, s3, 0
    v_mfma_f32_16x16x32_bf16 v[84:87], v[136:139], v[148:151], v[84:87]
    buffer_load_dwordx4 a[196:199], v17, s[8:11], s12 offen offset:1024 sc0 sc1
    v_mfma_f32_16x16x32_bf16 v[84:87], v[128:131], v[140:143], v[84:87]
    v_add_u32 v44, s3, v17
    v_xor_b32 v45, 0x4000, v44
    v_mfma_f32_16x16x32_bf16 v[88:91], v[136:139], v[124:127], v[88:91]
    s_lshl_b32 s3, s46, 9
    s_add_u32 s3, s3, 21520384
    v_mfma_f32_16x16x32_bf16 v[88:91], v[112:115], v[140:143], v[88:91]
    v_lshrrev_b32 v29, 1, v17
    v_add_u32 v29, s3, v29
    v_mfma_f32_16x16x32_bf16 v[92:95], v[136:139], v[132:135], v[92:95]
    ds_read2_b32 v[120:121], v65 offset0:32 offset1:33
    ds_read2_b32 v[122:123], v65 offset0:34 offset1:35
    v_mfma_f32_16x16x32_bf16 v[92:95], v[96:99], v[140:143], v[92:95]
    ds_read_b128 v[100:103], v59 offset:2560
    s_waitcnt lgkmcnt(3)
    v_mfma_f32_16x16x32_bf16 v[84:87], v[104:107], v[116:119], v[84:87]
    buffer_load_dwordx4 a[200:203], v17, s[8:11], s12 offen offset:2048 sc0 sc1
    v_mfma_f32_16x16x32_bf16 v[84:87], v[144:147], v[108:111], v[84:87]
    v_mfma_f32_16x16x32_bf16 v[88:91], v[104:107], v[148:151], v[88:91]
    ds_read2_b32 v[136:137], v65 offset0:160 offset1:161
    ds_read2_b32 v[138:139], v65 offset0:162 offset1:163
    v_mfma_f32_16x16x32_bf16 v[88:91], v[128:131], v[108:111], v[88:91]
    ds_read_b128 v[132:135], v59 offset:512
    v_mfma_f32_16x16x32_bf16 v[92:95], v[104:107], v[124:127], v[92:95]
    ds_read2_b32 v[96:97], v57 offset0:16 offset1:17
    ds_read2_b32 v[98:99], v57 offset0:18 offset1:19
    v_mfma_f32_16x16x32_bf16 v[92:95], v[112:115], v[108:111], v[92:95]
    ds_read_b128 v[140:143], v60 offset:14592
    s_waitcnt lgkmcnt(6)
    v_mfma_f32_16x16x32_bf16 v[88:91], v[120:123], v[116:119], v[88:91]
    ds_read2_b32 v[104:105], v57 offset0:144 offset1:145
    ds_read2_b32 v[106:107], v57 offset0:146 offset1:147
    v_mfma_f32_16x16x32_bf16 v[88:91], v[144:147], v[100:103], v[88:91]
    ds_read_b128 v[124:127], v60 offset:12544
    buffer_load_dwordx4 a[204:207], v17, s[8:11], s12 offen offset:3072 sc0 sc1
    v_mfma_f32_16x16x32_bf16 v[92:95], v[120:123], v[148:151], v[92:95]
    ds_read2_b32 v[112:113], v63 offset0:16 offset1:17
    ds_read2_b32 v[114:115], v63 offset0:18 offset1:19
    v_mfma_f32_16x16x32_bf16 v[92:95], v[128:131], v[100:103], v[92:95]
    ds_read_b128 v[108:111], v60 offset:10496
    s_waitcnt lgkmcnt(6)
    v_mfma_f32_16x16x32_bf16 v[92:95], v[136:139], v[116:119], v[92:95]
    s_bfe_u32 s7, s15, 0x40010
    s_lshl_b32 s7, s7, 12
    v_mfma_f32_16x16x32_bf16 v[92:95], v[144:147], v[132:135], v[92:95]
    s_add_u32 s12, s6, s7
    buffer_load_dwordx4 a[208:211], v17, s[8:11], s12 offen offset:0 sc0 sc1
    v_mfma_f32_16x16x32_bf16 v[46:49], v[96:99], v[140:143], v[46:49]
    s_waitcnt lgkmcnt(1)
    v_mfma_f32_16x16x32_bf16 v[66:69], v[104:107], v[140:143], v[66:69]
    ds_read2_b32 v[120:121], v63 offset0:144 offset1:145
    ds_read2_b32 v[122:123], v63 offset0:146 offset1:147
    v_mfma_f32_16x16x32_bf16 v[66:69], v[96:99], v[124:127], v[66:69]
    ds_read_b128 v[148:151], v60 offset:8448
    v_mfma_f32_16x16x32_bf16 v[70:73], v[104:107], v[124:127], v[70:73]
    buffer_load_dwordx4 a[212:215], v17, s[8:11], s12 offen offset:1024 sc0 sc1
    v_mfma_f32_16x16x32_bf16 v[70:73], v[112:115], v[140:143], v[70:73]
    s_waitcnt lgkmcnt(3)
    v_mfma_f32_16x16x32_bf16 v[70:73], v[96:99], v[108:111], v[70:73]
    v_mfma_f32_16x16x32_bf16 v[74:77], v[112:115], v[124:127], v[74:77]
    v_mfma_f32_16x16x32_bf16 v[74:77], v[104:107], v[108:111], v[74:77]
    v_mfma_f32_16x16x32_bf16 v[78:81], v[112:115], v[108:111], v[78:81]
    ds_read2_b32 v[128:129], v64 offset0:16 offset1:17
    s_waitcnt lgkmcnt(1)
    v_mfma_f32_16x16x32_bf16 v[74:77], v[120:123], v[140:143], v[74:77]
    ds_read2_b32 v[130:131], v64 offset0:18 offset1:19
    ds_read_b128 v[100:103], v60 offset:6400
    v_mfma_f32_16x16x32_bf16 v[74:77], v[96:99], v[148:151], v[74:77]
    buffer_load_dwordx4 a[216:219], v17, s[8:11], s12 offen offset:2048 sc0 sc1
    v_mfma_f32_16x16x32_bf16 v[78:81], v[120:123], v[124:127], v[78:81]
    v_mfma_f32_16x16x32_bf16 v[78:81], v[104:107], v[148:151], v[78:81]
    v_mfma_f32_16x16x32_bf16 v[84:87], v[120:123], v[108:111], v[84:87]
    buffer_load_dwordx4 a[220:223], v17, s[8:11], s12 offen offset:3072 sc0 sc1
    v_mfma_f32_16x16x32_bf16 v[84:87], v[112:115], v[148:151], v[84:87]
    s_mov_b32 s50, 0
    s_waitcnt vmcnt(8)
    v_cmp_ne_u64 vcc, s[42:43], v[82:83]
    s_nop 4
    s_cbranch_vccz Lfdone_gate_11
Lfpoll_gate_12:
    buffer_load_dwordx2 v[82:83], v182, s[8:11], 0 offen sc0 sc1
    s_waitcnt vmcnt(0)
    v_cmp_ne_u64 vcc, s[42:43], v[82:83]
    s_nop 4
    s_add_u32 s50, s50, 1
    s_cmp_gt_u32 s50, 20000
    s_cbranch_scc1 Lfdone_gate_11
    s_cbranch_vccnz Lfpoll_gate_12
Lfdone_gate_11:
    v_mfma_f32_16x16x32_bf16 v[88:91], v[120:123], v[148:151], v[88:91]
    s_bfe_u32 s17, s14, 0x40000
    s_waitcnt lgkmcnt(0)
    v_mfma_f32_16x16x32_bf16 v[78:81], v[128:131], v[140:143], v[78:81]
    ds_read2_b32 v[136:137], v64 offset0:144 offset1:145
    ds_read2_b32 v[138:139], v64 offset0:146 offset1:147
    v_mfma_f32_16x16x32_bf16 v[78:81], v[96:99], v[100:103], v[78:81]
    ds_read_b128 v[116:119], v60 offset:4352
    s_lshl_b32 s17, s17, 8
    v_mfma_f32_16x16x32_bf16 v[84:87], v[128:131], v[124:127], v[84:87]
    s_add_u32 s20, s16, s17
    s_add_u32 m0, s18, 32768
    v_mfma_f32_16x16x32_bf16 v[84:87], v[104:107], v[100:103], v[84:87]
    buffer_load_dwordx4 v7, s[8:11], s20 offen sc0 sc1 lds
    v_mfma_f32_16x16x32_bf16 v[88:91], v[128:131], v[108:111], v[88:91]
    s_bfe_u32 s7, s15, 0x40014
    s_lshl_b32 s7, s7, 12
    v_mfma_f32_16x16x32_bf16 v[88:91], v[112:115], v[100:103], v[88:91]
    s_add_u32 s12, s6, s7
    buffer_load_dwordx4 a[224:227], v17, s[8:11], s12 offen offset:0 sc0 sc1
    v_mfma_f32_16x16x32_bf16 v[92:95], v[128:131], v[148:151], v[92:95]
    ds_read2_b32 v[144:145], v65 offset0:16 offset1:17
    ds_read2_b32 v[146:147], v65 offset0:18 offset1:19
    v_mfma_f32_16x16x32_bf16 v[92:95], v[120:123], v[100:103], v[92:95]
    ds_read_b128 v[132:135], v60 offset:2304
    s_waitcnt lgkmcnt(3)
    v_mfma_f32_16x16x32_bf16 v[84:87], v[136:139], v[140:143], v[84:87]
    s_add_u32 m0, s18, 33792
    s_nop 0
    buffer_load_dwordx4 v8, s[8:11], s20 offen sc0 sc1 lds
    v_mfma_f32_16x16x32_bf16 v[84:87], v[96:99], v[116:119], v[84:87]
    buffer_load_dwordx4 a[228:231], v17, s[8:11], s12 offen offset:1024 sc0 sc1
    v_mfma_f32_16x16x32_bf16 v[88:91], v[136:139], v[124:127], v[88:91]
    ds_read2_b32 v[128:129], v65 offset0:144 offset1:145
    ds_read2_b32 v[130:131], v65 offset0:146 offset1:147
    v_mfma_f32_16x16x32_bf16 v[88:91], v[104:107], v[116:119], v[88:91]
    ds_read_b128 v[148:151], v60 offset:256
    s_add_u32 m0, s18, 34816
    v_mfma_f32_16x16x32_bf16 v[92:95], v[136:139], v[108:111], v[92:95]
    ds_read2_b32 v[120:121], v57 offset0:0 offset1:1
    ds_read2_b32 v[122:123], v57 offset0:2 offset1:3
    v_mfma_f32_16x16x32_bf16 v[92:95], v[112:115], v[116:119], v[92:95]
    ds_read_b128 v[100:103], v61 offset:14336
    s_waitcnt lgkmcnt(6)
    v_mfma_f32_16x16x32_bf16 v[88:91], v[144:147], v[140:143], v[88:91]
    ds_read2_b32 v[136:137], v57 offset0:128 offset1:129
    ds_read2_b32 v[138:139], v57 offset0:130 offset1:131
    v_mfma_f32_16x16x32_bf16 v[88:91], v[96:99], v[132:135], v[88:91]
    ds_read_b128 v[108:111], v61 offset:12288
    buffer_load_dwordx4 v9, s[8:11], s20 offen sc0 sc1 lds
    v_mfma_f32_16x16x32_bf16 v[92:95], v[144:147], v[124:127], v[92:95]
    ds_read2_b32 v[112:113], v63 offset0:0 offset1:1
    ds_read2_b32 v[114:115], v63 offset0:2 offset1:3
    v_mfma_f32_16x16x32_bf16 v[92:95], v[104:107], v[132:135], v[92:95]
    ds_read_b128 v[116:119], v61 offset:10240
    s_waitcnt lgkmcnt(6)
    v_mfma_f32_16x16x32_bf16 v[92:95], v[128:131], v[140:143], v[92:95]
    buffer_load_dwordx4 a[232:235], v17, s[8:11], s12 offen offset:2048 sc0 sc1
    v_mfma_f32_16x16x32_bf16 v[92:95], v[96:99], v[148:151], v[92:95]
    s_add_u32 m0, s18, 35840
    s_nop 0
    buffer_load_dwordx4 v10, s[8:11], s20 offen sc0 sc1 lds
    v_mfma_f32_16x16x32_bf16 v[46:49], v[120:123], v[100:103], v[46:49]
    buffer_load_dwordx4 a[236:239], v17, s[8:11], s12 offen offset:3072 sc0 sc1
    s_waitcnt lgkmcnt(1)
    v_mfma_f32_16x16x32_bf16 v[66:69], v[136:139], v[100:103], v[66:69]
    ds_read2_b32 v[144:145], v63 offset0:128 offset1:129
    ds_read2_b32 v[146:147], v63 offset0:130 offset1:131
    v_mfma_f32_16x16x32_bf16 v[66:69], v[120:123], v[108:111], v[66:69]
    ds_read_b128 v[124:127], v61 offset:8192
    s_add_u32 s21, s20, 65536
    v_mfma_f32_16x16x32_bf16 v[70:73], v[136:139], v[108:111], v[70:73]
    s_add_u32 m0, s18, 36864
    s_nop 0
    buffer_load_dwordx4 v7, s[8:11], s21 offen sc0 sc1 lds
    v_mfma_f32_16x16x32_bf16 v[70:73], v[112:115], v[100:103], v[70:73]
    s_bfe_u32 s7, s15, 0x40018
    s_waitcnt lgkmcnt(3)
    v_mfma_f32_16x16x32_bf16 v[70:73], v[120:123], v[116:119], v[70:73]
    s_lshl_b32 s7, s7, 12
    s_add_u32 s12, s6, s7
    v_mfma_f32_16x16x32_bf16 v[74:77], v[112:115], v[108:111], v[74:77]
    buffer_load_dwordx4 a[240:243], v17, s[8:11], s12 offen offset:0 sc0 sc1
    v_mfma_f32_16x16x32_bf16 v[74:77], v[136:139], v[116:119], v[74:77]
    s_add_u32 m0, s18, 37888
    s_nop 0
    buffer_load_dwordx4 v8, s[8:11], s21 offen sc0 sc1 lds
    v_mfma_f32_16x16x32_bf16 v[78:81], v[112:115], v[116:119], v[78:81]
    ds_read2_b32 v[104:105], v64 offset0:0 offset1:1
    s_waitcnt lgkmcnt(1)
    v_mfma_f32_16x16x32_bf16 v[74:77], v[144:147], v[100:103], v[74:77]
    ds_read2_b32 v[106:107], v64 offset0:2 offset1:3
    ds_read_b128 v[132:135], v61 offset:6144
    v_mfma_f32_16x16x32_bf16 v[74:77], v[120:123], v[124:127], v[74:77]
    buffer_load_dwordx4 a[244:247], v17, s[8:11], s12 offen offset:1024 sc0 sc1
    v_mfma_f32_16x16x32_bf16 v[78:81], v[144:147], v[108:111], v[78:81]
    s_add_u32 m0, s18, 38912
    s_nop 0
    buffer_load_dwordx4 v9, s[8:11], s21 offen sc0 sc1 lds
    v_mfma_f32_16x16x32_bf16 v[78:81], v[136:139], v[124:127], v[78:81]
    v_mfma_f32_16x16x32_bf16 v[84:87], v[144:147], v[116:119], v[84:87]
    v_mfma_f32_16x16x32_bf16 v[84:87], v[112:115], v[124:127], v[84:87]
    s_add_u32 m0, s18, 39936
    s_nop 0
    buffer_load_dwordx4 v10, s[8:11], s21 offen sc0 sc1 lds
    v_mfma_f32_16x16x32_bf16 v[88:91], v[144:147], v[124:127], v[88:91]
    buffer_load_dwordx4 a[248:251], v17, s[8:11], s12 offen offset:2048 sc0 sc1
    s_waitcnt lgkmcnt(0)
    v_mfma_f32_16x16x32_bf16 v[78:81], v[104:107], v[100:103], v[78:81]
    ds_read2_b32 v[128:129], v64 offset0:128 offset1:129
    ds_read2_b32 v[130:131], v64 offset0:130 offset1:131
    v_mfma_f32_16x16x32_bf16 v[78:81], v[120:123], v[132:135], v[78:81]
    ds_read_b128 v[140:143], v61 offset:4096
    v_mfma_f32_16x16x32_bf16 v[84:87], v[104:107], v[108:111], v[84:87]
    v_mfma_f32_16x16x32_bf16 v[84:87], v[136:139], v[132:135], v[84:87]
    v_mfma_f32_16x16x32_bf16 v[88:91], v[104:107], v[116:119], v[88:91]
    buffer_load_dwordx4 a[252:255], v17, s[8:11], s12 offen offset:3072 sc0 sc1
    v_mfma_f32_16x16x32_bf16 v[88:91], v[112:115], v[132:135], v[88:91]
    v_mfma_f32_16x16x32_bf16 v[92:95], v[104:107], v[124:127], v[92:95]
    ds_read2_b32 v[96:97], v65 offset0:0 offset1:1
    ds_read2_b32 v[98:99], v65 offset0:2 offset1:3
    v_mfma_f32_16x16x32_bf16 v[92:95], v[144:147], v[132:135], v[92:95]
    ds_read_b128 v[148:151], v61 offset:2048
    s_waitcnt lgkmcnt(3)
    v_mfma_f32_16x16x32_bf16 v[84:87], v[128:131], v[100:103], v[84:87]
    v_mfma_f32_16x16x32_bf16 v[84:87], v[120:123], v[140:143], v[84:87]
    v_mfma_f32_16x16x32_bf16 v[88:91], v[128:131], v[108:111], v[88:91]
    ds_read2_b32 v[104:105], v65 offset0:128 offset1:129
    ds_read2_b32 v[106:107], v65 offset0:130 offset1:131
    v_mfma_f32_16x16x32_bf16 v[88:91], v[136:139], v[140:143], v[88:91]
    ds_read_b128 v[124:127], v61 offset:0
    v_mfma_f32_16x16x32_bf16 v[92:95], v[128:131], v[116:119], v[92:95]
    v_mfma_f32_16x16x32_bf16 v[92:95], v[112:115], v[140:143], v[92:95]
    s_waitcnt lgkmcnt(3)
    v_mfma_f32_16x16x32_bf16 v[88:91], v[96:99], v[100:103], v[88:91]
    v_mfma_f32_16x16x32_bf16 v[88:91], v[120:123], v[148:151], v[88:91]
    v_mfma_f32_16x16x32_bf16 v[92:95], v[96:99], v[108:111], v[92:95]
    v_mfma_f32_16x16x32_bf16 v[92:95], v[136:139], v[148:151], v[92:95]
    s_waitcnt lgkmcnt(0)
    v_mfma_f32_16x16x32_bf16 v[92:95], v[104:107], v[100:103], v[92:95]
    v_mfma_f32_16x16x32_bf16 v[92:95], v[120:123], v[124:127], v[92:95]
    s_barrier
    ds_read_b128 v[96:99], v4 offset:0
    ds_read_b128 v[100:103], v4 offset:8192
    ds_read_b128 v[104:107], v18 offset:0
    ds_read_b128 v[108:111], v18 offset:8192
    s_bfe_u32 s17, s14, 0x40004
    s_lshl_b32 s17, s17, 8
    s_add_u32 s20, s16, s17
    s_add_u32 m0, s18, 65536
    s_waitcnt lgkmcnt(3)
    v_mfma_f32_32x32x16_bf16 v[128:143], v[96:99], a[0:3], 0
    ds_read_b128 v[112:115], v5 offset:0
    ds_read_b128 v[116:119], v5 offset:8192
    buffer_load_dwordx4 v7, s[8:11], s20 offen sc0 sc1 lds
    ds_read_b64 v[26:27], v62 offset:14336
    ds_read_b64 v[32:33], v62 offset:12288
    ds_read_b64 v[50:51], v62 offset:10240
    ds_read_b64 v[54:55], v62 offset:8192
    ds_read_b64 v[176:177], v62 offset:6144
    ds_read_b64 v[178:179], v62 offset:4096
    s_add_u32 m0, s18, 66560
    s_waitcnt lgkmcnt(10)
    v_mfma_f32_32x32x16_bf16 v[144:159], v[100:103], a[0:3], 0
    ds_read_b128 v[120:123], v19 offset:0
    ds_read_b128 v[124:127], v19 offset:8192
    buffer_load_dwordx4 v8, s[8:11], s20 offen sc0 sc1 lds
    ds_read_b64 v[200:201], v62 offset:2048
    ds_read_b64 v[202:203], v62 offset:0
    s_add_u32 s4, s22, 12582912
    s_waitcnt lgkmcnt(9)
    v_and_b32 v204, s5, v27
    v_lshlrev_b32 v205, 16, v27
    v_and_b32 v206, s5, v26
    s_add_u32 m0, s18, 67584
    v_mfma_f32_32x32x16_bf16 v[160:175], v[104:107], a[0:3], 0
    buffer_load_dwordx4 v9, s[8:11], s20 offen sc0 sc1 lds
    v_lshlrev_b32 v207, 16, v26
    v_fmac_f32 v46, v183, v204
    v_fmac_f32 v47, v183, v205
    v_fmac_f32 v48, v183, v206
    v_fmac_f32 v49, v183, v207
    v_cvt_pk_bf16_f32 v208, v46, v47
    v_cvt_pk_bf16_f32 v209, v48, v49
    s_waitcnt lgkmcnt(8)
    v_and_b32 v204, s5, v33
    s_add_u32 m0, s18, 68608
    v_mfma_f32_32x32x16_bf16 v[184:199], v[108:111], a[0:3], 0
    buffer_load_dwordx4 v10, s[8:11], s20 offen sc0 sc1 lds
    v_lshlrev_b32 v205, 16, v33
    v_and_b32 v206, s5, v32
    v_lshlrev_b32 v207, 16, v32
    v_fmac_f32 v66, v183, v204
    v_fmac_f32 v67, v183, v205
    v_fmac_f32 v68, v183, v206
    v_fmac_f32 v69, v183, v207
    v_cvt_pk_bf16_f32 v210, v66, v67
    v_cvt_pk_bf16_f32 v211, v68, v69
    s_add_u32 s21, s20, 65536
    s_add_u32 m0, s18, 69632
    v_mfma_f32_32x32x16_bf16 v[128:143], v[112:115], a[4:7], v[128:143]
    ds_read_b128 v[96:99], v11 offset:0
    ds_read_b128 v[100:103], v11 offset:8192
    buffer_load_dwordx4 v7, s[8:11], s21 offen sc0 sc1 lds
    v_permlane16_swap_b32 v208, v210
    v_permlane16_swap_b32 v209, v211
    s_waitcnt lgkmcnt(9)
    v_and_b32 v204, s5, v51
    v_lshlrev_b32 v205, 16, v51
    v_and_b32 v206, s5, v50
    v_lshlrev_b32 v207, 16, v50
    s_add_u32 m0, s18, 70656
    v_mfma_f32_32x32x16_bf16 v[144:159], v[116:119], a[4:7], v[144:159]
    ds_read_b128 v[104:107], v20 offset:0
    ds_read_b128 v[108:111], v20 offset:8192
    buffer_load_dwordx4 v8, s[8:11], s21 offen sc0 sc1 lds
    v_fmac_f32 v70, v183, v204
    v_fmac_f32 v71, v183, v205
    v_fmac_f32 v72, v183, v206
    v_fmac_f32 v73, v183, v207
    v_cvt_pk_bf16_f32 v212, v70, v71
    v_cvt_pk_bf16_f32 v213, v72, v73
    s_add_u32 m0, s18, 71680
    s_waitcnt lgkmcnt(7)
    v_mfma_f32_32x32x16_bf16 v[160:175], v[120:123], a[4:7], v[160:175]
    buffer_load_dwordx4 v9, s[8:11], s21 offen sc0 sc1 lds
    v_and_b32 v204, s5, v55
    v_lshlrev_b32 v205, 16, v55
    v_and_b32 v206, s5, v54
    v_lshlrev_b32 v207, 16, v54
    v_fmac_f32 v74, v183, v204
    v_fmac_f32 v75, v183, v205
    v_fmac_f32 v76, v183, v206
    v_fmac_f32 v77, v183, v207
    s_add_u32 m0, s18, 72704
    s_waitcnt lgkmcnt(6)
    v_mfma_f32_32x32x16_bf16 v[184:199], v[124:127], a[4:7], v[184:199]
    buffer_load_dwordx4 v10, s[8:11], s21 offen sc0 sc1 lds
    v_cvt_pk_bf16_f32 v214, v74, v75
    v_cvt_pk_bf16_f32 v215, v76, v77
    s_nop 0
    v_permlane16_swap_b32 v212, v214
    v_permlane16_swap_b32 v213, v215
    v_and_b32 v204, s5, v177
    v_lshlrev_b32 v205, 16, v177
    v_and_b32 v206, s5, v176
    v_lshlrev_b32 v207, 16, v176
    v_fmac_f32 v78, v183, v204
    s_bfe_u32 s17, s14, 0x40008
    s_lshl_b32 s17, s17, 8
    s_add_u32 s20, s16, s17
    s_add_u32 m0, s18, 98304
    s_waitcnt lgkmcnt(3)
    v_mfma_f32_32x32x16_bf16 v[128:143], v[96:99], a[8:11], v[128:143]
    ds_read_b128 v[112:115], v12 offset:0
    ds_read_b128 v[116:119], v12 offset:8192
    buffer_load_dwordx4 v7, s[8:11], s20 offen sc0 sc1 lds
    v_fmac_f32 v79, v183, v205
    v_fmac_f32 v80, v183, v206
    v_fmac_f32 v81, v183, v207
    v_cvt_pk_bf16_f32 v216, v78, v79
    v_cvt_pk_bf16_f32 v217, v80, v81
    v_and_b32 v204, s5, v179
    s_add_u32 m0, s18, 99328
    s_waitcnt lgkmcnt(4)
    v_mfma_f32_32x32x16_bf16 v[144:159], v[100:103], a[8:11], v[144:159]
    ds_read_b128 v[120:123], v21 offset:0
    ds_read_b128 v[124:127], v21 offset:8192
    buffer_load_dwordx4 v8, s[8:11], s20 offen sc0 sc1 lds
    v_lshlrev_b32 v205, 16, v179
    v_and_b32 v206, s5, v178
    v_lshlrev_b32 v207, 16, v178
    v_fmac_f32 v84, v183, v204
    v_fmac_f32 v85, v183, v205
    v_fmac_f32 v86, v183, v206
    s_add_u32 m0, s18, 100352
    s_waitcnt lgkmcnt(5)
    v_mfma_f32_32x32x16_bf16 v[160:175], v[104:107], a[8:11], v[160:175]
    buffer_load_dwordx4 v9, s[8:11], s20 offen sc0 sc1 lds
    v_fmac_f32 v87, v183, v207
    v_cvt_pk_bf16_f32 v218, v84, v85
    v_cvt_pk_bf16_f32 v219, v86, v87
    s_nop 0
    v_permlane16_swap_b32 v216, v218
    v_permlane16_swap_b32 v217, v219
    v_and_b32 v204, s5, v201
    v_lshlrev_b32 v205, 16, v201
    v_and_b32 v206, s5, v200
    s_add_u32 m0, s18, 101376
    s_waitcnt lgkmcnt(4)
    v_mfma_f32_32x32x16_bf16 v[184:199], v[108:111], a[8:11], v[184:199]
    buffer_load_dwordx4 v10, s[8:11], s20 offen sc0 sc1 lds
    v_lshlrev_b32 v207, 16, v200
    v_fmac_f32 v88, v183, v204
    v_fmac_f32 v89, v183, v205
    v_fmac_f32 v90, v183, v206
    v_fmac_f32 v91, v183, v207
    v_cvt_pk_bf16_f32 v220, v88, v89
    v_cvt_pk_bf16_f32 v221, v90, v91
    v_and_b32 v204, s5, v203
    v_lshlrev_b32 v205, 16, v203
    s_waitcnt lgkmcnt(0)
    s_waitcnt vmcnt(14)
    s_barrier
    s_add_u32 s21, s20, 65536
    s_add_u32 m0, s18, 102400
    v_mfma_f32_32x32x16_bf16 v[128:143], v[112:115], a[12:15], v[128:143]
    ds_read_b128 v[96:99], v4 offset:32768
    ds_read_b128 v[100:103], v4 offset:40960
    buffer_load_dwordx4 v7, s[8:11], s21 offen sc0 sc1 lds
    v_and_b32 v206, s5, v202
    v_lshlrev_b32 v207, 16, v202
    v_fmac_f32 v92, v183, v204
    v_fmac_f32 v93, v183, v205
    v_fmac_f32 v94, v183, v206
    v_fmac_f32 v95, v183, v207
    s_add_u32 m0, s18, 103424
    v_mfma_f32_32x32x16_bf16 v[144:159], v[116:119], a[12:15], v[144:159]
    ds_read_b128 v[104:107], v18 offset:32768
    ds_read_b128 v[108:111], v18 offset:40960
    buffer_load_dwordx4 v8, s[8:11], s21 offen sc0 sc1 lds
    v_cvt_pk_bf16_f32 v222, v92, v93
    v_cvt_pk_bf16_f32 v223, v94, v95
    s_nop 0
    v_permlane16_swap_b32 v220, v222
    v_permlane16_swap_b32 v221, v223
    s_add_u32 m0, s18, 104448
    v_mfma_f32_32x32x16_bf16 v[160:175], v[120:123], a[12:15], v[160:175]
    buffer_load_dwordx4 v9, s[8:11], s21 offen sc0 sc1 lds
    s_add_u32 m0, s18, 105472
    v_mfma_f32_32x32x16_bf16 v[184:199], v[124:127], a[12:15], v[184:199]
    buffer_load_dwordx4 v10, s[8:11], s21 offen sc0 sc1 lds
    s_waitcnt lgkmcnt(3)
    v_mfma_f32_32x32x16_bf16 v[128:143], v[96:99], a[16:19], v[128:143]
    ds_read_b128 v[112:115], v5 offset:32768
    ds_read_b128 v[116:119], v5 offset:40960
    buffer_store_dwordx4 v[208:211], v180, s[8:11], s4 offen offset:0 sc0 sc1
    buffer_store_dwordx4 v[212:215], v180, s[8:11], s4 offen offset:1024 sc0 sc1
    buffer_store_dwordx4 v[216:219], v180, s[8:11], s4 offen offset:2048 sc0 sc1
    s_waitcnt lgkmcnt(4)
    v_mfma_f32_32x32x16_bf16 v[144:159], v[100:103], a[16:19], v[144:159]
    ds_read_b128 v[120:123], v19 offset:32768
    ds_read_b128 v[124:127], v19 offset:40960
    s_bfe_u32 s17, s14, 0x4000c
    s_lshl_b32 s17, s17, 8
    s_add_u32 s20, s16, s17
    s_add_u32 m0, s18, 0
    s_waitcnt lgkmcnt(5)
    v_mfma_f32_32x32x16_bf16 v[160:175], v[104:107], a[16:19], v[160:175]
    buffer_load_dwordx4 v7, s[8:11], s20 offen sc0 sc1 lds
    buffer_store_dwordx4 v[220:223], v180, s[8:11], s4 offen offset:3072 sc0 sc1
    s_add_u32 m0, s18, 1024
    s_waitcnt lgkmcnt(4)
    v_mfma_f32_32x32x16_bf16 v[184:199], v[108:111], a[16:19], v[184:199]
    buffer_load_dwordx4 v8, s[8:11], s20 offen sc0 sc1 lds
    s_waitcnt lgkmcnt(3)
    v_mfma_f32_32x32x16_bf16 v[128:143], v[112:115], a[20:23], v[128:143]
    ds_read_b128 v[96:99], v11 offset:32768
    ds_read_b128 v[100:103], v11 offset:40960
    s_waitcnt lgkmcnt(4)
    v_mfma_f32_32x32x16_bf16 v[144:159], v[116:119], a[20:23], v[144:159]
    ds_read_b128 v[104:107], v20 offset:32768
    ds_read_b128 v[108:111], v20 offset:40960
    s_add_u32 m0, s18, 2048
    s_waitcnt lgkmcnt(5)
    v_mfma_f32_32x32x16_bf16 v[160:175], v[120:123], a[20:23], v[160:175]
    buffer_load_dwordx4 v9, s[8:11], s20 offen sc0 sc1 lds
    s_add_u32 m0, s18, 3072
    s_waitcnt lgkmcnt(4)
    v_mfma_f32_32x32x16_bf16 v[184:199], v[124:127], a[20:23], v[184:199]
    buffer_load_dwordx4 v10, s[8:11], s20 offen sc0 sc1 lds
    s_waitcnt lgkmcnt(3)
    v_mfma_f32_32x32x16_bf16 v[128:143], v[96:99], a[24:27], v[128:143]
    ds_read_b128 v[112:115], v12 offset:32768
    ds_read_b128 v[116:119], v12 offset:40960
    s_waitcnt lgkmcnt(4)
    v_mfma_f32_32x32x16_bf16 v[144:159], v[100:103], a[24:27], v[144:159]
    ds_read_b128 v[120:123], v21 offset:32768
    ds_read_b128 v[124:127], v21 offset:40960
    s_add_u32 s21, s20, 65536
    s_add_u32 m0, s18, 4096
    s_waitcnt lgkmcnt(5)
    v_mfma_f32_32x32x16_bf16 v[160:175], v[104:107], a[24:27], v[160:175]
    buffer_load_dwordx4 v7, s[8:11], s21 offen sc0 sc1 lds
    s_add_u32 m0, s18, 5120
    s_waitcnt lgkmcnt(4)
    v_mfma_f32_32x32x16_bf16 v[184:199], v[108:111], a[24:27], v[184:199]
    buffer_load_dwordx4 v8, s[8:11], s21 offen sc0 sc1 lds
    s_waitcnt lgkmcnt(0)
    s_waitcnt vmcnt(18)
    s_barrier
    v_mfma_f32_32x32x16_bf16 v[128:143], v[112:115], a[28:31], v[128:143]
    ds_read_b128 v[96:99], v13 offset:0
    ds_read_b128 v[100:103], v13 offset:8192
    v_mfma_f32_32x32x16_bf16 v[144:159], v[116:119], a[28:31], v[144:159]
    ds_read_b128 v[104:107], v22 offset:0
    ds_read_b128 v[108:111], v22 offset:8192
    s_add_u32 m0, s18, 6144
    v_mfma_f32_32x32x16_bf16 v[160:175], v[120:123], a[28:31], v[160:175]
    buffer_load_dwordx4 v9, s[8:11], s21 offen sc0 sc1 lds
    s_add_u32 m0, s18, 7168
    v_mfma_f32_32x32x16_bf16 v[184:199], v[124:127], a[28:31], v[184:199]
    buffer_load_dwordx4 v10, s[8:11], s21 offen sc0 sc1 lds
    s_waitcnt lgkmcnt(3)
    v_mfma_f32_32x32x16_bf16 v[128:143], v[96:99], a[32:35], v[128:143]
    ds_read_b128 v[112:115], v14 offset:0
    ds_read_b128 v[116:119], v14 offset:8192
    s_waitcnt lgkmcnt(4)
    v_mfma_f32_32x32x16_bf16 v[144:159], v[100:103], a[32:35], v[144:159]
    ds_read_b128 v[120:123], v23 offset:0
    ds_read_b128 v[124:127], v23 offset:8192
    s_bfe_u32 s17, s14, 0x40010
    s_lshl_b32 s17, s17, 8
    s_add_u32 s20, s16, s17
    s_add_u32 m0, s18, 32768
    s_waitcnt lgkmcnt(5)
    v_mfma_f32_32x32x16_bf16 v[160:175], v[104:107], a[32:35], v[160:175]
    buffer_load_dwordx4 v7, s[8:11], s20 offen sc0 sc1 lds
    s_add_u32 m0, s18, 33792
    s_waitcnt lgkmcnt(4)
    v_mfma_f32_32x32x16_bf16 v[184:199], v[108:111], a[32:35], v[184:199]
    buffer_load_dwordx4 v8, s[8:11], s20 offen sc0 sc1 lds
    s_waitcnt lgkmcnt(3)
    v_mfma_f32_32x32x16_bf16 v[128:143], v[112:115], a[36:39], v[128:143]
    ds_read_b128 v[96:99], v15 offset:0
    ds_read_b128 v[100:103], v15 offset:8192
    s_waitcnt lgkmcnt(4)
    v_mfma_f32_32x32x16_bf16 v[144:159], v[116:119], a[36:39], v[144:159]
    ds_read_b128 v[104:107], v24 offset:0
    ds_read_b128 v[108:111], v24 offset:8192
    s_add_u32 m0, s18, 34816
    s_waitcnt lgkmcnt(5)
    v_mfma_f32_32x32x16_bf16 v[160:175], v[120:123], a[36:39], v[160:175]
    buffer_load_dwordx4 v9, s[8:11], s20 offen sc0 sc1 lds
    s_add_u32 m0, s18, 35840
    s_waitcnt lgkmcnt(4)
    v_mfma_f32_32x32x16_bf16 v[184:199], v[124:127], a[36:39], v[184:199]
    buffer_load_dwordx4 v10, s[8:11], s20 offen sc0 sc1 lds
    s_waitcnt lgkmcnt(3)
    v_mfma_f32_32x32x16_bf16 v[128:143], v[96:99], a[40:43], v[128:143]
    ds_read_b128 v[112:115], v16 offset:0
    ds_read_b128 v[116:119], v16 offset:8192
    s_waitcnt lgkmcnt(4)
    v_mfma_f32_32x32x16_bf16 v[144:159], v[100:103], a[40:43], v[144:159]
    ds_read_b128 v[120:123], v25 offset:0
    ds_read_b128 v[124:127], v25 offset:8192
    s_add_u32 s21, s20, 65536
    s_add_u32 m0, s18, 36864
    s_waitcnt lgkmcnt(5)
    v_mfma_f32_32x32x16_bf16 v[160:175], v[104:107], a[40:43], v[160:175]
    buffer_load_dwordx4 v7, s[8:11], s21 offen sc0 sc1 lds
    s_add_u32 m0, s18, 37888
    s_waitcnt lgkmcnt(4)
    v_mfma_f32_32x32x16_bf16 v[184:199], v[108:111], a[40:43], v[184:199]
    buffer_load_dwordx4 v8, s[8:11], s21 offen sc0 sc1 lds
    s_waitcnt lgkmcnt(0)
    s_waitcnt vmcnt(18)
    s_barrier
    v_mfma_f32_32x32x16_bf16 v[128:143], v[112:115], a[44:47], v[128:143]
    ds_read_b128 v[96:99], v13 offset:32768
    ds_read_b128 v[100:103], v13 offset:40960
    v_mfma_f32_32x32x16_bf16 v[144:159], v[116:119], a[44:47], v[144:159]
    ds_read_b128 v[104:107], v22 offset:32768
    ds_read_b128 v[108:111], v22 offset:40960
    s_add_u32 m0, s18, 38912
    v_mfma_f32_32x32x16_bf16 v[160:175], v[120:123], a[44:47], v[160:175]
    buffer_load_dwordx4 v9, s[8:11], s21 offen sc0 sc1 lds
    s_add_u32 m0, s18, 39936
    v_mfma_f32_32x32x16_bf16 v[184:199], v[124:127], a[44:47], v[184:199]
    buffer_load_dwordx4 v10, s[8:11], s21 offen sc0 sc1 lds
    s_waitcnt lgkmcnt(3)
    v_mfma_f32_32x32x16_bf16 v[128:143], v[96:99], a[48:51], v[128:143]
    ds_read_b128 v[112:115], v14 offset:32768
    ds_read_b128 v[116:119], v14 offset:40960
    s_waitcnt lgkmcnt(4)
    v_mfma_f32_32x32x16_bf16 v[144:159], v[100:103], a[48:51], v[144:159]
    ds_read_b128 v[120:123], v23 offset:32768
    ds_read_b128 v[124:127], v23 offset:40960
    s_bfe_u32 s17, s14, 0x40014
    s_lshl_b32 s17, s17, 8
    s_add_u32 s20, s16, s17
    s_add_u32 m0, s18, 65536
    s_waitcnt lgkmcnt(5)
    v_mfma_f32_32x32x16_bf16 v[160:175], v[104:107], a[48:51], v[160:175]
    buffer_load_dwordx4 v7, s[8:11], s20 offen sc0 sc1 lds
    s_add_u32 m0, s18, 66560
    s_waitcnt lgkmcnt(4)
    v_mfma_f32_32x32x16_bf16 v[184:199], v[108:111], a[48:51], v[184:199]
    buffer_load_dwordx4 v8, s[8:11], s20 offen sc0 sc1 lds
    s_waitcnt lgkmcnt(3)
    v_mfma_f32_32x32x16_bf16 v[128:143], v[112:115], a[52:55], v[128:143]
    ds_read_b128 v[96:99], v15 offset:32768
    ds_read_b128 v[100:103], v15 offset:40960
    s_waitcnt lgkmcnt(4)
    v_mfma_f32_32x32x16_bf16 v[144:159], v[116:119], a[52:55], v[144:159]
    ds_read_b128 v[104:107], v24 offset:32768
    ds_read_b128 v[108:111], v24 offset:40960
    s_add_u32 m0, s18, 67584
    s_waitcnt lgkmcnt(5)
    v_mfma_f32_32x32x16_bf16 v[160:175], v[120:123], a[52:55], v[160:175]
    buffer_load_dwordx4 v9, s[8:11], s20 offen sc0 sc1 lds
    s_add_u32 m0, s18, 68608
    s_waitcnt lgkmcnt(4)
    v_mfma_f32_32x32x16_bf16 v[184:199], v[124:127], a[52:55], v[184:199]
    buffer_load_dwordx4 v10, s[8:11], s20 offen sc0 sc1 lds
    s_waitcnt lgkmcnt(3)
    v_mfma_f32_32x32x16_bf16 v[128:143], v[96:99], a[56:59], v[128:143]
    ds_read_b128 v[112:115], v16 offset:32768
    ds_read_b128 v[116:119], v16 offset:40960
    s_waitcnt lgkmcnt(4)
    v_mfma_f32_32x32x16_bf16 v[144:159], v[100:103], a[56:59], v[144:159]
    ds_read_b128 v[120:123], v25 offset:32768
    ds_read_b128 v[124:127], v25 offset:40960
    s_add_u32 s21, s20, 65536
    s_add_u32 m0, s18, 69632
    s_waitcnt lgkmcnt(5)
    v_mfma_f32_32x32x16_bf16 v[160:175], v[104:107], a[56:59], v[160:175]
    buffer_load_dwordx4 v7, s[8:11], s21 offen sc0 sc1 lds
    s_add_u32 m0, s18, 70656
    s_waitcnt lgkmcnt(4)
    v_mfma_f32_32x32x16_bf16 v[184:199], v[108:111], a[56:59], v[184:199]
    buffer_load_dwordx4 v8, s[8:11], s21 offen sc0 sc1 lds
    s_waitcnt lgkmcnt(0)
    s_waitcnt vmcnt(14)
    s_barrier
    v_mfma_f32_32x32x16_bf16 v[128:143], v[112:115], a[60:63], v[128:143]
    ds_read_b128 v[96:99], v4 offset:0
    ds_read_b128 v[100:103], v4 offset:8192
    v_mfma_f32_32x32x16_bf16 v[144:159], v[116:119], a[60:63], v[144:159]
    ds_read_b128 v[104:107], v18 offset:0
    ds_read_b128 v[108:111], v18 offset:8192
    s_add_u32 m0, s18, 71680
    v_mfma_f32_32x32x16_bf16 v[160:175], v[120:123], a[60:63], v[160:175]
    buffer_load_dwordx4 v9, s[8:11], s21 offen sc0 sc1 lds
    s_add_u32 m0, s18, 72704
    v_mfma_f32_32x32x16_bf16 v[184:199], v[124:127], a[60:63], v[184:199]
    buffer_load_dwordx4 v10, s[8:11], s21 offen sc0 sc1 lds
    s_waitcnt lgkmcnt(3)
    v_mfma_f32_32x32x16_bf16 v[128:143], v[96:99], a[64:67], v[128:143]
    ds_read_b128 v[112:115], v5 offset:0
    ds_read_b128 v[116:119], v5 offset:8192
    v_mov_b32 v82, s42
    v_mov_b32 v83, s43
    s_mov_b64 s[22:23], exec
    s_mov_b64 exec, 1
    buffer_store_dwordx2 v[82:83], v6, s[8:11], s13 offen sc0 sc1
    s_mov_b64 exec, s[22:23]
    s_waitcnt lgkmcnt(4)
    v_mfma_f32_32x32x16_bf16 v[144:159], v[100:103], a[64:67], v[144:159]
    ds_read_b128 v[120:123], v19 offset:0
    ds_read_b128 v[124:127], v19 offset:8192
    s_bfe_u32 s17, s14, 0x40018
    s_lshl_b32 s17, s17, 8
    s_add_u32 s20, s16, s17
    s_add_u32 m0, s18, 98304
    s_waitcnt lgkmcnt(5)
    v_mfma_f32_32x32x16_bf16 v[160:175], v[104:107], a[64:67], v[160:175]
    buffer_load_dwordx4 v7, s[8:11], s20 offen sc0 sc1 lds
    s_add_u32 m0, s18, 99328
    s_waitcnt lgkmcnt(4)
    v_mfma_f32_32x32x16_bf16 v[184:199], v[108:111], a[64:67], v[184:199]
    buffer_load_dwordx4 v8, s[8:11], s20 offen sc0 sc1 lds
    s_waitcnt lgkmcnt(3)
    v_mfma_f32_32x32x16_bf16 v[128:143], v[112:115], a[68:71], v[128:143]
    ds_read_b128 v[96:99], v11 offset:0
    ds_read_b128 v[100:103], v11 offset:8192
    s_waitcnt lgkmcnt(4)
    v_mfma_f32_32x32x16_bf16 v[144:159], v[116:119], a[68:71], v[144:159]
    ds_read_b128 v[104:107], v20 offset:0
    ds_read_b128 v[108:111], v20 offset:8192
    s_add_u32 m0, s18, 100352
    s_waitcnt lgkmcnt(5)
    v_mfma_f32_32x32x16_bf16 v[160:175], v[120:123], a[68:71], v[160:175]
    buffer_load_dwordx4 v9, s[8:11], s20 offen sc0 sc1 lds
    s_add_u32 m0, s18, 101376
    s_waitcnt lgkmcnt(4)
    v_mfma_f32_32x32x16_bf16 v[184:199], v[124:127], a[68:71], v[184:199]
    buffer_load_dwordx4 v10, s[8:11], s20 offen sc0 sc1 lds
    s_waitcnt lgkmcnt(3)
    v_mfma_f32_32x32x16_bf16 v[128:143], v[96:99], a[72:75], v[128:143]
    ds_read_b128 v[112:115], v12 offset:0
    ds_read_b128 v[116:119], v12 offset:8192
    s_waitcnt lgkmcnt(4)
    v_mfma_f32_32x32x16_bf16 v[144:159], v[100:103], a[72:75], v[144:159]
    ds_read_b128 v[120:123], v21 offset:0
    ds_read_b128 v[124:127], v21 offset:8192
    s_add_u32 s21, s20, 65536
    s_add_u32 m0, s18, 102400
    s_waitcnt lgkmcnt(5)
    v_mfma_f32_32x32x16_bf16 v[160:175], v[104:107], a[72:75], v[160:175]
    buffer_load_dwordx4 v7, s[8:11], s21 offen sc0 sc1 lds
    s_add_u32 m0, s18, 103424
    s_waitcnt lgkmcnt(4)
    v_mfma_f32_32x32x16_bf16 v[184:199], v[108:111], a[72:75], v[184:199]
    buffer_load_dwordx4 v8, s[8:11], s21 offen sc0 sc1 lds
    s_waitcnt lgkmcnt(0)
    s_waitcnt vmcnt(15)
    s_barrier
    v_mfma_f32_32x32x16_bf16 v[128:143], v[112:115], a[76:79], v[128:143]
    ds_read_b128 v[96:99], v4 offset:32768
    ds_read_b128 v[100:103], v4 offset:40960
    v_mfma_f32_32x32x16_bf16 v[144:159], v[116:119], a[76:79], v[144:159]
    ds_read_b128 v[104:107], v18 offset:32768
    ds_read_b128 v[108:111], v18 offset:40960
    s_add_u32 m0, s18, 104448
    v_mfma_f32_32x32x16_bf16 v[160:175], v[120:123], a[76:79], v[160:175]
    buffer_load_dwordx4 v9, s[8:11], s21 offen sc0 sc1 lds
    s_add_u32 m0, s18, 105472
    v_mfma_f32_32x32x16_bf16 v[184:199], v[124:127], a[76:79], v[184:199]
    buffer_load_dwordx4 v10, s[8:11], s21 offen sc0 sc1 lds
    s_waitcnt lgkmcnt(3)
    v_mfma_f32_32x32x16_bf16 v[128:143], v[96:99], a[80:83], v[128:143]
    ds_read_b128 v[112:115], v5 offset:32768
    ds_read_b128 v[116:119], v5 offset:40960
    s_add_u32 m0, s47, 131072
    s_nop 0
    buffer_load_dwordx4 v35, s[56:59], s31 offen lds
    s_add_u32 s31, s31, 16384
    s_add_u32 m0, s47, 132096
    s_nop 0
    buffer_load_dwordx4 v35, s[56:59], s31 offen lds
    s_waitcnt lgkmcnt(4)
    v_mfma_f32_32x32x16_bf16 v[144:159], v[100:103], a[80:83], v[144:159]
    ds_read_b128 v[120:123], v19 offset:32768
    ds_read_b128 v[124:127], v19 offset:40960
    s_bfe_u32 s17, s14, 0x4001c
    s_lshl_b32 s17, s17, 8
    s_add_u32 s20, s16, s17
    s_add_u32 m0, s18, 0
    s_waitcnt lgkmcnt(5)
    v_mfma_f32_32x32x16_bf16 v[160:175], v[104:107], a[80:83], v[160:175]
    buffer_load_dwordx4 v7, s[8:11], s20 offen sc0 sc1 lds
    s_add_u32 s31, s31, 16384
    s_add_u32 m0, s47, 133120
    s_nop 0
    buffer_load_dwordx4 v35, s[56:59], s31 offen lds
    s_add_u32 s31, s31, 16384
    s_add_u32 m0, s18, 1024
    s_waitcnt lgkmcnt(4)
    v_mfma_f32_32x32x16_bf16 v[184:199], v[108:111], a[80:83], v[184:199]
    buffer_load_dwordx4 v8, s[8:11], s20 offen sc0 sc1 lds
    s_add_u32 m0, s47, 134144
    s_nop 0
    buffer_load_dwordx4 v35, s[56:59], s31 offen lds
    s_lshr_b32 s3, s47, 2
    s_add_u32 m0, s3, 147456
    s_nop 0
    buffer_load_dwordx4 v38, s[8:11], 0 offen sc0 sc1 lds
    s_waitcnt lgkmcnt(3)
    v_mfma_f32_32x32x16_bf16 v[128:143], v[112:115], a[84:87], v[128:143]
    ds_read_b128 v[96:99], v11 offset:32768
    ds_read_b128 v[100:103], v11 offset:40960
    s_waitcnt lgkmcnt(4)
    v_mfma_f32_32x32x16_bf16 v[144:159], v[116:119], a[84:87], v[144:159]
    ds_read_b128 v[104:107], v20 offset:32768
    ds_read_b128 v[108:111], v20 offset:40960
    s_add_u32 m0, s18, 2048
    s_waitcnt lgkmcnt(5)
    v_mfma_f32_32x32x16_bf16 v[160:175], v[120:123], a[84:87], v[160:175]
    buffer_load_dwordx4 v9, s[8:11], s20 offen sc0 sc1 lds
    s_add_u32 m0, s18, 3072
    s_waitcnt lgkmcnt(4)
    v_mfma_f32_32x32x16_bf16 v[184:199], v[124:127], a[84:87], v[184:199]
    buffer_load_dwordx4 v10, s[8:11], s20 offen sc0 sc1 lds
    s_waitcnt lgkmcnt(3)
    v_mfma_f32_32x32x16_bf16 v[128:143], v[96:99], a[88:91], v[128:143]
    ds_read_b128 v[112:115], v12 offset:32768
    ds_read_b128 v[116:119], v12 offset:40960
    s_waitcnt lgkmcnt(4)
    v_mfma_f32_32x32x16_bf16 v[144:159], v[100:103], a[88:91], v[144:159]
    ds_read_b128 v[120:123], v21 offset:32768
    ds_read_b128 v[124:127], v21 offset:40960
    s_add_u32 s21, s20, 65536
    s_add_u32 m0, s18, 4096
    s_waitcnt lgkmcnt(5)
    v_mfma_f32_32x32x16_bf16 v[160:175], v[104:107], a[88:91], v[160:175]
    buffer_load_dwordx4 v7, s[8:11], s21 offen sc0 sc1 lds
    s_add_u32 m0, s18, 5120
    s_waitcnt lgkmcnt(4)
    v_mfma_f32_32x32x16_bf16 v[184:199], v[108:111], a[88:91], v[184:199]
    buffer_load_dwordx4 v8, s[8:11], s21 offen sc0 sc1 lds
    s_waitcnt lgkmcnt(0)
    s_waitcnt vmcnt(20)
    s_barrier
    v_mfma_f32_32x32x16_bf16 v[128:143], v[112:115], a[92:95], v[128:143]
    ds_read_b128 v[96:99], v13 offset:0
    ds_read_b128 v[100:103], v13 offset:8192
    v_mfma_f32_32x32x16_bf16 v[144:159], v[116:119], a[92:95], v[144:159]
    ds_read_b128 v[104:107], v22 offset:0
    ds_read_b128 v[108:111], v22 offset:8192
    s_add_u32 m0, s18, 6144
    v_mfma_f32_32x32x16_bf16 v[160:175], v[120:123], a[92:95], v[160:175]
    buffer_load_dwordx4 v9, s[8:11], s21 offen sc0 sc1 lds
    s_add_u32 m0, s18, 7168
    v_mfma_f32_32x32x16_bf16 v[184:199], v[124:127], a[92:95], v[184:199]
    buffer_load_dwordx4 v10, s[8:11], s21 offen sc0 sc1 lds
    s_waitcnt lgkmcnt(3)
    v_mfma_f32_32x32x16_bf16 v[128:143], v[96:99], a[96:99], v[128:143]
    ds_read_b128 v[112:115], v14 offset:0
    ds_read_b128 v[116:119], v14 offset:8192
    s_waitcnt lgkmcnt(4)
    v_mfma_f32_32x32x16_bf16 v[144:159], v[100:103], a[96:99], v[144:159]
    ds_read_b128 v[120:123], v23 offset:0
    ds_read_b128 v[124:127], v23 offset:8192
    s_bfe_u32 s17, s15, 0x40000
    s_lshl_b32 s17, s17, 8
    s_add_u32 s20, s16, s17
    s_add_u32 m0, s18, 32768
    s_waitcnt lgkmcnt(5)
    v_mfma_f32_32x32x16_bf16 v[160:175], v[104:107], a[96:99], v[160:175]
    buffer_load_dwordx4 v7, s[8:11], s20 offen sc0 sc1 lds
    s_add_u32 m0, s18, 33792
    s_waitcnt lgkmcnt(4)
    v_mfma_f32_32x32x16_bf16 v[184:199], v[108:111], a[96:99], v[184:199]
    buffer_load_dwordx4 v8, s[8:11], s20 offen sc0 sc1 lds
    s_waitcnt lgkmcnt(3)
    v_mfma_f32_32x32x16_bf16 v[128:143], v[112:115], a[100:103], v[128:143]
    ds_read_b128 v[96:99], v15 offset:0
    ds_read_b128 v[100:103], v15 offset:8192
    s_waitcnt lgkmcnt(4)
    v_mfma_f32_32x32x16_bf16 v[144:159], v[116:119], a[100:103], v[144:159]
    ds_read_b128 v[104:107], v24 offset:0
    ds_read_b128 v[108:111], v24 offset:8192
    s_add_u32 m0, s18, 34816
    s_waitcnt lgkmcnt(5)
    v_mfma_f32_32x32x16_bf16 v[160:175], v[120:123], a[100:103], v[160:175]
    buffer_load_dwordx4 v9, s[8:11], s20 offen sc0 sc1 lds
    s_add_u32 m0, s18, 35840
    s_waitcnt lgkmcnt(4)
    v_mfma_f32_32x32x16_bf16 v[184:199], v[124:127], a[100:103], v[184:199]
    buffer_load_dwordx4 v10, s[8:11], s20 offen sc0 sc1 lds
    s_waitcnt lgkmcnt(3)
    v_mfma_f32_32x32x16_bf16 v[128:143], v[96:99], a[104:107], v[128:143]
    ds_read_b128 v[112:115], v16 offset:0
    ds_read_b128 v[116:119], v16 offset:8192
    s_waitcnt lgkmcnt(4)
    v_mfma_f32_32x32x16_bf16 v[144:159], v[100:103], a[104:107], v[144:159]
    ds_read_b128 v[120:123], v25 offset:0
    ds_read_b128 v[124:127], v25 offset:8192
    s_add_u32 s21, s20, 65536
    s_add_u32 m0, s18, 36864
    s_waitcnt lgkmcnt(5)
    v_mfma_f32_32x32x16_bf16 v[160:175], v[104:107], a[104:107], v[160:175]
    buffer_load_dwordx4 v7, s[8:11], s21 offen sc0 sc1 lds
    s_add_u32 m0, s18, 37888
    s_waitcnt lgkmcnt(4)
    v_mfma_f32_32x32x16_bf16 v[184:199], v[108:111], a[104:107], v[184:199]
    buffer_load_dwordx4 v8, s[8:11], s21 offen sc0 sc1 lds
    s_waitcnt lgkmcnt(0)
    s_waitcnt vmcnt(19)
    s_barrier
    v_mfma_f32_32x32x16_bf16 v[128:143], v[112:115], a[108:111], v[128:143]
    ds_read_b128 v[96:99], v13 offset:32768
    ds_read_b128 v[100:103], v13 offset:40960
    v_mfma_f32_32x32x16_bf16 v[144:159], v[116:119], a[108:111], v[144:159]
    ds_read_b128 v[104:107], v22 offset:32768
    ds_read_b128 v[108:111], v22 offset:40960
    s_add_u32 m0, s18, 38912
    v_mfma_f32_32x32x16_bf16 v[160:175], v[120:123], a[108:111], v[160:175]
    buffer_load_dwordx4 v9, s[8:11], s21 offen sc0 sc1 lds
    s_add_u32 m0, s18, 39936
    v_mfma_f32_32x32x16_bf16 v[184:199], v[124:127], a[108:111], v[184:199]
    buffer_load_dwordx4 v10, s[8:11], s21 offen sc0 sc1 lds
    s_waitcnt lgkmcnt(3)
    v_mfma_f32_32x32x16_bf16 v[128:143], v[96:99], a[112:115], v[128:143]
    ds_read_b128 v[112:115], v14 offset:32768
    ds_read_b128 v[116:119], v14 offset:40960
    s_waitcnt vmcnt(14)
    ds_read_b128 v[46:49], v39 offset:0
    ds_read_b128 v[84:87], v39 offset:256
    s_waitcnt lgkmcnt(6)
    v_mfma_f32_32x32x16_bf16 v[144:159], v[100:103], a[112:115], v[144:159]
    ds_read_b128 v[120:123], v23 offset:32768
    ds_read_b128 v[124:127], v23 offset:40960
    s_bfe_u32 s17, s15, 0x40004
    s_lshl_b32 s17, s17, 8
    s_add_u32 s20, s16, s17
    s_add_u32 m0, s18, 65536
    s_waitcnt lgkmcnt(7)
    v_mfma_f32_32x32x16_bf16 v[160:175], v[104:107], a[112:115], v[160:175]
    buffer_load_dwordx4 v7, s[8:11], s20 offen sc0 sc1 lds
    ds_read_b128 v[54:57], v39 offset:32
    ds_read_b128 v[88:91], v39 offset:288
    ds_read_b128 v[58:61], v39 offset:64
    s_add_u32 m0, s18, 66560
    s_waitcnt lgkmcnt(9)
    v_mfma_f32_32x32x16_bf16 v[184:199], v[108:111], a[112:115], v[184:199]
    buffer_load_dwordx4 v8, s[8:11], s20 offen sc0 sc1 lds
    ds_read_b128 v[92:95], v39 offset:320
    ds_read_b128 v[62:65], v39 offset:96
    ds_read_b128 v[176:179], v39 offset:352
    ds_read_b128 v[66:69], v39 offset:128
    s_waitcnt lgkmcnt(12)
    v_mfma_f32_32x32x16_bf16 v[128:143], v[112:115], a[116:119], v[128:143]
    ds_read_b128 v[96:99], v15 offset:32768
    ds_read_b128 v[100:103], v15 offset:40960
    ds_read_b128 v[200:203], v39 offset:384
    ds_read_b128 v[70:73], v39 offset:160
    ds_read_b128 v[204:207], v39 offset:416
    s_waitcnt lgkmcnt(15)
    v_mfma_f32_32x32x16_bf16 v[144:159], v[116:119], a[116:119], v[144:159]
    ds_read_b128 v[104:107], v24 offset:32768
    ds_read_b128 v[108:111], v24 offset:40960
    ds_read_b128 v[74:77], v39 offset:192
    ds_read_b128 v[208:211], v39 offset:448
    s_add_u32 m0, s18, 67584
    s_waitcnt lgkmcnt(15)
    v_mfma_f32_32x32x16_bf16 v[160:175], v[120:123], a[116:119], v[160:175]
    buffer_load_dwordx4 v9, s[8:11], s20 offen sc0 sc1 lds
    ds_read_b128 v[78:81], v39 offset:224
    ds_read_b128 v[212:215], v39 offset:480
    buffer_load_dwordx2 v[30:31], v29, s[8:11], 0 offen sc0 sc1
    s_add_u32 m0, s18, 68608
    v_mfma_f32_32x32x16_bf16 v[184:199], v[124:127], a[116:119], v[184:199]
    buffer_load_dwordx4 v10, s[8:11], s20 offen sc0 sc1 lds
    s_waitcnt lgkmcnt(10)
    v_mfma_f32_32x32x16_bf16 v[128:143], v[96:99], a[120:123], v[128:143]
    ds_read_b128 v[112:115], v16 offset:32768
    ds_read_b128 v[116:119], v16 offset:40960
    s_waitcnt lgkmcnt(11)
    v_mfma_f32_32x32x16_bf16 v[144:159], v[100:103], a[120:123], v[144:159]
    ds_read_b128 v[120:123], v25 offset:32768
    ds_read_b128 v[124:127], v25 offset:40960
    s_add_u32 s21, s20, 65536
    s_add_u32 m0, s18, 69632
    s_waitcnt lgkmcnt(9)
    v_mfma_f32_32x32x16_bf16 v[160:175], v[104:107], a[120:123], v[160:175]
    buffer_load_dwordx4 v7, s[8:11], s21 offen sc0 sc1 lds
    s_add_u32 m0, s18, 70656
    s_waitcnt lgkmcnt(8)
    v_mfma_f32_32x32x16_bf16 v[184:199], v[108:111], a[120:123], v[184:199]
    buffer_load_dwordx4 v8, s[8:11], s21 offen sc0 sc1 lds
    s_waitcnt lgkmcnt(0)
    s_waitcnt vmcnt(15)
    s_barrier
    v_mfma_f32_32x32x16_bf16 v[128:143], v[112:115], a[124:127], v[128:143]
    ds_read_b128 v[96:99], v4 offset:0
    ds_read_b128 v[100:103], v4 offset:8192
    v_mfma_f32_32x32x16_bf16 v[144:159], v[116:119], a[124:127], v[144:159]
    ds_read_b128 v[104:107], v18 offset:0
    ds_read_b128 v[108:111], v18 offset:8192
    s_add_u32 m0, s18, 71680
    v_mfma_f32_32x32x16_bf16 v[160:175], v[120:123], a[124:127], v[160:175]
    buffer_load_dwordx4 v9, s[8:11], s21 offen sc0 sc1 lds
    s_add_u32 m0, s18, 72704
    v_mfma_f32_32x32x16_bf16 v[184:199], v[124:127], a[124:127], v[184:199]
    buffer_load_dwordx4 v10, s[8:11], s21 offen sc0 sc1 lds
    s_waitcnt lgkmcnt(3)
    v_mfma_f32_32x32x16_bf16 v[128:143], v[96:99], a[128:131], v[128:143]
    ds_read_b128 v[112:115], v5 offset:0
    ds_read_b128 v[116:119], v5 offset:8192
    s_waitcnt lgkmcnt(4)
    v_mfma_f32_32x32x16_bf16 v[144:159], v[100:103], a[128:131], v[144:159]
    ds_read_b128 v[120:123], v19 offset:0
    ds_read_b128 v[124:127], v19 offset:8192
    s_bfe_u32 s17, s15, 0x40008
    s_lshl_b32 s17, s17, 8
    s_add_u32 s20, s16, s17
    s_add_u32 m0, s18, 98304
    s_waitcnt lgkmcnt(5)
    v_mfma_f32_32x32x16_bf16 v[160:175], v[104:107], a[128:131], v[160:175]
    buffer_load_dwordx4 v7, s[8:11], s20 offen sc0 sc1 lds
    s_add_u32 m0, s18, 99328
    s_waitcnt lgkmcnt(4)
    v_mfma_f32_32x32x16_bf16 v[184:199], v[108:111], a[128:131], v[184:199]
    buffer_load_dwordx4 v8, s[8:11], s20 offen sc0 sc1 lds
    s_waitcnt lgkmcnt(3)
    v_mfma_f32_32x32x16_bf16 v[128:143], v[112:115], a[132:135], v[128:143]
    ds_read_b128 v[96:99], v11 offset:0
    ds_read_b128 v[100:103], v11 offset:8192
    s_waitcnt lgkmcnt(4)
    v_mfma_f32_32x32x16_bf16 v[144:159], v[116:119], a[132:135], v[144:159]
    ds_read_b128 v[104:107], v20 offset:0
    ds_read_b128 v[108:111], v20 offset:8192
    s_add_u32 m0, s18, 100352
    s_waitcnt lgkmcnt(5)
    v_mfma_f32_32x32x16_bf16 v[160:175], v[120:123], a[132:135], v[160:175]
    buffer_load_dwordx4 v9, s[8:11], s20 offen sc0 sc1 lds
    s_add_u32 m0, s18, 101376
    s_waitcnt lgkmcnt(4)
    v_mfma_f32_32x32x16_bf16 v[184:199], v[124:127], a[132:135], v[184:199]
    buffer_load_dwordx4 v10, s[8:11], s20 offen sc0 sc1 lds
    s_waitcnt lgkmcnt(3)
    v_mfma_f32_32x32x16_bf16 v[128:143], v[96:99], a[136:139], v[128:143]
    ds_read_b128 v[112:115], v12 offset:0
    ds_read_b128 v[116:119], v12 offset:8192
    s_waitcnt lgkmcnt(4)
    v_mfma_f32_32x32x16_bf16 v[144:159], v[100:103], a[136:139], v[144:159]
    ds_read_b128 v[120:123], v21 offset:0
    ds_read_b128 v[124:127], v21 offset:8192
    s_add_u32 s21, s20, 65536
    s_add_u32 m0, s18, 102400
    s_waitcnt lgkmcnt(5)
    v_mfma_f32_32x32x16_bf16 v[160:175], v[104:107], a[136:139], v[160:175]
    buffer_load_dwordx4 v7, s[8:11], s21 offen sc0 sc1 lds
    s_add_u32 m0, s18, 103424
    s_waitcnt lgkmcnt(4)
    v_mfma_f32_32x32x16_bf16 v[184:199], v[108:111], a[136:139], v[184:199]
    buffer_load_dwordx4 v8, s[8:11], s21 offen sc0 sc1 lds
    s_waitcnt lgkmcnt(0)
    s_waitcnt vmcnt(15)
    s_barrier
    v_mfma_f32_32x32x16_bf16 v[128:143], v[112:115], a[140:143], v[128:143]
    ds_read_b128 v[96:99], v4 offset:32768
    ds_read_b128 v[100:103], v4 offset:40960
    v_mfma_f32_32x32x16_bf16 v[144:159], v[116:119], a[140:143], v[144:159]
    ds_read_b128 v[104:107], v18 offset:32768
    ds_read_b128 v[108:111], v18 offset:40960
    s_add_u32 m0, s18, 104448
    v_mfma_f32_32x32x16_bf16 v[160:175], v[120:123], a[140:143], v[160:175]
    buffer_load_dwordx4 v9, s[8:11], s21 offen sc0 sc1 lds
    s_add_u32 m0, s18, 105472
    v_mfma_f32_32x32x16_bf16 v[184:199], v[124:127], a[140:143], v[184:199]
    buffer_load_dwordx4 v10, s[8:11], s21 offen sc0 sc1 lds
    s_waitcnt lgkmcnt(3)
    v_mfma_f32_32x32x16_bf16 v[128:143], v[96:99], a[144:147], v[128:143]
    ds_read_b128 v[112:115], v5 offset:32768
    ds_read_b128 v[116:119], v5 offset:40960
    s_mov_b32 s4, 0
    s_waitcnt vmcnt(13)
    v_cmp_ne_u64 vcc, s[42:43], v[30:31]
    s_nop 4
    s_cbranch_vccz Lfdone_gate_13
Lfpoll_gate_14:
    buffer_load_dwordx2 v[30:31], v29, s[8:11], 0 offen sc0 sc1
    s_waitcnt vmcnt(0)
    v_cmp_ne_u64 vcc, s[42:43], v[30:31]
    s_nop 4
    s_add_u32 s4, s4, 1
    s_cmp_gt_u32 s4, 20000
    s_cbranch_scc1 Lfdone_gate_13
    s_cbranch_vccnz Lfpoll_gate_14
Lfdone_gate_13:
    s_add_u32 m0, s47, 147456
    s_nop 0
    buffer_load_dwordx4 v7, s[8:11], s38 offen sc0 sc1 lds
    s_add_u32 m0, s47, 148480
    s_nop 0
    buffer_load_dwordx4 v8, s[8:11], s38 offen sc0 sc1 lds
    s_waitcnt lgkmcnt(4)
    v_mfma_f32_32x32x16_bf16 v[144:159], v[100:103], a[144:147], v[144:159]
    ds_read_b128 v[120:123], v19 offset:32768
    ds_read_b128 v[124:127], v19 offset:40960
    s_bfe_u32 s17, s15, 0x4000c
    s_lshl_b32 s17, s17, 8
    s_add_u32 s20, s16, s17
    s_add_u32 m0, s18, 0
    s_waitcnt lgkmcnt(5)
    v_mfma_f32_32x32x16_bf16 v[160:175], v[104:107], a[144:147], v[160:175]
    buffer_load_dwordx4 v7, s[8:11], s20 offen sc0 sc1 lds
    s_add_u32 m0, s47, 149504
    s_nop 0
    buffer_load_dwordx4 v9, s[8:11], s38 offen sc0 sc1 lds
    s_add_u32 m0, s47, 150528
    s_nop 0
    buffer_load_dwordx4 v10, s[8:11], s38 offen sc0 sc1 lds
    s_add_u32 m0, s18, 1024
    s_waitcnt lgkmcnt(4)
    v_mfma_f32_32x32x16_bf16 v[184:199], v[108:111], a[144:147], v[184:199]
    buffer_load_dwordx4 v8, s[8:11], s20 offen sc0 sc1 lds
    s_waitcnt lgkmcnt(3)
    v_mfma_f32_32x32x16_bf16 v[128:143], v[112:115], a[148:151], v[128:143]
    ds_read_b128 v[96:99], v11 offset:32768
    ds_read_b128 v[100:103], v11 offset:40960
    s_waitcnt lgkmcnt(4)
    v_mfma_f32_32x32x16_bf16 v[144:159], v[116:119], a[148:151], v[144:159]
    ds_read_b128 v[104:107], v20 offset:32768
    ds_read_b128 v[108:111], v20 offset:40960
    s_add_u32 m0, s18, 2048
    s_waitcnt lgkmcnt(5)
    v_mfma_f32_32x32x16_bf16 v[160:175], v[120:123], a[148:151], v[160:175]
    buffer_load_dwordx4 v9, s[8:11], s20 offen sc0 sc1 lds
    s_add_u32 m0, s18, 3072
    s_waitcnt lgkmcnt(4)
    v_mfma_f32_32x32x16_bf16 v[184:199], v[124:127], a[148:151], v[184:199]
    buffer_load_dwordx4 v10, s[8:11], s20 offen sc0 sc1 lds
    s_waitcnt lgkmcnt(3)
    v_mfma_f32_32x32x16_bf16 v[128:143], v[96:99], a[152:155], v[128:143]
    ds_read_b128 v[112:115], v12 offset:32768
    ds_read_b128 v[116:119], v12 offset:40960
    s_waitcnt lgkmcnt(4)
    v_mfma_f32_32x32x16_bf16 v[144:159], v[100:103], a[152:155], v[144:159]
    ds_read_b128 v[120:123], v21 offset:32768
    ds_read_b128 v[124:127], v21 offset:40960
    s_add_u32 s21, s20, 65536
    s_add_u32 m0, s18, 4096
    s_waitcnt lgkmcnt(5)
    v_mfma_f32_32x32x16_bf16 v[160:175], v[104:107], a[152:155], v[160:175]
    buffer_load_dwordx4 v7, s[8:11], s21 offen sc0 sc1 lds
    s_add_u32 m0, s18, 5120
    s_waitcnt lgkmcnt(4)
    v_mfma_f32_32x32x16_bf16 v[184:199], v[108:111], a[152:155], v[184:199]
    buffer_load_dwordx4 v8, s[8:11], s21 offen sc0 sc1 lds
    s_waitcnt lgkmcnt(0)
    s_waitcnt vmcnt(18)
    s_barrier
    v_mfma_f32_32x32x16_bf16 v[128:143], v[112:115], a[156:159], v[128:143]
    ds_read_b128 v[96:99], v13 offset:0
    ds_read_b128 v[100:103], v13 offset:8192
    v_mfma_f32_32x32x16_bf16 v[144:159], v[116:119], a[156:159], v[144:159]
    ds_read_b128 v[104:107], v22 offset:0
    ds_read_b128 v[108:111], v22 offset:8192
    s_add_u32 m0, s18, 6144
    v_mfma_f32_32x32x16_bf16 v[160:175], v[120:123], a[156:159], v[160:175]
    buffer_load_dwordx4 v9, s[8:11], s21 offen sc0 sc1 lds
    s_add_u32 m0, s18, 7168
    v_mfma_f32_32x32x16_bf16 v[184:199], v[124:127], a[156:159], v[184:199]
    buffer_load_dwordx4 v10, s[8:11], s21 offen sc0 sc1 lds
    s_waitcnt lgkmcnt(3)
    v_mfma_f32_32x32x16_bf16 v[128:143], v[96:99], a[160:163], v[128:143]
    ds_read_b128 v[112:115], v14 offset:0
    ds_read_b128 v[116:119], v14 offset:8192
    s_waitcnt lgkmcnt(4)
    v_mfma_f32_32x32x16_bf16 v[144:159], v[100:103], a[160:163], v[144:159]
    ds_read_b128 v[120:123], v23 offset:0
    ds_read_b128 v[124:127], v23 offset:8192
    s_bfe_u32 s17, s15, 0x40010
    s_lshl_b32 s17, s17, 8
    s_add_u32 s20, s16, s17
    s_add_u32 m0, s18, 32768
    s_waitcnt lgkmcnt(5)
    v_mfma_f32_32x32x16_bf16 v[160:175], v[104:107], a[160:163], v[160:175]
    buffer_load_dwordx4 v7, s[8:11], s20 offen sc0 sc1 lds
    s_add_u32 m0, s18, 33792
    s_waitcnt lgkmcnt(4)
    v_mfma_f32_32x32x16_bf16 v[184:199], v[108:111], a[160:163], v[184:199]
    buffer_load_dwordx4 v8, s[8:11], s20 offen sc0 sc1 lds
    s_waitcnt lgkmcnt(3)
    v_mfma_f32_32x32x16_bf16 v[128:143], v[112:115], a[164:167], v[128:143]
    ds_read_b128 v[96:99], v15 offset:0
    ds_read_b128 v[100:103], v15 offset:8192
    s_waitcnt lgkmcnt(4)
    v_mfma_f32_32x32x16_bf16 v[144:159], v[116:119], a[164:167], v[144:159]
    ds_read_b128 v[104:107], v24 offset:0
    ds_read_b128 v[108:111], v24 offset:8192
    s_add_u32 m0, s18, 34816
    s_waitcnt lgkmcnt(5)
    v_mfma_f32_32x32x16_bf16 v[160:175], v[120:123], a[164:167], v[160:175]
    buffer_load_dwordx4 v9, s[8:11], s20 offen sc0 sc1 lds
    s_add_u32 m0, s18, 35840
    s_waitcnt lgkmcnt(4)
    v_mfma_f32_32x32x16_bf16 v[184:199], v[124:127], a[164:167], v[184:199]
    buffer_load_dwordx4 v10, s[8:11], s20 offen sc0 sc1 lds
    s_waitcnt lgkmcnt(3)
    v_mfma_f32_32x32x16_bf16 v[128:143], v[96:99], a[168:171], v[128:143]
    ds_read_b128 v[112:115], v16 offset:0
    ds_read_b128 v[116:119], v16 offset:8192
    s_waitcnt lgkmcnt(4)
    v_mfma_f32_32x32x16_bf16 v[144:159], v[100:103], a[168:171], v[144:159]
    ds_read_b128 v[120:123], v25 offset:0
    ds_read_b128 v[124:127], v25 offset:8192
    s_add_u32 s21, s20, 65536
    s_add_u32 m0, s18, 36864
    s_waitcnt lgkmcnt(5)
    v_mfma_f32_32x32x16_bf16 v[160:175], v[104:107], a[168:171], v[160:175]
    buffer_load_dwordx4 v7, s[8:11], s21 offen sc0 sc1 lds
    s_add_u32 m0, s18, 37888
    s_waitcnt lgkmcnt(4)
    v_mfma_f32_32x32x16_bf16 v[184:199], v[108:111], a[168:171], v[184:199]
    buffer_load_dwordx4 v8, s[8:11], s21 offen sc0 sc1 lds
    s_waitcnt lgkmcnt(0)
    s_waitcnt vmcnt(18)
    s_barrier
    v_mfma_f32_32x32x16_bf16 v[128:143], v[112:115], a[172:175], v[128:143]
    ds_read_b128 v[96:99], v13 offset:32768
    ds_read_b128 v[100:103], v13 offset:40960
    v_mfma_f32_32x32x16_bf16 v[144:159], v[116:119], a[172:175], v[144:159]
    ds_read_b128 v[104:107], v22 offset:32768
    ds_read_b128 v[108:111], v22 offset:40960
    s_add_u32 m0, s18, 38912
    v_mfma_f32_32x32x16_bf16 v[160:175], v[120:123], a[172:175], v[160:175]
    buffer_load_dwordx4 v9, s[8:11], s21 offen sc0 sc1 lds
    s_add_u32 m0, s18, 39936
    v_mfma_f32_32x32x16_bf16 v[184:199], v[124:127], a[172:175], v[184:199]
    buffer_load_dwordx4 v10, s[8:11], s21 offen sc0 sc1 lds
    s_waitcnt lgkmcnt(3)
    v_mfma_f32_32x32x16_bf16 v[128:143], v[96:99], a[176:179], v[128:143]
    ds_read_b128 v[112:115], v14 offset:32768
    ds_read_b128 v[116:119], v14 offset:40960
    s_waitcnt lgkmcnt(4)
    v_mfma_f32_32x32x16_bf16 v[144:159], v[100:103], a[176:179], v[144:159]
    ds_read_b128 v[120:123], v23 offset:32768
    ds_read_b128 v[124:127], v23 offset:40960
    s_bfe_u32 s17, s15, 0x40014
    s_lshl_b32 s17, s17, 8
    s_add_u32 s20, s16, s17
    s_add_u32 m0, s18, 65536
    s_waitcnt lgkmcnt(5)
    v_mfma_f32_32x32x16_bf16 v[160:175], v[104:107], a[176:179], v[160:175]
    buffer_load_dwordx4 v7, s[8:11], s20 offen sc0 sc1 lds
    s_add_u32 m0, s18, 66560
    s_waitcnt lgkmcnt(4)
    v_mfma_f32_32x32x16_bf16 v[184:199], v[108:111], a[176:179], v[184:199]
    buffer_load_dwordx4 v8, s[8:11], s20 offen sc0 sc1 lds
    s_waitcnt lgkmcnt(3)
    v_mfma_f32_32x32x16_bf16 v[128:143], v[112:115], a[180:183], v[128:143]
    ds_read_b128 v[96:99], v15 offset:32768
    ds_read_b128 v[100:103], v15 offset:40960
    s_waitcnt lgkmcnt(4)
    v_mfma_f32_32x32x16_bf16 v[144:159], v[116:119], a[180:183], v[144:159]
    ds_read_b128 v[104:107], v24 offset:32768
    ds_read_b128 v[108:111], v24 offset:40960
    s_add_u32 m0, s18, 67584
    s_waitcnt lgkmcnt(5)
    v_mfma_f32_32x32x16_bf16 v[160:175], v[120:123], a[180:183], v[160:175]
    buffer_load_dwordx4 v9, s[8:11], s20 offen sc0 sc1 lds
    s_add_u32 m0, s18, 68608
    s_waitcnt lgkmcnt(4)
    v_mfma_f32_32x32x16_bf16 v[184:199], v[124:127], a[180:183], v[184:199]
    buffer_load_dwordx4 v10, s[8:11], s20 offen sc0 sc1 lds
    s_waitcnt lgkmcnt(3)
    v_mfma_f32_32x32x16_bf16 v[128:143], v[96:99], a[184:187], v[128:143]
    ds_read_b128 v[112:115], v16 offset:32768
    ds_read_b128 v[116:119], v16 offset:40960
    s_waitcnt lgkmcnt(4)
    v_mfma_f32_32x32x16_bf16 v[144:159], v[100:103], a[184:187], v[144:159]
    ds_read_b128 v[120:123], v25 offset:32768
    ds_read_b128 v[124:127], v25 offset:40960
    s_add_u32 s21, s20, 65536
    s_add_u32 m0, s18, 69632
    s_waitcnt lgkmcnt(5)
    v_mfma_f32_32x32x16_bf16 v[160:175], v[104:107], a[184:187], v[160:175]
    buffer_load_dwordx4 v7, s[8:11], s21 offen sc0 sc1 lds
    s_add_u32 m0, s18, 70656
    s_waitcnt lgkmcnt(4)
    v_mfma_f32_32x32x16_bf16 v[184:199], v[108:111], a[184:187], v[184:199]
    buffer_load_dwordx4 v8, s[8:11], s21 offen sc0 sc1 lds
    s_waitcnt lgkmcnt(0)
    s_waitcnt vmcnt(14)
    s_barrier
    v_mfma_f32_32x32x16_bf16 v[128:143], v[112:115], a[188:191], v[128:143]
    ds_read_b128 v[96:99], v4 offset:0
    ds_read_b128 v[100:103], v4 offset:8192
    v_mfma_f32_32x32x16_bf16 v[144:159], v[116:119], a[188:191], v[144:159]
    ds_read_b128 v[104:107], v18 offset:0
    ds_read_b128 v[108:111], v18 offset:8192
    s_add_u32 m0, s18, 71680
    v_mfma_f32_32x32x16_bf16 v[160:175], v[120:123], a[188:191], v[160:175]
    buffer_load_dwordx4 v9, s[8:11], s21 offen sc0 sc1 lds
    s_add_u32 m0, s18, 72704
    v_mfma_f32_32x32x16_bf16 v[184:199], v[124:127], a[188:191], v[184:199]
    buffer_load_dwordx4 v10, s[8:11], s21 offen sc0 sc1 lds
    s_waitcnt lgkmcnt(3)
    v_mfma_f32_32x32x16_bf16 v[128:143], v[96:99], a[192:195], v[128:143]
    ds_read_b128 v[112:115], v5 offset:0
    ds_read_b128 v[116:119], v5 offset:8192
    v_lshlrev_b32 v52, 16, v52
    ds_read_b64_tr_b16 v[26:27], v36 offset:0
    v_xor_b32 v1, 0, v37
    s_waitcnt lgkmcnt(5)
    v_mfma_f32_32x32x16_bf16 v[144:159], v[100:103], a[192:195], v[144:159]
    ds_read_b128 v[120:123], v19 offset:0
    ds_read_b128 v[124:127], v19 offset:8192
    s_bfe_u32 s17, s15, 0x40018
    s_lshl_b32 s17, s17, 8
    s_add_u32 s20, s16, s17
    s_add_u32 m0, s18, 98304
    s_waitcnt lgkmcnt(6)
    v_mfma_f32_32x32x16_bf16 v[160:175], v[104:107], a[192:195], v[160:175]
    buffer_load_dwordx4 v7, s[8:11], s20 offen sc0 sc1 lds
    ds_read_b64 v[50:51], v1
    s_waitcnt lgkmcnt(0)
    v_lshlrev_b32 v216, 16, v50
    v_lshlrev_b32 v220, 16, v26
    s_add_u32 m0, s18, 99328
    v_mfma_f32_32x32x16_bf16 v[184:199], v[108:111], a[192:195], v[184:199]
    buffer_load_dwordx4 v8, s[8:11], s20 offen sc0 sc1 lds
    v_and_b32 v217, s5, v50
    v_and_b32 v221, s5, v26
    v_lshlrev_b32 v218, 16, v51
    v_lshlrev_b32 v222, 16, v27
    v_mfma_f32_32x32x16_bf16 v[128:143], v[112:115], a[196:199], v[128:143]
    ds_read_b128 v[96:99], v11 offset:0
    ds_read_b128 v[100:103], v11 offset:8192
    v_and_b32 v219, s5, v51
    v_and_b32 v223, s5, v27
    ds_read_b64_tr_b16 v[32:33], v36 offset:1024
    v_mfma_f32_32x32x16_bf16 v[144:159], v[116:119], a[196:199], v[144:159]
    ds_read_b128 v[104:107], v20 offset:0
    ds_read_b128 v[108:111], v20 offset:8192
    v_xor_b32 v1, 16, v37
    ds_read_b64 v[180:181], v1
    s_add_u32 m0, s18, 100352
    v_mfma_f32_32x32x16_bf16 v[160:175], v[120:123], a[196:199], v[160:175]
    buffer_load_dwordx4 v9, s[8:11], s20 offen sc0 sc1 lds
    v_mul_f32 v84, v84, v216
    v_mul_f32 v85, v85, v217
    v_mul_f32 v86, v86, v218
    s_add_u32 m0, s18, 101376
    v_mfma_f32_32x32x16_bf16 v[184:199], v[124:127], a[196:199], v[184:199]
    buffer_load_dwordx4 v10, s[8:11], s20 offen sc0 sc1 lds
    v_mul_f32 v87, v87, v219
    v_fmac_f32 v84, v46, v52
    v_fmac_f32 v85, v47, v52
    v_fmac_f32 v86, v48, v52
    s_waitcnt lgkmcnt(5)
    v_mfma_f32_32x32x16_bf16 v[128:143], v[96:99], a[200:203], v[128:143]
    ds_read_b128 v[112:115], v12 offset:0
    ds_read_b128 v[116:119], v12 offset:8192
    v_fmac_f32 v87, v49, v52
    v_mul_f32 v84, v84, v220
    v_mul_f32 v85, v85, v221
    s_waitcnt lgkmcnt(6)
    v_mfma_f32_32x32x16_bf16 v[144:159], v[100:103], a[200:203], v[144:159]
    ds_read_b128 v[120:123], v21 offset:0
    ds_read_b128 v[124:127], v21 offset:8192
    v_mul_f32 v86, v86, v222
    s_add_u32 s21, s20, 65536
    s_add_u32 m0, s18, 102400
    s_waitcnt lgkmcnt(6)
    v_mfma_f32_32x32x16_bf16 v[160:175], v[104:107], a[200:203], v[160:175]
    buffer_load_dwordx4 v7, s[8:11], s21 offen sc0 sc1 lds
    v_mul_f32 v87, v87, v223
    s_waitcnt lgkmcnt(4)
    v_lshlrev_b32 v216, 16, v180
    v_lshlrev_b32 v220, 16, v32
    s_add_u32 m0, s18, 103424
    v_mfma_f32_32x32x16_bf16 v[184:199], v[108:111], a[200:203], v[184:199]
    buffer_load_dwordx4 v8, s[8:11], s21 offen sc0 sc1 lds
    v_and_b32 v217, s5, v180
    v_and_b32 v221, s5, v32
    v_lshlrev_b32 v218, 16, v181
    v_lshlrev_b32 v222, 16, v33
    s_waitcnt lgkmcnt(0)
    s_waitcnt vmcnt(14)
    s_barrier
    v_mfma_f32_32x32x16_bf16 v[128:143], v[112:115], a[204:207], v[128:143]
    ds_read_b128 v[96:99], v4 offset:32768
    ds_read_b128 v[100:103], v4 offset:40960
    v_and_b32 v219, s5, v181
    v_and_b32 v223, s5, v33
    ds_read_b64_tr_b16 v[26:27], v36 offset:2048
    v_mfma_f32_32x32x16_bf16 v[144:159], v[116:119], a[204:207], v[144:159]
    ds_read_b128 v[104:107], v18 offset:32768
    ds_read_b128 v[108:111], v18 offset:40960
    v_xor_b32 v1, 32, v37
    ds_read_b64 v[50:51], v1
    s_add_u32 m0, s18, 104448
    v_mfma_f32_32x32x16_bf16 v[160:175], v[120:123], a[204:207], v[160:175]
    buffer_load_dwordx4 v9, s[8:11], s21 offen sc0 sc1 lds
    v_mul_f32 v88, v88, v216
    v_mul_f32 v89, v89, v217
    v_mul_f32 v90, v90, v218
    s_add_u32 m0, s18, 105472
    v_mfma_f32_32x32x16_bf16 v[184:199], v[124:127], a[204:207], v[184:199]
    buffer_load_dwordx4 v10, s[8:11], s21 offen sc0 sc1 lds
    v_mul_f32 v91, v91, v219
    v_fmac_f32 v88, v54, v52
    v_fmac_f32 v89, v55, v52
    v_fmac_f32 v90, v56, v52
    s_waitcnt lgkmcnt(5)
    v_mfma_f32_32x32x16_bf16 v[128:143], v[96:99], a[208:211], v[128:143]
    ds_read_b128 v[112:115], v5 offset:32768
    ds_read_b128 v[116:119], v5 offset:40960
    v_fmac_f32 v91, v57, v52
    v_mul_f32 v88, v88, v220
    v_mul_f32 v89, v89, v221
    s_waitcnt lgkmcnt(6)
    v_mfma_f32_32x32x16_bf16 v[144:159], v[100:103], a[208:211], v[144:159]
    ds_read_b128 v[120:123], v19 offset:32768
    ds_read_b128 v[124:127], v19 offset:40960
    v_mul_f32 v90, v90, v222
    v_mul_f32 v91, v91, v223
    s_waitcnt lgkmcnt(4)
    v_lshlrev_b32 v216, 16, v50
    v_mfma_f32_32x32x16_bf16 v[160:175], v[104:107], a[208:211], v[160:175]
    v_lshlrev_b32 v220, 16, v26
    v_and_b32 v217, s5, v50
    v_and_b32 v221, s5, v26
    v_lshlrev_b32 v218, 16, v51
    v_lshlrev_b32 v222, 16, v27
    v_mfma_f32_32x32x16_bf16 v[184:199], v[108:111], a[208:211], v[184:199]
    v_and_b32 v219, s5, v51
    v_and_b32 v223, s5, v27
    ds_read_b64_tr_b16 v[32:33], v36 offset:3072
    v_xor_b32 v1, 48, v37
    ds_read_b64 v[180:181], v1
    s_waitcnt lgkmcnt(5)
    v_mfma_f32_32x32x16_bf16 v[128:143], v[112:115], a[212:215], v[128:143]
    ds_read_b128 v[96:99], v11 offset:32768
    ds_read_b128 v[100:103], v11 offset:40960
    v_mul_f32 v92, v92, v216
    v_mul_f32 v93, v93, v217
    v_mul_f32 v94, v94, v218
    s_waitcnt lgkmcnt(6)
    v_mfma_f32_32x32x16_bf16 v[144:159], v[116:119], a[212:215], v[144:159]
    ds_read_b128 v[104:107], v20 offset:32768
    ds_read_b128 v[108:111], v20 offset:40960
    v_mul_f32 v95, v95, v219
    v_fmac_f32 v92, v58, v52
    v_fmac_f32 v93, v59, v52
    s_waitcnt lgkmcnt(7)
    v_mfma_f32_32x32x16_bf16 v[160:175], v[120:123], a[212:215], v[160:175]
    v_fmac_f32 v94, v60, v52
    v_fmac_f32 v95, v61, v52
    v_mul_f32 v92, v92, v220
    v_mul_f32 v93, v93, v221
    v_mul_f32 v94, v94, v222
    s_waitcnt lgkmcnt(6)
    v_mfma_f32_32x32x16_bf16 v[184:199], v[124:127], a[212:215], v[184:199]
    v_mul_f32 v95, v95, v223
    s_waitcnt lgkmcnt(4)
    v_lshlrev_b32 v216, 16, v180
    v_lshlrev_b32 v220, 16, v32
    v_and_b32 v217, s5, v180
    v_and_b32 v221, s5, v32
    s_waitcnt lgkmcnt(3)
    v_mfma_f32_32x32x16_bf16 v[128:143], v[96:99], a[216:219], v[128:143]
    ds_read_b128 v[112:115], v12 offset:32768
    ds_read_b128 v[116:119], v12 offset:40960
    v_lshlrev_b32 v218, 16, v181
    v_lshlrev_b32 v222, 16, v33
    v_and_b32 v219, s5, v181
    s_waitcnt lgkmcnt(4)
    v_mfma_f32_32x32x16_bf16 v[144:159], v[100:103], a[216:219], v[144:159]
    ds_read_b128 v[120:123], v21 offset:32768
    ds_read_b128 v[124:127], v21 offset:40960
    v_and_b32 v223, s5, v33
    ds_read_b64_tr_b16 v[26:27], v36 offset:4096
    v_xor_b32 v1, 64, v37
    s_waitcnt lgkmcnt(6)
    v_mfma_f32_32x32x16_bf16 v[160:175], v[104:107], a[216:219], v[160:175]
    ds_read_b64 v[50:51], v1
    v_mul_f32 v176, v176, v216
    v_mul_f32 v177, v177, v217
    v_mul_f32 v178, v178, v218
    v_mul_f32 v179, v179, v219
    s_waitcnt lgkmcnt(6)
    v_mfma_f32_32x32x16_bf16 v[184:199], v[108:111], a[216:219], v[184:199]
    v_fmac_f32 v176, v62, v52
    v_fmac_f32 v177, v63, v52
    v_fmac_f32 v178, v64, v52
    v_fmac_f32 v179, v65, v52
    v_mul_f32 v176, v176, v220
    s_waitcnt lgkmcnt(2)
    s_waitcnt vmcnt(8)
    s_waitcnt vmcnt(0)
    s_barrier
    v_mfma_f32_32x32x16_bf16 v[128:143], v[112:115], a[220:223], v[128:143]
    ds_read_b128 v[96:99], v22 offset:0
    ds_read_b128 v[100:103], v23 offset:0
    v_mul_f32 v177, v177, v221
    v_mul_f32 v178, v178, v222
    v_mul_f32 v179, v179, v223
    v_mfma_f32_32x32x16_bf16 v[144:159], v[116:119], a[220:223], v[144:159]
    ds_read_b128 v[104:107], v24 offset:0
    ds_read_b128 v[108:111], v25 offset:0
    s_waitcnt lgkmcnt(4)
    v_lshlrev_b32 v216, 16, v50
    v_lshlrev_b32 v220, 16, v26
    v_and_b32 v217, s5, v50
    v_mfma_f32_32x32x16_bf16 v[160:175], v[120:123], a[220:223], v[160:175]
    v_and_b32 v221, s5, v26
    v_lshlrev_b32 v218, 16, v51
    v_lshlrev_b32 v222, 16, v27
    v_and_b32 v219, s5, v51
    v_and_b32 v223, s5, v27
    v_mfma_f32_32x32x16_bf16 v[184:199], v[124:127], a[220:223], v[184:199]
    ds_read_b64_tr_b16 v[32:33], v36 offset:5120
    v_xor_b32 v1, 80, v37
    ds_read_b64 v[180:181], v1
    v_mul_f32 v200, v200, v216
    v_mul_f32 v201, v201, v217
    s_waitcnt lgkmcnt(5)
    v_mfma_f32_32x32x16_bf16 v[160:175], v[96:99], a[224:227], v[160:175]
    ds_read_b128 v[112:115], v22 offset:32768
    ds_read_b128 v[116:119], v23 offset:32768
    v_mul_f32 v202, v202, v218
    v_mul_f32 v203, v203, v219
    v_fmac_f32 v200, v66, v52
    s_waitcnt lgkmcnt(6)
    v_mfma_f32_32x32x16_bf16 v[160:175], v[100:103], a[228:231], v[160:175]
    ds_read_b128 v[120:123], v24 offset:32768
    ds_read_b128 v[124:127], v25 offset:32768
    v_fmac_f32 v201, v67, v52
    v_fmac_f32 v202, v68, v52
    v_fmac_f32 v203, v69, v52
    s_waitcnt lgkmcnt(7)
    v_mfma_f32_32x32x16_bf16 v[160:175], v[104:107], a[232:235], v[160:175]
    v_mul_f32 v200, v200, v220
    v_mul_f32 v201, v201, v221
    v_mul_f32 v202, v202, v222
    v_mul_f32 v203, v203, v223
    s_waitcnt lgkmcnt(4)
    v_lshlrev_b32 v216, 16, v180
    v_mfma_f32_32x32x16_bf16 v[160:175], v[108:111], a[236:239], v[160:175]
    v_lshlrev_b32 v220, 16, v32
    v_and_b32 v217, s5, v180
    v_and_b32 v221, s5, v32
    v_lshlrev_b32 v218, 16, v181
    v_lshlrev_b32 v222, 16, v33
    s_waitcnt lgkmcnt(3)
    v_mfma_f32_32x32x16_bf16 v[160:175], v[112:115], a[240:243], v[160:175]
    ds_read_b128 v[96:99], v13 offset:0
    ds_read_b128 v[100:103], v14 offset:0
    v_and_b32 v219, s5, v181
    v_and_b32 v223, s5, v33
    ds_read_b64_tr_b16 v[26:27], v36 offset:6144
    s_waitcnt lgkmcnt(5)
    v_mfma_f32_32x32x16_bf16 v[160:175], v[116:119], a[244:247], v[160:175]
    ds_read_b128 v[104:107], v15 offset:0
    ds_read_b128 v[108:111], v16 offset:0
    v_xor_b32 v1, 96, v37
    ds_read_b64 v[50:51], v1
    v_mul_f32 v204, v204, v216
    s_waitcnt lgkmcnt(7)
    v_mfma_f32_32x32x16_bf16 v[160:175], v[120:123], a[248:251], v[160:175]
    v_mul_f32 v205, v205, v217
    v_mul_f32 v206, v206, v218
    v_mul_f32 v207, v207, v219
    v_fmac_f32 v204, v70, v52
    v_fmac_f32 v205, v71, v52
    s_waitcnt lgkmcnt(6)
    v_mfma_f32_32x32x16_bf16 v[160:175], v[124:127], a[252:255], v[160:175]
    v_fmac_f32 v206, v72, v52
    v_fmac_f32 v207, v73, v52
    v_mul_f32 v204, v204, v220
    v_mul_f32 v205, v205, v221
    v_mul_f32 v206, v206, v222
    s_waitcnt lgkmcnt(5)
    v_mfma_f32_32x32x16_bf16 v[128:143], v[96:99], a[224:227], v[128:143]
    ds_read_b128 v[112:115], v13 offset:32768
    ds_read_b128 v[116:119], v14 offset:32768
    v_mul_f32 v207, v207, v223
    s_waitcnt lgkmcnt(2)
    v_lshlrev_b32 v216, 16, v50
    v_lshlrev_b32 v220, 16, v26
    v_mfma_f32_32x32x16_bf16 v[128:143], v[100:103], a[228:231], v[128:143]
    ds_read_b128 v[120:123], v15 offset:32768
    ds_read_b128 v[124:127], v16 offset:32768
    ds_write_b128 v44, v[160:163] offset:0
    v_and_b32 v217, s5, v50
    v_and_b32 v221, s5, v26
    v_mfma_f32_32x32x16_bf16 v[128:143], v[104:107], a[232:235], v[128:143]
    ds_write_b128 v44, v[164:167] offset:1024
    ds_write_b128 v44, v[168:171] offset:2048
    v_lshlrev_b32 v218, 16, v51
    v_lshlrev_b32 v222, 16, v27
    v_and_b32 v219, s5, v51
    v_mfma_f32_32x32x16_bf16 v[128:143], v[108:111], a[236:239], v[128:143]
    ds_write_b128 v44, v[172:175] offset:3072
    v_and_b32 v223, s5, v27
    ds_read_b64_tr_b16 v[32:33], v36 offset:7168
    v_xor_b32 v1, 112, v37
    ds_read_b64 v[180:181], v1
    v_mul_f32 v208, v208, v216
    v_mul_f32 v209, v209, v217
    v_mul_f32 v210, v210, v218
    v_mul_f32 v211, v211, v219
    v_fmac_f32 v208, v74, v52
    v_fmac_f32 v209, v75, v52
    v_fmac_f32 v210, v76, v52
    v_fmac_f32 v211, v77, v52
    v_mul_f32 v208, v208, v220
    v_mul_f32 v209, v209, v221
    v_mul_f32 v210, v210, v222
    v_mul_f32 v211, v211, v223
    s_waitcnt lgkmcnt(0)
    v_lshlrev_b32 v216, 16, v180
    v_lshlrev_b32 v220, 16, v32
    v_and_b32 v217, s5, v180
    v_and_b32 v221, s5, v32
    v_lshlrev_b32 v218, 16, v181
    v_lshlrev_b32 v222, 16, v33
    v_and_b32 v219, s5, v181
    v_and_b32 v223, s5, v33
    v_mul_f32 v212, v212, v216
    v_mul_f32 v213, v213, v217
    v_mul_f32 v214, v214, v218
    v_mul_f32 v215, v215, v219
    v_fmac_f32 v212, v78, v52
    v_fmac_f32 v213, v79, v52
    v_fmac_f32 v214, v80, v52
    v_fmac_f32 v215, v81, v52
    v_mul_f32 v212, v212, v220
    v_mul_f32 v213, v213, v221
    v_mul_f32 v214, v214, v222
    v_mul_f32 v215, v215, v223
    v_mfma_f32_32x32x16_bf16 v[128:143], v[112:115], a[240:243], v[128:143]
    ds_read_b128 v[96:99], v22 offset:8192
    ds_read_b128 v[100:103], v23 offset:8192
    v_mfma_f32_32x32x16_bf16 v[128:143], v[116:119], a[244:247], v[128:143]
    ds_read_b128 v[104:107], v24 offset:8192
    ds_read_b128 v[108:111], v25 offset:8192
    v_mfma_f32_32x32x16_bf16 v[128:143], v[120:123], a[248:251], v[128:143]
    s_barrier
    ds_read_b128 v[224:227], v45 offset:0
    ds_read_b128 v[228:231], v45 offset:1024
    v_mfma_f32_32x32x16_bf16 v[128:143], v[124:127], a[252:255], v[128:143]
    ds_read_b128 v[232:235], v45 offset:2048
    ds_read_b128 v[236:239], v45 offset:3072
    s_waitcnt lgkmcnt(7)
    v_mfma_f32_32x32x16_bf16 v[184:199], v[96:99], a[224:227], v[184:199]
    ds_read_b128 v[112:115], v22 offset:40960
    ds_read_b128 v[116:119], v23 offset:40960
    s_waitcnt lgkmcnt(8)
    v_mfma_f32_32x32x16_bf16 v[184:199], v[100:103], a[228:231], v[184:199]
    ds_read_b128 v[120:123], v24 offset:40960
    ds_read_b128 v[124:127], v25 offset:40960
    s_waitcnt lgkmcnt(7)
    s_nop 0
    v_add_f32 v128, v128, v224
    v_add_f32 v129, v129, v225
    v_add_f32 v130, v130, v226
    v_mfma_f32_32x32x16_bf16 v[184:199], v[104:107], a[232:235], v[184:199]
    v_add_f32 v131, v131, v227
    v_fma_f32 v128, v46, v128, v84
    v_fma_f32 v129, v47, v129, v85
    v_fma_f32 v130, v48, v130, v86
    v_fma_f32 v131, v49, v131, v87
    v_mfma_f32_32x32x16_bf16 v[184:199], v[108:111], a[236:239], v[184:199]
    buffer_store_dword v128, v40, s[32:35], s39 offen sc1
    buffer_store_dword v129, v41, s[32:35], s39 offen sc1
    buffer_store_dword v130, v42, s[32:35], s39 offen sc1
    buffer_store_dword v131, v43, s[32:35], s39 offen sc1
    s_waitcnt lgkmcnt(6)
    v_add_f32 v132, v132, v228
    s_waitcnt lgkmcnt(3)
    v_mfma_f32_32x32x16_bf16 v[184:199], v[112:115], a[240:243], v[184:199]
    ds_read_b128 v[96:99], v13 offset:8192
    ds_read_b128 v[100:103], v14 offset:8192
    v_add_f32 v133, v133, v229
    v_add_f32 v134, v134, v230
    v_add_f32 v135, v135, v231
    s_waitcnt lgkmcnt(4)
    v_mfma_f32_32x32x16_bf16 v[184:199], v[116:119], a[244:247], v[184:199]
    ds_read_b128 v[104:107], v15 offset:8192
    ds_read_b128 v[108:111], v16 offset:8192
    v_fma_f32 v132, v54, v132, v88
    v_fma_f32 v133, v55, v133, v89
    v_fma_f32 v134, v56, v134, v90
    s_waitcnt lgkmcnt(5)
    v_mfma_f32_32x32x16_bf16 v[184:199], v[120:123], a[248:251], v[184:199]
    v_fma_f32 v135, v57, v135, v91
    s_add_u32 s39, s39, 32768
    buffer_store_dword v132, v40, s[32:35], s39 offen sc1
    buffer_store_dword v133, v41, s[32:35], s39 offen sc1
    buffer_store_dword v134, v42, s[32:35], s39 offen sc1
    s_waitcnt lgkmcnt(4)
    v_mfma_f32_32x32x16_bf16 v[184:199], v[124:127], a[252:255], v[184:199]
    buffer_store_dword v135, v43, s[32:35], s39 offen sc1
    v_add_f32 v136, v136, v232
    v_add_f32 v137, v137, v233
    v_add_f32 v138, v138, v234
    v_add_f32 v139, v139, v235
    s_waitcnt lgkmcnt(3)
    v_mfma_f32_32x32x16_bf16 v[144:159], v[96:99], a[224:227], v[144:159]
    ds_read_b128 v[112:115], v13 offset:40960
    ds_read_b128 v[116:119], v14 offset:40960
    v_fma_f32 v136, v58, v136, v92
    v_fma_f32 v137, v59, v137, v93
    v_fma_f32 v138, v60, v138, v94
    s_waitcnt lgkmcnt(4)
    v_mfma_f32_32x32x16_bf16 v[144:159], v[100:103], a[228:231], v[144:159]
    ds_read_b128 v[120:123], v15 offset:40960
    ds_read_b128 v[124:127], v16 offset:40960
    ds_write_b128 v44, v[184:187] offset:4096
    v_fma_f32 v139, v61, v139, v95
    s_add_u32 s39, s39, 32768
    s_waitcnt lgkmcnt(6)
    v_mfma_f32_32x32x16_bf16 v[144:159], v[104:107], a[232:235], v[144:159]
    ds_write_b128 v44, v[188:191] offset:5120
    ds_write_b128 v44, v[192:195] offset:6144
    buffer_store_dword v136, v40, s[32:35], s39 offen sc1
    buffer_store_dword v137, v41, s[32:35], s39 offen sc1
    buffer_store_dword v138, v42, s[32:35], s39 offen sc1
    s_waitcnt lgkmcnt(7)
    v_mfma_f32_32x32x16_bf16 v[144:159], v[108:111], a[236:239], v[144:159]
    ds_write_b128 v44, v[196:199] offset:7168
    buffer_store_dword v139, v43, s[32:35], s39 offen sc1
    v_add_f32 v140, v140, v236
    v_add_f32 v141, v141, v237
    v_add_f32 v142, v142, v238
    s_waitcnt lgkmcnt(7)
    v_mfma_f32_32x32x16_bf16 v[144:159], v[112:115], a[240:243], v[144:159]
    v_add_f32 v143, v143, v239
    v_fma_f32 v140, v62, v140, v176
    v_fma_f32 v141, v63, v141, v177
    v_fma_f32 v142, v64, v142, v178
    v_fma_f32 v143, v65, v143, v179
    s_waitcnt lgkmcnt(6)
    v_mfma_f32_32x32x16_bf16 v[144:159], v[116:119], a[244:247], v[144:159]
    s_add_u32 s39, s39, 32768
    buffer_store_dword v140, v40, s[32:35], s39 offen sc1
    buffer_store_dword v141, v41, s[32:35], s39 offen sc1
    buffer_store_dword v142, v42, s[32:35], s39 offen sc1
    buffer_store_dword v143, v43, s[32:35], s39 offen sc1
    s_waitcnt lgkmcnt(5)
    v_mfma_f32_32x32x16_bf16 v[144:159], v[120:123], a[248:251], v[144:159]
    s_waitcnt lgkmcnt(0)
    s_barrier
    ds_read_b128 v[96:99], v45 offset:4096
    ds_read_b128 v[100:103], v45 offset:5120
    v_mfma_f32_32x32x16_bf16 v[144:159], v[124:127], a[252:255], v[144:159]
    ds_read_b128 v[104:107], v45 offset:6144
    ds_read_b128 v[108:111], v45 offset:7168
    s_waitcnt lgkmcnt(3)
    s_nop 8
    v_add_f32 v144, v144, v96
    v_add_f32 v145, v145, v97
    v_add_f32 v146, v146, v98
    v_add_f32 v147, v147, v99
    v_fma_f32 v144, v66, v144, v200
    v_fma_f32 v145, v67, v145, v201
    v_fma_f32 v146, v68, v146, v202
    v_fma_f32 v147, v69, v147, v203
    s_add_u32 s39, s39, 32768
    buffer_store_dword v144, v40, s[32:35], s39 offen sc1
    buffer_store_dword v145, v41, s[32:35], s39 offen sc1
    buffer_store_dword v146, v42, s[32:35], s39 offen sc1
    buffer_store_dword v147, v43, s[32:35], s39 offen sc1
    s_waitcnt lgkmcnt(2)
    v_add_f32 v148, v148, v100
    v_add_f32 v149, v149, v101
    v_add_f32 v150, v150, v102
    v_add_f32 v151, v151, v103
    v_fma_f32 v148, v70, v148, v204
    v_fma_f32 v149, v71, v149, v205
    v_fma_f32 v150, v72, v150, v206
    v_fma_f32 v151, v73, v151, v207
    s_add_u32 s39, s39, 32768
    buffer_store_dword v148, v40, s[32:35], s39 offen sc1
    buffer_store_dword v149, v41, s[32:35], s39 offen sc1
    buffer_store_dword v150, v42, s[32:35], s39 offen sc1
    buffer_store_dword v151, v43, s[32:35], s39 offen sc1
    s_waitcnt lgkmcnt(1)
    v_add_f32 v152, v152, v104
    v_add_f32 v153, v153, v105
    v_add_f32 v154, v154, v106
    v_add_f32 v155, v155, v107
    v_fma_f32 v152, v74, v152, v208
    v_fma_f32 v153, v75, v153, v209
    v_fma_f32 v154, v76, v154, v210
    v_fma_f32 v155, v77, v155, v211
    s_add_u32 s39, s39, 32768
    buffer_store_dword v152, v40, s[32:35], s39 offen sc1
    buffer_store_dword v153, v41, s[32:35], s39 offen sc1
    buffer_store_dword v154, v42, s[32:35], s39 offen sc1
    buffer_store_dword v155, v43, s[32:35], s39 offen sc1
    s_waitcnt lgkmcnt(0)
    v_add_f32 v156, v156, v108
    v_add_f32 v157, v157, v109
    v_add_f32 v158, v158, v110
    v_add_f32 v159, v159, v111
    v_fma_f32 v156, v78, v156, v212
    v_fma_f32 v157, v79, v157, v213
    v_fma_f32 v158, v80, v158, v214
    v_fma_f32 v159, v81, v159, v215
    s_add_u32 s39, s39, 32768
    buffer_store_dword v156, v40, s[32:35], s39 offen sc1
    buffer_store_dword v157, v41, s[32:35], s39 offen sc1
    buffer_store_dword v158, v42, s[32:35], s39 offen sc1
    buffer_store_dword v159, v43, s[32:35], s39 offen sc1
Lend_gated_mix__ssm_conv_s5__ssm_conv_h3__prompt_kernel:
Lcode_last:
    s_endpgm

.section .rodata,"a"
.p2align 6
.amdhsa_kernel gated_mix__ssm_conv_s5__ssm_conv_h3__prompt_kernel
  .amdhsa_next_free_vgpr 504
  .amdhsa_next_free_sgpr 92
  .amdhsa_accum_offset 248
  .amdhsa_group_segment_fixed_size 0
  .amdhsa_kernarg_size 152
  .amdhsa_user_sgpr_count 2
  .amdhsa_user_sgpr_kernarg_segment_ptr 1
  .amdhsa_system_sgpr_workgroup_id_x 1
  .amdhsa_float_denorm_mode_32 3
.end_amdhsa_kernel
```
